```python
import torch

def _softmax(x, axis=-1):
    return torch.softmax(x, dim=axis)

def _gelu(x):
    return torch.nn.functional.gelu(x, approximate='tanh')

def _silu(x):
    return torch.nn.functional.silu(x)

def _sigmoid(x):
    return torch.sigmoid(x)

def _layernorm(x, axis=-1, eps=1e-05):
    m = x.mean(dim=axis, keepdim=True)
    v = x.var(dim=axis, keepdim=True, unbiased=False)
    return (x - m) / torch.sqrt(v + eps)

def _scatter_add(tgt, idx, src, axis=0):
    return tgt.clone().index_add_(axis, idx, src)

def _segment_sum(src, seg, n):
    out = torch.zeros((n,) + src.shape[1:], dtype=src.dtype)
    return out.index_add_(0, seg, src)

def _pad(x, pw):
    flat = tuple((v for pair in reversed(pw) for v in pair))
    return torch.nn.functional.pad(x, flat)
kernel_name = 'standalone__tensor_product_equiv_tfn__graph'

def setup_inputs():

    _w = lambda a: (lambda t: t.to(torch.bfloat16) if t.is_floating_point() else t)(torch.as_tensor(a))
    N, deg, C, L, DE = (10000, 32, 128, 1, 16)
    E = N * deg
    M = (L + 1) ** 2
    src = (lambda lo, hi, *s: torch.randint(lo, hi, s))(0, N, E).to(torch.int64)
    dst = (lambda lo, hi, *s: torch.randint(lo, hi, s))(0, N, E).to(torch.int64)
    r = (lambda *s: torch.randn(*s, dtype=torch.bfloat16) * 0.05)(E, 3)
    r = r / (torch.linalg.norm(r, dim=-1, keepdim=True) + 1e-09)
    rx, ry, rz = (r[:, 0].clone(), r[:, 1].clone(), r[:, 2].clone())
    Ys = [torch.ones((E, 1), dtype=float)]
    if L >= 1:
        Ys.append(r.to(float))
    if L >= 2:
        Ys.append(torch.stack([2 * rx * ry, 2 * ry * rz, (3 * rz * rz - 1.0) / (lambda _x: torch.sqrt(torch.as_tensor(_x)))(3.0), 2 * rx * rz, rx * rx - ry * ry], dim=-1).to(float))
    for _l in range(3, L + 1):
        Ys.append(((lambda *s: torch.randn(*s, dtype=torch.bfloat16) * 0.05)(E, 2 * _l + 1) * 0.3).to(float))
    Y = torch.cat(Ys, dim=-1)
    cg = torch.zeros((M, M, M), dtype=float)
    off = [_l * _l for _l in range(L + 2)]
    for l1 in range(L + 1):
        for l2 in range(L + 1):
            for l3 in range(abs(l1 - l2), min(L, l1 + l2) + 1):
                d1, d2, d3 = (2 * l1 + 1, 2 * l2 + 1, 2 * l3 + 1)
                cg[off[l1]:off[l1 + 1], off[l2]:off[l2 + 1], off[l3]:off[l3 + 1]] = (lambda *s: torch.randn(*s, dtype=torch.bfloat16) * 0.05)(d1, d2, d3) / (lambda _x: torch.sqrt(torch.as_tensor(_x)))(float(d1 * d2))
    return {'x': _w((lambda *s: torch.randn(*s, dtype=torch.bfloat16) * 0.05)(N, C, M) * 0.2), 'src': _w(src), 'dst': _w(dst), 'Y': _w(Y), 'edge_feat': _w((lambda *s: torch.randn(*s, dtype=torch.bfloat16) * 0.05)(E, DE)), 'w_rad': _w((lambda *s: torch.randn(*s, dtype=torch.bfloat16) * 0.05)(DE, C) * (1.0 / max(1.0, DE) ** 0.5)), 'cg': _w(cg), 'w_mix': _w((lambda *s: torch.randn(*s, dtype=torch.bfloat16) * 0.05)(C, C) * (1.0 / max(1.0, C) ** 0.5))}

def reference(x, src, dst, Y, edge_feat, w_rad, cg, w_mix):
    N, C, M = (x.shape[0], x.shape[1], x.shape[2])
    R = _silu(edge_feat @ w_rad)
    xs = x[src]
    tp = torch.einsum('eci,ef,ifo->eco', xs, Y, cg)
    msg = R[:, :, None] * tp
    agg = _segment_sum(msg.reshape(-1, C * M), dst, N).reshape(N, C, M)
    return torch.einsum('ncm,cd->ndm', agg, w_mix)
```

```asm
; @launch kernel=bin_kernel grid=(256,1,1) block=(640,1,1) lds=66560
; @launch kernel=main_kernel grid=(256,1,1) block=(512,1,1) lds=143872
.amdgcn_target "amdgcn-amd-amdhsa--gfx950"
.text
.globl bin_kernel
.p2align 8
.type bin_kernel,@function
bin_kernel:
    s_cmp_ge_u32 s2, 256
    s_cbranch_scc1 L_k1_end
    s_load_dwordx8 s[36:43], s[0:1], 8
    s_load_dwordx4 s[44:47], s[0:1], 40
    s_load_dwordx2 s[48:49], s[0:1], 56
    s_load_dwordx2 s[50:51], s[0:1], 80
    v_lshrrev_b32 v4, 6, v0
    v_lshlrev_b32 v1, 2, v0
    v_readfirstlane_b32 s28, v4
    v_lshlrev_b32 v2, 3, v0
    v_lshlrev_b32 v3, 4, v0
    v_and_b32 v4, 63, v0
    v_mov_b32 v18, 0
    ds_write_b32 v1, v18 offset:64000
    v_mov_b32 v18, 1
    s_and_b32 s29, s2, 7
    s_lshl_b32 s29, s29, 5
    s_lshr_b32 s33, s2, 3
    s_or_b32 s29, s29, s33
    s_mul_i32 s30, s29, 5000
    s_mul_i32 s31, s29, 10000
    s_add_u32 s32, s31, 5120
    s_movk_i32 s33, 610
    v_cmp_gt_u32 s[52:53], s33, v0
    s_movk_i32 s33, 580
    v_cmp_gt_u32 s[54:55], s33, v0
    s_waitcnt lgkmcnt(0)
    s_mov_b32 s8, s38
    s_mov_b32 s9, s39
    s_mov_b32 s10, 1280000
    s_mov_b32 s11, 0x00020000
    buffer_load_dword v5, v1, s[8:11], s30 offen nt
    buffer_load_dword v6, v1, s[8:11], s30 offen offset:2560 nt
    s_mov_b32 s4, s36
    s_mov_b32 s5, s37
    s_mov_b32 s6, 1280000
    s_mov_b32 s7, 0x00020000
    buffer_load_dword v7, v1, s[4:7], s30 offen nt
    buffer_load_dword v44, v1, s[4:7], s30 offen offset:2560 nt
    s_mov_b32 s12, s40
    s_mov_b32 s13, s41
    s_mov_b32 s14, 2560000
    s_mov_b32 s15, 0x00020000
    buffer_load_dwordx2 v[8:9], v2, s[12:15], s31 offen nt
    buffer_load_dwordx2 v[12:13], v2, s[12:15], s32 offen nt
    s_mov_b32 s16, s42
    s_mov_b32 s17, s43
    s_mov_b32 s18, 10240000
    s_mov_b32 s19, 0x00020000
    s_mov_b32 s20, s50
    s_mov_b32 s21, s51
    s_mov_b32 s22, 16777216
    s_mov_b32 s23, 0x00020000
    s_lshl_b32 s33, s2, 6
    v_or_b32 v45, s33, v4
    s_cmp_eq_u32 s28, 0
    s_cbranch_scc0 L_k1_r1
    s_mov_b32 s24, s48
    s_mov_b32 s25, s49
    s_mov_b32 s26, 32768
    s_mov_b32 s27, 0x00020000
    v_and_b32 v20, 7, v45
    v_bfe_u32 v21, v45, 7, 2
    v_lshl_add_u32 v20, v21, 3, v20
    v_bfe_u32 v21, v45, 9, 2
    v_lshl_add_u32 v20, v21, 5, v20
    v_bfe_u32 v21, v45, 11, 1
    v_bfe_u32 v22, v45, 3, 4
    v_lshl_add_u32 v21, v22, 1, v21
    v_lshrrev_b32 v22, 12, v45
    v_lshl_add_u32 v21, v22, 5, v21
    v_lshlrev_b32 v21, 1, v21
    v_lshl_add_u32 v20, v20, 8, v21
    buffer_load_ushort v19, v20, s[24:27], 0 offen
    s_branch L_k1_rdone
L_k1_r1:
    s_cmp_eq_u32 s28, 1
    s_cbranch_scc0 L_k1_r2
    s_cmp_lt_u32 s2, 32
    s_cbranch_scc0 L_k1_rdone
    s_mov_b32 s24, s44
    s_mov_b32 s25, s45
    s_mov_b32 s26, 4096
    s_mov_b32 s27, 0x00020000
    v_and_b32 v20, 7, v45
    v_bfe_u32 v21, v45, 8, 1
    v_lshl_add_u32 v20, v21, 3, v20
    v_bfe_u32 v21, v45, 9, 1
    v_bfe_u32 v22, v45, 3, 5
    v_lshl_add_u32 v21, v22, 1, v21
    v_lshrrev_b32 v22, 10, v45
    v_lshl_add_u32 v21, v22, 6, v21
    v_lshlrev_b32 v21, 1, v21
    v_lshl_add_u32 v20, v20, 8, v21
    buffer_load_ushort v19, v20, s[24:27], 0 offen
    s_branch L_k1_rdone
L_k1_r2:
    s_cmp_eq_u32 s28, 2
    s_cbranch_scc0 L_k1_rdone
    s_cmp_eq_u32 s2, 0
    s_cbranch_scc0 L_k1_rdone
    s_mov_b32 s24, s46
    s_mov_b32 s25, s47
    s_mov_b32 s26, 128
    s_mov_b32 s27, 0x00020000
    v_and_b32 v20, 0x30, v4
    v_and_b32 v21, 3, v4
    v_lshl_add_u32 v20, v21, 2, v20
    v_bfe_u32 v21, v4, 2, 2
    v_add_lshl_u32 v20, v20, v21, 1
    buffer_load_ushort v19, v20, s[24:27], 0 offen
L_k1_rdone:
    s_mul_i32 s34, s29, 40000
    s_lshl_b32 s35, s28, 10
    s_add_u32 m0, s35, 0
    s_nop 0
    buffer_load_dwordx4 v3, s[16:19], s34 offen nt lds
    s_add_u32 m0, s35, 10240
    s_add_u32 s34, s34, 10240
    buffer_load_dwordx4 v3, s[16:19], s34 offen nt lds
    s_add_u32 m0, s35, 20480
    s_add_u32 s34, s34, 10240
    buffer_load_dwordx4 v3, s[16:19], s34 offen nt lds
    s_mov_b64 exec, s[54:55]
    s_add_u32 m0, s35, 30720
    s_add_u32 s34, s34, 10240
    buffer_load_dwordx4 v3, s[16:19], s34 offen nt lds
    s_mov_b64 exec, -1
    s_barrier
    s_waitcnt vmcnt(8)
    v_and_b32 v20, 255, v5
    v_and_b32 v21, 255, v6
    v_lshlrev_b32 v28, 2, v20
    v_lshlrev_b32 v29, 2, v21
    ds_add_rtn_u32 v16, v28, v18 offset:64000
    s_mov_b64 exec, s[52:53]
    ds_add_rtn_u32 v17, v29, v18 offset:64000
    s_mov_b64 exec, -1
    s_movk_i32 s33, 6711
    s_waitcnt vmcnt(6)
    v_lshrrev_b32 v20, 11, v5
    v_lshlrev_b32 v20, 3, v20
    v_lshl_or_b32 v10, v7, 10, v20
    v_mul_u32_u24 v20, s33, v7
    v_lshrrev_b32 v20, 22, v20
    v_bfe_u32 v21, v5, 8, 3
    v_lshl_add_u32 v20, v21, 4, v20
    v_lshlrev_b32 v11, 2, v20
    v_lshrrev_b32 v20, 11, v6
    v_lshlrev_b32 v20, 3, v20
    v_lshl_or_b32 v14, v44, 10, v20
    v_mul_u32_u24 v20, s33, v44
    v_lshrrev_b32 v20, 22, v20
    v_bfe_u32 v21, v6, 8, 3
    v_lshl_add_u32 v20, v21, 4, v20
    v_lshlrev_b32 v15, 2, v20
    v_lshlrev_b32 v30, 4, v4
    s_waitcnt lgkmcnt(0)
    s_barrier
    ds_read_b128 v[20:23], v30 offset:64000
    s_waitcnt lgkmcnt(0)
    v_add_u32 v26, v20, v21
    v_add_u32 v27, v26, v22
    v_add_u32 v31, v27, v23
    v_mov_b32 v32, v31
    s_nop 1
    v_add_u32_dpp v32, v32, v32 row_shr:1 row_mask:0xf bank_mask:0xf
    s_nop 1
    v_add_u32_dpp v32, v32, v32 row_shr:2 row_mask:0xf bank_mask:0xf
    s_nop 1
    v_add_u32_dpp v32, v32, v32 row_shr:4 row_mask:0xf bank_mask:0xf
    s_nop 1
    v_add_u32_dpp v32, v32, v32 row_shr:8 row_mask:0xf bank_mask:0xf
    s_nop 1
    v_add_u32_dpp v32, v32, v32 row_bcast:15 row_mask:0xa bank_mask:0xf
    s_nop 1
    v_add_u32_dpp v32, v32, v32 row_bcast:31 row_mask:0xc bank_mask:0xf
    v_sub_u32 v24, v32, v31
    v_add_u32 v25, v24, v20
    v_add_u32 v26, v24, v26
    v_add_u32 v27, v24, v27
    ds_write_b128 v30, v[24:27] offset:65024
    ds_read_b32 v33, v28 offset:65024
    ds_read_b32 v34, v29 offset:65024
    v_lshlrev_b32 v35, 5, v0
    v_add_u32 v36, 20480, v35
    s_waitcnt lgkmcnt(0)
    v_add_lshl_u32 v33, v33, v16, 1
    v_add_lshl_u32 v34, v34, v17, 1
    ds_write_b16 v33, v35 offset:61440
    v_lshlrev_b32 v33, 3, v33
    s_waitcnt vmcnt(4)
    ds_write_b128 v33, v[8:11] offset:40960
    s_mov_b64 exec, s[52:53]
    ds_write_b16 v34, v36 offset:61440
    v_lshlrev_b32 v34, 3, v34
    ds_write_b128 v34, v[12:15] offset:40960
    s_mov_b64 exec, -1
    s_cmp_eq_u32 s28, 3
    s_cbranch_scc0 L_k1_s0
    s_lshl_b32 s33, s29, 2
    s_add_u32 s33, s33, 15728640
    v_lshlrev_b32 v37, 12, v4
    v_lshl_or_b32 v40, v20, 16, v24
    buffer_store_dword v40, v37, s[20:23], s33 offen offset:0
    v_lshl_or_b32 v41, v21, 16, v25
    buffer_store_dword v41, v37, s[20:23], s33 offen offset:1024
    v_lshl_or_b32 v42, v22, 16, v26
    buffer_store_dword v42, v37, s[20:23], s33 offen offset:2048
    v_lshl_or_b32 v43, v23, 16, v27
    buffer_store_dword v43, v37, s[20:23], s33 offen offset:3072
    s_branch L_k1_sdone
L_k1_s0:
    v_lshlrev_b32 v37, 1, v45
    s_cmp_eq_u32 s28, 0
    s_cbranch_scc0 L_k1_s1
    s_mov_b32 s33, 15990784
    buffer_store_short v19, v37, s[20:23], s33 offen
    s_branch L_k1_sdone
L_k1_s1:
    s_cmp_eq_u32 s28, 1
    s_cbranch_scc0 L_k1_s2
    s_cmp_lt_u32 s2, 32
    s_cbranch_scc0 L_k1_sdone
    v_lshlrev_b32 v38, 16, v19
    v_mul_f32 v38, 0xbfb8aa3b, v38
    v_cvt_pk_bf16_f32 v39, v38, v38
    v_lshlrev_b32 v40, 16, v39
    v_sub_f32 v38, v38, v40
    v_cvt_pk_bf16_f32 v40, v38, v38
    s_mov_b32 s33, 16023552
    buffer_store_short v39, v37, s[20:23], s33 offen
    s_mov_b32 s33, 16027648
    buffer_store_short v40, v37, s[20:23], s33 offen
    s_branch L_k1_sdone
L_k1_s2:
    s_cmp_eq_u32 s28, 2
    s_cbranch_scc0 L_k1_sdone
    s_cmp_eq_u32 s2, 0
    s_cbranch_scc0 L_k1_sdone
    s_mov_b32 s33, 16031744
    buffer_store_short v19, v37, s[20:23], s33 offen
L_k1_sdone:
    v_and_b32 v33, 0x3fe, v0
    v_and_b32 v34, 1, v0
    v_lshlrev_b32 v34, 4, v34
    s_mul_i32 s34, s29, 20480
    s_add_u32 s34, s34, 10485760
    s_add_u32 s35, s34, 10240
    s_waitcnt lgkmcnt(0)
    s_barrier
    ds_read_b128 v[8:11], v3 offset:40960
    ds_read_b128 v[12:15], v3 offset:51200
    ds_read_u16 v36, v33 offset:61440
    ds_read_u16 v37, v33 offset:62080
    ds_read_u16 v38, v33 offset:62720
    ds_read_u16 v39, v33 offset:63360
    s_waitcnt lgkmcnt(5)
    buffer_store_dwordx4 v[8:11], v3, s[20:23], s34 offen
    s_waitcnt lgkmcnt(4)
    s_mov_b64 exec, s[52:53]
    buffer_store_dwordx4 v[12:15], v3, s[20:23], s35 offen
    s_mov_b64 exec, -1
    s_waitcnt lgkmcnt(0)
    v_or_b32 v36, v36, v34
    v_or_b32 v37, v37, v34
    v_or_b32 v38, v38, v34
    v_or_b32 v39, v39, v34
    s_mul_i32 s34, s29, 40960
    s_waitcnt vmcnt(2)
    s_barrier
    ds_read_b128 v[16:19], v36 offset:0
    ds_read_b128 v[20:23], v37 offset:0
    ds_read_b128 v[24:27], v38 offset:0
    s_mov_b64 exec, s[54:55]
    ds_read_b128 v[28:31], v39 offset:0
    s_mov_b64 exec, -1
    s_waitcnt lgkmcnt(3)
    buffer_store_dwordx4 v[16:19], v3, s[20:23], s34 offen
    s_add_u32 s34, s34, 10240
    s_waitcnt lgkmcnt(2)
    buffer_store_dwordx4 v[20:23], v3, s[20:23], s34 offen
    s_add_u32 s34, s34, 10240
    s_waitcnt lgkmcnt(1)
    buffer_store_dwordx4 v[24:27], v3, s[20:23], s34 offen
    s_add_u32 s34, s34, 10240
    s_mov_b64 exec, s[54:55]
    s_waitcnt lgkmcnt(0)
    buffer_store_dwordx4 v[28:31], v3, s[20:23], s34 offen
L_k1_end:
    s_endpgm
.globl main_kernel
.p2align 8
.type main_kernel,@function
main_kernel:
    s_cmp_ge_u32 s2, 256
    s_cbranch_scc1 L_m_end
    s_load_dwordx2 s[44:45], s[0:1], 80
    s_load_dwordx2 s[46:47], s[0:1], 0
    s_load_dwordx2 s[48:49], s[0:1], 64
    v_lshrrev_b32 v2, 6, v0
    v_and_b32 v1, 63, v0
    v_readfirstlane_b32 s16, v2
    s_and_b32 s17, s2, 7
    s_lshl_b32 s17, s17, 5
    s_lshr_b32 s26, s2, 3
    s_or_b32 s17, s17, s26
    v_lshlrev_b32 v2, 2, v0
    v_mov_b32 v3, 0
    v_add_u32 v2, 141312, v2
    ds_write_b32 v2, v3
    v_lshrrev_b32 v4, 1, v0
    v_lshlrev_b32 v5, 2, v4
    s_lshl_b32 s26, s17, 10
    s_add_u32 s26, s26, 15728640
    v_lshlrev_b32 v212, 4, v1
    s_waitcnt lgkmcnt(0)
    s_mov_b32 s8, s44
    s_mov_b32 s9, s45
    s_mov_b32 s10, 16777216
    s_mov_b32 s11, 0x00020000
    buffer_load_dword v6, v5, s[8:11], s26 offen
    s_mov_b32 s26, 16023552
    buffer_load_dwordx4 v[180:183], v212, s[8:11], s26 offen offset:0
    buffer_load_dwordx4 v[184:187], v212, s[8:11], s26 offen offset:1024
    buffer_load_dwordx4 v[188:191], v212, s[8:11], s26 offen offset:2048
    buffer_load_dwordx4 v[192:195], v212, s[8:11], s26 offen offset:3072
    v_and_b32 v7, 3, v0
    v_lshlrev_b32 v7, 3, v7
    s_mov_b32 s26, 16031744
    buffer_load_dwordx2 v[196:197], v7, s[8:11], s26 offen offset:0
    buffer_load_dwordx2 v[198:199], v7, s[8:11], s26 offen offset:32
    buffer_load_dwordx2 v[200:201], v7, s[8:11], s26 offen offset:64
    buffer_load_dwordx2 v[202:203], v7, s[8:11], s26 offen offset:96
    s_lshl_b32 s26, s16, 12
    s_add_u32 m0, s26, 100352
    s_add_u32 s26, s26, 15990784
    buffer_load_dwordx4 v212, s[8:11], s26 offen offset:0 lds
    buffer_load_dwordx4 v212, s[8:11], s26 offen offset:1024 lds
    buffer_load_dwordx4 v212, s[8:11], s26 offen offset:2048 lds
    buffer_load_dwordx4 v212, s[8:11], s26 offen offset:3072 lds
    s_mov_b32 s4, s46
    s_mov_b32 s5, s47
    s_mov_b32 s6, 10240000
    s_mov_b32 s7, 0x00020000
    s_mov_b32 s12, s48
    s_mov_b32 s13, s49
    s_mov_b32 s14, 10240000
    s_mov_b32 s15, 0x00020000
    s_mov_b32 s20, 0x0f0f0f0f
    s_mov_b32 s21, 0x0f0f0f0f
    s_mov_b32 s22, 0xf0f0f0f0
    s_mov_b32 s23, 0xf0f0f0f0
    s_mov_b32 s31, 0xfffffc00
    s_mov_b32 s32, 0x9c4028
    s_mov_b32 s33, 0xffe0
    s_mov_b32 s24, 0
    v_mov_b32 v8, 0
    v_mov_b32 v9, 0
    v_mov_b32 v10, 0
    v_mov_b32 v11, 0
    v_mov_b32 v12, 0
    v_mov_b32 v13, 0
    v_mov_b32 v14, 0
    v_mov_b32 v15, 0
    v_mov_b32 v16, 0
    v_mov_b32 v17, 0
    v_mov_b32 v18, 0
    v_mov_b32 v19, 0
    v_mov_b32 v20, 0
    v_mov_b32 v21, 0
    v_mov_b32 v22, 0
    v_mov_b32 v23, 0
    v_mov_b32 v24, 0
    v_mov_b32 v25, 0
    v_mov_b32 v26, 0
    v_mov_b32 v27, 0
    v_mov_b32 v28, 0
    v_mov_b32 v29, 0
    v_mov_b32 v30, 0
    v_mov_b32 v31, 0
    v_mov_b32 v32, 0
    v_mov_b32 v33, 0
    v_mov_b32 v34, 0
    v_mov_b32 v35, 0
    v_mov_b32 v36, 0
    v_mov_b32 v37, 0
    v_mov_b32 v38, 0
    v_mov_b32 v39, 0
    v_mov_b32 v40, 0
    v_mov_b32 v41, 0
    v_mov_b32 v42, 0
    v_mov_b32 v43, 0
    v_mov_b32 v44, 0
    v_mov_b32 v45, 0
    v_mov_b32 v46, 0
    v_mov_b32 v47, 0
    v_mov_b32 v172, 0
    v_mov_b32 v173, 0
    v_mov_b32 v174, 0
    v_mov_b32 v175, 0
    v_mov_b32 v176, 0
    v_mov_b32 v177, 0
    v_mov_b32 v178, 0
    v_mov_b32 v179, 0
    v_and_b32 v2, 3, v1
    v_lshrrev_b32 v3, 2, v1
    v_lshl_add_u32 v214, v2, 4, v3
    v_lshrrev_b32 v2, 5, v1
    v_lshlrev_b32 v213, 4, v2
    s_barrier
    s_waitcnt vmcnt(12)
    v_lshrrev_b32 v2, 16, v6
    v_and_b32 v6, 0xffff, v6
    v_and_b32 v3, 1, v0
    v_cmp_eq_u32 vcc, 0, v3
    s_movk_i32 s26, 1280
    v_mad_u32_u24 v6, v4, s26, v6
    v_cndmask_b32 v216, 0, v2, vcc
    s_nop 1
    v_add_u32_dpp v216, v216, v216 row_shr:1 row_mask:0xf bank_mask:0xf
    s_nop 1
    v_add_u32_dpp v216, v216, v216 row_shr:2 row_mask:0xf bank_mask:0xf
    s_nop 1
    v_add_u32_dpp v216, v216, v216 row_shr:4 row_mask:0xf bank_mask:0xf
    s_nop 1
    v_add_u32_dpp v216, v216, v216 row_shr:8 row_mask:0xf bank_mask:0xf
    s_nop 1
    v_add_u32_dpp v216, v216, v216 row_bcast:15 row_mask:0xa bank_mask:0xf
    s_nop 1
    v_add_u32_dpp v216, v216, v216 row_bcast:31 row_mask:0xc bank_mask:0xf
    s_nop 0
    v_readlane_b32 s19, v216, 63
    v_sub_u32 v215, v216, v2
    v_sub_u32 v217, v6, v215
    s_add_u32 s26, s19, 255
    s_lshr_b32 s26, s26, 8
    v_mov_b32 v2, s26
    v_mov_b32 v3, 141824
    ds_max_u32 v3, v2
L_round:
    s_lshl_b32 s26, s16, 10
    s_add_u32 s26, s26, 133120
    v_add_u32 v7, s26, v212
    v_mov_b32 v80, 0x04000000
    v_mov_b32 v81, 0x04000000
    v_mov_b32 v82, 0x04000000
    v_mov_b32 v83, 0x04000000
    ds_write_b128 v7, v[80:83]
    v_and_b32 v2, 1, v0
    v_max_u32 v3, s24, v215
    v_add_u32 v3, v3, v2
    s_add_u32 s27, s24, 256
    v_min_u32 v4, s27, v216
    v_add_u32 v5, v217, v3
    s_lshl_b32 s27, s24, 2
    s_sub_u32 s27, s26, s27
    v_lshl_add_u32 v6, v3, 2, s27
L_exp:
    v_cmpx_lt_u32 vcc, v3, v4
    s_cbranch_execz L_exp_done
    ds_write_b32 v6, v5
    v_add_u32 v3, 2, v3
    v_add_u32 v5, 2, v5
    v_add_u32 v6, 8, v6
    s_branch L_exp
L_exp_done:
    s_mov_b64 exec, -1
    v_lshl_add_u32 v3, v1, 2, s26
    v_lshrrev_b32 v4, 1, v1
    v_lshl_add_u32 v4, v4, 2, s26
    v_lshlrev_b32 v2, 4, v2
    ds_read_b32 v96, v3 offset:0
    ds_read_b32 v97, v3 offset:256
    ds_read_b32 v98, v3 offset:512
    ds_read_b32 v99, v3 offset:768
    ds_read_b32 v100, v4 offset:0
    ds_read_b32 v101, v4 offset:128
    ds_read_b32 v102, v4 offset:256
    ds_read_b32 v103, v4 offset:384
    ds_read_b32 v104, v4 offset:512
    ds_read_b32 v105, v4 offset:640
    ds_read_b32 v106, v4 offset:768
    ds_read_b32 v107, v4 offset:896
    s_mov_b32 s26, 10485760
    s_mov_b32 s27, 0x04000000
    s_waitcnt lgkmcnt(11)
    v_cmp_gt_u32 s[36:37], s27, v96
    v_lshlrev_b32 v96, 4, v96
    buffer_load_dwordx4 v[80:83], v96, s[8:11], s26 offen
    s_waitcnt lgkmcnt(10)
    v_cmp_gt_u32 s[38:39], s27, v97
    v_lshlrev_b32 v97, 4, v97
    buffer_load_dwordx4 v[84:87], v97, s[8:11], s26 offen
    s_waitcnt lgkmcnt(9)
    v_cmp_gt_u32 s[40:41], s27, v98
    v_lshlrev_b32 v98, 4, v98
    buffer_load_dwordx4 v[88:91], v98, s[8:11], s26 offen
    s_waitcnt lgkmcnt(8)
    v_cmp_gt_u32 s[42:43], s27, v99
    v_lshlrev_b32 v99, 4, v99
    buffer_load_dwordx4 v[92:95], v99, s[8:11], s26 offen
    s_lshl_b32 s26, s16, 13
    s_add_u32 m0, s26, 0
    s_waitcnt lgkmcnt(7)
    v_lshl_or_b32 v100, v100, 5, v2
    buffer_load_dwordx4 v100, s[8:11], 0 offen  lds
    s_add_u32 m0, s26, 1024
    s_waitcnt lgkmcnt(6)
    v_lshl_or_b32 v101, v101, 5, v2
    buffer_load_dwordx4 v101, s[8:11], 0 offen  lds
    s_add_u32 m0, s26, 2048
    s_waitcnt lgkmcnt(5)
    v_lshl_or_b32 v102, v102, 5, v2
    buffer_load_dwordx4 v102, s[8:11], 0 offen  lds
    s_add_u32 m0, s26, 3072
    s_waitcnt lgkmcnt(4)
    v_lshl_or_b32 v103, v103, 5, v2
    buffer_load_dwordx4 v103, s[8:11], 0 offen  lds
    s_add_u32 m0, s26, 4096
    s_waitcnt lgkmcnt(3)
    v_lshl_or_b32 v104, v104, 5, v2
    buffer_load_dwordx4 v104, s[8:11], 0 offen  lds
    s_add_u32 m0, s26, 5120
    s_waitcnt lgkmcnt(2)
    v_lshl_or_b32 v105, v105, 5, v2
    buffer_load_dwordx4 v105, s[8:11], 0 offen  lds
    s_add_u32 m0, s26, 6144
    s_waitcnt lgkmcnt(1)
    v_lshl_or_b32 v106, v106, 5, v2
    buffer_load_dwordx4 v106, s[8:11], 0 offen  lds
    s_add_u32 m0, s26, 7168
    s_waitcnt lgkmcnt(0)
    v_lshl_or_b32 v107, v107, 5, v2
    buffer_load_dwordx4 v107, s[8:11], 0 offen  lds
    v_mov_b32 v2, 1
    v_lshl_add_u32 v5, v1, 5, s26
    s_waitcnt vmcnt(11)
    s_mov_b64 exec, s[36:37]
    v_add_u32 v83, 141312, v83
    ds_add_rtn_u32 v108, v83, v2
    s_waitcnt vmcnt(10)
    s_mov_b64 exec, s[38:39]
    v_add_u32 v87, 141312, v87
    ds_add_rtn_u32 v109, v87, v2
    s_waitcnt vmcnt(9)
    s_mov_b64 exec, s[40:41]
    v_add_u32 v91, 141312, v91
    ds_add_rtn_u32 v110, v91, v2
    s_waitcnt vmcnt(8)
    s_mov_b64 exec, s[42:43]
    v_add_u32 v95, 141312, v95
    ds_add_rtn_u32 v111, v95, v2
    s_mov_b64 exec, -1
    v_lshlrev_b32 v3, 3, v1
    v_add_u32 v3, 141312, v3
    v_mov_b32 v4, 141824
    s_waitcnt lgkmcnt(0)
    s_barrier
    ds_read_b64 v[112:113], v3
    ds_read_b32 v4, v4
    s_waitcnt lgkmcnt(0)
    v_readfirstlane_b32 s25, v4
    v_mov_b32 v6, v112
    v_add_u32 v6, v6, v113
    v_mov_b32 v7, v6
    s_nop 1
    v_add_u32_dpp v7, v7, v7 row_shr:1 row_mask:0xf bank_mask:0xf
    s_nop 1
    v_add_u32_dpp v7, v7, v7 row_shr:2 row_mask:0xf bank_mask:0xf
    s_nop 1
    v_add_u32_dpp v7, v7, v7 row_shr:4 row_mask:0xf bank_mask:0xf
    s_nop 1
    v_add_u32_dpp v7, v7, v7 row_shr:8 row_mask:0xf bank_mask:0xf
    s_nop 1
    v_add_u32_dpp v7, v7, v7 row_bcast:15 row_mask:0xa bank_mask:0xf
    s_nop 1
    v_add_u32_dpp v7, v7, v7 row_bcast:31 row_mask:0xc bank_mask:0xf
    v_sub_u32 v116, v7, v6
    v_add_u32 v117, v116, v112
    ds_write_b64 v3, v[116:117] offset:2048
    s_lshl_b32 s26, s16, 3
    s_add_u32 s27, s26, 7
    ds_read_b32 v96, v83 offset:2048
    ds_read_b32 v97, v87 offset:2048
    ds_read_b32 v98, v91 offset:2048
    ds_read_b32 v99, v95 offset:2048
    v_readlane_b32 s29, v116, s26
    v_readlane_b32 s18, v7, s27
    v_readlane_b32 s28, v7, 63
    s_waitcnt lgkmcnt(3)
    s_mov_b64 exec, s[36:37]
    v_add_lshl_u32 v96, v96, v108, 4
    v_add_u32 v83, 0, v5
    v_add_u32 v96, 65536, v96
    ds_write_b128 v96, v[80:83]
    s_waitcnt lgkmcnt(3)
    s_mov_b64 exec, s[38:39]
    v_add_lshl_u32 v97, v97, v109, 4
    v_add_u32 v87, 2048, v5
    v_add_u32 v97, 65536, v97
    ds_write_b128 v97, v[84:87]
    s_waitcnt lgkmcnt(3)
    s_mov_b64 exec, s[40:41]
    v_add_lshl_u32 v98, v98, v110, 4
    v_add_u32 v91, 4096, v5
    v_add_u32 v98, 65536, v98
    ds_write_b128 v98, v[88:91]
    s_waitcnt lgkmcnt(3)
    s_mov_b64 exec, s[42:43]
    v_add_lshl_u32 v99, v99, v111, 4
    v_add_u32 v95, 6144, v5
    v_add_u32 v99, 65536, v99
    ds_write_b128 v99, v[92:95]
    s_mov_b64 exec, -1
    s_sub_u32 s18, s18, s29
    s_min_u32 s18, s18, 2048
    s_min_u32 s28, s28, 2048
    s_min_u32 s25, s25, 157
    s_lshl_b32 s26, s29, 4
    s_add_u32 s26, s26, 65536
    v_lshl_add_u32 v210, v214, 4, s26
    v_and_b32 v2, 3, v1
    v_bfe_u32 v3, v1, 3, 2
    v_lshl_add_u32 v2, v3, 2, v2
    v_lshl_add_u32 v211, v2, 4, s26
    v_lshlrev_b32 v2, 2, v0
    v_add_u32 v2, 141312, v2
    v_mov_b32 v3, 0
    s_waitcnt lgkmcnt(0)
    s_barrier
    ds_read_b128 v[204:207], v210
    ds_read_b32 v209, v211 offset:12
    s_movk_i32 s26, 128
    v_cmp_gt_u32 vcc, s26, v0
    s_and_saveexec_b64 s[34:35], vcc
    ds_write_b32 v2, v3
    s_mov_b64 exec, -1
    v_cmp_gt_i32 vcc, s18, v214
    v_mov_b32 v4, s32
    s_waitcnt lgkmcnt(0)
    v_cndmask_b32 v208, v4, v206, vcc
    v_and_or_b32 v209, v209, s33, v213
    v_readlane_b32 s64, v208, 0
    v_readlane_b32 s65, v208, 4
    v_readlane_b32 s66, v208, 8
    v_readlane_b32 s67, v208, 12
    v_readlane_b32 s68, v208, 16
    v_readlane_b32 s69, v208, 20
    v_readlane_b32 s70, v208, 24
    v_readlane_b32 s71, v208, 28
    s_and_b32 s80, s64, s31
    buffer_load_dwordx4 v[48:51], v212, s[4:7], s80 offen
    s_and_b32 s81, s65, s31
    buffer_load_dwordx4 v[52:55], v212, s[4:7], s81 offen
    s_and_b32 s82, s66, s31
    buffer_load_dwordx4 v[56:59], v212, s[4:7], s82 offen
    s_and_b32 s83, s67, s31
    buffer_load_dwordx4 v[60:63], v212, s[4:7], s83 offen
    s_and_b32 s80, s68, s31
    buffer_load_dwordx4 v[64:67], v212, s[4:7], s80 offen
    s_and_b32 s81, s69, s31
    buffer_load_dwordx4 v[68:71], v212, s[4:7], s81 offen
    s_and_b32 s82, s70, s31
    buffer_load_dwordx4 v[72:75], v212, s[4:7], s82 offen
    s_and_b32 s83, s71, s31
    buffer_load_dwordx4 v[76:79], v212, s[4:7], s83 offen
    s_waitcnt vmcnt(8)
    s_barrier
    s_mov_b64 exec, s[20:21]
    ds_read_b128 v[172:175], v209
    s_mov_b64 exec, -1
    s_mov_b64 exec, s[22:23]
    ds_read_b128 v[176:179], v209
    s_mov_b64 exec, -1
    s_waitcnt lgkmcnt(0)
    ds_read_b32 v209, v211 offset:268
    v_mfma_f32_32x32x16_bf16 v[80:95], v[172:175], v[180:183], 0
    v_mfma_f32_32x32x16_bf16 v[96:111], v[172:175], v[184:187], 0
    v_mfma_f32_32x32x16_bf16 v[80:95], v[176:179], v[188:191], v[80:95]
    v_mfma_f32_32x32x16_bf16 v[96:111], v[176:179], v[192:195], v[96:111]
    s_waitcnt lgkmcnt(0)
    v_and_or_b32 v209, v209, s33, v213
    s_mov_b32 s30, s18
L_sb:
    v_mfma_f32_4x4x4_16b_bf16 v[144:147], v[204:205], v[196:197], 0
    v_mfma_f32_4x4x4_16b_bf16 v[148:151], v[204:205], v[198:199], 0
    v_mfma_f32_4x4x4_16b_bf16 v[152:155], v[204:205], v[200:201], 0
    v_mfma_f32_4x4x4_16b_bf16 v[156:159], v[204:205], v[202:203], 0
    v_add_u32 v210, 1024, v210
    s_sub_u32 s26, s30, 64
    s_nop 2
    v_cvt_pk_bf16_f32 v164, v144, v148
    v_cvt_pk_bf16_f32 v165, v152, v156
    v_cvt_pk_bf16_f32 v166, v145, v149
    v_cvt_pk_bf16_f32 v167, v153, v157
    v_cvt_pk_bf16_f32 v168, v146, v150
    v_cvt_pk_bf16_f32 v169, v154, v158
    v_cvt_pk_bf16_f32 v170, v147, v151
    v_cvt_pk_bf16_f32 v171, v155, v159
    ds_read_b128 v[204:207], v210
    v_cmp_gt_i32 s[34:35], s26, v214
    s_cmp_le_i32 s30, 0
    s_cbranch_scc1 L_exit
    s_mov_b64 exec, s[20:21]
    ds_read_b128 v[172:175], v209
    s_mov_b64 exec, -1
    s_mov_b64 exec, s[22:23]
    ds_read_b128 v[176:179], v209
    s_mov_b64 exec, -1
    s_waitcnt vmcnt(7)
    v_mfma_f32_4x4x4_16b_bf16 v[144:147], v[164:165], v[48:49], 0 cbsz:4 abid:0
    v_exp_f32 v160, v80
    v_mfma_f32_4x4x4_16b_bf16 v[148:151], v[164:165], v[50:51], 0 cbsz:4 abid:0
    v_exp_f32 v161, v81
    s_waitcnt vmcnt(6)
    v_mfma_f32_4x4x4_16b_bf16 v[152:155], v[164:165], v[52:53], 0 cbsz:4 abid:1
    v_exp_f32 v162, v96
    v_mfma_f32_4x4x4_16b_bf16 v[156:159], v[164:165], v[54:55], 0 cbsz:4 abid:1
    v_exp_f32 v163, v97
    v_readlane_b32 s72, v208, 32
    v_readlane_b32 s73, v208, 36
    v_pk_add_f32 v[160:161], v[160:161], 1.0 op_sel_hi:[1,0]
    v_pk_add_f32 v[162:163], v[162:163], 1.0 op_sel_hi:[1,0]
    s_and_b32 s80, s72, s31
    s_and_b32 s81, s73, s31
    v_rcp_f32 v160, v160
    buffer_load_dwordx4 v[48:51], v212, s[4:7], s80 offen
    v_rcp_f32 v161, v161
    buffer_load_dwordx4 v[52:55], v212, s[4:7], s81 offen
    v_rcp_f32 v162, v162
    v_rcp_f32 v163, v163
    v_pk_mul_f32 v[160:161], v[160:161], v[80:81]
    v_pk_mul_f32 v[162:163], v[162:163], v[96:97]
    s_set_gpr_idx_on s64, gpr_idx(SRC2,DST)
    v_pk_fma_f32 v[8:9], v[160:161], v[144:145], v[8:9] op_sel:[0,0,0] op_sel_hi:[0,1,1]
    v_pk_fma_f32 v[10:11], v[160:161], v[146:147], v[10:11] op_sel:[0,0,0] op_sel_hi:[0,1,1]
    v_pk_fma_f32 v[12:13], v[162:163], v[148:149], v[12:13] op_sel:[0,0,0] op_sel_hi:[0,1,1]
    v_pk_fma_f32 v[14:15], v[162:163], v[150:151], v[14:15] op_sel:[0,0,0] op_sel_hi:[0,1,1]
    s_set_gpr_idx_idx s65
    v_pk_fma_f32 v[8:9], v[160:161], v[152:153], v[8:9] op_sel:[1,0,0] op_sel_hi:[1,1,1]
    v_pk_fma_f32 v[10:11], v[160:161], v[154:155], v[10:11] op_sel:[1,0,0] op_sel_hi:[1,1,1]
    v_pk_fma_f32 v[12:13], v[162:163], v[156:157], v[12:13] op_sel:[1,0,0] op_sel_hi:[1,1,1]
    v_pk_fma_f32 v[14:15], v[162:163], v[158:159], v[14:15] op_sel:[1,0,0] op_sel_hi:[1,1,1]
    s_set_gpr_idx_off
    s_cmp_le_i32 s30, 2
    s_cbranch_scc1 L_exit
    s_waitcnt vmcnt(7)
    v_mfma_f32_4x4x4_16b_bf16 v[144:147], v[164:165], v[56:57], 0 cbsz:4 abid:2
    v_exp_f32 v160, v82
    v_mfma_f32_4x4x4_16b_bf16 v[148:151], v[164:165], v[58:59], 0 cbsz:4 abid:2
    v_exp_f32 v161, v83
    s_waitcnt vmcnt(6)
    v_mfma_f32_4x4x4_16b_bf16 v[152:155], v[164:165], v[60:61], 0 cbsz:4 abid:3
    v_exp_f32 v162, v98
    v_mfma_f32_4x4x4_16b_bf16 v[156:159], v[164:165], v[62:63], 0 cbsz:4 abid:3
    v_exp_f32 v163, v99
    v_readlane_b32 s74, v208, 40
    v_readlane_b32 s75, v208, 44
    v_pk_add_f32 v[160:161], v[160:161], 1.0 op_sel_hi:[1,0]
    v_pk_add_f32 v[162:163], v[162:163], 1.0 op_sel_hi:[1,0]
    s_and_b32 s80, s74, s31
    s_and_b32 s81, s75, s31
    v_rcp_f32 v160, v160
    buffer_load_dwordx4 v[56:59], v212, s[4:7], s80 offen
    v_rcp_f32 v161, v161
    buffer_load_dwordx4 v[60:63], v212, s[4:7], s81 offen
    v_rcp_f32 v162, v162
    v_rcp_f32 v163, v163
    v_pk_mul_f32 v[160:161], v[160:161], v[82:83]
    v_pk_mul_f32 v[162:163], v[162:163], v[98:99]
    s_set_gpr_idx_on s66, gpr_idx(SRC2,DST)
    v_pk_fma_f32 v[8:9], v[160:161], v[144:145], v[8:9] op_sel:[0,0,0] op_sel_hi:[0,1,1]
    v_pk_fma_f32 v[10:11], v[160:161], v[146:147], v[10:11] op_sel:[0,0,0] op_sel_hi:[0,1,1]
    v_pk_fma_f32 v[12:13], v[162:163], v[148:149], v[12:13] op_sel:[0,0,0] op_sel_hi:[0,1,1]
    v_pk_fma_f32 v[14:15], v[162:163], v[150:151], v[14:15] op_sel:[0,0,0] op_sel_hi:[0,1,1]
    s_set_gpr_idx_idx s67
    v_pk_fma_f32 v[8:9], v[160:161], v[152:153], v[8:9] op_sel:[1,0,0] op_sel_hi:[1,1,1]
    v_pk_fma_f32 v[10:11], v[160:161], v[154:155], v[10:11] op_sel:[1,0,0] op_sel_hi:[1,1,1]
    v_pk_fma_f32 v[12:13], v[162:163], v[156:157], v[12:13] op_sel:[1,0,0] op_sel_hi:[1,1,1]
    v_pk_fma_f32 v[14:15], v[162:163], v[158:159], v[14:15] op_sel:[1,0,0] op_sel_hi:[1,1,1]
    s_set_gpr_idx_off
    s_cmp_le_i32 s30, 4
    s_cbranch_scc1 L_exit
    s_waitcnt vmcnt(7)
    v_mfma_f32_4x4x4_16b_bf16 v[144:147], v[164:165], v[64:65], 0 cbsz:4 abid:4
    v_exp_f32 v160, v84
    v_mfma_f32_4x4x4_16b_bf16 v[148:151], v[164:165], v[66:67], 0 cbsz:4 abid:4
    v_exp_f32 v161, v85
    s_waitcnt vmcnt(6)
    v_mfma_f32_4x4x4_16b_bf16 v[152:155], v[164:165], v[68:69], 0 cbsz:4 abid:5
    v_exp_f32 v162, v100
    v_mfma_f32_4x4x4_16b_bf16 v[156:159], v[164:165], v[70:71], 0 cbsz:4 abid:5
    v_exp_f32 v163, v101
    v_readlane_b32 s76, v208, 48
    v_readlane_b32 s77, v208, 52
    v_pk_add_f32 v[160:161], v[160:161], 1.0 op_sel_hi:[1,0]
    v_pk_add_f32 v[162:163], v[162:163], 1.0 op_sel_hi:[1,0]
    s_and_b32 s80, s76, s31
    s_and_b32 s81, s77, s31
    s_waitcnt lgkmcnt(0)
    v_mfma_f32_32x32x16_bf16 v[112:127], v[172:175], v[180:183], 0
    v_rcp_f32 v160, v160
    buffer_load_dwordx4 v[64:67], v212, s[4:7], s80 offen
    v_rcp_f32 v161, v161
    buffer_load_dwordx4 v[68:71], v212, s[4:7], s81 offen
    v_rcp_f32 v162, v162
    v_rcp_f32 v163, v163
    v_pk_mul_f32 v[160:161], v[160:161], v[84:85]
    v_pk_mul_f32 v[162:163], v[162:163], v[100:101]
    s_set_gpr_idx_on s68, gpr_idx(SRC2,DST)
    v_pk_fma_f32 v[8:9], v[160:161], v[144:145], v[8:9] op_sel:[0,0,0] op_sel_hi:[0,1,1]
    v_pk_fma_f32 v[10:11], v[160:161], v[146:147], v[10:11] op_sel:[0,0,0] op_sel_hi:[0,1,1]
    v_pk_fma_f32 v[12:13], v[162:163], v[148:149], v[12:13] op_sel:[0,0,0] op_sel_hi:[0,1,1]
    v_pk_fma_f32 v[14:15], v[162:163], v[150:151], v[14:15] op_sel:[0,0,0] op_sel_hi:[0,1,1]
    s_set_gpr_idx_idx s69
    v_pk_fma_f32 v[8:9], v[160:161], v[152:153], v[8:9] op_sel:[1,0,0] op_sel_hi:[1,1,1]
    v_pk_fma_f32 v[10:11], v[160:161], v[154:155], v[10:11] op_sel:[1,0,0] op_sel_hi:[1,1,1]
    v_pk_fma_f32 v[12:13], v[162:163], v[156:157], v[12:13] op_sel:[1,0,0] op_sel_hi:[1,1,1]
    v_pk_fma_f32 v[14:15], v[162:163], v[158:159], v[14:15] op_sel:[1,0,0] op_sel_hi:[1,1,1]
    s_set_gpr_idx_off
    s_cmp_le_i32 s30, 6
    s_cbranch_scc1 L_exit
    s_waitcnt vmcnt(7)
    v_mfma_f32_4x4x4_16b_bf16 v[144:147], v[164:165], v[72:73], 0 cbsz:4 abid:6
    v_exp_f32 v160, v86
    v_mfma_f32_4x4x4_16b_bf16 v[148:151], v[164:165], v[74:75], 0 cbsz:4 abid:6
    v_exp_f32 v161, v87
    s_waitcnt vmcnt(6)
    v_mfma_f32_4x4x4_16b_bf16 v[152:155], v[164:165], v[76:77], 0 cbsz:4 abid:7
    v_exp_f32 v162, v102
    v_mfma_f32_4x4x4_16b_bf16 v[156:159], v[164:165], v[78:79], 0 cbsz:4 abid:7
    v_exp_f32 v163, v103
    v_readlane_b32 s78, v208, 56
    v_readlane_b32 s79, v208, 60
    v_pk_add_f32 v[160:161], v[160:161], 1.0 op_sel_hi:[1,0]
    v_pk_add_f32 v[162:163], v[162:163], 1.0 op_sel_hi:[1,0]
    s_and_b32 s80, s78, s31
    s_and_b32 s81, s79, s31
    v_mfma_f32_32x32x16_bf16 v[128:143], v[172:175], v[184:187], 0
    v_rcp_f32 v160, v160
    buffer_load_dwordx4 v[72:75], v212, s[4:7], s80 offen
    v_rcp_f32 v161, v161
    buffer_load_dwordx4 v[76:79], v212, s[4:7], s81 offen
    v_rcp_f32 v162, v162
    v_rcp_f32 v163, v163
    v_pk_mul_f32 v[160:161], v[160:161], v[86:87]
    v_pk_mul_f32 v[162:163], v[162:163], v[102:103]
    s_set_gpr_idx_on s70, gpr_idx(SRC2,DST)
    v_pk_fma_f32 v[8:9], v[160:161], v[144:145], v[8:9] op_sel:[0,0,0] op_sel_hi:[0,1,1]
    v_pk_fma_f32 v[10:11], v[160:161], v[146:147], v[10:11] op_sel:[0,0,0] op_sel_hi:[0,1,1]
    v_pk_fma_f32 v[12:13], v[162:163], v[148:149], v[12:13] op_sel:[0,0,0] op_sel_hi:[0,1,1]
    v_pk_fma_f32 v[14:15], v[162:163], v[150:151], v[14:15] op_sel:[0,0,0] op_sel_hi:[0,1,1]
    s_set_gpr_idx_idx s71
    v_pk_fma_f32 v[8:9], v[160:161], v[152:153], v[8:9] op_sel:[1,0,0] op_sel_hi:[1,1,1]
    v_pk_fma_f32 v[10:11], v[160:161], v[154:155], v[10:11] op_sel:[1,0,0] op_sel_hi:[1,1,1]
    v_pk_fma_f32 v[12:13], v[162:163], v[156:157], v[12:13] op_sel:[1,0,0] op_sel_hi:[1,1,1]
    v_pk_fma_f32 v[14:15], v[162:163], v[158:159], v[14:15] op_sel:[1,0,0] op_sel_hi:[1,1,1]
    s_set_gpr_idx_off
    s_cmp_le_i32 s30, 8
    s_cbranch_scc1 L_exit
    s_waitcnt vmcnt(7)
    v_mfma_f32_4x4x4_16b_bf16 v[144:147], v[164:165], v[48:49], 0 cbsz:4 abid:8
    v_exp_f32 v160, v88
    v_mfma_f32_4x4x4_16b_bf16 v[148:151], v[164:165], v[50:51], 0 cbsz:4 abid:8
    v_exp_f32 v161, v89
    s_waitcnt vmcnt(6)
    v_mfma_f32_4x4x4_16b_bf16 v[152:155], v[164:165], v[52:53], 0 cbsz:4 abid:9
    v_exp_f32 v162, v104
    v_mfma_f32_4x4x4_16b_bf16 v[156:159], v[164:165], v[54:55], 0 cbsz:4 abid:9
    v_exp_f32 v163, v105
    v_readlane_b32 s64, v208, 1
    v_readlane_b32 s65, v208, 5
    v_pk_add_f32 v[160:161], v[160:161], 1.0 op_sel_hi:[1,0]
    v_pk_add_f32 v[162:163], v[162:163], 1.0 op_sel_hi:[1,0]
    s_and_b32 s80, s64, s31
    s_and_b32 s81, s65, s31
    v_mfma_f32_32x32x16_bf16 v[112:127], v[176:179], v[188:191], v[112:127]
    v_rcp_f32 v160, v160
    buffer_load_dwordx4 v[48:51], v212, s[4:7], s80 offen
    v_rcp_f32 v161, v161
    buffer_load_dwordx4 v[52:55], v212, s[4:7], s81 offen
    v_rcp_f32 v162, v162
    v_rcp_f32 v163, v163
    v_pk_mul_f32 v[160:161], v[160:161], v[88:89]
    v_pk_mul_f32 v[162:163], v[162:163], v[104:105]
    s_set_gpr_idx_on s72, gpr_idx(SRC2,DST)
    v_pk_fma_f32 v[8:9], v[160:161], v[144:145], v[8:9] op_sel:[0,0,0] op_sel_hi:[0,1,1]
    v_pk_fma_f32 v[10:11], v[160:161], v[146:147], v[10:11] op_sel:[0,0,0] op_sel_hi:[0,1,1]
    v_pk_fma_f32 v[12:13], v[162:163], v[148:149], v[12:13] op_sel:[0,0,0] op_sel_hi:[0,1,1]
    v_pk_fma_f32 v[14:15], v[162:163], v[150:151], v[14:15] op_sel:[0,0,0] op_sel_hi:[0,1,1]
    s_set_gpr_idx_idx s73
    v_pk_fma_f32 v[8:9], v[160:161], v[152:153], v[8:9] op_sel:[1,0,0] op_sel_hi:[1,1,1]
    v_pk_fma_f32 v[10:11], v[160:161], v[154:155], v[10:11] op_sel:[1,0,0] op_sel_hi:[1,1,1]
    v_pk_fma_f32 v[12:13], v[162:163], v[156:157], v[12:13] op_sel:[1,0,0] op_sel_hi:[1,1,1]
    v_pk_fma_f32 v[14:15], v[162:163], v[158:159], v[14:15] op_sel:[1,0,0] op_sel_hi:[1,1,1]
    s_set_gpr_idx_off
    s_cmp_le_i32 s30, 10
    s_cbranch_scc1 L_exit
    s_waitcnt vmcnt(7)
    v_mfma_f32_4x4x4_16b_bf16 v[144:147], v[164:165], v[56:57], 0 cbsz:4 abid:10
    v_exp_f32 v160, v90
    v_mfma_f32_4x4x4_16b_bf16 v[148:151], v[164:165], v[58:59], 0 cbsz:4 abid:10
    v_exp_f32 v161, v91
    s_waitcnt vmcnt(6)
    v_mfma_f32_4x4x4_16b_bf16 v[152:155], v[164:165], v[60:61], 0 cbsz:4 abid:11
    v_exp_f32 v162, v106
    v_mfma_f32_4x4x4_16b_bf16 v[156:159], v[164:165], v[62:63], 0 cbsz:4 abid:11
    v_exp_f32 v163, v107
    v_readlane_b32 s66, v208, 9
    v_readlane_b32 s67, v208, 13
    v_pk_add_f32 v[160:161], v[160:161], 1.0 op_sel_hi:[1,0]
    v_pk_add_f32 v[162:163], v[162:163], 1.0 op_sel_hi:[1,0]
    s_and_b32 s80, s66, s31
    s_and_b32 s81, s67, s31
    v_mfma_f32_32x32x16_bf16 v[128:143], v[176:179], v[192:195], v[128:143]
    v_rcp_f32 v160, v160
    buffer_load_dwordx4 v[56:59], v212, s[4:7], s80 offen
    v_rcp_f32 v161, v161
    buffer_load_dwordx4 v[60:63], v212, s[4:7], s81 offen
    v_rcp_f32 v162, v162
    v_rcp_f32 v163, v163
    v_pk_mul_f32 v[160:161], v[160:161], v[90:91]
    v_pk_mul_f32 v[162:163], v[162:163], v[106:107]
    s_set_gpr_idx_on s74, gpr_idx(SRC2,DST)
    v_pk_fma_f32 v[8:9], v[160:161], v[144:145], v[8:9] op_sel:[0,0,0] op_sel_hi:[0,1,1]
    v_pk_fma_f32 v[10:11], v[160:161], v[146:147], v[10:11] op_sel:[0,0,0] op_sel_hi:[0,1,1]
    v_pk_fma_f32 v[12:13], v[162:163], v[148:149], v[12:13] op_sel:[0,0,0] op_sel_hi:[0,1,1]
    v_pk_fma_f32 v[14:15], v[162:163], v[150:151], v[14:15] op_sel:[0,0,0] op_sel_hi:[0,1,1]
    s_set_gpr_idx_idx s75
    v_pk_fma_f32 v[8:9], v[160:161], v[152:153], v[8:9] op_sel:[1,0,0] op_sel_hi:[1,1,1]
    v_pk_fma_f32 v[10:11], v[160:161], v[154:155], v[10:11] op_sel:[1,0,0] op_sel_hi:[1,1,1]
    v_pk_fma_f32 v[12:13], v[162:163], v[156:157], v[12:13] op_sel:[1,0,0] op_sel_hi:[1,1,1]
    v_pk_fma_f32 v[14:15], v[162:163], v[158:159], v[14:15] op_sel:[1,0,0] op_sel_hi:[1,1,1]
    s_set_gpr_idx_off
    s_cmp_le_i32 s30, 12
    s_cbranch_scc1 L_exit
    ds_read_b32 v209, v211 offset:524
    s_waitcnt vmcnt(7)
    v_mfma_f32_4x4x4_16b_bf16 v[144:147], v[164:165], v[64:65], 0 cbsz:4 abid:12
    v_exp_f32 v160, v92
    v_mfma_f32_4x4x4_16b_bf16 v[148:151], v[164:165], v[66:67], 0 cbsz:4 abid:12
    v_exp_f32 v161, v93
    s_waitcnt vmcnt(6)
    v_mfma_f32_4x4x4_16b_bf16 v[152:155], v[164:165], v[68:69], 0 cbsz:4 abid:13
    v_exp_f32 v162, v108
    v_mfma_f32_4x4x4_16b_bf16 v[156:159], v[164:165], v[70:71], 0 cbsz:4 abid:13
    v_exp_f32 v163, v109
    v_readlane_b32 s68, v208, 17
    v_readlane_b32 s69, v208, 21
    v_pk_add_f32 v[160:161], v[160:161], 1.0 op_sel_hi:[1,0]
    v_pk_add_f32 v[162:163], v[162:163], 1.0 op_sel_hi:[1,0]
    s_and_b32 s80, s68, s31
    s_and_b32 s81, s69, s31
    v_rcp_f32 v160, v160
    buffer_load_dwordx4 v[64:67], v212, s[4:7], s80 offen
    v_rcp_f32 v161, v161
    buffer_load_dwordx4 v[68:71], v212, s[4:7], s81 offen
    v_rcp_f32 v162, v162
    v_rcp_f32 v163, v163
    v_pk_mul_f32 v[160:161], v[160:161], v[92:93]
    v_pk_mul_f32 v[162:163], v[162:163], v[108:109]
    s_set_gpr_idx_on s76, gpr_idx(SRC2,DST)
    v_pk_fma_f32 v[8:9], v[160:161], v[144:145], v[8:9] op_sel:[0,0,0] op_sel_hi:[0,1,1]
    v_pk_fma_f32 v[10:11], v[160:161], v[146:147], v[10:11] op_sel:[0,0,0] op_sel_hi:[0,1,1]
    v_pk_fma_f32 v[12:13], v[162:163], v[148:149], v[12:13] op_sel:[0,0,0] op_sel_hi:[0,1,1]
    v_pk_fma_f32 v[14:15], v[162:163], v[150:151], v[14:15] op_sel:[0,0,0] op_sel_hi:[0,1,1]
    s_set_gpr_idx_idx s77
    v_pk_fma_f32 v[8:9], v[160:161], v[152:153], v[8:9] op_sel:[1,0,0] op_sel_hi:[1,1,1]
    v_pk_fma_f32 v[10:11], v[160:161], v[154:155], v[10:11] op_sel:[1,0,0] op_sel_hi:[1,1,1]
    v_pk_fma_f32 v[12:13], v[162:163], v[156:157], v[12:13] op_sel:[1,0,0] op_sel_hi:[1,1,1]
    v_pk_fma_f32 v[14:15], v[162:163], v[158:159], v[14:15] op_sel:[1,0,0] op_sel_hi:[1,1,1]
    s_set_gpr_idx_off
    s_cmp_le_i32 s30, 14
    s_cbranch_scc1 L_exit
    s_waitcnt lgkmcnt(0)
    v_and_or_b32 v209, v209, s33, v213
    s_waitcnt vmcnt(7)
    v_mfma_f32_4x4x4_16b_bf16 v[144:147], v[164:165], v[72:73], 0 cbsz:4 abid:14
    v_exp_f32 v160, v94
    v_mfma_f32_4x4x4_16b_bf16 v[148:151], v[164:165], v[74:75], 0 cbsz:4 abid:14
    v_exp_f32 v161, v95
    s_waitcnt vmcnt(6)
    v_mfma_f32_4x4x4_16b_bf16 v[152:155], v[164:165], v[76:77], 0 cbsz:4 abid:15
    v_exp_f32 v162, v110
    v_mfma_f32_4x4x4_16b_bf16 v[156:159], v[164:165], v[78:79], 0 cbsz:4 abid:15
    v_exp_f32 v163, v111
    v_readlane_b32 s70, v208, 25
    v_readlane_b32 s71, v208, 29
    v_pk_add_f32 v[160:161], v[160:161], 1.0 op_sel_hi:[1,0]
    v_pk_add_f32 v[162:163], v[162:163], 1.0 op_sel_hi:[1,0]
    s_and_b32 s80, s70, s31
    s_and_b32 s81, s71, s31
    v_rcp_f32 v160, v160
    buffer_load_dwordx4 v[72:75], v212, s[4:7], s80 offen
    v_rcp_f32 v161, v161
    buffer_load_dwordx4 v[76:79], v212, s[4:7], s81 offen
    v_rcp_f32 v162, v162
    v_rcp_f32 v163, v163
    v_pk_mul_f32 v[160:161], v[160:161], v[94:95]
    v_pk_mul_f32 v[162:163], v[162:163], v[110:111]
    s_set_gpr_idx_on s78, gpr_idx(SRC2,DST)
    v_pk_fma_f32 v[8:9], v[160:161], v[144:145], v[8:9] op_sel:[0,0,0] op_sel_hi:[0,1,1]
    v_pk_fma_f32 v[10:11], v[160:161], v[146:147], v[10:11] op_sel:[0,0,0] op_sel_hi:[0,1,1]
    v_pk_fma_f32 v[12:13], v[162:163], v[148:149], v[12:13] op_sel:[0,0,0] op_sel_hi:[0,1,1]
    v_pk_fma_f32 v[14:15], v[162:163], v[150:151], v[14:15] op_sel:[0,0,0] op_sel_hi:[0,1,1]
    s_set_gpr_idx_idx s79
    v_pk_fma_f32 v[8:9], v[160:161], v[152:153], v[8:9] op_sel:[1,0,0] op_sel_hi:[1,1,1]
    v_pk_fma_f32 v[10:11], v[160:161], v[154:155], v[10:11] op_sel:[1,0,0] op_sel_hi:[1,1,1]
    v_pk_fma_f32 v[12:13], v[162:163], v[156:157], v[12:13] op_sel:[1,0,0] op_sel_hi:[1,1,1]
    v_pk_fma_f32 v[14:15], v[162:163], v[158:159], v[14:15] op_sel:[1,0,0] op_sel_hi:[1,1,1]
    s_set_gpr_idx_off
    s_cmp_le_i32 s30, 16
    s_cbranch_scc1 L_exit
    s_mov_b64 exec, s[20:21]
    ds_read_b128 v[172:175], v209
    s_mov_b64 exec, -1
    s_mov_b64 exec, s[22:23]
    ds_read_b128 v[176:179], v209
    s_mov_b64 exec, -1
    s_waitcnt vmcnt(7)
    v_mfma_f32_4x4x4_16b_bf16 v[144:147], v[166:167], v[48:49], 0 cbsz:4 abid:0
    v_exp_f32 v160, v112
    v_mfma_f32_4x4x4_16b_bf16 v[148:151], v[166:167], v[50:51], 0 cbsz:4 abid:0
    v_exp_f32 v161, v113
    s_waitcnt vmcnt(6)
    v_mfma_f32_4x4x4_16b_bf16 v[152:155], v[166:167], v[52:53], 0 cbsz:4 abid:1
    v_exp_f32 v162, v128
    v_mfma_f32_4x4x4_16b_bf16 v[156:159], v[166:167], v[54:55], 0 cbsz:4 abid:1
    v_exp_f32 v163, v129
    v_readlane_b32 s72, v208, 33
    v_readlane_b32 s73, v208, 37
    v_pk_add_f32 v[160:161], v[160:161], 1.0 op_sel_hi:[1,0]
    v_pk_add_f32 v[162:163], v[162:163], 1.0 op_sel_hi:[1,0]
    s_and_b32 s80, s72, s31
    s_and_b32 s81, s73, s31
    v_rcp_f32 v160, v160
    buffer_load_dwordx4 v[48:51], v212, s[4:7], s80 offen
    v_rcp_f32 v161, v161
    buffer_load_dwordx4 v[52:55], v212, s[4:7], s81 offen
    v_rcp_f32 v162, v162
    v_rcp_f32 v163, v163
    v_pk_mul_f32 v[160:161], v[160:161], v[112:113]
    v_pk_mul_f32 v[162:163], v[162:163], v[128:129]
    s_set_gpr_idx_on s64, gpr_idx(SRC2,DST)
    v_pk_fma_f32 v[8:9], v[160:161], v[144:145], v[8:9] op_sel:[0,0,0] op_sel_hi:[0,1,1]
    v_pk_fma_f32 v[10:11], v[160:161], v[146:147], v[10:11] op_sel:[0,0,0] op_sel_hi:[0,1,1]
    v_pk_fma_f32 v[12:13], v[162:163], v[148:149], v[12:13] op_sel:[0,0,0] op_sel_hi:[0,1,1]
    v_pk_fma_f32 v[14:15], v[162:163], v[150:151], v[14:15] op_sel:[0,0,0] op_sel_hi:[0,1,1]
    s_set_gpr_idx_idx s65
    v_pk_fma_f32 v[8:9], v[160:161], v[152:153], v[8:9] op_sel:[1,0,0] op_sel_hi:[1,1,1]
    v_pk_fma_f32 v[10:11], v[160:161], v[154:155], v[10:11] op_sel:[1,0,0] op_sel_hi:[1,1,1]
    v_pk_fma_f32 v[12:13], v[162:163], v[156:157], v[12:13] op_sel:[1,0,0] op_sel_hi:[1,1,1]
    v_pk_fma_f32 v[14:15], v[162:163], v[158:159], v[14:15] op_sel:[1,0,0] op_sel_hi:[1,1,1]
    s_set_gpr_idx_off
    s_cmp_le_i32 s30, 18
    s_cbranch_scc1 L_exit
    s_waitcnt vmcnt(7)
    v_mfma_f32_4x4x4_16b_bf16 v[144:147], v[166:167], v[56:57], 0 cbsz:4 abid:2
    v_exp_f32 v160, v114
    v_mfma_f32_4x4x4_16b_bf16 v[148:151], v[166:167], v[58:59], 0 cbsz:4 abid:2
    v_exp_f32 v161, v115
    s_waitcnt vmcnt(6)
    v_mfma_f32_4x4x4_16b_bf16 v[152:155], v[166:167], v[60:61], 0 cbsz:4 abid:3
    v_exp_f32 v162, v130
    v_mfma_f32_4x4x4_16b_bf16 v[156:159], v[166:167], v[62:63], 0 cbsz:4 abid:3
    v_exp_f32 v163, v131
    v_readlane_b32 s74, v208, 41
    v_readlane_b32 s75, v208, 45
    v_pk_add_f32 v[160:161], v[160:161], 1.0 op_sel_hi:[1,0]
    v_pk_add_f32 v[162:163], v[162:163], 1.0 op_sel_hi:[1,0]
    s_and_b32 s80, s74, s31
    s_and_b32 s81, s75, s31
    v_rcp_f32 v160, v160
    buffer_load_dwordx4 v[56:59], v212, s[4:7], s80 offen
    v_rcp_f32 v161, v161
    buffer_load_dwordx4 v[60:63], v212, s[4:7], s81 offen
    v_rcp_f32 v162, v162
    v_rcp_f32 v163, v163
    v_pk_mul_f32 v[160:161], v[160:161], v[114:115]
    v_pk_mul_f32 v[162:163], v[162:163], v[130:131]
    s_set_gpr_idx_on s66, gpr_idx(SRC2,DST)
    v_pk_fma_f32 v[8:9], v[160:161], v[144:145], v[8:9] op_sel:[0,0,0] op_sel_hi:[0,1,1]
    v_pk_fma_f32 v[10:11], v[160:161], v[146:147], v[10:11] op_sel:[0,0,0] op_sel_hi:[0,1,1]
    v_pk_fma_f32 v[12:13], v[162:163], v[148:149], v[12:13] op_sel:[0,0,0] op_sel_hi:[0,1,1]
    v_pk_fma_f32 v[14:15], v[162:163], v[150:151], v[14:15] op_sel:[0,0,0] op_sel_hi:[0,1,1]
    s_set_gpr_idx_idx s67
    v_pk_fma_f32 v[8:9], v[160:161], v[152:153], v[8:9] op_sel:[1,0,0] op_sel_hi:[1,1,1]
    v_pk_fma_f32 v[10:11], v[160:161], v[154:155], v[10:11] op_sel:[1,0,0] op_sel_hi:[1,1,1]
    v_pk_fma_f32 v[12:13], v[162:163], v[156:157], v[12:13] op_sel:[1,0,0] op_sel_hi:[1,1,1]
    v_pk_fma_f32 v[14:15], v[162:163], v[158:159], v[14:15] op_sel:[1,0,0] op_sel_hi:[1,1,1]
    s_set_gpr_idx_off
    s_cmp_le_i32 s30, 20
    s_cbranch_scc1 L_exit
    s_waitcnt vmcnt(7)
    v_mfma_f32_4x4x4_16b_bf16 v[144:147], v[166:167], v[64:65], 0 cbsz:4 abid:4
    v_exp_f32 v160, v116
    v_mfma_f32_4x4x4_16b_bf16 v[148:151], v[166:167], v[66:67], 0 cbsz:4 abid:4
    v_exp_f32 v161, v117
    s_waitcnt vmcnt(6)
    v_mfma_f32_4x4x4_16b_bf16 v[152:155], v[166:167], v[68:69], 0 cbsz:4 abid:5
    v_exp_f32 v162, v132
    v_mfma_f32_4x4x4_16b_bf16 v[156:159], v[166:167], v[70:71], 0 cbsz:4 abid:5
    v_exp_f32 v163, v133
    v_readlane_b32 s76, v208, 49
    v_readlane_b32 s77, v208, 53
    v_pk_add_f32 v[160:161], v[160:161], 1.0 op_sel_hi:[1,0]
    v_pk_add_f32 v[162:163], v[162:163], 1.0 op_sel_hi:[1,0]
    s_and_b32 s80, s76, s31
    s_and_b32 s81, s77, s31
    s_waitcnt lgkmcnt(0)
    v_mfma_f32_32x32x16_bf16 v[80:95], v[172:175], v[180:183], 0
    v_rcp_f32 v160, v160
    buffer_load_dwordx4 v[64:67], v212, s[4:7], s80 offen
    v_rcp_f32 v161, v161
    buffer_load_dwordx4 v[68:71], v212, s[4:7], s81 offen
    v_rcp_f32 v162, v162
    v_rcp_f32 v163, v163
    v_pk_mul_f32 v[160:161], v[160:161], v[116:117]
    v_pk_mul_f32 v[162:163], v[162:163], v[132:133]
    s_set_gpr_idx_on s68, gpr_idx(SRC2,DST)
    v_pk_fma_f32 v[8:9], v[160:161], v[144:145], v[8:9] op_sel:[0,0,0] op_sel_hi:[0,1,1]
    v_pk_fma_f32 v[10:11], v[160:161], v[146:147], v[10:11] op_sel:[0,0,0] op_sel_hi:[0,1,1]
    v_pk_fma_f32 v[12:13], v[162:163], v[148:149], v[12:13] op_sel:[0,0,0] op_sel_hi:[0,1,1]
    v_pk_fma_f32 v[14:15], v[162:163], v[150:151], v[14:15] op_sel:[0,0,0] op_sel_hi:[0,1,1]
    s_set_gpr_idx_idx s69
    v_pk_fma_f32 v[8:9], v[160:161], v[152:153], v[8:9] op_sel:[1,0,0] op_sel_hi:[1,1,1]
    v_pk_fma_f32 v[10:11], v[160:161], v[154:155], v[10:11] op_sel:[1,0,0] op_sel_hi:[1,1,1]
    v_pk_fma_f32 v[12:13], v[162:163], v[156:157], v[12:13] op_sel:[1,0,0] op_sel_hi:[1,1,1]
    v_pk_fma_f32 v[14:15], v[162:163], v[158:159], v[14:15] op_sel:[1,0,0] op_sel_hi:[1,1,1]
    s_set_gpr_idx_off
    s_cmp_le_i32 s30, 22
    s_cbranch_scc1 L_exit
    s_waitcnt vmcnt(7)
    v_mfma_f32_4x4x4_16b_bf16 v[144:147], v[166:167], v[72:73], 0 cbsz:4 abid:6
    v_exp_f32 v160, v118
    v_mfma_f32_4x4x4_16b_bf16 v[148:151], v[166:167], v[74:75], 0 cbsz:4 abid:6
    v_exp_f32 v161, v119
    s_waitcnt vmcnt(6)
    v_mfma_f32_4x4x4_16b_bf16 v[152:155], v[166:167], v[76:77], 0 cbsz:4 abid:7
    v_exp_f32 v162, v134
    v_mfma_f32_4x4x4_16b_bf16 v[156:159], v[166:167], v[78:79], 0 cbsz:4 abid:7
    v_exp_f32 v163, v135
    v_readlane_b32 s78, v208, 57
    v_readlane_b32 s79, v208, 61
    v_pk_add_f32 v[160:161], v[160:161], 1.0 op_sel_hi:[1,0]
    v_pk_add_f32 v[162:163], v[162:163], 1.0 op_sel_hi:[1,0]
    s_and_b32 s80, s78, s31
    s_and_b32 s81, s79, s31
    v_mfma_f32_32x32x16_bf16 v[96:111], v[172:175], v[184:187], 0
    v_rcp_f32 v160, v160
    buffer_load_dwordx4 v[72:75], v212, s[4:7], s80 offen
    v_rcp_f32 v161, v161
    buffer_load_dwordx4 v[76:79], v212, s[4:7], s81 offen
    v_rcp_f32 v162, v162
    v_rcp_f32 v163, v163
    v_pk_mul_f32 v[160:161], v[160:161], v[118:119]
    v_pk_mul_f32 v[162:163], v[162:163], v[134:135]
    s_set_gpr_idx_on s70, gpr_idx(SRC2,DST)
    v_pk_fma_f32 v[8:9], v[160:161], v[144:145], v[8:9] op_sel:[0,0,0] op_sel_hi:[0,1,1]
    v_pk_fma_f32 v[10:11], v[160:161], v[146:147], v[10:11] op_sel:[0,0,0] op_sel_hi:[0,1,1]
    v_pk_fma_f32 v[12:13], v[162:163], v[148:149], v[12:13] op_sel:[0,0,0] op_sel_hi:[0,1,1]
    v_pk_fma_f32 v[14:15], v[162:163], v[150:151], v[14:15] op_sel:[0,0,0] op_sel_hi:[0,1,1]
    s_set_gpr_idx_idx s71
    v_pk_fma_f32 v[8:9], v[160:161], v[152:153], v[8:9] op_sel:[1,0,0] op_sel_hi:[1,1,1]
    v_pk_fma_f32 v[10:11], v[160:161], v[154:155], v[10:11] op_sel:[1,0,0] op_sel_hi:[1,1,1]
    v_pk_fma_f32 v[12:13], v[162:163], v[156:157], v[12:13] op_sel:[1,0,0] op_sel_hi:[1,1,1]
    v_pk_fma_f32 v[14:15], v[162:163], v[158:159], v[14:15] op_sel:[1,0,0] op_sel_hi:[1,1,1]
    s_set_gpr_idx_off
    s_cmp_le_i32 s30, 24
    s_cbranch_scc1 L_exit
    s_waitcnt vmcnt(7)
    v_mfma_f32_4x4x4_16b_bf16 v[144:147], v[166:167], v[48:49], 0 cbsz:4 abid:8
    v_exp_f32 v160, v120
    v_mfma_f32_4x4x4_16b_bf16 v[148:151], v[166:167], v[50:51], 0 cbsz:4 abid:8
    v_exp_f32 v161, v121
    s_waitcnt vmcnt(6)
    v_mfma_f32_4x4x4_16b_bf16 v[152:155], v[166:167], v[52:53], 0 cbsz:4 abid:9
    v_exp_f32 v162, v136
    v_mfma_f32_4x4x4_16b_bf16 v[156:159], v[166:167], v[54:55], 0 cbsz:4 abid:9
    v_exp_f32 v163, v137
    v_readlane_b32 s64, v208, 2
    v_readlane_b32 s65, v208, 6
    v_pk_add_f32 v[160:161], v[160:161], 1.0 op_sel_hi:[1,0]
    v_pk_add_f32 v[162:163], v[162:163], 1.0 op_sel_hi:[1,0]
    s_and_b32 s80, s64, s31
    s_and_b32 s81, s65, s31
    v_mfma_f32_32x32x16_bf16 v[80:95], v[176:179], v[188:191], v[80:95]
    v_rcp_f32 v160, v160
    buffer_load_dwordx4 v[48:51], v212, s[4:7], s80 offen
    v_rcp_f32 v161, v161
    buffer_load_dwordx4 v[52:55], v212, s[4:7], s81 offen
    v_rcp_f32 v162, v162
    v_rcp_f32 v163, v163
    v_pk_mul_f32 v[160:161], v[160:161], v[120:121]
    v_pk_mul_f32 v[162:163], v[162:163], v[136:137]
    s_set_gpr_idx_on s72, gpr_idx(SRC2,DST)
    v_pk_fma_f32 v[8:9], v[160:161], v[144:145], v[8:9] op_sel:[0,0,0] op_sel_hi:[0,1,1]
    v_pk_fma_f32 v[10:11], v[160:161], v[146:147], v[10:11] op_sel:[0,0,0] op_sel_hi:[0,1,1]
    v_pk_fma_f32 v[12:13], v[162:163], v[148:149], v[12:13] op_sel:[0,0,0] op_sel_hi:[0,1,1]
    v_pk_fma_f32 v[14:15], v[162:163], v[150:151], v[14:15] op_sel:[0,0,0] op_sel_hi:[0,1,1]
    s_set_gpr_idx_idx s73
    v_pk_fma_f32 v[8:9], v[160:161], v[152:153], v[8:9] op_sel:[1,0,0] op_sel_hi:[1,1,1]
    v_pk_fma_f32 v[10:11], v[160:161], v[154:155], v[10:11] op_sel:[1,0,0] op_sel_hi:[1,1,1]
    v_pk_fma_f32 v[12:13], v[162:163], v[156:157], v[12:13] op_sel:[1,0,0] op_sel_hi:[1,1,1]
    v_pk_fma_f32 v[14:15], v[162:163], v[158:159], v[14:15] op_sel:[1,0,0] op_sel_hi:[1,1,1]
    s_set_gpr_idx_off
    s_cmp_le_i32 s30, 26
    s_cbranch_scc1 L_exit
    s_waitcnt vmcnt(7)
    v_mfma_f32_4x4x4_16b_bf16 v[144:147], v[166:167], v[56:57], 0 cbsz:4 abid:10
    v_exp_f32 v160, v122
    v_mfma_f32_4x4x4_16b_bf16 v[148:151], v[166:167], v[58:59], 0 cbsz:4 abid:10
    v_exp_f32 v161, v123
    s_waitcnt vmcnt(6)
    v_mfma_f32_4x4x4_16b_bf16 v[152:155], v[166:167], v[60:61], 0 cbsz:4 abid:11
    v_exp_f32 v162, v138
    v_mfma_f32_4x4x4_16b_bf16 v[156:159], v[166:167], v[62:63], 0 cbsz:4 abid:11
    v_exp_f32 v163, v139
    v_readlane_b32 s66, v208, 10
    v_readlane_b32 s67, v208, 14
    v_pk_add_f32 v[160:161], v[160:161], 1.0 op_sel_hi:[1,0]
    v_pk_add_f32 v[162:163], v[162:163], 1.0 op_sel_hi:[1,0]
    s_and_b32 s80, s66, s31
    s_and_b32 s81, s67, s31
    v_mfma_f32_32x32x16_bf16 v[96:111], v[176:179], v[192:195], v[96:111]
    v_rcp_f32 v160, v160
    buffer_load_dwordx4 v[56:59], v212, s[4:7], s80 offen
    v_rcp_f32 v161, v161
    buffer_load_dwordx4 v[60:63], v212, s[4:7], s81 offen
    v_rcp_f32 v162, v162
    v_rcp_f32 v163, v163
    v_pk_mul_f32 v[160:161], v[160:161], v[122:123]
    v_pk_mul_f32 v[162:163], v[162:163], v[138:139]
    s_set_gpr_idx_on s74, gpr_idx(SRC2,DST)
    v_pk_fma_f32 v[8:9], v[160:161], v[144:145], v[8:9] op_sel:[0,0,0] op_sel_hi:[0,1,1]
    v_pk_fma_f32 v[10:11], v[160:161], v[146:147], v[10:11] op_sel:[0,0,0] op_sel_hi:[0,1,1]
    v_pk_fma_f32 v[12:13], v[162:163], v[148:149], v[12:13] op_sel:[0,0,0] op_sel_hi:[0,1,1]
    v_pk_fma_f32 v[14:15], v[162:163], v[150:151], v[14:15] op_sel:[0,0,0] op_sel_hi:[0,1,1]
    s_set_gpr_idx_idx s75
    v_pk_fma_f32 v[8:9], v[160:161], v[152:153], v[8:9] op_sel:[1,0,0] op_sel_hi:[1,1,1]
    v_pk_fma_f32 v[10:11], v[160:161], v[154:155], v[10:11] op_sel:[1,0,0] op_sel_hi:[1,1,1]
    v_pk_fma_f32 v[12:13], v[162:163], v[156:157], v[12:13] op_sel:[1,0,0] op_sel_hi:[1,1,1]
    v_pk_fma_f32 v[14:15], v[162:163], v[158:159], v[14:15] op_sel:[1,0,0] op_sel_hi:[1,1,1]
    s_set_gpr_idx_off
    s_cmp_le_i32 s30, 28
    s_cbranch_scc1 L_exit
    ds_read_b32 v209, v211 offset:780
    s_waitcnt vmcnt(7)
    v_mfma_f32_4x4x4_16b_bf16 v[144:147], v[166:167], v[64:65], 0 cbsz:4 abid:12
    v_exp_f32 v160, v124
    v_mfma_f32_4x4x4_16b_bf16 v[148:151], v[166:167], v[66:67], 0 cbsz:4 abid:12
    v_exp_f32 v161, v125
    s_waitcnt vmcnt(6)
    v_mfma_f32_4x4x4_16b_bf16 v[152:155], v[166:167], v[68:69], 0 cbsz:4 abid:13
    v_exp_f32 v162, v140
    v_mfma_f32_4x4x4_16b_bf16 v[156:159], v[166:167], v[70:71], 0 cbsz:4 abid:13
    v_exp_f32 v163, v141
    v_readlane_b32 s68, v208, 18
    v_readlane_b32 s69, v208, 22
    v_pk_add_f32 v[160:161], v[160:161], 1.0 op_sel_hi:[1,0]
    v_pk_add_f32 v[162:163], v[162:163], 1.0 op_sel_hi:[1,0]
    s_and_b32 s80, s68, s31
    s_and_b32 s81, s69, s31
    v_rcp_f32 v160, v160
    buffer_load_dwordx4 v[64:67], v212, s[4:7], s80 offen
    v_rcp_f32 v161, v161
    buffer_load_dwordx4 v[68:71], v212, s[4:7], s81 offen
    v_rcp_f32 v162, v162
    v_rcp_f32 v163, v163
    v_pk_mul_f32 v[160:161], v[160:161], v[124:125]
    v_pk_mul_f32 v[162:163], v[162:163], v[140:141]
    s_set_gpr_idx_on s76, gpr_idx(SRC2,DST)
    v_pk_fma_f32 v[8:9], v[160:161], v[144:145], v[8:9] op_sel:[0,0,0] op_sel_hi:[0,1,1]
    v_pk_fma_f32 v[10:11], v[160:161], v[146:147], v[10:11] op_sel:[0,0,0] op_sel_hi:[0,1,1]
    v_pk_fma_f32 v[12:13], v[162:163], v[148:149], v[12:13] op_sel:[0,0,0] op_sel_hi:[0,1,1]
    v_pk_fma_f32 v[14:15], v[162:163], v[150:151], v[14:15] op_sel:[0,0,0] op_sel_hi:[0,1,1]
    s_set_gpr_idx_idx s77
    v_pk_fma_f32 v[8:9], v[160:161], v[152:153], v[8:9] op_sel:[1,0,0] op_sel_hi:[1,1,1]
    v_pk_fma_f32 v[10:11], v[160:161], v[154:155], v[10:11] op_sel:[1,0,0] op_sel_hi:[1,1,1]
    v_pk_fma_f32 v[12:13], v[162:163], v[156:157], v[12:13] op_sel:[1,0,0] op_sel_hi:[1,1,1]
    v_pk_fma_f32 v[14:15], v[162:163], v[158:159], v[14:15] op_sel:[1,0,0] op_sel_hi:[1,1,1]
    s_set_gpr_idx_off
    s_cmp_le_i32 s30, 30
    s_cbranch_scc1 L_exit
    s_waitcnt lgkmcnt(0)
    v_and_or_b32 v209, v209, s33, v213
    s_waitcnt vmcnt(7)
    v_mfma_f32_4x4x4_16b_bf16 v[144:147], v[166:167], v[72:73], 0 cbsz:4 abid:14
    v_exp_f32 v160, v126
    v_mfma_f32_4x4x4_16b_bf16 v[148:151], v[166:167], v[74:75], 0 cbsz:4 abid:14
    v_exp_f32 v161, v127
    s_waitcnt vmcnt(6)
    v_mfma_f32_4x4x4_16b_bf16 v[152:155], v[166:167], v[76:77], 0 cbsz:4 abid:15
    v_exp_f32 v162, v142
    v_mfma_f32_4x4x4_16b_bf16 v[156:159], v[166:167], v[78:79], 0 cbsz:4 abid:15
    v_exp_f32 v163, v143
    v_readlane_b32 s70, v208, 26
    v_readlane_b32 s71, v208, 30
    v_pk_add_f32 v[160:161], v[160:161], 1.0 op_sel_hi:[1,0]
    v_pk_add_f32 v[162:163], v[162:163], 1.0 op_sel_hi:[1,0]
    s_and_b32 s80, s70, s31
    s_and_b32 s81, s71, s31
    v_rcp_f32 v160, v160
    buffer_load_dwordx4 v[72:75], v212, s[4:7], s80 offen
    v_rcp_f32 v161, v161
    buffer_load_dwordx4 v[76:79], v212, s[4:7], s81 offen
    v_rcp_f32 v162, v162
    v_rcp_f32 v163, v163
    v_pk_mul_f32 v[160:161], v[160:161], v[126:127]
    v_pk_mul_f32 v[162:163], v[162:163], v[142:143]
    s_set_gpr_idx_on s78, gpr_idx(SRC2,DST)
    v_pk_fma_f32 v[8:9], v[160:161], v[144:145], v[8:9] op_sel:[0,0,0] op_sel_hi:[0,1,1]
    v_pk_fma_f32 v[10:11], v[160:161], v[146:147], v[10:11] op_sel:[0,0,0] op_sel_hi:[0,1,1]
    v_pk_fma_f32 v[12:13], v[162:163], v[148:149], v[12:13] op_sel:[0,0,0] op_sel_hi:[0,1,1]
    v_pk_fma_f32 v[14:15], v[162:163], v[150:151], v[14:15] op_sel:[0,0,0] op_sel_hi:[0,1,1]
    s_set_gpr_idx_idx s79
    v_pk_fma_f32 v[8:9], v[160:161], v[152:153], v[8:9] op_sel:[1,0,0] op_sel_hi:[1,1,1]
    v_pk_fma_f32 v[10:11], v[160:161], v[154:155], v[10:11] op_sel:[1,0,0] op_sel_hi:[1,1,1]
    v_pk_fma_f32 v[12:13], v[162:163], v[156:157], v[12:13] op_sel:[1,0,0] op_sel_hi:[1,1,1]
    v_pk_fma_f32 v[14:15], v[162:163], v[158:159], v[14:15] op_sel:[1,0,0] op_sel_hi:[1,1,1]
    s_set_gpr_idx_off
    s_cmp_le_i32 s30, 32
    s_cbranch_scc1 L_exit
    s_mov_b64 exec, s[20:21]
    ds_read_b128 v[172:175], v209
    s_mov_b64 exec, -1
    s_mov_b64 exec, s[22:23]
    ds_read_b128 v[176:179], v209
    s_mov_b64 exec, -1
    s_waitcnt vmcnt(7)
    v_mfma_f32_4x4x4_16b_bf16 v[144:147], v[168:169], v[48:49], 0 cbsz:4 abid:0
    v_exp_f32 v160, v80
    v_mfma_f32_4x4x4_16b_bf16 v[148:151], v[168:169], v[50:51], 0 cbsz:4 abid:0
    v_exp_f32 v161, v81
    s_waitcnt vmcnt(6)
    v_mfma_f32_4x4x4_16b_bf16 v[152:155], v[168:169], v[52:53], 0 cbsz:4 abid:1
    v_exp_f32 v162, v96
    v_mfma_f32_4x4x4_16b_bf16 v[156:159], v[168:169], v[54:55], 0 cbsz:4 abid:1
    v_exp_f32 v163, v97
    v_readlane_b32 s72, v208, 34
    v_readlane_b32 s73, v208, 38
    v_pk_add_f32 v[160:161], v[160:161], 1.0 op_sel_hi:[1,0]
    v_pk_add_f32 v[162:163], v[162:163], 1.0 op_sel_hi:[1,0]
    s_and_b32 s80, s72, s31
    s_and_b32 s81, s73, s31
    v_rcp_f32 v160, v160
    buffer_load_dwordx4 v[48:51], v212, s[4:7], s80 offen
    v_rcp_f32 v161, v161
    buffer_load_dwordx4 v[52:55], v212, s[4:7], s81 offen
    v_rcp_f32 v162, v162
    v_rcp_f32 v163, v163
    v_pk_mul_f32 v[160:161], v[160:161], v[80:81]
    v_pk_mul_f32 v[162:163], v[162:163], v[96:97]
    s_set_gpr_idx_on s64, gpr_idx(SRC2,DST)
    v_pk_fma_f32 v[8:9], v[160:161], v[144:145], v[8:9] op_sel:[0,0,0] op_sel_hi:[0,1,1]
    v_pk_fma_f32 v[10:11], v[160:161], v[146:147], v[10:11] op_sel:[0,0,0] op_sel_hi:[0,1,1]
    v_pk_fma_f32 v[12:13], v[162:163], v[148:149], v[12:13] op_sel:[0,0,0] op_sel_hi:[0,1,1]
    v_pk_fma_f32 v[14:15], v[162:163], v[150:151], v[14:15] op_sel:[0,0,0] op_sel_hi:[0,1,1]
    s_set_gpr_idx_idx s65
    v_pk_fma_f32 v[8:9], v[160:161], v[152:153], v[8:9] op_sel:[1,0,0] op_sel_hi:[1,1,1]
    v_pk_fma_f32 v[10:11], v[160:161], v[154:155], v[10:11] op_sel:[1,0,0] op_sel_hi:[1,1,1]
    v_pk_fma_f32 v[12:13], v[162:163], v[156:157], v[12:13] op_sel:[1,0,0] op_sel_hi:[1,1,1]
    v_pk_fma_f32 v[14:15], v[162:163], v[158:159], v[14:15] op_sel:[1,0,0] op_sel_hi:[1,1,1]
    s_set_gpr_idx_off
    s_cmp_le_i32 s30, 34
    s_cbranch_scc1 L_exit
    s_waitcnt vmcnt(7)
    v_mfma_f32_4x4x4_16b_bf16 v[144:147], v[168:169], v[56:57], 0 cbsz:4 abid:2
    v_exp_f32 v160, v82
    v_mfma_f32_4x4x4_16b_bf16 v[148:151], v[168:169], v[58:59], 0 cbsz:4 abid:2
    v_exp_f32 v161, v83
    s_waitcnt vmcnt(6)
    v_mfma_f32_4x4x4_16b_bf16 v[152:155], v[168:169], v[60:61], 0 cbsz:4 abid:3
    v_exp_f32 v162, v98
    v_mfma_f32_4x4x4_16b_bf16 v[156:159], v[168:169], v[62:63], 0 cbsz:4 abid:3
    v_exp_f32 v163, v99
    v_readlane_b32 s74, v208, 42
    v_readlane_b32 s75, v208, 46
    v_pk_add_f32 v[160:161], v[160:161], 1.0 op_sel_hi:[1,0]
    v_pk_add_f32 v[162:163], v[162:163], 1.0 op_sel_hi:[1,0]
    s_and_b32 s80, s74, s31
    s_and_b32 s81, s75, s31
    v_rcp_f32 v160, v160
    buffer_load_dwordx4 v[56:59], v212, s[4:7], s80 offen
    v_rcp_f32 v161, v161
    buffer_load_dwordx4 v[60:63], v212, s[4:7], s81 offen
    v_rcp_f32 v162, v162
    v_rcp_f32 v163, v163
    v_pk_mul_f32 v[160:161], v[160:161], v[82:83]
    v_pk_mul_f32 v[162:163], v[162:163], v[98:99]
    s_set_gpr_idx_on s66, gpr_idx(SRC2,DST)
    v_pk_fma_f32 v[8:9], v[160:161], v[144:145], v[8:9] op_sel:[0,0,0] op_sel_hi:[0,1,1]
    v_pk_fma_f32 v[10:11], v[160:161], v[146:147], v[10:11] op_sel:[0,0,0] op_sel_hi:[0,1,1]
    v_pk_fma_f32 v[12:13], v[162:163], v[148:149], v[12:13] op_sel:[0,0,0] op_sel_hi:[0,1,1]
    v_pk_fma_f32 v[14:15], v[162:163], v[150:151], v[14:15] op_sel:[0,0,0] op_sel_hi:[0,1,1]
    s_set_gpr_idx_idx s67
    v_pk_fma_f32 v[8:9], v[160:161], v[152:153], v[8:9] op_sel:[1,0,0] op_sel_hi:[1,1,1]
    v_pk_fma_f32 v[10:11], v[160:161], v[154:155], v[10:11] op_sel:[1,0,0] op_sel_hi:[1,1,1]
    v_pk_fma_f32 v[12:13], v[162:163], v[156:157], v[12:13] op_sel:[1,0,0] op_sel_hi:[1,1,1]
    v_pk_fma_f32 v[14:15], v[162:163], v[158:159], v[14:15] op_sel:[1,0,0] op_sel_hi:[1,1,1]
    s_set_gpr_idx_off
    s_cmp_le_i32 s30, 36
    s_cbranch_scc1 L_exit
    s_waitcnt vmcnt(7)
    v_mfma_f32_4x4x4_16b_bf16 v[144:147], v[168:169], v[64:65], 0 cbsz:4 abid:4
    v_exp_f32 v160, v84
    v_mfma_f32_4x4x4_16b_bf16 v[148:151], v[168:169], v[66:67], 0 cbsz:4 abid:4
    v_exp_f32 v161, v85
    s_waitcnt vmcnt(6)
    v_mfma_f32_4x4x4_16b_bf16 v[152:155], v[168:169], v[68:69], 0 cbsz:4 abid:5
    v_exp_f32 v162, v100
    v_mfma_f32_4x4x4_16b_bf16 v[156:159], v[168:169], v[70:71], 0 cbsz:4 abid:5
    v_exp_f32 v163, v101
    v_readlane_b32 s76, v208, 50
    v_readlane_b32 s77, v208, 54
    v_pk_add_f32 v[160:161], v[160:161], 1.0 op_sel_hi:[1,0]
    v_pk_add_f32 v[162:163], v[162:163], 1.0 op_sel_hi:[1,0]
    s_and_b32 s80, s76, s31
    s_and_b32 s81, s77, s31
    s_waitcnt lgkmcnt(0)
    v_mfma_f32_32x32x16_bf16 v[112:127], v[172:175], v[180:183], 0
    v_rcp_f32 v160, v160
    buffer_load_dwordx4 v[64:67], v212, s[4:7], s80 offen
    v_rcp_f32 v161, v161
    buffer_load_dwordx4 v[68:71], v212, s[4:7], s81 offen
    v_rcp_f32 v162, v162
    v_rcp_f32 v163, v163
    v_pk_mul_f32 v[160:161], v[160:161], v[84:85]
    v_pk_mul_f32 v[162:163], v[162:163], v[100:101]
    s_set_gpr_idx_on s68, gpr_idx(SRC2,DST)
    v_pk_fma_f32 v[8:9], v[160:161], v[144:145], v[8:9] op_sel:[0,0,0] op_sel_hi:[0,1,1]
    v_pk_fma_f32 v[10:11], v[160:161], v[146:147], v[10:11] op_sel:[0,0,0] op_sel_hi:[0,1,1]
    v_pk_fma_f32 v[12:13], v[162:163], v[148:149], v[12:13] op_sel:[0,0,0] op_sel_hi:[0,1,1]
    v_pk_fma_f32 v[14:15], v[162:163], v[150:151], v[14:15] op_sel:[0,0,0] op_sel_hi:[0,1,1]
    s_set_gpr_idx_idx s69
    v_pk_fma_f32 v[8:9], v[160:161], v[152:153], v[8:9] op_sel:[1,0,0] op_sel_hi:[1,1,1]
    v_pk_fma_f32 v[10:11], v[160:161], v[154:155], v[10:11] op_sel:[1,0,0] op_sel_hi:[1,1,1]
    v_pk_fma_f32 v[12:13], v[162:163], v[156:157], v[12:13] op_sel:[1,0,0] op_sel_hi:[1,1,1]
    v_pk_fma_f32 v[14:15], v[162:163], v[158:159], v[14:15] op_sel:[1,0,0] op_sel_hi:[1,1,1]
    s_set_gpr_idx_off
    s_cmp_le_i32 s30, 38
    s_cbranch_scc1 L_exit
    s_waitcnt vmcnt(7)
    v_mfma_f32_4x4x4_16b_bf16 v[144:147], v[168:169], v[72:73], 0 cbsz:4 abid:6
    v_exp_f32 v160, v86
    v_mfma_f32_4x4x4_16b_bf16 v[148:151], v[168:169], v[74:75], 0 cbsz:4 abid:6
    v_exp_f32 v161, v87
    s_waitcnt vmcnt(6)
    v_mfma_f32_4x4x4_16b_bf16 v[152:155], v[168:169], v[76:77], 0 cbsz:4 abid:7
    v_exp_f32 v162, v102
    v_mfma_f32_4x4x4_16b_bf16 v[156:159], v[168:169], v[78:79], 0 cbsz:4 abid:7
    v_exp_f32 v163, v103
    v_readlane_b32 s78, v208, 58
    v_readlane_b32 s79, v208, 62
    v_pk_add_f32 v[160:161], v[160:161], 1.0 op_sel_hi:[1,0]
    v_pk_add_f32 v[162:163], v[162:163], 1.0 op_sel_hi:[1,0]
    s_and_b32 s80, s78, s31
    s_and_b32 s81, s79, s31
    v_mfma_f32_32x32x16_bf16 v[128:143], v[172:175], v[184:187], 0
    v_rcp_f32 v160, v160
    buffer_load_dwordx4 v[72:75], v212, s[4:7], s80 offen
    v_rcp_f32 v161, v161
    buffer_load_dwordx4 v[76:79], v212, s[4:7], s81 offen
    v_rcp_f32 v162, v162
    v_rcp_f32 v163, v163
    v_pk_mul_f32 v[160:161], v[160:161], v[86:87]
    v_pk_mul_f32 v[162:163], v[162:163], v[102:103]
    s_set_gpr_idx_on s70, gpr_idx(SRC2,DST)
    v_pk_fma_f32 v[8:9], v[160:161], v[144:145], v[8:9] op_sel:[0,0,0] op_sel_hi:[0,1,1]
    v_pk_fma_f32 v[10:11], v[160:161], v[146:147], v[10:11] op_sel:[0,0,0] op_sel_hi:[0,1,1]
    v_pk_fma_f32 v[12:13], v[162:163], v[148:149], v[12:13] op_sel:[0,0,0] op_sel_hi:[0,1,1]
    v_pk_fma_f32 v[14:15], v[162:163], v[150:151], v[14:15] op_sel:[0,0,0] op_sel_hi:[0,1,1]
    s_set_gpr_idx_idx s71
    v_pk_fma_f32 v[8:9], v[160:161], v[152:153], v[8:9] op_sel:[1,0,0] op_sel_hi:[1,1,1]
    v_pk_fma_f32 v[10:11], v[160:161], v[154:155], v[10:11] op_sel:[1,0,0] op_sel_hi:[1,1,1]
    v_pk_fma_f32 v[12:13], v[162:163], v[156:157], v[12:13] op_sel:[1,0,0] op_sel_hi:[1,1,1]
    v_pk_fma_f32 v[14:15], v[162:163], v[158:159], v[14:15] op_sel:[1,0,0] op_sel_hi:[1,1,1]
    s_set_gpr_idx_off
    s_cmp_le_i32 s30, 40
    s_cbranch_scc1 L_exit
    s_waitcnt vmcnt(7)
    v_mfma_f32_4x4x4_16b_bf16 v[144:147], v[168:169], v[48:49], 0 cbsz:4 abid:8
    v_exp_f32 v160, v88
    v_mfma_f32_4x4x4_16b_bf16 v[148:151], v[168:169], v[50:51], 0 cbsz:4 abid:8
    v_exp_f32 v161, v89
    s_waitcnt vmcnt(6)
    v_mfma_f32_4x4x4_16b_bf16 v[152:155], v[168:169], v[52:53], 0 cbsz:4 abid:9
    v_exp_f32 v162, v104
    v_mfma_f32_4x4x4_16b_bf16 v[156:159], v[168:169], v[54:55], 0 cbsz:4 abid:9
    v_exp_f32 v163, v105
    v_readlane_b32 s64, v208, 3
    v_readlane_b32 s65, v208, 7
    v_pk_add_f32 v[160:161], v[160:161], 1.0 op_sel_hi:[1,0]
    v_pk_add_f32 v[162:163], v[162:163], 1.0 op_sel_hi:[1,0]
    s_and_b32 s80, s64, s31
    s_and_b32 s81, s65, s31
    v_mfma_f32_32x32x16_bf16 v[112:127], v[176:179], v[188:191], v[112:127]
    v_rcp_f32 v160, v160
    buffer_load_dwordx4 v[48:51], v212, s[4:7], s80 offen
    v_rcp_f32 v161, v161
    buffer_load_dwordx4 v[52:55], v212, s[4:7], s81 offen
    v_rcp_f32 v162, v162
    v_rcp_f32 v163, v163
    v_pk_mul_f32 v[160:161], v[160:161], v[88:89]
    v_pk_mul_f32 v[162:163], v[162:163], v[104:105]
    s_set_gpr_idx_on s72, gpr_idx(SRC2,DST)
    v_pk_fma_f32 v[8:9], v[160:161], v[144:145], v[8:9] op_sel:[0,0,0] op_sel_hi:[0,1,1]
    v_pk_fma_f32 v[10:11], v[160:161], v[146:147], v[10:11] op_sel:[0,0,0] op_sel_hi:[0,1,1]
    v_pk_fma_f32 v[12:13], v[162:163], v[148:149], v[12:13] op_sel:[0,0,0] op_sel_hi:[0,1,1]
    v_pk_fma_f32 v[14:15], v[162:163], v[150:151], v[14:15] op_sel:[0,0,0] op_sel_hi:[0,1,1]
    s_set_gpr_idx_idx s73
    v_pk_fma_f32 v[8:9], v[160:161], v[152:153], v[8:9] op_sel:[1,0,0] op_sel_hi:[1,1,1]
    v_pk_fma_f32 v[10:11], v[160:161], v[154:155], v[10:11] op_sel:[1,0,0] op_sel_hi:[1,1,1]
    v_pk_fma_f32 v[12:13], v[162:163], v[156:157], v[12:13] op_sel:[1,0,0] op_sel_hi:[1,1,1]
    v_pk_fma_f32 v[14:15], v[162:163], v[158:159], v[14:15] op_sel:[1,0,0] op_sel_hi:[1,1,1]
    s_set_gpr_idx_off
    s_cmp_le_i32 s30, 42
    s_cbranch_scc1 L_exit
    s_waitcnt vmcnt(7)
    v_mfma_f32_4x4x4_16b_bf16 v[144:147], v[168:169], v[56:57], 0 cbsz:4 abid:10
    v_exp_f32 v160, v90
    v_mfma_f32_4x4x4_16b_bf16 v[148:151], v[168:169], v[58:59], 0 cbsz:4 abid:10
    v_exp_f32 v161, v91
    s_waitcnt vmcnt(6)
    v_mfma_f32_4x4x4_16b_bf16 v[152:155], v[168:169], v[60:61], 0 cbsz:4 abid:11
    v_exp_f32 v162, v106
    v_mfma_f32_4x4x4_16b_bf16 v[156:159], v[168:169], v[62:63], 0 cbsz:4 abid:11
    v_exp_f32 v163, v107
    v_readlane_b32 s66, v208, 11
    v_readlane_b32 s67, v208, 15
    v_pk_add_f32 v[160:161], v[160:161], 1.0 op_sel_hi:[1,0]
    v_pk_add_f32 v[162:163], v[162:163], 1.0 op_sel_hi:[1,0]
    s_and_b32 s80, s66, s31
    s_and_b32 s81, s67, s31
    v_mfma_f32_32x32x16_bf16 v[128:143], v[176:179], v[192:195], v[128:143]
    v_rcp_f32 v160, v160
    buffer_load_dwordx4 v[56:59], v212, s[4:7], s80 offen
    v_rcp_f32 v161, v161
    buffer_load_dwordx4 v[60:63], v212, s[4:7], s81 offen
    v_rcp_f32 v162, v162
    v_rcp_f32 v163, v163
    v_pk_mul_f32 v[160:161], v[160:161], v[90:91]
    v_pk_mul_f32 v[162:163], v[162:163], v[106:107]
    s_set_gpr_idx_on s74, gpr_idx(SRC2,DST)
    v_pk_fma_f32 v[8:9], v[160:161], v[144:145], v[8:9] op_sel:[0,0,0] op_sel_hi:[0,1,1]
    v_pk_fma_f32 v[10:11], v[160:161], v[146:147], v[10:11] op_sel:[0,0,0] op_sel_hi:[0,1,1]
    v_pk_fma_f32 v[12:13], v[162:163], v[148:149], v[12:13] op_sel:[0,0,0] op_sel_hi:[0,1,1]
    v_pk_fma_f32 v[14:15], v[162:163], v[150:151], v[14:15] op_sel:[0,0,0] op_sel_hi:[0,1,1]
    s_set_gpr_idx_idx s75
    v_pk_fma_f32 v[8:9], v[160:161], v[152:153], v[8:9] op_sel:[1,0,0] op_sel_hi:[1,1,1]
    v_pk_fma_f32 v[10:11], v[160:161], v[154:155], v[10:11] op_sel:[1,0,0] op_sel_hi:[1,1,1]
    v_pk_fma_f32 v[12:13], v[162:163], v[156:157], v[12:13] op_sel:[1,0,0] op_sel_hi:[1,1,1]
    v_pk_fma_f32 v[14:15], v[162:163], v[158:159], v[14:15] op_sel:[1,0,0] op_sel_hi:[1,1,1]
    s_set_gpr_idx_off
    s_cmp_le_i32 s30, 44
    s_cbranch_scc1 L_exit
    ds_read_b32 v209, v211 offset:1036
    s_waitcnt vmcnt(7)
    v_mfma_f32_4x4x4_16b_bf16 v[144:147], v[168:169], v[64:65], 0 cbsz:4 abid:12
    v_exp_f32 v160, v92
    v_mfma_f32_4x4x4_16b_bf16 v[148:151], v[168:169], v[66:67], 0 cbsz:4 abid:12
    v_exp_f32 v161, v93
    s_waitcnt vmcnt(6)
    v_mfma_f32_4x4x4_16b_bf16 v[152:155], v[168:169], v[68:69], 0 cbsz:4 abid:13
    v_exp_f32 v162, v108
    v_mfma_f32_4x4x4_16b_bf16 v[156:159], v[168:169], v[70:71], 0 cbsz:4 abid:13
    v_exp_f32 v163, v109
    v_readlane_b32 s68, v208, 19
    v_readlane_b32 s69, v208, 23
    v_pk_add_f32 v[160:161], v[160:161], 1.0 op_sel_hi:[1,0]
    v_pk_add_f32 v[162:163], v[162:163], 1.0 op_sel_hi:[1,0]
    s_and_b32 s80, s68, s31
    s_and_b32 s81, s69, s31
    v_rcp_f32 v160, v160
    buffer_load_dwordx4 v[64:67], v212, s[4:7], s80 offen
    v_rcp_f32 v161, v161
    buffer_load_dwordx4 v[68:71], v212, s[4:7], s81 offen
    v_rcp_f32 v162, v162
    v_rcp_f32 v163, v163
    v_pk_mul_f32 v[160:161], v[160:161], v[92:93]
    v_pk_mul_f32 v[162:163], v[162:163], v[108:109]
    s_set_gpr_idx_on s76, gpr_idx(SRC2,DST)
    v_pk_fma_f32 v[8:9], v[160:161], v[144:145], v[8:9] op_sel:[0,0,0] op_sel_hi:[0,1,1]
    v_pk_fma_f32 v[10:11], v[160:161], v[146:147], v[10:11] op_sel:[0,0,0] op_sel_hi:[0,1,1]
    v_pk_fma_f32 v[12:13], v[162:163], v[148:149], v[12:13] op_sel:[0,0,0] op_sel_hi:[0,1,1]
    v_pk_fma_f32 v[14:15], v[162:163], v[150:151], v[14:15] op_sel:[0,0,0] op_sel_hi:[0,1,1]
    s_set_gpr_idx_idx s77
    v_pk_fma_f32 v[8:9], v[160:161], v[152:153], v[8:9] op_sel:[1,0,0] op_sel_hi:[1,1,1]
    v_pk_fma_f32 v[10:11], v[160:161], v[154:155], v[10:11] op_sel:[1,0,0] op_sel_hi:[1,1,1]
    v_pk_fma_f32 v[12:13], v[162:163], v[156:157], v[12:13] op_sel:[1,0,0] op_sel_hi:[1,1,1]
    v_pk_fma_f32 v[14:15], v[162:163], v[158:159], v[14:15] op_sel:[1,0,0] op_sel_hi:[1,1,1]
    s_set_gpr_idx_off
    s_cmp_le_i32 s30, 46
    s_cbranch_scc1 L_exit
    s_waitcnt lgkmcnt(0)
    v_and_or_b32 v209, v209, s33, v213
    s_waitcnt vmcnt(7)
    v_mfma_f32_4x4x4_16b_bf16 v[144:147], v[168:169], v[72:73], 0 cbsz:4 abid:14
    v_exp_f32 v160, v94
    v_mfma_f32_4x4x4_16b_bf16 v[148:151], v[168:169], v[74:75], 0 cbsz:4 abid:14
    v_exp_f32 v161, v95
    s_waitcnt vmcnt(6)
    v_mfma_f32_4x4x4_16b_bf16 v[152:155], v[168:169], v[76:77], 0 cbsz:4 abid:15
    v_exp_f32 v162, v110
    v_mfma_f32_4x4x4_16b_bf16 v[156:159], v[168:169], v[78:79], 0 cbsz:4 abid:15
    v_exp_f32 v163, v111
    v_readlane_b32 s70, v208, 27
    v_readlane_b32 s71, v208, 31
    v_pk_add_f32 v[160:161], v[160:161], 1.0 op_sel_hi:[1,0]
    v_pk_add_f32 v[162:163], v[162:163], 1.0 op_sel_hi:[1,0]
    s_and_b32 s80, s70, s31
    s_and_b32 s81, s71, s31
    v_rcp_f32 v160, v160
    buffer_load_dwordx4 v[72:75], v212, s[4:7], s80 offen
    v_rcp_f32 v161, v161
    buffer_load_dwordx4 v[76:79], v212, s[4:7], s81 offen
    v_rcp_f32 v162, v162
    v_rcp_f32 v163, v163
    v_pk_mul_f32 v[160:161], v[160:161], v[94:95]
    v_pk_mul_f32 v[162:163], v[162:163], v[110:111]
    s_set_gpr_idx_on s78, gpr_idx(SRC2,DST)
    v_pk_fma_f32 v[8:9], v[160:161], v[144:145], v[8:9] op_sel:[0,0,0] op_sel_hi:[0,1,1]
    v_pk_fma_f32 v[10:11], v[160:161], v[146:147], v[10:11] op_sel:[0,0,0] op_sel_hi:[0,1,1]
    v_pk_fma_f32 v[12:13], v[162:163], v[148:149], v[12:13] op_sel:[0,0,0] op_sel_hi:[0,1,1]
    v_pk_fma_f32 v[14:15], v[162:163], v[150:151], v[14:15] op_sel:[0,0,0] op_sel_hi:[0,1,1]
    s_set_gpr_idx_idx s79
    v_pk_fma_f32 v[8:9], v[160:161], v[152:153], v[8:9] op_sel:[1,0,0] op_sel_hi:[1,1,1]
    v_pk_fma_f32 v[10:11], v[160:161], v[154:155], v[10:11] op_sel:[1,0,0] op_sel_hi:[1,1,1]
    v_pk_fma_f32 v[12:13], v[162:163], v[156:157], v[12:13] op_sel:[1,0,0] op_sel_hi:[1,1,1]
    v_pk_fma_f32 v[14:15], v[162:163], v[158:159], v[14:15] op_sel:[1,0,0] op_sel_hi:[1,1,1]
    s_set_gpr_idx_off
    s_cmp_le_i32 s30, 48
    s_cbranch_scc1 L_exit
    s_mov_b64 exec, s[20:21]
    ds_read_b128 v[172:175], v209
    s_mov_b64 exec, -1
    s_mov_b64 exec, s[22:23]
    ds_read_b128 v[176:179], v209
    s_mov_b64 exec, -1
    s_waitcnt vmcnt(7)
    v_mfma_f32_4x4x4_16b_bf16 v[144:147], v[170:171], v[48:49], 0 cbsz:4 abid:0
    v_exp_f32 v160, v112
    v_mfma_f32_4x4x4_16b_bf16 v[148:151], v[170:171], v[50:51], 0 cbsz:4 abid:0
    v_exp_f32 v161, v113
    s_waitcnt vmcnt(6)
    v_mfma_f32_4x4x4_16b_bf16 v[152:155], v[170:171], v[52:53], 0 cbsz:4 abid:1
    v_exp_f32 v162, v128
    v_mfma_f32_4x4x4_16b_bf16 v[156:159], v[170:171], v[54:55], 0 cbsz:4 abid:1
    v_exp_f32 v163, v129
    v_readlane_b32 s72, v208, 35
    v_readlane_b32 s73, v208, 39
    v_pk_add_f32 v[160:161], v[160:161], 1.0 op_sel_hi:[1,0]
    v_pk_add_f32 v[162:163], v[162:163], 1.0 op_sel_hi:[1,0]
    s_and_b32 s80, s72, s31
    s_and_b32 s81, s73, s31
    v_rcp_f32 v160, v160
    buffer_load_dwordx4 v[48:51], v212, s[4:7], s80 offen
    v_rcp_f32 v161, v161
    buffer_load_dwordx4 v[52:55], v212, s[4:7], s81 offen
    v_rcp_f32 v162, v162
    v_rcp_f32 v163, v163
    v_pk_mul_f32 v[160:161], v[160:161], v[112:113]
    v_pk_mul_f32 v[162:163], v[162:163], v[128:129]
    s_set_gpr_idx_on s64, gpr_idx(SRC2,DST)
    v_pk_fma_f32 v[8:9], v[160:161], v[144:145], v[8:9] op_sel:[0,0,0] op_sel_hi:[0,1,1]
    v_pk_fma_f32 v[10:11], v[160:161], v[146:147], v[10:11] op_sel:[0,0,0] op_sel_hi:[0,1,1]
    v_pk_fma_f32 v[12:13], v[162:163], v[148:149], v[12:13] op_sel:[0,0,0] op_sel_hi:[0,1,1]
    v_pk_fma_f32 v[14:15], v[162:163], v[150:151], v[14:15] op_sel:[0,0,0] op_sel_hi:[0,1,1]
    s_set_gpr_idx_idx s65
    v_pk_fma_f32 v[8:9], v[160:161], v[152:153], v[8:9] op_sel:[1,0,0] op_sel_hi:[1,1,1]
    v_pk_fma_f32 v[10:11], v[160:161], v[154:155], v[10:11] op_sel:[1,0,0] op_sel_hi:[1,1,1]
    v_pk_fma_f32 v[12:13], v[162:163], v[156:157], v[12:13] op_sel:[1,0,0] op_sel_hi:[1,1,1]
    v_pk_fma_f32 v[14:15], v[162:163], v[158:159], v[14:15] op_sel:[1,0,0] op_sel_hi:[1,1,1]
    s_set_gpr_idx_off
    s_cmp_le_i32 s30, 50
    s_cbranch_scc1 L_exit
    s_waitcnt vmcnt(7)
    v_mfma_f32_4x4x4_16b_bf16 v[144:147], v[170:171], v[56:57], 0 cbsz:4 abid:2
    v_exp_f32 v160, v114
    v_mfma_f32_4x4x4_16b_bf16 v[148:151], v[170:171], v[58:59], 0 cbsz:4 abid:2
    v_exp_f32 v161, v115
    s_waitcnt vmcnt(6)
    v_mfma_f32_4x4x4_16b_bf16 v[152:155], v[170:171], v[60:61], 0 cbsz:4 abid:3
    v_exp_f32 v162, v130
    v_mfma_f32_4x4x4_16b_bf16 v[156:159], v[170:171], v[62:63], 0 cbsz:4 abid:3
    v_exp_f32 v163, v131
    v_readlane_b32 s74, v208, 43
    v_readlane_b32 s75, v208, 47
    v_pk_add_f32 v[160:161], v[160:161], 1.0 op_sel_hi:[1,0]
    v_pk_add_f32 v[162:163], v[162:163], 1.0 op_sel_hi:[1,0]
    s_and_b32 s80, s74, s31
    s_and_b32 s81, s75, s31
    v_rcp_f32 v160, v160
    buffer_load_dwordx4 v[56:59], v212, s[4:7], s80 offen
    v_rcp_f32 v161, v161
    buffer_load_dwordx4 v[60:63], v212, s[4:7], s81 offen
    v_rcp_f32 v162, v162
    v_rcp_f32 v163, v163
    v_pk_mul_f32 v[160:161], v[160:161], v[114:115]
    v_pk_mul_f32 v[162:163], v[162:163], v[130:131]
    s_set_gpr_idx_on s66, gpr_idx(SRC2,DST)
    v_pk_fma_f32 v[8:9], v[160:161], v[144:145], v[8:9] op_sel:[0,0,0] op_sel_hi:[0,1,1]
    v_pk_fma_f32 v[10:11], v[160:161], v[146:147], v[10:11] op_sel:[0,0,0] op_sel_hi:[0,1,1]
    v_pk_fma_f32 v[12:13], v[162:163], v[148:149], v[12:13] op_sel:[0,0,0] op_sel_hi:[0,1,1]
    v_pk_fma_f32 v[14:15], v[162:163], v[150:151], v[14:15] op_sel:[0,0,0] op_sel_hi:[0,1,1]
    s_set_gpr_idx_idx s67
    v_pk_fma_f32 v[8:9], v[160:161], v[152:153], v[8:9] op_sel:[1,0,0] op_sel_hi:[1,1,1]
    v_pk_fma_f32 v[10:11], v[160:161], v[154:155], v[10:11] op_sel:[1,0,0] op_sel_hi:[1,1,1]
    v_pk_fma_f32 v[12:13], v[162:163], v[156:157], v[12:13] op_sel:[1,0,0] op_sel_hi:[1,1,1]
    v_pk_fma_f32 v[14:15], v[162:163], v[158:159], v[14:15] op_sel:[1,0,0] op_sel_hi:[1,1,1]
    s_set_gpr_idx_off
    s_cmp_le_i32 s30, 52
    s_cbranch_scc1 L_exit
    s_waitcnt vmcnt(7)
    v_mfma_f32_4x4x4_16b_bf16 v[144:147], v[170:171], v[64:65], 0 cbsz:4 abid:4
    v_exp_f32 v160, v116
    v_mfma_f32_4x4x4_16b_bf16 v[148:151], v[170:171], v[66:67], 0 cbsz:4 abid:4
    v_exp_f32 v161, v117
    s_waitcnt vmcnt(6)
    v_mfma_f32_4x4x4_16b_bf16 v[152:155], v[170:171], v[68:69], 0 cbsz:4 abid:5
    v_exp_f32 v162, v132
    v_mfma_f32_4x4x4_16b_bf16 v[156:159], v[170:171], v[70:71], 0 cbsz:4 abid:5
    v_exp_f32 v163, v133
    v_readlane_b32 s76, v208, 51
    v_readlane_b32 s77, v208, 55
    v_pk_add_f32 v[160:161], v[160:161], 1.0 op_sel_hi:[1,0]
    v_pk_add_f32 v[162:163], v[162:163], 1.0 op_sel_hi:[1,0]
    s_and_b32 s80, s76, s31
    s_and_b32 s81, s77, s31
    s_waitcnt lgkmcnt(0)
    v_mfma_f32_32x32x16_bf16 v[80:95], v[172:175], v[180:183], 0
    v_rcp_f32 v160, v160
    buffer_load_dwordx4 v[64:67], v212, s[4:7], s80 offen
    v_rcp_f32 v161, v161
    buffer_load_dwordx4 v[68:71], v212, s[4:7], s81 offen
    v_rcp_f32 v162, v162
    v_rcp_f32 v163, v163
    v_pk_mul_f32 v[160:161], v[160:161], v[116:117]
    v_pk_mul_f32 v[162:163], v[162:163], v[132:133]
    s_set_gpr_idx_on s68, gpr_idx(SRC2,DST)
    v_pk_fma_f32 v[8:9], v[160:161], v[144:145], v[8:9] op_sel:[0,0,0] op_sel_hi:[0,1,1]
    v_pk_fma_f32 v[10:11], v[160:161], v[146:147], v[10:11] op_sel:[0,0,0] op_sel_hi:[0,1,1]
    v_pk_fma_f32 v[12:13], v[162:163], v[148:149], v[12:13] op_sel:[0,0,0] op_sel_hi:[0,1,1]
    v_pk_fma_f32 v[14:15], v[162:163], v[150:151], v[14:15] op_sel:[0,0,0] op_sel_hi:[0,1,1]
    s_set_gpr_idx_idx s69
    v_pk_fma_f32 v[8:9], v[160:161], v[152:153], v[8:9] op_sel:[1,0,0] op_sel_hi:[1,1,1]
    v_pk_fma_f32 v[10:11], v[160:161], v[154:155], v[10:11] op_sel:[1,0,0] op_sel_hi:[1,1,1]
    v_pk_fma_f32 v[12:13], v[162:163], v[156:157], v[12:13] op_sel:[1,0,0] op_sel_hi:[1,1,1]
    v_pk_fma_f32 v[14:15], v[162:163], v[158:159], v[14:15] op_sel:[1,0,0] op_sel_hi:[1,1,1]
    s_set_gpr_idx_off
    s_cmp_le_i32 s30, 54
    s_cbranch_scc1 L_exit
    s_waitcnt vmcnt(7)
    v_mfma_f32_4x4x4_16b_bf16 v[144:147], v[170:171], v[72:73], 0 cbsz:4 abid:6
    v_exp_f32 v160, v118
    v_mfma_f32_4x4x4_16b_bf16 v[148:151], v[170:171], v[74:75], 0 cbsz:4 abid:6
    v_exp_f32 v161, v119
    s_waitcnt vmcnt(6)
    v_mfma_f32_4x4x4_16b_bf16 v[152:155], v[170:171], v[76:77], 0 cbsz:4 abid:7
    v_exp_f32 v162, v134
    v_mfma_f32_4x4x4_16b_bf16 v[156:159], v[170:171], v[78:79], 0 cbsz:4 abid:7
    v_exp_f32 v163, v135
    v_readlane_b32 s78, v208, 59
    v_readlane_b32 s79, v208, 63
    v_pk_add_f32 v[160:161], v[160:161], 1.0 op_sel_hi:[1,0]
    v_pk_add_f32 v[162:163], v[162:163], 1.0 op_sel_hi:[1,0]
    s_and_b32 s80, s78, s31
    s_and_b32 s81, s79, s31
    v_mfma_f32_32x32x16_bf16 v[96:111], v[172:175], v[184:187], 0
    v_rcp_f32 v160, v160
    buffer_load_dwordx4 v[72:75], v212, s[4:7], s80 offen
    v_rcp_f32 v161, v161
    buffer_load_dwordx4 v[76:79], v212, s[4:7], s81 offen
    v_rcp_f32 v162, v162
    v_rcp_f32 v163, v163
    v_pk_mul_f32 v[160:161], v[160:161], v[118:119]
    v_pk_mul_f32 v[162:163], v[162:163], v[134:135]
    s_set_gpr_idx_on s70, gpr_idx(SRC2,DST)
    v_pk_fma_f32 v[8:9], v[160:161], v[144:145], v[8:9] op_sel:[0,0,0] op_sel_hi:[0,1,1]
    v_pk_fma_f32 v[10:11], v[160:161], v[146:147], v[10:11] op_sel:[0,0,0] op_sel_hi:[0,1,1]
    v_pk_fma_f32 v[12:13], v[162:163], v[148:149], v[12:13] op_sel:[0,0,0] op_sel_hi:[0,1,1]
    v_pk_fma_f32 v[14:15], v[162:163], v[150:151], v[14:15] op_sel:[0,0,0] op_sel_hi:[0,1,1]
    s_set_gpr_idx_idx s71
    v_pk_fma_f32 v[8:9], v[160:161], v[152:153], v[8:9] op_sel:[1,0,0] op_sel_hi:[1,1,1]
    v_pk_fma_f32 v[10:11], v[160:161], v[154:155], v[10:11] op_sel:[1,0,0] op_sel_hi:[1,1,1]
    v_pk_fma_f32 v[12:13], v[162:163], v[156:157], v[12:13] op_sel:[1,0,0] op_sel_hi:[1,1,1]
    v_pk_fma_f32 v[14:15], v[162:163], v[158:159], v[14:15] op_sel:[1,0,0] op_sel_hi:[1,1,1]
    s_set_gpr_idx_off
    s_cmp_le_i32 s30, 56
    s_cbranch_scc1 L_exit
    s_waitcnt lgkmcnt(0)
    v_cndmask_b32 v208, v4, v206, s[34:35]
    s_waitcnt vmcnt(7)
    v_mfma_f32_4x4x4_16b_bf16 v[144:147], v[170:171], v[48:49], 0 cbsz:4 abid:8
    v_exp_f32 v160, v120
    v_mfma_f32_4x4x4_16b_bf16 v[148:151], v[170:171], v[50:51], 0 cbsz:4 abid:8
    v_exp_f32 v161, v121
    s_waitcnt vmcnt(6)
    v_mfma_f32_4x4x4_16b_bf16 v[152:155], v[170:171], v[52:53], 0 cbsz:4 abid:9
    v_exp_f32 v162, v136
    v_mfma_f32_4x4x4_16b_bf16 v[156:159], v[170:171], v[54:55], 0 cbsz:4 abid:9
    v_exp_f32 v163, v137
    v_readlane_b32 s64, v208, 0
    v_readlane_b32 s65, v208, 4
    v_pk_add_f32 v[160:161], v[160:161], 1.0 op_sel_hi:[1,0]
    v_pk_add_f32 v[162:163], v[162:163], 1.0 op_sel_hi:[1,0]
    s_and_b32 s80, s64, s31
    s_and_b32 s81, s65, s31
    v_mfma_f32_32x32x16_bf16 v[80:95], v[176:179], v[188:191], v[80:95]
    v_rcp_f32 v160, v160
    buffer_load_dwordx4 v[48:51], v212, s[4:7], s80 offen
    v_rcp_f32 v161, v161
    buffer_load_dwordx4 v[52:55], v212, s[4:7], s81 offen
    v_rcp_f32 v162, v162
    v_rcp_f32 v163, v163
    v_pk_mul_f32 v[160:161], v[160:161], v[120:121]
    v_pk_mul_f32 v[162:163], v[162:163], v[136:137]
    s_set_gpr_idx_on s72, gpr_idx(SRC2,DST)
    v_pk_fma_f32 v[8:9], v[160:161], v[144:145], v[8:9] op_sel:[0,0,0] op_sel_hi:[0,1,1]
    v_pk_fma_f32 v[10:11], v[160:161], v[146:147], v[10:11] op_sel:[0,0,0] op_sel_hi:[0,1,1]
    v_pk_fma_f32 v[12:13], v[162:163], v[148:149], v[12:13] op_sel:[0,0,0] op_sel_hi:[0,1,1]
    v_pk_fma_f32 v[14:15], v[162:163], v[150:151], v[14:15] op_sel:[0,0,0] op_sel_hi:[0,1,1]
    s_set_gpr_idx_idx s73
    v_pk_fma_f32 v[8:9], v[160:161], v[152:153], v[8:9] op_sel:[1,0,0] op_sel_hi:[1,1,1]
    v_pk_fma_f32 v[10:11], v[160:161], v[154:155], v[10:11] op_sel:[1,0,0] op_sel_hi:[1,1,1]
    v_pk_fma_f32 v[12:13], v[162:163], v[156:157], v[12:13] op_sel:[1,0,0] op_sel_hi:[1,1,1]
    v_pk_fma_f32 v[14:15], v[162:163], v[158:159], v[14:15] op_sel:[1,0,0] op_sel_hi:[1,1,1]
    s_set_gpr_idx_off
    s_cmp_le_i32 s30, 58
    s_cbranch_scc1 L_exit
    s_waitcnt vmcnt(7)
    v_mfma_f32_4x4x4_16b_bf16 v[144:147], v[170:171], v[56:57], 0 cbsz:4 abid:10
    v_exp_f32 v160, v122
    v_mfma_f32_4x4x4_16b_bf16 v[148:151], v[170:171], v[58:59], 0 cbsz:4 abid:10
    v_exp_f32 v161, v123
    s_waitcnt vmcnt(6)
    v_mfma_f32_4x4x4_16b_bf16 v[152:155], v[170:171], v[60:61], 0 cbsz:4 abid:11
    v_exp_f32 v162, v138
    v_mfma_f32_4x4x4_16b_bf16 v[156:159], v[170:171], v[62:63], 0 cbsz:4 abid:11
    v_exp_f32 v163, v139
    v_readlane_b32 s66, v208, 8
    v_readlane_b32 s67, v208, 12
    v_pk_add_f32 v[160:161], v[160:161], 1.0 op_sel_hi:[1,0]
    v_pk_add_f32 v[162:163], v[162:163], 1.0 op_sel_hi:[1,0]
    s_and_b32 s80, s66, s31
    s_and_b32 s81, s67, s31
    v_mfma_f32_32x32x16_bf16 v[96:111], v[176:179], v[192:195], v[96:111]
    v_rcp_f32 v160, v160
    buffer_load_dwordx4 v[56:59], v212, s[4:7], s80 offen
    v_rcp_f32 v161, v161
    buffer_load_dwordx4 v[60:63], v212, s[4:7], s81 offen
    v_rcp_f32 v162, v162
    v_rcp_f32 v163, v163
    v_pk_mul_f32 v[160:161], v[160:161], v[122:123]
    v_pk_mul_f32 v[162:163], v[162:163], v[138:139]
    s_set_gpr_idx_on s74, gpr_idx(SRC2,DST)
    v_pk_fma_f32 v[8:9], v[160:161], v[144:145], v[8:9] op_sel:[0,0,0] op_sel_hi:[0,1,1]
    v_pk_fma_f32 v[10:11], v[160:161], v[146:147], v[10:11] op_sel:[0,0,0] op_sel_hi:[0,1,1]
    v_pk_fma_f32 v[12:13], v[162:163], v[148:149], v[12:13] op_sel:[0,0,0] op_sel_hi:[0,1,1]
    v_pk_fma_f32 v[14:15], v[162:163], v[150:151], v[14:15] op_sel:[0,0,0] op_sel_hi:[0,1,1]
    s_set_gpr_idx_idx s75
    v_pk_fma_f32 v[8:9], v[160:161], v[152:153], v[8:9] op_sel:[1,0,0] op_sel_hi:[1,1,1]
    v_pk_fma_f32 v[10:11], v[160:161], v[154:155], v[10:11] op_sel:[1,0,0] op_sel_hi:[1,1,1]
    v_pk_fma_f32 v[12:13], v[162:163], v[156:157], v[12:13] op_sel:[1,0,0] op_sel_hi:[1,1,1]
    v_pk_fma_f32 v[14:15], v[162:163], v[158:159], v[14:15] op_sel:[1,0,0] op_sel_hi:[1,1,1]
    s_set_gpr_idx_off
    s_cmp_le_i32 s30, 60
    s_cbranch_scc1 L_exit
    ds_read_b32 v209, v211 offset:1292
    s_waitcnt vmcnt(7)
    v_mfma_f32_4x4x4_16b_bf16 v[144:147], v[170:171], v[64:65], 0 cbsz:4 abid:12
    v_exp_f32 v160, v124
    v_mfma_f32_4x4x4_16b_bf16 v[148:151], v[170:171], v[66:67], 0 cbsz:4 abid:12
    v_exp_f32 v161, v125
    s_waitcnt vmcnt(6)
    v_mfma_f32_4x4x4_16b_bf16 v[152:155], v[170:171], v[68:69], 0 cbsz:4 abid:13
    v_exp_f32 v162, v140
    v_mfma_f32_4x4x4_16b_bf16 v[156:159], v[170:171], v[70:71], 0 cbsz:4 abid:13
    v_exp_f32 v163, v141
    v_readlane_b32 s68, v208, 16
    v_readlane_b32 s69, v208, 20
    v_pk_add_f32 v[160:161], v[160:161], 1.0 op_sel_hi:[1,0]
    v_pk_add_f32 v[162:163], v[162:163], 1.0 op_sel_hi:[1,0]
    s_and_b32 s80, s68, s31
    s_and_b32 s81, s69, s31
    v_rcp_f32 v160, v160
    buffer_load_dwordx4 v[64:67], v212, s[4:7], s80 offen
    v_rcp_f32 v161, v161
    buffer_load_dwordx4 v[68:71], v212, s[4:7], s81 offen
    v_rcp_f32 v162, v162
    v_rcp_f32 v163, v163
    v_pk_mul_f32 v[160:161], v[160:161], v[124:125]
    v_pk_mul_f32 v[162:163], v[162:163], v[140:141]
    s_set_gpr_idx_on s76, gpr_idx(SRC2,DST)
    v_pk_fma_f32 v[8:9], v[160:161], v[144:145], v[8:9] op_sel:[0,0,0] op_sel_hi:[0,1,1]
    v_pk_fma_f32 v[10:11], v[160:161], v[146:147], v[10:11] op_sel:[0,0,0] op_sel_hi:[0,1,1]
    v_pk_fma_f32 v[12:13], v[162:163], v[148:149], v[12:13] op_sel:[0,0,0] op_sel_hi:[0,1,1]
    v_pk_fma_f32 v[14:15], v[162:163], v[150:151], v[14:15] op_sel:[0,0,0] op_sel_hi:[0,1,1]
    s_set_gpr_idx_idx s77
    v_pk_fma_f32 v[8:9], v[160:161], v[152:153], v[8:9] op_sel:[1,0,0] op_sel_hi:[1,1,1]
    v_pk_fma_f32 v[10:11], v[160:161], v[154:155], v[10:11] op_sel:[1,0,0] op_sel_hi:[1,1,1]
    v_pk_fma_f32 v[12:13], v[162:163], v[156:157], v[12:13] op_sel:[1,0,0] op_sel_hi:[1,1,1]
    v_pk_fma_f32 v[14:15], v[162:163], v[158:159], v[14:15] op_sel:[1,0,0] op_sel_hi:[1,1,1]
    s_set_gpr_idx_off
    s_cmp_le_i32 s30, 62
    s_cbranch_scc1 L_exit
    s_waitcnt lgkmcnt(0)
    v_and_or_b32 v209, v209, s33, v213
    s_waitcnt vmcnt(7)
    v_mfma_f32_4x4x4_16b_bf16 v[144:147], v[170:171], v[72:73], 0 cbsz:4 abid:14
    v_exp_f32 v160, v126
    v_mfma_f32_4x4x4_16b_bf16 v[148:151], v[170:171], v[74:75], 0 cbsz:4 abid:14
    v_exp_f32 v161, v127
    s_waitcnt vmcnt(6)
    v_mfma_f32_4x4x4_16b_bf16 v[152:155], v[170:171], v[76:77], 0 cbsz:4 abid:15
    v_exp_f32 v162, v142
    v_mfma_f32_4x4x4_16b_bf16 v[156:159], v[170:171], v[78:79], 0 cbsz:4 abid:15
    v_exp_f32 v163, v143
    v_readlane_b32 s70, v208, 24
    v_readlane_b32 s71, v208, 28
    v_pk_add_f32 v[160:161], v[160:161], 1.0 op_sel_hi:[1,0]
    v_pk_add_f32 v[162:163], v[162:163], 1.0 op_sel_hi:[1,0]
    s_and_b32 s80, s70, s31
    s_and_b32 s81, s71, s31
    v_rcp_f32 v160, v160
    buffer_load_dwordx4 v[72:75], v212, s[4:7], s80 offen
    v_rcp_f32 v161, v161
    buffer_load_dwordx4 v[76:79], v212, s[4:7], s81 offen
    v_rcp_f32 v162, v162
    v_rcp_f32 v163, v163
    v_pk_mul_f32 v[160:161], v[160:161], v[126:127]
    v_pk_mul_f32 v[162:163], v[162:163], v[142:143]
    s_set_gpr_idx_on s78, gpr_idx(SRC2,DST)
    v_pk_fma_f32 v[8:9], v[160:161], v[144:145], v[8:9] op_sel:[0,0,0] op_sel_hi:[0,1,1]
    v_pk_fma_f32 v[10:11], v[160:161], v[146:147], v[10:11] op_sel:[0,0,0] op_sel_hi:[0,1,1]
    v_pk_fma_f32 v[12:13], v[162:163], v[148:149], v[12:13] op_sel:[0,0,0] op_sel_hi:[0,1,1]
    v_pk_fma_f32 v[14:15], v[162:163], v[150:151], v[14:15] op_sel:[0,0,0] op_sel_hi:[0,1,1]
    s_set_gpr_idx_idx s79
    v_pk_fma_f32 v[8:9], v[160:161], v[152:153], v[8:9] op_sel:[1,0,0] op_sel_hi:[1,1,1]
    v_pk_fma_f32 v[10:11], v[160:161], v[154:155], v[10:11] op_sel:[1,0,0] op_sel_hi:[1,1,1]
    v_pk_fma_f32 v[12:13], v[162:163], v[156:157], v[12:13] op_sel:[1,0,0] op_sel_hi:[1,1,1]
    v_pk_fma_f32 v[14:15], v[162:163], v[158:159], v[14:15] op_sel:[1,0,0] op_sel_hi:[1,1,1]
    s_set_gpr_idx_off
    v_add_u32 v211, 1024, v211
    s_sub_u32 s30, s30, 64
    s_branch L_sb
L_exit:
    s_add_u32 s24, s24, 256
    s_lshl_b32 s26, s25, 8
    s_cmp_lt_u32 s24, s26
    s_cbranch_scc0 L_epi
    s_waitcnt vmcnt(0) lgkmcnt(0)
    s_nop 15
    s_barrier
    s_branch L_round
L_epi:
    s_mov_b32 s34, 0xbf317218
    s_mov_b32 s35, 0xbf317218
    s_mul_i32 s26, s16, 1088
    v_lshl_add_u32 v2, v1, 2, s26
    v_pk_mul_f32 v[8:9], v[8:9], s[34:35]
    v_pk_mul_f32 v[10:11], v[10:11], s[34:35]
    v_pk_mul_f32 v[12:13], v[12:13], s[34:35]
    v_pk_mul_f32 v[14:15], v[14:15], s[34:35]
    v_pk_mul_f32 v[16:17], v[16:17], s[34:35]
    v_pk_mul_f32 v[18:19], v[18:19], s[34:35]
    v_pk_mul_f32 v[20:21], v[20:21], s[34:35]
    v_pk_mul_f32 v[22:23], v[22:23], s[34:35]
    v_pk_mul_f32 v[24:25], v[24:25], s[34:35]
    v_pk_mul_f32 v[26:27], v[26:27], s[34:35]
    v_pk_mul_f32 v[28:29], v[28:29], s[34:35]
    v_pk_mul_f32 v[30:31], v[30:31], s[34:35]
    v_pk_mul_f32 v[32:33], v[32:33], s[34:35]
    v_pk_mul_f32 v[34:35], v[34:35], s[34:35]
    v_pk_mul_f32 v[36:37], v[36:37], s[34:35]
    v_pk_mul_f32 v[38:39], v[38:39], s[34:35]
    v_pk_mul_f32 v[40:41], v[40:41], s[34:35]
    v_pk_mul_f32 v[42:43], v[42:43], s[34:35]
    v_pk_mul_f32 v[44:45], v[44:45], s[34:35]
    v_pk_mul_f32 v[46:47], v[46:47], s[34:35]
    v_cvt_pk_bf16_f32 v8, v8, v12
    v_cvt_pk_bf16_f32 v9, v9, v13
    v_cvt_pk_bf16_f32 v10, v10, v14
    v_cvt_pk_bf16_f32 v11, v11, v15
    v_cvt_pk_bf16_f32 v16, v16, v20
    v_cvt_pk_bf16_f32 v17, v17, v21
    v_cvt_pk_bf16_f32 v18, v18, v22
    v_cvt_pk_bf16_f32 v19, v19, v23
    v_cvt_pk_bf16_f32 v24, v24, v28
    v_cvt_pk_bf16_f32 v25, v25, v29
    v_cvt_pk_bf16_f32 v26, v26, v30
    v_cvt_pk_bf16_f32 v27, v27, v31
    v_cvt_pk_bf16_f32 v32, v32, v36
    v_cvt_pk_bf16_f32 v33, v33, v37
    v_cvt_pk_bf16_f32 v34, v34, v38
    v_cvt_pk_bf16_f32 v35, v35, v39
    v_cvt_pk_bf16_f32 v40, v40, v44
    v_cvt_pk_bf16_f32 v41, v41, v45
    v_cvt_pk_bf16_f32 v42, v42, v46
    v_cvt_pk_bf16_f32 v43, v43, v47
    s_and_b32 s26, s16, 3
    s_lshl_b32 s27, s26, 13
    s_add_u32 s27, s27, 100352
    v_add_u32 v3, s27, v212
    s_waitcnt lgkmcnt(0)
    ds_read_b128 v[80:83], v3 offset:0
    ds_read_b128 v[84:87], v3 offset:1024
    ds_read_b128 v[88:91], v3 offset:2048
    ds_read_b128 v[92:95], v3 offset:3072
    ds_read_b128 v[96:99], v3 offset:4096
    ds_read_b128 v[100:103], v3 offset:5120
    ds_read_b128 v[104:107], v3 offset:6144
    ds_read_b128 v[108:111], v3 offset:7168
    s_barrier
    ds_write_b32 v2, v8 offset:0
    ds_write_b32 v2, v9 offset:272
    ds_write_b32 v2, v10 offset:544
    ds_write_b32 v2, v11 offset:816
    ds_write_b32 v2, v16 offset:8704
    ds_write_b32 v2, v17 offset:8976
    ds_write_b32 v2, v18 offset:9248
    ds_write_b32 v2, v19 offset:9520
    ds_write_b32 v2, v24 offset:17408
    ds_write_b32 v2, v25 offset:17680
    ds_write_b32 v2, v26 offset:17952
    ds_write_b32 v2, v27 offset:18224
    ds_write_b32 v2, v32 offset:26112
    ds_write_b32 v2, v33 offset:26384
    ds_write_b32 v2, v34 offset:26656
    ds_write_b32 v2, v35 offset:26928
    ds_write_b32 v2, v40 offset:34816
    ds_write_b32 v2, v41 offset:35088
    ds_write_b32 v2, v42 offset:35360
    ds_write_b32 v2, v43 offset:35632
    s_lshr_b32 s27, s16, 2
    v_and_b32 v4, 15, v1
    v_lshrrev_b32 v5, 4, v1
    s_movk_i32 s36, 272
    v_mul_u32_u24 v6, s36, v4
    v_lshl_add_u32 v6, v5, 4, v6
    s_mul_i32 s36, s27, 21760
    v_add_u32 v6, s36, v6
    v_lshlrev_b32 v7, 18, v5
    v_lshl_add_u32 v7, v4, 4, v7
    s_mul_i32 s36, s27, 5242880
    s_lshl_b32 s37, s17, 10
    s_add_u32 s36, s36, s37
    s_lshl_b32 s37, s26, 8
    s_add_u32 s36, s36, s37
    v_add_u32 v7, s36, v7
    s_waitcnt lgkmcnt(0)
    s_barrier
    s_waitcnt vmcnt(0)
    ds_read_b128 v[112:115], v6 offset:0
    ds_read_b128 v[116:119], v6 offset:64
    ds_read_b128 v[120:123], v6 offset:128
    ds_read_b128 v[124:127], v6 offset:192
    ds_read_b128 v[128:131], v6 offset:4352
    ds_read_b128 v[132:135], v6 offset:4416
    ds_read_b128 v[136:139], v6 offset:4480
    ds_read_b128 v[140:143], v6 offset:4544
    s_waitcnt lgkmcnt(7)
    v_mfma_f32_16x16x32_bf16 v[144:147], v[112:115], v[80:83], 0
    v_mfma_f32_16x16x32_bf16 v[148:151], v[112:115], v[96:99], 0
    s_waitcnt lgkmcnt(6)
    v_mfma_f32_16x16x32_bf16 v[144:147], v[116:119], v[84:87], v[144:147]
    v_mfma_f32_16x16x32_bf16 v[148:151], v[116:119], v[100:103], v[148:151]
    s_waitcnt lgkmcnt(5)
    v_mfma_f32_16x16x32_bf16 v[144:147], v[120:123], v[88:91], v[144:147]
    v_mfma_f32_16x16x32_bf16 v[148:151], v[120:123], v[104:107], v[148:151]
    s_waitcnt lgkmcnt(4)
    v_mfma_f32_16x16x32_bf16 v[144:147], v[124:127], v[92:95], v[144:147]
    v_mfma_f32_16x16x32_bf16 v[148:151], v[124:127], v[108:111], v[148:151]
    ds_read_b128 v[112:115], v6 offset:8704
    ds_read_b128 v[116:119], v6 offset:8768
    ds_read_b128 v[120:123], v6 offset:8832
    ds_read_b128 v[124:127], v6 offset:8896
    s_waitcnt lgkmcnt(7)
    v_mfma_f32_16x16x32_bf16 v[152:155], v[128:131], v[80:83], 0
    v_mfma_f32_16x16x32_bf16 v[156:159], v[128:131], v[96:99], 0
    s_waitcnt lgkmcnt(6)
    v_mfma_f32_16x16x32_bf16 v[152:155], v[132:135], v[84:87], v[152:155]
    v_mfma_f32_16x16x32_bf16 v[156:159], v[132:135], v[100:103], v[156:159]
    s_waitcnt lgkmcnt(5)
    v_mfma_f32_16x16x32_bf16 v[152:155], v[136:139], v[88:91], v[152:155]
    v_mfma_f32_16x16x32_bf16 v[156:159], v[136:139], v[104:107], v[156:159]
    s_waitcnt lgkmcnt(4)
    v_mfma_f32_16x16x32_bf16 v[152:155], v[140:143], v[92:95], v[152:155]
    v_mfma_f32_16x16x32_bf16 v[156:159], v[140:143], v[108:111], v[156:159]
    ds_read_b128 v[128:131], v6 offset:13056
    ds_read_b128 v[132:135], v6 offset:13120
    ds_read_b128 v[136:139], v6 offset:13184
    ds_read_b128 v[140:143], v6 offset:13248
    v_cvt_pk_bf16_f32 v48, v144, v145
    v_cvt_pk_bf16_f32 v49, v146, v147
    v_cvt_pk_bf16_f32 v50, v148, v149
    v_cvt_pk_bf16_f32 v51, v150, v151
    buffer_store_dwordx4 v[48:51], v7, s[12:15], 0 offen
    v_add_u32 v7, 1048576, v7
    s_waitcnt lgkmcnt(7)
    v_mfma_f32_16x16x32_bf16 v[144:147], v[112:115], v[80:83], 0
    v_mfma_f32_16x16x32_bf16 v[148:151], v[112:115], v[96:99], 0
    s_waitcnt lgkmcnt(6)
    v_mfma_f32_16x16x32_bf16 v[144:147], v[116:119], v[84:87], v[144:147]
    v_mfma_f32_16x16x32_bf16 v[148:151], v[116:119], v[100:103], v[148:151]
    s_waitcnt lgkmcnt(5)
    v_mfma_f32_16x16x32_bf16 v[144:147], v[120:123], v[88:91], v[144:147]
    v_mfma_f32_16x16x32_bf16 v[148:151], v[120:123], v[104:107], v[148:151]
    s_waitcnt lgkmcnt(4)
    v_mfma_f32_16x16x32_bf16 v[144:147], v[124:127], v[92:95], v[144:147]
    v_mfma_f32_16x16x32_bf16 v[148:151], v[124:127], v[108:111], v[148:151]
    ds_read_b128 v[112:115], v6 offset:17408
    ds_read_b128 v[116:119], v6 offset:17472
    ds_read_b128 v[120:123], v6 offset:17536
    ds_read_b128 v[124:127], v6 offset:17600
    v_cvt_pk_bf16_f32 v52, v152, v153
    v_cvt_pk_bf16_f32 v53, v154, v155
    v_cvt_pk_bf16_f32 v54, v156, v157
    v_cvt_pk_bf16_f32 v55, v158, v159
    buffer_store_dwordx4 v[52:55], v7, s[12:15], 0 offen
    v_add_u32 v7, 1048576, v7
    s_waitcnt lgkmcnt(7)
    v_mfma_f32_16x16x32_bf16 v[152:155], v[128:131], v[80:83], 0
    v_mfma_f32_16x16x32_bf16 v[156:159], v[128:131], v[96:99], 0
    s_waitcnt lgkmcnt(6)
    v_mfma_f32_16x16x32_bf16 v[152:155], v[132:135], v[84:87], v[152:155]
    v_mfma_f32_16x16x32_bf16 v[156:159], v[132:135], v[100:103], v[156:159]
    s_waitcnt lgkmcnt(5)
    v_mfma_f32_16x16x32_bf16 v[152:155], v[136:139], v[88:91], v[152:155]
    v_mfma_f32_16x16x32_bf16 v[156:159], v[136:139], v[104:107], v[156:159]
    s_waitcnt lgkmcnt(4)
    v_mfma_f32_16x16x32_bf16 v[152:155], v[140:143], v[92:95], v[152:155]
    v_mfma_f32_16x16x32_bf16 v[156:159], v[140:143], v[108:111], v[156:159]
    v_cvt_pk_bf16_f32 v48, v144, v145
    v_cvt_pk_bf16_f32 v49, v146, v147
    v_cvt_pk_bf16_f32 v50, v148, v149
    v_cvt_pk_bf16_f32 v51, v150, v151
    buffer_store_dwordx4 v[48:51], v7, s[12:15], 0 offen
    v_add_u32 v7, 1048576, v7
    s_waitcnt lgkmcnt(3)
    v_mfma_f32_16x16x32_bf16 v[144:147], v[112:115], v[80:83], 0
    v_mfma_f32_16x16x32_bf16 v[148:151], v[112:115], v[96:99], 0
    s_waitcnt lgkmcnt(2)
    v_mfma_f32_16x16x32_bf16 v[144:147], v[116:119], v[84:87], v[144:147]
    v_mfma_f32_16x16x32_bf16 v[148:151], v[116:119], v[100:103], v[148:151]
    s_waitcnt lgkmcnt(1)
    v_mfma_f32_16x16x32_bf16 v[144:147], v[120:123], v[88:91], v[144:147]
    v_mfma_f32_16x16x32_bf16 v[148:151], v[120:123], v[104:107], v[148:151]
    s_waitcnt lgkmcnt(0)
    v_mfma_f32_16x16x32_bf16 v[144:147], v[124:127], v[92:95], v[144:147]
    v_mfma_f32_16x16x32_bf16 v[148:151], v[124:127], v[108:111], v[148:151]
    v_cvt_pk_bf16_f32 v52, v152, v153
    v_cvt_pk_bf16_f32 v53, v154, v155
    v_cvt_pk_bf16_f32 v54, v156, v157
    v_cvt_pk_bf16_f32 v55, v158, v159
    buffer_store_dwordx4 v[52:55], v7, s[12:15], 0 offen
    v_add_u32 v7, 1048576, v7
    s_nop 7
    v_cvt_pk_bf16_f32 v48, v144, v145
    v_cvt_pk_bf16_f32 v49, v146, v147
    v_cvt_pk_bf16_f32 v50, v148, v149
    v_cvt_pk_bf16_f32 v51, v150, v151
    buffer_store_dwordx4 v[48:51], v7, s[12:15], 0 offen
L_m_end:
    s_endpgm
.section .rodata,"a"
.p2align 6
.amdhsa_kernel bin_kernel
.amdhsa_next_free_vgpr 48
.amdhsa_next_free_sgpr 100
.amdhsa_accum_offset 48
.amdhsa_group_segment_fixed_size 0
.amdhsa_kernarg_size 88
.amdhsa_user_sgpr_count 2
.amdhsa_user_sgpr_kernarg_segment_ptr 1
.amdhsa_system_sgpr_workgroup_id_x 1
.amdhsa_float_denorm_mode_32 3
.end_amdhsa_kernel
.amdhsa_kernel main_kernel
.amdhsa_next_free_vgpr 218
.amdhsa_next_free_sgpr 100
.amdhsa_accum_offset 220
.amdhsa_group_segment_fixed_size 0
.amdhsa_kernarg_size 88
.amdhsa_user_sgpr_count 2
.amdhsa_user_sgpr_kernarg_segment_ptr 1
.amdhsa_system_sgpr_workgroup_id_x 1
.amdhsa_float_denorm_mode_32 3
.end_amdhsa_kernel
```

```asm
; @launch kernel=bin_kernel grid=(256,1,1) block=(640,1,1) lds=66560
; @launch kernel=main_kernel grid=(256,1,1) block=(512,1,1) lds=149504
.amdgcn_target "amdgcn-amd-amdhsa--gfx950"
.text
.globl bin_kernel
.p2align 8
.type bin_kernel,@function
bin_kernel:
    s_cmp_ge_u32 s2, 256
    s_cbranch_scc1 L_k1_end
    s_load_dwordx8 s[36:43], s[0:1], 8
    s_load_dwordx4 s[44:47], s[0:1], 40
    s_load_dwordx2 s[48:49], s[0:1], 56
    s_load_dwordx2 s[50:51], s[0:1], 80
    v_lshrrev_b32 v4, 6, v0
    v_lshlrev_b32 v1, 2, v0
    v_readfirstlane_b32 s28, v4
    v_lshlrev_b32 v2, 3, v0
    v_lshlrev_b32 v3, 4, v0
    v_and_b32 v4, 63, v0
    v_mov_b32 v18, 0
    ds_write_b32 v1, v18 offset:64000
    v_mov_b32 v18, 1
    s_and_b32 s29, s2, 7
    s_lshl_b32 s29, s29, 5
    s_lshr_b32 s33, s2, 3
    s_or_b32 s29, s29, s33
    s_mul_i32 s30, s29, 5000
    s_mul_i32 s31, s29, 10000
    s_add_u32 s32, s31, 5120
    s_movk_i32 s33, 610
    v_cmp_gt_u32 s[52:53], s33, v0
    s_movk_i32 s33, 580
    v_cmp_gt_u32 s[54:55], s33, v0
    s_waitcnt lgkmcnt(0)
    s_mov_b32 s8, s38
    s_mov_b32 s9, s39
    s_mov_b32 s10, 1280000
    s_mov_b32 s11, 0x00020000
    buffer_load_dword v5, v1, s[8:11], s30 offen
    buffer_load_dword v6, v1, s[8:11], s30 offen offset:2560
    s_mov_b32 s4, s36
    s_mov_b32 s5, s37
    s_mov_b32 s6, 1280000
    s_mov_b32 s7, 0x00020000
    buffer_load_dword v7, v1, s[4:7], s30 offen
    buffer_load_dword v44, v1, s[4:7], s30 offen offset:2560
    s_mov_b32 s12, s40
    s_mov_b32 s13, s41
    s_mov_b32 s14, 2560000
    s_mov_b32 s15, 0x00020000
    buffer_load_dwordx2 v[8:9], v2, s[12:15], s31 offen
    buffer_load_dwordx2 v[12:13], v2, s[12:15], s32 offen
    s_mov_b32 s16, s42
    s_mov_b32 s17, s43
    s_mov_b32 s18, 10240000
    s_mov_b32 s19, 0x00020000
    s_mov_b32 s20, s50
    s_mov_b32 s21, s51
    s_mov_b32 s22, 16777216
    s_mov_b32 s23, 0x00020000
    s_lshl_b32 s33, s2, 6
    v_or_b32 v45, s33, v4
    s_cmp_eq_u32 s28, 0
    s_cbranch_scc0 L_k1_r1
    s_mov_b32 s24, s48
    s_mov_b32 s25, s49
    s_mov_b32 s26, 32768
    s_mov_b32 s27, 0x00020000
    v_and_b32 v20, 7, v45
    v_bfe_u32 v21, v45, 7, 2
    v_lshl_add_u32 v20, v21, 3, v20
    v_bfe_u32 v21, v45, 9, 2
    v_lshl_add_u32 v20, v21, 5, v20
    v_bfe_u32 v21, v45, 11, 1
    v_bfe_u32 v22, v45, 3, 4
    v_lshl_add_u32 v21, v22, 1, v21
    v_lshrrev_b32 v22, 12, v45
    v_lshl_add_u32 v21, v22, 5, v21
    v_lshlrev_b32 v21, 1, v21
    v_lshl_add_u32 v20, v20, 8, v21
    buffer_load_ushort v19, v20, s[24:27], 0 offen
    s_branch L_k1_rdone
L_k1_r1:
    s_cmp_eq_u32 s28, 1
    s_cbranch_scc0 L_k1_r2
    s_cmp_lt_u32 s2, 32
    s_cbranch_scc0 L_k1_rdone
    s_mov_b32 s24, s44
    s_mov_b32 s25, s45
    s_mov_b32 s26, 4096
    s_mov_b32 s27, 0x00020000
    v_and_b32 v20, 7, v45
    v_bfe_u32 v21, v45, 8, 1
    v_lshl_add_u32 v20, v21, 3, v20
    v_bfe_u32 v21, v45, 9, 1
    v_bfe_u32 v22, v45, 3, 5
    v_lshl_add_u32 v21, v22, 1, v21
    v_lshrrev_b32 v22, 10, v45
    v_lshl_add_u32 v21, v22, 6, v21
    v_lshlrev_b32 v21, 1, v21
    v_lshl_add_u32 v20, v20, 8, v21
    buffer_load_ushort v19, v20, s[24:27], 0 offen
    s_branch L_k1_rdone
L_k1_r2:
    s_cmp_eq_u32 s28, 2
    s_cbranch_scc0 L_k1_rdone
    s_cmp_eq_u32 s2, 0
    s_cbranch_scc0 L_k1_rdone
    s_mov_b32 s24, s46
    s_mov_b32 s25, s47
    s_mov_b32 s26, 128
    s_mov_b32 s27, 0x00020000
    v_and_b32 v20, 0x30, v4
    v_and_b32 v21, 3, v4
    v_lshl_add_u32 v20, v21, 2, v20
    v_bfe_u32 v21, v4, 2, 2
    v_add_lshl_u32 v20, v20, v21, 1
    buffer_load_ushort v19, v20, s[24:27], 0 offen
L_k1_rdone:
    s_mul_i32 s34, s29, 40000
    s_lshl_b32 s35, s28, 10
    s_barrier
    s_add_u32 m0, s35, 0
    s_nop 0
    buffer_load_dwordx4 v3, s[16:19], s34 offen  lds
    s_add_u32 m0, s35, 10240
    s_add_u32 s34, s34, 10240
    buffer_load_dwordx4 v3, s[16:19], s34 offen  lds
    s_add_u32 m0, s35, 20480
    s_add_u32 s34, s34, 10240
    buffer_load_dwordx4 v3, s[16:19], s34 offen  lds
    s_mov_b64 exec, s[54:55]
    s_add_u32 m0, s35, 30720
    s_add_u32 s34, s34, 10240
    buffer_load_dwordx4 v3, s[16:19], s34 offen  lds
    s_mov_b64 exec, -1
    s_waitcnt vmcnt(8)
    v_and_b32 v20, 255, v5
    v_and_b32 v21, 255, v6
    v_lshlrev_b32 v28, 2, v20
    v_lshlrev_b32 v29, 2, v21
    ds_add_rtn_u32 v16, v28, v18 offset:64000
    s_mov_b64 exec, s[52:53]
    ds_add_rtn_u32 v17, v29, v18 offset:64000
    s_mov_b64 exec, -1
    s_movk_i32 s33, 5033
    s_waitcnt vmcnt(6)
    v_lshrrev_b32 v21, 8, v5
    v_lshlrev_b32 v20, 2, v21
    v_lshl_or_b32 v10, v7, 10, v20
    v_mul_u32_u24 v20, s33, v7
    v_lshrrev_b32 v20, 22, v20
    v_mad_u32_u24 v20, v21, 12, v20
    v_lshlrev_b32 v11, 2, v20
    v_lshrrev_b32 v21, 8, v6
    v_lshlrev_b32 v20, 2, v21
    v_lshl_or_b32 v14, v44, 10, v20
    v_mul_u32_u24 v20, s33, v44
    v_lshrrev_b32 v20, 22, v20
    v_mad_u32_u24 v20, v21, 12, v20
    v_lshlrev_b32 v15, 2, v20
    v_lshlrev_b32 v30, 4, v4
    s_waitcnt lgkmcnt(0)
    s_barrier
    ds_read_b128 v[20:23], v30 offset:64000
    s_waitcnt lgkmcnt(0)
    v_add_u32 v26, v20, v21
    v_add_u32 v27, v26, v22
    v_add_u32 v31, v27, v23
    v_mov_b32 v32, v31
    s_nop 1
    v_add_u32_dpp v32, v32, v32 row_shr:1 row_mask:0xf bank_mask:0xf
    s_nop 1
    v_add_u32_dpp v32, v32, v32 row_shr:2 row_mask:0xf bank_mask:0xf
    s_nop 1
    v_add_u32_dpp v32, v32, v32 row_shr:4 row_mask:0xf bank_mask:0xf
    s_nop 1
    v_add_u32_dpp v32, v32, v32 row_shr:8 row_mask:0xf bank_mask:0xf
    s_nop 1
    v_add_u32_dpp v32, v32, v32 row_bcast:15 row_mask:0xa bank_mask:0xf
    s_nop 1
    v_add_u32_dpp v32, v32, v32 row_bcast:31 row_mask:0xc bank_mask:0xf
    v_sub_u32 v24, v32, v31
    v_add_u32 v25, v24, v20
    v_add_u32 v26, v24, v26
    v_add_u32 v27, v24, v27
    ds_write_b128 v30, v[24:27] offset:65024
    ds_read_b32 v33, v28 offset:65024
    ds_read_b32 v34, v29 offset:65024
    v_lshlrev_b32 v35, 5, v0
    v_add_u32 v36, 20480, v35
    s_waitcnt lgkmcnt(0)
    v_add_lshl_u32 v33, v33, v16, 1
    v_add_lshl_u32 v34, v34, v17, 1
    ds_write_b16 v33, v35 offset:61440
    v_lshlrev_b32 v33, 3, v33
    s_waitcnt vmcnt(4)
    ds_write_b128 v33, v[8:11] offset:40960
    s_mov_b64 exec, s[52:53]
    ds_write_b16 v34, v36 offset:61440
    v_lshlrev_b32 v34, 3, v34
    ds_write_b128 v34, v[12:15] offset:40960
    s_mov_b64 exec, -1
    s_cmp_eq_u32 s28, 3
    s_cbranch_scc0 L_k1_s0
    s_lshl_b32 s33, s29, 2
    s_add_u32 s33, s33, 15728640
    v_lshlrev_b32 v37, 12, v4
    v_lshl_or_b32 v40, v20, 16, v24
    buffer_store_dword v40, v37, s[20:23], s33 offen offset:0
    v_lshl_or_b32 v41, v21, 16, v25
    buffer_store_dword v41, v37, s[20:23], s33 offen offset:1024
    v_lshl_or_b32 v42, v22, 16, v26
    buffer_store_dword v42, v37, s[20:23], s33 offen offset:2048
    v_lshl_or_b32 v43, v23, 16, v27
    buffer_store_dword v43, v37, s[20:23], s33 offen offset:3072
    s_branch L_k1_sdone
L_k1_s0:
    v_lshlrev_b32 v37, 1, v45
    s_cmp_eq_u32 s28, 0
    s_cbranch_scc0 L_k1_s1
    s_mov_b32 s33, 15990784
    buffer_store_short v19, v37, s[20:23], s33 offen
    s_branch L_k1_sdone
L_k1_s1:
    s_cmp_eq_u32 s28, 1
    s_cbranch_scc0 L_k1_s2
    s_cmp_lt_u32 s2, 32
    s_cbranch_scc0 L_k1_sdone
    v_lshlrev_b32 v38, 16, v19
    v_mul_f32 v38, 0xbfb8aa3b, v38
    v_cvt_pk_bf16_f32 v39, v38, v38
    v_lshlrev_b32 v40, 16, v39
    v_sub_f32 v38, v38, v40
    v_cvt_pk_bf16_f32 v40, v38, v38
    s_mov_b32 s33, 16023552
    buffer_store_short v39, v37, s[20:23], s33 offen
    s_mov_b32 s33, 16027648
    buffer_store_short v40, v37, s[20:23], s33 offen
    s_branch L_k1_sdone
L_k1_s2:
    s_cmp_eq_u32 s28, 2
    s_cbranch_scc0 L_k1_sdone
    s_cmp_eq_u32 s2, 0
    s_cbranch_scc0 L_k1_sdone
    s_mov_b32 s33, 16031744
    buffer_store_short v19, v37, s[20:23], s33 offen
L_k1_sdone:
    v_and_b32 v33, 0x3fe, v0
    v_and_b32 v34, 1, v0
    v_lshlrev_b32 v34, 4, v34
    s_mul_i32 s34, s29, 20480
    s_add_u32 s34, s34, 10485760
    s_add_u32 s35, s34, 10240
    s_waitcnt lgkmcnt(0)
    s_barrier
    ds_read_b128 v[8:11], v3 offset:40960
    ds_read_b128 v[12:15], v3 offset:51200
    ds_read_u16 v36, v33 offset:61440
    ds_read_u16 v37, v33 offset:62080
    ds_read_u16 v38, v33 offset:62720
    ds_read_u16 v39, v33 offset:63360
    s_waitcnt lgkmcnt(5)
    buffer_store_dwordx4 v[8:11], v3, s[20:23], s34 offen sc1
    s_waitcnt lgkmcnt(4)
    s_mov_b64 exec, s[52:53]
    buffer_store_dwordx4 v[12:15], v3, s[20:23], s35 offen sc1
    s_mov_b64 exec, -1
    s_waitcnt lgkmcnt(0)
    v_or_b32 v36, v36, v34
    v_or_b32 v37, v37, v34
    v_or_b32 v38, v38, v34
    v_or_b32 v39, v39, v34
    s_mul_i32 s34, s29, 40960
    s_waitcnt vmcnt(2)
    s_barrier
    ds_read_b128 v[16:19], v36 offset:0
    ds_read_b128 v[20:23], v37 offset:0
    ds_read_b128 v[24:27], v38 offset:0
    s_mov_b64 exec, s[54:55]
    ds_read_b128 v[28:31], v39 offset:0
    s_mov_b64 exec, -1
    s_waitcnt lgkmcnt(3)
    buffer_store_dwordx4 v[16:19], v3, s[20:23], s34 offen sc1
    s_add_u32 s34, s34, 10240
    s_waitcnt lgkmcnt(2)
    buffer_store_dwordx4 v[20:23], v3, s[20:23], s34 offen sc1
    s_add_u32 s34, s34, 10240
    s_waitcnt lgkmcnt(1)
    buffer_store_dwordx4 v[24:27], v3, s[20:23], s34 offen sc1
    s_add_u32 s34, s34, 10240
    s_mov_b64 exec, s[54:55]
    s_waitcnt lgkmcnt(0)
    buffer_store_dwordx4 v[28:31], v3, s[20:23], s34 offen sc1
L_k1_end:
    s_endpgm
.globl main_kernel
.p2align 8
.type main_kernel,@function
main_kernel:
    s_cmp_ge_u32 s2, 256
    s_cbranch_scc1 L_m_end
    s_load_dwordx2 s[44:45], s[0:1], 80
    s_load_dwordx2 s[46:47], s[0:1], 0
    s_load_dwordx2 s[48:49], s[0:1], 64
    v_lshrrev_b32 v2, 6, v0
    v_and_b32 v1, 63, v0
    v_readfirstlane_b32 s16, v2
    s_and_b32 s17, s2, 7
    s_lshl_b32 s17, s17, 5
    s_lshr_b32 s26, s2, 3
    s_or_b32 s17, s17, s26
    v_lshrrev_b32 v4, 1, v0
    v_lshlrev_b32 v5, 2, v4
    s_lshl_b32 s26, s17, 10
    s_add_u32 s26, s26, 15728640
    v_lshlrev_b32 v232, 4, v1
    s_waitcnt lgkmcnt(0)
    s_mov_b32 s8, s44
    s_mov_b32 s9, s45
    s_mov_b32 s10, 16777216
    s_mov_b32 s11, 0x00020000
    buffer_load_dword v6, v5, s[8:11], s26 offen
    v_lshlrev_b32 v7, 3, v0
    v_mov_b32 v2, 0
    v_mov_b32 v3, 0
    ds_write_b64 v7, v[2:3]
    s_waitcnt lgkmcnt(0)
    s_barrier
    s_mov_b32 s26, 16023552
    buffer_load_dwordx4 v[200:203], v232, s[8:11], s26 offen offset:0
    buffer_load_dwordx4 v[204:207], v232, s[8:11], s26 offen offset:1024
    buffer_load_dwordx4 v[208:211], v232, s[8:11], s26 offen offset:2048
    buffer_load_dwordx4 v[212:215], v232, s[8:11], s26 offen offset:3072
    v_and_b32 v7, 3, v0
    v_lshlrev_b32 v7, 3, v7
    s_mov_b32 s26, 16031744
    buffer_load_dwordx2 v[216:217], v7, s[8:11], s26 offen offset:0
    buffer_load_dwordx2 v[218:219], v7, s[8:11], s26 offen offset:32
    buffer_load_dwordx2 v[220:221], v7, s[8:11], s26 offen offset:64
    buffer_load_dwordx2 v[222:223], v7, s[8:11], s26 offen offset:96
    s_lshl_b32 s26, s16, 12
    s_add_u32 m0, s26, 116736
    s_add_u32 s26, s26, 15990784
    buffer_load_dwordx4 v232, s[8:11], s26 offen offset:0 lds
    buffer_load_dwordx4 v232, s[8:11], s26 offen offset:1024 lds
    buffer_load_dwordx4 v232, s[8:11], s26 offen offset:2048 lds
    buffer_load_dwordx4 v232, s[8:11], s26 offen offset:3072 lds
    s_mov_b32 s4, s46
    s_mov_b32 s5, s47
    s_mov_b32 s6, 10240000
    s_mov_b32 s7, 0x00020000
    s_mov_b32 s12, s48
    s_mov_b32 s13, s49
    s_mov_b32 s14, 10240000
    s_mov_b32 s15, 0x00020000
    s_mov_b32 s20, 0x0f0f0f0f
    s_mov_b32 s21, 0x0f0f0f0f
    s_mov_b32 s22, 0xf0f0f0f0
    s_mov_b32 s23, 0xf0f0f0f0
    s_mov_b32 s31, 0xfffffc00
    s_mov_b32 s32, 0x9c4028
    s_mov_b32 s33, 0xffe0
    s_mov_b32 s24, 0
    s_mov_b32 s25, 0
    v_mov_b32 v8, 0
    v_mov_b32 v9, 0
    v_mov_b32 v10, 0
    v_mov_b32 v11, 0
    v_mov_b32 v12, 0
    v_mov_b32 v13, 0
    v_mov_b32 v14, 0
    v_mov_b32 v15, 0
    v_mov_b32 v16, 0
    v_mov_b32 v17, 0
    v_mov_b32 v18, 0
    v_mov_b32 v19, 0
    v_mov_b32 v20, 0
    v_mov_b32 v21, 0
    v_mov_b32 v22, 0
    v_mov_b32 v23, 0
    v_mov_b32 v24, 0
    v_mov_b32 v25, 0
    v_mov_b32 v26, 0
    v_mov_b32 v27, 0
    v_mov_b32 v28, 0
    v_mov_b32 v29, 0
    v_mov_b32 v30, 0
    v_mov_b32 v31, 0
    v_mov_b32 v32, 0
    v_mov_b32 v33, 0
    v_mov_b32 v34, 0
    v_mov_b32 v35, 0
    v_mov_b32 v36, 0
    v_mov_b32 v37, 0
    v_mov_b32 v38, 0
    v_mov_b32 v39, 0
    v_mov_b32 v40, 0
    v_mov_b32 v41, 0
    v_mov_b32 v42, 0
    v_mov_b32 v43, 0
    v_mov_b32 v44, 0
    v_mov_b32 v45, 0
    v_mov_b32 v46, 0
    v_mov_b32 v47, 0
    v_mov_b32 v192, 0
    v_mov_b32 v193, 0
    v_mov_b32 v194, 0
    v_mov_b32 v195, 0
    v_mov_b32 v196, 0
    v_mov_b32 v197, 0
    v_mov_b32 v198, 0
    v_mov_b32 v199, 0
    v_mov_b32 v112, 0
    v_mov_b32 v238, 0
    s_cmp_lt_u32 s17, 16
    s_cbranch_scc1 L_map40
    v_writelane_b32 v112, 0, 0
    v_writelane_b32 v112, 5, 1
    v_writelane_b32 v112, 6, 2
    v_writelane_b32 v112, 3, 3
    v_writelane_b32 v112, 8, 4
    v_writelane_b32 v112, 7, 5
    v_writelane_b32 v112, 2, 6
    v_writelane_b32 v112, 4, 7
    v_writelane_b32 v112, 1, 8
    v_writelane_b32 v112, 16, 9
    v_writelane_b32 v112, 10, 10
    v_writelane_b32 v112, 15, 11
    v_writelane_b32 v112, 9, 12
    v_writelane_b32 v112, 24, 13
    v_writelane_b32 v112, 14, 14
    v_writelane_b32 v112, 11, 15
    v_writelane_b32 v112, 13, 16
    v_writelane_b32 v112, 12, 17
    v_writelane_b32 v112, 17, 18
    v_writelane_b32 v112, 23, 19
    v_writelane_b32 v112, 20, 20
    v_writelane_b32 v112, 22, 21
    v_writelane_b32 v112, 19, 22
    v_writelane_b32 v112, 18, 23
    v_writelane_b32 v112, 21, 24
    v_writelane_b32 v112, 28, 25
    v_writelane_b32 v112, 29, 26
    v_writelane_b32 v112, 31, 27
    v_writelane_b32 v112, 26, 28
    v_writelane_b32 v112, 25, 29
    v_writelane_b32 v112, 27, 30
    v_writelane_b32 v112, 30, 31
    v_writelane_b32 v112, 36, 32
    v_writelane_b32 v112, 33, 33
    v_writelane_b32 v112, 35, 34
    v_writelane_b32 v112, 34, 35
    v_writelane_b32 v112, 38, 36
    v_writelane_b32 v112, 39, 37
    v_writelane_b32 v112, 37, 38
    v_writelane_b32 v112, 32, 39
    s_branch L_mapd
L_map40:
    v_writelane_b32 v112, 7, 0
    v_writelane_b32 v112, 0, 1
    v_writelane_b32 v112, 5, 2
    v_writelane_b32 v112, 2, 3
    v_writelane_b32 v112, 4, 4
    v_writelane_b32 v112, 3, 5
    v_writelane_b32 v112, 1, 6
    v_writelane_b32 v112, 6, 7
    v_writelane_b32 v112, 12, 8
    v_writelane_b32 v112, 9, 9
    v_writelane_b32 v112, 14, 10
    v_writelane_b32 v112, 11, 11
    v_writelane_b32 v112, 15, 12
    v_writelane_b32 v112, 10, 13
    v_writelane_b32 v112, 8, 14
    v_writelane_b32 v112, 13, 15
    v_writelane_b32 v112, 21, 16
    v_writelane_b32 v112, 22, 17
    v_writelane_b32 v112, 19, 18
    v_writelane_b32 v112, 16, 19
    v_writelane_b32 v112, 23, 20
    v_writelane_b32 v112, 17, 21
    v_writelane_b32 v112, 18, 22
    v_writelane_b32 v112, 20, 23
    v_writelane_b32 v112, 26, 24
    v_writelane_b32 v112, 29, 25
    v_writelane_b32 v112, 27, 26
    v_writelane_b32 v112, 25, 27
    v_writelane_b32 v112, 28, 28
    v_writelane_b32 v112, 30, 29
    v_writelane_b32 v112, 24, 30
    v_writelane_b32 v112, 31, 31
    v_writelane_b32 v112, 38, 32
    v_writelane_b32 v112, 33, 33
    v_writelane_b32 v112, 36, 34
    v_writelane_b32 v112, 35, 35
    v_writelane_b32 v112, 34, 36
    v_writelane_b32 v112, 32, 37
    v_writelane_b32 v112, 37, 38
    v_writelane_b32 v112, 39, 39
L_mapd:
    v_and_b32 v2, 3, v1
    v_lshrrev_b32 v3, 2, v1
    v_lshl_add_u32 v234, v2, 4, v3
    v_lshrrev_b32 v2, 5, v1
    v_lshlrev_b32 v233, 4, v2
    v_and_b32 v3, 1, v0
    v_cmp_eq_u32 vcc, 0, v3
    s_movk_i32 s26, 1280
    s_waitcnt vmcnt(12)
    v_lshrrev_b32 v2, 16, v6
    v_cndmask_b32 v236, 0, v2, vcc
    v_and_b32 v6, 0xffff, v6
    v_mad_u32_u24 v6, v4, s26, v6
    s_nop 1
    v_add_u32_dpp v236, v236, v236 row_shr:1 row_mask:0xf bank_mask:0xf
    s_nop 1
    v_add_u32_dpp v236, v236, v236 row_shr:2 row_mask:0xf bank_mask:0xf
    s_nop 1
    v_add_u32_dpp v236, v236, v236 row_shr:4 row_mask:0xf bank_mask:0xf
    s_nop 1
    v_add_u32_dpp v236, v236, v236 row_shr:8 row_mask:0xf bank_mask:0xf
    s_nop 1
    v_add_u32_dpp v236, v236, v236 row_bcast:15 row_mask:0xa bank_mask:0xf
    s_nop 1
    v_add_u32_dpp v236, v236, v236 row_bcast:31 row_mask:0xc bank_mask:0xf
    v_sub_u32 v235, v236, v2
    v_readlane_b32 s19, v236, 63
    v_sub_u32 v237, v6, v235
L_round:
    s_lshl_b32 s26, s16, 10
    s_add_u32 s26, s26, 8192
    v_and_b32 v2, 1, v0
    v_max_u32 v3, s24, v235
    v_add_u32 v3, v3, v2
    s_add_u32 s27, s24, 256
    v_min_u32 v4, s27, v236
    v_add_u32 v5, v237, v3
    s_lshl_b32 s27, s24, 2
    s_sub_u32 s27, s26, s27
    v_lshl_add_u32 v6, v3, 2, s27
    v_cmpx_lt_u32 vcc, v3, v4
    s_cbranch_execz L_exp_done
L_exp:
    ds_write_b32 v6, v5
    v_add_u32 v3, 2, v3
    v_add_u32 v5, 2, v5
    v_add_u32 v6, 8, v6
    v_cmpx_lt_u32 vcc, v3, v4
    s_cbranch_execnz L_exp
L_exp_done:
    s_mov_b64 exec, -1
    v_lshl_add_u32 v3, v1, 2, s26
    v_lshrrev_b32 v7, 1, v1
    v_lshl_add_u32 v4, v7, 2, s26
    ds_read_b32 v99, v3 offset:768
    ds_read_b32 v98, v3 offset:512
    ds_read_b32 v97, v3 offset:256
    ds_read_b32 v96, v3 offset:0
    ds_read_b32 v100, v4 offset:0
    ds_read_b32 v101, v4 offset:128
    ds_read_b32 v102, v4 offset:256
    ds_read_b32 v103, v4 offset:384
    ds_read_b32 v104, v4 offset:512
    ds_read_b32 v105, v4 offset:640
    ds_read_b32 v106, v4 offset:768
    ds_read_b32 v107, v4 offset:896
    s_sub_i32 s28, s19, s24
    s_max_i32 s28, s28, 0
    s_min_i32 s28, s28, 256
    v_lshlrev_b32 v2, 4, v2
    v_mov_b32 v5, 0x04000000
    s_sub_i32 s27, s28, 0
    v_cmp_gt_i32 s[36:37], s27, v1
    s_sub_i32 s27, s28, 64
    v_cmp_gt_i32 s[38:39], s27, v1
    s_sub_i32 s27, s28, 128
    v_cmp_gt_i32 s[40:41], s27, v1
    s_sub_i32 s27, s28, 192
    v_cmp_gt_i32 s[42:43], s27, v1
    s_mov_b32 s26, 10485760
    s_cmp_le_u32 s28, 192
    s_cbranch_scc1 L_sk3
    s_waitcnt lgkmcnt(11)
    v_cndmask_b32 v99, v5, v99, s[42:43]
    v_lshlrev_b32 v99, 4, v99
    buffer_load_dwordx4 v[92:95], v99, s[8:11], s26 offen
L_sk3:
    s_waitcnt lgkmcnt(10)
    v_cndmask_b32 v98, v5, v98, s[40:41]
    v_lshlrev_b32 v98, 4, v98
    buffer_load_dwordx4 v[88:91], v98, s[8:11], s26 offen
    s_waitcnt lgkmcnt(9)
    v_cndmask_b32 v97, v5, v97, s[38:39]
    v_lshlrev_b32 v97, 4, v97
    buffer_load_dwordx4 v[84:87], v97, s[8:11], s26 offen
    s_waitcnt lgkmcnt(8)
    v_cndmask_b32 v96, v5, v96, s[36:37]
    v_lshlrev_b32 v96, 4, v96
    buffer_load_dwordx4 v[80:83], v96, s[8:11], s26 offen
    s_waitcnt lgkmcnt(0)
    s_barrier
    s_sub_i32 s27, s28, 0
    v_cmp_gt_i32 vcc, s27, v7
    s_lshl_b32 s26, s16, 13
    s_add_u32 m0, s26, 16384
    v_cndmask_b32 v100, v5, v100, vcc
    v_lshl_or_b32 v100, v100, 5, v2
    buffer_load_dwordx4 v100, s[8:11], 0 offen  lds
    s_sub_i32 s27, s28, 32
    v_cmp_gt_i32 vcc, s27, v7
    s_lshl_b32 s26, s16, 13
    s_add_u32 m0, s26, 17408
    v_cndmask_b32 v101, v5, v101, vcc
    v_lshl_or_b32 v101, v101, 5, v2
    buffer_load_dwordx4 v101, s[8:11], 0 offen  lds
    s_sub_i32 s27, s28, 64
    v_cmp_gt_i32 vcc, s27, v7
    s_lshl_b32 s26, s16, 13
    s_add_u32 m0, s26, 18432
    v_cndmask_b32 v102, v5, v102, vcc
    v_lshl_or_b32 v102, v102, 5, v2
    buffer_load_dwordx4 v102, s[8:11], 0 offen  lds
    s_add_u32 s26, s19, 255
    s_lshr_b32 s26, s26, 8
    v_mov_b32 v3, s26
    v_mov_b32 v4, 2304
    ds_max_u32 v4, v3
    s_mul_i32 s26, s16, 5
    v_add_u32 v113, s26, v1
    v_subrev_u32 v3, 40, v113
    v_min_u32 v113, v113, v3
    v_mul_u32_u24 v3, 205, v1
    v_lshrrev_b32 v3, 10, v3
    v_lshlrev_b32 v114, 2, v3
    v_mul_u32_u24 v3, 5, v3
    v_sub_u32 v115, v1, v3
    v_mov_b32 v6, 1
    s_waitcnt vmcnt(6)
    s_mov_b64 exec, s[42:43]
    v_and_b32 v3, 0xff, v94
    ds_add_rtn_u32 v111, v95, v6 offset:0
    ds_add_u32 v3, v6 offset:2048
    s_waitcnt vmcnt(5)
    s_mov_b64 exec, s[40:41]
    v_and_b32 v3, 0xff, v90
    ds_add_rtn_u32 v110, v91, v6 offset:0
    ds_add_u32 v3, v6 offset:2048
    s_waitcnt vmcnt(4)
    s_mov_b64 exec, s[38:39]
    v_and_b32 v3, 0xff, v86
    ds_add_rtn_u32 v109, v87, v6 offset:0
    ds_add_u32 v3, v6 offset:2048
    s_waitcnt vmcnt(3)
    s_mov_b64 exec, s[36:37]
    v_and_b32 v3, 0xff, v82
    ds_add_rtn_u32 v108, v83, v6 offset:0
    ds_add_u32 v3, v6 offset:2048
    s_mov_b64 exec, -1
    v_lshlrev_b32 v3, 2, v113
    s_waitcnt lgkmcnt(0)
    s_barrier
    ds_read_b32 v3, v3 offset:2048
    ds_read_b32 v4, v4
    s_cmp_le_u32 s28, 96
    s_cbranch_scc1 L_efd
    s_sub_i32 s27, s28, 96
    v_cmp_gt_i32 vcc, s27, v7
    s_lshl_b32 s26, s16, 13
    s_add_u32 m0, s26, 19456
    v_cndmask_b32 v103, v5, v103, vcc
    v_lshl_or_b32 v103, v103, 5, v2
    buffer_load_dwordx4 v103, s[8:11], 0 offen  lds
    s_cmp_le_u32 s28, 128
    s_cbranch_scc1 L_efd
    s_sub_i32 s27, s28, 128
    v_cmp_gt_i32 vcc, s27, v7
    s_lshl_b32 s26, s16, 13
    s_add_u32 m0, s26, 20480
    v_cndmask_b32 v104, v5, v104, vcc
    v_lshl_or_b32 v104, v104, 5, v2
    buffer_load_dwordx4 v104, s[8:11], 0 offen  lds
    s_cmp_le_u32 s28, 160
    s_cbranch_scc1 L_efd
    s_sub_i32 s27, s28, 160
    v_cmp_gt_i32 vcc, s27, v7
    s_lshl_b32 s26, s16, 13
    s_add_u32 m0, s26, 21504
    v_cndmask_b32 v105, v5, v105, vcc
    v_lshl_or_b32 v105, v105, 5, v2
    buffer_load_dwordx4 v105, s[8:11], 0 offen  lds
    s_cmp_le_u32 s28, 192
    s_cbranch_scc1 L_efd
    s_sub_i32 s27, s28, 192
    v_cmp_gt_i32 vcc, s27, v7
    s_lshl_b32 s26, s16, 13
    s_add_u32 m0, s26, 22528
    v_cndmask_b32 v106, v5, v106, vcc
    v_lshl_or_b32 v106, v106, 5, v2
    buffer_load_dwordx4 v106, s[8:11], 0 offen  lds
    s_cmp_le_u32 s28, 224
    s_cbranch_scc1 L_efd
    s_sub_i32 s27, s28, 224
    v_cmp_gt_i32 vcc, s27, v7
    s_lshl_b32 s26, s16, 13
    s_add_u32 m0, s26, 23552
    v_cndmask_b32 v107, v5, v107, vcc
    v_lshl_or_b32 v107, v107, 5, v2
    buffer_load_dwordx4 v107, s[8:11], 0 offen  lds
L_efd:
    v_cmp_gt_u32 vcc, 40, v1
    s_waitcnt lgkmcnt(0)
    v_readfirstlane_b32 s26, v4
    v_lshl_or_b32 v3, v3, 6, v113
    v_cndmask_b32 v3, 0, v3, vcc
    s_max_u32 s25, s25, s26
    s_cmp_lg_u32 s24, 0
    s_cbranch_scc1 L_havepos
    v_readlane_b32 s64, v3, 0
    v_readlane_b32 s65, v3, 1
    v_readlane_b32 s66, v3, 2
    v_readlane_b32 s67, v3, 3
    v_readlane_b32 s68, v3, 4
    v_cmp_lt_u32 s[70:71], s64, v3
    v_cmp_lt_u32 s[72:73], s65, v3
    v_cmp_lt_u32 s[74:75], s66, v3
    v_cmp_lt_u32 s[76:77], s67, v3
    v_cmp_lt_u32 s[78:79], s68, v3
    s_bcnt1_i32_b64 s64, s[70:71]
    s_bcnt1_i32_b64 s65, s[72:73]
    s_bcnt1_i32_b64 s66, s[74:75]
    s_bcnt1_i32_b64 s67, s[76:77]
    s_bcnt1_i32_b64 s68, s[78:79]
    v_readlane_b32 s70, v112, s64
    v_readlane_b32 s71, v112, s65
    v_readlane_b32 s72, v112, s66
    v_readlane_b32 s73, v112, s67
    v_readlane_b32 s74, v112, s68
    v_writelane_b32 v238, s70, 0
    v_writelane_b32 v238, s71, 1
    v_writelane_b32 v238, s72, 2
    v_writelane_b32 v238, s73, 3
    v_writelane_b32 v238, s74, 4
    v_lshlrev_b32 v238, 2, v238
L_havepos:
    s_mov_b64 exec, 31
    ds_write_b32 v238, v3 offset:4096
    s_mov_b64 exec, -1
    s_lshl_b32 s26, s16, 2
    v_lshl_add_u32 v3, v115, 5, s26
    v_lshlrev_b32 v4, 2, v1
    v_and_b32 v6, 7, v1
    v_cmp_gt_u32 s[34:35], s16, v6
    v_cmp_gt_u32 vcc, 40, v1
    s_and_b64 s[34:35], s[34:35], vcc
    v_cmp_gt_u32 vcc, 60, v1
    s_waitcnt lgkmcnt(0)
    s_barrier
    ds_read_b32 v3, v3 offset:4096
    ds_read_b32 v4, v4 offset:4096
    s_waitcnt lgkmcnt(1)
    v_and_b32 v3, 63, v3
    v_mad_u32_u24 v3, v3, 48, v114
    ds_read_b32 v116, v3 offset:0
    s_waitcnt lgkmcnt(1)
    v_lshrrev_b32 v4, 6, v4
    v_cndmask_b32 v118, 0, v4, s[34:35]
    s_waitcnt lgkmcnt(0)
    v_cndmask_b32 v116, 0, v116, vcc
    v_mov_b32 v117, v116
    s_nop 0
    s_nop 0
    v_add_u32_dpp v117, v117, v117 row_shr:1 row_mask:0xf bank_mask:0xf
    v_add_u32_dpp v118, v118, v118 row_shr:1 row_mask:0xf bank_mask:0xf
    s_nop 0
    v_add_u32_dpp v117, v117, v117 row_shr:2 row_mask:0xf bank_mask:0xf
    v_add_u32_dpp v118, v118, v118 row_shr:2 row_mask:0xf bank_mask:0xf
    s_nop 0
    v_add_u32_dpp v117, v117, v117 row_shr:4 row_mask:0xf bank_mask:0xf
    v_add_u32_dpp v118, v118, v118 row_shr:4 row_mask:0xf bank_mask:0xf
    s_nop 0
    v_add_u32_dpp v117, v117, v117 row_shr:8 row_mask:0xf bank_mask:0xf
    v_add_u32_dpp v118, v118, v118 row_shr:8 row_mask:0xf bank_mask:0xf
    s_nop 0
    v_add_u32_dpp v117, v117, v117 row_bcast:15 row_mask:0xa bank_mask:0xf
    v_add_u32_dpp v118, v118, v118 row_bcast:15 row_mask:0xa bank_mask:0xf
    s_nop 0
    v_add_u32_dpp v117, v117, v117 row_bcast:31 row_mask:0xc bank_mask:0xf
    v_add_u32_dpp v118, v118, v118 row_bcast:31 row_mask:0xc bank_mask:0xf
    v_sub_u32 v116, v117, v116
    v_readlane_b32 s29, v118, 63
    v_readlane_b32 s18, v117, 63
    s_min_u32 s25, s25, 157
    s_lshl_b32 s26, s29, 4
    s_add_u32 s26, s26, 81920
    v_lshl_add_u32 v116, v116, 4, s26
    v_lshlrev_b32 v4, 3, v115
    v_lshl_or_b32 v116, v116, 8, v4
    s_mov_b64 exec, vcc
    ds_write_b32 v3, v116 offset:4608
    s_mov_b64 exec, -1
    s_min_u32 s18, s18, 2048
    v_lshl_add_u32 v230, v234, 4, s26
    v_and_b32 v2, 3, v1
    v_bfe_u32 v3, v1, 3, 2
    v_lshl_add_u32 v2, v3, 2, v2
    v_lshl_add_u32 v231, v2, 4, s26
    s_lshl_b32 s26, s16, 13
    v_lshl_add_u32 v5, v1, 5, s26
    s_movk_i32 s27, 0xff
    s_waitcnt lgkmcnt(0)
    s_barrier
    s_mov_b64 exec, s[36:37]
    ds_read_b32 v96, v83 offset:4608
    s_mov_b64 exec, s[38:39]
    ds_read_b32 v97, v87 offset:4608
    s_mov_b64 exec, s[40:41]
    ds_read_b32 v98, v91 offset:4608
    s_mov_b64 exec, s[42:43]
    ds_read_b32 v99, v95 offset:4608
    s_waitcnt lgkmcnt(0)
    s_mov_b64 exec, s[36:37]
    v_bfi_b32 v82, s27, v96, v82
    v_lshrrev_b32 v96, 8, v96
    v_add_u32 v83, 0, v5
    v_lshl_add_u32 v96, v108, 4, v96
    ds_write_b128 v96, v[80:83]
    s_mov_b64 exec, s[38:39]
    v_bfi_b32 v86, s27, v97, v86
    v_lshrrev_b32 v97, 8, v97
    v_add_u32 v87, 2048, v5
    v_lshl_add_u32 v97, v109, 4, v97
    ds_write_b128 v97, v[84:87]
    s_mov_b64 exec, s[40:41]
    v_bfi_b32 v90, s27, v98, v90
    v_lshrrev_b32 v98, 8, v98
    v_add_u32 v91, 4096, v5
    v_lshl_add_u32 v98, v110, 4, v98
    ds_write_b128 v98, v[88:91]
    s_mov_b64 exec, s[42:43]
    v_bfi_b32 v94, s27, v99, v94
    v_lshrrev_b32 v99, 8, v99
    v_add_u32 v95, 6144, v5
    v_lshl_add_u32 v99, v111, 4, v99
    ds_write_b128 v99, v[92:95]
    s_mov_b64 exec, -1
    v_cmp_gt_i32 vcc, s18, v234
    v_mov_b32 v4, s32
    s_waitcnt lgkmcnt(0)
    s_barrier
    ds_read_b128 v[224:227], v230
    ds_read_b32 v229, v231 offset:12
    s_waitcnt lgkmcnt(0)
    v_cndmask_b32 v228, v4, v226, vcc
    v_and_or_b32 v229, v229, s33, v233
    v_readlane_b32 s64, v228, 0
    v_readlane_b32 s65, v228, 4
    v_readlane_b32 s66, v228, 8
    v_readlane_b32 s67, v228, 12
    v_readlane_b32 s68, v228, 16
    v_readlane_b32 s69, v228, 20
    v_readlane_b32 s70, v228, 24
    v_readlane_b32 s71, v228, 28
    s_and_b32 s80, s64, s31
    buffer_load_dwordx4 v[48:51], v232, s[4:7], s80 offen
    s_and_b32 s81, s65, s31
    buffer_load_dwordx4 v[52:55], v232, s[4:7], s81 offen
    s_and_b32 s82, s66, s31
    buffer_load_dwordx4 v[56:59], v232, s[4:7], s82 offen
    s_and_b32 s83, s67, s31
    buffer_load_dwordx4 v[60:63], v232, s[4:7], s83 offen
    s_waitcnt vmcnt(4)
    s_barrier
    s_mov_b64 exec, s[20:21]
    ds_read_b128 v[192:195], v229 offset:16384
    s_mov_b64 exec, s[22:23]
    ds_read_b128 v[196:199], v229 offset:16384
    s_mov_b64 exec, -1
    s_waitcnt lgkmcnt(0)
    ds_read_b32 v229, v231 offset:268
    v_mfma_f32_32x32x16_bf16 v[80:95], v[192:195], v[200:203], 0
    v_mfma_f32_32x32x16_bf16 v[96:111], v[192:195], v[204:207], 0
    v_mfma_f32_32x32x16_bf16 v[80:95], v[196:199], v[208:211], v[80:95]
    v_mfma_f32_32x32x16_bf16 v[96:111], v[196:199], v[212:215], v[96:111]
    s_and_b32 s80, s68, s31
    buffer_load_dwordx4 v[64:67], v232, s[4:7], s80 offen
    s_and_b32 s81, s69, s31
    buffer_load_dwordx4 v[68:71], v232, s[4:7], s81 offen
    s_and_b32 s82, s70, s31
    buffer_load_dwordx4 v[72:75], v232, s[4:7], s82 offen
    s_and_b32 s83, s71, s31
    buffer_load_dwordx4 v[76:79], v232, s[4:7], s83 offen
    s_waitcnt lgkmcnt(0)
    v_and_or_b32 v229, v229, s33, v233
    s_nop 7
    s_mov_b64 exec, s[20:21]
    ds_read_b128 v[192:195], v229 offset:16384
    s_mov_b64 exec, -1
    s_waitcnt lgkmcnt(0)
    s_mov_b32 s30, s18
L_sb:
    v_mfma_f32_4x4x4_16b_bf16 v[144:147], v[224:225], v[216:217], 0
    v_mfma_f32_4x4x4_16b_bf16 v[148:151], v[224:225], v[218:219], 0
    v_mfma_f32_4x4x4_16b_bf16 v[152:155], v[224:225], v[220:221], 0
    v_mfma_f32_4x4x4_16b_bf16 v[156:159], v[224:225], v[222:223], 0
    v_add_u32 v230, 1024, v230
    s_sub_u32 s26, s30, 64
    v_cmp_gt_i32 s[34:35], s26, v234
    s_cmp_le_i32 s30, 0
    s_nop 0
    v_cvt_pk_bf16_f32 v184, v144, v148
    v_cvt_pk_bf16_f32 v185, v152, v156
    v_cvt_pk_bf16_f32 v186, v145, v149
    v_cvt_pk_bf16_f32 v187, v153, v157
    v_cvt_pk_bf16_f32 v188, v146, v150
    v_cvt_pk_bf16_f32 v189, v154, v158
    v_cvt_pk_bf16_f32 v190, v147, v151
    v_cvt_pk_bf16_f32 v191, v155, v159
    ds_read_b128 v[224:227], v230
    s_cbranch_scc1 L_exit
    s_setprio 3
    s_waitcnt vmcnt(4)
    v_mfma_f32_4x4x4_16b_bf16 v[144:147], v[184:185], v[48:49], 0 cbsz:4 abid:0
    v_exp_f32 v176, v80
    v_mfma_f32_4x4x4_16b_bf16 v[148:151], v[184:185], v[50:51], 0 cbsz:4 abid:0
    v_exp_f32 v180, v96
    v_mfma_f32_4x4x4_16b_bf16 v[152:155], v[184:185], v[52:53], 0 cbsz:4 abid:1
    v_exp_f32 v177, v81
    v_mfma_f32_4x4x4_16b_bf16 v[156:159], v[184:185], v[54:55], 0 cbsz:4 abid:1
    v_exp_f32 v181, v97
    v_mfma_f32_4x4x4_16b_bf16 v[160:163], v[184:185], v[56:57], 0 cbsz:4 abid:2
    v_exp_f32 v178, v82
    v_mfma_f32_4x4x4_16b_bf16 v[164:167], v[184:185], v[58:59], 0 cbsz:4 abid:2
    v_exp_f32 v182, v98
    v_mfma_f32_4x4x4_16b_bf16 v[168:171], v[184:185], v[60:61], 0 cbsz:4 abid:3
    v_exp_f32 v179, v83
    v_mfma_f32_4x4x4_16b_bf16 v[172:175], v[184:185], v[62:63], 0 cbsz:4 abid:3
    v_exp_f32 v183, v99
    v_readlane_b32 s72, v228, 32
    v_readlane_b32 s73, v228, 36
    v_readlane_b32 s74, v228, 40
    v_readlane_b32 s75, v228, 44
    s_and_b32 s80, s72, s31
    v_pk_add_f32 v[176:177], v[176:177], 1.0 op_sel_hi:[1,0]
    s_and_b32 s81, s73, s31
    v_pk_add_f32 v[178:179], v[178:179], 1.0 op_sel_hi:[1,0]
    s_and_b32 s82, s74, s31
    v_pk_add_f32 v[180:181], v[180:181], 1.0 op_sel_hi:[1,0]
    s_and_b32 s83, s75, s31
    v_pk_add_f32 v[182:183], v[182:183], 1.0 op_sel_hi:[1,0]
    v_mfma_f32_32x32x16_bf16 v[112:127], v[192:195], v[200:203], 0
    v_rcp_f32 v176, v176
    v_rcp_f32 v177, v177
    v_rcp_f32 v178, v178
    v_rcp_f32 v179, v179
    v_rcp_f32 v180, v180
    buffer_load_dwordx4 v[48:51], v232, s[4:7], s80 offen
    v_rcp_f32 v181, v181
    buffer_load_dwordx4 v[52:55], v232, s[4:7], s81 offen
    v_rcp_f32 v182, v182
    buffer_load_dwordx4 v[56:59], v232, s[4:7], s82 offen
    v_rcp_f32 v183, v183
    buffer_load_dwordx4 v[60:63], v232, s[4:7], s83 offen
    s_cmp_le_i32 s30, 4
    s_mov_b64 exec, s[22:23]
    ds_read_b128 v[196:199], v229 offset:16384
    s_mov_b64 exec, -1
    ds_read_b32 v2, v231 offset:524
    v_pk_mul_f32 v[176:177], v[176:177], v[80:81]
    v_pk_mul_f32 v[178:179], v[178:179], v[82:83]
    v_pk_mul_f32 v[180:181], v[180:181], v[96:97]
    v_pk_mul_f32 v[182:183], v[182:183], v[98:99]
    s_set_gpr_idx_on s64, gpr_idx(SRC2,DST)
    v_pk_fma_f32 v[8:9], v[176:177], v[144:145], v[8:9] op_sel:[0,0,0] op_sel_hi:[0,1,1]
    v_pk_fma_f32 v[10:11], v[176:177], v[146:147], v[10:11] op_sel:[0,0,0] op_sel_hi:[0,1,1]
    v_pk_fma_f32 v[12:13], v[180:181], v[148:149], v[12:13] op_sel:[0,0,0] op_sel_hi:[0,1,1]
    v_pk_fma_f32 v[14:15], v[180:181], v[150:151], v[14:15] op_sel:[0,0,0] op_sel_hi:[0,1,1]
    s_set_gpr_idx_idx s65
    v_pk_fma_f32 v[8:9], v[176:177], v[152:153], v[8:9] op_sel:[1,0,0] op_sel_hi:[1,1,1]
    v_pk_fma_f32 v[10:11], v[176:177], v[154:155], v[10:11] op_sel:[1,0,0] op_sel_hi:[1,1,1]
    v_pk_fma_f32 v[12:13], v[180:181], v[156:157], v[12:13] op_sel:[1,0,0] op_sel_hi:[1,1,1]
    v_pk_fma_f32 v[14:15], v[180:181], v[158:159], v[14:15] op_sel:[1,0,0] op_sel_hi:[1,1,1]
    s_set_gpr_idx_idx s66
    v_pk_fma_f32 v[8:9], v[178:179], v[160:161], v[8:9] op_sel:[0,0,0] op_sel_hi:[0,1,1]
    v_pk_fma_f32 v[10:11], v[178:179], v[162:163], v[10:11] op_sel:[0,0,0] op_sel_hi:[0,1,1]
    v_pk_fma_f32 v[12:13], v[182:183], v[164:165], v[12:13] op_sel:[0,0,0] op_sel_hi:[0,1,1]
    v_pk_fma_f32 v[14:15], v[182:183], v[166:167], v[14:15] op_sel:[0,0,0] op_sel_hi:[0,1,1]
    s_set_gpr_idx_idx s67
    v_pk_fma_f32 v[8:9], v[178:179], v[168:169], v[8:9] op_sel:[1,0,0] op_sel_hi:[1,1,1]
    v_pk_fma_f32 v[10:11], v[178:179], v[170:171], v[10:11] op_sel:[1,0,0] op_sel_hi:[1,1,1]
    v_pk_fma_f32 v[12:13], v[182:183], v[172:173], v[12:13] op_sel:[1,0,0] op_sel_hi:[1,1,1]
    v_pk_fma_f32 v[14:15], v[182:183], v[174:175], v[14:15] op_sel:[1,0,0] op_sel_hi:[1,1,1]
    s_set_gpr_idx_off
    s_cbranch_scc1 L_exit
    s_waitcnt vmcnt(4)
    v_mfma_f32_4x4x4_16b_bf16 v[144:147], v[184:185], v[64:65], 0 cbsz:4 abid:4
    v_exp_f32 v176, v84
    v_mfma_f32_4x4x4_16b_bf16 v[148:151], v[184:185], v[66:67], 0 cbsz:4 abid:4
    v_exp_f32 v180, v100
    v_mfma_f32_4x4x4_16b_bf16 v[152:155], v[184:185], v[68:69], 0 cbsz:4 abid:5
    v_exp_f32 v177, v85
    v_mfma_f32_4x4x4_16b_bf16 v[156:159], v[184:185], v[70:71], 0 cbsz:4 abid:5
    v_exp_f32 v181, v101
    v_mfma_f32_4x4x4_16b_bf16 v[160:163], v[184:185], v[72:73], 0 cbsz:4 abid:6
    v_exp_f32 v178, v86
    v_mfma_f32_4x4x4_16b_bf16 v[164:167], v[184:185], v[74:75], 0 cbsz:4 abid:6
    v_exp_f32 v182, v102
    v_mfma_f32_4x4x4_16b_bf16 v[168:171], v[184:185], v[76:77], 0 cbsz:4 abid:7
    v_exp_f32 v179, v87
    v_mfma_f32_4x4x4_16b_bf16 v[172:175], v[184:185], v[78:79], 0 cbsz:4 abid:7
    v_exp_f32 v183, v103
    v_readlane_b32 s76, v228, 48
    v_readlane_b32 s77, v228, 52
    v_readlane_b32 s78, v228, 56
    v_readlane_b32 s79, v228, 60
    s_and_b32 s80, s76, s31
    v_pk_add_f32 v[176:177], v[176:177], 1.0 op_sel_hi:[1,0]
    s_and_b32 s81, s77, s31
    v_pk_add_f32 v[178:179], v[178:179], 1.0 op_sel_hi:[1,0]
    s_and_b32 s82, s78, s31
    v_pk_add_f32 v[180:181], v[180:181], 1.0 op_sel_hi:[1,0]
    s_and_b32 s83, s79, s31
    v_pk_add_f32 v[182:183], v[182:183], 1.0 op_sel_hi:[1,0]
    v_mfma_f32_32x32x16_bf16 v[128:143], v[192:195], v[204:207], 0
    v_rcp_f32 v176, v176
    v_rcp_f32 v177, v177
    v_rcp_f32 v178, v178
    v_rcp_f32 v179, v179
    v_rcp_f32 v180, v180
    buffer_load_dwordx4 v[64:67], v232, s[4:7], s80 offen
    v_rcp_f32 v181, v181
    buffer_load_dwordx4 v[68:71], v232, s[4:7], s81 offen
    v_rcp_f32 v182, v182
    buffer_load_dwordx4 v[72:75], v232, s[4:7], s82 offen
    v_rcp_f32 v183, v183
    buffer_load_dwordx4 v[76:79], v232, s[4:7], s83 offen
    s_cmp_le_i32 s30, 8
    s_waitcnt lgkmcnt(0)
    v_pk_mul_f32 v[176:177], v[176:177], v[84:85]
    v_pk_mul_f32 v[178:179], v[178:179], v[86:87]
    v_pk_mul_f32 v[180:181], v[180:181], v[100:101]
    v_pk_mul_f32 v[182:183], v[182:183], v[102:103]
    s_set_gpr_idx_on s68, gpr_idx(SRC2,DST)
    v_pk_fma_f32 v[8:9], v[176:177], v[144:145], v[8:9] op_sel:[0,0,0] op_sel_hi:[0,1,1]
    v_pk_fma_f32 v[10:11], v[176:177], v[146:147], v[10:11] op_sel:[0,0,0] op_sel_hi:[0,1,1]
    v_pk_fma_f32 v[12:13], v[180:181], v[148:149], v[12:13] op_sel:[0,0,0] op_sel_hi:[0,1,1]
    v_pk_fma_f32 v[14:15], v[180:181], v[150:151], v[14:15] op_sel:[0,0,0] op_sel_hi:[0,1,1]
    s_set_gpr_idx_idx s69
    v_pk_fma_f32 v[8:9], v[176:177], v[152:153], v[8:9] op_sel:[1,0,0] op_sel_hi:[1,1,1]
    v_pk_fma_f32 v[10:11], v[176:177], v[154:155], v[10:11] op_sel:[1,0,0] op_sel_hi:[1,1,1]
    v_pk_fma_f32 v[12:13], v[180:181], v[156:157], v[12:13] op_sel:[1,0,0] op_sel_hi:[1,1,1]
    v_pk_fma_f32 v[14:15], v[180:181], v[158:159], v[14:15] op_sel:[1,0,0] op_sel_hi:[1,1,1]
    s_set_gpr_idx_idx s70
    v_pk_fma_f32 v[8:9], v[178:179], v[160:161], v[8:9] op_sel:[0,0,0] op_sel_hi:[0,1,1]
    v_pk_fma_f32 v[10:11], v[178:179], v[162:163], v[10:11] op_sel:[0,0,0] op_sel_hi:[0,1,1]
    v_pk_fma_f32 v[12:13], v[182:183], v[164:165], v[12:13] op_sel:[0,0,0] op_sel_hi:[0,1,1]
    v_pk_fma_f32 v[14:15], v[182:183], v[166:167], v[14:15] op_sel:[0,0,0] op_sel_hi:[0,1,1]
    s_set_gpr_idx_idx s71
    v_pk_fma_f32 v[8:9], v[178:179], v[168:169], v[8:9] op_sel:[1,0,0] op_sel_hi:[1,1,1]
    v_pk_fma_f32 v[10:11], v[178:179], v[170:171], v[10:11] op_sel:[1,0,0] op_sel_hi:[1,1,1]
    v_pk_fma_f32 v[12:13], v[182:183], v[172:173], v[12:13] op_sel:[1,0,0] op_sel_hi:[1,1,1]
    v_pk_fma_f32 v[14:15], v[182:183], v[174:175], v[14:15] op_sel:[1,0,0] op_sel_hi:[1,1,1]
    s_set_gpr_idx_off
    s_cbranch_scc1 L_exit
    s_setprio 2
    s_waitcnt vmcnt(4)
    v_mfma_f32_4x4x4_16b_bf16 v[144:147], v[184:185], v[48:49], 0 cbsz:4 abid:8
    v_exp_f32 v176, v88
    v_mfma_f32_4x4x4_16b_bf16 v[148:151], v[184:185], v[50:51], 0 cbsz:4 abid:8
    v_exp_f32 v180, v104
    v_mfma_f32_4x4x4_16b_bf16 v[152:155], v[184:185], v[52:53], 0 cbsz:4 abid:9
    v_exp_f32 v177, v89
    v_mfma_f32_4x4x4_16b_bf16 v[156:159], v[184:185], v[54:55], 0 cbsz:4 abid:9
    v_exp_f32 v181, v105
    v_mfma_f32_4x4x4_16b_bf16 v[160:163], v[184:185], v[56:57], 0 cbsz:4 abid:10
    v_exp_f32 v178, v90
    v_mfma_f32_4x4x4_16b_bf16 v[164:167], v[184:185], v[58:59], 0 cbsz:4 abid:10
    v_exp_f32 v182, v106
    v_mfma_f32_4x4x4_16b_bf16 v[168:171], v[184:185], v[60:61], 0 cbsz:4 abid:11
    v_exp_f32 v179, v91
    v_mfma_f32_4x4x4_16b_bf16 v[172:175], v[184:185], v[62:63], 0 cbsz:4 abid:11
    v_exp_f32 v183, v107
    v_readlane_b32 s64, v228, 1
    v_readlane_b32 s65, v228, 5
    v_readlane_b32 s66, v228, 9
    v_readlane_b32 s67, v228, 13
    v_and_or_b32 v229, v2, s33, v233
    s_and_b32 s80, s64, s31
    v_pk_add_f32 v[176:177], v[176:177], 1.0 op_sel_hi:[1,0]
    s_and_b32 s81, s65, s31
    v_pk_add_f32 v[178:179], v[178:179], 1.0 op_sel_hi:[1,0]
    s_and_b32 s82, s66, s31
    v_pk_add_f32 v[180:181], v[180:181], 1.0 op_sel_hi:[1,0]
    s_and_b32 s83, s67, s31
    v_pk_add_f32 v[182:183], v[182:183], 1.0 op_sel_hi:[1,0]
    v_mfma_f32_32x32x16_bf16 v[112:127], v[196:199], v[208:211], v[112:127]
    v_rcp_f32 v176, v176
    v_rcp_f32 v177, v177
    v_rcp_f32 v178, v178
    v_rcp_f32 v179, v179
    v_rcp_f32 v180, v180
    buffer_load_dwordx4 v[48:51], v232, s[4:7], s80 offen
    v_rcp_f32 v181, v181
    buffer_load_dwordx4 v[52:55], v232, s[4:7], s81 offen
    v_rcp_f32 v182, v182
    buffer_load_dwordx4 v[56:59], v232, s[4:7], s82 offen
    v_rcp_f32 v183, v183
    buffer_load_dwordx4 v[60:63], v232, s[4:7], s83 offen
    s_cmp_le_i32 s30, 12
    s_mov_b64 exec, s[20:21]
    ds_read_b128 v[192:195], v229 offset:16384
    s_mov_b64 exec, -1
    v_pk_mul_f32 v[176:177], v[176:177], v[88:89]
    v_pk_mul_f32 v[178:179], v[178:179], v[90:91]
    v_pk_mul_f32 v[180:181], v[180:181], v[104:105]
    v_pk_mul_f32 v[182:183], v[182:183], v[106:107]
    s_set_gpr_idx_on s72, gpr_idx(SRC2,DST)
    v_pk_fma_f32 v[8:9], v[176:177], v[144:145], v[8:9] op_sel:[0,0,0] op_sel_hi:[0,1,1]
    v_pk_fma_f32 v[10:11], v[176:177], v[146:147], v[10:11] op_sel:[0,0,0] op_sel_hi:[0,1,1]
    v_pk_fma_f32 v[12:13], v[180:181], v[148:149], v[12:13] op_sel:[0,0,0] op_sel_hi:[0,1,1]
    v_pk_fma_f32 v[14:15], v[180:181], v[150:151], v[14:15] op_sel:[0,0,0] op_sel_hi:[0,1,1]
    s_set_gpr_idx_idx s73
    v_pk_fma_f32 v[8:9], v[176:177], v[152:153], v[8:9] op_sel:[1,0,0] op_sel_hi:[1,1,1]
    v_pk_fma_f32 v[10:11], v[176:177], v[154:155], v[10:11] op_sel:[1,0,0] op_sel_hi:[1,1,1]
    v_pk_fma_f32 v[12:13], v[180:181], v[156:157], v[12:13] op_sel:[1,0,0] op_sel_hi:[1,1,1]
    v_pk_fma_f32 v[14:15], v[180:181], v[158:159], v[14:15] op_sel:[1,0,0] op_sel_hi:[1,1,1]
    s_set_gpr_idx_idx s74
    v_pk_fma_f32 v[8:9], v[178:179], v[160:161], v[8:9] op_sel:[0,0,0] op_sel_hi:[0,1,1]
    v_pk_fma_f32 v[10:11], v[178:179], v[162:163], v[10:11] op_sel:[0,0,0] op_sel_hi:[0,1,1]
    v_pk_fma_f32 v[12:13], v[182:183], v[164:165], v[12:13] op_sel:[0,0,0] op_sel_hi:[0,1,1]
    v_pk_fma_f32 v[14:15], v[182:183], v[166:167], v[14:15] op_sel:[0,0,0] op_sel_hi:[0,1,1]
    s_set_gpr_idx_idx s75
    v_pk_fma_f32 v[8:9], v[178:179], v[168:169], v[8:9] op_sel:[1,0,0] op_sel_hi:[1,1,1]
    v_pk_fma_f32 v[10:11], v[178:179], v[170:171], v[10:11] op_sel:[1,0,0] op_sel_hi:[1,1,1]
    v_pk_fma_f32 v[12:13], v[182:183], v[172:173], v[12:13] op_sel:[1,0,0] op_sel_hi:[1,1,1]
    v_pk_fma_f32 v[14:15], v[182:183], v[174:175], v[14:15] op_sel:[1,0,0] op_sel_hi:[1,1,1]
    s_set_gpr_idx_off
    s_cbranch_scc1 L_exit
    s_waitcnt vmcnt(4)
    v_mfma_f32_4x4x4_16b_bf16 v[144:147], v[184:185], v[64:65], 0 cbsz:4 abid:12
    v_exp_f32 v176, v92
    v_mfma_f32_4x4x4_16b_bf16 v[148:151], v[184:185], v[66:67], 0 cbsz:4 abid:12
    v_exp_f32 v180, v108
    v_mfma_f32_4x4x4_16b_bf16 v[152:155], v[184:185], v[68:69], 0 cbsz:4 abid:13
    v_exp_f32 v177, v93
    v_mfma_f32_4x4x4_16b_bf16 v[156:159], v[184:185], v[70:71], 0 cbsz:4 abid:13
    v_exp_f32 v181, v109
    v_mfma_f32_4x4x4_16b_bf16 v[160:163], v[184:185], v[72:73], 0 cbsz:4 abid:14
    v_exp_f32 v178, v94
    v_mfma_f32_4x4x4_16b_bf16 v[164:167], v[184:185], v[74:75], 0 cbsz:4 abid:14
    v_exp_f32 v182, v110
    v_mfma_f32_4x4x4_16b_bf16 v[168:171], v[184:185], v[76:77], 0 cbsz:4 abid:15
    v_exp_f32 v179, v95
    v_mfma_f32_4x4x4_16b_bf16 v[172:175], v[184:185], v[78:79], 0 cbsz:4 abid:15
    v_exp_f32 v183, v111
    v_readlane_b32 s68, v228, 17
    v_readlane_b32 s69, v228, 21
    v_readlane_b32 s70, v228, 25
    v_readlane_b32 s71, v228, 29
    s_and_b32 s80, s68, s31
    v_pk_add_f32 v[176:177], v[176:177], 1.0 op_sel_hi:[1,0]
    s_and_b32 s81, s69, s31
    v_pk_add_f32 v[178:179], v[178:179], 1.0 op_sel_hi:[1,0]
    s_and_b32 s82, s70, s31
    v_pk_add_f32 v[180:181], v[180:181], 1.0 op_sel_hi:[1,0]
    s_and_b32 s83, s71, s31
    v_pk_add_f32 v[182:183], v[182:183], 1.0 op_sel_hi:[1,0]
    v_mfma_f32_32x32x16_bf16 v[128:143], v[196:199], v[212:215], v[128:143]
    v_rcp_f32 v176, v176
    v_rcp_f32 v177, v177
    v_rcp_f32 v178, v178
    v_rcp_f32 v179, v179
    v_rcp_f32 v180, v180
    buffer_load_dwordx4 v[64:67], v232, s[4:7], s80 offen
    v_rcp_f32 v181, v181
    buffer_load_dwordx4 v[68:71], v232, s[4:7], s81 offen
    v_rcp_f32 v182, v182
    buffer_load_dwordx4 v[72:75], v232, s[4:7], s82 offen
    v_rcp_f32 v183, v183
    buffer_load_dwordx4 v[76:79], v232, s[4:7], s83 offen
    s_cmp_le_i32 s30, 16
    s_waitcnt lgkmcnt(0)
    v_pk_mul_f32 v[176:177], v[176:177], v[92:93]
    v_pk_mul_f32 v[178:179], v[178:179], v[94:95]
    v_pk_mul_f32 v[180:181], v[180:181], v[108:109]
    v_pk_mul_f32 v[182:183], v[182:183], v[110:111]
    s_set_gpr_idx_on s76, gpr_idx(SRC2,DST)
    v_pk_fma_f32 v[8:9], v[176:177], v[144:145], v[8:9] op_sel:[0,0,0] op_sel_hi:[0,1,1]
    v_pk_fma_f32 v[10:11], v[176:177], v[146:147], v[10:11] op_sel:[0,0,0] op_sel_hi:[0,1,1]
    v_pk_fma_f32 v[12:13], v[180:181], v[148:149], v[12:13] op_sel:[0,0,0] op_sel_hi:[0,1,1]
    v_pk_fma_f32 v[14:15], v[180:181], v[150:151], v[14:15] op_sel:[0,0,0] op_sel_hi:[0,1,1]
    s_set_gpr_idx_idx s77
    v_pk_fma_f32 v[8:9], v[176:177], v[152:153], v[8:9] op_sel:[1,0,0] op_sel_hi:[1,1,1]
    v_pk_fma_f32 v[10:11], v[176:177], v[154:155], v[10:11] op_sel:[1,0,0] op_sel_hi:[1,1,1]
    v_pk_fma_f32 v[12:13], v[180:181], v[156:157], v[12:13] op_sel:[1,0,0] op_sel_hi:[1,1,1]
    v_pk_fma_f32 v[14:15], v[180:181], v[158:159], v[14:15] op_sel:[1,0,0] op_sel_hi:[1,1,1]
    s_set_gpr_idx_idx s78
    v_pk_fma_f32 v[8:9], v[178:179], v[160:161], v[8:9] op_sel:[0,0,0] op_sel_hi:[0,1,1]
    v_pk_fma_f32 v[10:11], v[178:179], v[162:163], v[10:11] op_sel:[0,0,0] op_sel_hi:[0,1,1]
    v_pk_fma_f32 v[12:13], v[182:183], v[164:165], v[12:13] op_sel:[0,0,0] op_sel_hi:[0,1,1]
    v_pk_fma_f32 v[14:15], v[182:183], v[166:167], v[14:15] op_sel:[0,0,0] op_sel_hi:[0,1,1]
    s_set_gpr_idx_idx s79
    v_pk_fma_f32 v[8:9], v[178:179], v[168:169], v[8:9] op_sel:[1,0,0] op_sel_hi:[1,1,1]
    v_pk_fma_f32 v[10:11], v[178:179], v[170:171], v[10:11] op_sel:[1,0,0] op_sel_hi:[1,1,1]
    v_pk_fma_f32 v[12:13], v[182:183], v[172:173], v[12:13] op_sel:[1,0,0] op_sel_hi:[1,1,1]
    v_pk_fma_f32 v[14:15], v[182:183], v[174:175], v[14:15] op_sel:[1,0,0] op_sel_hi:[1,1,1]
    s_set_gpr_idx_off
    s_cbranch_scc1 L_exit
    s_setprio 1
    s_waitcnt vmcnt(4)
    v_mfma_f32_4x4x4_16b_bf16 v[144:147], v[186:187], v[48:49], 0 cbsz:4 abid:0
    v_exp_f32 v176, v112
    v_mfma_f32_4x4x4_16b_bf16 v[148:151], v[186:187], v[50:51], 0 cbsz:4 abid:0
    v_exp_f32 v180, v128
    v_mfma_f32_4x4x4_16b_bf16 v[152:155], v[186:187], v[52:53], 0 cbsz:4 abid:1
    v_exp_f32 v177, v113
    v_mfma_f32_4x4x4_16b_bf16 v[156:159], v[186:187], v[54:55], 0 cbsz:4 abid:1
    v_exp_f32 v181, v129
    v_mfma_f32_4x4x4_16b_bf16 v[160:163], v[186:187], v[56:57], 0 cbsz:4 abid:2
    v_exp_f32 v178, v114
    v_mfma_f32_4x4x4_16b_bf16 v[164:167], v[186:187], v[58:59], 0 cbsz:4 abid:2
    v_exp_f32 v182, v130
    v_mfma_f32_4x4x4_16b_bf16 v[168:171], v[186:187], v[60:61], 0 cbsz:4 abid:3
    v_exp_f32 v179, v115
    v_mfma_f32_4x4x4_16b_bf16 v[172:175], v[186:187], v[62:63], 0 cbsz:4 abid:3
    v_exp_f32 v183, v131
    v_readlane_b32 s72, v228, 33
    v_readlane_b32 s73, v228, 37
    v_readlane_b32 s74, v228, 41
    v_readlane_b32 s75, v228, 45
    s_and_b32 s80, s72, s31
    v_pk_add_f32 v[176:177], v[176:177], 1.0 op_sel_hi:[1,0]
    s_and_b32 s81, s73, s31
    v_pk_add_f32 v[178:179], v[178:179], 1.0 op_sel_hi:[1,0]
    s_and_b32 s82, s74, s31
    v_pk_add_f32 v[180:181], v[180:181], 1.0 op_sel_hi:[1,0]
    s_and_b32 s83, s75, s31
    v_pk_add_f32 v[182:183], v[182:183], 1.0 op_sel_hi:[1,0]
    v_mfma_f32_32x32x16_bf16 v[80:95], v[192:195], v[200:203], 0
    v_rcp_f32 v176, v176
    v_rcp_f32 v177, v177
    v_rcp_f32 v178, v178
    v_rcp_f32 v179, v179
    v_rcp_f32 v180, v180
    buffer_load_dwordx4 v[48:51], v232, s[4:7], s80 offen
    v_rcp_f32 v181, v181
    buffer_load_dwordx4 v[52:55], v232, s[4:7], s81 offen
    v_rcp_f32 v182, v182
    buffer_load_dwordx4 v[56:59], v232, s[4:7], s82 offen
    v_rcp_f32 v183, v183
    buffer_load_dwordx4 v[60:63], v232, s[4:7], s83 offen
    s_cmp_le_i32 s30, 20
    s_mov_b64 exec, s[22:23]
    ds_read_b128 v[196:199], v229 offset:16384
    s_mov_b64 exec, -1
    ds_read_b32 v2, v231 offset:780
    v_pk_mul_f32 v[176:177], v[176:177], v[112:113]
    v_pk_mul_f32 v[178:179], v[178:179], v[114:115]
    v_pk_mul_f32 v[180:181], v[180:181], v[128:129]
    v_pk_mul_f32 v[182:183], v[182:183], v[130:131]
    s_set_gpr_idx_on s64, gpr_idx(SRC2,DST)
    v_pk_fma_f32 v[8:9], v[176:177], v[144:145], v[8:9] op_sel:[0,0,0] op_sel_hi:[0,1,1]
    v_pk_fma_f32 v[10:11], v[176:177], v[146:147], v[10:11] op_sel:[0,0,0] op_sel_hi:[0,1,1]
    v_pk_fma_f32 v[12:13], v[180:181], v[148:149], v[12:13] op_sel:[0,0,0] op_sel_hi:[0,1,1]
    v_pk_fma_f32 v[14:15], v[180:181], v[150:151], v[14:15] op_sel:[0,0,0] op_sel_hi:[0,1,1]
    s_set_gpr_idx_idx s65
    v_pk_fma_f32 v[8:9], v[176:177], v[152:153], v[8:9] op_sel:[1,0,0] op_sel_hi:[1,1,1]
    v_pk_fma_f32 v[10:11], v[176:177], v[154:155], v[10:11] op_sel:[1,0,0] op_sel_hi:[1,1,1]
    v_pk_fma_f32 v[12:13], v[180:181], v[156:157], v[12:13] op_sel:[1,0,0] op_sel_hi:[1,1,1]
    v_pk_fma_f32 v[14:15], v[180:181], v[158:159], v[14:15] op_sel:[1,0,0] op_sel_hi:[1,1,1]
    s_set_gpr_idx_idx s66
    v_pk_fma_f32 v[8:9], v[178:179], v[160:161], v[8:9] op_sel:[0,0,0] op_sel_hi:[0,1,1]
    v_pk_fma_f32 v[10:11], v[178:179], v[162:163], v[10:11] op_sel:[0,0,0] op_sel_hi:[0,1,1]
    v_pk_fma_f32 v[12:13], v[182:183], v[164:165], v[12:13] op_sel:[0,0,0] op_sel_hi:[0,1,1]
    v_pk_fma_f32 v[14:15], v[182:183], v[166:167], v[14:15] op_sel:[0,0,0] op_sel_hi:[0,1,1]
    s_set_gpr_idx_idx s67
    v_pk_fma_f32 v[8:9], v[178:179], v[168:169], v[8:9] op_sel:[1,0,0] op_sel_hi:[1,1,1]
    v_pk_fma_f32 v[10:11], v[178:179], v[170:171], v[10:11] op_sel:[1,0,0] op_sel_hi:[1,1,1]
    v_pk_fma_f32 v[12:13], v[182:183], v[172:173], v[12:13] op_sel:[1,0,0] op_sel_hi:[1,1,1]
    v_pk_fma_f32 v[14:15], v[182:183], v[174:175], v[14:15] op_sel:[1,0,0] op_sel_hi:[1,1,1]
    s_set_gpr_idx_off
    s_cbranch_scc1 L_exit
    s_waitcnt vmcnt(4)
    v_mfma_f32_4x4x4_16b_bf16 v[144:147], v[186:187], v[64:65], 0 cbsz:4 abid:4
    v_exp_f32 v176, v116
    v_mfma_f32_4x4x4_16b_bf16 v[148:151], v[186:187], v[66:67], 0 cbsz:4 abid:4
    v_exp_f32 v180, v132
    v_mfma_f32_4x4x4_16b_bf16 v[152:155], v[186:187], v[68:69], 0 cbsz:4 abid:5
    v_exp_f32 v177, v117
    v_mfma_f32_4x4x4_16b_bf16 v[156:159], v[186:187], v[70:71], 0 cbsz:4 abid:5
    v_exp_f32 v181, v133
    v_mfma_f32_4x4x4_16b_bf16 v[160:163], v[186:187], v[72:73], 0 cbsz:4 abid:6
    v_exp_f32 v178, v118
    v_mfma_f32_4x4x4_16b_bf16 v[164:167], v[186:187], v[74:75], 0 cbsz:4 abid:6
    v_exp_f32 v182, v134
    v_mfma_f32_4x4x4_16b_bf16 v[168:171], v[186:187], v[76:77], 0 cbsz:4 abid:7
    v_exp_f32 v179, v119
    v_mfma_f32_4x4x4_16b_bf16 v[172:175], v[186:187], v[78:79], 0 cbsz:4 abid:7
    v_exp_f32 v183, v135
    v_readlane_b32 s76, v228, 49
    v_readlane_b32 s77, v228, 53
    v_readlane_b32 s78, v228, 57
    v_readlane_b32 s79, v228, 61
    s_and_b32 s80, s76, s31
    v_pk_add_f32 v[176:177], v[176:177], 1.0 op_sel_hi:[1,0]
    s_and_b32 s81, s77, s31
    v_pk_add_f32 v[178:179], v[178:179], 1.0 op_sel_hi:[1,0]
    s_and_b32 s82, s78, s31
    v_pk_add_f32 v[180:181], v[180:181], 1.0 op_sel_hi:[1,0]
    s_and_b32 s83, s79, s31
    v_pk_add_f32 v[182:183], v[182:183], 1.0 op_sel_hi:[1,0]
    v_mfma_f32_32x32x16_bf16 v[96:111], v[192:195], v[204:207], 0
    v_rcp_f32 v176, v176
    v_rcp_f32 v177, v177
    v_rcp_f32 v178, v178
    v_rcp_f32 v179, v179
    v_rcp_f32 v180, v180
    buffer_load_dwordx4 v[64:67], v232, s[4:7], s80 offen
    v_rcp_f32 v181, v181
    buffer_load_dwordx4 v[68:71], v232, s[4:7], s81 offen
    v_rcp_f32 v182, v182
    buffer_load_dwordx4 v[72:75], v232, s[4:7], s82 offen
    v_rcp_f32 v183, v183
    buffer_load_dwordx4 v[76:79], v232, s[4:7], s83 offen
    s_cmp_le_i32 s30, 24
    s_waitcnt lgkmcnt(0)
    v_pk_mul_f32 v[176:177], v[176:177], v[116:117]
    v_pk_mul_f32 v[178:179], v[178:179], v[118:119]
    v_pk_mul_f32 v[180:181], v[180:181], v[132:133]
    v_pk_mul_f32 v[182:183], v[182:183], v[134:135]
    s_set_gpr_idx_on s68, gpr_idx(SRC2,DST)
    v_pk_fma_f32 v[8:9], v[176:177], v[144:145], v[8:9] op_sel:[0,0,0] op_sel_hi:[0,1,1]
    v_pk_fma_f32 v[10:11], v[176:177], v[146:147], v[10:11] op_sel:[0,0,0] op_sel_hi:[0,1,1]
    v_pk_fma_f32 v[12:13], v[180:181], v[148:149], v[12:13] op_sel:[0,0,0] op_sel_hi:[0,1,1]
    v_pk_fma_f32 v[14:15], v[180:181], v[150:151], v[14:15] op_sel:[0,0,0] op_sel_hi:[0,1,1]
    s_set_gpr_idx_idx s69
    v_pk_fma_f32 v[8:9], v[176:177], v[152:153], v[8:9] op_sel:[1,0,0] op_sel_hi:[1,1,1]
    v_pk_fma_f32 v[10:11], v[176:177], v[154:155], v[10:11] op_sel:[1,0,0] op_sel_hi:[1,1,1]
    v_pk_fma_f32 v[12:13], v[180:181], v[156:157], v[12:13] op_sel:[1,0,0] op_sel_hi:[1,1,1]
    v_pk_fma_f32 v[14:15], v[180:181], v[158:159], v[14:15] op_sel:[1,0,0] op_sel_hi:[1,1,1]
    s_set_gpr_idx_idx s70
    v_pk_fma_f32 v[8:9], v[178:179], v[160:161], v[8:9] op_sel:[0,0,0] op_sel_hi:[0,1,1]
    v_pk_fma_f32 v[10:11], v[178:179], v[162:163], v[10:11] op_sel:[0,0,0] op_sel_hi:[0,1,1]
    v_pk_fma_f32 v[12:13], v[182:183], v[164:165], v[12:13] op_sel:[0,0,0] op_sel_hi:[0,1,1]
    v_pk_fma_f32 v[14:15], v[182:183], v[166:167], v[14:15] op_sel:[0,0,0] op_sel_hi:[0,1,1]
    s_set_gpr_idx_idx s71
    v_pk_fma_f32 v[8:9], v[178:179], v[168:169], v[8:9] op_sel:[1,0,0] op_sel_hi:[1,1,1]
    v_pk_fma_f32 v[10:11], v[178:179], v[170:171], v[10:11] op_sel:[1,0,0] op_sel_hi:[1,1,1]
    v_pk_fma_f32 v[12:13], v[182:183], v[172:173], v[12:13] op_sel:[1,0,0] op_sel_hi:[1,1,1]
    v_pk_fma_f32 v[14:15], v[182:183], v[174:175], v[14:15] op_sel:[1,0,0] op_sel_hi:[1,1,1]
    s_set_gpr_idx_off
    s_cbranch_scc1 L_exit
    s_setprio 0
    s_waitcnt vmcnt(4)
    v_mfma_f32_4x4x4_16b_bf16 v[144:147], v[186:187], v[48:49], 0 cbsz:4 abid:8
    v_exp_f32 v176, v120
    v_mfma_f32_4x4x4_16b_bf16 v[148:151], v[186:187], v[50:51], 0 cbsz:4 abid:8
    v_exp_f32 v180, v136
    v_mfma_f32_4x4x4_16b_bf16 v[152:155], v[186:187], v[52:53], 0 cbsz:4 abid:9
    v_exp_f32 v177, v121
    v_mfma_f32_4x4x4_16b_bf16 v[156:159], v[186:187], v[54:55], 0 cbsz:4 abid:9
    v_exp_f32 v181, v137
    v_mfma_f32_4x4x4_16b_bf16 v[160:163], v[186:187], v[56:57], 0 cbsz:4 abid:10
    v_exp_f32 v178, v122
    v_mfma_f32_4x4x4_16b_bf16 v[164:167], v[186:187], v[58:59], 0 cbsz:4 abid:10
    v_exp_f32 v182, v138
    v_mfma_f32_4x4x4_16b_bf16 v[168:171], v[186:187], v[60:61], 0 cbsz:4 abid:11
    v_exp_f32 v179, v123
    v_mfma_f32_4x4x4_16b_bf16 v[172:175], v[186:187], v[62:63], 0 cbsz:4 abid:11
    v_exp_f32 v183, v139
    v_readlane_b32 s64, v228, 2
    v_readlane_b32 s65, v228, 6
    v_readlane_b32 s66, v228, 10
    v_readlane_b32 s67, v228, 14
    v_and_or_b32 v229, v2, s33, v233
    s_and_b32 s80, s64, s31
    v_pk_add_f32 v[176:177], v[176:177], 1.0 op_sel_hi:[1,0]
    s_and_b32 s81, s65, s31
    v_pk_add_f32 v[178:179], v[178:179], 1.0 op_sel_hi:[1,0]
    s_and_b32 s82, s66, s31
    v_pk_add_f32 v[180:181], v[180:181], 1.0 op_sel_hi:[1,0]
    s_and_b32 s83, s67, s31
    v_pk_add_f32 v[182:183], v[182:183], 1.0 op_sel_hi:[1,0]
    v_mfma_f32_32x32x16_bf16 v[80:95], v[196:199], v[208:211], v[80:95]
    v_rcp_f32 v176, v176
    v_rcp_f32 v177, v177
    v_rcp_f32 v178, v178
    v_rcp_f32 v179, v179
    v_rcp_f32 v180, v180
    buffer_load_dwordx4 v[48:51], v232, s[4:7], s80 offen
    v_rcp_f32 v181, v181
    buffer_load_dwordx4 v[52:55], v232, s[4:7], s81 offen
    v_rcp_f32 v182, v182
    buffer_load_dwordx4 v[56:59], v232, s[4:7], s82 offen
    v_rcp_f32 v183, v183
    buffer_load_dwordx4 v[60:63], v232, s[4:7], s83 offen
    s_cmp_le_i32 s30, 28
    s_mov_b64 exec, s[20:21]
    ds_read_b128 v[192:195], v229 offset:16384
    s_mov_b64 exec, -1
    v_pk_mul_f32 v[176:177], v[176:177], v[120:121]
    v_pk_mul_f32 v[178:179], v[178:179], v[122:123]
    v_pk_mul_f32 v[180:181], v[180:181], v[136:137]
    v_pk_mul_f32 v[182:183], v[182:183], v[138:139]
    s_set_gpr_idx_on s72, gpr_idx(SRC2,DST)
    v_pk_fma_f32 v[8:9], v[176:177], v[144:145], v[8:9] op_sel:[0,0,0] op_sel_hi:[0,1,1]
    v_pk_fma_f32 v[10:11], v[176:177], v[146:147], v[10:11] op_sel:[0,0,0] op_sel_hi:[0,1,1]
    v_pk_fma_f32 v[12:13], v[180:181], v[148:149], v[12:13] op_sel:[0,0,0] op_sel_hi:[0,1,1]
    v_pk_fma_f32 v[14:15], v[180:181], v[150:151], v[14:15] op_sel:[0,0,0] op_sel_hi:[0,1,1]
    s_set_gpr_idx_idx s73
    v_pk_fma_f32 v[8:9], v[176:177], v[152:153], v[8:9] op_sel:[1,0,0] op_sel_hi:[1,1,1]
    v_pk_fma_f32 v[10:11], v[176:177], v[154:155], v[10:11] op_sel:[1,0,0] op_sel_hi:[1,1,1]
    v_pk_fma_f32 v[12:13], v[180:181], v[156:157], v[12:13] op_sel:[1,0,0] op_sel_hi:[1,1,1]
    v_pk_fma_f32 v[14:15], v[180:181], v[158:159], v[14:15] op_sel:[1,0,0] op_sel_hi:[1,1,1]
    s_set_gpr_idx_idx s74
    v_pk_fma_f32 v[8:9], v[178:179], v[160:161], v[8:9] op_sel:[0,0,0] op_sel_hi:[0,1,1]
    v_pk_fma_f32 v[10:11], v[178:179], v[162:163], v[10:11] op_sel:[0,0,0] op_sel_hi:[0,1,1]
    v_pk_fma_f32 v[12:13], v[182:183], v[164:165], v[12:13] op_sel:[0,0,0] op_sel_hi:[0,1,1]
    v_pk_fma_f32 v[14:15], v[182:183], v[166:167], v[14:15] op_sel:[0,0,0] op_sel_hi:[0,1,1]
    s_set_gpr_idx_idx s75
    v_pk_fma_f32 v[8:9], v[178:179], v[168:169], v[8:9] op_sel:[1,0,0] op_sel_hi:[1,1,1]
    v_pk_fma_f32 v[10:11], v[178:179], v[170:171], v[10:11] op_sel:[1,0,0] op_sel_hi:[1,1,1]
    v_pk_fma_f32 v[12:13], v[182:183], v[172:173], v[12:13] op_sel:[1,0,0] op_sel_hi:[1,1,1]
    v_pk_fma_f32 v[14:15], v[182:183], v[174:175], v[14:15] op_sel:[1,0,0] op_sel_hi:[1,1,1]
    s_set_gpr_idx_off
    s_cbranch_scc1 L_exit
    s_waitcnt vmcnt(4)
    v_mfma_f32_4x4x4_16b_bf16 v[144:147], v[186:187], v[64:65], 0 cbsz:4 abid:12
    v_exp_f32 v176, v124
    v_mfma_f32_4x4x4_16b_bf16 v[148:151], v[186:187], v[66:67], 0 cbsz:4 abid:12
    v_exp_f32 v180, v140
    v_mfma_f32_4x4x4_16b_bf16 v[152:155], v[186:187], v[68:69], 0 cbsz:4 abid:13
    v_exp_f32 v177, v125
    v_mfma_f32_4x4x4_16b_bf16 v[156:159], v[186:187], v[70:71], 0 cbsz:4 abid:13
    v_exp_f32 v181, v141
    v_mfma_f32_4x4x4_16b_bf16 v[160:163], v[186:187], v[72:73], 0 cbsz:4 abid:14
    v_exp_f32 v178, v126
    v_mfma_f32_4x4x4_16b_bf16 v[164:167], v[186:187], v[74:75], 0 cbsz:4 abid:14
    v_exp_f32 v182, v142
    v_mfma_f32_4x4x4_16b_bf16 v[168:171], v[186:187], v[76:77], 0 cbsz:4 abid:15
    v_exp_f32 v179, v127
    v_mfma_f32_4x4x4_16b_bf16 v[172:175], v[186:187], v[78:79], 0 cbsz:4 abid:15
    v_exp_f32 v183, v143
    v_readlane_b32 s68, v228, 18
    v_readlane_b32 s69, v228, 22
    v_readlane_b32 s70, v228, 26
    v_readlane_b32 s71, v228, 30
    s_and_b32 s80, s68, s31
    v_pk_add_f32 v[176:177], v[176:177], 1.0 op_sel_hi:[1,0]
    s_and_b32 s81, s69, s31
    v_pk_add_f32 v[178:179], v[178:179], 1.0 op_sel_hi:[1,0]
    s_and_b32 s82, s70, s31
    v_pk_add_f32 v[180:181], v[180:181], 1.0 op_sel_hi:[1,0]
    s_and_b32 s83, s71, s31
    v_pk_add_f32 v[182:183], v[182:183], 1.0 op_sel_hi:[1,0]
    v_mfma_f32_32x32x16_bf16 v[96:111], v[196:199], v[212:215], v[96:111]
    v_rcp_f32 v176, v176
    v_rcp_f32 v177, v177
    v_rcp_f32 v178, v178
    v_rcp_f32 v179, v179
    v_rcp_f32 v180, v180
    buffer_load_dwordx4 v[64:67], v232, s[4:7], s80 offen
    v_rcp_f32 v181, v181
    buffer_load_dwordx4 v[68:71], v232, s[4:7], s81 offen
    v_rcp_f32 v182, v182
    buffer_load_dwordx4 v[72:75], v232, s[4:7], s82 offen
    v_rcp_f32 v183, v183
    buffer_load_dwordx4 v[76:79], v232, s[4:7], s83 offen
    s_cmp_le_i32 s30, 32
    s_waitcnt lgkmcnt(0)
    v_pk_mul_f32 v[176:177], v[176:177], v[124:125]
    v_pk_mul_f32 v[178:179], v[178:179], v[126:127]
    v_pk_mul_f32 v[180:181], v[180:181], v[140:141]
    v_pk_mul_f32 v[182:183], v[182:183], v[142:143]
    s_set_gpr_idx_on s76, gpr_idx(SRC2,DST)
    v_pk_fma_f32 v[8:9], v[176:177], v[144:145], v[8:9] op_sel:[0,0,0] op_sel_hi:[0,1,1]
    v_pk_fma_f32 v[10:11], v[176:177], v[146:147], v[10:11] op_sel:[0,0,0] op_sel_hi:[0,1,1]
    v_pk_fma_f32 v[12:13], v[180:181], v[148:149], v[12:13] op_sel:[0,0,0] op_sel_hi:[0,1,1]
    v_pk_fma_f32 v[14:15], v[180:181], v[150:151], v[14:15] op_sel:[0,0,0] op_sel_hi:[0,1,1]
    s_set_gpr_idx_idx s77
    v_pk_fma_f32 v[8:9], v[176:177], v[152:153], v[8:9] op_sel:[1,0,0] op_sel_hi:[1,1,1]
    v_pk_fma_f32 v[10:11], v[176:177], v[154:155], v[10:11] op_sel:[1,0,0] op_sel_hi:[1,1,1]
    v_pk_fma_f32 v[12:13], v[180:181], v[156:157], v[12:13] op_sel:[1,0,0] op_sel_hi:[1,1,1]
    v_pk_fma_f32 v[14:15], v[180:181], v[158:159], v[14:15] op_sel:[1,0,0] op_sel_hi:[1,1,1]
    s_set_gpr_idx_idx s78
    v_pk_fma_f32 v[8:9], v[178:179], v[160:161], v[8:9] op_sel:[0,0,0] op_sel_hi:[0,1,1]
    v_pk_fma_f32 v[10:11], v[178:179], v[162:163], v[10:11] op_sel:[0,0,0] op_sel_hi:[0,1,1]
    v_pk_fma_f32 v[12:13], v[182:183], v[164:165], v[12:13] op_sel:[0,0,0] op_sel_hi:[0,1,1]
    v_pk_fma_f32 v[14:15], v[182:183], v[166:167], v[14:15] op_sel:[0,0,0] op_sel_hi:[0,1,1]
    s_set_gpr_idx_idx s79
    v_pk_fma_f32 v[8:9], v[178:179], v[168:169], v[8:9] op_sel:[1,0,0] op_sel_hi:[1,1,1]
    v_pk_fma_f32 v[10:11], v[178:179], v[170:171], v[10:11] op_sel:[1,0,0] op_sel_hi:[1,1,1]
    v_pk_fma_f32 v[12:13], v[182:183], v[172:173], v[12:13] op_sel:[1,0,0] op_sel_hi:[1,1,1]
    v_pk_fma_f32 v[14:15], v[182:183], v[174:175], v[14:15] op_sel:[1,0,0] op_sel_hi:[1,1,1]
    s_set_gpr_idx_off
    s_cbranch_scc1 L_exit
    s_setprio 3
    s_waitcnt vmcnt(4)
    v_mfma_f32_4x4x4_16b_bf16 v[144:147], v[188:189], v[48:49], 0 cbsz:4 abid:0
    v_exp_f32 v176, v80
    v_mfma_f32_4x4x4_16b_bf16 v[148:151], v[188:189], v[50:51], 0 cbsz:4 abid:0
    v_exp_f32 v180, v96
    v_mfma_f32_4x4x4_16b_bf16 v[152:155], v[188:189], v[52:53], 0 cbsz:4 abid:1
    v_exp_f32 v177, v81
    v_mfma_f32_4x4x4_16b_bf16 v[156:159], v[188:189], v[54:55], 0 cbsz:4 abid:1
    v_exp_f32 v181, v97
    v_mfma_f32_4x4x4_16b_bf16 v[160:163], v[188:189], v[56:57], 0 cbsz:4 abid:2
    v_exp_f32 v178, v82
    v_mfma_f32_4x4x4_16b_bf16 v[164:167], v[188:189], v[58:59], 0 cbsz:4 abid:2
    v_exp_f32 v182, v98
    v_mfma_f32_4x4x4_16b_bf16 v[168:171], v[188:189], v[60:61], 0 cbsz:4 abid:3
    v_exp_f32 v179, v83
    v_mfma_f32_4x4x4_16b_bf16 v[172:175], v[188:189], v[62:63], 0 cbsz:4 abid:3
    v_exp_f32 v183, v99
    v_readlane_b32 s72, v228, 34
    v_readlane_b32 s73, v228, 38
    v_readlane_b32 s74, v228, 42
    v_readlane_b32 s75, v228, 46
    s_and_b32 s80, s72, s31
    v_pk_add_f32 v[176:177], v[176:177], 1.0 op_sel_hi:[1,0]
    s_and_b32 s81, s73, s31
    v_pk_add_f32 v[178:179], v[178:179], 1.0 op_sel_hi:[1,0]
    s_and_b32 s82, s74, s31
    v_pk_add_f32 v[180:181], v[180:181], 1.0 op_sel_hi:[1,0]
    s_and_b32 s83, s75, s31
    v_pk_add_f32 v[182:183], v[182:183], 1.0 op_sel_hi:[1,0]
    v_mfma_f32_32x32x16_bf16 v[112:127], v[192:195], v[200:203], 0
    v_rcp_f32 v176, v176
    v_rcp_f32 v177, v177
    v_rcp_f32 v178, v178
    v_rcp_f32 v179, v179
    v_rcp_f32 v180, v180
    buffer_load_dwordx4 v[48:51], v232, s[4:7], s80 offen
    v_rcp_f32 v181, v181
    buffer_load_dwordx4 v[52:55], v232, s[4:7], s81 offen
    v_rcp_f32 v182, v182
    buffer_load_dwordx4 v[56:59], v232, s[4:7], s82 offen
    v_rcp_f32 v183, v183
    buffer_load_dwordx4 v[60:63], v232, s[4:7], s83 offen
    s_cmp_le_i32 s30, 36
    s_mov_b64 exec, s[22:23]
    ds_read_b128 v[196:199], v229 offset:16384
    s_mov_b64 exec, -1
    ds_read_b32 v2, v231 offset:1036
    v_pk_mul_f32 v[176:177], v[176:177], v[80:81]
    v_pk_mul_f32 v[178:179], v[178:179], v[82:83]
    v_pk_mul_f32 v[180:181], v[180:181], v[96:97]
    v_pk_mul_f32 v[182:183], v[182:183], v[98:99]
    s_set_gpr_idx_on s64, gpr_idx(SRC2,DST)
    v_pk_fma_f32 v[8:9], v[176:177], v[144:145], v[8:9] op_sel:[0,0,0] op_sel_hi:[0,1,1]
    v_pk_fma_f32 v[10:11], v[176:177], v[146:147], v[10:11] op_sel:[0,0,0] op_sel_hi:[0,1,1]
    v_pk_fma_f32 v[12:13], v[180:181], v[148:149], v[12:13] op_sel:[0,0,0] op_sel_hi:[0,1,1]
    v_pk_fma_f32 v[14:15], v[180:181], v[150:151], v[14:15] op_sel:[0,0,0] op_sel_hi:[0,1,1]
    s_set_gpr_idx_idx s65
    v_pk_fma_f32 v[8:9], v[176:177], v[152:153], v[8:9] op_sel:[1,0,0] op_sel_hi:[1,1,1]
    v_pk_fma_f32 v[10:11], v[176:177], v[154:155], v[10:11] op_sel:[1,0,0] op_sel_hi:[1,1,1]
    v_pk_fma_f32 v[12:13], v[180:181], v[156:157], v[12:13] op_sel:[1,0,0] op_sel_hi:[1,1,1]
    v_pk_fma_f32 v[14:15], v[180:181], v[158:159], v[14:15] op_sel:[1,0,0] op_sel_hi:[1,1,1]
    s_set_gpr_idx_idx s66
    v_pk_fma_f32 v[8:9], v[178:179], v[160:161], v[8:9] op_sel:[0,0,0] op_sel_hi:[0,1,1]
    v_pk_fma_f32 v[10:11], v[178:179], v[162:163], v[10:11] op_sel:[0,0,0] op_sel_hi:[0,1,1]
    v_pk_fma_f32 v[12:13], v[182:183], v[164:165], v[12:13] op_sel:[0,0,0] op_sel_hi:[0,1,1]
    v_pk_fma_f32 v[14:15], v[182:183], v[166:167], v[14:15] op_sel:[0,0,0] op_sel_hi:[0,1,1]
    s_set_gpr_idx_idx s67
    v_pk_fma_f32 v[8:9], v[178:179], v[168:169], v[8:9] op_sel:[1,0,0] op_sel_hi:[1,1,1]
    v_pk_fma_f32 v[10:11], v[178:179], v[170:171], v[10:11] op_sel:[1,0,0] op_sel_hi:[1,1,1]
    v_pk_fma_f32 v[12:13], v[182:183], v[172:173], v[12:13] op_sel:[1,0,0] op_sel_hi:[1,1,1]
    v_pk_fma_f32 v[14:15], v[182:183], v[174:175], v[14:15] op_sel:[1,0,0] op_sel_hi:[1,1,1]
    s_set_gpr_idx_off
    s_cbranch_scc1 L_exit
    s_waitcnt vmcnt(4)
    v_mfma_f32_4x4x4_16b_bf16 v[144:147], v[188:189], v[64:65], 0 cbsz:4 abid:4
    v_exp_f32 v176, v84
    v_mfma_f32_4x4x4_16b_bf16 v[148:151], v[188:189], v[66:67], 0 cbsz:4 abid:4
    v_exp_f32 v180, v100
    v_mfma_f32_4x4x4_16b_bf16 v[152:155], v[188:189], v[68:69], 0 cbsz:4 abid:5
    v_exp_f32 v177, v85
    v_mfma_f32_4x4x4_16b_bf16 v[156:159], v[188:189], v[70:71], 0 cbsz:4 abid:5
    v_exp_f32 v181, v101
    v_mfma_f32_4x4x4_16b_bf16 v[160:163], v[188:189], v[72:73], 0 cbsz:4 abid:6
    v_exp_f32 v178, v86
    v_mfma_f32_4x4x4_16b_bf16 v[164:167], v[188:189], v[74:75], 0 cbsz:4 abid:6
    v_exp_f32 v182, v102
    v_mfma_f32_4x4x4_16b_bf16 v[168:171], v[188:189], v[76:77], 0 cbsz:4 abid:7
    v_exp_f32 v179, v87
    v_mfma_f32_4x4x4_16b_bf16 v[172:175], v[188:189], v[78:79], 0 cbsz:4 abid:7
    v_exp_f32 v183, v103
    v_readlane_b32 s76, v228, 50
    v_readlane_b32 s77, v228, 54
    v_readlane_b32 s78, v228, 58
    v_readlane_b32 s79, v228, 62
    s_and_b32 s80, s76, s31
    v_pk_add_f32 v[176:177], v[176:177], 1.0 op_sel_hi:[1,0]
    s_and_b32 s81, s77, s31
    v_pk_add_f32 v[178:179], v[178:179], 1.0 op_sel_hi:[1,0]
    s_and_b32 s82, s78, s31
    v_pk_add_f32 v[180:181], v[180:181], 1.0 op_sel_hi:[1,0]
    s_and_b32 s83, s79, s31
    v_pk_add_f32 v[182:183], v[182:183], 1.0 op_sel_hi:[1,0]
    v_mfma_f32_32x32x16_bf16 v[128:143], v[192:195], v[204:207], 0
    v_rcp_f32 v176, v176
    v_rcp_f32 v177, v177
    v_rcp_f32 v178, v178
    v_rcp_f32 v179, v179
    v_rcp_f32 v180, v180
    buffer_load_dwordx4 v[64:67], v232, s[4:7], s80 offen
    v_rcp_f32 v181, v181
    buffer_load_dwordx4 v[68:71], v232, s[4:7], s81 offen
    v_rcp_f32 v182, v182
    buffer_load_dwordx4 v[72:75], v232, s[4:7], s82 offen
    v_rcp_f32 v183, v183
    buffer_load_dwordx4 v[76:79], v232, s[4:7], s83 offen
    s_cmp_le_i32 s30, 40
    s_waitcnt lgkmcnt(0)
    v_pk_mul_f32 v[176:177], v[176:177], v[84:85]
    v_pk_mul_f32 v[178:179], v[178:179], v[86:87]
    v_pk_mul_f32 v[180:181], v[180:181], v[100:101]
    v_pk_mul_f32 v[182:183], v[182:183], v[102:103]
    s_set_gpr_idx_on s68, gpr_idx(SRC2,DST)
    v_pk_fma_f32 v[8:9], v[176:177], v[144:145], v[8:9] op_sel:[0,0,0] op_sel_hi:[0,1,1]
    v_pk_fma_f32 v[10:11], v[176:177], v[146:147], v[10:11] op_sel:[0,0,0] op_sel_hi:[0,1,1]
    v_pk_fma_f32 v[12:13], v[180:181], v[148:149], v[12:13] op_sel:[0,0,0] op_sel_hi:[0,1,1]
    v_pk_fma_f32 v[14:15], v[180:181], v[150:151], v[14:15] op_sel:[0,0,0] op_sel_hi:[0,1,1]
    s_set_gpr_idx_idx s69
    v_pk_fma_f32 v[8:9], v[176:177], v[152:153], v[8:9] op_sel:[1,0,0] op_sel_hi:[1,1,1]
    v_pk_fma_f32 v[10:11], v[176:177], v[154:155], v[10:11] op_sel:[1,0,0] op_sel_hi:[1,1,1]
    v_pk_fma_f32 v[12:13], v[180:181], v[156:157], v[12:13] op_sel:[1,0,0] op_sel_hi:[1,1,1]
    v_pk_fma_f32 v[14:15], v[180:181], v[158:159], v[14:15] op_sel:[1,0,0] op_sel_hi:[1,1,1]
    s_set_gpr_idx_idx s70
    v_pk_fma_f32 v[8:9], v[178:179], v[160:161], v[8:9] op_sel:[0,0,0] op_sel_hi:[0,1,1]
    v_pk_fma_f32 v[10:11], v[178:179], v[162:163], v[10:11] op_sel:[0,0,0] op_sel_hi:[0,1,1]
    v_pk_fma_f32 v[12:13], v[182:183], v[164:165], v[12:13] op_sel:[0,0,0] op_sel_hi:[0,1,1]
    v_pk_fma_f32 v[14:15], v[182:183], v[166:167], v[14:15] op_sel:[0,0,0] op_sel_hi:[0,1,1]
    s_set_gpr_idx_idx s71
    v_pk_fma_f32 v[8:9], v[178:179], v[168:169], v[8:9] op_sel:[1,0,0] op_sel_hi:[1,1,1]
    v_pk_fma_f32 v[10:11], v[178:179], v[170:171], v[10:11] op_sel:[1,0,0] op_sel_hi:[1,1,1]
    v_pk_fma_f32 v[12:13], v[182:183], v[172:173], v[12:13] op_sel:[1,0,0] op_sel_hi:[1,1,1]
    v_pk_fma_f32 v[14:15], v[182:183], v[174:175], v[14:15] op_sel:[1,0,0] op_sel_hi:[1,1,1]
    s_set_gpr_idx_off
    s_cbranch_scc1 L_exit
    s_setprio 2
    s_waitcnt vmcnt(4)
    v_mfma_f32_4x4x4_16b_bf16 v[144:147], v[188:189], v[48:49], 0 cbsz:4 abid:8
    v_exp_f32 v176, v88
    v_mfma_f32_4x4x4_16b_bf16 v[148:151], v[188:189], v[50:51], 0 cbsz:4 abid:8
    v_exp_f32 v180, v104
    v_mfma_f32_4x4x4_16b_bf16 v[152:155], v[188:189], v[52:53], 0 cbsz:4 abid:9
    v_exp_f32 v177, v89
    v_mfma_f32_4x4x4_16b_bf16 v[156:159], v[188:189], v[54:55], 0 cbsz:4 abid:9
    v_exp_f32 v181, v105
    v_mfma_f32_4x4x4_16b_bf16 v[160:163], v[188:189], v[56:57], 0 cbsz:4 abid:10
    v_exp_f32 v178, v90
    v_mfma_f32_4x4x4_16b_bf16 v[164:167], v[188:189], v[58:59], 0 cbsz:4 abid:10
    v_exp_f32 v182, v106
    v_mfma_f32_4x4x4_16b_bf16 v[168:171], v[188:189], v[60:61], 0 cbsz:4 abid:11
    v_exp_f32 v179, v91
    v_mfma_f32_4x4x4_16b_bf16 v[172:175], v[188:189], v[62:63], 0 cbsz:4 abid:11
    v_exp_f32 v183, v107
    v_readlane_b32 s64, v228, 3
    v_readlane_b32 s65, v228, 7
    v_readlane_b32 s66, v228, 11
    v_readlane_b32 s67, v228, 15
    v_and_or_b32 v229, v2, s33, v233
    s_and_b32 s80, s64, s31
    v_pk_add_f32 v[176:177], v[176:177], 1.0 op_sel_hi:[1,0]
    s_and_b32 s81, s65, s31
    v_pk_add_f32 v[178:179], v[178:179], 1.0 op_sel_hi:[1,0]
    s_and_b32 s82, s66, s31
    v_pk_add_f32 v[180:181], v[180:181], 1.0 op_sel_hi:[1,0]
    s_and_b32 s83, s67, s31
    v_pk_add_f32 v[182:183], v[182:183], 1.0 op_sel_hi:[1,0]
    v_mfma_f32_32x32x16_bf16 v[112:127], v[196:199], v[208:211], v[112:127]
    v_rcp_f32 v176, v176
    v_rcp_f32 v177, v177
    v_rcp_f32 v178, v178
    v_rcp_f32 v179, v179
    v_rcp_f32 v180, v180
    buffer_load_dwordx4 v[48:51], v232, s[4:7], s80 offen
    v_rcp_f32 v181, v181
    buffer_load_dwordx4 v[52:55], v232, s[4:7], s81 offen
    v_rcp_f32 v182, v182
    buffer_load_dwordx4 v[56:59], v232, s[4:7], s82 offen
    v_rcp_f32 v183, v183
    buffer_load_dwordx4 v[60:63], v232, s[4:7], s83 offen
    s_cmp_le_i32 s30, 44
    s_mov_b64 exec, s[20:21]
    ds_read_b128 v[192:195], v229 offset:16384
    s_mov_b64 exec, -1
    v_pk_mul_f32 v[176:177], v[176:177], v[88:89]
    v_pk_mul_f32 v[178:179], v[178:179], v[90:91]
    v_pk_mul_f32 v[180:181], v[180:181], v[104:105]
    v_pk_mul_f32 v[182:183], v[182:183], v[106:107]
    s_set_gpr_idx_on s72, gpr_idx(SRC2,DST)
    v_pk_fma_f32 v[8:9], v[176:177], v[144:145], v[8:9] op_sel:[0,0,0] op_sel_hi:[0,1,1]
    v_pk_fma_f32 v[10:11], v[176:177], v[146:147], v[10:11] op_sel:[0,0,0] op_sel_hi:[0,1,1]
    v_pk_fma_f32 v[12:13], v[180:181], v[148:149], v[12:13] op_sel:[0,0,0] op_sel_hi:[0,1,1]
    v_pk_fma_f32 v[14:15], v[180:181], v[150:151], v[14:15] op_sel:[0,0,0] op_sel_hi:[0,1,1]
    s_set_gpr_idx_idx s73
    v_pk_fma_f32 v[8:9], v[176:177], v[152:153], v[8:9] op_sel:[1,0,0] op_sel_hi:[1,1,1]
    v_pk_fma_f32 v[10:11], v[176:177], v[154:155], v[10:11] op_sel:[1,0,0] op_sel_hi:[1,1,1]
    v_pk_fma_f32 v[12:13], v[180:181], v[156:157], v[12:13] op_sel:[1,0,0] op_sel_hi:[1,1,1]
    v_pk_fma_f32 v[14:15], v[180:181], v[158:159], v[14:15] op_sel:[1,0,0] op_sel_hi:[1,1,1]
    s_set_gpr_idx_idx s74
    v_pk_fma_f32 v[8:9], v[178:179], v[160:161], v[8:9] op_sel:[0,0,0] op_sel_hi:[0,1,1]
    v_pk_fma_f32 v[10:11], v[178:179], v[162:163], v[10:11] op_sel:[0,0,0] op_sel_hi:[0,1,1]
    v_pk_fma_f32 v[12:13], v[182:183], v[164:165], v[12:13] op_sel:[0,0,0] op_sel_hi:[0,1,1]
    v_pk_fma_f32 v[14:15], v[182:183], v[166:167], v[14:15] op_sel:[0,0,0] op_sel_hi:[0,1,1]
    s_set_gpr_idx_idx s75
    v_pk_fma_f32 v[8:9], v[178:179], v[168:169], v[8:9] op_sel:[1,0,0] op_sel_hi:[1,1,1]
    v_pk_fma_f32 v[10:11], v[178:179], v[170:171], v[10:11] op_sel:[1,0,0] op_sel_hi:[1,1,1]
    v_pk_fma_f32 v[12:13], v[182:183], v[172:173], v[12:13] op_sel:[1,0,0] op_sel_hi:[1,1,1]
    v_pk_fma_f32 v[14:15], v[182:183], v[174:175], v[14:15] op_sel:[1,0,0] op_sel_hi:[1,1,1]
    s_set_gpr_idx_off
    s_cbranch_scc1 L_exit
    s_waitcnt vmcnt(4)
    v_mfma_f32_4x4x4_16b_bf16 v[144:147], v[188:189], v[64:65], 0 cbsz:4 abid:12
    v_exp_f32 v176, v92
    v_mfma_f32_4x4x4_16b_bf16 v[148:151], v[188:189], v[66:67], 0 cbsz:4 abid:12
    v_exp_f32 v180, v108
    v_mfma_f32_4x4x4_16b_bf16 v[152:155], v[188:189], v[68:69], 0 cbsz:4 abid:13
    v_exp_f32 v177, v93
    v_mfma_f32_4x4x4_16b_bf16 v[156:159], v[188:189], v[70:71], 0 cbsz:4 abid:13
    v_exp_f32 v181, v109
    v_mfma_f32_4x4x4_16b_bf16 v[160:163], v[188:189], v[72:73], 0 cbsz:4 abid:14
    v_exp_f32 v178, v94
    v_mfma_f32_4x4x4_16b_bf16 v[164:167], v[188:189], v[74:75], 0 cbsz:4 abid:14
    v_exp_f32 v182, v110
    v_mfma_f32_4x4x4_16b_bf16 v[168:171], v[188:189], v[76:77], 0 cbsz:4 abid:15
    v_exp_f32 v179, v95
    v_mfma_f32_4x4x4_16b_bf16 v[172:175], v[188:189], v[78:79], 0 cbsz:4 abid:15
    v_exp_f32 v183, v111
    v_readlane_b32 s68, v228, 19
    v_readlane_b32 s69, v228, 23
    v_readlane_b32 s70, v228, 27
    v_readlane_b32 s71, v228, 31
    s_and_b32 s80, s68, s31
    v_pk_add_f32 v[176:177], v[176:177], 1.0 op_sel_hi:[1,0]
    s_and_b32 s81, s69, s31
    v_pk_add_f32 v[178:179], v[178:179], 1.0 op_sel_hi:[1,0]
    s_and_b32 s82, s70, s31
    v_pk_add_f32 v[180:181], v[180:181], 1.0 op_sel_hi:[1,0]
    s_and_b32 s83, s71, s31
    v_pk_add_f32 v[182:183], v[182:183], 1.0 op_sel_hi:[1,0]
    v_mfma_f32_32x32x16_bf16 v[128:143], v[196:199], v[212:215], v[128:143]
    v_rcp_f32 v176, v176
    v_rcp_f32 v177, v177
    v_rcp_f32 v178, v178
    v_rcp_f32 v179, v179
    v_rcp_f32 v180, v180
    buffer_load_dwordx4 v[64:67], v232, s[4:7], s80 offen
    v_rcp_f32 v181, v181
    buffer_load_dwordx4 v[68:71], v232, s[4:7], s81 offen
    v_rcp_f32 v182, v182
    buffer_load_dwordx4 v[72:75], v232, s[4:7], s82 offen
    v_rcp_f32 v183, v183
    buffer_load_dwordx4 v[76:79], v232, s[4:7], s83 offen
    s_cmp_le_i32 s30, 48
    s_waitcnt lgkmcnt(0)
    v_pk_mul_f32 v[176:177], v[176:177], v[92:93]
    v_pk_mul_f32 v[178:179], v[178:179], v[94:95]
    v_pk_mul_f32 v[180:181], v[180:181], v[108:109]
    v_pk_mul_f32 v[182:183], v[182:183], v[110:111]
    s_set_gpr_idx_on s76, gpr_idx(SRC2,DST)
    v_pk_fma_f32 v[8:9], v[176:177], v[144:145], v[8:9] op_sel:[0,0,0] op_sel_hi:[0,1,1]
    v_pk_fma_f32 v[10:11], v[176:177], v[146:147], v[10:11] op_sel:[0,0,0] op_sel_hi:[0,1,1]
    v_pk_fma_f32 v[12:13], v[180:181], v[148:149], v[12:13] op_sel:[0,0,0] op_sel_hi:[0,1,1]
    v_pk_fma_f32 v[14:15], v[180:181], v[150:151], v[14:15] op_sel:[0,0,0] op_sel_hi:[0,1,1]
    s_set_gpr_idx_idx s77
    v_pk_fma_f32 v[8:9], v[176:177], v[152:153], v[8:9] op_sel:[1,0,0] op_sel_hi:[1,1,1]
    v_pk_fma_f32 v[10:11], v[176:177], v[154:155], v[10:11] op_sel:[1,0,0] op_sel_hi:[1,1,1]
    v_pk_fma_f32 v[12:13], v[180:181], v[156:157], v[12:13] op_sel:[1,0,0] op_sel_hi:[1,1,1]
    v_pk_fma_f32 v[14:15], v[180:181], v[158:159], v[14:15] op_sel:[1,0,0] op_sel_hi:[1,1,1]
    s_set_gpr_idx_idx s78
    v_pk_fma_f32 v[8:9], v[178:179], v[160:161], v[8:9] op_sel:[0,0,0] op_sel_hi:[0,1,1]
    v_pk_fma_f32 v[10:11], v[178:179], v[162:163], v[10:11] op_sel:[0,0,0] op_sel_hi:[0,1,1]
    v_pk_fma_f32 v[12:13], v[182:183], v[164:165], v[12:13] op_sel:[0,0,0] op_sel_hi:[0,1,1]
    v_pk_fma_f32 v[14:15], v[182:183], v[166:167], v[14:15] op_sel:[0,0,0] op_sel_hi:[0,1,1]
    s_set_gpr_idx_idx s79
    v_pk_fma_f32 v[8:9], v[178:179], v[168:169], v[8:9] op_sel:[1,0,0] op_sel_hi:[1,1,1]
    v_pk_fma_f32 v[10:11], v[178:179], v[170:171], v[10:11] op_sel:[1,0,0] op_sel_hi:[1,1,1]
    v_pk_fma_f32 v[12:13], v[182:183], v[172:173], v[12:13] op_sel:[1,0,0] op_sel_hi:[1,1,1]
    v_pk_fma_f32 v[14:15], v[182:183], v[174:175], v[14:15] op_sel:[1,0,0] op_sel_hi:[1,1,1]
    s_set_gpr_idx_off
    s_cbranch_scc1 L_exit
    s_setprio 1
    s_waitcnt vmcnt(4)
    v_mfma_f32_4x4x4_16b_bf16 v[144:147], v[190:191], v[48:49], 0 cbsz:4 abid:0
    v_exp_f32 v176, v112
    v_mfma_f32_4x4x4_16b_bf16 v[148:151], v[190:191], v[50:51], 0 cbsz:4 abid:0
    v_exp_f32 v180, v128
    v_mfma_f32_4x4x4_16b_bf16 v[152:155], v[190:191], v[52:53], 0 cbsz:4 abid:1
    v_exp_f32 v177, v113
    v_mfma_f32_4x4x4_16b_bf16 v[156:159], v[190:191], v[54:55], 0 cbsz:4 abid:1
    v_exp_f32 v181, v129
    v_mfma_f32_4x4x4_16b_bf16 v[160:163], v[190:191], v[56:57], 0 cbsz:4 abid:2
    v_exp_f32 v178, v114
    v_mfma_f32_4x4x4_16b_bf16 v[164:167], v[190:191], v[58:59], 0 cbsz:4 abid:2
    v_exp_f32 v182, v130
    v_mfma_f32_4x4x4_16b_bf16 v[168:171], v[190:191], v[60:61], 0 cbsz:4 abid:3
    v_exp_f32 v179, v115
    v_mfma_f32_4x4x4_16b_bf16 v[172:175], v[190:191], v[62:63], 0 cbsz:4 abid:3
    v_exp_f32 v183, v131
    v_readlane_b32 s72, v228, 35
    v_readlane_b32 s73, v228, 39
    v_readlane_b32 s74, v228, 43
    v_readlane_b32 s75, v228, 47
    s_and_b32 s80, s72, s31
    v_pk_add_f32 v[176:177], v[176:177], 1.0 op_sel_hi:[1,0]
    s_and_b32 s81, s73, s31
    v_pk_add_f32 v[178:179], v[178:179], 1.0 op_sel_hi:[1,0]
    s_and_b32 s82, s74, s31
    v_pk_add_f32 v[180:181], v[180:181], 1.0 op_sel_hi:[1,0]
    s_and_b32 s83, s75, s31
    v_pk_add_f32 v[182:183], v[182:183], 1.0 op_sel_hi:[1,0]
    v_mfma_f32_32x32x16_bf16 v[80:95], v[192:195], v[200:203], 0
    v_rcp_f32 v176, v176
    v_rcp_f32 v177, v177
    v_rcp_f32 v178, v178
    v_rcp_f32 v179, v179
    v_rcp_f32 v180, v180
    buffer_load_dwordx4 v[48:51], v232, s[4:7], s80 offen
    v_rcp_f32 v181, v181
    buffer_load_dwordx4 v[52:55], v232, s[4:7], s81 offen
    v_rcp_f32 v182, v182
    buffer_load_dwordx4 v[56:59], v232, s[4:7], s82 offen
    v_rcp_f32 v183, v183
    buffer_load_dwordx4 v[60:63], v232, s[4:7], s83 offen
    s_cmp_le_i32 s30, 52
    s_mov_b64 exec, s[22:23]
    ds_read_b128 v[196:199], v229 offset:16384
    s_mov_b64 exec, -1
    ds_read_b32 v2, v231 offset:1292
    v_pk_mul_f32 v[176:177], v[176:177], v[112:113]
    v_pk_mul_f32 v[178:179], v[178:179], v[114:115]
    v_pk_mul_f32 v[180:181], v[180:181], v[128:129]
    v_pk_mul_f32 v[182:183], v[182:183], v[130:131]
    s_set_gpr_idx_on s64, gpr_idx(SRC2,DST)
    v_pk_fma_f32 v[8:9], v[176:177], v[144:145], v[8:9] op_sel:[0,0,0] op_sel_hi:[0,1,1]
    v_pk_fma_f32 v[10:11], v[176:177], v[146:147], v[10:11] op_sel:[0,0,0] op_sel_hi:[0,1,1]
    v_pk_fma_f32 v[12:13], v[180:181], v[148:149], v[12:13] op_sel:[0,0,0] op_sel_hi:[0,1,1]
    v_pk_fma_f32 v[14:15], v[180:181], v[150:151], v[14:15] op_sel:[0,0,0] op_sel_hi:[0,1,1]
    s_set_gpr_idx_idx s65
    v_pk_fma_f32 v[8:9], v[176:177], v[152:153], v[8:9] op_sel:[1,0,0] op_sel_hi:[1,1,1]
    v_pk_fma_f32 v[10:11], v[176:177], v[154:155], v[10:11] op_sel:[1,0,0] op_sel_hi:[1,1,1]
    v_pk_fma_f32 v[12:13], v[180:181], v[156:157], v[12:13] op_sel:[1,0,0] op_sel_hi:[1,1,1]
    v_pk_fma_f32 v[14:15], v[180:181], v[158:159], v[14:15] op_sel:[1,0,0] op_sel_hi:[1,1,1]
    s_set_gpr_idx_idx s66
    v_pk_fma_f32 v[8:9], v[178:179], v[160:161], v[8:9] op_sel:[0,0,0] op_sel_hi:[0,1,1]
    v_pk_fma_f32 v[10:11], v[178:179], v[162:163], v[10:11] op_sel:[0,0,0] op_sel_hi:[0,1,1]
    v_pk_fma_f32 v[12:13], v[182:183], v[164:165], v[12:13] op_sel:[0,0,0] op_sel_hi:[0,1,1]
    v_pk_fma_f32 v[14:15], v[182:183], v[166:167], v[14:15] op_sel:[0,0,0] op_sel_hi:[0,1,1]
    s_set_gpr_idx_idx s67
    v_pk_fma_f32 v[8:9], v[178:179], v[168:169], v[8:9] op_sel:[1,0,0] op_sel_hi:[1,1,1]
    v_pk_fma_f32 v[10:11], v[178:179], v[170:171], v[10:11] op_sel:[1,0,0] op_sel_hi:[1,1,1]
    v_pk_fma_f32 v[12:13], v[182:183], v[172:173], v[12:13] op_sel:[1,0,0] op_sel_hi:[1,1,1]
    v_pk_fma_f32 v[14:15], v[182:183], v[174:175], v[14:15] op_sel:[1,0,0] op_sel_hi:[1,1,1]
    s_set_gpr_idx_off
    s_cbranch_scc1 L_exit
    s_waitcnt vmcnt(4)
    v_mfma_f32_4x4x4_16b_bf16 v[144:147], v[190:191], v[64:65], 0 cbsz:4 abid:4
    v_exp_f32 v176, v116
    v_mfma_f32_4x4x4_16b_bf16 v[148:151], v[190:191], v[66:67], 0 cbsz:4 abid:4
    v_exp_f32 v180, v132
    v_mfma_f32_4x4x4_16b_bf16 v[152:155], v[190:191], v[68:69], 0 cbsz:4 abid:5
    v_exp_f32 v177, v117
    v_mfma_f32_4x4x4_16b_bf16 v[156:159], v[190:191], v[70:71], 0 cbsz:4 abid:5
    v_exp_f32 v181, v133
    v_mfma_f32_4x4x4_16b_bf16 v[160:163], v[190:191], v[72:73], 0 cbsz:4 abid:6
    v_exp_f32 v178, v118
    v_mfma_f32_4x4x4_16b_bf16 v[164:167], v[190:191], v[74:75], 0 cbsz:4 abid:6
    v_exp_f32 v182, v134
    v_mfma_f32_4x4x4_16b_bf16 v[168:171], v[190:191], v[76:77], 0 cbsz:4 abid:7
    v_exp_f32 v179, v119
    v_mfma_f32_4x4x4_16b_bf16 v[172:175], v[190:191], v[78:79], 0 cbsz:4 abid:7
    v_exp_f32 v183, v135
    v_readlane_b32 s76, v228, 51
    v_readlane_b32 s77, v228, 55
    v_readlane_b32 s78, v228, 59
    v_readlane_b32 s79, v228, 63
    s_and_b32 s80, s76, s31
    v_pk_add_f32 v[176:177], v[176:177], 1.0 op_sel_hi:[1,0]
    s_and_b32 s81, s77, s31
    v_pk_add_f32 v[178:179], v[178:179], 1.0 op_sel_hi:[1,0]
    s_and_b32 s82, s78, s31
    v_pk_add_f32 v[180:181], v[180:181], 1.0 op_sel_hi:[1,0]
    s_and_b32 s83, s79, s31
    v_pk_add_f32 v[182:183], v[182:183], 1.0 op_sel_hi:[1,0]
    v_mfma_f32_32x32x16_bf16 v[96:111], v[192:195], v[204:207], 0
    v_rcp_f32 v176, v176
    v_rcp_f32 v177, v177
    v_rcp_f32 v178, v178
    v_rcp_f32 v179, v179
    v_rcp_f32 v180, v180
    buffer_load_dwordx4 v[64:67], v232, s[4:7], s80 offen
    v_rcp_f32 v181, v181
    buffer_load_dwordx4 v[68:71], v232, s[4:7], s81 offen
    v_rcp_f32 v182, v182
    buffer_load_dwordx4 v[72:75], v232, s[4:7], s82 offen
    v_rcp_f32 v183, v183
    buffer_load_dwordx4 v[76:79], v232, s[4:7], s83 offen
    s_cmp_le_i32 s30, 56
    s_waitcnt lgkmcnt(0)
    v_pk_mul_f32 v[176:177], v[176:177], v[116:117]
    v_pk_mul_f32 v[178:179], v[178:179], v[118:119]
    v_pk_mul_f32 v[180:181], v[180:181], v[132:133]
    v_pk_mul_f32 v[182:183], v[182:183], v[134:135]
    s_set_gpr_idx_on s68, gpr_idx(SRC2,DST)
    v_pk_fma_f32 v[8:9], v[176:177], v[144:145], v[8:9] op_sel:[0,0,0] op_sel_hi:[0,1,1]
    v_pk_fma_f32 v[10:11], v[176:177], v[146:147], v[10:11] op_sel:[0,0,0] op_sel_hi:[0,1,1]
    v_pk_fma_f32 v[12:13], v[180:181], v[148:149], v[12:13] op_sel:[0,0,0] op_sel_hi:[0,1,1]
    v_pk_fma_f32 v[14:15], v[180:181], v[150:151], v[14:15] op_sel:[0,0,0] op_sel_hi:[0,1,1]
    s_set_gpr_idx_idx s69
    v_pk_fma_f32 v[8:9], v[176:177], v[152:153], v[8:9] op_sel:[1,0,0] op_sel_hi:[1,1,1]
    v_pk_fma_f32 v[10:11], v[176:177], v[154:155], v[10:11] op_sel:[1,0,0] op_sel_hi:[1,1,1]
    v_pk_fma_f32 v[12:13], v[180:181], v[156:157], v[12:13] op_sel:[1,0,0] op_sel_hi:[1,1,1]
    v_pk_fma_f32 v[14:15], v[180:181], v[158:159], v[14:15] op_sel:[1,0,0] op_sel_hi:[1,1,1]
    s_set_gpr_idx_idx s70
    v_pk_fma_f32 v[8:9], v[178:179], v[160:161], v[8:9] op_sel:[0,0,0] op_sel_hi:[0,1,1]
    v_pk_fma_f32 v[10:11], v[178:179], v[162:163], v[10:11] op_sel:[0,0,0] op_sel_hi:[0,1,1]
    v_pk_fma_f32 v[12:13], v[182:183], v[164:165], v[12:13] op_sel:[0,0,0] op_sel_hi:[0,1,1]
    v_pk_fma_f32 v[14:15], v[182:183], v[166:167], v[14:15] op_sel:[0,0,0] op_sel_hi:[0,1,1]
    s_set_gpr_idx_idx s71
    v_pk_fma_f32 v[8:9], v[178:179], v[168:169], v[8:9] op_sel:[1,0,0] op_sel_hi:[1,1,1]
    v_pk_fma_f32 v[10:11], v[178:179], v[170:171], v[10:11] op_sel:[1,0,0] op_sel_hi:[1,1,1]
    v_pk_fma_f32 v[12:13], v[182:183], v[172:173], v[12:13] op_sel:[1,0,0] op_sel_hi:[1,1,1]
    v_pk_fma_f32 v[14:15], v[182:183], v[174:175], v[14:15] op_sel:[1,0,0] op_sel_hi:[1,1,1]
    s_set_gpr_idx_off
    s_cbranch_scc1 L_exit
    s_setprio 0
    v_cndmask_b32 v228, v4, v226, s[34:35]
    s_waitcnt vmcnt(4)
    v_mfma_f32_4x4x4_16b_bf16 v[144:147], v[190:191], v[48:49], 0 cbsz:4 abid:8
    v_exp_f32 v176, v120
    v_mfma_f32_4x4x4_16b_bf16 v[148:151], v[190:191], v[50:51], 0 cbsz:4 abid:8
    v_exp_f32 v180, v136
    v_mfma_f32_4x4x4_16b_bf16 v[152:155], v[190:191], v[52:53], 0 cbsz:4 abid:9
    v_exp_f32 v177, v121
    v_mfma_f32_4x4x4_16b_bf16 v[156:159], v[190:191], v[54:55], 0 cbsz:4 abid:9
    v_exp_f32 v181, v137
    v_mfma_f32_4x4x4_16b_bf16 v[160:163], v[190:191], v[56:57], 0 cbsz:4 abid:10
    v_exp_f32 v178, v122
    v_mfma_f32_4x4x4_16b_bf16 v[164:167], v[190:191], v[58:59], 0 cbsz:4 abid:10
    v_exp_f32 v182, v138
    v_mfma_f32_4x4x4_16b_bf16 v[168:171], v[190:191], v[60:61], 0 cbsz:4 abid:11
    v_exp_f32 v179, v123
    v_mfma_f32_4x4x4_16b_bf16 v[172:175], v[190:191], v[62:63], 0 cbsz:4 abid:11
    v_exp_f32 v183, v139
    v_readlane_b32 s64, v228, 0
    v_readlane_b32 s65, v228, 4
    v_readlane_b32 s66, v228, 8
    v_readlane_b32 s67, v228, 12
    v_and_or_b32 v229, v2, s33, v233
    s_and_b32 s80, s64, s31
    v_pk_add_f32 v[176:177], v[176:177], 1.0 op_sel_hi:[1,0]
    s_and_b32 s81, s65, s31
    v_pk_add_f32 v[178:179], v[178:179], 1.0 op_sel_hi:[1,0]
    s_and_b32 s82, s66, s31
    v_pk_add_f32 v[180:181], v[180:181], 1.0 op_sel_hi:[1,0]
    s_and_b32 s83, s67, s31
    v_pk_add_f32 v[182:183], v[182:183], 1.0 op_sel_hi:[1,0]
    v_mfma_f32_32x32x16_bf16 v[80:95], v[196:199], v[208:211], v[80:95]
    v_rcp_f32 v176, v176
    v_rcp_f32 v177, v177
    v_rcp_f32 v178, v178
    v_rcp_f32 v179, v179
    v_rcp_f32 v180, v180
    buffer_load_dwordx4 v[48:51], v232, s[4:7], s80 offen
    v_rcp_f32 v181, v181
    buffer_load_dwordx4 v[52:55], v232, s[4:7], s81 offen
    v_rcp_f32 v182, v182
    buffer_load_dwordx4 v[56:59], v232, s[4:7], s82 offen
    v_rcp_f32 v183, v183
    buffer_load_dwordx4 v[60:63], v232, s[4:7], s83 offen
    s_cmp_le_i32 s30, 60
    s_mov_b64 exec, s[20:21]
    ds_read_b128 v[192:195], v229 offset:16384
    s_mov_b64 exec, -1
    v_pk_mul_f32 v[176:177], v[176:177], v[120:121]
    v_pk_mul_f32 v[178:179], v[178:179], v[122:123]
    v_pk_mul_f32 v[180:181], v[180:181], v[136:137]
    v_pk_mul_f32 v[182:183], v[182:183], v[138:139]
    s_set_gpr_idx_on s72, gpr_idx(SRC2,DST)
    v_pk_fma_f32 v[8:9], v[176:177], v[144:145], v[8:9] op_sel:[0,0,0] op_sel_hi:[0,1,1]
    v_pk_fma_f32 v[10:11], v[176:177], v[146:147], v[10:11] op_sel:[0,0,0] op_sel_hi:[0,1,1]
    v_pk_fma_f32 v[12:13], v[180:181], v[148:149], v[12:13] op_sel:[0,0,0] op_sel_hi:[0,1,1]
    v_pk_fma_f32 v[14:15], v[180:181], v[150:151], v[14:15] op_sel:[0,0,0] op_sel_hi:[0,1,1]
    s_set_gpr_idx_idx s73
    v_pk_fma_f32 v[8:9], v[176:177], v[152:153], v[8:9] op_sel:[1,0,0] op_sel_hi:[1,1,1]
    v_pk_fma_f32 v[10:11], v[176:177], v[154:155], v[10:11] op_sel:[1,0,0] op_sel_hi:[1,1,1]
    v_pk_fma_f32 v[12:13], v[180:181], v[156:157], v[12:13] op_sel:[1,0,0] op_sel_hi:[1,1,1]
    v_pk_fma_f32 v[14:15], v[180:181], v[158:159], v[14:15] op_sel:[1,0,0] op_sel_hi:[1,1,1]
    s_set_gpr_idx_idx s74
    v_pk_fma_f32 v[8:9], v[178:179], v[160:161], v[8:9] op_sel:[0,0,0] op_sel_hi:[0,1,1]
    v_pk_fma_f32 v[10:11], v[178:179], v[162:163], v[10:11] op_sel:[0,0,0] op_sel_hi:[0,1,1]
    v_pk_fma_f32 v[12:13], v[182:183], v[164:165], v[12:13] op_sel:[0,0,0] op_sel_hi:[0,1,1]
    v_pk_fma_f32 v[14:15], v[182:183], v[166:167], v[14:15] op_sel:[0,0,0] op_sel_hi:[0,1,1]
    s_set_gpr_idx_idx s75
    v_pk_fma_f32 v[8:9], v[178:179], v[168:169], v[8:9] op_sel:[1,0,0] op_sel_hi:[1,1,1]
    v_pk_fma_f32 v[10:11], v[178:179], v[170:171], v[10:11] op_sel:[1,0,0] op_sel_hi:[1,1,1]
    v_pk_fma_f32 v[12:13], v[182:183], v[172:173], v[12:13] op_sel:[1,0,0] op_sel_hi:[1,1,1]
    v_pk_fma_f32 v[14:15], v[182:183], v[174:175], v[14:15] op_sel:[1,0,0] op_sel_hi:[1,1,1]
    s_set_gpr_idx_off
    s_cbranch_scc1 L_exit
    s_waitcnt vmcnt(4)
    v_mfma_f32_4x4x4_16b_bf16 v[144:147], v[190:191], v[64:65], 0 cbsz:4 abid:12
    v_exp_f32 v176, v124
    v_mfma_f32_4x4x4_16b_bf16 v[148:151], v[190:191], v[66:67], 0 cbsz:4 abid:12
    v_exp_f32 v180, v140
    v_mfma_f32_4x4x4_16b_bf16 v[152:155], v[190:191], v[68:69], 0 cbsz:4 abid:13
    v_exp_f32 v177, v125
    v_mfma_f32_4x4x4_16b_bf16 v[156:159], v[190:191], v[70:71], 0 cbsz:4 abid:13
    v_exp_f32 v181, v141
    v_mfma_f32_4x4x4_16b_bf16 v[160:163], v[190:191], v[72:73], 0 cbsz:4 abid:14
    v_exp_f32 v178, v126
    v_mfma_f32_4x4x4_16b_bf16 v[164:167], v[190:191], v[74:75], 0 cbsz:4 abid:14
    v_exp_f32 v182, v142
    v_mfma_f32_4x4x4_16b_bf16 v[168:171], v[190:191], v[76:77], 0 cbsz:4 abid:15
    v_exp_f32 v179, v127
    v_mfma_f32_4x4x4_16b_bf16 v[172:175], v[190:191], v[78:79], 0 cbsz:4 abid:15
    v_exp_f32 v183, v143
    v_readlane_b32 s68, v228, 16
    v_readlane_b32 s69, v228, 20
    v_readlane_b32 s70, v228, 24
    v_readlane_b32 s71, v228, 28
    s_and_b32 s80, s68, s31
    v_pk_add_f32 v[176:177], v[176:177], 1.0 op_sel_hi:[1,0]
    s_and_b32 s81, s69, s31
    v_pk_add_f32 v[178:179], v[178:179], 1.0 op_sel_hi:[1,0]
    s_and_b32 s82, s70, s31
    v_pk_add_f32 v[180:181], v[180:181], 1.0 op_sel_hi:[1,0]
    s_and_b32 s83, s71, s31
    v_pk_add_f32 v[182:183], v[182:183], 1.0 op_sel_hi:[1,0]
    v_mfma_f32_32x32x16_bf16 v[96:111], v[196:199], v[212:215], v[96:111]
    v_rcp_f32 v176, v176
    v_rcp_f32 v177, v177
    v_rcp_f32 v178, v178
    v_rcp_f32 v179, v179
    v_rcp_f32 v180, v180
    buffer_load_dwordx4 v[64:67], v232, s[4:7], s80 offen
    v_rcp_f32 v181, v181
    buffer_load_dwordx4 v[68:71], v232, s[4:7], s81 offen
    v_rcp_f32 v182, v182
    buffer_load_dwordx4 v[72:75], v232, s[4:7], s82 offen
    v_rcp_f32 v183, v183
    buffer_load_dwordx4 v[76:79], v232, s[4:7], s83 offen
    s_waitcnt lgkmcnt(0)
    v_pk_mul_f32 v[176:177], v[176:177], v[124:125]
    v_pk_mul_f32 v[178:179], v[178:179], v[126:127]
    v_pk_mul_f32 v[180:181], v[180:181], v[140:141]
    v_pk_mul_f32 v[182:183], v[182:183], v[142:143]
    s_set_gpr_idx_on s76, gpr_idx(SRC2,DST)
    v_pk_fma_f32 v[8:9], v[176:177], v[144:145], v[8:9] op_sel:[0,0,0] op_sel_hi:[0,1,1]
    v_pk_fma_f32 v[10:11], v[176:177], v[146:147], v[10:11] op_sel:[0,0,0] op_sel_hi:[0,1,1]
    v_pk_fma_f32 v[12:13], v[180:181], v[148:149], v[12:13] op_sel:[0,0,0] op_sel_hi:[0,1,1]
    v_pk_fma_f32 v[14:15], v[180:181], v[150:151], v[14:15] op_sel:[0,0,0] op_sel_hi:[0,1,1]
    s_set_gpr_idx_idx s77
    v_pk_fma_f32 v[8:9], v[176:177], v[152:153], v[8:9] op_sel:[1,0,0] op_sel_hi:[1,1,1]
    v_pk_fma_f32 v[10:11], v[176:177], v[154:155], v[10:11] op_sel:[1,0,0] op_sel_hi:[1,1,1]
    v_pk_fma_f32 v[12:13], v[180:181], v[156:157], v[12:13] op_sel:[1,0,0] op_sel_hi:[1,1,1]
    v_pk_fma_f32 v[14:15], v[180:181], v[158:159], v[14:15] op_sel:[1,0,0] op_sel_hi:[1,1,1]
    s_set_gpr_idx_idx s78
    v_pk_fma_f32 v[8:9], v[178:179], v[160:161], v[8:9] op_sel:[0,0,0] op_sel_hi:[0,1,1]
    v_pk_fma_f32 v[10:11], v[178:179], v[162:163], v[10:11] op_sel:[0,0,0] op_sel_hi:[0,1,1]
    v_pk_fma_f32 v[12:13], v[182:183], v[164:165], v[12:13] op_sel:[0,0,0] op_sel_hi:[0,1,1]
    v_pk_fma_f32 v[14:15], v[182:183], v[166:167], v[14:15] op_sel:[0,0,0] op_sel_hi:[0,1,1]
    s_set_gpr_idx_idx s79
    v_pk_fma_f32 v[8:9], v[178:179], v[168:169], v[8:9] op_sel:[1,0,0] op_sel_hi:[1,1,1]
    v_pk_fma_f32 v[10:11], v[178:179], v[170:171], v[10:11] op_sel:[1,0,0] op_sel_hi:[1,1,1]
    v_pk_fma_f32 v[12:13], v[182:183], v[172:173], v[12:13] op_sel:[1,0,0] op_sel_hi:[1,1,1]
    v_pk_fma_f32 v[14:15], v[182:183], v[174:175], v[14:15] op_sel:[1,0,0] op_sel_hi:[1,1,1]
    s_set_gpr_idx_off
    v_add_u32 v231, 1024, v231
    s_sub_u32 s30, s30, 64
    s_branch L_sb
L_exit:
    s_setprio 0
    s_add_u32 s24, s24, 256
    s_lshl_b32 s26, s25, 8
    s_cmp_lt_u32 s24, s26
    s_cbranch_scc0 L_epi
    v_lshlrev_b32 v7, 3, v0
    v_mov_b32 v2, 0
    v_mov_b32 v3, 0
    ds_write_b64 v7, v[2:3]
    s_waitcnt vmcnt(0) lgkmcnt(0)
    s_nop 15
    s_barrier
    s_branch L_round
L_epi:
    s_mov_b32 s34, 0xbf317218
    s_mov_b32 s35, 0xbf317218
    s_lshl_b32 s26, s16, 2
    v_mov_b32 v2, s26
    s_waitcnt lgkmcnt(0)
    ds_read_b32 v184, v2 offset:4096
    ds_read_b32 v185, v2 offset:4128
    ds_read_b32 v186, v2 offset:4160
    ds_read_b32 v187, v2 offset:4192
    ds_read_b32 v188, v2 offset:4224
    v_pk_mul_f32 v[8:9], v[8:9], s[34:35]
    v_pk_mul_f32 v[10:11], v[10:11], s[34:35]
    v_pk_mul_f32 v[12:13], v[12:13], s[34:35]
    v_pk_mul_f32 v[14:15], v[14:15], s[34:35]
    v_pk_mul_f32 v[16:17], v[16:17], s[34:35]
    v_pk_mul_f32 v[18:19], v[18:19], s[34:35]
    v_pk_mul_f32 v[20:21], v[20:21], s[34:35]
    v_pk_mul_f32 v[22:23], v[22:23], s[34:35]
    v_pk_mul_f32 v[24:25], v[24:25], s[34:35]
    v_pk_mul_f32 v[26:27], v[26:27], s[34:35]
    v_pk_mul_f32 v[28:29], v[28:29], s[34:35]
    v_pk_mul_f32 v[30:31], v[30:31], s[34:35]
    v_pk_mul_f32 v[32:33], v[32:33], s[34:35]
    v_pk_mul_f32 v[34:35], v[34:35], s[34:35]
    v_pk_mul_f32 v[36:37], v[36:37], s[34:35]
    v_pk_mul_f32 v[38:39], v[38:39], s[34:35]
    v_pk_mul_f32 v[40:41], v[40:41], s[34:35]
    v_pk_mul_f32 v[42:43], v[42:43], s[34:35]
    v_pk_mul_f32 v[44:45], v[44:45], s[34:35]
    v_pk_mul_f32 v[46:47], v[46:47], s[34:35]
    v_cvt_pk_bf16_f32 v8, v8, v12
    v_cvt_pk_bf16_f32 v9, v9, v13
    v_cvt_pk_bf16_f32 v10, v10, v14
    v_cvt_pk_bf16_f32 v11, v11, v15
    v_cvt_pk_bf16_f32 v16, v16, v20
    v_cvt_pk_bf16_f32 v17, v17, v21
    v_cvt_pk_bf16_f32 v18, v18, v22
    v_cvt_pk_bf16_f32 v19, v19, v23
    v_cvt_pk_bf16_f32 v24, v24, v28
    v_cvt_pk_bf16_f32 v25, v25, v29
    v_cvt_pk_bf16_f32 v26, v26, v30
    v_cvt_pk_bf16_f32 v27, v27, v31
    v_cvt_pk_bf16_f32 v32, v32, v36
    v_cvt_pk_bf16_f32 v33, v33, v37
    v_cvt_pk_bf16_f32 v34, v34, v38
    v_cvt_pk_bf16_f32 v35, v35, v39
    v_cvt_pk_bf16_f32 v40, v40, v44
    v_cvt_pk_bf16_f32 v41, v41, v45
    v_cvt_pk_bf16_f32 v42, v42, v46
    v_cvt_pk_bf16_f32 v43, v43, v47
    s_and_b32 s26, s16, 3
    s_lshl_b32 s27, s26, 13
    s_add_u32 s27, s27, 116736
    v_add_u32 v3, s27, v232
    v_lshlrev_b32 v2, 2, v1
    s_movk_i32 s36, 1088
    s_waitcnt lgkmcnt(0)
    ds_read_b128 v[80:83], v3 offset:0
    ds_read_b128 v[84:87], v3 offset:1024
    ds_read_b128 v[88:91], v3 offset:2048
    ds_read_b128 v[92:95], v3 offset:3072
    ds_read_b128 v[96:99], v3 offset:4096
    ds_read_b128 v[100:103], v3 offset:5120
    ds_read_b128 v[104:107], v3 offset:6144
    ds_read_b128 v[108:111], v3 offset:7168
    v_and_b32 v184, 63, v184
    v_mad_u32_u24 v184, v184, s36, v2
    v_and_b32 v185, 63, v185
    v_mad_u32_u24 v185, v185, s36, v2
    v_and_b32 v186, 63, v186
    v_mad_u32_u24 v186, v186, s36, v2
    v_and_b32 v187, 63, v187
    v_mad_u32_u24 v187, v187, s36, v2
    v_and_b32 v188, 63, v188
    v_mad_u32_u24 v188, v188, s36, v2
    s_barrier
    ds_write_b32 v184, v8 offset:16384
    ds_write_b32 v184, v9 offset:16656
    ds_write_b32 v184, v10 offset:16928
    ds_write_b32 v184, v11 offset:17200
    ds_write_b32 v185, v16 offset:16384
    ds_write_b32 v185, v17 offset:16656
    ds_write_b32 v185, v18 offset:16928
    ds_write_b32 v185, v19 offset:17200
    ds_write_b32 v186, v24 offset:16384
    ds_write_b32 v186, v25 offset:16656
    ds_write_b32 v186, v26 offset:16928
    ds_write_b32 v186, v27 offset:17200
    ds_write_b32 v187, v32 offset:16384
    ds_write_b32 v187, v33 offset:16656
    ds_write_b32 v187, v34 offset:16928
    ds_write_b32 v187, v35 offset:17200
    ds_write_b32 v188, v40 offset:16384
    ds_write_b32 v188, v41 offset:16656
    ds_write_b32 v188, v42 offset:16928
    ds_write_b32 v188, v43 offset:17200
    s_lshr_b32 s27, s16, 2
    v_and_b32 v4, 15, v1
    v_lshrrev_b32 v5, 4, v1
    s_movk_i32 s36, 272
    v_mul_u32_u24 v6, s36, v4
    v_lshl_add_u32 v6, v5, 4, v6
    s_mul_i32 s36, s27, 21760
    v_add_u32 v6, s36, v6
    v_lshlrev_b32 v7, 18, v5
    v_lshl_add_u32 v7, v4, 4, v7
    s_mul_i32 s36, s27, 5242880
    s_lshl_b32 s37, s17, 10
    s_add_u32 s36, s36, s37
    s_lshl_b32 s37, s26, 8
    s_add_u32 s36, s36, s37
    v_add_u32 v7, s36, v7
    s_waitcnt lgkmcnt(0)
    s_barrier
    s_waitcnt vmcnt(0)
    ds_read_b128 v[112:115], v6 offset:16384
    ds_read_b128 v[116:119], v6 offset:16448
    ds_read_b128 v[120:123], v6 offset:16512
    ds_read_b128 v[124:127], v6 offset:16576
    ds_read_b128 v[128:131], v6 offset:20736
    ds_read_b128 v[132:135], v6 offset:20800
    ds_read_b128 v[136:139], v6 offset:20864
    ds_read_b128 v[140:143], v6 offset:20928
    s_waitcnt lgkmcnt(7)
    v_mfma_f32_16x16x32_bf16 v[144:147], v[112:115], v[80:83], 0
    v_mfma_f32_16x16x32_bf16 v[148:151], v[112:115], v[96:99], 0
    s_waitcnt lgkmcnt(6)
    v_mfma_f32_16x16x32_bf16 v[144:147], v[116:119], v[84:87], v[144:147]
    v_mfma_f32_16x16x32_bf16 v[148:151], v[116:119], v[100:103], v[148:151]
    s_waitcnt lgkmcnt(5)
    v_mfma_f32_16x16x32_bf16 v[144:147], v[120:123], v[88:91], v[144:147]
    v_mfma_f32_16x16x32_bf16 v[148:151], v[120:123], v[104:107], v[148:151]
    s_waitcnt lgkmcnt(4)
    v_mfma_f32_16x16x32_bf16 v[144:147], v[124:127], v[92:95], v[144:147]
    v_mfma_f32_16x16x32_bf16 v[148:151], v[124:127], v[108:111], v[148:151]
    ds_read_b128 v[112:115], v6 offset:25088
    ds_read_b128 v[116:119], v6 offset:25152
    ds_read_b128 v[120:123], v6 offset:25216
    ds_read_b128 v[124:127], v6 offset:25280
    s_waitcnt lgkmcnt(7)
    v_mfma_f32_16x16x32_bf16 v[152:155], v[128:131], v[80:83], 0
    v_mfma_f32_16x16x32_bf16 v[156:159], v[128:131], v[96:99], 0
    s_waitcnt lgkmcnt(6)
    v_mfma_f32_16x16x32_bf16 v[152:155], v[132:135], v[84:87], v[152:155]
    v_mfma_f32_16x16x32_bf16 v[156:159], v[132:135], v[100:103], v[156:159]
    s_waitcnt lgkmcnt(5)
    v_mfma_f32_16x16x32_bf16 v[152:155], v[136:139], v[88:91], v[152:155]
    v_mfma_f32_16x16x32_bf16 v[156:159], v[136:139], v[104:107], v[156:159]
    s_waitcnt lgkmcnt(4)
    v_mfma_f32_16x16x32_bf16 v[152:155], v[140:143], v[92:95], v[152:155]
    v_mfma_f32_16x16x32_bf16 v[156:159], v[140:143], v[108:111], v[156:159]
    ds_read_b128 v[128:131], v6 offset:29440
    ds_read_b128 v[132:135], v6 offset:29504
    ds_read_b128 v[136:139], v6 offset:29568
    ds_read_b128 v[140:143], v6 offset:29632
    v_cvt_pk_bf16_f32 v48, v144, v145
    v_cvt_pk_bf16_f32 v49, v146, v147
    v_cvt_pk_bf16_f32 v50, v148, v149
    v_cvt_pk_bf16_f32 v51, v150, v151
    buffer_store_dwordx4 v[48:51], v7, s[12:15], 0 offen sc1
    v_add_u32 v7, 1048576, v7
    s_waitcnt lgkmcnt(7)
    v_mfma_f32_16x16x32_bf16 v[144:147], v[112:115], v[80:83], 0
    v_mfma_f32_16x16x32_bf16 v[148:151], v[112:115], v[96:99], 0
    s_waitcnt lgkmcnt(6)
    v_mfma_f32_16x16x32_bf16 v[144:147], v[116:119], v[84:87], v[144:147]
    v_mfma_f32_16x16x32_bf16 v[148:151], v[116:119], v[100:103], v[148:151]
    s_waitcnt lgkmcnt(5)
    v_mfma_f32_16x16x32_bf16 v[144:147], v[120:123], v[88:91], v[144:147]
    v_mfma_f32_16x16x32_bf16 v[148:151], v[120:123], v[104:107], v[148:151]
    s_waitcnt lgkmcnt(4)
    v_mfma_f32_16x16x32_bf16 v[144:147], v[124:127], v[92:95], v[144:147]
    v_mfma_f32_16x16x32_bf16 v[148:151], v[124:127], v[108:111], v[148:151]
    ds_read_b128 v[112:115], v6 offset:33792
    ds_read_b128 v[116:119], v6 offset:33856
    ds_read_b128 v[120:123], v6 offset:33920
    ds_read_b128 v[124:127], v6 offset:33984
    v_cvt_pk_bf16_f32 v52, v152, v153
    v_cvt_pk_bf16_f32 v53, v154, v155
    v_cvt_pk_bf16_f32 v54, v156, v157
    v_cvt_pk_bf16_f32 v55, v158, v159
    buffer_store_dwordx4 v[52:55], v7, s[12:15], 0 offen sc1
    v_add_u32 v7, 1048576, v7
    s_waitcnt lgkmcnt(7)
    v_mfma_f32_16x16x32_bf16 v[152:155], v[128:131], v[80:83], 0
    v_mfma_f32_16x16x32_bf16 v[156:159], v[128:131], v[96:99], 0
    s_waitcnt lgkmcnt(6)
    v_mfma_f32_16x16x32_bf16 v[152:155], v[132:135], v[84:87], v[152:155]
    v_mfma_f32_16x16x32_bf16 v[156:159], v[132:135], v[100:103], v[156:159]
    s_waitcnt lgkmcnt(5)
    v_mfma_f32_16x16x32_bf16 v[152:155], v[136:139], v[88:91], v[152:155]
    v_mfma_f32_16x16x32_bf16 v[156:159], v[136:139], v[104:107], v[156:159]
    s_waitcnt lgkmcnt(4)
    v_mfma_f32_16x16x32_bf16 v[152:155], v[140:143], v[92:95], v[152:155]
    v_mfma_f32_16x16x32_bf16 v[156:159], v[140:143], v[108:111], v[156:159]
    v_cvt_pk_bf16_f32 v48, v144, v145
    v_cvt_pk_bf16_f32 v49, v146, v147
    v_cvt_pk_bf16_f32 v50, v148, v149
    v_cvt_pk_bf16_f32 v51, v150, v151
    buffer_store_dwordx4 v[48:51], v7, s[12:15], 0 offen sc1
    v_add_u32 v7, 1048576, v7
    s_waitcnt lgkmcnt(3)
    v_mfma_f32_16x16x32_bf16 v[144:147], v[112:115], v[80:83], 0
    v_mfma_f32_16x16x32_bf16 v[148:151], v[112:115], v[96:99], 0
    s_waitcnt lgkmcnt(2)
    v_mfma_f32_16x16x32_bf16 v[144:147], v[116:119], v[84:87], v[144:147]
    v_mfma_f32_16x16x32_bf16 v[148:151], v[116:119], v[100:103], v[148:151]
    s_waitcnt lgkmcnt(1)
    v_mfma_f32_16x16x32_bf16 v[144:147], v[120:123], v[88:91], v[144:147]
    v_mfma_f32_16x16x32_bf16 v[148:151], v[120:123], v[104:107], v[148:151]
    s_waitcnt lgkmcnt(0)
    v_mfma_f32_16x16x32_bf16 v[144:147], v[124:127], v[92:95], v[144:147]
    v_mfma_f32_16x16x32_bf16 v[148:151], v[124:127], v[108:111], v[148:151]
    v_cvt_pk_bf16_f32 v52, v152, v153
    v_cvt_pk_bf16_f32 v53, v154, v155
    v_cvt_pk_bf16_f32 v54, v156, v157
    v_cvt_pk_bf16_f32 v55, v158, v159
    buffer_store_dwordx4 v[52:55], v7, s[12:15], 0 offen sc1
    v_add_u32 v7, 1048576, v7
    s_nop 7
    v_cvt_pk_bf16_f32 v48, v144, v145
    v_cvt_pk_bf16_f32 v49, v146, v147
    v_cvt_pk_bf16_f32 v50, v148, v149
    v_cvt_pk_bf16_f32 v51, v150, v151
    buffer_store_dwordx4 v[48:51], v7, s[12:15], 0 offen sc1
L_m_end:
    s_endpgm
.section .rodata,"a"
.p2align 6
.amdhsa_kernel bin_kernel
.amdhsa_next_free_vgpr 48
.amdhsa_next_free_sgpr 100
.amdhsa_accum_offset 48
.amdhsa_group_segment_fixed_size 0
.amdhsa_kernarg_size 88
.amdhsa_user_sgpr_count 2
.amdhsa_user_sgpr_kernarg_segment_ptr 1
.amdhsa_system_sgpr_workgroup_id_x 1
.amdhsa_float_denorm_mode_32 3
.end_amdhsa_kernel
.amdhsa_kernel main_kernel
.amdhsa_next_free_vgpr 239
.amdhsa_next_free_sgpr 100
.amdhsa_accum_offset 240
.amdhsa_group_segment_fixed_size 0
.amdhsa_kernarg_size 88
.amdhsa_user_sgpr_count 2
.amdhsa_user_sgpr_kernarg_segment_ptr 1
.amdhsa_system_sgpr_workgroup_id_x 1
.amdhsa_float_denorm_mode_32 3
.end_amdhsa_kernel
```

```asm
; @launch grid=(256,1,1) block=(512,1,1) lds=153600
.amdgcn_target "amdgcn-amd-amdhsa--gfx950"
.text
.globl standalone__tensor_product_equiv_tfn__graph_kernel
.p2align 8
.type standalone__tensor_product_equiv_tfn__graph_kernel,@function
standalone__tensor_product_equiv_tfn__graph_kernel:
    s_cmp_ge_u32 s2, 256
    s_cbranch_scc1 L_m_end
    s_load_dwordx16 s[36:51], s[0:1], 0
    s_load_dwordx4 s[52:55], s[0:1], 64
    s_load_dwordx2 s[56:57], s[0:1], 80
    v_lshrrev_b32 v2, 6, v0
    v_and_b32 v1, 63, v0
    v_readfirstlane_b32 s16, v2
    s_and_b32 s17, s2, 7
    s_lshl_b32 s17, s17, 5
    s_lshr_b32 s26, s2, 3
    s_or_b32 s17, s17, s26
    v_lshlrev_b32 v7, 3, v0
    v_mov_b32 v2, 0
    v_mov_b32 v3, 0
    v_mov_b32 v4, 0
    v_mov_b32 v5, 0
    ds_write_b64 v7, v[2:3]
    v_lshlrev_b32 v232, 4, v1
    s_mul_i32 s26, s16, 160
    v_add_u32 v6, s26, v1
    v_lshlrev_b32 v53, 2, v6
    v_lshlrev_b32 v54, 3, v6
    v_lshlrev_b32 v55, 4, v6
    s_mul_i32 s26, s16, 5120
    v_add_u32 v56, s26, v232
    s_cmp_lt_u32 s16, 7
    s_cselect_b32 s60, -1, 3
    s_mov_b32 s61, 0
    s_cselect_b64 s[62:63], -1, 15
    s_cselect_b32 s34, -1, 0xff
    s_mul_i32 s58, s17, 5000
    s_mul_i32 s59, s17, 10000
    s_lshl_b32 s29, s17, 10
    s_add_u32 s29, s29, 15728640
    s_waitcnt lgkmcnt(0)
    s_mov_b32 s8, s56
    s_mov_b32 s9, s57
    s_mov_b32 s10, 16777216
    s_mov_b32 s11, 0x00020000
    s_mov_b32 s64, s40
    s_mov_b32 s65, s41
    s_mov_b32 s66, 1280000
    s_mov_b32 s67, 0x00020000
    buffer_load_dword v144, v53, s[64:67], s58 offen offset:0
    buffer_load_dword v145, v53, s[64:67], s58 offen offset:256
    s_mov_b64 exec, s[60:61]
    buffer_load_dword v146, v53, s[64:67], s58 offen offset:512
    s_mov_b64 exec, -1
    s_getpc_b64 s[82:83]
L_pc:
    s_lshr_b32 s80, s2, 3
    s_lshl_b32 s81, s80, 7
    s_and_b32 s3, s16, 1
    s_lshl_b32 s3, s3, 6
    s_add_u32 s81, s81, s3
    s_load_dword s3, s[46:47], s81
    s_lshl_b32 s80, s80, 3
    s_add_u32 s80, s80, s16
    s_lshl_b32 s81, s80, 7
    s_load_dword s3, s[50:51], s81
    s_add_u32 s81, s81, 64
    s_load_dword s3, s[50:51], s81
    s_lshl_b32 s81, s80, 6
    s_min_u32 s81, s81, L_m_end-L_pc
    s_load_dword s3, s[82:83], s81
    s_load_dword s3, s[48:49], 0
    s_load_dword s3, s[48:49], 64
    s_mov_b32 s68, s38
    s_mov_b32 s69, s39
    s_mov_b32 s70, 1280000
    s_mov_b32 s71, 0x00020000
    buffer_load_dword v147, v53, s[68:71], s58 offen offset:0
    buffer_load_dword v148, v53, s[68:71], s58 offen offset:256
    s_mov_b64 exec, s[60:61]
    buffer_load_dword v149, v53, s[68:71], s58 offen offset:512
    s_mov_b64 exec, -1
    s_mov_b32 s72, s42
    s_mov_b32 s73, s43
    s_mov_b32 s74, 2560000
    s_mov_b32 s75, 0x00020000
    buffer_load_dwordx2 v[152:153], v54, s[72:75], s59 offen offset:0
    buffer_load_dwordx2 v[156:157], v54, s[72:75], s59 offen offset:512
    s_mov_b64 exec, s[60:61]
    buffer_load_dwordx2 v[160:161], v54, s[72:75], s59 offen offset:1024
    s_mov_b64 exec, -1
    s_mov_b32 s76, s44
    s_mov_b32 s77, s45
    s_mov_b32 s78, 10240000
    s_mov_b32 s79, 0x00020000
    s_mul_i32 s58, s17, 40000
    s_add_u32 m0, s26, 36864
    s_barrier
    buffer_load_dwordx4 v56, s[76:79], s58 offen offset:0  lds
    buffer_load_dwordx4 v56, s[76:79], s58 offen offset:1024  lds
    buffer_load_dwordx4 v56, s[76:79], s58 offen offset:2048  lds
    buffer_load_dwordx4 v56, s[76:79], s58 offen offset:3072  lds
    s_add_u32 m0, s26, 40960
    s_add_u32 s58, s58, 4096
    s_mov_b64 exec, s[62:63]
    buffer_load_dwordx4 v56, s[76:79], s58 offen  lds
    s_mov_b64 exec, -1
    v_mov_b32 v6, 1
    s_mov_b32 s64, s54
    s_mov_b32 s65, s55
    s_mov_b32 s66, 256
    s_mov_b32 s67, 0x00020000
    s_waitcnt vmcnt(11)
    v_and_b32 v2, 255, v144
    v_lshlrev_b32 v167, 2, v2
    ds_add_rtn_u32 v164, v167, v6 offset:3072
    v_and_b32 v2, 255, v145
    v_lshlrev_b32 v168, 2, v2
    ds_add_rtn_u32 v165, v168, v6 offset:3072
    s_mov_b64 exec, s[60:61]
    v_and_b32 v2, 255, v146
    v_lshlrev_b32 v169, 2, v2
    ds_add_rtn_u32 v166, v169, v6 offset:3072
    s_mov_b64 exec, -1
    s_movk_i32 s27, 5033
    s_waitcnt vmcnt(8)
    v_lshrrev_b32 v3, 8, v144
    v_lshlrev_b32 v2, 2, v3
    v_lshl_or_b32 v154, v147, 10, v2
    v_mul_u32_u24 v2, s27, v147
    v_lshrrev_b32 v2, 22, v2
    v_mad_u32_u24 v2, v3, 12, v2
    v_lshlrev_b32 v155, 2, v2
    v_lshrrev_b32 v3, 8, v145
    v_lshlrev_b32 v2, 2, v3
    v_lshl_or_b32 v158, v148, 10, v2
    v_mul_u32_u24 v2, s27, v148
    v_lshrrev_b32 v2, 22, v2
    v_mad_u32_u24 v2, v3, 12, v2
    v_lshlrev_b32 v159, 2, v2
    v_lshrrev_b32 v3, 8, v146
    v_lshlrev_b32 v2, 2, v3
    v_lshl_or_b32 v162, v149, 10, v2
    v_mul_u32_u24 v2, s27, v149
    v_lshrrev_b32 v2, 22, v2
    v_mad_u32_u24 v2, v3, 12, v2
    v_lshlrev_b32 v163, 2, v2
    s_waitcnt lgkmcnt(0)
    s_barrier
    ds_read_b128 v[172:175], v232 offset:3072
    s_waitcnt lgkmcnt(0)
    v_add_u32 v50, v172, v173
    v_add_u32 v51, v50, v174
    v_add_u32 v2, v51, v175
    v_mov_b32 v3, v2
    s_nop 1
    v_add_u32_dpp v3, v3, v3 row_shr:1 row_mask:0xf bank_mask:0xf
    s_nop 1
    v_add_u32_dpp v3, v3, v3 row_shr:2 row_mask:0xf bank_mask:0xf
    s_nop 1
    v_add_u32_dpp v3, v3, v3 row_shr:4 row_mask:0xf bank_mask:0xf
    s_nop 1
    v_add_u32_dpp v3, v3, v3 row_shr:8 row_mask:0xf bank_mask:0xf
    s_nop 1
    v_add_u32_dpp v3, v3, v3 row_bcast:15 row_mask:0xa bank_mask:0xf
    s_nop 1
    v_add_u32_dpp v3, v3, v3 row_bcast:31 row_mask:0xc bank_mask:0xf
    v_sub_u32 v48, v3, v2
    v_add_u32 v49, v48, v172
    v_add_u32 v50, v48, v50
    v_add_u32 v51, v48, v51
    ds_write_b128 v232, v[48:51] offset:10752
    ds_read_b32 v167, v167 offset:10752
    ds_read_b32 v168, v168 offset:10752
    s_mov_b64 exec, s[60:61]
    ds_read_b32 v169, v169 offset:10752
    s_mov_b64 exec, -1
    v_lshlrev_b32 v4, 1, v55
    v_lshl_or_b32 v60, v172, 16, v48
    v_lshl_or_b32 v61, v173, 16, v49
    v_lshl_or_b32 v62, v174, 16, v50
    v_lshl_or_b32 v63, v175, 16, v51
    s_waitcnt vmcnt(5) lgkmcnt(0)
    v_add_lshl_u32 v2, v167, v164, 1
    v_add_u32 v3, 0, v4
    ds_write_b16 v2, v3 offset:8192
    v_lshlrev_b32 v2, 3, v2
    ds_write_b128 v2, v[152:155] offset:16384
    v_add_lshl_u32 v2, v168, v165, 1
    v_add_u32 v3, 2048, v4
    ds_write_b16 v2, v3 offset:8192
    v_lshlrev_b32 v2, 3, v2
    ds_write_b128 v2, v[156:159] offset:16384
    s_mov_b64 exec, s[60:61]
    v_add_lshl_u32 v2, v169, v166, 1
    v_add_u32 v3, 4096, v4
    ds_write_b16 v2, v3 offset:8192
    v_lshlrev_b32 v2, 3, v2
    ds_write_b128 v2, v[160:163] offset:16384
    s_mov_b64 exec, -1
    v_lshrrev_b32 v2, 4, v56
    v_and_b32 v2, 0xffe, v2
    v_and_b32 v3, 1, v1
    v_lshlrev_b32 v3, 4, v3
    s_mul_i32 s58, s17, 20480
    s_add_u32 s58, s58, 10485760
    s_waitcnt lgkmcnt(0)
    s_barrier
    v_lshrrev_b32 v4, 1, v0
    s_lshl_b32 s59, s17, 2
    s_add_u32 s59, s59, 15728640
    v_lshl_add_u32 v5, v4, 10, s59
    buffer_load_dword v59, v5, s[8:11], 0 offen
    s_cmp_eq_u32 s16, 7
    s_cselect_b32 s59, s29, 0x40000000
    v_add_u32 v7, s59, v232
    buffer_load_dwordx4 v[64:67], v7, s[8:11], 0 offen
    ds_read_b128 v[152:155], v55 offset:16384
    ds_read_b128 v[156:159], v55 offset:17408
    ds_read_b128 v[160:163], v55 offset:18432
    ds_read_u16 v164, v2 offset:8192
    ds_read_u16 v165, v2 offset:8256
    ds_read_u16 v166, v2 offset:8320
    ds_read_u16 v167, v2 offset:8384
    ds_read_u16 v168, v2 offset:8448
    s_mov_b32 s27, s58
    s_mov_b64 exec, -1
    s_waitcnt lgkmcnt(0)
    v_or_b32 v164, v164, v3
    v_or_b32 v165, v165, v3
    v_or_b32 v166, v166, v3
    v_or_b32 v167, v167, v3
    v_or_b32 v168, v168, v3
    s_mov_b32 s4, s36
    s_mov_b32 s5, s37
    s_mov_b32 s6, 10240000
    s_mov_b32 s7, 0x00020000
    s_mov_b32 s12, s52
    s_mov_b32 s13, s53
    s_mov_b32 s14, 10240000
    s_mov_b32 s15, 0x00020000
    s_mov_b32 s20, 0x0f0f0f0f
    s_mov_b32 s21, 0x0f0f0f0f
    s_mov_b32 s22, 0xf0f0f0f0
    s_mov_b32 s23, 0xf0f0f0f0
    s_mov_b32 s31, 0xfffffc00
    s_mov_b32 s32, 0x9c4028
    s_mov_b32 s33, 0xffe0
    s_mov_b32 s24, 0
    s_mov_b32 s25, 0
    v_mov_b32 v8, 0
    v_mov_b32 v9, 0
    v_mov_b32 v10, 0
    v_mov_b32 v11, 0
    v_mov_b32 v12, 0
    v_mov_b32 v13, 0
    v_mov_b32 v14, 0
    v_mov_b32 v15, 0
    v_mov_b32 v16, 0
    v_mov_b32 v17, 0
    v_mov_b32 v18, 0
    v_mov_b32 v19, 0
    v_mov_b32 v20, 0
    v_mov_b32 v21, 0
    v_mov_b32 v22, 0
    v_mov_b32 v23, 0
    v_mov_b32 v24, 0
    v_mov_b32 v25, 0
    v_mov_b32 v26, 0
    v_mov_b32 v27, 0
    v_mov_b32 v28, 0
    v_mov_b32 v29, 0
    v_mov_b32 v30, 0
    v_mov_b32 v31, 0
    v_mov_b32 v32, 0
    v_mov_b32 v33, 0
    v_mov_b32 v34, 0
    v_mov_b32 v35, 0
    v_mov_b32 v36, 0
    v_mov_b32 v37, 0
    v_mov_b32 v38, 0
    v_mov_b32 v39, 0
    v_mov_b32 v40, 0
    v_mov_b32 v41, 0
    v_mov_b32 v42, 0
    v_mov_b32 v43, 0
    v_mov_b32 v44, 0
    v_mov_b32 v45, 0
    v_mov_b32 v46, 0
    v_mov_b32 v47, 0
    v_mov_b32 v192, 0
    v_mov_b32 v193, 0
    v_mov_b32 v194, 0
    v_mov_b32 v195, 0
    v_mov_b32 v196, 0
    v_mov_b32 v197, 0
    v_mov_b32 v198, 0
    v_mov_b32 v199, 0
    v_mov_b32 v112, 0
    v_mov_b32 v238, 0
    s_cmp_lt_u32 s17, 16
    s_cbranch_scc1 L_map40
    v_writelane_b32 v112, 0, 0
    v_writelane_b32 v112, 5, 1
    v_writelane_b32 v112, 6, 2
    v_writelane_b32 v112, 3, 3
    v_writelane_b32 v112, 8, 4
    v_writelane_b32 v112, 7, 5
    v_writelane_b32 v112, 2, 6
    v_writelane_b32 v112, 4, 7
    v_writelane_b32 v112, 1, 8
    v_writelane_b32 v112, 16, 9
    v_writelane_b32 v112, 10, 10
    v_writelane_b32 v112, 15, 11
    v_writelane_b32 v112, 9, 12
    v_writelane_b32 v112, 24, 13
    v_writelane_b32 v112, 14, 14
    v_writelane_b32 v112, 11, 15
    v_writelane_b32 v112, 13, 16
    v_writelane_b32 v112, 12, 17
    v_writelane_b32 v112, 17, 18
    v_writelane_b32 v112, 23, 19
    v_writelane_b32 v112, 20, 20
    v_writelane_b32 v112, 22, 21
    v_writelane_b32 v112, 19, 22
    v_writelane_b32 v112, 18, 23
    v_writelane_b32 v112, 21, 24
    v_writelane_b32 v112, 28, 25
    v_writelane_b32 v112, 29, 26
    v_writelane_b32 v112, 31, 27
    v_writelane_b32 v112, 26, 28
    v_writelane_b32 v112, 25, 29
    v_writelane_b32 v112, 27, 30
    v_writelane_b32 v112, 30, 31
    v_writelane_b32 v112, 36, 32
    v_writelane_b32 v112, 33, 33
    v_writelane_b32 v112, 35, 34
    v_writelane_b32 v112, 34, 35
    v_writelane_b32 v112, 38, 36
    v_writelane_b32 v112, 39, 37
    v_writelane_b32 v112, 37, 38
    v_writelane_b32 v112, 32, 39
    s_branch L_mapd
L_map40:
    v_writelane_b32 v112, 7, 0
    v_writelane_b32 v112, 0, 1
    v_writelane_b32 v112, 5, 2
    v_writelane_b32 v112, 2, 3
    v_writelane_b32 v112, 4, 4
    v_writelane_b32 v112, 3, 5
    v_writelane_b32 v112, 1, 6
    v_writelane_b32 v112, 6, 7
    v_writelane_b32 v112, 12, 8
    v_writelane_b32 v112, 9, 9
    v_writelane_b32 v112, 14, 10
    v_writelane_b32 v112, 11, 11
    v_writelane_b32 v112, 15, 12
    v_writelane_b32 v112, 10, 13
    v_writelane_b32 v112, 8, 14
    v_writelane_b32 v112, 13, 15
    v_writelane_b32 v112, 21, 16
    v_writelane_b32 v112, 22, 17
    v_writelane_b32 v112, 19, 18
    v_writelane_b32 v112, 16, 19
    v_writelane_b32 v112, 23, 20
    v_writelane_b32 v112, 17, 21
    v_writelane_b32 v112, 18, 22
    v_writelane_b32 v112, 20, 23
    v_writelane_b32 v112, 26, 24
    v_writelane_b32 v112, 29, 25
    v_writelane_b32 v112, 27, 26
    v_writelane_b32 v112, 25, 27
    v_writelane_b32 v112, 28, 28
    v_writelane_b32 v112, 30, 29
    v_writelane_b32 v112, 24, 30
    v_writelane_b32 v112, 31, 31
    v_writelane_b32 v112, 38, 32
    v_writelane_b32 v112, 33, 33
    v_writelane_b32 v112, 36, 34
    v_writelane_b32 v112, 35, 35
    v_writelane_b32 v112, 34, 36
    v_writelane_b32 v112, 32, 37
    v_writelane_b32 v112, 37, 38
    v_writelane_b32 v112, 39, 39
L_mapd:
    v_and_b32 v2, 3, v1
    v_lshrrev_b32 v3, 2, v1
    v_lshl_add_u32 v234, v2, 4, v3
    v_lshrrev_b32 v2, 5, v1
    v_lshlrev_b32 v233, 4, v2
    s_mov_b32 s68, s46
    s_mov_b32 s69, s47
    s_mov_b32 s70, 4096
    s_mov_b32 s71, 0x00020000
    s_mov_b32 s76, s48
    s_mov_b32 s77, s49
    s_mov_b32 s78, 128
    s_mov_b32 s79, 0x00020000
    v_lshlrev_b32 v7, 1, v1
    s_lshl_b32 s58, s16, 9
    s_add_u32 m0, s58, 149504
    s_mov_b32 exec_hi, 0
    buffer_load_dwordx4 v232, s[68:71], s58 offen lds
    s_mov_b32 exec_hi, -1
    buffer_load_ushort v57, v7, s[76:79], 0 offen
    s_mul_i32 s58, s17, 40960
    s_add_u32 s59, s58, 4096
    s_waitcnt vmcnt(4)
    s_barrier
    ds_read_b128 v[80:83], v164 offset:36864
    ds_read_b128 v[84:87], v165 offset:36864
    ds_read_b128 v[88:91], v166 offset:36864
    ds_read_b128 v[92:95], v167 offset:36864
    s_mov_b64 exec, s[62:63]
    ds_read_b128 v[96:99], v168 offset:36864
    s_mov_b64 exec, -1
    s_waitcnt lgkmcnt(7)
    buffer_store_dwordx4 v[152:155], v55, s[8:11], s27 offen offset:0 sc1
    s_waitcnt lgkmcnt(6)
    buffer_store_dwordx4 v[156:159], v55, s[8:11], s27 offen offset:1024 sc1
    s_mov_b32 exec_lo, s34
    s_mov_b32 exec_hi, 0
    s_waitcnt lgkmcnt(5)
    buffer_store_dwordx4 v[160:163], v55, s[8:11], s27 offen offset:2048 sc1
    s_mov_b64 exec, -1
    s_waitcnt lgkmcnt(4)
    buffer_store_dwordx4 v[80:83], v56, s[8:11], s58 offen offset:0 sc1
    s_waitcnt lgkmcnt(3)
    buffer_store_dwordx4 v[84:87], v56, s[8:11], s58 offen offset:1024 sc1
    s_waitcnt lgkmcnt(2)
    buffer_store_dwordx4 v[88:91], v56, s[8:11], s58 offen offset:2048 sc1
    s_waitcnt lgkmcnt(1)
    buffer_store_dwordx4 v[92:95], v56, s[8:11], s58 offen offset:3072 sc1
    s_mov_b32 exec_lo, s34
    s_mov_b32 exec_hi, s63
    s_waitcnt lgkmcnt(0)
    buffer_store_dwordx4 v[96:99], v56, s[8:11], s59 offen offset:0 sc1
    s_mov_b64 exec, -1
    s_mov_b32 s30, 200000
    s_waitcnt vmcnt(8)
    v_and_b32 v2, 0x30, v1
    v_and_b32 v3, 3, v1
    v_lshl_add_u32 v2, v3, 2, v2
    v_bfe_u32 v7, v1, 2, 2
    v_add_lshl_u32 v2, v2, v7, 1
    ds_write_b16 v2, v57 offset:6656
    v_lshlrev_b32 v3, 3, v3
    ds_read_b64 v[216:217], v3 offset:6656
    ds_read_b64 v[218:219], v3 offset:6688
    ds_read_b64 v[220:221], v3 offset:6720
    ds_read_b64 v[222:223], v3 offset:6752
    s_brev_b32 s59, 1
    v_not_b32 v64, v64
    v_and_or_b32 v60, v64, s59, v60
    v_not_b32 v65, v65
    v_and_or_b32 v61, v65, s59, v61
    v_not_b32 v66, v66
    v_and_or_b32 v62, v66, s59, v62
    v_not_b32 v67, v67
    v_and_or_b32 v63, v67, s59, v63
    s_waitcnt vmcnt(0)
    s_barrier
    s_cmp_eq_u32 s16, 7
    s_cbranch_scc0 L_notb
    buffer_store_dwordx4 v[60:63], v232, s[8:11], s29 offen sc1
L_notb:
    s_mov_b32 s72, s50
    s_mov_b32 s73, s51
    s_mov_b32 s74, 32768
    s_mov_b32 s75, 0x00020000
    s_lshl_b32 s58, s16, 12
    s_add_u32 m0, s58, 116736
    s_nop 0
    buffer_load_dwordx4 v232, s[72:75], s58 offen offset:0 lds
    buffer_load_dwordx4 v232, s[72:75], s58 offen offset:1024 lds
    buffer_load_dwordx4 v232, s[72:75], s58 offen offset:2048 lds
    buffer_load_dwordx4 v232, s[72:75], s58 offen offset:3072 lds
    v_and_b32 v3, 31, v1
    v_lshlrev_b32 v2, 7, v233
    v_lshl_add_u32 v2, v3, 2, v2
    v_add_u32 v2, 149504, v2
    v_add_u32 v3, 128, v2
    ds_read2st64_b32 v[144:145], v2 offset0:0 offset1:1
    ds_read2st64_b32 v[146:147], v2 offset0:2 offset1:3
    ds_read2st64_b32 v[148:149], v2 offset0:4 offset1:5
    ds_read2st64_b32 v[150:151], v2 offset0:6 offset1:7
    ds_read2st64_b32 v[152:153], v3 offset0:0 offset1:1
    ds_read2st64_b32 v[154:155], v3 offset0:2 offset1:3
    ds_read2st64_b32 v[156:157], v3 offset0:4 offset1:5
    ds_read2st64_b32 v[158:159], v3 offset0:6 offset1:7
    s_mov_b32 s58, 0xbfb8aa3b
    s_mov_b32 s59, 0xbfb8aa3b
    s_waitcnt lgkmcnt(7)
    v_lshlrev_b32 v160, 16, v144
    v_lshlrev_b32 v161, 16, v145
    v_and_b32 v162, 0xffff0000, v144
    v_and_b32 v163, 0xffff0000, v145
    v_pk_mul_f32 v[160:161], v[160:161], s[58:59]
    v_pk_mul_f32 v[162:163], v[162:163], s[58:59]
    v_cvt_pk_bf16_f32 v200, v160, v161
    v_cvt_pk_bf16_f32 v204, v162, v163
    s_waitcnt lgkmcnt(6)
    v_lshlrev_b32 v160, 16, v146
    v_lshlrev_b32 v161, 16, v147
    v_and_b32 v162, 0xffff0000, v146
    v_and_b32 v163, 0xffff0000, v147
    v_pk_mul_f32 v[160:161], v[160:161], s[58:59]
    v_pk_mul_f32 v[162:163], v[162:163], s[58:59]
    v_cvt_pk_bf16_f32 v201, v160, v161
    v_cvt_pk_bf16_f32 v205, v162, v163
    s_waitcnt lgkmcnt(5)
    v_lshlrev_b32 v160, 16, v148
    v_lshlrev_b32 v161, 16, v149
    v_and_b32 v162, 0xffff0000, v148
    v_and_b32 v163, 0xffff0000, v149
    v_pk_mul_f32 v[160:161], v[160:161], s[58:59]
    v_pk_mul_f32 v[162:163], v[162:163], s[58:59]
    v_cvt_pk_bf16_f32 v202, v160, v161
    v_cvt_pk_bf16_f32 v206, v162, v163
    s_waitcnt lgkmcnt(4)
    v_lshlrev_b32 v160, 16, v150
    v_lshlrev_b32 v161, 16, v151
    v_and_b32 v162, 0xffff0000, v150
    v_and_b32 v163, 0xffff0000, v151
    v_pk_mul_f32 v[160:161], v[160:161], s[58:59]
    v_pk_mul_f32 v[162:163], v[162:163], s[58:59]
    v_cvt_pk_bf16_f32 v203, v160, v161
    v_cvt_pk_bf16_f32 v207, v162, v163
    s_waitcnt lgkmcnt(3)
    v_lshlrev_b32 v160, 16, v152
    v_lshlrev_b32 v161, 16, v153
    v_and_b32 v162, 0xffff0000, v152
    v_and_b32 v163, 0xffff0000, v153
    v_pk_mul_f32 v[160:161], v[160:161], s[58:59]
    v_pk_mul_f32 v[162:163], v[162:163], s[58:59]
    v_cvt_pk_bf16_f32 v208, v160, v161
    v_cvt_pk_bf16_f32 v212, v162, v163
    s_waitcnt lgkmcnt(2)
    v_lshlrev_b32 v160, 16, v154
    v_lshlrev_b32 v161, 16, v155
    v_and_b32 v162, 0xffff0000, v154
    v_and_b32 v163, 0xffff0000, v155
    v_pk_mul_f32 v[160:161], v[160:161], s[58:59]
    v_pk_mul_f32 v[162:163], v[162:163], s[58:59]
    v_cvt_pk_bf16_f32 v209, v160, v161
    v_cvt_pk_bf16_f32 v213, v162, v163
    s_waitcnt lgkmcnt(1)
    v_lshlrev_b32 v160, 16, v156
    v_lshlrev_b32 v161, 16, v157
    v_and_b32 v162, 0xffff0000, v156
    v_and_b32 v163, 0xffff0000, v157
    v_pk_mul_f32 v[160:161], v[160:161], s[58:59]
    v_pk_mul_f32 v[162:163], v[162:163], s[58:59]
    v_cvt_pk_bf16_f32 v210, v160, v161
    v_cvt_pk_bf16_f32 v214, v162, v163
    s_waitcnt lgkmcnt(0)
    v_lshlrev_b32 v160, 16, v158
    v_lshlrev_b32 v161, 16, v159
    v_and_b32 v162, 0xffff0000, v158
    v_and_b32 v163, 0xffff0000, v159
    v_pk_mul_f32 v[160:161], v[160:161], s[58:59]
    v_pk_mul_f32 v[162:163], v[162:163], s[58:59]
    v_cvt_pk_bf16_f32 v211, v160, v161
    v_cvt_pk_bf16_f32 v215, v162, v163
L_poll:
    buffer_load_dword v6, v5, s[8:11], 0 offen sc1
    s_waitcnt vmcnt(0)
    v_xor_b32 v2, v6, v59
    v_cmpx_le_i32 vcc, 0, v2
    s_cbranch_execz L_polld
    s_sub_u32 s30, s30, 1
    s_cbranch_scc1 L_m_end
    s_and_b32 s58, s30, 7
    s_cbranch_scc1 L_poll
    v_mov_b32 v3, 0
    buffer_load_dword v2, v3, s[64:67], 0 offen sc1
    s_waitcnt vmcnt(0)
    v_readfirstlane_b32 s58, v2
    s_cmp_eq_u32 s58, 0
    s_cbranch_scc1 L_poll
    buffer_load_dword v6, v5, s[8:11], 0 offen sc1
    s_waitcnt vmcnt(0)
L_polld:
    s_mov_b64 exec, -1
    v_and_b32 v3, 1, v0
    v_cmp_eq_u32 vcc, 0, v3
    s_movk_i32 s26, 1280
    v_and_b32 v6, 0x7fffffff, v6
    v_lshrrev_b32 v2, 16, v6
    v_cndmask_b32 v236, 0, v2, vcc
    v_and_b32 v6, 0xffff, v6
    v_mad_u32_u24 v6, v4, s26, v6
    s_nop 1
    v_add_u32_dpp v236, v236, v236 row_shr:1 row_mask:0xf bank_mask:0xf
    s_nop 1
    v_add_u32_dpp v236, v236, v236 row_shr:2 row_mask:0xf bank_mask:0xf
    s_nop 1
    v_add_u32_dpp v236, v236, v236 row_shr:4 row_mask:0xf bank_mask:0xf
    s_nop 1
    v_add_u32_dpp v236, v236, v236 row_shr:8 row_mask:0xf bank_mask:0xf
    s_nop 1
    v_add_u32_dpp v236, v236, v236 row_bcast:15 row_mask:0xa bank_mask:0xf
    s_nop 1
    v_add_u32_dpp v236, v236, v236 row_bcast:31 row_mask:0xc bank_mask:0xf
    v_sub_u32 v235, v236, v2
    v_readlane_b32 s19, v236, 63
    v_sub_u32 v237, v6, v235
L_round:
    s_lshl_b32 s26, s16, 10
    s_add_u32 s26, s26, 8192
    v_and_b32 v2, 1, v0
    v_max_u32 v3, s24, v235
    v_add_u32 v3, v3, v2
    s_add_u32 s27, s24, 256
    v_min_u32 v4, s27, v236
    v_add_u32 v5, v237, v3
    s_lshl_b32 s27, s24, 2
    s_sub_u32 s27, s26, s27
    v_lshl_add_u32 v6, v3, 2, s27
    v_cmpx_lt_u32 vcc, v3, v4
    s_cbranch_execz L_exp_done
L_exp:
    ds_write_b32 v6, v5
    v_add_u32 v3, 2, v3
    v_add_u32 v5, 2, v5
    v_add_u32 v6, 8, v6
    v_cmpx_lt_u32 vcc, v3, v4
    s_cbranch_execnz L_exp
L_exp_done:
    s_mov_b64 exec, -1
    v_lshl_add_u32 v3, v1, 2, s26
    v_lshrrev_b32 v7, 1, v1
    v_lshl_add_u32 v4, v7, 2, s26
    ds_read_b32 v99, v3 offset:768
    ds_read_b32 v98, v3 offset:512
    ds_read_b32 v97, v3 offset:256
    ds_read_b32 v96, v3 offset:0
    ds_read_b32 v100, v4 offset:0
    ds_read_b32 v101, v4 offset:128
    ds_read_b32 v102, v4 offset:256
    ds_read_b32 v103, v4 offset:384
    ds_read_b32 v104, v4 offset:512
    ds_read_b32 v105, v4 offset:640
    ds_read_b32 v106, v4 offset:768
    ds_read_b32 v107, v4 offset:896
    s_sub_i32 s28, s19, s24
    s_max_i32 s28, s28, 0
    s_min_i32 s28, s28, 256
    v_lshlrev_b32 v2, 4, v2
    v_mov_b32 v5, 0x04000000
    s_sub_i32 s27, s28, 0
    v_cmp_gt_i32 s[36:37], s27, v1
    s_sub_i32 s27, s28, 64
    v_cmp_gt_i32 s[38:39], s27, v1
    s_sub_i32 s27, s28, 128
    v_cmp_gt_i32 s[40:41], s27, v1
    s_sub_i32 s27, s28, 192
    v_cmp_gt_i32 s[42:43], s27, v1
    s_mov_b32 s26, 10485760
    s_cmp_le_u32 s28, 192
    s_cbranch_scc1 L_sk3
    s_waitcnt lgkmcnt(11)
    v_cndmask_b32 v99, v5, v99, s[42:43]
    v_lshlrev_b32 v99, 4, v99
    buffer_load_dwordx4 v[92:95], v99, s[8:11], s26 offen sc1
L_sk3:
    s_waitcnt lgkmcnt(10)
    v_cndmask_b32 v98, v5, v98, s[40:41]
    v_lshlrev_b32 v98, 4, v98
    buffer_load_dwordx4 v[88:91], v98, s[8:11], s26 offen sc1
    s_waitcnt lgkmcnt(9)
    v_cndmask_b32 v97, v5, v97, s[38:39]
    v_lshlrev_b32 v97, 4, v97
    buffer_load_dwordx4 v[84:87], v97, s[8:11], s26 offen sc1
    s_waitcnt lgkmcnt(8)
    v_cndmask_b32 v96, v5, v96, s[36:37]
    v_lshlrev_b32 v96, 4, v96
    buffer_load_dwordx4 v[80:83], v96, s[8:11], s26 offen sc1
    s_waitcnt lgkmcnt(0)
    s_barrier
    s_sub_i32 s27, s28, 0
    v_cmp_gt_i32 vcc, s27, v7
    s_lshl_b32 s26, s16, 13
    s_add_u32 m0, s26, 16384
    v_cndmask_b32 v100, v5, v100, vcc
    v_lshl_or_b32 v100, v100, 5, v2
    buffer_load_dwordx4 v100, s[8:11], 0 offen sc1 lds
    s_sub_i32 s27, s28, 32
    v_cmp_gt_i32 vcc, s27, v7
    s_lshl_b32 s26, s16, 13
    s_add_u32 m0, s26, 17408
    v_cndmask_b32 v101, v5, v101, vcc
    v_lshl_or_b32 v101, v101, 5, v2
    buffer_load_dwordx4 v101, s[8:11], 0 offen sc1 lds
    s_add_u32 s26, s19, 255
    s_lshr_b32 s26, s26, 8
    v_mov_b32 v3, s26
    v_mov_b32 v4, 2304
    ds_max_u32 v4, v3
    s_mul_i32 s26, s16, 5
    v_add_u32 v113, s26, v1
    v_subrev_u32 v3, 40, v113
    v_min_u32 v113, v113, v3
    v_mul_u32_u24 v3, 205, v1
    v_lshrrev_b32 v3, 10, v3
    v_mul_u32_u24 v6, 5, v3
    v_sub_u32 v115, v1, v6
    s_lshr_b32 s26, s17, 5
    s_mul_i32 s26, s26, 12
    s_lshr_b32 s26, s26, 3
    v_add_u32 v3, s26, v3
    v_subrev_u32 v6, 12, v3
    v_min_u32 v3, v3, v6
    v_lshlrev_b32 v114, 2, v3
    v_mov_b32 v6, 1
    s_waitcnt vmcnt(5)
    s_mov_b64 exec, s[42:43]
    v_and_b32 v3, 0xff, v94
    ds_add_rtn_u32 v111, v95, v6 offset:0
    ds_add_u32 v3, v6 offset:2048
    s_waitcnt vmcnt(4)
    s_mov_b64 exec, s[40:41]
    v_and_b32 v3, 0xff, v90
    ds_add_rtn_u32 v110, v91, v6 offset:0
    ds_add_u32 v3, v6 offset:2048
    s_waitcnt vmcnt(3)
    s_mov_b64 exec, s[38:39]
    v_and_b32 v3, 0xff, v86
    ds_add_rtn_u32 v109, v87, v6 offset:0
    ds_add_u32 v3, v6 offset:2048
    s_waitcnt vmcnt(2)
    s_mov_b64 exec, s[36:37]
    v_and_b32 v3, 0xff, v82
    ds_add_rtn_u32 v108, v83, v6 offset:0
    ds_add_u32 v3, v6 offset:2048
    s_mov_b64 exec, -1
    v_lshlrev_b32 v3, 2, v113
    s_waitcnt lgkmcnt(0)
    s_barrier
    s_lshl_b32 s26, s2, 3
    s_add_u32 s26, s26, s16
    s_add_u32 s26, s26, s24
    s_cmp_eq_u32 s26, 7
    s_cbranch_scc0 L_noall
    s_mov_b32 s44, s54
    s_mov_b32 s45, s55
    s_mov_b32 s46, 256
    s_mov_b32 s47, 0x00020000
    v_mov_b32 v144, 0
    v_mov_b32 v145, 1
    s_mov_b64 exec, 1
    buffer_store_dword v145, v144, s[44:47], 0 offen sc1
    s_mov_b64 exec, -1
L_noall:
    ds_read_b32 v3, v3 offset:2048
    ds_read_b32 v4, v4
    s_cmp_le_u32 s28, 64
    s_cbranch_scc1 L_efd
    s_sub_i32 s27, s28, 64
    v_cmp_gt_i32 vcc, s27, v7
    s_lshl_b32 s26, s16, 13
    s_add_u32 m0, s26, 18432
    v_cndmask_b32 v102, v5, v102, vcc
    v_lshl_or_b32 v102, v102, 5, v2
    buffer_load_dwordx4 v102, s[8:11], 0 offen sc1 lds
    s_cmp_le_u32 s28, 96
    s_cbranch_scc1 L_efd
    s_sub_i32 s27, s28, 96
    v_cmp_gt_i32 vcc, s27, v7
    s_lshl_b32 s26, s16, 13
    s_add_u32 m0, s26, 19456
    v_cndmask_b32 v103, v5, v103, vcc
    v_lshl_or_b32 v103, v103, 5, v2
    buffer_load_dwordx4 v103, s[8:11], 0 offen sc1 lds
    s_cmp_le_u32 s28, 128
    s_cbranch_scc1 L_efd
    s_sub_i32 s27, s28, 128
    v_cmp_gt_i32 vcc, s27, v7
    s_lshl_b32 s26, s16, 13
    s_add_u32 m0, s26, 20480
    v_cndmask_b32 v104, v5, v104, vcc
    v_lshl_or_b32 v104, v104, 5, v2
    buffer_load_dwordx4 v104, s[8:11], 0 offen sc1 lds
    s_cmp_le_u32 s28, 160
    s_cbranch_scc1 L_efd
    s_sub_i32 s27, s28, 160
    v_cmp_gt_i32 vcc, s27, v7
    s_lshl_b32 s26, s16, 13
    s_add_u32 m0, s26, 21504
    v_cndmask_b32 v105, v5, v105, vcc
    v_lshl_or_b32 v105, v105, 5, v2
    buffer_load_dwordx4 v105, s[8:11], 0 offen sc1 lds
    s_cmp_le_u32 s28, 192
    s_cbranch_scc1 L_efd
    s_sub_i32 s27, s28, 192
    v_cmp_gt_i32 vcc, s27, v7
    s_lshl_b32 s26, s16, 13
    s_add_u32 m0, s26, 22528
    v_cndmask_b32 v106, v5, v106, vcc
    v_lshl_or_b32 v106, v106, 5, v2
    buffer_load_dwordx4 v106, s[8:11], 0 offen sc1 lds
    s_cmp_le_u32 s28, 224
    s_cbranch_scc1 L_efd
    s_sub_i32 s27, s28, 224
    v_cmp_gt_i32 vcc, s27, v7
    s_lshl_b32 s26, s16, 13
    s_add_u32 m0, s26, 23552
    v_cndmask_b32 v107, v5, v107, vcc
    v_lshl_or_b32 v107, v107, 5, v2
    buffer_load_dwordx4 v107, s[8:11], 0 offen sc1 lds
L_efd:
    v_cmp_gt_u32 vcc, 40, v1
    s_waitcnt lgkmcnt(0)
    v_readfirstlane_b32 s26, v4
    v_lshl_or_b32 v3, v3, 6, v113
    v_cndmask_b32 v3, 0, v3, vcc
    s_max_u32 s25, s25, s26
    s_cmp_lg_u32 s24, 0
    s_cbranch_scc1 L_havepos
    v_readlane_b32 s64, v3, 0
    v_readlane_b32 s65, v3, 1
    v_readlane_b32 s66, v3, 2
    v_readlane_b32 s67, v3, 3
    v_readlane_b32 s68, v3, 4
    v_cmp_lt_u32 s[70:71], s64, v3
    v_cmp_lt_u32 s[72:73], s65, v3
    v_cmp_lt_u32 s[74:75], s66, v3
    v_cmp_lt_u32 s[76:77], s67, v3
    v_cmp_lt_u32 s[78:79], s68, v3
    s_bcnt1_i32_b64 s64, s[70:71]
    s_bcnt1_i32_b64 s65, s[72:73]
    s_bcnt1_i32_b64 s66, s[74:75]
    s_bcnt1_i32_b64 s67, s[76:77]
    s_bcnt1_i32_b64 s68, s[78:79]
    v_readlane_b32 s70, v112, s64
    v_readlane_b32 s71, v112, s65
    v_readlane_b32 s72, v112, s66
    v_readlane_b32 s73, v112, s67
    v_readlane_b32 s74, v112, s68
    v_writelane_b32 v238, s70, 0
    v_writelane_b32 v238, s71, 1
    v_writelane_b32 v238, s72, 2
    v_writelane_b32 v238, s73, 3
    v_writelane_b32 v238, s74, 4
    v_lshlrev_b32 v238, 2, v238
L_havepos:
    s_mov_b64 exec, 31
    ds_write_b32 v238, v3 offset:4096
    s_mov_b64 exec, -1
    s_lshl_b32 s26, s16, 2
    v_lshl_add_u32 v3, v115, 5, s26
    v_lshlrev_b32 v4, 2, v1
    v_and_b32 v6, 7, v1
    v_cmp_gt_u32 s[34:35], s16, v6
    v_cmp_gt_u32 vcc, 40, v1
    s_and_b64 s[34:35], s[34:35], vcc
    v_cmp_gt_u32 vcc, 60, v1
    s_waitcnt lgkmcnt(0)
    s_barrier
    ds_read_b32 v3, v3 offset:4096
    ds_read_b32 v4, v4 offset:4096
    s_waitcnt lgkmcnt(1)
    v_and_b32 v3, 63, v3
    v_mad_u32_u24 v3, v3, 48, v114
    ds_read_b32 v116, v3 offset:0
    s_waitcnt lgkmcnt(1)
    v_lshrrev_b32 v4, 6, v4
    v_cndmask_b32 v118, 0, v4, s[34:35]
    s_waitcnt lgkmcnt(0)
    v_cndmask_b32 v116, 0, v116, vcc
    v_mov_b32 v117, v116
    s_nop 0
    s_nop 0
    v_add_u32_dpp v117, v117, v117 row_shr:1 row_mask:0xf bank_mask:0xf
    v_add_u32_dpp v118, v118, v118 row_shr:1 row_mask:0xf bank_mask:0xf
    s_nop 0
    v_add_u32_dpp v117, v117, v117 row_shr:2 row_mask:0xf bank_mask:0xf
    v_add_u32_dpp v118, v118, v118 row_shr:2 row_mask:0xf bank_mask:0xf
    s_nop 0
    v_add_u32_dpp v117, v117, v117 row_shr:4 row_mask:0xf bank_mask:0xf
    v_add_u32_dpp v118, v118, v118 row_shr:4 row_mask:0xf bank_mask:0xf
    s_nop 0
    v_add_u32_dpp v117, v117, v117 row_shr:8 row_mask:0xf bank_mask:0xf
    v_add_u32_dpp v118, v118, v118 row_shr:8 row_mask:0xf bank_mask:0xf
    s_nop 0
    v_add_u32_dpp v117, v117, v117 row_bcast:15 row_mask:0xa bank_mask:0xf
    v_add_u32_dpp v118, v118, v118 row_bcast:15 row_mask:0xa bank_mask:0xf
    s_nop 0
    v_add_u32_dpp v117, v117, v117 row_bcast:31 row_mask:0xc bank_mask:0xf
    v_add_u32_dpp v118, v118, v118 row_bcast:31 row_mask:0xc bank_mask:0xf
    v_sub_u32 v116, v117, v116
    v_readlane_b32 s29, v118, 63
    v_readlane_b32 s18, v117, 63
    s_min_u32 s25, s25, 157
    s_lshl_b32 s26, s29, 4
    s_add_u32 s26, s26, 81920
    v_lshl_add_u32 v116, v116, 4, s26
    v_lshlrev_b32 v4, 3, v115
    v_lshl_or_b32 v116, v116, 8, v4
    s_mov_b64 exec, vcc
    ds_write_b32 v3, v116 offset:4608
    s_mov_b64 exec, -1
    s_min_u32 s18, s18, 2048
    v_lshl_add_u32 v230, v234, 4, s26
    v_and_b32 v2, 3, v1
    v_bfe_u32 v3, v1, 3, 2
    v_lshl_add_u32 v2, v3, 2, v2
    v_lshl_add_u32 v231, v2, 4, s26
    s_lshl_b32 s26, s16, 13
    v_lshl_add_u32 v5, v1, 5, s26
    s_movk_i32 s27, 0xff
    s_waitcnt lgkmcnt(0)
    s_barrier
    s_mov_b64 exec, s[36:37]
    ds_read_b32 v96, v83 offset:4608
    s_mov_b64 exec, s[38:39]
    ds_read_b32 v97, v87 offset:4608
    s_mov_b64 exec, s[40:41]
    ds_read_b32 v98, v91 offset:4608
    s_mov_b64 exec, s[42:43]
    ds_read_b32 v99, v95 offset:4608
    s_waitcnt lgkmcnt(0)
    s_mov_b64 exec, s[36:37]
    v_bfi_b32 v82, s27, v96, v82
    v_lshrrev_b32 v96, 8, v96
    v_add_u32 v83, 0, v5
    v_lshl_add_u32 v96, v108, 4, v96
    ds_write_b128 v96, v[80:83]
    s_mov_b64 exec, s[38:39]
    v_bfi_b32 v86, s27, v97, v86
    v_lshrrev_b32 v97, 8, v97
    v_add_u32 v87, 2048, v5
    v_lshl_add_u32 v97, v109, 4, v97
    ds_write_b128 v97, v[84:87]
    s_mov_b64 exec, s[40:41]
    v_bfi_b32 v90, s27, v98, v90
    v_lshrrev_b32 v98, 8, v98
    v_add_u32 v91, 4096, v5
    v_lshl_add_u32 v98, v110, 4, v98
    ds_write_b128 v98, v[88:91]
    s_mov_b64 exec, s[42:43]
    v_bfi_b32 v94, s27, v99, v94
    v_lshrrev_b32 v99, 8, v99
    v_add_u32 v95, 6144, v5
    v_lshl_add_u32 v99, v111, 4, v99
    ds_write_b128 v99, v[92:95]
    s_mov_b64 exec, -1
    v_cmp_gt_i32 vcc, s18, v234
    v_mov_b32 v4, s32
    s_waitcnt lgkmcnt(0)
    s_barrier
    ds_read_b128 v[224:227], v230
    ds_read_b32 v229, v231 offset:12
    s_waitcnt lgkmcnt(0)
    v_cndmask_b32 v228, v4, v226, vcc
    v_and_or_b32 v229, v229, s33, v233
    v_readlane_b32 s64, v228, 0
    v_readlane_b32 s65, v228, 4
    v_readlane_b32 s66, v228, 8
    v_readlane_b32 s67, v228, 12
    v_readlane_b32 s68, v228, 16
    v_readlane_b32 s69, v228, 20
    v_readlane_b32 s70, v228, 24
    v_readlane_b32 s71, v228, 28
    s_and_b32 s80, s64, s31
    buffer_load_dwordx4 v[48:51], v232, s[4:7], s80 offen
    s_and_b32 s81, s65, s31
    buffer_load_dwordx4 v[52:55], v232, s[4:7], s81 offen
    s_and_b32 s82, s66, s31
    buffer_load_dwordx4 v[56:59], v232, s[4:7], s82 offen
    s_and_b32 s83, s67, s31
    buffer_load_dwordx4 v[60:63], v232, s[4:7], s83 offen
    s_waitcnt vmcnt(4)
    s_barrier
    s_mov_b64 exec, s[20:21]
    ds_read_b128 v[192:195], v229 offset:16384
    s_mov_b64 exec, s[22:23]
    ds_read_b128 v[196:199], v229 offset:16384
    s_mov_b64 exec, -1
    s_waitcnt lgkmcnt(0)
    ds_read_b32 v229, v231 offset:268
    v_mfma_f32_32x32x16_bf16 v[80:95], v[192:195], v[200:203], 0
    v_mfma_f32_32x32x16_bf16 v[96:111], v[192:195], v[204:207], 0
    v_mfma_f32_32x32x16_bf16 v[80:95], v[196:199], v[208:211], v[80:95]
    v_mfma_f32_32x32x16_bf16 v[96:111], v[196:199], v[212:215], v[96:111]
    s_and_b32 s80, s68, s31
    buffer_load_dwordx4 v[64:67], v232, s[4:7], s80 offen
    s_and_b32 s81, s69, s31
    buffer_load_dwordx4 v[68:71], v232, s[4:7], s81 offen
    s_and_b32 s82, s70, s31
    buffer_load_dwordx4 v[72:75], v232, s[4:7], s82 offen
    s_and_b32 s83, s71, s31
    buffer_load_dwordx4 v[76:79], v232, s[4:7], s83 offen
    s_waitcnt lgkmcnt(0)
    v_and_or_b32 v229, v229, s33, v233
    s_nop 7
    s_mov_b64 exec, s[20:21]
    ds_read_b128 v[192:195], v229 offset:16384
    s_mov_b64 exec, -1
    s_waitcnt lgkmcnt(0)
    s_cmp_lg_u32 s24, 0
    s_cbranch_scc1 L_wdone
    v_lshrrev_b32 v7, 5, v0
    v_and_b32 v3, 31, v1
    v_lshlrev_b32 v7, 11, v7
    v_add_u32 v7, 116736, v7
    v_lshl_add_u32 v2, v3, 3, v7
    ds_read_b64 v[160:161], v2 offset:0
    ds_read_b64 v[162:163], v2 offset:256
    ds_read_b64 v[164:165], v2 offset:512
    ds_read_b64 v[166:167], v2 offset:768
    ds_read_b64 v[168:169], v2 offset:1024
    ds_read_b64 v[170:171], v2 offset:1280
    ds_read_b64 v[172:173], v2 offset:1536
    ds_read_b64 v[174:175], v2 offset:1792
    s_mov_b32 s58, 0x05040100
    s_mov_b32 s59, 0x07060302
    v_bfe_u32 v3, v0, 3, 2
    v_lshl_add_u32 v7, v3, 9, v7
    v_and_b32 v3, 7, v0
    v_lshl_add_u32 v7, v3, 5, v7
    s_waitcnt lgkmcnt(0)
    v_perm_b32 v112, v162, v160, s58
    v_perm_b32 v113, v166, v164, s58
    v_perm_b32 v114, v170, v168, s58
    v_perm_b32 v115, v174, v172, s58
    ds_write_b128 v7, v[112:115] offset:0
    v_perm_b32 v116, v162, v160, s59
    v_perm_b32 v117, v166, v164, s59
    v_perm_b32 v118, v170, v168, s59
    v_perm_b32 v119, v174, v172, s59
    ds_write_b128 v7, v[116:119] offset:256
    v_perm_b32 v120, v163, v161, s58
    v_perm_b32 v121, v167, v165, s58
    v_perm_b32 v122, v171, v169, s58
    v_perm_b32 v123, v175, v173, s58
    ds_write_b128 v7, v[120:123] offset:16
    v_perm_b32 v124, v163, v161, s59
    v_perm_b32 v125, v167, v165, s59
    v_perm_b32 v126, v171, v169, s59
    v_perm_b32 v127, v175, v173, s59
    ds_write_b128 v7, v[124:127] offset:272
L_wdone:
    s_mov_b32 s30, s18
L_sb:
    v_mfma_f32_4x4x4_16b_bf16 v[144:147], v[224:225], v[216:217], 0
    v_mfma_f32_4x4x4_16b_bf16 v[148:151], v[224:225], v[218:219], 0
    v_mfma_f32_4x4x4_16b_bf16 v[152:155], v[224:225], v[220:221], 0
    v_mfma_f32_4x4x4_16b_bf16 v[156:159], v[224:225], v[222:223], 0
    v_add_u32 v230, 1024, v230
    s_sub_u32 s26, s30, 64
    v_cmp_gt_i32 s[34:35], s26, v234
    s_cmp_le_i32 s30, 0
    s_nop 0
    v_cvt_pk_bf16_f32 v184, v144, v148
    v_cvt_pk_bf16_f32 v185, v152, v156
    v_cvt_pk_bf16_f32 v186, v145, v149
    v_cvt_pk_bf16_f32 v187, v153, v157
    v_cvt_pk_bf16_f32 v188, v146, v150
    v_cvt_pk_bf16_f32 v189, v154, v158
    v_cvt_pk_bf16_f32 v190, v147, v151
    v_cvt_pk_bf16_f32 v191, v155, v159
    ds_read_b128 v[224:227], v230
    s_cbranch_scc1 L_exit
    s_setprio 3
    s_waitcnt vmcnt(4)
    v_mfma_f32_4x4x4_16b_bf16 v[144:147], v[184:185], v[48:49], 0 cbsz:4 abid:0
    v_exp_f32 v176, v80
    v_mfma_f32_4x4x4_16b_bf16 v[148:151], v[184:185], v[50:51], 0 cbsz:4 abid:0
    v_exp_f32 v180, v96
    v_mfma_f32_4x4x4_16b_bf16 v[152:155], v[184:185], v[52:53], 0 cbsz:4 abid:1
    v_exp_f32 v177, v81
    v_mfma_f32_4x4x4_16b_bf16 v[156:159], v[184:185], v[54:55], 0 cbsz:4 abid:1
    v_exp_f32 v181, v97
    v_mfma_f32_4x4x4_16b_bf16 v[160:163], v[184:185], v[56:57], 0 cbsz:4 abid:2
    v_exp_f32 v178, v82
    v_mfma_f32_4x4x4_16b_bf16 v[164:167], v[184:185], v[58:59], 0 cbsz:4 abid:2
    v_exp_f32 v182, v98
    v_mfma_f32_4x4x4_16b_bf16 v[168:171], v[184:185], v[60:61], 0 cbsz:4 abid:3
    v_exp_f32 v179, v83
    v_mfma_f32_4x4x4_16b_bf16 v[172:175], v[184:185], v[62:63], 0 cbsz:4 abid:3
    v_exp_f32 v183, v99
    v_readlane_b32 s72, v228, 32
    v_readlane_b32 s73, v228, 36
    v_readlane_b32 s74, v228, 40
    v_readlane_b32 s75, v228, 44
    s_and_b32 s80, s72, s31
    v_pk_add_f32 v[176:177], v[176:177], 1.0 op_sel_hi:[1,0]
    s_and_b32 s81, s73, s31
    v_pk_add_f32 v[178:179], v[178:179], 1.0 op_sel_hi:[1,0]
    s_and_b32 s82, s74, s31
    v_pk_add_f32 v[180:181], v[180:181], 1.0 op_sel_hi:[1,0]
    s_and_b32 s83, s75, s31
    v_pk_add_f32 v[182:183], v[182:183], 1.0 op_sel_hi:[1,0]
    v_mfma_f32_32x32x16_bf16 v[112:127], v[192:195], v[200:203], 0
    v_rcp_f32 v176, v176
    v_rcp_f32 v177, v177
    v_rcp_f32 v178, v178
    v_rcp_f32 v179, v179
    v_rcp_f32 v180, v180
    buffer_load_dwordx4 v[48:51], v232, s[4:7], s80 offen
    v_rcp_f32 v181, v181
    buffer_load_dwordx4 v[52:55], v232, s[4:7], s81 offen
    v_rcp_f32 v182, v182
    buffer_load_dwordx4 v[56:59], v232, s[4:7], s82 offen
    v_rcp_f32 v183, v183
    buffer_load_dwordx4 v[60:63], v232, s[4:7], s83 offen
    s_cmp_le_i32 s30, 4
    s_mov_b64 exec, s[22:23]
    ds_read_b128 v[196:199], v229 offset:16384
    s_mov_b64 exec, -1
    ds_read_b32 v2, v231 offset:524
    v_pk_mul_f32 v[176:177], v[176:177], v[80:81]
    v_pk_mul_f32 v[178:179], v[178:179], v[82:83]
    v_pk_mul_f32 v[180:181], v[180:181], v[96:97]
    v_pk_mul_f32 v[182:183], v[182:183], v[98:99]
    s_set_gpr_idx_on s64, gpr_idx(SRC2,DST)
    v_pk_fma_f32 v[8:9], v[176:177], v[144:145], v[8:9] op_sel:[0,0,0] op_sel_hi:[0,1,1]
    v_pk_fma_f32 v[10:11], v[176:177], v[146:147], v[10:11] op_sel:[0,0,0] op_sel_hi:[0,1,1]
    v_pk_fma_f32 v[12:13], v[180:181], v[148:149], v[12:13] op_sel:[0,0,0] op_sel_hi:[0,1,1]
    v_pk_fma_f32 v[14:15], v[180:181], v[150:151], v[14:15] op_sel:[0,0,0] op_sel_hi:[0,1,1]
    s_set_gpr_idx_idx s65
    v_pk_fma_f32 v[8:9], v[176:177], v[152:153], v[8:9] op_sel:[1,0,0] op_sel_hi:[1,1,1]
    v_pk_fma_f32 v[10:11], v[176:177], v[154:155], v[10:11] op_sel:[1,0,0] op_sel_hi:[1,1,1]
    v_pk_fma_f32 v[12:13], v[180:181], v[156:157], v[12:13] op_sel:[1,0,0] op_sel_hi:[1,1,1]
    v_pk_fma_f32 v[14:15], v[180:181], v[158:159], v[14:15] op_sel:[1,0,0] op_sel_hi:[1,1,1]
    s_set_gpr_idx_idx s66
    v_pk_fma_f32 v[8:9], v[178:179], v[160:161], v[8:9] op_sel:[0,0,0] op_sel_hi:[0,1,1]
    v_pk_fma_f32 v[10:11], v[178:179], v[162:163], v[10:11] op_sel:[0,0,0] op_sel_hi:[0,1,1]
    v_pk_fma_f32 v[12:13], v[182:183], v[164:165], v[12:13] op_sel:[0,0,0] op_sel_hi:[0,1,1]
    v_pk_fma_f32 v[14:15], v[182:183], v[166:167], v[14:15] op_sel:[0,0,0] op_sel_hi:[0,1,1]
    s_set_gpr_idx_idx s67
    v_pk_fma_f32 v[8:9], v[178:179], v[168:169], v[8:9] op_sel:[1,0,0] op_sel_hi:[1,1,1]
    v_pk_fma_f32 v[10:11], v[178:179], v[170:171], v[10:11] op_sel:[1,0,0] op_sel_hi:[1,1,1]
    v_pk_fma_f32 v[12:13], v[182:183], v[172:173], v[12:13] op_sel:[1,0,0] op_sel_hi:[1,1,1]
    v_pk_fma_f32 v[14:15], v[182:183], v[174:175], v[14:15] op_sel:[1,0,0] op_sel_hi:[1,1,1]
    s_set_gpr_idx_off
    s_cbranch_scc1 L_exit
    s_waitcnt vmcnt(4)
    v_mfma_f32_4x4x4_16b_bf16 v[144:147], v[184:185], v[64:65], 0 cbsz:4 abid:4
    v_exp_f32 v176, v84
    v_mfma_f32_4x4x4_16b_bf16 v[148:151], v[184:185], v[66:67], 0 cbsz:4 abid:4
    v_exp_f32 v180, v100
    v_mfma_f32_4x4x4_16b_bf16 v[152:155], v[184:185], v[68:69], 0 cbsz:4 abid:5
    v_exp_f32 v177, v85
    v_mfma_f32_4x4x4_16b_bf16 v[156:159], v[184:185], v[70:71], 0 cbsz:4 abid:5
    v_exp_f32 v181, v101
    v_mfma_f32_4x4x4_16b_bf16 v[160:163], v[184:185], v[72:73], 0 cbsz:4 abid:6
    v_exp_f32 v178, v86
    v_mfma_f32_4x4x4_16b_bf16 v[164:167], v[184:185], v[74:75], 0 cbsz:4 abid:6
    v_exp_f32 v182, v102
    v_mfma_f32_4x4x4_16b_bf16 v[168:171], v[184:185], v[76:77], 0 cbsz:4 abid:7
    v_exp_f32 v179, v87
    v_mfma_f32_4x4x4_16b_bf16 v[172:175], v[184:185], v[78:79], 0 cbsz:4 abid:7
    v_exp_f32 v183, v103
    v_readlane_b32 s76, v228, 48
    v_readlane_b32 s77, v228, 52
    v_readlane_b32 s78, v228, 56
    v_readlane_b32 s79, v228, 60
    s_and_b32 s80, s76, s31
    v_pk_add_f32 v[176:177], v[176:177], 1.0 op_sel_hi:[1,0]
    s_and_b32 s81, s77, s31
    v_pk_add_f32 v[178:179], v[178:179], 1.0 op_sel_hi:[1,0]
    s_and_b32 s82, s78, s31
    v_pk_add_f32 v[180:181], v[180:181], 1.0 op_sel_hi:[1,0]
    s_and_b32 s83, s79, s31
    v_pk_add_f32 v[182:183], v[182:183], 1.0 op_sel_hi:[1,0]
    v_mfma_f32_32x32x16_bf16 v[128:143], v[192:195], v[204:207], 0
    v_rcp_f32 v176, v176
    v_rcp_f32 v177, v177
    v_rcp_f32 v178, v178
    v_rcp_f32 v179, v179
    v_rcp_f32 v180, v180
    buffer_load_dwordx4 v[64:67], v232, s[4:7], s80 offen
    v_rcp_f32 v181, v181
    buffer_load_dwordx4 v[68:71], v232, s[4:7], s81 offen
    v_rcp_f32 v182, v182
    buffer_load_dwordx4 v[72:75], v232, s[4:7], s82 offen
    v_rcp_f32 v183, v183
    buffer_load_dwordx4 v[76:79], v232, s[4:7], s83 offen
    s_cmp_le_i32 s30, 8
    s_waitcnt lgkmcnt(0)
    v_pk_mul_f32 v[176:177], v[176:177], v[84:85]
    v_pk_mul_f32 v[178:179], v[178:179], v[86:87]
    v_pk_mul_f32 v[180:181], v[180:181], v[100:101]
    v_pk_mul_f32 v[182:183], v[182:183], v[102:103]
    s_set_gpr_idx_on s68, gpr_idx(SRC2,DST)
    v_pk_fma_f32 v[8:9], v[176:177], v[144:145], v[8:9] op_sel:[0,0,0] op_sel_hi:[0,1,1]
    v_pk_fma_f32 v[10:11], v[176:177], v[146:147], v[10:11] op_sel:[0,0,0] op_sel_hi:[0,1,1]
    v_pk_fma_f32 v[12:13], v[180:181], v[148:149], v[12:13] op_sel:[0,0,0] op_sel_hi:[0,1,1]
    v_pk_fma_f32 v[14:15], v[180:181], v[150:151], v[14:15] op_sel:[0,0,0] op_sel_hi:[0,1,1]
    s_set_gpr_idx_idx s69
    v_pk_fma_f32 v[8:9], v[176:177], v[152:153], v[8:9] op_sel:[1,0,0] op_sel_hi:[1,1,1]
    v_pk_fma_f32 v[10:11], v[176:177], v[154:155], v[10:11] op_sel:[1,0,0] op_sel_hi:[1,1,1]
    v_pk_fma_f32 v[12:13], v[180:181], v[156:157], v[12:13] op_sel:[1,0,0] op_sel_hi:[1,1,1]
    v_pk_fma_f32 v[14:15], v[180:181], v[158:159], v[14:15] op_sel:[1,0,0] op_sel_hi:[1,1,1]
    s_set_gpr_idx_idx s70
    v_pk_fma_f32 v[8:9], v[178:179], v[160:161], v[8:9] op_sel:[0,0,0] op_sel_hi:[0,1,1]
    v_pk_fma_f32 v[10:11], v[178:179], v[162:163], v[10:11] op_sel:[0,0,0] op_sel_hi:[0,1,1]
    v_pk_fma_f32 v[12:13], v[182:183], v[164:165], v[12:13] op_sel:[0,0,0] op_sel_hi:[0,1,1]
    v_pk_fma_f32 v[14:15], v[182:183], v[166:167], v[14:15] op_sel:[0,0,0] op_sel_hi:[0,1,1]
    s_set_gpr_idx_idx s71
    v_pk_fma_f32 v[8:9], v[178:179], v[168:169], v[8:9] op_sel:[1,0,0] op_sel_hi:[1,1,1]
    v_pk_fma_f32 v[10:11], v[178:179], v[170:171], v[10:11] op_sel:[1,0,0] op_sel_hi:[1,1,1]
    v_pk_fma_f32 v[12:13], v[182:183], v[172:173], v[12:13] op_sel:[1,0,0] op_sel_hi:[1,1,1]
    v_pk_fma_f32 v[14:15], v[182:183], v[174:175], v[14:15] op_sel:[1,0,0] op_sel_hi:[1,1,1]
    s_set_gpr_idx_off
    s_cbranch_scc1 L_exit
    s_setprio 2
    s_waitcnt vmcnt(4)
    v_mfma_f32_4x4x4_16b_bf16 v[144:147], v[184:185], v[48:49], 0 cbsz:4 abid:8
    v_exp_f32 v176, v88
    v_mfma_f32_4x4x4_16b_bf16 v[148:151], v[184:185], v[50:51], 0 cbsz:4 abid:8
    v_exp_f32 v180, v104
    v_mfma_f32_4x4x4_16b_bf16 v[152:155], v[184:185], v[52:53], 0 cbsz:4 abid:9
    v_exp_f32 v177, v89
    v_mfma_f32_4x4x4_16b_bf16 v[156:159], v[184:185], v[54:55], 0 cbsz:4 abid:9
    v_exp_f32 v181, v105
    v_mfma_f32_4x4x4_16b_bf16 v[160:163], v[184:185], v[56:57], 0 cbsz:4 abid:10
    v_exp_f32 v178, v90
    v_mfma_f32_4x4x4_16b_bf16 v[164:167], v[184:185], v[58:59], 0 cbsz:4 abid:10
    v_exp_f32 v182, v106
    v_mfma_f32_4x4x4_16b_bf16 v[168:171], v[184:185], v[60:61], 0 cbsz:4 abid:11
    v_exp_f32 v179, v91
    v_mfma_f32_4x4x4_16b_bf16 v[172:175], v[184:185], v[62:63], 0 cbsz:4 abid:11
    v_exp_f32 v183, v107
    v_readlane_b32 s64, v228, 1
    v_readlane_b32 s65, v228, 5
    v_readlane_b32 s66, v228, 9
    v_readlane_b32 s67, v228, 13
    v_and_or_b32 v229, v2, s33, v233
    s_and_b32 s80, s64, s31
    v_pk_add_f32 v[176:177], v[176:177], 1.0 op_sel_hi:[1,0]
    s_and_b32 s81, s65, s31
    v_pk_add_f32 v[178:179], v[178:179], 1.0 op_sel_hi:[1,0]
    s_and_b32 s82, s66, s31
    v_pk_add_f32 v[180:181], v[180:181], 1.0 op_sel_hi:[1,0]
    s_and_b32 s83, s67, s31
    v_pk_add_f32 v[182:183], v[182:183], 1.0 op_sel_hi:[1,0]
    v_mfma_f32_32x32x16_bf16 v[112:127], v[196:199], v[208:211], v[112:127]
    v_rcp_f32 v176, v176
    v_rcp_f32 v177, v177
    v_rcp_f32 v178, v178
    v_rcp_f32 v179, v179
    v_rcp_f32 v180, v180
    buffer_load_dwordx4 v[48:51], v232, s[4:7], s80 offen
    v_rcp_f32 v181, v181
    buffer_load_dwordx4 v[52:55], v232, s[4:7], s81 offen
    v_rcp_f32 v182, v182
    buffer_load_dwordx4 v[56:59], v232, s[4:7], s82 offen
    v_rcp_f32 v183, v183
    buffer_load_dwordx4 v[60:63], v232, s[4:7], s83 offen
    s_cmp_le_i32 s30, 12
    s_mov_b64 exec, s[20:21]
    ds_read_b128 v[192:195], v229 offset:16384
    s_mov_b64 exec, -1
    v_pk_mul_f32 v[176:177], v[176:177], v[88:89]
    v_pk_mul_f32 v[178:179], v[178:179], v[90:91]
    v_pk_mul_f32 v[180:181], v[180:181], v[104:105]
    v_pk_mul_f32 v[182:183], v[182:183], v[106:107]
    s_set_gpr_idx_on s72, gpr_idx(SRC2,DST)
    v_pk_fma_f32 v[8:9], v[176:177], v[144:145], v[8:9] op_sel:[0,0,0] op_sel_hi:[0,1,1]
    v_pk_fma_f32 v[10:11], v[176:177], v[146:147], v[10:11] op_sel:[0,0,0] op_sel_hi:[0,1,1]
    v_pk_fma_f32 v[12:13], v[180:181], v[148:149], v[12:13] op_sel:[0,0,0] op_sel_hi:[0,1,1]
    v_pk_fma_f32 v[14:15], v[180:181], v[150:151], v[14:15] op_sel:[0,0,0] op_sel_hi:[0,1,1]
    s_set_gpr_idx_idx s73
    v_pk_fma_f32 v[8:9], v[176:177], v[152:153], v[8:9] op_sel:[1,0,0] op_sel_hi:[1,1,1]
    v_pk_fma_f32 v[10:11], v[176:177], v[154:155], v[10:11] op_sel:[1,0,0] op_sel_hi:[1,1,1]
    v_pk_fma_f32 v[12:13], v[180:181], v[156:157], v[12:13] op_sel:[1,0,0] op_sel_hi:[1,1,1]
    v_pk_fma_f32 v[14:15], v[180:181], v[158:159], v[14:15] op_sel:[1,0,0] op_sel_hi:[1,1,1]
    s_set_gpr_idx_idx s74
    v_pk_fma_f32 v[8:9], v[178:179], v[160:161], v[8:9] op_sel:[0,0,0] op_sel_hi:[0,1,1]
    v_pk_fma_f32 v[10:11], v[178:179], v[162:163], v[10:11] op_sel:[0,0,0] op_sel_hi:[0,1,1]
    v_pk_fma_f32 v[12:13], v[182:183], v[164:165], v[12:13] op_sel:[0,0,0] op_sel_hi:[0,1,1]
    v_pk_fma_f32 v[14:15], v[182:183], v[166:167], v[14:15] op_sel:[0,0,0] op_sel_hi:[0,1,1]
    s_set_gpr_idx_idx s75
    v_pk_fma_f32 v[8:9], v[178:179], v[168:169], v[8:9] op_sel:[1,0,0] op_sel_hi:[1,1,1]
    v_pk_fma_f32 v[10:11], v[178:179], v[170:171], v[10:11] op_sel:[1,0,0] op_sel_hi:[1,1,1]
    v_pk_fma_f32 v[12:13], v[182:183], v[172:173], v[12:13] op_sel:[1,0,0] op_sel_hi:[1,1,1]
    v_pk_fma_f32 v[14:15], v[182:183], v[174:175], v[14:15] op_sel:[1,0,0] op_sel_hi:[1,1,1]
    s_set_gpr_idx_off
    s_cbranch_scc1 L_exit
    s_waitcnt vmcnt(4)
    v_mfma_f32_4x4x4_16b_bf16 v[144:147], v[184:185], v[64:65], 0 cbsz:4 abid:12
    v_exp_f32 v176, v92
    v_mfma_f32_4x4x4_16b_bf16 v[148:151], v[184:185], v[66:67], 0 cbsz:4 abid:12
    v_exp_f32 v180, v108
    v_mfma_f32_4x4x4_16b_bf16 v[152:155], v[184:185], v[68:69], 0 cbsz:4 abid:13
    v_exp_f32 v177, v93
    v_mfma_f32_4x4x4_16b_bf16 v[156:159], v[184:185], v[70:71], 0 cbsz:4 abid:13
    v_exp_f32 v181, v109
    v_mfma_f32_4x4x4_16b_bf16 v[160:163], v[184:185], v[72:73], 0 cbsz:4 abid:14
    v_exp_f32 v178, v94
    v_mfma_f32_4x4x4_16b_bf16 v[164:167], v[184:185], v[74:75], 0 cbsz:4 abid:14
    v_exp_f32 v182, v110
    v_mfma_f32_4x4x4_16b_bf16 v[168:171], v[184:185], v[76:77], 0 cbsz:4 abid:15
    v_exp_f32 v179, v95
    v_mfma_f32_4x4x4_16b_bf16 v[172:175], v[184:185], v[78:79], 0 cbsz:4 abid:15
    v_exp_f32 v183, v111
    v_readlane_b32 s68, v228, 17
    v_readlane_b32 s69, v228, 21
    v_readlane_b32 s70, v228, 25
    v_readlane_b32 s71, v228, 29
    s_and_b32 s80, s68, s31
    v_pk_add_f32 v[176:177], v[176:177], 1.0 op_sel_hi:[1,0]
    s_and_b32 s81, s69, s31
    v_pk_add_f32 v[178:179], v[178:179], 1.0 op_sel_hi:[1,0]
    s_and_b32 s82, s70, s31
    v_pk_add_f32 v[180:181], v[180:181], 1.0 op_sel_hi:[1,0]
    s_and_b32 s83, s71, s31
    v_pk_add_f32 v[182:183], v[182:183], 1.0 op_sel_hi:[1,0]
    v_mfma_f32_32x32x16_bf16 v[128:143], v[196:199], v[212:215], v[128:143]
    v_rcp_f32 v176, v176
    v_rcp_f32 v177, v177
    v_rcp_f32 v178, v178
    v_rcp_f32 v179, v179
    v_rcp_f32 v180, v180
    buffer_load_dwordx4 v[64:67], v232, s[4:7], s80 offen
    v_rcp_f32 v181, v181
    buffer_load_dwordx4 v[68:71], v232, s[4:7], s81 offen
    v_rcp_f32 v182, v182
    buffer_load_dwordx4 v[72:75], v232, s[4:7], s82 offen
    v_rcp_f32 v183, v183
    buffer_load_dwordx4 v[76:79], v232, s[4:7], s83 offen
    s_cmp_le_i32 s30, 16
    s_waitcnt lgkmcnt(0)
    v_pk_mul_f32 v[176:177], v[176:177], v[92:93]
    v_pk_mul_f32 v[178:179], v[178:179], v[94:95]
    v_pk_mul_f32 v[180:181], v[180:181], v[108:109]
    v_pk_mul_f32 v[182:183], v[182:183], v[110:111]
    s_set_gpr_idx_on s76, gpr_idx(SRC2,DST)
    v_pk_fma_f32 v[8:9], v[176:177], v[144:145], v[8:9] op_sel:[0,0,0] op_sel_hi:[0,1,1]
    v_pk_fma_f32 v[10:11], v[176:177], v[146:147], v[10:11] op_sel:[0,0,0] op_sel_hi:[0,1,1]
    v_pk_fma_f32 v[12:13], v[180:181], v[148:149], v[12:13] op_sel:[0,0,0] op_sel_hi:[0,1,1]
    v_pk_fma_f32 v[14:15], v[180:181], v[150:151], v[14:15] op_sel:[0,0,0] op_sel_hi:[0,1,1]
    s_set_gpr_idx_idx s77
    v_pk_fma_f32 v[8:9], v[176:177], v[152:153], v[8:9] op_sel:[1,0,0] op_sel_hi:[1,1,1]
    v_pk_fma_f32 v[10:11], v[176:177], v[154:155], v[10:11] op_sel:[1,0,0] op_sel_hi:[1,1,1]
    v_pk_fma_f32 v[12:13], v[180:181], v[156:157], v[12:13] op_sel:[1,0,0] op_sel_hi:[1,1,1]
    v_pk_fma_f32 v[14:15], v[180:181], v[158:159], v[14:15] op_sel:[1,0,0] op_sel_hi:[1,1,1]
    s_set_gpr_idx_idx s78
    v_pk_fma_f32 v[8:9], v[178:179], v[160:161], v[8:9] op_sel:[0,0,0] op_sel_hi:[0,1,1]
    v_pk_fma_f32 v[10:11], v[178:179], v[162:163], v[10:11] op_sel:[0,0,0] op_sel_hi:[0,1,1]
    v_pk_fma_f32 v[12:13], v[182:183], v[164:165], v[12:13] op_sel:[0,0,0] op_sel_hi:[0,1,1]
    v_pk_fma_f32 v[14:15], v[182:183], v[166:167], v[14:15] op_sel:[0,0,0] op_sel_hi:[0,1,1]
    s_set_gpr_idx_idx s79
    v_pk_fma_f32 v[8:9], v[178:179], v[168:169], v[8:9] op_sel:[1,0,0] op_sel_hi:[1,1,1]
    v_pk_fma_f32 v[10:11], v[178:179], v[170:171], v[10:11] op_sel:[1,0,0] op_sel_hi:[1,1,1]
    v_pk_fma_f32 v[12:13], v[182:183], v[172:173], v[12:13] op_sel:[1,0,0] op_sel_hi:[1,1,1]
    v_pk_fma_f32 v[14:15], v[182:183], v[174:175], v[14:15] op_sel:[1,0,0] op_sel_hi:[1,1,1]
    s_set_gpr_idx_off
    s_cbranch_scc1 L_exit
    s_setprio 1
    s_waitcnt vmcnt(4)
    v_mfma_f32_4x4x4_16b_bf16 v[144:147], v[186:187], v[48:49], 0 cbsz:4 abid:0
    v_exp_f32 v176, v112
    v_mfma_f32_4x4x4_16b_bf16 v[148:151], v[186:187], v[50:51], 0 cbsz:4 abid:0
    v_exp_f32 v180, v128
    v_mfma_f32_4x4x4_16b_bf16 v[152:155], v[186:187], v[52:53], 0 cbsz:4 abid:1
    v_exp_f32 v177, v113
    v_mfma_f32_4x4x4_16b_bf16 v[156:159], v[186:187], v[54:55], 0 cbsz:4 abid:1
    v_exp_f32 v181, v129
    v_mfma_f32_4x4x4_16b_bf16 v[160:163], v[186:187], v[56:57], 0 cbsz:4 abid:2
    v_exp_f32 v178, v114
    v_mfma_f32_4x4x4_16b_bf16 v[164:167], v[186:187], v[58:59], 0 cbsz:4 abid:2
    v_exp_f32 v182, v130
    v_mfma_f32_4x4x4_16b_bf16 v[168:171], v[186:187], v[60:61], 0 cbsz:4 abid:3
    v_exp_f32 v179, v115
    v_mfma_f32_4x4x4_16b_bf16 v[172:175], v[186:187], v[62:63], 0 cbsz:4 abid:3
    v_exp_f32 v183, v131
    v_readlane_b32 s72, v228, 33
    v_readlane_b32 s73, v228, 37
    v_readlane_b32 s74, v228, 41
    v_readlane_b32 s75, v228, 45
    s_and_b32 s80, s72, s31
    v_pk_add_f32 v[176:177], v[176:177], 1.0 op_sel_hi:[1,0]
    s_and_b32 s81, s73, s31
    v_pk_add_f32 v[178:179], v[178:179], 1.0 op_sel_hi:[1,0]
    s_and_b32 s82, s74, s31
    v_pk_add_f32 v[180:181], v[180:181], 1.0 op_sel_hi:[1,0]
    s_and_b32 s83, s75, s31
    v_pk_add_f32 v[182:183], v[182:183], 1.0 op_sel_hi:[1,0]
    v_mfma_f32_32x32x16_bf16 v[80:95], v[192:195], v[200:203], 0
    v_rcp_f32 v176, v176
    v_rcp_f32 v177, v177
    v_rcp_f32 v178, v178
    v_rcp_f32 v179, v179
    v_rcp_f32 v180, v180
    buffer_load_dwordx4 v[48:51], v232, s[4:7], s80 offen
    v_rcp_f32 v181, v181
    buffer_load_dwordx4 v[52:55], v232, s[4:7], s81 offen
    v_rcp_f32 v182, v182
    buffer_load_dwordx4 v[56:59], v232, s[4:7], s82 offen
    v_rcp_f32 v183, v183
    buffer_load_dwordx4 v[60:63], v232, s[4:7], s83 offen
    s_cmp_le_i32 s30, 20
    s_mov_b64 exec, s[22:23]
    ds_read_b128 v[196:199], v229 offset:16384
    s_mov_b64 exec, -1
    ds_read_b32 v2, v231 offset:780
    v_pk_mul_f32 v[176:177], v[176:177], v[112:113]
    v_pk_mul_f32 v[178:179], v[178:179], v[114:115]
    v_pk_mul_f32 v[180:181], v[180:181], v[128:129]
    v_pk_mul_f32 v[182:183], v[182:183], v[130:131]
    s_set_gpr_idx_on s64, gpr_idx(SRC2,DST)
    v_pk_fma_f32 v[8:9], v[176:177], v[144:145], v[8:9] op_sel:[0,0,0] op_sel_hi:[0,1,1]
    v_pk_fma_f32 v[10:11], v[176:177], v[146:147], v[10:11] op_sel:[0,0,0] op_sel_hi:[0,1,1]
    v_pk_fma_f32 v[12:13], v[180:181], v[148:149], v[12:13] op_sel:[0,0,0] op_sel_hi:[0,1,1]
    v_pk_fma_f32 v[14:15], v[180:181], v[150:151], v[14:15] op_sel:[0,0,0] op_sel_hi:[0,1,1]
    s_set_gpr_idx_idx s65
    v_pk_fma_f32 v[8:9], v[176:177], v[152:153], v[8:9] op_sel:[1,0,0] op_sel_hi:[1,1,1]
    v_pk_fma_f32 v[10:11], v[176:177], v[154:155], v[10:11] op_sel:[1,0,0] op_sel_hi:[1,1,1]
    v_pk_fma_f32 v[12:13], v[180:181], v[156:157], v[12:13] op_sel:[1,0,0] op_sel_hi:[1,1,1]
    v_pk_fma_f32 v[14:15], v[180:181], v[158:159], v[14:15] op_sel:[1,0,0] op_sel_hi:[1,1,1]
    s_set_gpr_idx_idx s66
    v_pk_fma_f32 v[8:9], v[178:179], v[160:161], v[8:9] op_sel:[0,0,0] op_sel_hi:[0,1,1]
    v_pk_fma_f32 v[10:11], v[178:179], v[162:163], v[10:11] op_sel:[0,0,0] op_sel_hi:[0,1,1]
    v_pk_fma_f32 v[12:13], v[182:183], v[164:165], v[12:13] op_sel:[0,0,0] op_sel_hi:[0,1,1]
    v_pk_fma_f32 v[14:15], v[182:183], v[166:167], v[14:15] op_sel:[0,0,0] op_sel_hi:[0,1,1]
    s_set_gpr_idx_idx s67
    v_pk_fma_f32 v[8:9], v[178:179], v[168:169], v[8:9] op_sel:[1,0,0] op_sel_hi:[1,1,1]
    v_pk_fma_f32 v[10:11], v[178:179], v[170:171], v[10:11] op_sel:[1,0,0] op_sel_hi:[1,1,1]
    v_pk_fma_f32 v[12:13], v[182:183], v[172:173], v[12:13] op_sel:[1,0,0] op_sel_hi:[1,1,1]
    v_pk_fma_f32 v[14:15], v[182:183], v[174:175], v[14:15] op_sel:[1,0,0] op_sel_hi:[1,1,1]
    s_set_gpr_idx_off
    s_cbranch_scc1 L_exit
    s_waitcnt vmcnt(4)
    v_mfma_f32_4x4x4_16b_bf16 v[144:147], v[186:187], v[64:65], 0 cbsz:4 abid:4
    v_exp_f32 v176, v116
    v_mfma_f32_4x4x4_16b_bf16 v[148:151], v[186:187], v[66:67], 0 cbsz:4 abid:4
    v_exp_f32 v180, v132
    v_mfma_f32_4x4x4_16b_bf16 v[152:155], v[186:187], v[68:69], 0 cbsz:4 abid:5
    v_exp_f32 v177, v117
    v_mfma_f32_4x4x4_16b_bf16 v[156:159], v[186:187], v[70:71], 0 cbsz:4 abid:5
    v_exp_f32 v181, v133
    v_mfma_f32_4x4x4_16b_bf16 v[160:163], v[186:187], v[72:73], 0 cbsz:4 abid:6
    v_exp_f32 v178, v118
    v_mfma_f32_4x4x4_16b_bf16 v[164:167], v[186:187], v[74:75], 0 cbsz:4 abid:6
    v_exp_f32 v182, v134
    v_mfma_f32_4x4x4_16b_bf16 v[168:171], v[186:187], v[76:77], 0 cbsz:4 abid:7
    v_exp_f32 v179, v119
    v_mfma_f32_4x4x4_16b_bf16 v[172:175], v[186:187], v[78:79], 0 cbsz:4 abid:7
    v_exp_f32 v183, v135
    v_readlane_b32 s76, v228, 49
    v_readlane_b32 s77, v228, 53
    v_readlane_b32 s78, v228, 57
    v_readlane_b32 s79, v228, 61
    s_and_b32 s80, s76, s31
    v_pk_add_f32 v[176:177], v[176:177], 1.0 op_sel_hi:[1,0]
    s_and_b32 s81, s77, s31
    v_pk_add_f32 v[178:179], v[178:179], 1.0 op_sel_hi:[1,0]
    s_and_b32 s82, s78, s31
    v_pk_add_f32 v[180:181], v[180:181], 1.0 op_sel_hi:[1,0]
    s_and_b32 s83, s79, s31
    v_pk_add_f32 v[182:183], v[182:183], 1.0 op_sel_hi:[1,0]
    v_mfma_f32_32x32x16_bf16 v[96:111], v[192:195], v[204:207], 0
    v_rcp_f32 v176, v176
    v_rcp_f32 v177, v177
    v_rcp_f32 v178, v178
    v_rcp_f32 v179, v179
    v_rcp_f32 v180, v180
    buffer_load_dwordx4 v[64:67], v232, s[4:7], s80 offen
    v_rcp_f32 v181, v181
    buffer_load_dwordx4 v[68:71], v232, s[4:7], s81 offen
    v_rcp_f32 v182, v182
    buffer_load_dwordx4 v[72:75], v232, s[4:7], s82 offen
    v_rcp_f32 v183, v183
    buffer_load_dwordx4 v[76:79], v232, s[4:7], s83 offen
    s_cmp_le_i32 s30, 24
    s_waitcnt lgkmcnt(0)
    v_pk_mul_f32 v[176:177], v[176:177], v[116:117]
    v_pk_mul_f32 v[178:179], v[178:179], v[118:119]
    v_pk_mul_f32 v[180:181], v[180:181], v[132:133]
    v_pk_mul_f32 v[182:183], v[182:183], v[134:135]
    s_set_gpr_idx_on s68, gpr_idx(SRC2,DST)
    v_pk_fma_f32 v[8:9], v[176:177], v[144:145], v[8:9] op_sel:[0,0,0] op_sel_hi:[0,1,1]
    v_pk_fma_f32 v[10:11], v[176:177], v[146:147], v[10:11] op_sel:[0,0,0] op_sel_hi:[0,1,1]
    v_pk_fma_f32 v[12:13], v[180:181], v[148:149], v[12:13] op_sel:[0,0,0] op_sel_hi:[0,1,1]
    v_pk_fma_f32 v[14:15], v[180:181], v[150:151], v[14:15] op_sel:[0,0,0] op_sel_hi:[0,1,1]
    s_set_gpr_idx_idx s69
    v_pk_fma_f32 v[8:9], v[176:177], v[152:153], v[8:9] op_sel:[1,0,0] op_sel_hi:[1,1,1]
    v_pk_fma_f32 v[10:11], v[176:177], v[154:155], v[10:11] op_sel:[1,0,0] op_sel_hi:[1,1,1]
    v_pk_fma_f32 v[12:13], v[180:181], v[156:157], v[12:13] op_sel:[1,0,0] op_sel_hi:[1,1,1]
    v_pk_fma_f32 v[14:15], v[180:181], v[158:159], v[14:15] op_sel:[1,0,0] op_sel_hi:[1,1,1]
    s_set_gpr_idx_idx s70
    v_pk_fma_f32 v[8:9], v[178:179], v[160:161], v[8:9] op_sel:[0,0,0] op_sel_hi:[0,1,1]
    v_pk_fma_f32 v[10:11], v[178:179], v[162:163], v[10:11] op_sel:[0,0,0] op_sel_hi:[0,1,1]
    v_pk_fma_f32 v[12:13], v[182:183], v[164:165], v[12:13] op_sel:[0,0,0] op_sel_hi:[0,1,1]
    v_pk_fma_f32 v[14:15], v[182:183], v[166:167], v[14:15] op_sel:[0,0,0] op_sel_hi:[0,1,1]
    s_set_gpr_idx_idx s71
    v_pk_fma_f32 v[8:9], v[178:179], v[168:169], v[8:9] op_sel:[1,0,0] op_sel_hi:[1,1,1]
    v_pk_fma_f32 v[10:11], v[178:179], v[170:171], v[10:11] op_sel:[1,0,0] op_sel_hi:[1,1,1]
    v_pk_fma_f32 v[12:13], v[182:183], v[172:173], v[12:13] op_sel:[1,0,0] op_sel_hi:[1,1,1]
    v_pk_fma_f32 v[14:15], v[182:183], v[174:175], v[14:15] op_sel:[1,0,0] op_sel_hi:[1,1,1]
    s_set_gpr_idx_off
    s_cbranch_scc1 L_exit
    s_setprio 0
    s_waitcnt vmcnt(4)
    v_mfma_f32_4x4x4_16b_bf16 v[144:147], v[186:187], v[48:49], 0 cbsz:4 abid:8
    v_exp_f32 v176, v120
    v_mfma_f32_4x4x4_16b_bf16 v[148:151], v[186:187], v[50:51], 0 cbsz:4 abid:8
    v_exp_f32 v180, v136
    v_mfma_f32_4x4x4_16b_bf16 v[152:155], v[186:187], v[52:53], 0 cbsz:4 abid:9
    v_exp_f32 v177, v121
    v_mfma_f32_4x4x4_16b_bf16 v[156:159], v[186:187], v[54:55], 0 cbsz:4 abid:9
    v_exp_f32 v181, v137
    v_mfma_f32_4x4x4_16b_bf16 v[160:163], v[186:187], v[56:57], 0 cbsz:4 abid:10
    v_exp_f32 v178, v122
    v_mfma_f32_4x4x4_16b_bf16 v[164:167], v[186:187], v[58:59], 0 cbsz:4 abid:10
    v_exp_f32 v182, v138
    v_mfma_f32_4x4x4_16b_bf16 v[168:171], v[186:187], v[60:61], 0 cbsz:4 abid:11
    v_exp_f32 v179, v123
    v_mfma_f32_4x4x4_16b_bf16 v[172:175], v[186:187], v[62:63], 0 cbsz:4 abid:11
    v_exp_f32 v183, v139
    v_readlane_b32 s64, v228, 2
    v_readlane_b32 s65, v228, 6
    v_readlane_b32 s66, v228, 10
    v_readlane_b32 s67, v228, 14
    v_and_or_b32 v229, v2, s33, v233
    s_and_b32 s80, s64, s31
    v_pk_add_f32 v[176:177], v[176:177], 1.0 op_sel_hi:[1,0]
    s_and_b32 s81, s65, s31
    v_pk_add_f32 v[178:179], v[178:179], 1.0 op_sel_hi:[1,0]
    s_and_b32 s82, s66, s31
    v_pk_add_f32 v[180:181], v[180:181], 1.0 op_sel_hi:[1,0]
    s_and_b32 s83, s67, s31
    v_pk_add_f32 v[182:183], v[182:183], 1.0 op_sel_hi:[1,0]
    v_mfma_f32_32x32x16_bf16 v[80:95], v[196:199], v[208:211], v[80:95]
    v_rcp_f32 v176, v176
    v_rcp_f32 v177, v177
    v_rcp_f32 v178, v178
    v_rcp_f32 v179, v179
    v_rcp_f32 v180, v180
    buffer_load_dwordx4 v[48:51], v232, s[4:7], s80 offen
    v_rcp_f32 v181, v181
    buffer_load_dwordx4 v[52:55], v232, s[4:7], s81 offen
    v_rcp_f32 v182, v182
    buffer_load_dwordx4 v[56:59], v232, s[4:7], s82 offen
    v_rcp_f32 v183, v183
    buffer_load_dwordx4 v[60:63], v232, s[4:7], s83 offen
    s_cmp_le_i32 s30, 28
    s_mov_b64 exec, s[20:21]
    ds_read_b128 v[192:195], v229 offset:16384
    s_mov_b64 exec, -1
    v_pk_mul_f32 v[176:177], v[176:177], v[120:121]
    v_pk_mul_f32 v[178:179], v[178:179], v[122:123]
    v_pk_mul_f32 v[180:181], v[180:181], v[136:137]
    v_pk_mul_f32 v[182:183], v[182:183], v[138:139]
    s_set_gpr_idx_on s72, gpr_idx(SRC2,DST)
    v_pk_fma_f32 v[8:9], v[176:177], v[144:145], v[8:9] op_sel:[0,0,0] op_sel_hi:[0,1,1]
    v_pk_fma_f32 v[10:11], v[176:177], v[146:147], v[10:11] op_sel:[0,0,0] op_sel_hi:[0,1,1]
    v_pk_fma_f32 v[12:13], v[180:181], v[148:149], v[12:13] op_sel:[0,0,0] op_sel_hi:[0,1,1]
    v_pk_fma_f32 v[14:15], v[180:181], v[150:151], v[14:15] op_sel:[0,0,0] op_sel_hi:[0,1,1]
    s_set_gpr_idx_idx s73
    v_pk_fma_f32 v[8:9], v[176:177], v[152:153], v[8:9] op_sel:[1,0,0] op_sel_hi:[1,1,1]
    v_pk_fma_f32 v[10:11], v[176:177], v[154:155], v[10:11] op_sel:[1,0,0] op_sel_hi:[1,1,1]
    v_pk_fma_f32 v[12:13], v[180:181], v[156:157], v[12:13] op_sel:[1,0,0] op_sel_hi:[1,1,1]
    v_pk_fma_f32 v[14:15], v[180:181], v[158:159], v[14:15] op_sel:[1,0,0] op_sel_hi:[1,1,1]
    s_set_gpr_idx_idx s74
    v_pk_fma_f32 v[8:9], v[178:179], v[160:161], v[8:9] op_sel:[0,0,0] op_sel_hi:[0,1,1]
    v_pk_fma_f32 v[10:11], v[178:179], v[162:163], v[10:11] op_sel:[0,0,0] op_sel_hi:[0,1,1]
    v_pk_fma_f32 v[12:13], v[182:183], v[164:165], v[12:13] op_sel:[0,0,0] op_sel_hi:[0,1,1]
    v_pk_fma_f32 v[14:15], v[182:183], v[166:167], v[14:15] op_sel:[0,0,0] op_sel_hi:[0,1,1]
    s_set_gpr_idx_idx s75
    v_pk_fma_f32 v[8:9], v[178:179], v[168:169], v[8:9] op_sel:[1,0,0] op_sel_hi:[1,1,1]
    v_pk_fma_f32 v[10:11], v[178:179], v[170:171], v[10:11] op_sel:[1,0,0] op_sel_hi:[1,1,1]
    v_pk_fma_f32 v[12:13], v[182:183], v[172:173], v[12:13] op_sel:[1,0,0] op_sel_hi:[1,1,1]
    v_pk_fma_f32 v[14:15], v[182:183], v[174:175], v[14:15] op_sel:[1,0,0] op_sel_hi:[1,1,1]
    s_set_gpr_idx_off
    s_cbranch_scc1 L_exit
    s_waitcnt vmcnt(4)
    v_mfma_f32_4x4x4_16b_bf16 v[144:147], v[186:187], v[64:65], 0 cbsz:4 abid:12
    v_exp_f32 v176, v124
    v_mfma_f32_4x4x4_16b_bf16 v[148:151], v[186:187], v[66:67], 0 cbsz:4 abid:12
    v_exp_f32 v180, v140
    v_mfma_f32_4x4x4_16b_bf16 v[152:155], v[186:187], v[68:69], 0 cbsz:4 abid:13
    v_exp_f32 v177, v125
    v_mfma_f32_4x4x4_16b_bf16 v[156:159], v[186:187], v[70:71], 0 cbsz:4 abid:13
    v_exp_f32 v181, v141
    v_mfma_f32_4x4x4_16b_bf16 v[160:163], v[186:187], v[72:73], 0 cbsz:4 abid:14
    v_exp_f32 v178, v126
    v_mfma_f32_4x4x4_16b_bf16 v[164:167], v[186:187], v[74:75], 0 cbsz:4 abid:14
    v_exp_f32 v182, v142
    v_mfma_f32_4x4x4_16b_bf16 v[168:171], v[186:187], v[76:77], 0 cbsz:4 abid:15
    v_exp_f32 v179, v127
    v_mfma_f32_4x4x4_16b_bf16 v[172:175], v[186:187], v[78:79], 0 cbsz:4 abid:15
    v_exp_f32 v183, v143
    v_readlane_b32 s68, v228, 18
    v_readlane_b32 s69, v228, 22
    v_readlane_b32 s70, v228, 26
    v_readlane_b32 s71, v228, 30
    s_and_b32 s80, s68, s31
    v_pk_add_f32 v[176:177], v[176:177], 1.0 op_sel_hi:[1,0]
    s_and_b32 s81, s69, s31
    v_pk_add_f32 v[178:179], v[178:179], 1.0 op_sel_hi:[1,0]
    s_and_b32 s82, s70, s31
    v_pk_add_f32 v[180:181], v[180:181], 1.0 op_sel_hi:[1,0]
    s_and_b32 s83, s71, s31
    v_pk_add_f32 v[182:183], v[182:183], 1.0 op_sel_hi:[1,0]
    v_mfma_f32_32x32x16_bf16 v[96:111], v[196:199], v[212:215], v[96:111]
    v_rcp_f32 v176, v176
    v_rcp_f32 v177, v177
    v_rcp_f32 v178, v178
    v_rcp_f32 v179, v179
    v_rcp_f32 v180, v180
    buffer_load_dwordx4 v[64:67], v232, s[4:7], s80 offen
    v_rcp_f32 v181, v181
    buffer_load_dwordx4 v[68:71], v232, s[4:7], s81 offen
    v_rcp_f32 v182, v182
    buffer_load_dwordx4 v[72:75], v232, s[4:7], s82 offen
    v_rcp_f32 v183, v183
    buffer_load_dwordx4 v[76:79], v232, s[4:7], s83 offen
    s_cmp_le_i32 s30, 32
    s_waitcnt lgkmcnt(0)
    v_pk_mul_f32 v[176:177], v[176:177], v[124:125]
    v_pk_mul_f32 v[178:179], v[178:179], v[126:127]
    v_pk_mul_f32 v[180:181], v[180:181], v[140:141]
    v_pk_mul_f32 v[182:183], v[182:183], v[142:143]
    s_set_gpr_idx_on s76, gpr_idx(SRC2,DST)
    v_pk_fma_f32 v[8:9], v[176:177], v[144:145], v[8:9] op_sel:[0,0,0] op_sel_hi:[0,1,1]
    v_pk_fma_f32 v[10:11], v[176:177], v[146:147], v[10:11] op_sel:[0,0,0] op_sel_hi:[0,1,1]
    v_pk_fma_f32 v[12:13], v[180:181], v[148:149], v[12:13] op_sel:[0,0,0] op_sel_hi:[0,1,1]
    v_pk_fma_f32 v[14:15], v[180:181], v[150:151], v[14:15] op_sel:[0,0,0] op_sel_hi:[0,1,1]
    s_set_gpr_idx_idx s77
    v_pk_fma_f32 v[8:9], v[176:177], v[152:153], v[8:9] op_sel:[1,0,0] op_sel_hi:[1,1,1]
    v_pk_fma_f32 v[10:11], v[176:177], v[154:155], v[10:11] op_sel:[1,0,0] op_sel_hi:[1,1,1]
    v_pk_fma_f32 v[12:13], v[180:181], v[156:157], v[12:13] op_sel:[1,0,0] op_sel_hi:[1,1,1]
    v_pk_fma_f32 v[14:15], v[180:181], v[158:159], v[14:15] op_sel:[1,0,0] op_sel_hi:[1,1,1]
    s_set_gpr_idx_idx s78
    v_pk_fma_f32 v[8:9], v[178:179], v[160:161], v[8:9] op_sel:[0,0,0] op_sel_hi:[0,1,1]
    v_pk_fma_f32 v[10:11], v[178:179], v[162:163], v[10:11] op_sel:[0,0,0] op_sel_hi:[0,1,1]
    v_pk_fma_f32 v[12:13], v[182:183], v[164:165], v[12:13] op_sel:[0,0,0] op_sel_hi:[0,1,1]
    v_pk_fma_f32 v[14:15], v[182:183], v[166:167], v[14:15] op_sel:[0,0,0] op_sel_hi:[0,1,1]
    s_set_gpr_idx_idx s79
    v_pk_fma_f32 v[8:9], v[178:179], v[168:169], v[8:9] op_sel:[1,0,0] op_sel_hi:[1,1,1]
    v_pk_fma_f32 v[10:11], v[178:179], v[170:171], v[10:11] op_sel:[1,0,0] op_sel_hi:[1,1,1]
    v_pk_fma_f32 v[12:13], v[182:183], v[172:173], v[12:13] op_sel:[1,0,0] op_sel_hi:[1,1,1]
    v_pk_fma_f32 v[14:15], v[182:183], v[174:175], v[14:15] op_sel:[1,0,0] op_sel_hi:[1,1,1]
    s_set_gpr_idx_off
    s_cbranch_scc1 L_exit
    s_setprio 3
    s_waitcnt vmcnt(4)
    v_mfma_f32_4x4x4_16b_bf16 v[144:147], v[188:189], v[48:49], 0 cbsz:4 abid:0
    v_exp_f32 v176, v80
    v_mfma_f32_4x4x4_16b_bf16 v[148:151], v[188:189], v[50:51], 0 cbsz:4 abid:0
    v_exp_f32 v180, v96
    v_mfma_f32_4x4x4_16b_bf16 v[152:155], v[188:189], v[52:53], 0 cbsz:4 abid:1
    v_exp_f32 v177, v81
    v_mfma_f32_4x4x4_16b_bf16 v[156:159], v[188:189], v[54:55], 0 cbsz:4 abid:1
    v_exp_f32 v181, v97
    v_mfma_f32_4x4x4_16b_bf16 v[160:163], v[188:189], v[56:57], 0 cbsz:4 abid:2
    v_exp_f32 v178, v82
    v_mfma_f32_4x4x4_16b_bf16 v[164:167], v[188:189], v[58:59], 0 cbsz:4 abid:2
    v_exp_f32 v182, v98
    v_mfma_f32_4x4x4_16b_bf16 v[168:171], v[188:189], v[60:61], 0 cbsz:4 abid:3
    v_exp_f32 v179, v83
    v_mfma_f32_4x4x4_16b_bf16 v[172:175], v[188:189], v[62:63], 0 cbsz:4 abid:3
    v_exp_f32 v183, v99
    v_readlane_b32 s72, v228, 34
    v_readlane_b32 s73, v228, 38
    v_readlane_b32 s74, v228, 42
    v_readlane_b32 s75, v228, 46
    s_and_b32 s80, s72, s31
    v_pk_add_f32 v[176:177], v[176:177], 1.0 op_sel_hi:[1,0]
    s_and_b32 s81, s73, s31
    v_pk_add_f32 v[178:179], v[178:179], 1.0 op_sel_hi:[1,0]
    s_and_b32 s82, s74, s31
    v_pk_add_f32 v[180:181], v[180:181], 1.0 op_sel_hi:[1,0]
    s_and_b32 s83, s75, s31
    v_pk_add_f32 v[182:183], v[182:183], 1.0 op_sel_hi:[1,0]
    v_mfma_f32_32x32x16_bf16 v[112:127], v[192:195], v[200:203], 0
    v_rcp_f32 v176, v176
    v_rcp_f32 v177, v177
    v_rcp_f32 v178, v178
    v_rcp_f32 v179, v179
    v_rcp_f32 v180, v180
    buffer_load_dwordx4 v[48:51], v232, s[4:7], s80 offen
    v_rcp_f32 v181, v181
    buffer_load_dwordx4 v[52:55], v232, s[4:7], s81 offen
    v_rcp_f32 v182, v182
    buffer_load_dwordx4 v[56:59], v232, s[4:7], s82 offen
    v_rcp_f32 v183, v183
    buffer_load_dwordx4 v[60:63], v232, s[4:7], s83 offen
    s_cmp_le_i32 s30, 36
    s_mov_b64 exec, s[22:23]
    ds_read_b128 v[196:199], v229 offset:16384
    s_mov_b64 exec, -1
    ds_read_b32 v2, v231 offset:1036
    v_pk_mul_f32 v[176:177], v[176:177], v[80:81]
    v_pk_mul_f32 v[178:179], v[178:179], v[82:83]
    v_pk_mul_f32 v[180:181], v[180:181], v[96:97]
    v_pk_mul_f32 v[182:183], v[182:183], v[98:99]
    s_set_gpr_idx_on s64, gpr_idx(SRC2,DST)
    v_pk_fma_f32 v[8:9], v[176:177], v[144:145], v[8:9] op_sel:[0,0,0] op_sel_hi:[0,1,1]
    v_pk_fma_f32 v[10:11], v[176:177], v[146:147], v[10:11] op_sel:[0,0,0] op_sel_hi:[0,1,1]
    v_pk_fma_f32 v[12:13], v[180:181], v[148:149], v[12:13] op_sel:[0,0,0] op_sel_hi:[0,1,1]
    v_pk_fma_f32 v[14:15], v[180:181], v[150:151], v[14:15] op_sel:[0,0,0] op_sel_hi:[0,1,1]
    s_set_gpr_idx_idx s65
    v_pk_fma_f32 v[8:9], v[176:177], v[152:153], v[8:9] op_sel:[1,0,0] op_sel_hi:[1,1,1]
    v_pk_fma_f32 v[10:11], v[176:177], v[154:155], v[10:11] op_sel:[1,0,0] op_sel_hi:[1,1,1]
    v_pk_fma_f32 v[12:13], v[180:181], v[156:157], v[12:13] op_sel:[1,0,0] op_sel_hi:[1,1,1]
    v_pk_fma_f32 v[14:15], v[180:181], v[158:159], v[14:15] op_sel:[1,0,0] op_sel_hi:[1,1,1]
    s_set_gpr_idx_idx s66
    v_pk_fma_f32 v[8:9], v[178:179], v[160:161], v[8:9] op_sel:[0,0,0] op_sel_hi:[0,1,1]
    v_pk_fma_f32 v[10:11], v[178:179], v[162:163], v[10:11] op_sel:[0,0,0] op_sel_hi:[0,1,1]
    v_pk_fma_f32 v[12:13], v[182:183], v[164:165], v[12:13] op_sel:[0,0,0] op_sel_hi:[0,1,1]
    v_pk_fma_f32 v[14:15], v[182:183], v[166:167], v[14:15] op_sel:[0,0,0] op_sel_hi:[0,1,1]
    s_set_gpr_idx_idx s67
    v_pk_fma_f32 v[8:9], v[178:179], v[168:169], v[8:9] op_sel:[1,0,0] op_sel_hi:[1,1,1]
    v_pk_fma_f32 v[10:11], v[178:179], v[170:171], v[10:11] op_sel:[1,0,0] op_sel_hi:[1,1,1]
    v_pk_fma_f32 v[12:13], v[182:183], v[172:173], v[12:13] op_sel:[1,0,0] op_sel_hi:[1,1,1]
    v_pk_fma_f32 v[14:15], v[182:183], v[174:175], v[14:15] op_sel:[1,0,0] op_sel_hi:[1,1,1]
    s_set_gpr_idx_off
    s_cbranch_scc1 L_exit
    s_waitcnt vmcnt(4)
    v_mfma_f32_4x4x4_16b_bf16 v[144:147], v[188:189], v[64:65], 0 cbsz:4 abid:4
    v_exp_f32 v176, v84
    v_mfma_f32_4x4x4_16b_bf16 v[148:151], v[188:189], v[66:67], 0 cbsz:4 abid:4
    v_exp_f32 v180, v100
    v_mfma_f32_4x4x4_16b_bf16 v[152:155], v[188:189], v[68:69], 0 cbsz:4 abid:5
    v_exp_f32 v177, v85
    v_mfma_f32_4x4x4_16b_bf16 v[156:159], v[188:189], v[70:71], 0 cbsz:4 abid:5
    v_exp_f32 v181, v101
    v_mfma_f32_4x4x4_16b_bf16 v[160:163], v[188:189], v[72:73], 0 cbsz:4 abid:6
    v_exp_f32 v178, v86
    v_mfma_f32_4x4x4_16b_bf16 v[164:167], v[188:189], v[74:75], 0 cbsz:4 abid:6
    v_exp_f32 v182, v102
    v_mfma_f32_4x4x4_16b_bf16 v[168:171], v[188:189], v[76:77], 0 cbsz:4 abid:7
    v_exp_f32 v179, v87
    v_mfma_f32_4x4x4_16b_bf16 v[172:175], v[188:189], v[78:79], 0 cbsz:4 abid:7
    v_exp_f32 v183, v103
    v_readlane_b32 s76, v228, 50
    v_readlane_b32 s77, v228, 54
    v_readlane_b32 s78, v228, 58
    v_readlane_b32 s79, v228, 62
    s_and_b32 s80, s76, s31
    v_pk_add_f32 v[176:177], v[176:177], 1.0 op_sel_hi:[1,0]
    s_and_b32 s81, s77, s31
    v_pk_add_f32 v[178:179], v[178:179], 1.0 op_sel_hi:[1,0]
    s_and_b32 s82, s78, s31
    v_pk_add_f32 v[180:181], v[180:181], 1.0 op_sel_hi:[1,0]
    s_and_b32 s83, s79, s31
    v_pk_add_f32 v[182:183], v[182:183], 1.0 op_sel_hi:[1,0]
    v_mfma_f32_32x32x16_bf16 v[128:143], v[192:195], v[204:207], 0
    v_rcp_f32 v176, v176
    v_rcp_f32 v177, v177
    v_rcp_f32 v178, v178
    v_rcp_f32 v179, v179
    v_rcp_f32 v180, v180
    buffer_load_dwordx4 v[64:67], v232, s[4:7], s80 offen
    v_rcp_f32 v181, v181
    buffer_load_dwordx4 v[68:71], v232, s[4:7], s81 offen
    v_rcp_f32 v182, v182
    buffer_load_dwordx4 v[72:75], v232, s[4:7], s82 offen
    v_rcp_f32 v183, v183
    buffer_load_dwordx4 v[76:79], v232, s[4:7], s83 offen
    s_cmp_le_i32 s30, 40
    s_waitcnt lgkmcnt(0)
    v_pk_mul_f32 v[176:177], v[176:177], v[84:85]
    v_pk_mul_f32 v[178:179], v[178:179], v[86:87]
    v_pk_mul_f32 v[180:181], v[180:181], v[100:101]
    v_pk_mul_f32 v[182:183], v[182:183], v[102:103]
    s_set_gpr_idx_on s68, gpr_idx(SRC2,DST)
    v_pk_fma_f32 v[8:9], v[176:177], v[144:145], v[8:9] op_sel:[0,0,0] op_sel_hi:[0,1,1]
    v_pk_fma_f32 v[10:11], v[176:177], v[146:147], v[10:11] op_sel:[0,0,0] op_sel_hi:[0,1,1]
    v_pk_fma_f32 v[12:13], v[180:181], v[148:149], v[12:13] op_sel:[0,0,0] op_sel_hi:[0,1,1]
    v_pk_fma_f32 v[14:15], v[180:181], v[150:151], v[14:15] op_sel:[0,0,0] op_sel_hi:[0,1,1]
    s_set_gpr_idx_idx s69
    v_pk_fma_f32 v[8:9], v[176:177], v[152:153], v[8:9] op_sel:[1,0,0] op_sel_hi:[1,1,1]
    v_pk_fma_f32 v[10:11], v[176:177], v[154:155], v[10:11] op_sel:[1,0,0] op_sel_hi:[1,1,1]
    v_pk_fma_f32 v[12:13], v[180:181], v[156:157], v[12:13] op_sel:[1,0,0] op_sel_hi:[1,1,1]
    v_pk_fma_f32 v[14:15], v[180:181], v[158:159], v[14:15] op_sel:[1,0,0] op_sel_hi:[1,1,1]
    s_set_gpr_idx_idx s70
    v_pk_fma_f32 v[8:9], v[178:179], v[160:161], v[8:9] op_sel:[0,0,0] op_sel_hi:[0,1,1]
    v_pk_fma_f32 v[10:11], v[178:179], v[162:163], v[10:11] op_sel:[0,0,0] op_sel_hi:[0,1,1]
    v_pk_fma_f32 v[12:13], v[182:183], v[164:165], v[12:13] op_sel:[0,0,0] op_sel_hi:[0,1,1]
    v_pk_fma_f32 v[14:15], v[182:183], v[166:167], v[14:15] op_sel:[0,0,0] op_sel_hi:[0,1,1]
    s_set_gpr_idx_idx s71
    v_pk_fma_f32 v[8:9], v[178:179], v[168:169], v[8:9] op_sel:[1,0,0] op_sel_hi:[1,1,1]
    v_pk_fma_f32 v[10:11], v[178:179], v[170:171], v[10:11] op_sel:[1,0,0] op_sel_hi:[1,1,1]
    v_pk_fma_f32 v[12:13], v[182:183], v[172:173], v[12:13] op_sel:[1,0,0] op_sel_hi:[1,1,1]
    v_pk_fma_f32 v[14:15], v[182:183], v[174:175], v[14:15] op_sel:[1,0,0] op_sel_hi:[1,1,1]
    s_set_gpr_idx_off
    s_cbranch_scc1 L_exit
    s_setprio 2
    s_waitcnt vmcnt(4)
    v_mfma_f32_4x4x4_16b_bf16 v[144:147], v[188:189], v[48:49], 0 cbsz:4 abid:8
    v_exp_f32 v176, v88
    v_mfma_f32_4x4x4_16b_bf16 v[148:151], v[188:189], v[50:51], 0 cbsz:4 abid:8
    v_exp_f32 v180, v104
    v_mfma_f32_4x4x4_16b_bf16 v[152:155], v[188:189], v[52:53], 0 cbsz:4 abid:9
    v_exp_f32 v177, v89
    v_mfma_f32_4x4x4_16b_bf16 v[156:159], v[188:189], v[54:55], 0 cbsz:4 abid:9
    v_exp_f32 v181, v105
    v_mfma_f32_4x4x4_16b_bf16 v[160:163], v[188:189], v[56:57], 0 cbsz:4 abid:10
    v_exp_f32 v178, v90
    v_mfma_f32_4x4x4_16b_bf16 v[164:167], v[188:189], v[58:59], 0 cbsz:4 abid:10
    v_exp_f32 v182, v106
    v_mfma_f32_4x4x4_16b_bf16 v[168:171], v[188:189], v[60:61], 0 cbsz:4 abid:11
    v_exp_f32 v179, v91
    v_mfma_f32_4x4x4_16b_bf16 v[172:175], v[188:189], v[62:63], 0 cbsz:4 abid:11
    v_exp_f32 v183, v107
    v_readlane_b32 s64, v228, 3
    v_readlane_b32 s65, v228, 7
    v_readlane_b32 s66, v228, 11
    v_readlane_b32 s67, v228, 15
    v_and_or_b32 v229, v2, s33, v233
    s_and_b32 s80, s64, s31
    v_pk_add_f32 v[176:177], v[176:177], 1.0 op_sel_hi:[1,0]
    s_and_b32 s81, s65, s31
    v_pk_add_f32 v[178:179], v[178:179], 1.0 op_sel_hi:[1,0]
    s_and_b32 s82, s66, s31
    v_pk_add_f32 v[180:181], v[180:181], 1.0 op_sel_hi:[1,0]
    s_and_b32 s83, s67, s31
    v_pk_add_f32 v[182:183], v[182:183], 1.0 op_sel_hi:[1,0]
    v_mfma_f32_32x32x16_bf16 v[112:127], v[196:199], v[208:211], v[112:127]
    v_rcp_f32 v176, v176
    v_rcp_f32 v177, v177
    v_rcp_f32 v178, v178
    v_rcp_f32 v179, v179
    v_rcp_f32 v180, v180
    buffer_load_dwordx4 v[48:51], v232, s[4:7], s80 offen
    v_rcp_f32 v181, v181
    buffer_load_dwordx4 v[52:55], v232, s[4:7], s81 offen
    v_rcp_f32 v182, v182
    buffer_load_dwordx4 v[56:59], v232, s[4:7], s82 offen
    v_rcp_f32 v183, v183
    buffer_load_dwordx4 v[60:63], v232, s[4:7], s83 offen
    s_cmp_le_i32 s30, 44
    s_mov_b64 exec, s[20:21]
    ds_read_b128 v[192:195], v229 offset:16384
    s_mov_b64 exec, -1
    v_pk_mul_f32 v[176:177], v[176:177], v[88:89]
    v_pk_mul_f32 v[178:179], v[178:179], v[90:91]
    v_pk_mul_f32 v[180:181], v[180:181], v[104:105]
    v_pk_mul_f32 v[182:183], v[182:183], v[106:107]
    s_set_gpr_idx_on s72, gpr_idx(SRC2,DST)
    v_pk_fma_f32 v[8:9], v[176:177], v[144:145], v[8:9] op_sel:[0,0,0] op_sel_hi:[0,1,1]
    v_pk_fma_f32 v[10:11], v[176:177], v[146:147], v[10:11] op_sel:[0,0,0] op_sel_hi:[0,1,1]
    v_pk_fma_f32 v[12:13], v[180:181], v[148:149], v[12:13] op_sel:[0,0,0] op_sel_hi:[0,1,1]
    v_pk_fma_f32 v[14:15], v[180:181], v[150:151], v[14:15] op_sel:[0,0,0] op_sel_hi:[0,1,1]
    s_set_gpr_idx_idx s73
    v_pk_fma_f32 v[8:9], v[176:177], v[152:153], v[8:9] op_sel:[1,0,0] op_sel_hi:[1,1,1]
    v_pk_fma_f32 v[10:11], v[176:177], v[154:155], v[10:11] op_sel:[1,0,0] op_sel_hi:[1,1,1]
    v_pk_fma_f32 v[12:13], v[180:181], v[156:157], v[12:13] op_sel:[1,0,0] op_sel_hi:[1,1,1]
    v_pk_fma_f32 v[14:15], v[180:181], v[158:159], v[14:15] op_sel:[1,0,0] op_sel_hi:[1,1,1]
    s_set_gpr_idx_idx s74
    v_pk_fma_f32 v[8:9], v[178:179], v[160:161], v[8:9] op_sel:[0,0,0] op_sel_hi:[0,1,1]
    v_pk_fma_f32 v[10:11], v[178:179], v[162:163], v[10:11] op_sel:[0,0,0] op_sel_hi:[0,1,1]
    v_pk_fma_f32 v[12:13], v[182:183], v[164:165], v[12:13] op_sel:[0,0,0] op_sel_hi:[0,1,1]
    v_pk_fma_f32 v[14:15], v[182:183], v[166:167], v[14:15] op_sel:[0,0,0] op_sel_hi:[0,1,1]
    s_set_gpr_idx_idx s75
    v_pk_fma_f32 v[8:9], v[178:179], v[168:169], v[8:9] op_sel:[1,0,0] op_sel_hi:[1,1,1]
    v_pk_fma_f32 v[10:11], v[178:179], v[170:171], v[10:11] op_sel:[1,0,0] op_sel_hi:[1,1,1]
    v_pk_fma_f32 v[12:13], v[182:183], v[172:173], v[12:13] op_sel:[1,0,0] op_sel_hi:[1,1,1]
    v_pk_fma_f32 v[14:15], v[182:183], v[174:175], v[14:15] op_sel:[1,0,0] op_sel_hi:[1,1,1]
    s_set_gpr_idx_off
    s_cbranch_scc1 L_exit
    s_waitcnt vmcnt(4)
    v_mfma_f32_4x4x4_16b_bf16 v[144:147], v[188:189], v[64:65], 0 cbsz:4 abid:12
    v_exp_f32 v176, v92
    v_mfma_f32_4x4x4_16b_bf16 v[148:151], v[188:189], v[66:67], 0 cbsz:4 abid:12
    v_exp_f32 v180, v108
    v_mfma_f32_4x4x4_16b_bf16 v[152:155], v[188:189], v[68:69], 0 cbsz:4 abid:13
    v_exp_f32 v177, v93
    v_mfma_f32_4x4x4_16b_bf16 v[156:159], v[188:189], v[70:71], 0 cbsz:4 abid:13
    v_exp_f32 v181, v109
    v_mfma_f32_4x4x4_16b_bf16 v[160:163], v[188:189], v[72:73], 0 cbsz:4 abid:14
    v_exp_f32 v178, v94
    v_mfma_f32_4x4x4_16b_bf16 v[164:167], v[188:189], v[74:75], 0 cbsz:4 abid:14
    v_exp_f32 v182, v110
    v_mfma_f32_4x4x4_16b_bf16 v[168:171], v[188:189], v[76:77], 0 cbsz:4 abid:15
    v_exp_f32 v179, v95
    v_mfma_f32_4x4x4_16b_bf16 v[172:175], v[188:189], v[78:79], 0 cbsz:4 abid:15
    v_exp_f32 v183, v111
    v_readlane_b32 s68, v228, 19
    v_readlane_b32 s69, v228, 23
    v_readlane_b32 s70, v228, 27
    v_readlane_b32 s71, v228, 31
    s_and_b32 s80, s68, s31
    v_pk_add_f32 v[176:177], v[176:177], 1.0 op_sel_hi:[1,0]
    s_and_b32 s81, s69, s31
    v_pk_add_f32 v[178:179], v[178:179], 1.0 op_sel_hi:[1,0]
    s_and_b32 s82, s70, s31
    v_pk_add_f32 v[180:181], v[180:181], 1.0 op_sel_hi:[1,0]
    s_and_b32 s83, s71, s31
    v_pk_add_f32 v[182:183], v[182:183], 1.0 op_sel_hi:[1,0]
    v_mfma_f32_32x32x16_bf16 v[128:143], v[196:199], v[212:215], v[128:143]
    v_rcp_f32 v176, v176
    v_rcp_f32 v177, v177
    v_rcp_f32 v178, v178
    v_rcp_f32 v179, v179
    v_rcp_f32 v180, v180
    buffer_load_dwordx4 v[64:67], v232, s[4:7], s80 offen
    v_rcp_f32 v181, v181
    buffer_load_dwordx4 v[68:71], v232, s[4:7], s81 offen
    v_rcp_f32 v182, v182
    buffer_load_dwordx4 v[72:75], v232, s[4:7], s82 offen
    v_rcp_f32 v183, v183
    buffer_load_dwordx4 v[76:79], v232, s[4:7], s83 offen
    s_cmp_le_i32 s30, 48
    s_waitcnt lgkmcnt(0)
    v_pk_mul_f32 v[176:177], v[176:177], v[92:93]
    v_pk_mul_f32 v[178:179], v[178:179], v[94:95]
    v_pk_mul_f32 v[180:181], v[180:181], v[108:109]
    v_pk_mul_f32 v[182:183], v[182:183], v[110:111]
    s_set_gpr_idx_on s76, gpr_idx(SRC2,DST)
    v_pk_fma_f32 v[8:9], v[176:177], v[144:145], v[8:9] op_sel:[0,0,0] op_sel_hi:[0,1,1]
    v_pk_fma_f32 v[10:11], v[176:177], v[146:147], v[10:11] op_sel:[0,0,0] op_sel_hi:[0,1,1]
    v_pk_fma_f32 v[12:13], v[180:181], v[148:149], v[12:13] op_sel:[0,0,0] op_sel_hi:[0,1,1]
    v_pk_fma_f32 v[14:15], v[180:181], v[150:151], v[14:15] op_sel:[0,0,0] op_sel_hi:[0,1,1]
    s_set_gpr_idx_idx s77
    v_pk_fma_f32 v[8:9], v[176:177], v[152:153], v[8:9] op_sel:[1,0,0] op_sel_hi:[1,1,1]
    v_pk_fma_f32 v[10:11], v[176:177], v[154:155], v[10:11] op_sel:[1,0,0] op_sel_hi:[1,1,1]
    v_pk_fma_f32 v[12:13], v[180:181], v[156:157], v[12:13] op_sel:[1,0,0] op_sel_hi:[1,1,1]
    v_pk_fma_f32 v[14:15], v[180:181], v[158:159], v[14:15] op_sel:[1,0,0] op_sel_hi:[1,1,1]
    s_set_gpr_idx_idx s78
    v_pk_fma_f32 v[8:9], v[178:179], v[160:161], v[8:9] op_sel:[0,0,0] op_sel_hi:[0,1,1]
    v_pk_fma_f32 v[10:11], v[178:179], v[162:163], v[10:11] op_sel:[0,0,0] op_sel_hi:[0,1,1]
    v_pk_fma_f32 v[12:13], v[182:183], v[164:165], v[12:13] op_sel:[0,0,0] op_sel_hi:[0,1,1]
    v_pk_fma_f32 v[14:15], v[182:183], v[166:167], v[14:15] op_sel:[0,0,0] op_sel_hi:[0,1,1]
    s_set_gpr_idx_idx s79
    v_pk_fma_f32 v[8:9], v[178:179], v[168:169], v[8:9] op_sel:[1,0,0] op_sel_hi:[1,1,1]
    v_pk_fma_f32 v[10:11], v[178:179], v[170:171], v[10:11] op_sel:[1,0,0] op_sel_hi:[1,1,1]
    v_pk_fma_f32 v[12:13], v[182:183], v[172:173], v[12:13] op_sel:[1,0,0] op_sel_hi:[1,1,1]
    v_pk_fma_f32 v[14:15], v[182:183], v[174:175], v[14:15] op_sel:[1,0,0] op_sel_hi:[1,1,1]
    s_set_gpr_idx_off
    s_cbranch_scc1 L_exit
    s_setprio 1
    s_waitcnt vmcnt(4)
    v_mfma_f32_4x4x4_16b_bf16 v[144:147], v[190:191], v[48:49], 0 cbsz:4 abid:0
    v_exp_f32 v176, v112
    v_mfma_f32_4x4x4_16b_bf16 v[148:151], v[190:191], v[50:51], 0 cbsz:4 abid:0
    v_exp_f32 v180, v128
    v_mfma_f32_4x4x4_16b_bf16 v[152:155], v[190:191], v[52:53], 0 cbsz:4 abid:1
    v_exp_f32 v177, v113
    v_mfma_f32_4x4x4_16b_bf16 v[156:159], v[190:191], v[54:55], 0 cbsz:4 abid:1
    v_exp_f32 v181, v129
    v_mfma_f32_4x4x4_16b_bf16 v[160:163], v[190:191], v[56:57], 0 cbsz:4 abid:2
    v_exp_f32 v178, v114
    v_mfma_f32_4x4x4_16b_bf16 v[164:167], v[190:191], v[58:59], 0 cbsz:4 abid:2
    v_exp_f32 v182, v130
    v_mfma_f32_4x4x4_16b_bf16 v[168:171], v[190:191], v[60:61], 0 cbsz:4 abid:3
    v_exp_f32 v179, v115
    v_mfma_f32_4x4x4_16b_bf16 v[172:175], v[190:191], v[62:63], 0 cbsz:4 abid:3
    v_exp_f32 v183, v131
    v_readlane_b32 s72, v228, 35
    v_readlane_b32 s73, v228, 39
    v_readlane_b32 s74, v228, 43
    v_readlane_b32 s75, v228, 47
    s_and_b32 s80, s72, s31
    v_pk_add_f32 v[176:177], v[176:177], 1.0 op_sel_hi:[1,0]
    s_and_b32 s81, s73, s31
    v_pk_add_f32 v[178:179], v[178:179], 1.0 op_sel_hi:[1,0]
    s_and_b32 s82, s74, s31
    v_pk_add_f32 v[180:181], v[180:181], 1.0 op_sel_hi:[1,0]
    s_and_b32 s83, s75, s31
    v_pk_add_f32 v[182:183], v[182:183], 1.0 op_sel_hi:[1,0]
    v_mfma_f32_32x32x16_bf16 v[80:95], v[192:195], v[200:203], 0
    v_rcp_f32 v176, v176
    v_rcp_f32 v177, v177
    v_rcp_f32 v178, v178
    v_rcp_f32 v179, v179
    v_rcp_f32 v180, v180
    buffer_load_dwordx4 v[48:51], v232, s[4:7], s80 offen
    v_rcp_f32 v181, v181
    buffer_load_dwordx4 v[52:55], v232, s[4:7], s81 offen
    v_rcp_f32 v182, v182
    buffer_load_dwordx4 v[56:59], v232, s[4:7], s82 offen
    v_rcp_f32 v183, v183
    buffer_load_dwordx4 v[60:63], v232, s[4:7], s83 offen
    s_cmp_le_i32 s30, 52
    s_mov_b64 exec, s[22:23]
    ds_read_b128 v[196:199], v229 offset:16384
    s_mov_b64 exec, -1
    ds_read_b32 v2, v231 offset:1292
    v_pk_mul_f32 v[176:177], v[176:177], v[112:113]
    v_pk_mul_f32 v[178:179], v[178:179], v[114:115]
    v_pk_mul_f32 v[180:181], v[180:181], v[128:129]
    v_pk_mul_f32 v[182:183], v[182:183], v[130:131]
    s_set_gpr_idx_on s64, gpr_idx(SRC2,DST)
    v_pk_fma_f32 v[8:9], v[176:177], v[144:145], v[8:9] op_sel:[0,0,0] op_sel_hi:[0,1,1]
    v_pk_fma_f32 v[10:11], v[176:177], v[146:147], v[10:11] op_sel:[0,0,0] op_sel_hi:[0,1,1]
    v_pk_fma_f32 v[12:13], v[180:181], v[148:149], v[12:13] op_sel:[0,0,0] op_sel_hi:[0,1,1]
    v_pk_fma_f32 v[14:15], v[180:181], v[150:151], v[14:15] op_sel:[0,0,0] op_sel_hi:[0,1,1]
    s_set_gpr_idx_idx s65
    v_pk_fma_f32 v[8:9], v[176:177], v[152:153], v[8:9] op_sel:[1,0,0] op_sel_hi:[1,1,1]
    v_pk_fma_f32 v[10:11], v[176:177], v[154:155], v[10:11] op_sel:[1,0,0] op_sel_hi:[1,1,1]
    v_pk_fma_f32 v[12:13], v[180:181], v[156:157], v[12:13] op_sel:[1,0,0] op_sel_hi:[1,1,1]
    v_pk_fma_f32 v[14:15], v[180:181], v[158:159], v[14:15] op_sel:[1,0,0] op_sel_hi:[1,1,1]
    s_set_gpr_idx_idx s66
    v_pk_fma_f32 v[8:9], v[178:179], v[160:161], v[8:9] op_sel:[0,0,0] op_sel_hi:[0,1,1]
    v_pk_fma_f32 v[10:11], v[178:179], v[162:163], v[10:11] op_sel:[0,0,0] op_sel_hi:[0,1,1]
    v_pk_fma_f32 v[12:13], v[182:183], v[164:165], v[12:13] op_sel:[0,0,0] op_sel_hi:[0,1,1]
    v_pk_fma_f32 v[14:15], v[182:183], v[166:167], v[14:15] op_sel:[0,0,0] op_sel_hi:[0,1,1]
    s_set_gpr_idx_idx s67
    v_pk_fma_f32 v[8:9], v[178:179], v[168:169], v[8:9] op_sel:[1,0,0] op_sel_hi:[1,1,1]
    v_pk_fma_f32 v[10:11], v[178:179], v[170:171], v[10:11] op_sel:[1,0,0] op_sel_hi:[1,1,1]
    v_pk_fma_f32 v[12:13], v[182:183], v[172:173], v[12:13] op_sel:[1,0,0] op_sel_hi:[1,1,1]
    v_pk_fma_f32 v[14:15], v[182:183], v[174:175], v[14:15] op_sel:[1,0,0] op_sel_hi:[1,1,1]
    s_set_gpr_idx_off
    s_cbranch_scc1 L_exit
    s_waitcnt vmcnt(4)
    v_mfma_f32_4x4x4_16b_bf16 v[144:147], v[190:191], v[64:65], 0 cbsz:4 abid:4
    v_exp_f32 v176, v116
    v_mfma_f32_4x4x4_16b_bf16 v[148:151], v[190:191], v[66:67], 0 cbsz:4 abid:4
    v_exp_f32 v180, v132
    v_mfma_f32_4x4x4_16b_bf16 v[152:155], v[190:191], v[68:69], 0 cbsz:4 abid:5
    v_exp_f32 v177, v117
    v_mfma_f32_4x4x4_16b_bf16 v[156:159], v[190:191], v[70:71], 0 cbsz:4 abid:5
    v_exp_f32 v181, v133
    v_mfma_f32_4x4x4_16b_bf16 v[160:163], v[190:191], v[72:73], 0 cbsz:4 abid:6
    v_exp_f32 v178, v118
    v_mfma_f32_4x4x4_16b_bf16 v[164:167], v[190:191], v[74:75], 0 cbsz:4 abid:6
    v_exp_f32 v182, v134
    v_mfma_f32_4x4x4_16b_bf16 v[168:171], v[190:191], v[76:77], 0 cbsz:4 abid:7
    v_exp_f32 v179, v119
    v_mfma_f32_4x4x4_16b_bf16 v[172:175], v[190:191], v[78:79], 0 cbsz:4 abid:7
    v_exp_f32 v183, v135
    v_readlane_b32 s76, v228, 51
    v_readlane_b32 s77, v228, 55
    v_readlane_b32 s78, v228, 59
    v_readlane_b32 s79, v228, 63
    s_and_b32 s80, s76, s31
    v_pk_add_f32 v[176:177], v[176:177], 1.0 op_sel_hi:[1,0]
    s_and_b32 s81, s77, s31
    v_pk_add_f32 v[178:179], v[178:179], 1.0 op_sel_hi:[1,0]
    s_and_b32 s82, s78, s31
    v_pk_add_f32 v[180:181], v[180:181], 1.0 op_sel_hi:[1,0]
    s_and_b32 s83, s79, s31
    v_pk_add_f32 v[182:183], v[182:183], 1.0 op_sel_hi:[1,0]
    v_mfma_f32_32x32x16_bf16 v[96:111], v[192:195], v[204:207], 0
    v_rcp_f32 v176, v176
    v_rcp_f32 v177, v177
    v_rcp_f32 v178, v178
    v_rcp_f32 v179, v179
    v_rcp_f32 v180, v180
    buffer_load_dwordx4 v[64:67], v232, s[4:7], s80 offen
    v_rcp_f32 v181, v181
    buffer_load_dwordx4 v[68:71], v232, s[4:7], s81 offen
    v_rcp_f32 v182, v182
    buffer_load_dwordx4 v[72:75], v232, s[4:7], s82 offen
    v_rcp_f32 v183, v183
    buffer_load_dwordx4 v[76:79], v232, s[4:7], s83 offen
    s_cmp_le_i32 s30, 56
    s_waitcnt lgkmcnt(0)
    v_pk_mul_f32 v[176:177], v[176:177], v[116:117]
    v_pk_mul_f32 v[178:179], v[178:179], v[118:119]
    v_pk_mul_f32 v[180:181], v[180:181], v[132:133]
    v_pk_mul_f32 v[182:183], v[182:183], v[134:135]
    s_set_gpr_idx_on s68, gpr_idx(SRC2,DST)
    v_pk_fma_f32 v[8:9], v[176:177], v[144:145], v[8:9] op_sel:[0,0,0] op_sel_hi:[0,1,1]
    v_pk_fma_f32 v[10:11], v[176:177], v[146:147], v[10:11] op_sel:[0,0,0] op_sel_hi:[0,1,1]
    v_pk_fma_f32 v[12:13], v[180:181], v[148:149], v[12:13] op_sel:[0,0,0] op_sel_hi:[0,1,1]
    v_pk_fma_f32 v[14:15], v[180:181], v[150:151], v[14:15] op_sel:[0,0,0] op_sel_hi:[0,1,1]
    s_set_gpr_idx_idx s69
    v_pk_fma_f32 v[8:9], v[176:177], v[152:153], v[8:9] op_sel:[1,0,0] op_sel_hi:[1,1,1]
    v_pk_fma_f32 v[10:11], v[176:177], v[154:155], v[10:11] op_sel:[1,0,0] op_sel_hi:[1,1,1]
    v_pk_fma_f32 v[12:13], v[180:181], v[156:157], v[12:13] op_sel:[1,0,0] op_sel_hi:[1,1,1]
    v_pk_fma_f32 v[14:15], v[180:181], v[158:159], v[14:15] op_sel:[1,0,0] op_sel_hi:[1,1,1]
    s_set_gpr_idx_idx s70
    v_pk_fma_f32 v[8:9], v[178:179], v[160:161], v[8:9] op_sel:[0,0,0] op_sel_hi:[0,1,1]
    v_pk_fma_f32 v[10:11], v[178:179], v[162:163], v[10:11] op_sel:[0,0,0] op_sel_hi:[0,1,1]
    v_pk_fma_f32 v[12:13], v[182:183], v[164:165], v[12:13] op_sel:[0,0,0] op_sel_hi:[0,1,1]
    v_pk_fma_f32 v[14:15], v[182:183], v[166:167], v[14:15] op_sel:[0,0,0] op_sel_hi:[0,1,1]
    s_set_gpr_idx_idx s71
    v_pk_fma_f32 v[8:9], v[178:179], v[168:169], v[8:9] op_sel:[1,0,0] op_sel_hi:[1,1,1]
    v_pk_fma_f32 v[10:11], v[178:179], v[170:171], v[10:11] op_sel:[1,0,0] op_sel_hi:[1,1,1]
    v_pk_fma_f32 v[12:13], v[182:183], v[172:173], v[12:13] op_sel:[1,0,0] op_sel_hi:[1,1,1]
    v_pk_fma_f32 v[14:15], v[182:183], v[174:175], v[14:15] op_sel:[1,0,0] op_sel_hi:[1,1,1]
    s_set_gpr_idx_off
    s_cbranch_scc1 L_exit
    s_setprio 0
    v_cndmask_b32 v228, v4, v226, s[34:35]
    s_waitcnt vmcnt(4)
    v_mfma_f32_4x4x4_16b_bf16 v[144:147], v[190:191], v[48:49], 0 cbsz:4 abid:8
    v_exp_f32 v176, v120
    v_mfma_f32_4x4x4_16b_bf16 v[148:151], v[190:191], v[50:51], 0 cbsz:4 abid:8
    v_exp_f32 v180, v136
    v_mfma_f32_4x4x4_16b_bf16 v[152:155], v[190:191], v[52:53], 0 cbsz:4 abid:9
    v_exp_f32 v177, v121
    v_mfma_f32_4x4x4_16b_bf16 v[156:159], v[190:191], v[54:55], 0 cbsz:4 abid:9
    v_exp_f32 v181, v137
    v_mfma_f32_4x4x4_16b_bf16 v[160:163], v[190:191], v[56:57], 0 cbsz:4 abid:10
    v_exp_f32 v178, v122
    v_mfma_f32_4x4x4_16b_bf16 v[164:167], v[190:191], v[58:59], 0 cbsz:4 abid:10
    v_exp_f32 v182, v138
    v_mfma_f32_4x4x4_16b_bf16 v[168:171], v[190:191], v[60:61], 0 cbsz:4 abid:11
    v_exp_f32 v179, v123
    v_mfma_f32_4x4x4_16b_bf16 v[172:175], v[190:191], v[62:63], 0 cbsz:4 abid:11
    v_exp_f32 v183, v139
    v_readlane_b32 s64, v228, 0
    v_readlane_b32 s65, v228, 4
    v_readlane_b32 s66, v228, 8
    v_readlane_b32 s67, v228, 12
    v_and_or_b32 v229, v2, s33, v233
    s_and_b32 s80, s64, s31
    v_pk_add_f32 v[176:177], v[176:177], 1.0 op_sel_hi:[1,0]
    s_and_b32 s81, s65, s31
    v_pk_add_f32 v[178:179], v[178:179], 1.0 op_sel_hi:[1,0]
    s_and_b32 s82, s66, s31
    v_pk_add_f32 v[180:181], v[180:181], 1.0 op_sel_hi:[1,0]
    s_and_b32 s83, s67, s31
    v_pk_add_f32 v[182:183], v[182:183], 1.0 op_sel_hi:[1,0]
    v_mfma_f32_32x32x16_bf16 v[80:95], v[196:199], v[208:211], v[80:95]
    v_rcp_f32 v176, v176
    v_rcp_f32 v177, v177
    v_rcp_f32 v178, v178
    v_rcp_f32 v179, v179
    v_rcp_f32 v180, v180
    buffer_load_dwordx4 v[48:51], v232, s[4:7], s80 offen
    v_rcp_f32 v181, v181
    buffer_load_dwordx4 v[52:55], v232, s[4:7], s81 offen
    v_rcp_f32 v182, v182
    buffer_load_dwordx4 v[56:59], v232, s[4:7], s82 offen
    v_rcp_f32 v183, v183
    buffer_load_dwordx4 v[60:63], v232, s[4:7], s83 offen
    s_cmp_le_i32 s30, 60
    s_mov_b64 exec, s[20:21]
    ds_read_b128 v[192:195], v229 offset:16384
    s_mov_b64 exec, -1
    v_pk_mul_f32 v[176:177], v[176:177], v[120:121]
    v_pk_mul_f32 v[178:179], v[178:179], v[122:123]
    v_pk_mul_f32 v[180:181], v[180:181], v[136:137]
    v_pk_mul_f32 v[182:183], v[182:183], v[138:139]
    s_set_gpr_idx_on s72, gpr_idx(SRC2,DST)
    v_pk_fma_f32 v[8:9], v[176:177], v[144:145], v[8:9] op_sel:[0,0,0] op_sel_hi:[0,1,1]
    v_pk_fma_f32 v[10:11], v[176:177], v[146:147], v[10:11] op_sel:[0,0,0] op_sel_hi:[0,1,1]
    v_pk_fma_f32 v[12:13], v[180:181], v[148:149], v[12:13] op_sel:[0,0,0] op_sel_hi:[0,1,1]
    v_pk_fma_f32 v[14:15], v[180:181], v[150:151], v[14:15] op_sel:[0,0,0] op_sel_hi:[0,1,1]
    s_set_gpr_idx_idx s73
    v_pk_fma_f32 v[8:9], v[176:177], v[152:153], v[8:9] op_sel:[1,0,0] op_sel_hi:[1,1,1]
    v_pk_fma_f32 v[10:11], v[176:177], v[154:155], v[10:11] op_sel:[1,0,0] op_sel_hi:[1,1,1]
    v_pk_fma_f32 v[12:13], v[180:181], v[156:157], v[12:13] op_sel:[1,0,0] op_sel_hi:[1,1,1]
    v_pk_fma_f32 v[14:15], v[180:181], v[158:159], v[14:15] op_sel:[1,0,0] op_sel_hi:[1,1,1]
    s_set_gpr_idx_idx s74
    v_pk_fma_f32 v[8:9], v[178:179], v[160:161], v[8:9] op_sel:[0,0,0] op_sel_hi:[0,1,1]
    v_pk_fma_f32 v[10:11], v[178:179], v[162:163], v[10:11] op_sel:[0,0,0] op_sel_hi:[0,1,1]
    v_pk_fma_f32 v[12:13], v[182:183], v[164:165], v[12:13] op_sel:[0,0,0] op_sel_hi:[0,1,1]
    v_pk_fma_f32 v[14:15], v[182:183], v[166:167], v[14:15] op_sel:[0,0,0] op_sel_hi:[0,1,1]
    s_set_gpr_idx_idx s75
    v_pk_fma_f32 v[8:9], v[178:179], v[168:169], v[8:9] op_sel:[1,0,0] op_sel_hi:[1,1,1]
    v_pk_fma_f32 v[10:11], v[178:179], v[170:171], v[10:11] op_sel:[1,0,0] op_sel_hi:[1,1,1]
    v_pk_fma_f32 v[12:13], v[182:183], v[172:173], v[12:13] op_sel:[1,0,0] op_sel_hi:[1,1,1]
    v_pk_fma_f32 v[14:15], v[182:183], v[174:175], v[14:15] op_sel:[1,0,0] op_sel_hi:[1,1,1]
    s_set_gpr_idx_off
    s_cbranch_scc1 L_exit
    s_waitcnt vmcnt(4)
    v_mfma_f32_4x4x4_16b_bf16 v[144:147], v[190:191], v[64:65], 0 cbsz:4 abid:12
    v_exp_f32 v176, v124
    v_mfma_f32_4x4x4_16b_bf16 v[148:151], v[190:191], v[66:67], 0 cbsz:4 abid:12
    v_exp_f32 v180, v140
    v_mfma_f32_4x4x4_16b_bf16 v[152:155], v[190:191], v[68:69], 0 cbsz:4 abid:13
    v_exp_f32 v177, v125
    v_mfma_f32_4x4x4_16b_bf16 v[156:159], v[190:191], v[70:71], 0 cbsz:4 abid:13
    v_exp_f32 v181, v141
    v_mfma_f32_4x4x4_16b_bf16 v[160:163], v[190:191], v[72:73], 0 cbsz:4 abid:14
    v_exp_f32 v178, v126
    v_mfma_f32_4x4x4_16b_bf16 v[164:167], v[190:191], v[74:75], 0 cbsz:4 abid:14
    v_exp_f32 v182, v142
    v_mfma_f32_4x4x4_16b_bf16 v[168:171], v[190:191], v[76:77], 0 cbsz:4 abid:15
    v_exp_f32 v179, v127
    v_mfma_f32_4x4x4_16b_bf16 v[172:175], v[190:191], v[78:79], 0 cbsz:4 abid:15
    v_exp_f32 v183, v143
    v_readlane_b32 s68, v228, 16
    v_readlane_b32 s69, v228, 20
    v_readlane_b32 s70, v228, 24
    v_readlane_b32 s71, v228, 28
    s_and_b32 s80, s68, s31
    v_pk_add_f32 v[176:177], v[176:177], 1.0 op_sel_hi:[1,0]
    s_and_b32 s81, s69, s31
    v_pk_add_f32 v[178:179], v[178:179], 1.0 op_sel_hi:[1,0]
    s_and_b32 s82, s70, s31
    v_pk_add_f32 v[180:181], v[180:181], 1.0 op_sel_hi:[1,0]
    s_and_b32 s83, s71, s31
    v_pk_add_f32 v[182:183], v[182:183], 1.0 op_sel_hi:[1,0]
    v_mfma_f32_32x32x16_bf16 v[96:111], v[196:199], v[212:215], v[96:111]
    v_rcp_f32 v176, v176
    v_rcp_f32 v177, v177
    v_rcp_f32 v178, v178
    v_rcp_f32 v179, v179
    v_rcp_f32 v180, v180
    buffer_load_dwordx4 v[64:67], v232, s[4:7], s80 offen
    v_rcp_f32 v181, v181
    buffer_load_dwordx4 v[68:71], v232, s[4:7], s81 offen
    v_rcp_f32 v182, v182
    buffer_load_dwordx4 v[72:75], v232, s[4:7], s82 offen
    v_rcp_f32 v183, v183
    buffer_load_dwordx4 v[76:79], v232, s[4:7], s83 offen
    s_waitcnt lgkmcnt(0)
    v_pk_mul_f32 v[176:177], v[176:177], v[124:125]
    v_pk_mul_f32 v[178:179], v[178:179], v[126:127]
    v_pk_mul_f32 v[180:181], v[180:181], v[140:141]
    v_pk_mul_f32 v[182:183], v[182:183], v[142:143]
    s_set_gpr_idx_on s76, gpr_idx(SRC2,DST)
    v_pk_fma_f32 v[8:9], v[176:177], v[144:145], v[8:9] op_sel:[0,0,0] op_sel_hi:[0,1,1]
    v_pk_fma_f32 v[10:11], v[176:177], v[146:147], v[10:11] op_sel:[0,0,0] op_sel_hi:[0,1,1]
    v_pk_fma_f32 v[12:13], v[180:181], v[148:149], v[12:13] op_sel:[0,0,0] op_sel_hi:[0,1,1]
    v_pk_fma_f32 v[14:15], v[180:181], v[150:151], v[14:15] op_sel:[0,0,0] op_sel_hi:[0,1,1]
    s_set_gpr_idx_idx s77
    v_pk_fma_f32 v[8:9], v[176:177], v[152:153], v[8:9] op_sel:[1,0,0] op_sel_hi:[1,1,1]
    v_pk_fma_f32 v[10:11], v[176:177], v[154:155], v[10:11] op_sel:[1,0,0] op_sel_hi:[1,1,1]
    v_pk_fma_f32 v[12:13], v[180:181], v[156:157], v[12:13] op_sel:[1,0,0] op_sel_hi:[1,1,1]
    v_pk_fma_f32 v[14:15], v[180:181], v[158:159], v[14:15] op_sel:[1,0,0] op_sel_hi:[1,1,1]
    s_set_gpr_idx_idx s78
    v_pk_fma_f32 v[8:9], v[178:179], v[160:161], v[8:9] op_sel:[0,0,0] op_sel_hi:[0,1,1]
    v_pk_fma_f32 v[10:11], v[178:179], v[162:163], v[10:11] op_sel:[0,0,0] op_sel_hi:[0,1,1]
    v_pk_fma_f32 v[12:13], v[182:183], v[164:165], v[12:13] op_sel:[0,0,0] op_sel_hi:[0,1,1]
    v_pk_fma_f32 v[14:15], v[182:183], v[166:167], v[14:15] op_sel:[0,0,0] op_sel_hi:[0,1,1]
    s_set_gpr_idx_idx s79
    v_pk_fma_f32 v[8:9], v[178:179], v[168:169], v[8:9] op_sel:[1,0,0] op_sel_hi:[1,1,1]
    v_pk_fma_f32 v[10:11], v[178:179], v[170:171], v[10:11] op_sel:[1,0,0] op_sel_hi:[1,1,1]
    v_pk_fma_f32 v[12:13], v[182:183], v[172:173], v[12:13] op_sel:[1,0,0] op_sel_hi:[1,1,1]
    v_pk_fma_f32 v[14:15], v[182:183], v[174:175], v[14:15] op_sel:[1,0,0] op_sel_hi:[1,1,1]
    s_set_gpr_idx_off
    v_add_u32 v231, 1024, v231
    s_sub_u32 s30, s30, 64
    s_branch L_sb
L_exit:
    s_setprio 0
    s_add_u32 s24, s24, 256
    s_lshl_b32 s26, s25, 8
    s_cmp_lt_u32 s24, s26
    s_cbranch_scc0 L_epi
    v_lshlrev_b32 v7, 3, v0
    v_mov_b32 v2, 0
    v_mov_b32 v3, 0
    ds_write_b64 v7, v[2:3]
    s_waitcnt vmcnt(0) lgkmcnt(0)
    s_nop 15
    s_barrier
    s_branch L_round
L_epi:
    s_mov_b32 s34, 0xbf317218
    s_mov_b32 s35, 0xbf317218
    s_lshl_b32 s26, s16, 2
    v_mov_b32 v2, s26
    s_waitcnt lgkmcnt(0)
    ds_read_b32 v184, v2 offset:4096
    ds_read_b32 v185, v2 offset:4128
    ds_read_b32 v186, v2 offset:4160
    ds_read_b32 v187, v2 offset:4192
    ds_read_b32 v188, v2 offset:4224
    v_pk_mul_f32 v[8:9], v[8:9], s[34:35]
    v_pk_mul_f32 v[10:11], v[10:11], s[34:35]
    v_pk_mul_f32 v[12:13], v[12:13], s[34:35]
    v_pk_mul_f32 v[14:15], v[14:15], s[34:35]
    v_pk_mul_f32 v[16:17], v[16:17], s[34:35]
    v_pk_mul_f32 v[18:19], v[18:19], s[34:35]
    v_pk_mul_f32 v[20:21], v[20:21], s[34:35]
    v_pk_mul_f32 v[22:23], v[22:23], s[34:35]
    v_pk_mul_f32 v[24:25], v[24:25], s[34:35]
    v_pk_mul_f32 v[26:27], v[26:27], s[34:35]
    v_pk_mul_f32 v[28:29], v[28:29], s[34:35]
    v_pk_mul_f32 v[30:31], v[30:31], s[34:35]
    v_pk_mul_f32 v[32:33], v[32:33], s[34:35]
    v_pk_mul_f32 v[34:35], v[34:35], s[34:35]
    v_pk_mul_f32 v[36:37], v[36:37], s[34:35]
    v_pk_mul_f32 v[38:39], v[38:39], s[34:35]
    v_pk_mul_f32 v[40:41], v[40:41], s[34:35]
    v_pk_mul_f32 v[42:43], v[42:43], s[34:35]
    v_pk_mul_f32 v[44:45], v[44:45], s[34:35]
    v_pk_mul_f32 v[46:47], v[46:47], s[34:35]
    v_cvt_pk_bf16_f32 v8, v8, v12
    v_cvt_pk_bf16_f32 v9, v9, v13
    v_cvt_pk_bf16_f32 v10, v10, v14
    v_cvt_pk_bf16_f32 v11, v11, v15
    v_cvt_pk_bf16_f32 v16, v16, v20
    v_cvt_pk_bf16_f32 v17, v17, v21
    v_cvt_pk_bf16_f32 v18, v18, v22
    v_cvt_pk_bf16_f32 v19, v19, v23
    v_cvt_pk_bf16_f32 v24, v24, v28
    v_cvt_pk_bf16_f32 v25, v25, v29
    v_cvt_pk_bf16_f32 v26, v26, v30
    v_cvt_pk_bf16_f32 v27, v27, v31
    v_cvt_pk_bf16_f32 v32, v32, v36
    v_cvt_pk_bf16_f32 v33, v33, v37
    v_cvt_pk_bf16_f32 v34, v34, v38
    v_cvt_pk_bf16_f32 v35, v35, v39
    v_cvt_pk_bf16_f32 v40, v40, v44
    v_cvt_pk_bf16_f32 v41, v41, v45
    v_cvt_pk_bf16_f32 v42, v42, v46
    v_cvt_pk_bf16_f32 v43, v43, v47
    s_and_b32 s26, s16, 3
    s_lshl_b32 s27, s26, 9
    s_add_u32 s27, s27, 116736
    v_lshrrev_b32 v3, 4, v1
    v_mul_u32_u24 v3, 1792, v3
    v_add3_u32 v3, v3, s27, v232
    v_lshlrev_b32 v2, 2, v1
    s_movk_i32 s36, 1088
    s_waitcnt lgkmcnt(0)
    s_waitcnt vmcnt(0)
    s_mov_b32 s44, s54
    s_mov_b32 s45, s55
    s_mov_b32 s46, 256
    s_mov_b32 s47, 0x00020000
    s_cmp_eq_u32 s16, 7
    s_cselect_b32 s37, 0, 0x1000
    v_mov_b32 v4, s37
    buffer_load_dword v176, v4, s[44:47], 0 offen sc1
    v_and_b32 v184, 63, v184
    v_mad_u32_u24 v184, v184, s36, v2
    v_and_b32 v185, 63, v185
    v_mad_u32_u24 v185, v185, s36, v2
    v_and_b32 v186, 63, v186
    v_mad_u32_u24 v186, v186, s36, v2
    v_and_b32 v187, 63, v187
    v_mad_u32_u24 v187, v187, s36, v2
    v_and_b32 v188, 63, v188
    v_mad_u32_u24 v188, v188, s36, v2
    s_barrier
    ds_write_b32 v184, v8 offset:16384
    ds_write_b32 v184, v9 offset:16656
    ds_write_b32 v184, v10 offset:16928
    ds_write_b32 v184, v11 offset:17200
    ds_write_b32 v185, v16 offset:16384
    ds_write_b32 v185, v17 offset:16656
    ds_write_b32 v185, v18 offset:16928
    ds_write_b32 v185, v19 offset:17200
    ds_write_b32 v186, v24 offset:16384
    ds_write_b32 v186, v25 offset:16656
    ds_write_b32 v186, v26 offset:16928
    ds_write_b32 v186, v27 offset:17200
    ds_write_b32 v187, v32 offset:16384
    ds_write_b32 v187, v33 offset:16656
    ds_write_b32 v187, v34 offset:16928
    ds_write_b32 v187, v35 offset:17200
    ds_write_b32 v188, v40 offset:16384
    ds_write_b32 v188, v41 offset:16656
    ds_write_b32 v188, v42 offset:16928
    ds_write_b32 v188, v43 offset:17200
    ds_read_b128 v[80:83], v3 offset:0
    ds_read_b128 v[84:87], v3 offset:8192
    ds_read_b128 v[88:91], v3 offset:16384
    ds_read_b128 v[92:95], v3 offset:24576
    ds_read_b128 v[96:99], v3 offset:256
    ds_read_b128 v[100:103], v3 offset:8448
    ds_read_b128 v[104:107], v3 offset:16640
    ds_read_b128 v[108:111], v3 offset:24832
    s_lshr_b32 s27, s16, 2
    v_and_b32 v4, 15, v1
    v_lshrrev_b32 v5, 4, v1
    s_movk_i32 s36, 272
    v_mul_u32_u24 v6, s36, v4
    v_lshl_add_u32 v6, v5, 4, v6
    s_mul_i32 s36, s27, 21760
    v_add_u32 v6, s36, v6
    v_lshlrev_b32 v7, 18, v5
    v_lshl_add_u32 v7, v4, 4, v7
    s_mul_i32 s36, s27, 5242880
    s_lshl_b32 s37, s17, 10
    s_add_u32 s36, s36, s37
    s_lshl_b32 s37, s26, 8
    s_add_u32 s36, s36, s37
    v_add_u32 v7, s36, v7
    s_waitcnt lgkmcnt(0)
    s_barrier
    ds_read_b128 v[112:115], v6 offset:16384
    ds_read_b128 v[116:119], v6 offset:16448
    ds_read_b128 v[120:123], v6 offset:16512
    ds_read_b128 v[124:127], v6 offset:16576
    ds_read_b128 v[128:131], v6 offset:20736
    ds_read_b128 v[132:135], v6 offset:20800
    ds_read_b128 v[136:139], v6 offset:20864
    ds_read_b128 v[140:143], v6 offset:20928
    s_waitcnt lgkmcnt(7)
    v_mfma_f32_16x16x32_bf16 v[144:147], v[112:115], v[80:83], 0
    v_mfma_f32_16x16x32_bf16 v[148:151], v[112:115], v[96:99], 0
    s_waitcnt lgkmcnt(6)
    v_mfma_f32_16x16x32_bf16 v[144:147], v[116:119], v[84:87], v[144:147]
    v_mfma_f32_16x16x32_bf16 v[148:151], v[116:119], v[100:103], v[148:151]
    s_waitcnt lgkmcnt(5)
    v_mfma_f32_16x16x32_bf16 v[144:147], v[120:123], v[88:91], v[144:147]
    v_mfma_f32_16x16x32_bf16 v[148:151], v[120:123], v[104:107], v[148:151]
    s_waitcnt lgkmcnt(4)
    v_mfma_f32_16x16x32_bf16 v[144:147], v[124:127], v[92:95], v[144:147]
    v_mfma_f32_16x16x32_bf16 v[148:151], v[124:127], v[108:111], v[148:151]
    ds_read_b128 v[112:115], v6 offset:25088
    ds_read_b128 v[116:119], v6 offset:25152
    ds_read_b128 v[120:123], v6 offset:25216
    ds_read_b128 v[124:127], v6 offset:25280
    s_waitcnt lgkmcnt(7)
    v_mfma_f32_16x16x32_bf16 v[152:155], v[128:131], v[80:83], 0
    v_mfma_f32_16x16x32_bf16 v[156:159], v[128:131], v[96:99], 0
    s_waitcnt lgkmcnt(6)
    v_mfma_f32_16x16x32_bf16 v[152:155], v[132:135], v[84:87], v[152:155]
    v_mfma_f32_16x16x32_bf16 v[156:159], v[132:135], v[100:103], v[156:159]
    s_waitcnt lgkmcnt(5)
    v_mfma_f32_16x16x32_bf16 v[152:155], v[136:139], v[88:91], v[152:155]
    v_mfma_f32_16x16x32_bf16 v[156:159], v[136:139], v[104:107], v[156:159]
    s_waitcnt lgkmcnt(4)
    v_mfma_f32_16x16x32_bf16 v[152:155], v[140:143], v[92:95], v[152:155]
    v_mfma_f32_16x16x32_bf16 v[156:159], v[140:143], v[108:111], v[156:159]
    ds_read_b128 v[128:131], v6 offset:29440
    ds_read_b128 v[132:135], v6 offset:29504
    ds_read_b128 v[136:139], v6 offset:29568
    ds_read_b128 v[140:143], v6 offset:29632
    v_cvt_pk_bf16_f32 v48, v144, v145
    v_cvt_pk_bf16_f32 v49, v146, v147
    v_cvt_pk_bf16_f32 v50, v148, v149
    v_cvt_pk_bf16_f32 v51, v150, v151
    buffer_store_dwordx4 v[48:51], v7, s[12:15], 0 offen sc1
    v_add_u32 v7, 1048576, v7
    s_waitcnt lgkmcnt(7)
    v_mfma_f32_16x16x32_bf16 v[144:147], v[112:115], v[80:83], 0
    v_mfma_f32_16x16x32_bf16 v[148:151], v[112:115], v[96:99], 0
    s_waitcnt lgkmcnt(6)
    v_mfma_f32_16x16x32_bf16 v[144:147], v[116:119], v[84:87], v[144:147]
    v_mfma_f32_16x16x32_bf16 v[148:151], v[116:119], v[100:103], v[148:151]
    s_waitcnt lgkmcnt(5)
    v_mfma_f32_16x16x32_bf16 v[144:147], v[120:123], v[88:91], v[144:147]
    v_mfma_f32_16x16x32_bf16 v[148:151], v[120:123], v[104:107], v[148:151]
    s_waitcnt lgkmcnt(4)
    v_mfma_f32_16x16x32_bf16 v[144:147], v[124:127], v[92:95], v[144:147]
    v_mfma_f32_16x16x32_bf16 v[148:151], v[124:127], v[108:111], v[148:151]
    ds_read_b128 v[112:115], v6 offset:33792
    ds_read_b128 v[116:119], v6 offset:33856
    ds_read_b128 v[120:123], v6 offset:33920
    ds_read_b128 v[124:127], v6 offset:33984
    v_cvt_pk_bf16_f32 v52, v152, v153
    v_cvt_pk_bf16_f32 v53, v154, v155
    v_cvt_pk_bf16_f32 v54, v156, v157
    v_cvt_pk_bf16_f32 v55, v158, v159
    buffer_store_dwordx4 v[52:55], v7, s[12:15], 0 offen sc1
    v_add_u32 v7, 1048576, v7
    s_waitcnt lgkmcnt(7)
    v_mfma_f32_16x16x32_bf16 v[152:155], v[128:131], v[80:83], 0
    v_mfma_f32_16x16x32_bf16 v[156:159], v[128:131], v[96:99], 0
    s_waitcnt lgkmcnt(6)
    v_mfma_f32_16x16x32_bf16 v[152:155], v[132:135], v[84:87], v[152:155]
    v_mfma_f32_16x16x32_bf16 v[156:159], v[132:135], v[100:103], v[156:159]
    s_waitcnt lgkmcnt(5)
    v_mfma_f32_16x16x32_bf16 v[152:155], v[136:139], v[88:91], v[152:155]
    v_mfma_f32_16x16x32_bf16 v[156:159], v[136:139], v[104:107], v[156:159]
    s_waitcnt lgkmcnt(4)
    v_mfma_f32_16x16x32_bf16 v[152:155], v[140:143], v[92:95], v[152:155]
    v_mfma_f32_16x16x32_bf16 v[156:159], v[140:143], v[108:111], v[156:159]
    v_cvt_pk_bf16_f32 v48, v144, v145
    v_cvt_pk_bf16_f32 v49, v146, v147
    v_cvt_pk_bf16_f32 v50, v148, v149
    v_cvt_pk_bf16_f32 v51, v150, v151
    buffer_store_dwordx4 v[48:51], v7, s[12:15], 0 offen sc1
    v_add_u32 v7, 1048576, v7
    s_waitcnt lgkmcnt(3)
    v_mfma_f32_16x16x32_bf16 v[144:147], v[112:115], v[80:83], 0
    v_mfma_f32_16x16x32_bf16 v[148:151], v[112:115], v[96:99], 0
    s_waitcnt lgkmcnt(2)
    v_mfma_f32_16x16x32_bf16 v[144:147], v[116:119], v[84:87], v[144:147]
    v_mfma_f32_16x16x32_bf16 v[148:151], v[116:119], v[100:103], v[148:151]
    s_waitcnt lgkmcnt(1)
    v_mfma_f32_16x16x32_bf16 v[144:147], v[120:123], v[88:91], v[144:147]
    v_mfma_f32_16x16x32_bf16 v[148:151], v[120:123], v[104:107], v[148:151]
    s_waitcnt lgkmcnt(0)
    v_mfma_f32_16x16x32_bf16 v[144:147], v[124:127], v[92:95], v[144:147]
    v_mfma_f32_16x16x32_bf16 v[148:151], v[124:127], v[108:111], v[148:151]
    v_cvt_pk_bf16_f32 v52, v152, v153
    v_cvt_pk_bf16_f32 v53, v154, v155
    v_cvt_pk_bf16_f32 v54, v156, v157
    v_cvt_pk_bf16_f32 v55, v158, v159
    buffer_store_dwordx4 v[52:55], v7, s[12:15], 0 offen sc1
    v_add_u32 v7, 1048576, v7
    s_nop 7
    v_cvt_pk_bf16_f32 v48, v144, v145
    v_cvt_pk_bf16_f32 v49, v146, v147
    v_cvt_pk_bf16_f32 v50, v148, v149
    v_cvt_pk_bf16_f32 v51, v150, v151
    buffer_store_dwordx4 v[48:51], v7, s[12:15], 0 offen sc1
    s_cmp_eq_u32 s16, 7
    s_cbranch_scc0 L_fin
    s_waitcnt vmcnt(5)
    v_readfirstlane_b32 s36, v176
    s_cmp_eq_u32 s36, 0
    s_cbranch_scc0 L_fin
    s_mov_b32 s44, s54
    s_mov_b32 s45, s55
    s_mov_b32 s46, 256
    s_mov_b32 s47, 0x00020000
    v_mov_b32 v144, 0
    v_mov_b32 v145, 1
    s_mov_b64 exec, 1
    buffer_store_dword v145, v144, s[44:47], 0 offen sc1
    s_mov_b64 exec, -1
L_fin:
L_m_end:
    s_endpgm
.section .rodata,"a"
.p2align 6
.amdhsa_kernel standalone__tensor_product_equiv_tfn__graph_kernel
.amdhsa_next_free_vgpr 239
.amdhsa_next_free_sgpr 100
.amdhsa_accum_offset 240
.amdhsa_group_segment_fixed_size 0
.amdhsa_kernarg_size 88
.amdhsa_user_sgpr_count 2
.amdhsa_user_sgpr_kernarg_segment_ptr 1
.amdhsa_system_sgpr_workgroup_id_x 1
.amdhsa_float_denorm_mode_32 3
.end_amdhsa_kernel
```

```asm
; @launch grid=(256,1,1) block=(512,1,1) lds=162320
.amdgcn_target "amdgcn-amd-amdhsa--gfx950"
.text
.globl standalone__tensor_product_equiv_tfn__graph_kernel
.p2align 8
.type standalone__tensor_product_equiv_tfn__graph_kernel,@function
standalone__tensor_product_equiv_tfn__graph_kernel:
    s_cmp_ge_u32 s2, 256
    s_cbranch_scc1 L_end
    s_load_dwordx16 s[36:51], s[0:1], 0
    s_load_dwordx4 s[52:55], s[0:1], 64
    s_load_dwordx2 s[56:57], s[0:1], 80
    v_lshrrev_b32 v2, 6, v0
    v_and_b32 v1, 63, v0
    v_readfirstlane_b32 s16, v2
    s_and_b32 s17, s2, 7
    s_lshl_b32 s17, s17, 5
    s_lshr_b32 s26, s2, 3
    s_or_b32 s17, s17, s26
    v_lshlrev_b32 v7, 3, v0
    v_mov_b32 v2, 0
    v_mov_b32 v3, 0
    v_mov_b32 v4, 162304
    ds_write_b64 v7, v[2:3]
    ds_write_b32 v4, v2
    v_lshlrev_b32 v232, 4, v1
    s_mul_i32 s26, s16, 160
    v_add_u32 v6, s26, v1
    v_lshlrev_b32 v53, 2, v6
    v_lshlrev_b32 v54, 3, v6
    s_mul_i32 s26, s16, 1920
    v_add_u32 v55, s26, v232
    s_mul_i32 s26, s16, 5120
    v_add_u32 v56, s26, v232
    s_cmp_lt_u32 s16, 7
    s_cselect_b32 s60, -1, 3
    s_mov_b32 s61, 0
    s_cselect_b64 s[62:63], -1, 15
    s_cselect_b32 s34, -1, 0xff
    s_cselect_b32 s35, 0xffffff, s34
    s_mul_i32 s58, s17, 5000
    s_mul_i32 s59, s17, 10000
    s_lshl_b32 s29, s17, 6
    s_add_u32 s29, s29, 14417920
    s_waitcnt lgkmcnt(0)
    s_mov_b32 s64, s40
    s_mov_b32 s65, s41
    s_mov_b32 s66, 1280000
    s_mov_b32 s67, 0x00020000
    buffer_load_dword v144, v53, s[64:67], s58 offen offset:0
    buffer_load_dword v145, v53, s[64:67], s58 offen offset:256
    s_mov_b64 exec, s[60:61]
    buffer_load_dword v146, v53, s[64:67], s58 offen offset:512
    s_mov_b64 exec, -1
    s_getpc_b64 s[82:83]
L_pc:
    s_lshr_b32 s80, s2, 3
    s_lshl_b32 s80, s80, 3
    s_add_u32 s80, s80, s16
    s_lshl_b32 s81, s80, 6
    s_min_u32 s81, s81, L_end-L_pc
    s_load_dword s3, s[82:83], s81
    s_lshl_b32 s81, s80, 7
    s_load_dword s3, s[50:51], s81
    s_add_u32 s81, s81, 64
    s_load_dword s3, s[50:51], s81
    s_lshl_b32 s81, s80, 4
    s_load_dword s3, s[46:47], s81
    s_and_b32 s81, s80, 64
    s_load_dword s3, s[48:49], s81
    s_mov_b32 s68, s38
    s_mov_b32 s69, s39
    s_mov_b32 s70, 1280000
    s_mov_b32 s71, 0x00020000
    buffer_load_dword v147, v53, s[68:71], s58 offen offset:0
    buffer_load_dword v148, v53, s[68:71], s58 offen offset:256
    s_mov_b64 exec, s[60:61]
    buffer_load_dword v149, v53, s[68:71], s58 offen offset:512
    s_mov_b64 exec, -1
    s_mov_b32 s72, s42
    s_mov_b32 s73, s43
    s_mov_b32 s74, 2560000
    s_mov_b32 s75, 0x00020000
    buffer_load_dwordx2 v[152:153], v54, s[72:75], s59 offen offset:0
    buffer_load_dwordx2 v[156:157], v54, s[72:75], s59 offen offset:512
    s_mov_b64 exec, s[60:61]
    buffer_load_dwordx2 v[160:161], v54, s[72:75], s59 offen offset:1024
    s_mov_b64 exec, -1
    s_mov_b32 s8, s56
    s_mov_b32 s9, s57
    s_mov_b32 s10, 16777216
    s_mov_b32 s11, 0x00020000
    s_mov_b32 s76, s44
    s_mov_b32 s77, s45
    s_mov_b32 s78, 10240000
    s_mov_b32 s79, 0x00020000
    s_barrier
    s_add_u32 m0, s26, 58880
    s_mul_i32 s58, s17, 40000
    buffer_load_dwordx4 v56, s[76:79], s58 offen offset:0 lds
    buffer_load_dwordx4 v56, s[76:79], s58 offen offset:1024 lds
    buffer_load_dwordx4 v56, s[76:79], s58 offen offset:2048 lds
    buffer_load_dwordx4 v56, s[76:79], s58 offen offset:3072 lds
    s_add_u32 m0, s26, 62976
    s_add_u32 s58, s58, 4096
    s_mov_b64 exec, s[62:63]
    buffer_load_dwordx4 v56, s[76:79], s58 offen lds
    s_mov_b64 exec, -1
    v_mov_b32 v6, 1
    v_lshrrev_b32 v7, 2, v1
    v_mul_u32_u24 v7, 16320, v7
    v_add_u32 v72, v7, v232
    s_cmp_eq_u32 s16, 7
    s_cselect_b32 s59, s29, 0x40000000
    v_add_u32 v7, s59, v72
    buffer_load_dwordx4 v[64:67], v7, s[8:11], 0 offen
    s_waitcnt vmcnt(12)
    v_and_b32 v2, 255, v144
    v_lshlrev_b32 v167, 2, v2
    ds_add_rtn_u32 v164, v167, v6 offset:3072
    v_and_b32 v2, 255, v145
    v_lshlrev_b32 v168, 2, v2
    ds_add_rtn_u32 v165, v168, v6 offset:3072
    s_mov_b64 exec, s[60:61]
    v_and_b32 v2, 255, v146
    v_lshlrev_b32 v169, 2, v2
    ds_add_rtn_u32 v166, v169, v6 offset:3072
    s_mov_b64 exec, -1
    s_movk_i32 s27, 5033
    s_waitcnt vmcnt(9)
    v_lshrrev_b32 v3, 8, v144
    v_mul_u32_u24 v2, s27, v147
    v_lshrrev_b32 v2, 22, v2
    v_mad_u32_u24 v2, v3, 12, v2
    v_lshl_or_b32 v154, v147, 10, v2
    v_lshrrev_b32 v3, 8, v145
    v_mul_u32_u24 v2, s27, v148
    v_lshrrev_b32 v2, 22, v2
    v_mad_u32_u24 v2, v3, 12, v2
    v_lshl_or_b32 v158, v148, 10, v2
    v_lshrrev_b32 v3, 8, v146
    v_mul_u32_u24 v2, s27, v149
    v_lshrrev_b32 v2, 22, v2
    v_mad_u32_u24 v2, v3, 12, v2
    v_lshl_or_b32 v162, v149, 10, v2
    s_waitcnt lgkmcnt(0)
    s_barrier
    ds_read_b128 v[172:175], v232 offset:3072
    s_waitcnt lgkmcnt(0)
    v_add_u32 v50, v172, v173
    v_add_u32 v51, v50, v174
    v_add_u32 v2, v51, v175
    v_mov_b32 v3, v2
    v_lshlrev_b32 v4, 2, v54
    v_lshrrev_b32 v5, 1, v0
    v_add_u32_dpp v3, v3, v3 row_shr:1 row_mask:0xf bank_mask:0xf
    s_lshr_b32 s59, s17, 4
    s_mul_i32 s59, s59, 16320
    v_add_u32_dpp v3, v3, v3 row_shr:2 row_mask:0xf bank_mask:0xf
    s_lshl2_add_u32 s59, s17, s59
    s_add_u32 s59, s59, 14417920
    v_add_u32_dpp v3, v3, v3 row_shr:4 row_mask:0xf bank_mask:0xf
    v_lshl_add_u32 v58, v5, 6, s59
    s_nop 0
    v_add_u32_dpp v3, v3, v3 row_shr:8 row_mask:0xf bank_mask:0xf
    s_nop 1
    v_add_u32_dpp v3, v3, v3 row_bcast:15 row_mask:0xa bank_mask:0xf
    s_nop 1
    v_add_u32_dpp v3, v3, v3 row_bcast:31 row_mask:0xc bank_mask:0xf
    v_sub_u32 v48, v3, v2
    v_add_u32 v49, v48, v172
    v_add_u32 v50, v48, v50
    v_add_u32 v51, v48, v51
    ds_write_b128 v232, v[48:51] offset:10752
    ds_read_b32 v167, v167 offset:10752
    ds_read_b32 v168, v168 offset:10752
    s_mov_b64 exec, s[60:61]
    ds_read_b32 v169, v169 offset:10752
    s_mov_b64 exec, -1
    v_lshl_or_b32 v60, v172, 16, v48
    v_lshl_or_b32 v61, v173, 16, v49
    v_lshl_or_b32 v62, v174, 16, v50
    v_lshl_or_b32 v63, v175, 16, v51
    s_mov_b32 s27, 43520
    s_waitcnt vmcnt(6) lgkmcnt(0)
    v_add_lshl_u32 v2, v167, v164, 1
    v_add_u32 v3, 0, v4
    ds_write_b16 v2, v3 offset:8192
    v_mad_u32_u24 v2, v2, 6, s27
    ds_write2_b32 v2, v152, v153 offset0:0 offset1:1
    ds_write_b32 v2, v154 offset:8
    v_add_lshl_u32 v2, v168, v165, 1
    v_add_u32 v3, 2048, v4
    ds_write_b16 v2, v3 offset:8192
    v_mad_u32_u24 v2, v2, 6, s27
    ds_write2_b32 v2, v156, v157 offset0:0 offset1:1
    ds_write_b32 v2, v158 offset:8
    s_mov_b64 exec, s[60:61]
    v_add_lshl_u32 v2, v169, v166, 1
    v_add_u32 v3, 4096, v4
    ds_write_b16 v2, v3 offset:8192
    v_mad_u32_u24 v2, v2, 6, s27
    ds_write2_b32 v2, v160, v161 offset0:0 offset1:1
    ds_write_b32 v2, v162 offset:8
    s_mov_b64 exec, -1
    v_lshrrev_b32 v2, 4, v56
    v_and_b32 v2, 0xffe, v2
    v_and_b32 v5, 1, v1
    v_lshlrev_b32 v5, 4, v5
    s_waitcnt lgkmcnt(0)
    s_barrier
    buffer_load_dword v59, v58, s[8:11], 0 offen
    s_mov_b32 s68, s46
    s_mov_b32 s69, s47
    s_mov_b32 s70, 4096
    s_mov_b32 s71, 0x00020000
    s_mov_b32 s64, s48
    s_mov_b32 s65, s49
    s_mov_b32 s66, 128
    s_mov_b32 s67, 0x00020000
    v_lshlrev_b32 v7, 1, v1
    s_lshl_b32 s58, s16, 9
    s_add_u32 m0, s58, 16384
    s_mov_b32 exec_hi, 0
    buffer_load_dwordx4 v232, s[68:71], s58 offen lds
    s_mov_b32 exec_hi, -1
    buffer_load_ushort v57, v7, s[64:67], 0 offen
    ds_read_b128 v[152:155], v55 offset:43520
    ds_read_b128 v[156:159], v55 offset:44544
    ds_read_u16 v164, v2 offset:8192
    ds_read_u16 v165, v2 offset:8256
    ds_read_u16 v166, v2 offset:8320
    ds_read_u16 v167, v2 offset:8384
    ds_read_u16 v168, v2 offset:8448
    s_mov_b32 s4, s36
    s_mov_b32 s5, s37
    s_mov_b32 s6, 10240000
    s_mov_b32 s7, 0x00020000
    s_mov_b32 s12, s52
    s_mov_b32 s13, s53
    s_mov_b32 s14, 10240000
    s_mov_b32 s15, 0x00020000
    s_mov_b32 s20, 0x0f0f0f0f
    s_mov_b32 s21, 0x0f0f0f0f
    s_mov_b32 s22, 0xf0f0f0f0
    s_mov_b32 s23, 0xf0f0f0f0
    s_mov_b32 s31, 0xfffffc00
    s_mov_b32 s32, 0x9c4028
    s_mov_b32 s33, 0xffe0
    s_mov_b32 s24, 0
    s_mov_b32 s25, 0
    v_mov_b32 v8, 0
    v_mov_b32 v9, 0
    v_mov_b32 v10, 0
    v_mov_b32 v11, 0
    v_mov_b32 v12, 0
    v_mov_b32 v13, 0
    v_mov_b32 v14, 0
    v_mov_b32 v15, 0
    v_mov_b32 v16, 0
    v_mov_b32 v17, 0
    v_mov_b32 v18, 0
    v_mov_b32 v19, 0
    v_mov_b32 v20, 0
    v_mov_b32 v21, 0
    v_mov_b32 v22, 0
    v_mov_b32 v23, 0
    v_mov_b32 v24, 0
    v_mov_b32 v25, 0
    v_mov_b32 v26, 0
    v_mov_b32 v27, 0
    v_mov_b32 v28, 0
    v_mov_b32 v29, 0
    v_mov_b32 v30, 0
    v_mov_b32 v31, 0
    v_mov_b32 v32, 0
    v_mov_b32 v33, 0
    v_mov_b32 v34, 0
    v_mov_b32 v35, 0
    v_mov_b32 v36, 0
    v_mov_b32 v37, 0
    v_mov_b32 v38, 0
    v_mov_b32 v39, 0
    v_mov_b32 v40, 0
    v_mov_b32 v41, 0
    v_mov_b32 v42, 0
    v_mov_b32 v43, 0
    v_mov_b32 v44, 0
    v_mov_b32 v45, 0
    v_mov_b32 v46, 0
    v_mov_b32 v47, 0
    v_mov_b32 v192, 0
    v_mov_b32 v193, 0
    v_mov_b32 v194, 0
    v_mov_b32 v195, 0
    v_mov_b32 v196, 0
    v_mov_b32 v197, 0
    v_mov_b32 v198, 0
    v_mov_b32 v199, 0
    v_mov_b32 v112, 0
    v_mov_b32 v238, 0
    s_cmp_lt_u32 s17, 16
    s_cbranch_scc1 L_map40
    v_writelane_b32 v112, 0, 0
    v_writelane_b32 v112, 5, 1
    v_writelane_b32 v112, 6, 2
    v_writelane_b32 v112, 3, 3
    v_writelane_b32 v112, 8, 4
    v_writelane_b32 v112, 7, 5
    v_writelane_b32 v112, 2, 6
    v_writelane_b32 v112, 4, 7
    v_writelane_b32 v112, 1, 8
    v_writelane_b32 v112, 16, 9
    v_writelane_b32 v112, 10, 10
    v_writelane_b32 v112, 15, 11
    v_writelane_b32 v112, 9, 12
    v_writelane_b32 v112, 24, 13
    v_writelane_b32 v112, 14, 14
    v_writelane_b32 v112, 11, 15
    v_writelane_b32 v112, 13, 16
    v_writelane_b32 v112, 12, 17
    v_writelane_b32 v112, 17, 18
    v_writelane_b32 v112, 23, 19
    v_writelane_b32 v112, 20, 20
    v_writelane_b32 v112, 22, 21
    v_writelane_b32 v112, 19, 22
    v_writelane_b32 v112, 18, 23
    v_writelane_b32 v112, 21, 24
    v_writelane_b32 v112, 28, 25
    v_writelane_b32 v112, 29, 26
    v_writelane_b32 v112, 31, 27
    v_writelane_b32 v112, 26, 28
    v_writelane_b32 v112, 25, 29
    v_writelane_b32 v112, 27, 30
    v_writelane_b32 v112, 30, 31
    v_writelane_b32 v112, 36, 32
    v_writelane_b32 v112, 33, 33
    v_writelane_b32 v112, 35, 34
    v_writelane_b32 v112, 34, 35
    v_writelane_b32 v112, 38, 36
    v_writelane_b32 v112, 39, 37
    v_writelane_b32 v112, 37, 38
    v_writelane_b32 v112, 32, 39
    s_branch L_mapd
L_map40:
    v_writelane_b32 v112, 7, 0
    v_writelane_b32 v112, 0, 1
    v_writelane_b32 v112, 5, 2
    v_writelane_b32 v112, 2, 3
    v_writelane_b32 v112, 4, 4
    v_writelane_b32 v112, 3, 5
    v_writelane_b32 v112, 1, 6
    v_writelane_b32 v112, 6, 7
    v_writelane_b32 v112, 12, 8
    v_writelane_b32 v112, 9, 9
    v_writelane_b32 v112, 14, 10
    v_writelane_b32 v112, 11, 11
    v_writelane_b32 v112, 15, 12
    v_writelane_b32 v112, 10, 13
    v_writelane_b32 v112, 8, 14
    v_writelane_b32 v112, 13, 15
    v_writelane_b32 v112, 21, 16
    v_writelane_b32 v112, 22, 17
    v_writelane_b32 v112, 19, 18
    v_writelane_b32 v112, 16, 19
    v_writelane_b32 v112, 23, 20
    v_writelane_b32 v112, 17, 21
    v_writelane_b32 v112, 18, 22
    v_writelane_b32 v112, 20, 23
    v_writelane_b32 v112, 26, 24
    v_writelane_b32 v112, 29, 25
    v_writelane_b32 v112, 27, 26
    v_writelane_b32 v112, 25, 27
    v_writelane_b32 v112, 28, 28
    v_writelane_b32 v112, 30, 29
    v_writelane_b32 v112, 24, 30
    v_writelane_b32 v112, 31, 31
    v_writelane_b32 v112, 38, 32
    v_writelane_b32 v112, 33, 33
    v_writelane_b32 v112, 36, 34
    v_writelane_b32 v112, 35, 35
    v_writelane_b32 v112, 34, 36
    v_writelane_b32 v112, 32, 37
    v_writelane_b32 v112, 37, 38
    v_writelane_b32 v112, 39, 39
L_mapd:
    v_and_b32 v2, 3, v1
    v_lshrrev_b32 v3, 2, v1
    v_lshl_add_u32 v234, v2, 4, v3
    v_lshrrev_b32 v2, 5, v1
    v_lshlrev_b32 v233, 4, v2
    s_mul_i32 s26, s16, 5
    v_add_u32 v113, s26, v1
    v_subrev_u32 v3, 40, v113
    v_min_u32 v113, v113, v3
    v_mul_u32_u24 v3, 205, v1
    v_lshrrev_b32 v3, 10, v3
    v_mul_u32_u24 v2, 5, v3
    v_sub_u32 v115, v1, v2
    s_lshr_b32 s26, s17, 5
    s_mul_i32 s26, s26, 12
    s_lshr_b32 s26, s26, 3
    v_add_u32 v3, s26, v3
    v_subrev_u32 v2, 12, v3
    v_min_u32 v3, v3, v2
    v_lshlrev_b32 v114, 2, v3
    s_and_b32 s26, s16, 3
    s_lshl_b32 s58, s26, 9
    s_add_u32 s58, s58, 129536
    v_lshrrev_b32 v3, 4, v1
    v_mul_u32_u24 v2, 1792, v3
    v_add3_u32 v240, v2, s58, v232
    s_lshr_b32 s58, s16, 2
    v_and_b32 v2, 15, v1
    v_mul_u32_u24 v241, 272, v2
    v_lshl_add_u32 v241, v3, 4, v241
    s_mul_i32 s59, s58, 21760
    v_add_u32 v241, s59, v241
    v_lshlrev_b32 v242, 18, v3
    v_lshl_add_u32 v242, v2, 4, v242
    s_mul_i32 s58, s58, 5242880
    s_lshl_b32 s59, s17, 10
    s_add_u32 s58, s58, s59
    s_lshl_b32 s59, s26, 8
    s_add_u32 s58, s58, s59
    v_add_u32 v242, s58, v242
    v_mov_b32 v244, 162304
    s_mov_b32 s72, s50
    s_mov_b32 s73, s51
    s_mov_b32 s74, 32768
    s_mov_b32 s75, 0x00020000
    s_mov_b32 s44, s54
    s_mov_b32 s45, s55
    s_mov_b32 s46, 256
    s_mov_b32 s47, 0x00020000
    s_waitcnt lgkmcnt(0)
    v_or_b32 v164, v164, v5
    v_or_b32 v165, v165, v5
    v_or_b32 v166, v166, v5
    v_or_b32 v167, v167, v5
    v_or_b32 v168, v168, v5
    s_mul_i32 s27, s17, 15360
    s_add_u32 s27, s27, 10485760
    s_mul_i32 s58, s17, 40960
    s_add_u32 s59, s58, 4096
    s_waitcnt vmcnt(4)
    s_barrier
    ds_read_b128 v[80:83], v164 offset:58880
    ds_read_b128 v[84:87], v165 offset:58880
    ds_read_b128 v[88:91], v166 offset:58880
    ds_read_b128 v[92:95], v167 offset:58880
    s_mov_b64 exec, s[62:63]
    ds_read_b128 v[96:99], v168 offset:58880
    s_mov_b64 exec, -1
    buffer_store_dwordx4 v[152:155], v55, s[8:11], s27 offen sc1
    s_mov_b32 exec_hi, s35
    buffer_store_dwordx4 v[156:159], v55, s[8:11], s27 offen offset:1024 sc1
    s_mov_b32 exec_hi, -1
    s_waitcnt lgkmcnt(4)
    buffer_store_dwordx4 v[80:83], v56, s[8:11], s58 offen offset:0 sc1
    s_waitcnt lgkmcnt(3)
    buffer_store_dwordx4 v[84:87], v56, s[8:11], s58 offen offset:1024 sc1
    s_waitcnt lgkmcnt(2)
    buffer_store_dwordx4 v[88:91], v56, s[8:11], s58 offen offset:2048 sc1
    s_waitcnt lgkmcnt(1)
    buffer_store_dwordx4 v[92:95], v56, s[8:11], s58 offen offset:3072 sc1
    s_mov_b32 exec_lo, s34
    s_mov_b32 exec_hi, s63
    s_waitcnt lgkmcnt(0)
    buffer_store_dwordx4 v[96:99], v56, s[8:11], s59 offen offset:0 sc1
    s_mov_b64 exec, -1
    s_mov_b32 s30, 400000
    s_mov_b32 s53, 0
    s_mov_b32 s59, 0xc0000000
    s_waitcnt vmcnt(7)
    v_not_b32 v64, v64
    v_and_or_b32 v60, v64, s59, v60
    v_not_b32 v65, v65
    v_and_or_b32 v61, v65, s59, v61
    v_not_b32 v66, v66
    v_and_or_b32 v62, v66, s59, v62
    v_not_b32 v67, v67
    v_and_or_b32 v63, v67, s59, v63
    v_and_b32 v2, 0x30, v1
    v_and_b32 v3, 3, v1
    v_lshl_add_u32 v2, v3, 2, v2
    v_bfe_u32 v7, v1, 2, 2
    v_add_lshl_u32 v2, v2, v7, 1
    ds_write_b16 v2, v57 offset:6656
    v_lshlrev_b32 v3, 3, v3
    ds_read_b64 v[216:217], v3 offset:6656
    ds_read_b64 v[218:219], v3 offset:6688
    ds_read_b64 v[220:221], v3 offset:6720
    ds_read_b64 v[222:223], v3 offset:6752
    s_lshl_b32 s58, s16, 12
    s_add_u32 m0, s58, 129536
    s_cmp_eq_u32 s16, 7
    s_waitcnt vmcnt(0) lgkmcnt(0)
    s_barrier
    s_cbranch_scc0 L_nrow2
    buffer_store_dwordx4 v[60:63], v72, s[8:11], s29 offen sc1
L_nrow2:
    s_barrier
    buffer_load_dwordx4 v232, s[72:75], s58 offen offset:0 lds
    buffer_load_dwordx4 v232, s[72:75], s58 offen offset:1024 lds
    buffer_load_dwordx4 v232, s[72:75], s58 offen offset:2048 lds
    buffer_load_dwordx4 v232, s[72:75], s58 offen offset:3072 lds
    v_and_b32 v3, 31, v1
    v_lshlrev_b32 v2, 7, v233
    v_lshl_add_u32 v2, v3, 2, v2
    v_add_u32 v3, 128, v2
    ds_read2st64_b32 v[144:145], v2 offset0:64 offset1:65
    ds_read2st64_b32 v[146:147], v2 offset0:66 offset1:67
    ds_read2st64_b32 v[148:149], v2 offset0:68 offset1:69
    ds_read2st64_b32 v[150:151], v2 offset0:70 offset1:71
    ds_read2st64_b32 v[152:153], v3 offset0:64 offset1:65
    ds_read2st64_b32 v[154:155], v3 offset0:66 offset1:67
    ds_read2st64_b32 v[156:157], v3 offset0:68 offset1:69
    ds_read2st64_b32 v[158:159], v3 offset0:70 offset1:71
    s_mov_b32 s56, 0xbfb8aa3b
    s_mov_b32 s57, 0xbfb8aa3b
    s_waitcnt lgkmcnt(7)
    v_lshlrev_b32 v160, 16, v144
    v_lshlrev_b32 v161, 16, v145
    v_and_b32 v162, 0xffff0000, v144
    v_and_b32 v163, 0xffff0000, v145
    v_pk_mul_f32 v[160:161], v[160:161], s[56:57]
    v_pk_mul_f32 v[162:163], v[162:163], s[56:57]
    v_cvt_pk_bf16_f32 v200, v160, v161
    v_cvt_pk_bf16_f32 v204, v162, v163
    s_waitcnt lgkmcnt(6)
    v_lshlrev_b32 v160, 16, v146
    v_lshlrev_b32 v161, 16, v147
    v_and_b32 v162, 0xffff0000, v146
    v_and_b32 v163, 0xffff0000, v147
    v_pk_mul_f32 v[160:161], v[160:161], s[56:57]
    v_pk_mul_f32 v[162:163], v[162:163], s[56:57]
    v_cvt_pk_bf16_f32 v201, v160, v161
    v_cvt_pk_bf16_f32 v205, v162, v163
    s_waitcnt lgkmcnt(5)
    v_lshlrev_b32 v160, 16, v148
    v_lshlrev_b32 v161, 16, v149
    v_and_b32 v162, 0xffff0000, v148
    v_and_b32 v163, 0xffff0000, v149
    v_pk_mul_f32 v[160:161], v[160:161], s[56:57]
    v_pk_mul_f32 v[162:163], v[162:163], s[56:57]
    v_cvt_pk_bf16_f32 v202, v160, v161
    v_cvt_pk_bf16_f32 v206, v162, v163
    s_waitcnt lgkmcnt(4)
    v_lshlrev_b32 v160, 16, v150
    v_lshlrev_b32 v161, 16, v151
    v_and_b32 v162, 0xffff0000, v150
    v_and_b32 v163, 0xffff0000, v151
    v_pk_mul_f32 v[160:161], v[160:161], s[56:57]
    v_pk_mul_f32 v[162:163], v[162:163], s[56:57]
    v_cvt_pk_bf16_f32 v203, v160, v161
    v_cvt_pk_bf16_f32 v207, v162, v163
    s_waitcnt lgkmcnt(3)
    v_lshlrev_b32 v160, 16, v152
    v_lshlrev_b32 v161, 16, v153
    v_and_b32 v162, 0xffff0000, v152
    v_and_b32 v163, 0xffff0000, v153
    v_pk_mul_f32 v[160:161], v[160:161], s[56:57]
    v_pk_mul_f32 v[162:163], v[162:163], s[56:57]
    v_cvt_pk_bf16_f32 v208, v160, v161
    v_cvt_pk_bf16_f32 v212, v162, v163
    s_waitcnt lgkmcnt(2)
    v_lshlrev_b32 v160, 16, v154
    v_lshlrev_b32 v161, 16, v155
    v_and_b32 v162, 0xffff0000, v154
    v_and_b32 v163, 0xffff0000, v155
    v_pk_mul_f32 v[160:161], v[160:161], s[56:57]
    v_pk_mul_f32 v[162:163], v[162:163], s[56:57]
    v_cvt_pk_bf16_f32 v209, v160, v161
    v_cvt_pk_bf16_f32 v213, v162, v163
    s_waitcnt lgkmcnt(1)
    v_lshlrev_b32 v160, 16, v156
    v_lshlrev_b32 v161, 16, v157
    v_and_b32 v162, 0xffff0000, v156
    v_and_b32 v163, 0xffff0000, v157
    v_pk_mul_f32 v[160:161], v[160:161], s[56:57]
    v_pk_mul_f32 v[162:163], v[162:163], s[56:57]
    v_cvt_pk_bf16_f32 v210, v160, v161
    v_cvt_pk_bf16_f32 v214, v162, v163
    s_waitcnt lgkmcnt(0)
    v_lshlrev_b32 v160, 16, v158
    v_lshlrev_b32 v161, 16, v159
    v_and_b32 v162, 0xffff0000, v158
    v_and_b32 v163, 0xffff0000, v159
    v_pk_mul_f32 v[160:161], v[160:161], s[56:57]
    v_pk_mul_f32 v[162:163], v[162:163], s[56:57]
    v_cvt_pk_bf16_f32 v211, v160, v161
    v_cvt_pk_bf16_f32 v215, v162, v163
L_pa:
    buffer_load_dword v6, v58, s[8:11], 0 offen sc1
L_pwa:
    s_waitcnt vmcnt(0)
    v_xor_b32 v144, v6, v59
    v_lshlrev_b32 v144, 1, v144
    v_cmpx_le_i32 vcc, 0, v144
    s_cbranch_execz L_pda
    s_sub_u32 s30, s30, 1
    s_cbranch_scc1 L_end
    s_and_b32 s58, s30, 7
    s_cbranch_scc1 L_pa
    v_mov_b32 v144, 0
    buffer_load_dword v145, v144, s[44:47], 0 offen sc1
    s_waitcnt vmcnt(0)
    v_readfirstlane_b32 s53, v145
    s_cmp_eq_u32 s53, 0
    s_cbranch_scc1 L_pa
    buffer_load_dword v6, v58, s[8:11], 0 offen sc1
    s_waitcnt vmcnt(0)
L_pda:
    s_mov_b64 exec, -1
    v_and_b32 v3, 1, v0
    v_cmp_eq_u32 vcc, 0, v3
    v_bfe_u32 v2, v6, 16, 11
    v_lshrrev_b32 v4, 1, v0
    v_cndmask_b32 v236, 0, v2, vcc
    v_and_b32 v6, 0xffff, v6
    s_movk_i32 s26, 1280
    v_add_u32_dpp v236, v236, v236 row_shr:1 row_mask:0xf bank_mask:0xf
    v_mad_u32_u24 v6, v4, s26, v6
    s_nop 0
    v_add_u32_dpp v236, v236, v236 row_shr:2 row_mask:0xf bank_mask:0xf
    s_nop 1
    v_add_u32_dpp v236, v236, v236 row_shr:4 row_mask:0xf bank_mask:0xf
    s_nop 1
    v_add_u32_dpp v236, v236, v236 row_shr:8 row_mask:0xf bank_mask:0xf
    s_nop 1
    v_add_u32_dpp v236, v236, v236 row_bcast:15 row_mask:0xa bank_mask:0xf
    s_nop 1
    v_add_u32_dpp v236, v236, v236 row_bcast:31 row_mask:0xc bank_mask:0xf
    v_sub_u32 v235, v236, v2
    v_readlane_b32 s19, v236, 63
    v_sub_u32 v237, v6, v235
L_round:
    s_lshl_b32 s26, s16, 10
    s_add_u32 s26, s26, 8192
    v_and_b32 v2, 1, v0
    v_max_u32 v3, s24, v235
    v_add_u32 v3, v3, v2
    s_add_u32 s27, s24, 224
    v_min_u32 v4, s27, v236
    v_add_u32 v5, v237, v3
    s_lshl_b32 s27, s24, 2
    s_sub_u32 s27, s26, s27
    v_lshl_add_u32 v6, v3, 2, s27
    v_sub_u32 v4, v4, v3
L_exp:
    v_cmpx_lt_i32 vcc, 0, v4
    ds_write_b32 v6, v5 offset:0
    v_add_u32 v5, 2, v5
    v_cmpx_lt_i32 vcc, 2, v4
    ds_write_b32 v6, v5 offset:8
    v_add_u32 v5, 2, v5
    v_cmpx_lt_i32 vcc, 4, v4
    ds_write_b32 v6, v5 offset:16
    v_add_u32 v5, 2, v5
    v_cmpx_lt_i32 vcc, 6, v4
    ds_write_b32 v6, v5 offset:24
    v_add_u32 v5, 2, v5
    v_cmpx_lt_i32 vcc, 8, v4
    ds_write_b32 v6, v5 offset:32
    v_add_u32 v5, 2, v5
    v_cmpx_lt_i32 vcc, 10, v4
    s_cbranch_execz L_exp_done
    v_add_u32 v6, 40, v6
    v_subrev_u32 v4, 10, v4
    s_branch L_exp
L_exp_done:
    s_mov_b64 exec, -1
    v_lshl_add_u32 v3, v1, 2, s26
    v_lshrrev_b32 v7, 1, v1
    v_lshl_add_u32 v4, v7, 2, s26
    ds_read_b32 v99, v3 offset:768
    ds_read_b32 v98, v3 offset:512
    ds_read_b32 v97, v3 offset:256
    ds_read_b32 v96, v3 offset:0
    ds_read_b32 v100, v4 offset:0
    ds_read_b32 v101, v4 offset:128
    ds_read_b32 v102, v4 offset:256
    ds_read_b32 v103, v4 offset:384
    ds_read_b32 v104, v4 offset:512
    ds_read_b32 v105, v4 offset:640
    ds_read_b32 v106, v4 offset:768
    s_sub_i32 s28, s19, s24
    s_max_i32 s28, s28, 0
    s_min_i32 s28, s28, 224
    v_lshlrev_b32 v2, 4, v2
    v_mov_b32 v5, 0xffffff
    v_mov_b32 v3, s19
    v_mov_b32 v4, 2048
    s_sub_i32 s27, s28, 0
    v_cmp_gt_i32 s[36:37], s27, v1
    s_sub_i32 s27, s28, 64
    v_cmp_gt_i32 s[38:39], s27, v1
    s_sub_i32 s27, s28, 128
    v_cmp_gt_i32 s[40:41], s27, v1
    s_sub_i32 s27, s28, 192
    v_cmp_gt_i32 s[42:43], s27, v1
    s_waitcnt lgkmcnt(7)
    v_cndmask_b32 v96, v5, v96, s[36:37]
    v_mul_u32_u24 v96, 12, v96
    v_cndmask_b32 v97, v5, v97, s[38:39]
    v_mul_u32_u24 v97, 12, v97
    v_cndmask_b32 v98, v5, v98, s[40:41]
    v_mul_u32_u24 v98, 12, v98
    v_cndmask_b32 v99, v5, v99, s[42:43]
    v_mul_u32_u24 v99, 12, v99
    s_mul_i32 s80, s16, 7168
    s_mov_b32 s26, 10485760
    s_cmp_le_u32 s28, 192
    s_cbranch_scc1 L_sk3
    buffer_load_dwordx3 v[92:94], v99, s[8:11], s26 offen sc1
L_sk3:
    buffer_load_dwordx3 v[88:90], v98, s[8:11], s26 offen sc1
    buffer_load_dwordx3 v[84:86], v97, s[8:11], s26 offen sc1
    buffer_load_dwordx3 v[80:82], v96, s[8:11], s26 offen sc1
    s_waitcnt lgkmcnt(0)
    ds_max_u32 v4, v3
    s_sub_i32 s27, s28, 0
    v_cmp_gt_i32 s[64:65], s27, v7
    s_sub_i32 s27, s28, 32
    v_cmp_gt_i32 s[66:67], s27, v7
    s_sub_i32 s27, s28, 64
    v_cmp_gt_i32 s[68:69], s27, v7
    s_sub_i32 s27, s28, 96
    v_cmp_gt_i32 s[70:71], s27, v7
    s_sub_i32 s27, s28, 128
    v_cmp_gt_i32 s[72:73], s27, v7
    s_sub_i32 s27, s28, 160
    v_cmp_gt_i32 s[74:75], s27, v7
    s_sub_i32 s27, s28, 192
    v_cmp_gt_i32 s[76:77], s27, v7
    v_cndmask_b32 v100, v5, v100, s[64:65]
    v_lshl_or_b32 v100, v100, 5, v2
    v_cndmask_b32 v101, v5, v101, s[66:67]
    v_lshl_or_b32 v101, v101, 5, v2
    v_cndmask_b32 v102, v5, v102, s[68:69]
    v_lshl_or_b32 v102, v102, 5, v2
    v_cndmask_b32 v103, v5, v103, s[70:71]
    v_lshl_or_b32 v103, v103, 5, v2
    v_cndmask_b32 v104, v5, v104, s[72:73]
    v_lshl_or_b32 v104, v104, 5, v2
    v_cndmask_b32 v105, v5, v105, s[74:75]
    v_lshl_or_b32 v105, v105, 5, v2
    v_cndmask_b32 v106, v5, v106, s[76:77]
    v_lshl_or_b32 v106, v106, 5, v2
    s_barrier
    s_add_u32 m0, s80, 43520
    s_cmp_le_u32 s28, 32
    buffer_load_dwordx4 v100, s[8:11], 0 offen sc1 lds
    s_add_u32 m0, s80, 44544
    s_cmp_le_u32 s28, 64
    buffer_load_dwordx4 v101, s[8:11], 0 offen sc1 lds
    v_mov_b32 v6, 1
    v_mul_u32_u24 v3, 48, v113
    s_waitcnt vmcnt(5)
    s_mov_b64 exec, s[42:43]
    v_and_b32 v2, 0x3ff, v94
    v_lshlrev_b32 v95, 2, v2
    ds_add_rtn_u32 v111, v95, v6 offset:0
    s_waitcnt vmcnt(4)
    s_mov_b64 exec, s[40:41]
    v_and_b32 v2, 0x3ff, v90
    v_lshlrev_b32 v91, 2, v2
    ds_add_rtn_u32 v110, v91, v6 offset:0
    s_waitcnt vmcnt(3)
    s_mov_b64 exec, s[38:39]
    v_and_b32 v2, 0x3ff, v86
    v_lshlrev_b32 v87, 2, v2
    ds_add_rtn_u32 v109, v87, v6 offset:0
    s_waitcnt vmcnt(2)
    s_mov_b64 exec, s[36:37]
    v_and_b32 v2, 0x3ff, v82
    v_lshlrev_b32 v83, 2, v2
    ds_add_rtn_u32 v108, v83, v6 offset:0
    s_mov_b64 exec, -1
    s_waitcnt lgkmcnt(0)
    s_barrier
    ds_read_b128 v[148:151], v3 offset:0
    ds_read_b128 v[152:155], v3 offset:16
    ds_read_b128 v[156:159], v3 offset:32
    ds_read_b32 v4, v4
    s_lshl_b32 s26, s2, 3
    s_add_u32 s26, s26, s16
    s_add_u32 s26, s26, s24
    s_cmp_eq_u32 s26, 7
    s_cbranch_scc0 L_noall
    v_mov_b32 v144, 0
    v_mov_b32 v145, 1
    s_mov_b64 exec, 1
    buffer_store_dword v145, v144, s[44:47], 0 offen sc1
    s_mov_b64 exec, -1
L_noall:
    s_cmp_le_u32 s28, 64
    s_cbranch_scc1 L_efd
    s_add_u32 m0, s80, 45568
    s_cmp_le_u32 s28, 96
    buffer_load_dwordx4 v102, s[8:11], 0 offen sc1 lds
    s_cbranch_scc1 L_efd
    s_add_u32 m0, s80, 46592
    s_cmp_le_u32 s28, 128
    buffer_load_dwordx4 v103, s[8:11], 0 offen sc1 lds
    s_cbranch_scc1 L_efd
    s_add_u32 m0, s80, 47616
    s_cmp_le_u32 s28, 160
    buffer_load_dwordx4 v104, s[8:11], 0 offen sc1 lds
    s_cbranch_scc1 L_efd
    s_add_u32 m0, s80, 48640
    s_cmp_le_u32 s28, 192
    buffer_load_dwordx4 v105, s[8:11], 0 offen sc1 lds
    s_cbranch_scc1 L_efd
    s_add_u32 m0, s80, 49664
    s_cmp_le_u32 s28, 224
    buffer_load_dwordx4 v106, s[8:11], 0 offen sc1 lds
L_efd:
    v_cmp_gt_u32 vcc, 40, v1
    s_waitcnt lgkmcnt(0)
    v_readfirstlane_b32 s26, v4
    v_add_u32 v3, v148, v149
    v_add3_u32 v3, v3, v150, v151
    v_add3_u32 v3, v3, v152, v153
    v_add3_u32 v3, v3, v154, v155
    v_add3_u32 v3, v3, v156, v157
    v_add3_u32 v3, v3, v158, v159
    v_lshl_or_b32 v3, v3, 6, v113
    v_cndmask_b32 v3, 0, v3, vcc
    s_max_u32 s25, s25, s26
    s_cmp_lg_u32 s24, 0
    s_cbranch_scc1 L_havepos
    v_readlane_b32 s64, v3, 0
    v_readlane_b32 s65, v3, 1
    v_readlane_b32 s66, v3, 2
    v_readlane_b32 s67, v3, 3
    v_readlane_b32 s68, v3, 4
    v_cmp_lt_u32 s[70:71], s64, v3
    v_cmp_lt_u32 s[72:73], s65, v3
    v_cmp_lt_u32 s[74:75], s66, v3
    v_cmp_lt_u32 s[76:77], s67, v3
    v_cmp_lt_u32 s[78:79], s68, v3
    s_bcnt1_i32_b64 s64, s[70:71]
    s_bcnt1_i32_b64 s65, s[72:73]
    s_bcnt1_i32_b64 s66, s[74:75]
    s_bcnt1_i32_b64 s67, s[76:77]
    s_bcnt1_i32_b64 s68, s[78:79]
    v_readlane_b32 s70, v112, s64
    v_readlane_b32 s71, v112, s65
    v_readlane_b32 s72, v112, s66
    v_readlane_b32 s73, v112, s67
    v_readlane_b32 s74, v112, s68
    v_writelane_b32 v238, s70, 0
    v_writelane_b32 v238, s71, 1
    v_writelane_b32 v238, s72, 2
    v_writelane_b32 v238, s73, 3
    v_writelane_b32 v238, s74, 4
    v_lshlrev_b32 v238, 2, v238
L_havepos:
    s_mov_b64 exec, 31
    ds_write_b32 v238, v3 offset:4096
    s_mov_b64 exec, -1
    s_lshl_b32 s26, s16, 2
    v_lshl_add_u32 v3, v115, 5, s26
    v_lshlrev_b32 v4, 2, v1
    v_and_b32 v6, 7, v1
    v_cmp_gt_u32 s[34:35], s16, v6
    s_and_b64 s[34:35], s[34:35], vcc
    v_cmp_gt_u32 vcc, 60, v1
    s_waitcnt lgkmcnt(0)
    s_barrier
    ds_read_b32 v119, v3 offset:4096
    ds_read_b32 v4, v4 offset:4096
    s_waitcnt lgkmcnt(1)
    v_and_b32 v119, 63, v119
    v_mad_u32_u24 v3, v119, 48, v114
    ds_read_b32 v116, v3 offset:0
    s_waitcnt lgkmcnt(1)
    v_lshrrev_b32 v4, 6, v4
    v_cndmask_b32 v118, 0, v4, s[34:35]
    v_mul_u32_u24 v119, 1088, v119
    s_waitcnt lgkmcnt(0)
    v_cndmask_b32 v116, 0, v116, vcc
    v_mov_b32 v117, v116
    v_readlane_b32 s48, v119, 0
    v_readlane_b32 s49, v119, 1
    v_add_u32_dpp v117, v117, v117 row_shr:1 row_mask:0xf bank_mask:0xf
    v_add_u32_dpp v118, v118, v118 row_shr:1 row_mask:0xf bank_mask:0xf
    v_readlane_b32 s50, v119, 2
    v_add_u32_dpp v117, v117, v117 row_shr:2 row_mask:0xf bank_mask:0xf
    v_add_u32_dpp v118, v118, v118 row_shr:2 row_mask:0xf bank_mask:0xf
    v_readlane_b32 s51, v119, 3
    v_add_u32_dpp v117, v117, v117 row_shr:4 row_mask:0xf bank_mask:0xf
    v_add_u32_dpp v118, v118, v118 row_shr:4 row_mask:0xf bank_mask:0xf
    v_readlane_b32 s52, v119, 4
    v_add_u32_dpp v117, v117, v117 row_shr:8 row_mask:0xf bank_mask:0xf
    v_add_u32_dpp v118, v118, v118 row_shr:8 row_mask:0xf bank_mask:0xf
    v_lshlrev_b32 v4, 3, v115
    v_add_u32_dpp v117, v117, v117 row_bcast:15 row_mask:0xa bank_mask:0xf
    v_add_u32_dpp v118, v118, v118 row_bcast:15 row_mask:0xa bank_mask:0xf
    s_min_u32 s25, s25, 40000
    v_add_u32_dpp v117, v117, v117 row_bcast:31 row_mask:0xc bank_mask:0xf
    v_add_u32_dpp v118, v118, v118 row_bcast:31 row_mask:0xc bank_mask:0xf
    v_sub_u32 v116, v117, v116
    v_readlane_b32 s29, v118, 63
    v_readlane_b32 s18, v117, 63
    s_lshl_b32 s26, s29, 4
    s_add_u32 s26, s26, 100864
    v_lshl_add_u32 v116, v116, 4, s26
    v_lshl_or_b32 v116, v116, 10, v4
    s_mov_b64 exec, vcc
    ds_write_b32 v3, v116 offset:4608
    s_mov_b64 exec, -1
    s_min_u32 s18, s18, 1792
    v_lshl_add_u32 v230, v234, 4, s26
    v_and_b32 v2, 3, v1
    v_bfe_u32 v3, v1, 3, 2
    v_lshl_add_u32 v2, v3, 2, v2
    v_lshl_add_u32 v231, v2, 4, s26
    v_lshl_add_u32 v5, v1, 5, s80
    s_movk_i32 s27, 0x3ff
    s_waitcnt lgkmcnt(0)
    s_barrier
    s_mov_b64 exec, s[36:37]
    ds_read_b32 v96, v83 offset:4608
    s_mov_b64 exec, s[38:39]
    ds_read_b32 v97, v87 offset:4608
    s_mov_b64 exec, s[40:41]
    ds_read_b32 v98, v91 offset:4608
    s_mov_b64 exec, s[42:43]
    ds_read_b32 v99, v95 offset:4608
    s_mov_b64 exec, -1
    v_add_u32 v83, 0, v5
    v_add_u32 v87, 2048, v5
    v_add_u32 v91, 4096, v5
    v_add_u32 v95, 6144, v5
    s_waitcnt lgkmcnt(0)
    s_mov_b64 exec, s[36:37]
    v_bfi_b32 v82, s27, v96, v82
    v_lshrrev_b32 v96, 10, v96
    v_lshl_add_u32 v96, v108, 4, v96
    ds_write_b128 v96, v[80:83]
    s_mov_b64 exec, s[38:39]
    v_bfi_b32 v86, s27, v97, v86
    v_lshrrev_b32 v97, 10, v97
    v_lshl_add_u32 v97, v109, 4, v97
    ds_write_b128 v97, v[84:87]
    s_mov_b64 exec, s[40:41]
    v_bfi_b32 v90, s27, v98, v90
    v_lshrrev_b32 v98, 10, v98
    v_lshl_add_u32 v98, v110, 4, v98
    ds_write_b128 v98, v[88:91]
    s_mov_b64 exec, s[42:43]
    v_bfi_b32 v94, s27, v99, v94
    v_lshrrev_b32 v99, 10, v99
    v_lshl_add_u32 v99, v111, 4, v99
    ds_write_b128 v99, v[92:95]
    s_mov_b64 exec, -1
    v_cmp_gt_i32 vcc, s18, v234
    v_mov_b32 v4, s32
    s_waitcnt lgkmcnt(0)
    s_barrier
    ds_read_b128 v[224:227], v230
    ds_read_b32 v229, v231 offset:12
    ds_read_b32 v2, v231 offset:268
    s_waitcnt lgkmcnt(0)
    v_cndmask_b32 v228, v4, v226, vcc
    v_and_or_b32 v229, v229, s33, v233
    v_readlane_b32 s64, v228, 0
    v_readlane_b32 s65, v228, 4
    v_readlane_b32 s66, v228, 8
    v_readlane_b32 s67, v228, 12
    v_readlane_b32 s68, v228, 16
    v_readlane_b32 s69, v228, 20
    v_readlane_b32 s70, v228, 24
    v_readlane_b32 s71, v228, 28
    s_and_b32 s80, s64, s31
    buffer_load_dwordx4 v[48:51], v232, s[4:7], s80 offen
    s_and_b32 s81, s65, s31
    buffer_load_dwordx4 v[52:55], v232, s[4:7], s81 offen
    s_waitcnt vmcnt(2)
    s_barrier
    s_mov_b64 exec, s[20:21]
    ds_read_b128 v[192:195], v229 offset:43520
    s_mov_b64 exec, s[22:23]
    ds_read_b128 v[196:199], v229 offset:43520
    s_mov_b64 exec, -1
    v_and_or_b32 v229, v2, s33, v233
    s_and_b32 s82, s66, s31
    buffer_load_dwordx4 v[56:59], v232, s[4:7], s82 offen
    s_and_b32 s83, s67, s31
    buffer_load_dwordx4 v[60:63], v232, s[4:7], s83 offen
    s_waitcnt lgkmcnt(0)
    v_mfma_f32_32x32x16_bf16 v[80:95], v[192:195], v[200:203], 0
    v_mfma_f32_32x32x16_bf16 v[96:111], v[192:195], v[204:207], 0
    v_mfma_f32_32x32x16_bf16 v[80:95], v[196:199], v[208:211], v[80:95]
    v_mfma_f32_32x32x16_bf16 v[96:111], v[196:199], v[212:215], v[96:111]
    s_and_b32 s80, s68, s31
    buffer_load_dwordx4 v[64:67], v232, s[4:7], s80 offen
    s_and_b32 s81, s69, s31
    buffer_load_dwordx4 v[68:71], v232, s[4:7], s81 offen
    s_and_b32 s82, s70, s31
    buffer_load_dwordx4 v[72:75], v232, s[4:7], s82 offen
    s_and_b32 s83, s71, s31
    buffer_load_dwordx4 v[76:79], v232, s[4:7], s83 offen
    s_mov_b64 exec, s[20:21]
    ds_read_b128 v[192:195], v229 offset:43520
    s_mov_b64 exec, -1
    s_cmp_lg_u32 s24, 0
    s_cbranch_scc1 L_wdone
    v_lshrrev_b32 v7, 5, v0
    v_and_b32 v3, 31, v1
    v_lshlrev_b32 v7, 11, v7
    v_add_u32 v7, 129536, v7
    v_lshl_add_u32 v2, v3, 3, v7
    ds_read_b64 v[160:161], v2 offset:0
    ds_read_b64 v[162:163], v2 offset:256
    ds_read_b64 v[164:165], v2 offset:512
    ds_read_b64 v[166:167], v2 offset:768
    ds_read_b64 v[168:169], v2 offset:1024
    ds_read_b64 v[170:171], v2 offset:1280
    ds_read_b64 v[172:173], v2 offset:1536
    ds_read_b64 v[174:175], v2 offset:1792
    s_mov_b32 s58, 0x05040100
    s_mov_b32 s59, 0x07060302
    v_bfe_u32 v3, v0, 3, 2
    v_lshl_add_u32 v7, v3, 9, v7
    v_and_b32 v3, 7, v0
    v_lshl_add_u32 v7, v3, 5, v7
    v_mov_b32 v5, 162304
    v_mov_b32 v6, 1
    s_waitcnt lgkmcnt(0)
    v_perm_b32 v112, v162, v160, s58
    v_perm_b32 v113, v166, v164, s58
    v_perm_b32 v114, v170, v168, s58
    v_perm_b32 v115, v174, v172, s58
    ds_write_b128 v7, v[112:115] offset:0
    v_perm_b32 v116, v162, v160, s59
    v_perm_b32 v117, v166, v164, s59
    v_perm_b32 v118, v170, v168, s59
    v_perm_b32 v119, v174, v172, s59
    ds_write_b128 v7, v[116:119] offset:256
    v_perm_b32 v120, v163, v161, s58
    v_perm_b32 v121, v167, v165, s58
    v_perm_b32 v122, v171, v169, s58
    v_perm_b32 v123, v175, v173, s58
    ds_write_b128 v7, v[120:123] offset:16
    v_perm_b32 v124, v163, v161, s59
    v_perm_b32 v125, v167, v165, s59
    v_perm_b32 v126, v171, v169, s59
    v_perm_b32 v127, v175, v173, s59
    ds_write_b128 v7, v[124:127] offset:272
    s_mov_b64 exec, 1
    ds_add_u32 v5, v6
    s_mov_b64 exec, -1
L_wdone:
    s_cmp_eq_u32 s16, 7
    s_cselect_b32 s3, 64, 0x80000000
    s_mov_b32 s53, 1
    s_mov_b32 s30, s18
    s_waitcnt lgkmcnt(0)
L_sb:
    s_cmp_gt_i32 s30, s3
    s_cbranch_scc1 L_nofl
    s_load_dword s53, s[54:55], 0
L_nofl:
    v_mfma_f32_4x4x4_16b_bf16 v[144:147], v[224:225], v[216:217], 0
    v_mfma_f32_4x4x4_16b_bf16 v[148:151], v[224:225], v[218:219], 0
    v_mfma_f32_4x4x4_16b_bf16 v[152:155], v[224:225], v[220:221], 0
    v_mfma_f32_4x4x4_16b_bf16 v[156:159], v[224:225], v[222:223], 0
    v_add_u32 v230, 1024, v230
    s_sub_u32 s26, s30, 64
    v_cmp_gt_i32 s[34:35], s26, v234
    s_cmp_le_i32 s30, 0
    s_nop 0
    v_cvt_pk_bf16_f32 v184, v144, v148
    v_cvt_pk_bf16_f32 v185, v152, v156
    v_cvt_pk_bf16_f32 v186, v145, v149
    v_cvt_pk_bf16_f32 v187, v153, v157
    v_cvt_pk_bf16_f32 v188, v146, v150
    v_cvt_pk_bf16_f32 v189, v154, v158
    v_cvt_pk_bf16_f32 v190, v147, v151
    v_cvt_pk_bf16_f32 v191, v155, v159
    ds_read_b128 v[224:227], v230
    ds_read_b32 v243, v244
    s_cbranch_scc1 L_exit
    s_setprio 3
    s_waitcnt vmcnt(4)
    v_mfma_f32_4x4x4_16b_bf16 v[144:147], v[184:185], v[48:49], 0 cbsz:4 abid:0
    v_exp_f32 v176, v80
    v_mfma_f32_4x4x4_16b_bf16 v[148:151], v[184:185], v[50:51], 0 cbsz:4 abid:0
    v_exp_f32 v180, v96
    v_mfma_f32_4x4x4_16b_bf16 v[152:155], v[184:185], v[52:53], 0 cbsz:4 abid:1
    v_exp_f32 v177, v81
    v_mfma_f32_4x4x4_16b_bf16 v[156:159], v[184:185], v[54:55], 0 cbsz:4 abid:1
    v_exp_f32 v181, v97
    v_mfma_f32_4x4x4_16b_bf16 v[160:163], v[184:185], v[56:57], 0 cbsz:4 abid:2
    v_exp_f32 v178, v82
    v_mfma_f32_4x4x4_16b_bf16 v[164:167], v[184:185], v[58:59], 0 cbsz:4 abid:2
    v_exp_f32 v182, v98
    v_mfma_f32_4x4x4_16b_bf16 v[168:171], v[184:185], v[60:61], 0 cbsz:4 abid:3
    v_exp_f32 v179, v83
    v_mfma_f32_4x4x4_16b_bf16 v[172:175], v[184:185], v[62:63], 0 cbsz:4 abid:3
    v_exp_f32 v183, v99
    v_readlane_b32 s72, v228, 32
    v_readlane_b32 s73, v228, 36
    v_readlane_b32 s74, v228, 40
    v_readlane_b32 s75, v228, 44
    s_and_b32 s80, s72, s31
    v_pk_fma_f32 v[176:177], v[176:177], s[56:57], s[56:57]
    s_and_b32 s81, s73, s31
    v_pk_fma_f32 v[178:179], v[178:179], s[56:57], s[56:57]
    s_and_b32 s82, s74, s31
    v_pk_fma_f32 v[180:181], v[180:181], s[56:57], s[56:57]
    s_and_b32 s83, s75, s31
    v_pk_fma_f32 v[182:183], v[182:183], s[56:57], s[56:57]
    v_mfma_f32_32x32x16_bf16 v[112:127], v[192:195], v[200:203], 0
    v_rcp_f32 v176, v176
    v_rcp_f32 v177, v177
    v_rcp_f32 v178, v178
    v_rcp_f32 v179, v179
    v_rcp_f32 v180, v180
    buffer_load_dwordx4 v[48:51], v232, s[4:7], s80 offen
    v_rcp_f32 v181, v181
    buffer_load_dwordx4 v[52:55], v232, s[4:7], s81 offen
    v_rcp_f32 v182, v182
    buffer_load_dwordx4 v[56:59], v232, s[4:7], s82 offen
    v_rcp_f32 v183, v183
    buffer_load_dwordx4 v[60:63], v232, s[4:7], s83 offen
    s_cmp_le_i32 s30, 4
    s_mov_b64 exec, s[22:23]
    ds_read_b128 v[196:199], v229 offset:43520
    s_mov_b64 exec, -1
    ds_read_b32 v2, v231 offset:524
    v_pk_mul_f32 v[176:177], v[176:177], v[80:81]
    v_pk_mul_f32 v[178:179], v[178:179], v[82:83]
    v_pk_mul_f32 v[180:181], v[180:181], v[96:97]
    v_pk_mul_f32 v[182:183], v[182:183], v[98:99]
    s_set_gpr_idx_on s64, gpr_idx(SRC2,DST)
    v_pk_fma_f32 v[8:9], v[176:177], v[144:145], v[8:9] op_sel:[0,0,0] op_sel_hi:[0,1,1]
    v_pk_fma_f32 v[10:11], v[176:177], v[146:147], v[10:11] op_sel:[0,0,0] op_sel_hi:[0,1,1]
    v_pk_fma_f32 v[12:13], v[180:181], v[148:149], v[12:13] op_sel:[0,0,0] op_sel_hi:[0,1,1]
    v_pk_fma_f32 v[14:15], v[180:181], v[150:151], v[14:15] op_sel:[0,0,0] op_sel_hi:[0,1,1]
    s_set_gpr_idx_idx s65
    v_pk_fma_f32 v[8:9], v[176:177], v[152:153], v[8:9] op_sel:[1,0,0] op_sel_hi:[1,1,1]
    v_pk_fma_f32 v[10:11], v[176:177], v[154:155], v[10:11] op_sel:[1,0,0] op_sel_hi:[1,1,1]
    v_pk_fma_f32 v[12:13], v[180:181], v[156:157], v[12:13] op_sel:[1,0,0] op_sel_hi:[1,1,1]
    v_pk_fma_f32 v[14:15], v[180:181], v[158:159], v[14:15] op_sel:[1,0,0] op_sel_hi:[1,1,1]
    s_set_gpr_idx_idx s66
    v_pk_fma_f32 v[8:9], v[178:179], v[160:161], v[8:9] op_sel:[0,0,0] op_sel_hi:[0,1,1]
    v_pk_fma_f32 v[10:11], v[178:179], v[162:163], v[10:11] op_sel:[0,0,0] op_sel_hi:[0,1,1]
    v_pk_fma_f32 v[12:13], v[182:183], v[164:165], v[12:13] op_sel:[0,0,0] op_sel_hi:[0,1,1]
    v_pk_fma_f32 v[14:15], v[182:183], v[166:167], v[14:15] op_sel:[0,0,0] op_sel_hi:[0,1,1]
    s_set_gpr_idx_idx s67
    v_pk_fma_f32 v[8:9], v[178:179], v[168:169], v[8:9] op_sel:[1,0,0] op_sel_hi:[1,1,1]
    v_pk_fma_f32 v[10:11], v[178:179], v[170:171], v[10:11] op_sel:[1,0,0] op_sel_hi:[1,1,1]
    v_pk_fma_f32 v[12:13], v[182:183], v[172:173], v[12:13] op_sel:[1,0,0] op_sel_hi:[1,1,1]
    v_pk_fma_f32 v[14:15], v[182:183], v[174:175], v[14:15] op_sel:[1,0,0] op_sel_hi:[1,1,1]
    s_set_gpr_idx_off
    s_cbranch_scc1 L_exit
    s_waitcnt vmcnt(4)
    v_mfma_f32_4x4x4_16b_bf16 v[144:147], v[184:185], v[64:65], 0 cbsz:4 abid:4
    v_exp_f32 v176, v84
    v_mfma_f32_4x4x4_16b_bf16 v[148:151], v[184:185], v[66:67], 0 cbsz:4 abid:4
    v_exp_f32 v180, v100
    v_mfma_f32_4x4x4_16b_bf16 v[152:155], v[184:185], v[68:69], 0 cbsz:4 abid:5
    v_exp_f32 v177, v85
    v_mfma_f32_4x4x4_16b_bf16 v[156:159], v[184:185], v[70:71], 0 cbsz:4 abid:5
    v_exp_f32 v181, v101
    v_mfma_f32_4x4x4_16b_bf16 v[160:163], v[184:185], v[72:73], 0 cbsz:4 abid:6
    v_exp_f32 v178, v86
    v_mfma_f32_4x4x4_16b_bf16 v[164:167], v[184:185], v[74:75], 0 cbsz:4 abid:6
    v_exp_f32 v182, v102
    v_mfma_f32_4x4x4_16b_bf16 v[168:171], v[184:185], v[76:77], 0 cbsz:4 abid:7
    v_exp_f32 v179, v87
    v_mfma_f32_4x4x4_16b_bf16 v[172:175], v[184:185], v[78:79], 0 cbsz:4 abid:7
    v_exp_f32 v183, v103
    v_readlane_b32 s76, v228, 48
    v_readlane_b32 s77, v228, 52
    v_readlane_b32 s78, v228, 56
    v_readlane_b32 s79, v228, 60
    s_and_b32 s80, s76, s31
    v_pk_fma_f32 v[176:177], v[176:177], s[56:57], s[56:57]
    s_and_b32 s81, s77, s31
    v_pk_fma_f32 v[178:179], v[178:179], s[56:57], s[56:57]
    s_and_b32 s82, s78, s31
    v_pk_fma_f32 v[180:181], v[180:181], s[56:57], s[56:57]
    s_and_b32 s83, s79, s31
    v_pk_fma_f32 v[182:183], v[182:183], s[56:57], s[56:57]
    v_mfma_f32_32x32x16_bf16 v[128:143], v[192:195], v[204:207], 0
    v_rcp_f32 v176, v176
    v_rcp_f32 v177, v177
    v_rcp_f32 v178, v178
    v_rcp_f32 v179, v179
    v_rcp_f32 v180, v180
    buffer_load_dwordx4 v[64:67], v232, s[4:7], s80 offen
    v_rcp_f32 v181, v181
    buffer_load_dwordx4 v[68:71], v232, s[4:7], s81 offen
    v_rcp_f32 v182, v182
    buffer_load_dwordx4 v[72:75], v232, s[4:7], s82 offen
    v_rcp_f32 v183, v183
    buffer_load_dwordx4 v[76:79], v232, s[4:7], s83 offen
    s_cmp_le_i32 s30, 8
    s_waitcnt lgkmcnt(0)
    v_pk_mul_f32 v[176:177], v[176:177], v[84:85]
    v_pk_mul_f32 v[178:179], v[178:179], v[86:87]
    v_pk_mul_f32 v[180:181], v[180:181], v[100:101]
    v_pk_mul_f32 v[182:183], v[182:183], v[102:103]
    s_set_gpr_idx_on s68, gpr_idx(SRC2,DST)
    v_pk_fma_f32 v[8:9], v[176:177], v[144:145], v[8:9] op_sel:[0,0,0] op_sel_hi:[0,1,1]
    v_pk_fma_f32 v[10:11], v[176:177], v[146:147], v[10:11] op_sel:[0,0,0] op_sel_hi:[0,1,1]
    v_pk_fma_f32 v[12:13], v[180:181], v[148:149], v[12:13] op_sel:[0,0,0] op_sel_hi:[0,1,1]
    v_pk_fma_f32 v[14:15], v[180:181], v[150:151], v[14:15] op_sel:[0,0,0] op_sel_hi:[0,1,1]
    s_set_gpr_idx_idx s69
    v_pk_fma_f32 v[8:9], v[176:177], v[152:153], v[8:9] op_sel:[1,0,0] op_sel_hi:[1,1,1]
    v_pk_fma_f32 v[10:11], v[176:177], v[154:155], v[10:11] op_sel:[1,0,0] op_sel_hi:[1,1,1]
    v_pk_fma_f32 v[12:13], v[180:181], v[156:157], v[12:13] op_sel:[1,0,0] op_sel_hi:[1,1,1]
    v_pk_fma_f32 v[14:15], v[180:181], v[158:159], v[14:15] op_sel:[1,0,0] op_sel_hi:[1,1,1]
    s_set_gpr_idx_idx s70
    v_pk_fma_f32 v[8:9], v[178:179], v[160:161], v[8:9] op_sel:[0,0,0] op_sel_hi:[0,1,1]
    v_pk_fma_f32 v[10:11], v[178:179], v[162:163], v[10:11] op_sel:[0,0,0] op_sel_hi:[0,1,1]
    v_pk_fma_f32 v[12:13], v[182:183], v[164:165], v[12:13] op_sel:[0,0,0] op_sel_hi:[0,1,1]
    v_pk_fma_f32 v[14:15], v[182:183], v[166:167], v[14:15] op_sel:[0,0,0] op_sel_hi:[0,1,1]
    s_set_gpr_idx_idx s71
    v_pk_fma_f32 v[8:9], v[178:179], v[168:169], v[8:9] op_sel:[1,0,0] op_sel_hi:[1,1,1]
    v_pk_fma_f32 v[10:11], v[178:179], v[170:171], v[10:11] op_sel:[1,0,0] op_sel_hi:[1,1,1]
    v_pk_fma_f32 v[12:13], v[182:183], v[172:173], v[12:13] op_sel:[1,0,0] op_sel_hi:[1,1,1]
    v_pk_fma_f32 v[14:15], v[182:183], v[174:175], v[14:15] op_sel:[1,0,0] op_sel_hi:[1,1,1]
    s_set_gpr_idx_off
    s_cbranch_scc1 L_exit
    s_setprio 2
    s_waitcnt vmcnt(4)
    v_mfma_f32_4x4x4_16b_bf16 v[144:147], v[184:185], v[48:49], 0 cbsz:4 abid:8
    v_exp_f32 v176, v88
    v_mfma_f32_4x4x4_16b_bf16 v[148:151], v[184:185], v[50:51], 0 cbsz:4 abid:8
    v_exp_f32 v180, v104
    v_mfma_f32_4x4x4_16b_bf16 v[152:155], v[184:185], v[52:53], 0 cbsz:4 abid:9
    v_exp_f32 v177, v89
    v_mfma_f32_4x4x4_16b_bf16 v[156:159], v[184:185], v[54:55], 0 cbsz:4 abid:9
    v_exp_f32 v181, v105
    v_mfma_f32_4x4x4_16b_bf16 v[160:163], v[184:185], v[56:57], 0 cbsz:4 abid:10
    v_exp_f32 v178, v90
    v_mfma_f32_4x4x4_16b_bf16 v[164:167], v[184:185], v[58:59], 0 cbsz:4 abid:10
    v_exp_f32 v182, v106
    v_mfma_f32_4x4x4_16b_bf16 v[168:171], v[184:185], v[60:61], 0 cbsz:4 abid:11
    v_exp_f32 v179, v91
    v_mfma_f32_4x4x4_16b_bf16 v[172:175], v[184:185], v[62:63], 0 cbsz:4 abid:11
    v_exp_f32 v183, v107
    v_readlane_b32 s64, v228, 1
    v_readlane_b32 s65, v228, 5
    v_readlane_b32 s66, v228, 9
    v_readlane_b32 s67, v228, 13
    v_and_or_b32 v229, v2, s33, v233
    s_and_b32 s80, s64, s31
    v_pk_fma_f32 v[176:177], v[176:177], s[56:57], s[56:57]
    s_and_b32 s81, s65, s31
    v_pk_fma_f32 v[178:179], v[178:179], s[56:57], s[56:57]
    s_and_b32 s82, s66, s31
    v_pk_fma_f32 v[180:181], v[180:181], s[56:57], s[56:57]
    s_and_b32 s83, s67, s31
    v_pk_fma_f32 v[182:183], v[182:183], s[56:57], s[56:57]
    v_mfma_f32_32x32x16_bf16 v[112:127], v[196:199], v[208:211], v[112:127]
    v_rcp_f32 v176, v176
    v_rcp_f32 v177, v177
    v_rcp_f32 v178, v178
    v_rcp_f32 v179, v179
    v_rcp_f32 v180, v180
    buffer_load_dwordx4 v[48:51], v232, s[4:7], s80 offen
    v_rcp_f32 v181, v181
    buffer_load_dwordx4 v[52:55], v232, s[4:7], s81 offen
    v_rcp_f32 v182, v182
    buffer_load_dwordx4 v[56:59], v232, s[4:7], s82 offen
    v_rcp_f32 v183, v183
    buffer_load_dwordx4 v[60:63], v232, s[4:7], s83 offen
    s_cmp_le_i32 s30, 12
    s_mov_b64 exec, s[20:21]
    ds_read_b128 v[192:195], v229 offset:43520
    s_mov_b64 exec, -1
    v_pk_mul_f32 v[176:177], v[176:177], v[88:89]
    v_pk_mul_f32 v[178:179], v[178:179], v[90:91]
    v_pk_mul_f32 v[180:181], v[180:181], v[104:105]
    v_pk_mul_f32 v[182:183], v[182:183], v[106:107]
    s_set_gpr_idx_on s72, gpr_idx(SRC2,DST)
    v_pk_fma_f32 v[8:9], v[176:177], v[144:145], v[8:9] op_sel:[0,0,0] op_sel_hi:[0,1,1]
    v_pk_fma_f32 v[10:11], v[176:177], v[146:147], v[10:11] op_sel:[0,0,0] op_sel_hi:[0,1,1]
    v_pk_fma_f32 v[12:13], v[180:181], v[148:149], v[12:13] op_sel:[0,0,0] op_sel_hi:[0,1,1]
    v_pk_fma_f32 v[14:15], v[180:181], v[150:151], v[14:15] op_sel:[0,0,0] op_sel_hi:[0,1,1]
    s_set_gpr_idx_idx s73
    v_pk_fma_f32 v[8:9], v[176:177], v[152:153], v[8:9] op_sel:[1,0,0] op_sel_hi:[1,1,1]
    v_pk_fma_f32 v[10:11], v[176:177], v[154:155], v[10:11] op_sel:[1,0,0] op_sel_hi:[1,1,1]
    v_pk_fma_f32 v[12:13], v[180:181], v[156:157], v[12:13] op_sel:[1,0,0] op_sel_hi:[1,1,1]
    v_pk_fma_f32 v[14:15], v[180:181], v[158:159], v[14:15] op_sel:[1,0,0] op_sel_hi:[1,1,1]
    s_set_gpr_idx_idx s74
    v_pk_fma_f32 v[8:9], v[178:179], v[160:161], v[8:9] op_sel:[0,0,0] op_sel_hi:[0,1,1]
    v_pk_fma_f32 v[10:11], v[178:179], v[162:163], v[10:11] op_sel:[0,0,0] op_sel_hi:[0,1,1]
    v_pk_fma_f32 v[12:13], v[182:183], v[164:165], v[12:13] op_sel:[0,0,0] op_sel_hi:[0,1,1]
    v_pk_fma_f32 v[14:15], v[182:183], v[166:167], v[14:15] op_sel:[0,0,0] op_sel_hi:[0,1,1]
    s_set_gpr_idx_idx s75
    v_pk_fma_f32 v[8:9], v[178:179], v[168:169], v[8:9] op_sel:[1,0,0] op_sel_hi:[1,1,1]
    v_pk_fma_f32 v[10:11], v[178:179], v[170:171], v[10:11] op_sel:[1,0,0] op_sel_hi:[1,1,1]
    v_pk_fma_f32 v[12:13], v[182:183], v[172:173], v[12:13] op_sel:[1,0,0] op_sel_hi:[1,1,1]
    v_pk_fma_f32 v[14:15], v[182:183], v[174:175], v[14:15] op_sel:[1,0,0] op_sel_hi:[1,1,1]
    s_set_gpr_idx_off
    s_cbranch_scc1 L_exit
    s_waitcnt vmcnt(4)
    v_mfma_f32_4x4x4_16b_bf16 v[144:147], v[184:185], v[64:65], 0 cbsz:4 abid:12
    v_exp_f32 v176, v92
    v_mfma_f32_4x4x4_16b_bf16 v[148:151], v[184:185], v[66:67], 0 cbsz:4 abid:12
    v_exp_f32 v180, v108
    v_mfma_f32_4x4x4_16b_bf16 v[152:155], v[184:185], v[68:69], 0 cbsz:4 abid:13
    v_exp_f32 v177, v93
    v_mfma_f32_4x4x4_16b_bf16 v[156:159], v[184:185], v[70:71], 0 cbsz:4 abid:13
    v_exp_f32 v181, v109
    v_mfma_f32_4x4x4_16b_bf16 v[160:163], v[184:185], v[72:73], 0 cbsz:4 abid:14
    v_exp_f32 v178, v94
    v_mfma_f32_4x4x4_16b_bf16 v[164:167], v[184:185], v[74:75], 0 cbsz:4 abid:14
    v_exp_f32 v182, v110
    v_mfma_f32_4x4x4_16b_bf16 v[168:171], v[184:185], v[76:77], 0 cbsz:4 abid:15
    v_exp_f32 v179, v95
    v_mfma_f32_4x4x4_16b_bf16 v[172:175], v[184:185], v[78:79], 0 cbsz:4 abid:15
    v_exp_f32 v183, v111
    v_readlane_b32 s68, v228, 17
    v_readlane_b32 s69, v228, 21
    v_readlane_b32 s70, v228, 25
    v_readlane_b32 s71, v228, 29
    s_and_b32 s80, s68, s31
    v_pk_fma_f32 v[176:177], v[176:177], s[56:57], s[56:57]
    s_and_b32 s81, s69, s31
    v_pk_fma_f32 v[178:179], v[178:179], s[56:57], s[56:57]
    s_and_b32 s82, s70, s31
    v_pk_fma_f32 v[180:181], v[180:181], s[56:57], s[56:57]
    s_and_b32 s83, s71, s31
    v_pk_fma_f32 v[182:183], v[182:183], s[56:57], s[56:57]
    v_mfma_f32_32x32x16_bf16 v[128:143], v[196:199], v[212:215], v[128:143]
    v_rcp_f32 v176, v176
    v_rcp_f32 v177, v177
    v_rcp_f32 v178, v178
    v_rcp_f32 v179, v179
    v_rcp_f32 v180, v180
    buffer_load_dwordx4 v[64:67], v232, s[4:7], s80 offen
    v_rcp_f32 v181, v181
    buffer_load_dwordx4 v[68:71], v232, s[4:7], s81 offen
    v_rcp_f32 v182, v182
    buffer_load_dwordx4 v[72:75], v232, s[4:7], s82 offen
    v_rcp_f32 v183, v183
    buffer_load_dwordx4 v[76:79], v232, s[4:7], s83 offen
    s_cmp_le_i32 s30, 16
    s_waitcnt lgkmcnt(0)
    v_pk_mul_f32 v[176:177], v[176:177], v[92:93]
    v_pk_mul_f32 v[178:179], v[178:179], v[94:95]
    v_pk_mul_f32 v[180:181], v[180:181], v[108:109]
    v_pk_mul_f32 v[182:183], v[182:183], v[110:111]
    s_set_gpr_idx_on s76, gpr_idx(SRC2,DST)
    v_pk_fma_f32 v[8:9], v[176:177], v[144:145], v[8:9] op_sel:[0,0,0] op_sel_hi:[0,1,1]
    v_pk_fma_f32 v[10:11], v[176:177], v[146:147], v[10:11] op_sel:[0,0,0] op_sel_hi:[0,1,1]
    v_pk_fma_f32 v[12:13], v[180:181], v[148:149], v[12:13] op_sel:[0,0,0] op_sel_hi:[0,1,1]
    v_pk_fma_f32 v[14:15], v[180:181], v[150:151], v[14:15] op_sel:[0,0,0] op_sel_hi:[0,1,1]
    s_set_gpr_idx_idx s77
    v_pk_fma_f32 v[8:9], v[176:177], v[152:153], v[8:9] op_sel:[1,0,0] op_sel_hi:[1,1,1]
    v_pk_fma_f32 v[10:11], v[176:177], v[154:155], v[10:11] op_sel:[1,0,0] op_sel_hi:[1,1,1]
    v_pk_fma_f32 v[12:13], v[180:181], v[156:157], v[12:13] op_sel:[1,0,0] op_sel_hi:[1,1,1]
    v_pk_fma_f32 v[14:15], v[180:181], v[158:159], v[14:15] op_sel:[1,0,0] op_sel_hi:[1,1,1]
    s_set_gpr_idx_idx s78
    v_pk_fma_f32 v[8:9], v[178:179], v[160:161], v[8:9] op_sel:[0,0,0] op_sel_hi:[0,1,1]
    v_pk_fma_f32 v[10:11], v[178:179], v[162:163], v[10:11] op_sel:[0,0,0] op_sel_hi:[0,1,1]
    v_pk_fma_f32 v[12:13], v[182:183], v[164:165], v[12:13] op_sel:[0,0,0] op_sel_hi:[0,1,1]
    v_pk_fma_f32 v[14:15], v[182:183], v[166:167], v[14:15] op_sel:[0,0,0] op_sel_hi:[0,1,1]
    s_set_gpr_idx_idx s79
    v_pk_fma_f32 v[8:9], v[178:179], v[168:169], v[8:9] op_sel:[1,0,0] op_sel_hi:[1,1,1]
    v_pk_fma_f32 v[10:11], v[178:179], v[170:171], v[10:11] op_sel:[1,0,0] op_sel_hi:[1,1,1]
    v_pk_fma_f32 v[12:13], v[182:183], v[172:173], v[12:13] op_sel:[1,0,0] op_sel_hi:[1,1,1]
    v_pk_fma_f32 v[14:15], v[182:183], v[174:175], v[14:15] op_sel:[1,0,0] op_sel_hi:[1,1,1]
    s_set_gpr_idx_off
    s_cbranch_scc1 L_exit
    s_setprio 1
    s_waitcnt vmcnt(4)
    v_mfma_f32_4x4x4_16b_bf16 v[144:147], v[186:187], v[48:49], 0 cbsz:4 abid:0
    v_exp_f32 v176, v112
    v_mfma_f32_4x4x4_16b_bf16 v[148:151], v[186:187], v[50:51], 0 cbsz:4 abid:0
    v_exp_f32 v180, v128
    v_mfma_f32_4x4x4_16b_bf16 v[152:155], v[186:187], v[52:53], 0 cbsz:4 abid:1
    v_exp_f32 v177, v113
    v_mfma_f32_4x4x4_16b_bf16 v[156:159], v[186:187], v[54:55], 0 cbsz:4 abid:1
    v_exp_f32 v181, v129
    v_mfma_f32_4x4x4_16b_bf16 v[160:163], v[186:187], v[56:57], 0 cbsz:4 abid:2
    v_exp_f32 v178, v114
    v_mfma_f32_4x4x4_16b_bf16 v[164:167], v[186:187], v[58:59], 0 cbsz:4 abid:2
    v_exp_f32 v182, v130
    v_mfma_f32_4x4x4_16b_bf16 v[168:171], v[186:187], v[60:61], 0 cbsz:4 abid:3
    v_exp_f32 v179, v115
    v_mfma_f32_4x4x4_16b_bf16 v[172:175], v[186:187], v[62:63], 0 cbsz:4 abid:3
    v_exp_f32 v183, v131
    v_readlane_b32 s72, v228, 33
    v_readlane_b32 s73, v228, 37
    v_readlane_b32 s74, v228, 41
    v_readlane_b32 s75, v228, 45
    s_and_b32 s80, s72, s31
    v_pk_fma_f32 v[176:177], v[176:177], s[56:57], s[56:57]
    s_and_b32 s81, s73, s31
    v_pk_fma_f32 v[178:179], v[178:179], s[56:57], s[56:57]
    s_and_b32 s82, s74, s31
    v_pk_fma_f32 v[180:181], v[180:181], s[56:57], s[56:57]
    s_and_b32 s83, s75, s31
    v_pk_fma_f32 v[182:183], v[182:183], s[56:57], s[56:57]
    v_mfma_f32_32x32x16_bf16 v[80:95], v[192:195], v[200:203], 0
    v_rcp_f32 v176, v176
    v_rcp_f32 v177, v177
    v_rcp_f32 v178, v178
    v_rcp_f32 v179, v179
    v_rcp_f32 v180, v180
    buffer_load_dwordx4 v[48:51], v232, s[4:7], s80 offen
    v_rcp_f32 v181, v181
    buffer_load_dwordx4 v[52:55], v232, s[4:7], s81 offen
    v_rcp_f32 v182, v182
    buffer_load_dwordx4 v[56:59], v232, s[4:7], s82 offen
    v_rcp_f32 v183, v183
    buffer_load_dwordx4 v[60:63], v232, s[4:7], s83 offen
    s_cmp_le_i32 s30, 20
    s_mov_b64 exec, s[22:23]
    ds_read_b128 v[196:199], v229 offset:43520
    s_mov_b64 exec, -1
    ds_read_b32 v2, v231 offset:780
    v_pk_mul_f32 v[176:177], v[176:177], v[112:113]
    v_pk_mul_f32 v[178:179], v[178:179], v[114:115]
    v_pk_mul_f32 v[180:181], v[180:181], v[128:129]
    v_pk_mul_f32 v[182:183], v[182:183], v[130:131]
    s_set_gpr_idx_on s64, gpr_idx(SRC2,DST)
    v_pk_fma_f32 v[8:9], v[176:177], v[144:145], v[8:9] op_sel:[0,0,0] op_sel_hi:[0,1,1]
    v_pk_fma_f32 v[10:11], v[176:177], v[146:147], v[10:11] op_sel:[0,0,0] op_sel_hi:[0,1,1]
    v_pk_fma_f32 v[12:13], v[180:181], v[148:149], v[12:13] op_sel:[0,0,0] op_sel_hi:[0,1,1]
    v_pk_fma_f32 v[14:15], v[180:181], v[150:151], v[14:15] op_sel:[0,0,0] op_sel_hi:[0,1,1]
    s_set_gpr_idx_idx s65
    v_pk_fma_f32 v[8:9], v[176:177], v[152:153], v[8:9] op_sel:[1,0,0] op_sel_hi:[1,1,1]
    v_pk_fma_f32 v[10:11], v[176:177], v[154:155], v[10:11] op_sel:[1,0,0] op_sel_hi:[1,1,1]
    v_pk_fma_f32 v[12:13], v[180:181], v[156:157], v[12:13] op_sel:[1,0,0] op_sel_hi:[1,1,1]
    v_pk_fma_f32 v[14:15], v[180:181], v[158:159], v[14:15] op_sel:[1,0,0] op_sel_hi:[1,1,1]
    s_set_gpr_idx_idx s66
    v_pk_fma_f32 v[8:9], v[178:179], v[160:161], v[8:9] op_sel:[0,0,0] op_sel_hi:[0,1,1]
    v_pk_fma_f32 v[10:11], v[178:179], v[162:163], v[10:11] op_sel:[0,0,0] op_sel_hi:[0,1,1]
    v_pk_fma_f32 v[12:13], v[182:183], v[164:165], v[12:13] op_sel:[0,0,0] op_sel_hi:[0,1,1]
    v_pk_fma_f32 v[14:15], v[182:183], v[166:167], v[14:15] op_sel:[0,0,0] op_sel_hi:[0,1,1]
    s_set_gpr_idx_idx s67
    v_pk_fma_f32 v[8:9], v[178:179], v[168:169], v[8:9] op_sel:[1,0,0] op_sel_hi:[1,1,1]
    v_pk_fma_f32 v[10:11], v[178:179], v[170:171], v[10:11] op_sel:[1,0,0] op_sel_hi:[1,1,1]
    v_pk_fma_f32 v[12:13], v[182:183], v[172:173], v[12:13] op_sel:[1,0,0] op_sel_hi:[1,1,1]
    v_pk_fma_f32 v[14:15], v[182:183], v[174:175], v[14:15] op_sel:[1,0,0] op_sel_hi:[1,1,1]
    s_set_gpr_idx_off
    s_cbranch_scc1 L_exit
    s_waitcnt vmcnt(4)
    v_mfma_f32_4x4x4_16b_bf16 v[144:147], v[186:187], v[64:65], 0 cbsz:4 abid:4
    v_exp_f32 v176, v116
    v_mfma_f32_4x4x4_16b_bf16 v[148:151], v[186:187], v[66:67], 0 cbsz:4 abid:4
    v_exp_f32 v180, v132
    v_mfma_f32_4x4x4_16b_bf16 v[152:155], v[186:187], v[68:69], 0 cbsz:4 abid:5
    v_exp_f32 v177, v117
    v_mfma_f32_4x4x4_16b_bf16 v[156:159], v[186:187], v[70:71], 0 cbsz:4 abid:5
    v_exp_f32 v181, v133
    v_mfma_f32_4x4x4_16b_bf16 v[160:163], v[186:187], v[72:73], 0 cbsz:4 abid:6
    v_exp_f32 v178, v118
    v_mfma_f32_4x4x4_16b_bf16 v[164:167], v[186:187], v[74:75], 0 cbsz:4 abid:6
    v_exp_f32 v182, v134
    v_mfma_f32_4x4x4_16b_bf16 v[168:171], v[186:187], v[76:77], 0 cbsz:4 abid:7
    v_exp_f32 v179, v119
    v_mfma_f32_4x4x4_16b_bf16 v[172:175], v[186:187], v[78:79], 0 cbsz:4 abid:7
    v_exp_f32 v183, v135
    v_readlane_b32 s76, v228, 49
    v_readlane_b32 s77, v228, 53
    v_readlane_b32 s78, v228, 57
    v_readlane_b32 s79, v228, 61
    s_and_b32 s80, s76, s31
    v_pk_fma_f32 v[176:177], v[176:177], s[56:57], s[56:57]
    s_and_b32 s81, s77, s31
    v_pk_fma_f32 v[178:179], v[178:179], s[56:57], s[56:57]
    s_and_b32 s82, s78, s31
    v_pk_fma_f32 v[180:181], v[180:181], s[56:57], s[56:57]
    s_and_b32 s83, s79, s31
    v_pk_fma_f32 v[182:183], v[182:183], s[56:57], s[56:57]
    v_mfma_f32_32x32x16_bf16 v[96:111], v[192:195], v[204:207], 0
    v_rcp_f32 v176, v176
    v_rcp_f32 v177, v177
    v_rcp_f32 v178, v178
    v_rcp_f32 v179, v179
    v_rcp_f32 v180, v180
    buffer_load_dwordx4 v[64:67], v232, s[4:7], s80 offen
    v_rcp_f32 v181, v181
    buffer_load_dwordx4 v[68:71], v232, s[4:7], s81 offen
    v_rcp_f32 v182, v182
    buffer_load_dwordx4 v[72:75], v232, s[4:7], s82 offen
    v_rcp_f32 v183, v183
    buffer_load_dwordx4 v[76:79], v232, s[4:7], s83 offen
    s_cmp_le_i32 s30, 24
    s_waitcnt lgkmcnt(0)
    v_pk_mul_f32 v[176:177], v[176:177], v[116:117]
    v_pk_mul_f32 v[178:179], v[178:179], v[118:119]
    v_pk_mul_f32 v[180:181], v[180:181], v[132:133]
    v_pk_mul_f32 v[182:183], v[182:183], v[134:135]
    s_set_gpr_idx_on s68, gpr_idx(SRC2,DST)
    v_pk_fma_f32 v[8:9], v[176:177], v[144:145], v[8:9] op_sel:[0,0,0] op_sel_hi:[0,1,1]
    v_pk_fma_f32 v[10:11], v[176:177], v[146:147], v[10:11] op_sel:[0,0,0] op_sel_hi:[0,1,1]
    v_pk_fma_f32 v[12:13], v[180:181], v[148:149], v[12:13] op_sel:[0,0,0] op_sel_hi:[0,1,1]
    v_pk_fma_f32 v[14:15], v[180:181], v[150:151], v[14:15] op_sel:[0,0,0] op_sel_hi:[0,1,1]
    s_set_gpr_idx_idx s69
    v_pk_fma_f32 v[8:9], v[176:177], v[152:153], v[8:9] op_sel:[1,0,0] op_sel_hi:[1,1,1]
    v_pk_fma_f32 v[10:11], v[176:177], v[154:155], v[10:11] op_sel:[1,0,0] op_sel_hi:[1,1,1]
    v_pk_fma_f32 v[12:13], v[180:181], v[156:157], v[12:13] op_sel:[1,0,0] op_sel_hi:[1,1,1]
    v_pk_fma_f32 v[14:15], v[180:181], v[158:159], v[14:15] op_sel:[1,0,0] op_sel_hi:[1,1,1]
    s_set_gpr_idx_idx s70
    v_pk_fma_f32 v[8:9], v[178:179], v[160:161], v[8:9] op_sel:[0,0,0] op_sel_hi:[0,1,1]
    v_pk_fma_f32 v[10:11], v[178:179], v[162:163], v[10:11] op_sel:[0,0,0] op_sel_hi:[0,1,1]
    v_pk_fma_f32 v[12:13], v[182:183], v[164:165], v[12:13] op_sel:[0,0,0] op_sel_hi:[0,1,1]
    v_pk_fma_f32 v[14:15], v[182:183], v[166:167], v[14:15] op_sel:[0,0,0] op_sel_hi:[0,1,1]
    s_set_gpr_idx_idx s71
    v_pk_fma_f32 v[8:9], v[178:179], v[168:169], v[8:9] op_sel:[1,0,0] op_sel_hi:[1,1,1]
    v_pk_fma_f32 v[10:11], v[178:179], v[170:171], v[10:11] op_sel:[1,0,0] op_sel_hi:[1,1,1]
    v_pk_fma_f32 v[12:13], v[182:183], v[172:173], v[12:13] op_sel:[1,0,0] op_sel_hi:[1,1,1]
    v_pk_fma_f32 v[14:15], v[182:183], v[174:175], v[14:15] op_sel:[1,0,0] op_sel_hi:[1,1,1]
    s_set_gpr_idx_off
    s_cbranch_scc1 L_exit
    s_setprio 0
    s_waitcnt vmcnt(4)
    v_mfma_f32_4x4x4_16b_bf16 v[144:147], v[186:187], v[48:49], 0 cbsz:4 abid:8
    v_exp_f32 v176, v120
    v_mfma_f32_4x4x4_16b_bf16 v[148:151], v[186:187], v[50:51], 0 cbsz:4 abid:8
    v_exp_f32 v180, v136
    v_mfma_f32_4x4x4_16b_bf16 v[152:155], v[186:187], v[52:53], 0 cbsz:4 abid:9
    v_exp_f32 v177, v121
    v_mfma_f32_4x4x4_16b_bf16 v[156:159], v[186:187], v[54:55], 0 cbsz:4 abid:9
    v_exp_f32 v181, v137
    v_mfma_f32_4x4x4_16b_bf16 v[160:163], v[186:187], v[56:57], 0 cbsz:4 abid:10
    v_exp_f32 v178, v122
    v_mfma_f32_4x4x4_16b_bf16 v[164:167], v[186:187], v[58:59], 0 cbsz:4 abid:10
    v_exp_f32 v182, v138
    v_mfma_f32_4x4x4_16b_bf16 v[168:171], v[186:187], v[60:61], 0 cbsz:4 abid:11
    v_exp_f32 v179, v123
    v_mfma_f32_4x4x4_16b_bf16 v[172:175], v[186:187], v[62:63], 0 cbsz:4 abid:11
    v_exp_f32 v183, v139
    v_readlane_b32 s64, v228, 2
    v_readlane_b32 s65, v228, 6
    v_readlane_b32 s66, v228, 10
    v_readlane_b32 s67, v228, 14
    v_and_or_b32 v229, v2, s33, v233
    s_and_b32 s80, s64, s31
    v_pk_fma_f32 v[176:177], v[176:177], s[56:57], s[56:57]
    s_and_b32 s81, s65, s31
    v_pk_fma_f32 v[178:179], v[178:179], s[56:57], s[56:57]
    s_and_b32 s82, s66, s31
    v_pk_fma_f32 v[180:181], v[180:181], s[56:57], s[56:57]
    s_and_b32 s83, s67, s31
    v_pk_fma_f32 v[182:183], v[182:183], s[56:57], s[56:57]
    v_mfma_f32_32x32x16_bf16 v[80:95], v[196:199], v[208:211], v[80:95]
    v_rcp_f32 v176, v176
    v_rcp_f32 v177, v177
    v_rcp_f32 v178, v178
    v_rcp_f32 v179, v179
    v_rcp_f32 v180, v180
    buffer_load_dwordx4 v[48:51], v232, s[4:7], s80 offen
    v_rcp_f32 v181, v181
    buffer_load_dwordx4 v[52:55], v232, s[4:7], s81 offen
    v_rcp_f32 v182, v182
    buffer_load_dwordx4 v[56:59], v232, s[4:7], s82 offen
    v_rcp_f32 v183, v183
    buffer_load_dwordx4 v[60:63], v232, s[4:7], s83 offen
    s_cmp_le_i32 s30, 28
    s_mov_b64 exec, s[20:21]
    ds_read_b128 v[192:195], v229 offset:43520
    s_mov_b64 exec, -1
    v_pk_mul_f32 v[176:177], v[176:177], v[120:121]
    v_pk_mul_f32 v[178:179], v[178:179], v[122:123]
    v_pk_mul_f32 v[180:181], v[180:181], v[136:137]
    v_pk_mul_f32 v[182:183], v[182:183], v[138:139]
    s_set_gpr_idx_on s72, gpr_idx(SRC2,DST)
    v_pk_fma_f32 v[8:9], v[176:177], v[144:145], v[8:9] op_sel:[0,0,0] op_sel_hi:[0,1,1]
    v_pk_fma_f32 v[10:11], v[176:177], v[146:147], v[10:11] op_sel:[0,0,0] op_sel_hi:[0,1,1]
    v_pk_fma_f32 v[12:13], v[180:181], v[148:149], v[12:13] op_sel:[0,0,0] op_sel_hi:[0,1,1]
    v_pk_fma_f32 v[14:15], v[180:181], v[150:151], v[14:15] op_sel:[0,0,0] op_sel_hi:[0,1,1]
    s_set_gpr_idx_idx s73
    v_pk_fma_f32 v[8:9], v[176:177], v[152:153], v[8:9] op_sel:[1,0,0] op_sel_hi:[1,1,1]
    v_pk_fma_f32 v[10:11], v[176:177], v[154:155], v[10:11] op_sel:[1,0,0] op_sel_hi:[1,1,1]
    v_pk_fma_f32 v[12:13], v[180:181], v[156:157], v[12:13] op_sel:[1,0,0] op_sel_hi:[1,1,1]
    v_pk_fma_f32 v[14:15], v[180:181], v[158:159], v[14:15] op_sel:[1,0,0] op_sel_hi:[1,1,1]
    s_set_gpr_idx_idx s74
    v_pk_fma_f32 v[8:9], v[178:179], v[160:161], v[8:9] op_sel:[0,0,0] op_sel_hi:[0,1,1]
    v_pk_fma_f32 v[10:11], v[178:179], v[162:163], v[10:11] op_sel:[0,0,0] op_sel_hi:[0,1,1]
    v_pk_fma_f32 v[12:13], v[182:183], v[164:165], v[12:13] op_sel:[0,0,0] op_sel_hi:[0,1,1]
    v_pk_fma_f32 v[14:15], v[182:183], v[166:167], v[14:15] op_sel:[0,0,0] op_sel_hi:[0,1,1]
    s_set_gpr_idx_idx s75
    v_pk_fma_f32 v[8:9], v[178:179], v[168:169], v[8:9] op_sel:[1,0,0] op_sel_hi:[1,1,1]
    v_pk_fma_f32 v[10:11], v[178:179], v[170:171], v[10:11] op_sel:[1,0,0] op_sel_hi:[1,1,1]
    v_pk_fma_f32 v[12:13], v[182:183], v[172:173], v[12:13] op_sel:[1,0,0] op_sel_hi:[1,1,1]
    v_pk_fma_f32 v[14:15], v[182:183], v[174:175], v[14:15] op_sel:[1,0,0] op_sel_hi:[1,1,1]
    s_set_gpr_idx_off
    s_cbranch_scc1 L_exit
    s_waitcnt vmcnt(4)
    v_mfma_f32_4x4x4_16b_bf16 v[144:147], v[186:187], v[64:65], 0 cbsz:4 abid:12
    v_exp_f32 v176, v124
    v_mfma_f32_4x4x4_16b_bf16 v[148:151], v[186:187], v[66:67], 0 cbsz:4 abid:12
    v_exp_f32 v180, v140
    v_mfma_f32_4x4x4_16b_bf16 v[152:155], v[186:187], v[68:69], 0 cbsz:4 abid:13
    v_exp_f32 v177, v125
    v_mfma_f32_4x4x4_16b_bf16 v[156:159], v[186:187], v[70:71], 0 cbsz:4 abid:13
    v_exp_f32 v181, v141
    v_mfma_f32_4x4x4_16b_bf16 v[160:163], v[186:187], v[72:73], 0 cbsz:4 abid:14
    v_exp_f32 v178, v126
    v_mfma_f32_4x4x4_16b_bf16 v[164:167], v[186:187], v[74:75], 0 cbsz:4 abid:14
    v_exp_f32 v182, v142
    v_mfma_f32_4x4x4_16b_bf16 v[168:171], v[186:187], v[76:77], 0 cbsz:4 abid:15
    v_exp_f32 v179, v127
    v_mfma_f32_4x4x4_16b_bf16 v[172:175], v[186:187], v[78:79], 0 cbsz:4 abid:15
    v_exp_f32 v183, v143
    v_readlane_b32 s68, v228, 18
    v_readlane_b32 s69, v228, 22
    v_readlane_b32 s70, v228, 26
    v_readlane_b32 s71, v228, 30
    s_and_b32 s80, s68, s31
    v_pk_fma_f32 v[176:177], v[176:177], s[56:57], s[56:57]
    s_and_b32 s81, s69, s31
    v_pk_fma_f32 v[178:179], v[178:179], s[56:57], s[56:57]
    s_and_b32 s82, s70, s31
    v_pk_fma_f32 v[180:181], v[180:181], s[56:57], s[56:57]
    s_and_b32 s83, s71, s31
    v_pk_fma_f32 v[182:183], v[182:183], s[56:57], s[56:57]
    v_mfma_f32_32x32x16_bf16 v[96:111], v[196:199], v[212:215], v[96:111]
    v_rcp_f32 v176, v176
    v_rcp_f32 v177, v177
    v_rcp_f32 v178, v178
    v_rcp_f32 v179, v179
    v_rcp_f32 v180, v180
    buffer_load_dwordx4 v[64:67], v232, s[4:7], s80 offen
    v_rcp_f32 v181, v181
    buffer_load_dwordx4 v[68:71], v232, s[4:7], s81 offen
    v_rcp_f32 v182, v182
    buffer_load_dwordx4 v[72:75], v232, s[4:7], s82 offen
    v_rcp_f32 v183, v183
    buffer_load_dwordx4 v[76:79], v232, s[4:7], s83 offen
    s_cmp_le_i32 s30, 32
    s_waitcnt lgkmcnt(0)
    v_pk_mul_f32 v[176:177], v[176:177], v[124:125]
    v_pk_mul_f32 v[178:179], v[178:179], v[126:127]
    v_pk_mul_f32 v[180:181], v[180:181], v[140:141]
    v_pk_mul_f32 v[182:183], v[182:183], v[142:143]
    s_set_gpr_idx_on s76, gpr_idx(SRC2,DST)
    v_pk_fma_f32 v[8:9], v[176:177], v[144:145], v[8:9] op_sel:[0,0,0] op_sel_hi:[0,1,1]
    v_pk_fma_f32 v[10:11], v[176:177], v[146:147], v[10:11] op_sel:[0,0,0] op_sel_hi:[0,1,1]
    v_pk_fma_f32 v[12:13], v[180:181], v[148:149], v[12:13] op_sel:[0,0,0] op_sel_hi:[0,1,1]
    v_pk_fma_f32 v[14:15], v[180:181], v[150:151], v[14:15] op_sel:[0,0,0] op_sel_hi:[0,1,1]
    s_set_gpr_idx_idx s77
    v_pk_fma_f32 v[8:9], v[176:177], v[152:153], v[8:9] op_sel:[1,0,0] op_sel_hi:[1,1,1]
    v_pk_fma_f32 v[10:11], v[176:177], v[154:155], v[10:11] op_sel:[1,0,0] op_sel_hi:[1,1,1]
    v_pk_fma_f32 v[12:13], v[180:181], v[156:157], v[12:13] op_sel:[1,0,0] op_sel_hi:[1,1,1]
    v_pk_fma_f32 v[14:15], v[180:181], v[158:159], v[14:15] op_sel:[1,0,0] op_sel_hi:[1,1,1]
    s_set_gpr_idx_idx s78
    v_pk_fma_f32 v[8:9], v[178:179], v[160:161], v[8:9] op_sel:[0,0,0] op_sel_hi:[0,1,1]
    v_pk_fma_f32 v[10:11], v[178:179], v[162:163], v[10:11] op_sel:[0,0,0] op_sel_hi:[0,1,1]
    v_pk_fma_f32 v[12:13], v[182:183], v[164:165], v[12:13] op_sel:[0,0,0] op_sel_hi:[0,1,1]
    v_pk_fma_f32 v[14:15], v[182:183], v[166:167], v[14:15] op_sel:[0,0,0] op_sel_hi:[0,1,1]
    s_set_gpr_idx_idx s79
    v_pk_fma_f32 v[8:9], v[178:179], v[168:169], v[8:9] op_sel:[1,0,0] op_sel_hi:[1,1,1]
    v_pk_fma_f32 v[10:11], v[178:179], v[170:171], v[10:11] op_sel:[1,0,0] op_sel_hi:[1,1,1]
    v_pk_fma_f32 v[12:13], v[182:183], v[172:173], v[12:13] op_sel:[1,0,0] op_sel_hi:[1,1,1]
    v_pk_fma_f32 v[14:15], v[182:183], v[174:175], v[14:15] op_sel:[1,0,0] op_sel_hi:[1,1,1]
    s_set_gpr_idx_off
    s_cbranch_scc1 L_exit
    s_setprio 3
    s_waitcnt vmcnt(4)
    v_mfma_f32_4x4x4_16b_bf16 v[144:147], v[188:189], v[48:49], 0 cbsz:4 abid:0
    v_exp_f32 v176, v80
    v_mfma_f32_4x4x4_16b_bf16 v[148:151], v[188:189], v[50:51], 0 cbsz:4 abid:0
    v_exp_f32 v180, v96
    v_mfma_f32_4x4x4_16b_bf16 v[152:155], v[188:189], v[52:53], 0 cbsz:4 abid:1
    v_exp_f32 v177, v81
    v_mfma_f32_4x4x4_16b_bf16 v[156:159], v[188:189], v[54:55], 0 cbsz:4 abid:1
    v_exp_f32 v181, v97
    v_mfma_f32_4x4x4_16b_bf16 v[160:163], v[188:189], v[56:57], 0 cbsz:4 abid:2
    v_exp_f32 v178, v82
    v_mfma_f32_4x4x4_16b_bf16 v[164:167], v[188:189], v[58:59], 0 cbsz:4 abid:2
    v_exp_f32 v182, v98
    v_mfma_f32_4x4x4_16b_bf16 v[168:171], v[188:189], v[60:61], 0 cbsz:4 abid:3
    v_exp_f32 v179, v83
    v_mfma_f32_4x4x4_16b_bf16 v[172:175], v[188:189], v[62:63], 0 cbsz:4 abid:3
    v_exp_f32 v183, v99
    v_readlane_b32 s72, v228, 34
    v_readlane_b32 s73, v228, 38
    v_readlane_b32 s74, v228, 42
    v_readlane_b32 s75, v228, 46
    s_and_b32 s80, s72, s31
    v_pk_fma_f32 v[176:177], v[176:177], s[56:57], s[56:57]
    s_and_b32 s81, s73, s31
    v_pk_fma_f32 v[178:179], v[178:179], s[56:57], s[56:57]
    s_and_b32 s82, s74, s31
    v_pk_fma_f32 v[180:181], v[180:181], s[56:57], s[56:57]
    s_and_b32 s83, s75, s31
    v_pk_fma_f32 v[182:183], v[182:183], s[56:57], s[56:57]
    v_mfma_f32_32x32x16_bf16 v[112:127], v[192:195], v[200:203], 0
    v_rcp_f32 v176, v176
    v_rcp_f32 v177, v177
    v_rcp_f32 v178, v178
    v_rcp_f32 v179, v179
    v_rcp_f32 v180, v180
    buffer_load_dwordx4 v[48:51], v232, s[4:7], s80 offen
    v_rcp_f32 v181, v181
    buffer_load_dwordx4 v[52:55], v232, s[4:7], s81 offen
    v_rcp_f32 v182, v182
    buffer_load_dwordx4 v[56:59], v232, s[4:7], s82 offen
    v_rcp_f32 v183, v183
    buffer_load_dwordx4 v[60:63], v232, s[4:7], s83 offen
    s_cmp_le_i32 s30, 36
    s_mov_b64 exec, s[22:23]
    ds_read_b128 v[196:199], v229 offset:43520
    s_mov_b64 exec, -1
    ds_read_b32 v2, v231 offset:1036
    v_pk_mul_f32 v[176:177], v[176:177], v[80:81]
    v_pk_mul_f32 v[178:179], v[178:179], v[82:83]
    v_pk_mul_f32 v[180:181], v[180:181], v[96:97]
    v_pk_mul_f32 v[182:183], v[182:183], v[98:99]
    s_set_gpr_idx_on s64, gpr_idx(SRC2,DST)
    v_pk_fma_f32 v[8:9], v[176:177], v[144:145], v[8:9] op_sel:[0,0,0] op_sel_hi:[0,1,1]
    v_pk_fma_f32 v[10:11], v[176:177], v[146:147], v[10:11] op_sel:[0,0,0] op_sel_hi:[0,1,1]
    v_pk_fma_f32 v[12:13], v[180:181], v[148:149], v[12:13] op_sel:[0,0,0] op_sel_hi:[0,1,1]
    v_pk_fma_f32 v[14:15], v[180:181], v[150:151], v[14:15] op_sel:[0,0,0] op_sel_hi:[0,1,1]
    s_set_gpr_idx_idx s65
    v_pk_fma_f32 v[8:9], v[176:177], v[152:153], v[8:9] op_sel:[1,0,0] op_sel_hi:[1,1,1]
    v_pk_fma_f32 v[10:11], v[176:177], v[154:155], v[10:11] op_sel:[1,0,0] op_sel_hi:[1,1,1]
    v_pk_fma_f32 v[12:13], v[180:181], v[156:157], v[12:13] op_sel:[1,0,0] op_sel_hi:[1,1,1]
    v_pk_fma_f32 v[14:15], v[180:181], v[158:159], v[14:15] op_sel:[1,0,0] op_sel_hi:[1,1,1]
    s_set_gpr_idx_idx s66
    v_pk_fma_f32 v[8:9], v[178:179], v[160:161], v[8:9] op_sel:[0,0,0] op_sel_hi:[0,1,1]
    v_pk_fma_f32 v[10:11], v[178:179], v[162:163], v[10:11] op_sel:[0,0,0] op_sel_hi:[0,1,1]
    v_pk_fma_f32 v[12:13], v[182:183], v[164:165], v[12:13] op_sel:[0,0,0] op_sel_hi:[0,1,1]
    v_pk_fma_f32 v[14:15], v[182:183], v[166:167], v[14:15] op_sel:[0,0,0] op_sel_hi:[0,1,1]
    s_set_gpr_idx_idx s67
    v_pk_fma_f32 v[8:9], v[178:179], v[168:169], v[8:9] op_sel:[1,0,0] op_sel_hi:[1,1,1]
    v_pk_fma_f32 v[10:11], v[178:179], v[170:171], v[10:11] op_sel:[1,0,0] op_sel_hi:[1,1,1]
    v_pk_fma_f32 v[12:13], v[182:183], v[172:173], v[12:13] op_sel:[1,0,0] op_sel_hi:[1,1,1]
    v_pk_fma_f32 v[14:15], v[182:183], v[174:175], v[14:15] op_sel:[1,0,0] op_sel_hi:[1,1,1]
    s_set_gpr_idx_off
    s_cbranch_scc1 L_exit
    s_waitcnt vmcnt(4)
    v_mfma_f32_4x4x4_16b_bf16 v[144:147], v[188:189], v[64:65], 0 cbsz:4 abid:4
    v_exp_f32 v176, v84
    v_mfma_f32_4x4x4_16b_bf16 v[148:151], v[188:189], v[66:67], 0 cbsz:4 abid:4
    v_exp_f32 v180, v100
    v_mfma_f32_4x4x4_16b_bf16 v[152:155], v[188:189], v[68:69], 0 cbsz:4 abid:5
    v_exp_f32 v177, v85
    v_mfma_f32_4x4x4_16b_bf16 v[156:159], v[188:189], v[70:71], 0 cbsz:4 abid:5
    v_exp_f32 v181, v101
    v_mfma_f32_4x4x4_16b_bf16 v[160:163], v[188:189], v[72:73], 0 cbsz:4 abid:6
    v_exp_f32 v178, v86
    v_mfma_f32_4x4x4_16b_bf16 v[164:167], v[188:189], v[74:75], 0 cbsz:4 abid:6
    v_exp_f32 v182, v102
    v_mfma_f32_4x4x4_16b_bf16 v[168:171], v[188:189], v[76:77], 0 cbsz:4 abid:7
    v_exp_f32 v179, v87
    v_mfma_f32_4x4x4_16b_bf16 v[172:175], v[188:189], v[78:79], 0 cbsz:4 abid:7
    v_exp_f32 v183, v103
    v_readlane_b32 s76, v228, 50
    v_readlane_b32 s77, v228, 54
    v_readlane_b32 s78, v228, 58
    v_readlane_b32 s79, v228, 62
    s_and_b32 s80, s76, s31
    v_pk_fma_f32 v[176:177], v[176:177], s[56:57], s[56:57]
    s_and_b32 s81, s77, s31
    v_pk_fma_f32 v[178:179], v[178:179], s[56:57], s[56:57]
    s_and_b32 s82, s78, s31
    v_pk_fma_f32 v[180:181], v[180:181], s[56:57], s[56:57]
    s_and_b32 s83, s79, s31
    v_pk_fma_f32 v[182:183], v[182:183], s[56:57], s[56:57]
    v_mfma_f32_32x32x16_bf16 v[128:143], v[192:195], v[204:207], 0
    v_rcp_f32 v176, v176
    v_rcp_f32 v177, v177
    v_rcp_f32 v178, v178
    v_rcp_f32 v179, v179
    v_rcp_f32 v180, v180
    buffer_load_dwordx4 v[64:67], v232, s[4:7], s80 offen
    v_rcp_f32 v181, v181
    buffer_load_dwordx4 v[68:71], v232, s[4:7], s81 offen
    v_rcp_f32 v182, v182
    buffer_load_dwordx4 v[72:75], v232, s[4:7], s82 offen
    v_rcp_f32 v183, v183
    buffer_load_dwordx4 v[76:79], v232, s[4:7], s83 offen
    s_cmp_le_i32 s30, 40
    s_waitcnt lgkmcnt(0)
    v_pk_mul_f32 v[176:177], v[176:177], v[84:85]
    v_pk_mul_f32 v[178:179], v[178:179], v[86:87]
    v_pk_mul_f32 v[180:181], v[180:181], v[100:101]
    v_pk_mul_f32 v[182:183], v[182:183], v[102:103]
    s_set_gpr_idx_on s68, gpr_idx(SRC2,DST)
    v_pk_fma_f32 v[8:9], v[176:177], v[144:145], v[8:9] op_sel:[0,0,0] op_sel_hi:[0,1,1]
    v_pk_fma_f32 v[10:11], v[176:177], v[146:147], v[10:11] op_sel:[0,0,0] op_sel_hi:[0,1,1]
    v_pk_fma_f32 v[12:13], v[180:181], v[148:149], v[12:13] op_sel:[0,0,0] op_sel_hi:[0,1,1]
    v_pk_fma_f32 v[14:15], v[180:181], v[150:151], v[14:15] op_sel:[0,0,0] op_sel_hi:[0,1,1]
    s_set_gpr_idx_idx s69
    v_pk_fma_f32 v[8:9], v[176:177], v[152:153], v[8:9] op_sel:[1,0,0] op_sel_hi:[1,1,1]
    v_pk_fma_f32 v[10:11], v[176:177], v[154:155], v[10:11] op_sel:[1,0,0] op_sel_hi:[1,1,1]
    v_pk_fma_f32 v[12:13], v[180:181], v[156:157], v[12:13] op_sel:[1,0,0] op_sel_hi:[1,1,1]
    v_pk_fma_f32 v[14:15], v[180:181], v[158:159], v[14:15] op_sel:[1,0,0] op_sel_hi:[1,1,1]
    s_set_gpr_idx_idx s70
    v_pk_fma_f32 v[8:9], v[178:179], v[160:161], v[8:9] op_sel:[0,0,0] op_sel_hi:[0,1,1]
    v_pk_fma_f32 v[10:11], v[178:179], v[162:163], v[10:11] op_sel:[0,0,0] op_sel_hi:[0,1,1]
    v_pk_fma_f32 v[12:13], v[182:183], v[164:165], v[12:13] op_sel:[0,0,0] op_sel_hi:[0,1,1]
    v_pk_fma_f32 v[14:15], v[182:183], v[166:167], v[14:15] op_sel:[0,0,0] op_sel_hi:[0,1,1]
    s_set_gpr_idx_idx s71
    v_pk_fma_f32 v[8:9], v[178:179], v[168:169], v[8:9] op_sel:[1,0,0] op_sel_hi:[1,1,1]
    v_pk_fma_f32 v[10:11], v[178:179], v[170:171], v[10:11] op_sel:[1,0,0] op_sel_hi:[1,1,1]
    v_pk_fma_f32 v[12:13], v[182:183], v[172:173], v[12:13] op_sel:[1,0,0] op_sel_hi:[1,1,1]
    v_pk_fma_f32 v[14:15], v[182:183], v[174:175], v[14:15] op_sel:[1,0,0] op_sel_hi:[1,1,1]
    s_set_gpr_idx_off
    s_cbranch_scc1 L_exit
    s_setprio 2
    s_waitcnt vmcnt(4)
    v_mfma_f32_4x4x4_16b_bf16 v[144:147], v[188:189], v[48:49], 0 cbsz:4 abid:8
    v_exp_f32 v176, v88
    v_mfma_f32_4x4x4_16b_bf16 v[148:151], v[188:189], v[50:51], 0 cbsz:4 abid:8
    v_exp_f32 v180, v104
    v_mfma_f32_4x4x4_16b_bf16 v[152:155], v[188:189], v[52:53], 0 cbsz:4 abid:9
    v_exp_f32 v177, v89
    v_mfma_f32_4x4x4_16b_bf16 v[156:159], v[188:189], v[54:55], 0 cbsz:4 abid:9
    v_exp_f32 v181, v105
    v_mfma_f32_4x4x4_16b_bf16 v[160:163], v[188:189], v[56:57], 0 cbsz:4 abid:10
    v_exp_f32 v178, v90
    v_mfma_f32_4x4x4_16b_bf16 v[164:167], v[188:189], v[58:59], 0 cbsz:4 abid:10
    v_exp_f32 v182, v106
    v_mfma_f32_4x4x4_16b_bf16 v[168:171], v[188:189], v[60:61], 0 cbsz:4 abid:11
    v_exp_f32 v179, v91
    v_mfma_f32_4x4x4_16b_bf16 v[172:175], v[188:189], v[62:63], 0 cbsz:4 abid:11
    v_exp_f32 v183, v107
    v_readlane_b32 s64, v228, 3
    v_readlane_b32 s65, v228, 7
    v_readlane_b32 s66, v228, 11
    v_readlane_b32 s67, v228, 15
    v_and_or_b32 v229, v2, s33, v233
    s_and_b32 s80, s64, s31
    v_pk_fma_f32 v[176:177], v[176:177], s[56:57], s[56:57]
    s_and_b32 s81, s65, s31
    v_pk_fma_f32 v[178:179], v[178:179], s[56:57], s[56:57]
    s_and_b32 s82, s66, s31
    v_pk_fma_f32 v[180:181], v[180:181], s[56:57], s[56:57]
    s_and_b32 s83, s67, s31
    v_pk_fma_f32 v[182:183], v[182:183], s[56:57], s[56:57]
    v_mfma_f32_32x32x16_bf16 v[112:127], v[196:199], v[208:211], v[112:127]
    v_rcp_f32 v176, v176
    v_rcp_f32 v177, v177
    v_rcp_f32 v178, v178
    v_rcp_f32 v179, v179
    v_rcp_f32 v180, v180
    buffer_load_dwordx4 v[48:51], v232, s[4:7], s80 offen
    v_rcp_f32 v181, v181
    buffer_load_dwordx4 v[52:55], v232, s[4:7], s81 offen
    v_rcp_f32 v182, v182
    buffer_load_dwordx4 v[56:59], v232, s[4:7], s82 offen
    v_rcp_f32 v183, v183
    buffer_load_dwordx4 v[60:63], v232, s[4:7], s83 offen
    s_cmp_le_i32 s30, 44
    s_mov_b64 exec, s[20:21]
    ds_read_b128 v[192:195], v229 offset:43520
    s_mov_b64 exec, -1
    v_pk_mul_f32 v[176:177], v[176:177], v[88:89]
    v_pk_mul_f32 v[178:179], v[178:179], v[90:91]
    v_pk_mul_f32 v[180:181], v[180:181], v[104:105]
    v_pk_mul_f32 v[182:183], v[182:183], v[106:107]
    s_set_gpr_idx_on s72, gpr_idx(SRC2,DST)
    v_pk_fma_f32 v[8:9], v[176:177], v[144:145], v[8:9] op_sel:[0,0,0] op_sel_hi:[0,1,1]
    v_pk_fma_f32 v[10:11], v[176:177], v[146:147], v[10:11] op_sel:[0,0,0] op_sel_hi:[0,1,1]
    v_pk_fma_f32 v[12:13], v[180:181], v[148:149], v[12:13] op_sel:[0,0,0] op_sel_hi:[0,1,1]
    v_pk_fma_f32 v[14:15], v[180:181], v[150:151], v[14:15] op_sel:[0,0,0] op_sel_hi:[0,1,1]
    s_set_gpr_idx_idx s73
    v_pk_fma_f32 v[8:9], v[176:177], v[152:153], v[8:9] op_sel:[1,0,0] op_sel_hi:[1,1,1]
    v_pk_fma_f32 v[10:11], v[176:177], v[154:155], v[10:11] op_sel:[1,0,0] op_sel_hi:[1,1,1]
    v_pk_fma_f32 v[12:13], v[180:181], v[156:157], v[12:13] op_sel:[1,0,0] op_sel_hi:[1,1,1]
    v_pk_fma_f32 v[14:15], v[180:181], v[158:159], v[14:15] op_sel:[1,0,0] op_sel_hi:[1,1,1]
    s_set_gpr_idx_idx s74
    v_pk_fma_f32 v[8:9], v[178:179], v[160:161], v[8:9] op_sel:[0,0,0] op_sel_hi:[0,1,1]
    v_pk_fma_f32 v[10:11], v[178:179], v[162:163], v[10:11] op_sel:[0,0,0] op_sel_hi:[0,1,1]
    v_pk_fma_f32 v[12:13], v[182:183], v[164:165], v[12:13] op_sel:[0,0,0] op_sel_hi:[0,1,1]
    v_pk_fma_f32 v[14:15], v[182:183], v[166:167], v[14:15] op_sel:[0,0,0] op_sel_hi:[0,1,1]
    s_set_gpr_idx_idx s75
    v_pk_fma_f32 v[8:9], v[178:179], v[168:169], v[8:9] op_sel:[1,0,0] op_sel_hi:[1,1,1]
    v_pk_fma_f32 v[10:11], v[178:179], v[170:171], v[10:11] op_sel:[1,0,0] op_sel_hi:[1,1,1]
    v_pk_fma_f32 v[12:13], v[182:183], v[172:173], v[12:13] op_sel:[1,0,0] op_sel_hi:[1,1,1]
    v_pk_fma_f32 v[14:15], v[182:183], v[174:175], v[14:15] op_sel:[1,0,0] op_sel_hi:[1,1,1]
    s_set_gpr_idx_off
    s_cbranch_scc1 L_exit
    s_waitcnt vmcnt(4)
    v_mfma_f32_4x4x4_16b_bf16 v[144:147], v[188:189], v[64:65], 0 cbsz:4 abid:12
    v_exp_f32 v176, v92
    v_mfma_f32_4x4x4_16b_bf16 v[148:151], v[188:189], v[66:67], 0 cbsz:4 abid:12
    v_exp_f32 v180, v108
    v_mfma_f32_4x4x4_16b_bf16 v[152:155], v[188:189], v[68:69], 0 cbsz:4 abid:13
    v_exp_f32 v177, v93
    v_mfma_f32_4x4x4_16b_bf16 v[156:159], v[188:189], v[70:71], 0 cbsz:4 abid:13
    v_exp_f32 v181, v109
    v_mfma_f32_4x4x4_16b_bf16 v[160:163], v[188:189], v[72:73], 0 cbsz:4 abid:14
    v_exp_f32 v178, v94
    v_mfma_f32_4x4x4_16b_bf16 v[164:167], v[188:189], v[74:75], 0 cbsz:4 abid:14
    v_exp_f32 v182, v110
    v_mfma_f32_4x4x4_16b_bf16 v[168:171], v[188:189], v[76:77], 0 cbsz:4 abid:15
    v_exp_f32 v179, v95
    v_mfma_f32_4x4x4_16b_bf16 v[172:175], v[188:189], v[78:79], 0 cbsz:4 abid:15
    v_exp_f32 v183, v111
    v_readlane_b32 s68, v228, 19
    v_readlane_b32 s69, v228, 23
    v_readlane_b32 s70, v228, 27
    v_readlane_b32 s71, v228, 31
    s_and_b32 s80, s68, s31
    v_pk_fma_f32 v[176:177], v[176:177], s[56:57], s[56:57]
    s_and_b32 s81, s69, s31
    v_pk_fma_f32 v[178:179], v[178:179], s[56:57], s[56:57]
    s_and_b32 s82, s70, s31
    v_pk_fma_f32 v[180:181], v[180:181], s[56:57], s[56:57]
    s_and_b32 s83, s71, s31
    v_pk_fma_f32 v[182:183], v[182:183], s[56:57], s[56:57]
    v_mfma_f32_32x32x16_bf16 v[128:143], v[196:199], v[212:215], v[128:143]
    v_rcp_f32 v176, v176
    v_rcp_f32 v177, v177
    v_rcp_f32 v178, v178
    v_rcp_f32 v179, v179
    v_rcp_f32 v180, v180
    buffer_load_dwordx4 v[64:67], v232, s[4:7], s80 offen
    v_rcp_f32 v181, v181
    buffer_load_dwordx4 v[68:71], v232, s[4:7], s81 offen
    v_rcp_f32 v182, v182
    buffer_load_dwordx4 v[72:75], v232, s[4:7], s82 offen
    v_rcp_f32 v183, v183
    buffer_load_dwordx4 v[76:79], v232, s[4:7], s83 offen
    s_cmp_le_i32 s30, 48
    s_waitcnt lgkmcnt(0)
    v_pk_mul_f32 v[176:177], v[176:177], v[92:93]
    v_pk_mul_f32 v[178:179], v[178:179], v[94:95]
    v_pk_mul_f32 v[180:181], v[180:181], v[108:109]
    v_pk_mul_f32 v[182:183], v[182:183], v[110:111]
    s_set_gpr_idx_on s76, gpr_idx(SRC2,DST)
    v_pk_fma_f32 v[8:9], v[176:177], v[144:145], v[8:9] op_sel:[0,0,0] op_sel_hi:[0,1,1]
    v_pk_fma_f32 v[10:11], v[176:177], v[146:147], v[10:11] op_sel:[0,0,0] op_sel_hi:[0,1,1]
    v_pk_fma_f32 v[12:13], v[180:181], v[148:149], v[12:13] op_sel:[0,0,0] op_sel_hi:[0,1,1]
    v_pk_fma_f32 v[14:15], v[180:181], v[150:151], v[14:15] op_sel:[0,0,0] op_sel_hi:[0,1,1]
    s_set_gpr_idx_idx s77
    v_pk_fma_f32 v[8:9], v[176:177], v[152:153], v[8:9] op_sel:[1,0,0] op_sel_hi:[1,1,1]
    v_pk_fma_f32 v[10:11], v[176:177], v[154:155], v[10:11] op_sel:[1,0,0] op_sel_hi:[1,1,1]
    v_pk_fma_f32 v[12:13], v[180:181], v[156:157], v[12:13] op_sel:[1,0,0] op_sel_hi:[1,1,1]
    v_pk_fma_f32 v[14:15], v[180:181], v[158:159], v[14:15] op_sel:[1,0,0] op_sel_hi:[1,1,1]
    s_set_gpr_idx_idx s78
    v_pk_fma_f32 v[8:9], v[178:179], v[160:161], v[8:9] op_sel:[0,0,0] op_sel_hi:[0,1,1]
    v_pk_fma_f32 v[10:11], v[178:179], v[162:163], v[10:11] op_sel:[0,0,0] op_sel_hi:[0,1,1]
    v_pk_fma_f32 v[12:13], v[182:183], v[164:165], v[12:13] op_sel:[0,0,0] op_sel_hi:[0,1,1]
    v_pk_fma_f32 v[14:15], v[182:183], v[166:167], v[14:15] op_sel:[0,0,0] op_sel_hi:[0,1,1]
    s_set_gpr_idx_idx s79
    v_pk_fma_f32 v[8:9], v[178:179], v[168:169], v[8:9] op_sel:[1,0,0] op_sel_hi:[1,1,1]
    v_pk_fma_f32 v[10:11], v[178:179], v[170:171], v[10:11] op_sel:[1,0,0] op_sel_hi:[1,1,1]
    v_pk_fma_f32 v[12:13], v[182:183], v[172:173], v[12:13] op_sel:[1,0,0] op_sel_hi:[1,1,1]
    v_pk_fma_f32 v[14:15], v[182:183], v[174:175], v[14:15] op_sel:[1,0,0] op_sel_hi:[1,1,1]
    s_set_gpr_idx_off
    s_cbranch_scc1 L_exit
    s_setprio 1
    s_waitcnt vmcnt(4)
    v_mfma_f32_4x4x4_16b_bf16 v[144:147], v[190:191], v[48:49], 0 cbsz:4 abid:0
    v_exp_f32 v176, v112
    v_mfma_f32_4x4x4_16b_bf16 v[148:151], v[190:191], v[50:51], 0 cbsz:4 abid:0
    v_exp_f32 v180, v128
    v_mfma_f32_4x4x4_16b_bf16 v[152:155], v[190:191], v[52:53], 0 cbsz:4 abid:1
    v_exp_f32 v177, v113
    v_mfma_f32_4x4x4_16b_bf16 v[156:159], v[190:191], v[54:55], 0 cbsz:4 abid:1
    v_exp_f32 v181, v129
    v_mfma_f32_4x4x4_16b_bf16 v[160:163], v[190:191], v[56:57], 0 cbsz:4 abid:2
    v_exp_f32 v178, v114
    v_mfma_f32_4x4x4_16b_bf16 v[164:167], v[190:191], v[58:59], 0 cbsz:4 abid:2
    v_exp_f32 v182, v130
    v_mfma_f32_4x4x4_16b_bf16 v[168:171], v[190:191], v[60:61], 0 cbsz:4 abid:3
    v_exp_f32 v179, v115
    v_mfma_f32_4x4x4_16b_bf16 v[172:175], v[190:191], v[62:63], 0 cbsz:4 abid:3
    v_exp_f32 v183, v131
    v_readlane_b32 s72, v228, 35
    v_readlane_b32 s73, v228, 39
    v_readlane_b32 s74, v228, 43
    v_readlane_b32 s75, v228, 47
    s_and_b32 s80, s72, s31
    v_pk_fma_f32 v[176:177], v[176:177], s[56:57], s[56:57]
    s_and_b32 s81, s73, s31
    v_pk_fma_f32 v[178:179], v[178:179], s[56:57], s[56:57]
    s_and_b32 s82, s74, s31
    v_pk_fma_f32 v[180:181], v[180:181], s[56:57], s[56:57]
    s_and_b32 s83, s75, s31
    v_pk_fma_f32 v[182:183], v[182:183], s[56:57], s[56:57]
    v_mfma_f32_32x32x16_bf16 v[80:95], v[192:195], v[200:203], 0
    v_rcp_f32 v176, v176
    v_rcp_f32 v177, v177
    v_rcp_f32 v178, v178
    v_rcp_f32 v179, v179
    v_rcp_f32 v180, v180
    buffer_load_dwordx4 v[48:51], v232, s[4:7], s80 offen
    v_rcp_f32 v181, v181
    buffer_load_dwordx4 v[52:55], v232, s[4:7], s81 offen
    v_rcp_f32 v182, v182
    buffer_load_dwordx4 v[56:59], v232, s[4:7], s82 offen
    v_rcp_f32 v183, v183
    buffer_load_dwordx4 v[60:63], v232, s[4:7], s83 offen
    s_cmp_le_i32 s30, 52
    s_mov_b64 exec, s[22:23]
    ds_read_b128 v[196:199], v229 offset:43520
    s_mov_b64 exec, -1
    ds_read_b32 v2, v231 offset:1292
    v_pk_mul_f32 v[176:177], v[176:177], v[112:113]
    v_pk_mul_f32 v[178:179], v[178:179], v[114:115]
    v_pk_mul_f32 v[180:181], v[180:181], v[128:129]
    v_pk_mul_f32 v[182:183], v[182:183], v[130:131]
    s_set_gpr_idx_on s64, gpr_idx(SRC2,DST)
    v_pk_fma_f32 v[8:9], v[176:177], v[144:145], v[8:9] op_sel:[0,0,0] op_sel_hi:[0,1,1]
    v_pk_fma_f32 v[10:11], v[176:177], v[146:147], v[10:11] op_sel:[0,0,0] op_sel_hi:[0,1,1]
    v_pk_fma_f32 v[12:13], v[180:181], v[148:149], v[12:13] op_sel:[0,0,0] op_sel_hi:[0,1,1]
    v_pk_fma_f32 v[14:15], v[180:181], v[150:151], v[14:15] op_sel:[0,0,0] op_sel_hi:[0,1,1]
    s_set_gpr_idx_idx s65
    v_pk_fma_f32 v[8:9], v[176:177], v[152:153], v[8:9] op_sel:[1,0,0] op_sel_hi:[1,1,1]
    v_pk_fma_f32 v[10:11], v[176:177], v[154:155], v[10:11] op_sel:[1,0,0] op_sel_hi:[1,1,1]
    v_pk_fma_f32 v[12:13], v[180:181], v[156:157], v[12:13] op_sel:[1,0,0] op_sel_hi:[1,1,1]
    v_pk_fma_f32 v[14:15], v[180:181], v[158:159], v[14:15] op_sel:[1,0,0] op_sel_hi:[1,1,1]
    s_set_gpr_idx_idx s66
    v_pk_fma_f32 v[8:9], v[178:179], v[160:161], v[8:9] op_sel:[0,0,0] op_sel_hi:[0,1,1]
    v_pk_fma_f32 v[10:11], v[178:179], v[162:163], v[10:11] op_sel:[0,0,0] op_sel_hi:[0,1,1]
    v_pk_fma_f32 v[12:13], v[182:183], v[164:165], v[12:13] op_sel:[0,0,0] op_sel_hi:[0,1,1]
    v_pk_fma_f32 v[14:15], v[182:183], v[166:167], v[14:15] op_sel:[0,0,0] op_sel_hi:[0,1,1]
    s_set_gpr_idx_idx s67
    v_pk_fma_f32 v[8:9], v[178:179], v[168:169], v[8:9] op_sel:[1,0,0] op_sel_hi:[1,1,1]
    v_pk_fma_f32 v[10:11], v[178:179], v[170:171], v[10:11] op_sel:[1,0,0] op_sel_hi:[1,1,1]
    v_pk_fma_f32 v[12:13], v[182:183], v[172:173], v[12:13] op_sel:[1,0,0] op_sel_hi:[1,1,1]
    v_pk_fma_f32 v[14:15], v[182:183], v[174:175], v[14:15] op_sel:[1,0,0] op_sel_hi:[1,1,1]
    s_set_gpr_idx_off
    s_cbranch_scc1 L_exit
    s_waitcnt vmcnt(4)
    v_mfma_f32_4x4x4_16b_bf16 v[144:147], v[190:191], v[64:65], 0 cbsz:4 abid:4
    v_exp_f32 v176, v116
    v_mfma_f32_4x4x4_16b_bf16 v[148:151], v[190:191], v[66:67], 0 cbsz:4 abid:4
    v_exp_f32 v180, v132
    v_mfma_f32_4x4x4_16b_bf16 v[152:155], v[190:191], v[68:69], 0 cbsz:4 abid:5
    v_exp_f32 v177, v117
    v_mfma_f32_4x4x4_16b_bf16 v[156:159], v[190:191], v[70:71], 0 cbsz:4 abid:5
    v_exp_f32 v181, v133
    v_mfma_f32_4x4x4_16b_bf16 v[160:163], v[190:191], v[72:73], 0 cbsz:4 abid:6
    v_exp_f32 v178, v118
    v_mfma_f32_4x4x4_16b_bf16 v[164:167], v[190:191], v[74:75], 0 cbsz:4 abid:6
    v_exp_f32 v182, v134
    v_mfma_f32_4x4x4_16b_bf16 v[168:171], v[190:191], v[76:77], 0 cbsz:4 abid:7
    v_exp_f32 v179, v119
    v_mfma_f32_4x4x4_16b_bf16 v[172:175], v[190:191], v[78:79], 0 cbsz:4 abid:7
    v_exp_f32 v183, v135
    v_readlane_b32 s76, v228, 51
    v_readlane_b32 s77, v228, 55
    v_readlane_b32 s78, v228, 59
    v_readlane_b32 s79, v228, 63
    s_and_b32 s80, s76, s31
    v_pk_fma_f32 v[176:177], v[176:177], s[56:57], s[56:57]
    s_and_b32 s81, s77, s31
    v_pk_fma_f32 v[178:179], v[178:179], s[56:57], s[56:57]
    s_and_b32 s82, s78, s31
    v_pk_fma_f32 v[180:181], v[180:181], s[56:57], s[56:57]
    s_and_b32 s83, s79, s31
    v_pk_fma_f32 v[182:183], v[182:183], s[56:57], s[56:57]
    v_mfma_f32_32x32x16_bf16 v[96:111], v[192:195], v[204:207], 0
    v_rcp_f32 v176, v176
    v_rcp_f32 v177, v177
    v_rcp_f32 v178, v178
    v_rcp_f32 v179, v179
    v_rcp_f32 v180, v180
    buffer_load_dwordx4 v[64:67], v232, s[4:7], s80 offen
    v_rcp_f32 v181, v181
    buffer_load_dwordx4 v[68:71], v232, s[4:7], s81 offen
    v_rcp_f32 v182, v182
    buffer_load_dwordx4 v[72:75], v232, s[4:7], s82 offen
    v_rcp_f32 v183, v183
    buffer_load_dwordx4 v[76:79], v232, s[4:7], s83 offen
    s_cmp_le_i32 s30, 56
    s_waitcnt lgkmcnt(0)
    v_pk_mul_f32 v[176:177], v[176:177], v[116:117]
    v_pk_mul_f32 v[178:179], v[178:179], v[118:119]
    v_pk_mul_f32 v[180:181], v[180:181], v[132:133]
    v_pk_mul_f32 v[182:183], v[182:183], v[134:135]
    s_set_gpr_idx_on s68, gpr_idx(SRC2,DST)
    v_pk_fma_f32 v[8:9], v[176:177], v[144:145], v[8:9] op_sel:[0,0,0] op_sel_hi:[0,1,1]
    v_pk_fma_f32 v[10:11], v[176:177], v[146:147], v[10:11] op_sel:[0,0,0] op_sel_hi:[0,1,1]
    v_pk_fma_f32 v[12:13], v[180:181], v[148:149], v[12:13] op_sel:[0,0,0] op_sel_hi:[0,1,1]
    v_pk_fma_f32 v[14:15], v[180:181], v[150:151], v[14:15] op_sel:[0,0,0] op_sel_hi:[0,1,1]
    s_set_gpr_idx_idx s69
    v_pk_fma_f32 v[8:9], v[176:177], v[152:153], v[8:9] op_sel:[1,0,0] op_sel_hi:[1,1,1]
    v_pk_fma_f32 v[10:11], v[176:177], v[154:155], v[10:11] op_sel:[1,0,0] op_sel_hi:[1,1,1]
    v_pk_fma_f32 v[12:13], v[180:181], v[156:157], v[12:13] op_sel:[1,0,0] op_sel_hi:[1,1,1]
    v_pk_fma_f32 v[14:15], v[180:181], v[158:159], v[14:15] op_sel:[1,0,0] op_sel_hi:[1,1,1]
    s_set_gpr_idx_idx s70
    v_pk_fma_f32 v[8:9], v[178:179], v[160:161], v[8:9] op_sel:[0,0,0] op_sel_hi:[0,1,1]
    v_pk_fma_f32 v[10:11], v[178:179], v[162:163], v[10:11] op_sel:[0,0,0] op_sel_hi:[0,1,1]
    v_pk_fma_f32 v[12:13], v[182:183], v[164:165], v[12:13] op_sel:[0,0,0] op_sel_hi:[0,1,1]
    v_pk_fma_f32 v[14:15], v[182:183], v[166:167], v[14:15] op_sel:[0,0,0] op_sel_hi:[0,1,1]
    s_set_gpr_idx_idx s71
    v_pk_fma_f32 v[8:9], v[178:179], v[168:169], v[8:9] op_sel:[1,0,0] op_sel_hi:[1,1,1]
    v_pk_fma_f32 v[10:11], v[178:179], v[170:171], v[10:11] op_sel:[1,0,0] op_sel_hi:[1,1,1]
    v_pk_fma_f32 v[12:13], v[182:183], v[172:173], v[12:13] op_sel:[1,0,0] op_sel_hi:[1,1,1]
    v_pk_fma_f32 v[14:15], v[182:183], v[174:175], v[14:15] op_sel:[1,0,0] op_sel_hi:[1,1,1]
    s_set_gpr_idx_off
    s_cbranch_scc1 L_exit
    s_setprio 0
    v_cndmask_b32 v228, v4, v226, s[34:35]
    s_waitcnt vmcnt(4)
    v_mfma_f32_4x4x4_16b_bf16 v[144:147], v[190:191], v[48:49], 0 cbsz:4 abid:8
    v_exp_f32 v176, v120
    v_mfma_f32_4x4x4_16b_bf16 v[148:151], v[190:191], v[50:51], 0 cbsz:4 abid:8
    v_exp_f32 v180, v136
    v_mfma_f32_4x4x4_16b_bf16 v[152:155], v[190:191], v[52:53], 0 cbsz:4 abid:9
    v_exp_f32 v177, v121
    v_mfma_f32_4x4x4_16b_bf16 v[156:159], v[190:191], v[54:55], 0 cbsz:4 abid:9
    v_exp_f32 v181, v137
    v_mfma_f32_4x4x4_16b_bf16 v[160:163], v[190:191], v[56:57], 0 cbsz:4 abid:10
    v_exp_f32 v178, v122
    v_mfma_f32_4x4x4_16b_bf16 v[164:167], v[190:191], v[58:59], 0 cbsz:4 abid:10
    v_exp_f32 v182, v138
    v_mfma_f32_4x4x4_16b_bf16 v[168:171], v[190:191], v[60:61], 0 cbsz:4 abid:11
    v_exp_f32 v179, v123
    v_mfma_f32_4x4x4_16b_bf16 v[172:175], v[190:191], v[62:63], 0 cbsz:4 abid:11
    v_exp_f32 v183, v139
    v_readlane_b32 s64, v228, 0
    v_readlane_b32 s65, v228, 4
    v_readlane_b32 s66, v228, 8
    v_readlane_b32 s67, v228, 12
    v_and_or_b32 v229, v2, s33, v233
    s_and_b32 s80, s64, s31
    v_pk_fma_f32 v[176:177], v[176:177], s[56:57], s[56:57]
    s_and_b32 s81, s65, s31
    v_pk_fma_f32 v[178:179], v[178:179], s[56:57], s[56:57]
    s_and_b32 s82, s66, s31
    v_pk_fma_f32 v[180:181], v[180:181], s[56:57], s[56:57]
    s_and_b32 s83, s67, s31
    v_pk_fma_f32 v[182:183], v[182:183], s[56:57], s[56:57]
    v_mfma_f32_32x32x16_bf16 v[80:95], v[196:199], v[208:211], v[80:95]
    v_rcp_f32 v176, v176
    v_rcp_f32 v177, v177
    v_rcp_f32 v178, v178
    v_rcp_f32 v179, v179
    v_rcp_f32 v180, v180
    buffer_load_dwordx4 v[48:51], v232, s[4:7], s80 offen
    v_rcp_f32 v181, v181
    buffer_load_dwordx4 v[52:55], v232, s[4:7], s81 offen
    v_rcp_f32 v182, v182
    buffer_load_dwordx4 v[56:59], v232, s[4:7], s82 offen
    v_rcp_f32 v183, v183
    buffer_load_dwordx4 v[60:63], v232, s[4:7], s83 offen
    s_cmp_le_i32 s30, 60
    s_mov_b64 exec, s[20:21]
    ds_read_b128 v[192:195], v229 offset:43520
    s_mov_b64 exec, -1
    v_pk_mul_f32 v[176:177], v[176:177], v[120:121]
    v_pk_mul_f32 v[178:179], v[178:179], v[122:123]
    v_pk_mul_f32 v[180:181], v[180:181], v[136:137]
    v_pk_mul_f32 v[182:183], v[182:183], v[138:139]
    s_set_gpr_idx_on s72, gpr_idx(SRC2,DST)
    v_pk_fma_f32 v[8:9], v[176:177], v[144:145], v[8:9] op_sel:[0,0,0] op_sel_hi:[0,1,1]
    v_pk_fma_f32 v[10:11], v[176:177], v[146:147], v[10:11] op_sel:[0,0,0] op_sel_hi:[0,1,1]
    v_pk_fma_f32 v[12:13], v[180:181], v[148:149], v[12:13] op_sel:[0,0,0] op_sel_hi:[0,1,1]
    v_pk_fma_f32 v[14:15], v[180:181], v[150:151], v[14:15] op_sel:[0,0,0] op_sel_hi:[0,1,1]
    s_set_gpr_idx_idx s73
    v_pk_fma_f32 v[8:9], v[176:177], v[152:153], v[8:9] op_sel:[1,0,0] op_sel_hi:[1,1,1]
    v_pk_fma_f32 v[10:11], v[176:177], v[154:155], v[10:11] op_sel:[1,0,0] op_sel_hi:[1,1,1]
    v_pk_fma_f32 v[12:13], v[180:181], v[156:157], v[12:13] op_sel:[1,0,0] op_sel_hi:[1,1,1]
    v_pk_fma_f32 v[14:15], v[180:181], v[158:159], v[14:15] op_sel:[1,0,0] op_sel_hi:[1,1,1]
    s_set_gpr_idx_idx s74
    v_pk_fma_f32 v[8:9], v[178:179], v[160:161], v[8:9] op_sel:[0,0,0] op_sel_hi:[0,1,1]
    v_pk_fma_f32 v[10:11], v[178:179], v[162:163], v[10:11] op_sel:[0,0,0] op_sel_hi:[0,1,1]
    v_pk_fma_f32 v[12:13], v[182:183], v[164:165], v[12:13] op_sel:[0,0,0] op_sel_hi:[0,1,1]
    v_pk_fma_f32 v[14:15], v[182:183], v[166:167], v[14:15] op_sel:[0,0,0] op_sel_hi:[0,1,1]
    s_set_gpr_idx_idx s75
    v_pk_fma_f32 v[8:9], v[178:179], v[168:169], v[8:9] op_sel:[1,0,0] op_sel_hi:[1,1,1]
    v_pk_fma_f32 v[10:11], v[178:179], v[170:171], v[10:11] op_sel:[1,0,0] op_sel_hi:[1,1,1]
    v_pk_fma_f32 v[12:13], v[182:183], v[172:173], v[12:13] op_sel:[1,0,0] op_sel_hi:[1,1,1]
    v_pk_fma_f32 v[14:15], v[182:183], v[174:175], v[14:15] op_sel:[1,0,0] op_sel_hi:[1,1,1]
    s_set_gpr_idx_off
    s_cbranch_scc1 L_exit
    s_waitcnt vmcnt(4)
    v_mfma_f32_4x4x4_16b_bf16 v[144:147], v[190:191], v[64:65], 0 cbsz:4 abid:12
    v_exp_f32 v176, v124
    v_mfma_f32_4x4x4_16b_bf16 v[148:151], v[190:191], v[66:67], 0 cbsz:4 abid:12
    v_exp_f32 v180, v140
    v_mfma_f32_4x4x4_16b_bf16 v[152:155], v[190:191], v[68:69], 0 cbsz:4 abid:13
    v_exp_f32 v177, v125
    v_mfma_f32_4x4x4_16b_bf16 v[156:159], v[190:191], v[70:71], 0 cbsz:4 abid:13
    v_exp_f32 v181, v141
    v_mfma_f32_4x4x4_16b_bf16 v[160:163], v[190:191], v[72:73], 0 cbsz:4 abid:14
    v_exp_f32 v178, v126
    v_mfma_f32_4x4x4_16b_bf16 v[164:167], v[190:191], v[74:75], 0 cbsz:4 abid:14
    v_exp_f32 v182, v142
    v_mfma_f32_4x4x4_16b_bf16 v[168:171], v[190:191], v[76:77], 0 cbsz:4 abid:15
    v_exp_f32 v179, v127
    v_mfma_f32_4x4x4_16b_bf16 v[172:175], v[190:191], v[78:79], 0 cbsz:4 abid:15
    v_exp_f32 v183, v143
    v_readlane_b32 s68, v228, 16
    v_readlane_b32 s69, v228, 20
    v_readlane_b32 s70, v228, 24
    v_readlane_b32 s71, v228, 28
    s_and_b32 s80, s68, s31
    v_pk_fma_f32 v[176:177], v[176:177], s[56:57], s[56:57]
    s_and_b32 s81, s69, s31
    v_pk_fma_f32 v[178:179], v[178:179], s[56:57], s[56:57]
    s_and_b32 s82, s70, s31
    v_pk_fma_f32 v[180:181], v[180:181], s[56:57], s[56:57]
    s_and_b32 s83, s71, s31
    v_pk_fma_f32 v[182:183], v[182:183], s[56:57], s[56:57]
    v_mfma_f32_32x32x16_bf16 v[96:111], v[196:199], v[212:215], v[96:111]
    v_rcp_f32 v176, v176
    v_rcp_f32 v177, v177
    v_rcp_f32 v178, v178
    v_rcp_f32 v179, v179
    v_rcp_f32 v180, v180
    buffer_load_dwordx4 v[64:67], v232, s[4:7], s80 offen
    v_rcp_f32 v181, v181
    buffer_load_dwordx4 v[68:71], v232, s[4:7], s81 offen
    v_rcp_f32 v182, v182
    buffer_load_dwordx4 v[72:75], v232, s[4:7], s82 offen
    v_rcp_f32 v183, v183
    buffer_load_dwordx4 v[76:79], v232, s[4:7], s83 offen
    s_waitcnt lgkmcnt(0)
    v_pk_mul_f32 v[176:177], v[176:177], v[124:125]
    v_pk_mul_f32 v[178:179], v[178:179], v[126:127]
    v_pk_mul_f32 v[180:181], v[180:181], v[140:141]
    v_pk_mul_f32 v[182:183], v[182:183], v[142:143]
    s_set_gpr_idx_on s76, gpr_idx(SRC2,DST)
    v_pk_fma_f32 v[8:9], v[176:177], v[144:145], v[8:9] op_sel:[0,0,0] op_sel_hi:[0,1,1]
    v_pk_fma_f32 v[10:11], v[176:177], v[146:147], v[10:11] op_sel:[0,0,0] op_sel_hi:[0,1,1]
    v_pk_fma_f32 v[12:13], v[180:181], v[148:149], v[12:13] op_sel:[0,0,0] op_sel_hi:[0,1,1]
    v_pk_fma_f32 v[14:15], v[180:181], v[150:151], v[14:15] op_sel:[0,0,0] op_sel_hi:[0,1,1]
    s_set_gpr_idx_idx s77
    v_pk_fma_f32 v[8:9], v[176:177], v[152:153], v[8:9] op_sel:[1,0,0] op_sel_hi:[1,1,1]
    v_pk_fma_f32 v[10:11], v[176:177], v[154:155], v[10:11] op_sel:[1,0,0] op_sel_hi:[1,1,1]
    v_pk_fma_f32 v[12:13], v[180:181], v[156:157], v[12:13] op_sel:[1,0,0] op_sel_hi:[1,1,1]
    v_pk_fma_f32 v[14:15], v[180:181], v[158:159], v[14:15] op_sel:[1,0,0] op_sel_hi:[1,1,1]
    s_set_gpr_idx_idx s78
    v_pk_fma_f32 v[8:9], v[178:179], v[160:161], v[8:9] op_sel:[0,0,0] op_sel_hi:[0,1,1]
    v_pk_fma_f32 v[10:11], v[178:179], v[162:163], v[10:11] op_sel:[0,0,0] op_sel_hi:[0,1,1]
    v_pk_fma_f32 v[12:13], v[182:183], v[164:165], v[12:13] op_sel:[0,0,0] op_sel_hi:[0,1,1]
    v_pk_fma_f32 v[14:15], v[182:183], v[166:167], v[14:15] op_sel:[0,0,0] op_sel_hi:[0,1,1]
    s_set_gpr_idx_idx s79
    v_pk_fma_f32 v[8:9], v[178:179], v[168:169], v[8:9] op_sel:[1,0,0] op_sel_hi:[1,1,1]
    v_pk_fma_f32 v[10:11], v[178:179], v[170:171], v[10:11] op_sel:[1,0,0] op_sel_hi:[1,1,1]
    v_pk_fma_f32 v[12:13], v[182:183], v[172:173], v[12:13] op_sel:[1,0,0] op_sel_hi:[1,1,1]
    v_pk_fma_f32 v[14:15], v[182:183], v[174:175], v[14:15] op_sel:[1,0,0] op_sel_hi:[1,1,1]
    s_set_gpr_idx_off
    v_add_u32 v231, 1024, v231
    s_sub_u32 s30, s30, 64
    s_branch L_sb
L_exit:
    s_setprio 0
    s_add_u32 s24, s24, 224
    s_cmp_lt_u32 s24, s25
    s_cbranch_scc0 L_epi
    v_lshlrev_b32 v7, 3, v0
    v_mov_b32 v2, 0
    v_mov_b32 v3, 0
    ds_write_b64 v7, v[2:3]
    s_waitcnt vmcnt(0) lgkmcnt(0)
    s_nop 15
    s_mul_i32 s26, s16, 5
    v_add_u32 v113, s26, v1
    v_subrev_u32 v3, 40, v113
    v_min_u32 v113, v113, v3
    v_mul_u32_u24 v3, 205, v1
    v_lshrrev_b32 v3, 10, v3
    v_mul_u32_u24 v2, 5, v3
    v_sub_u32 v115, v1, v2
    s_lshr_b32 s26, s17, 5
    s_mul_i32 s26, s26, 12
    s_lshr_b32 s26, s26, 3
    v_add_u32 v3, s26, v3
    v_subrev_u32 v2, 12, v3
    v_min_u32 v3, v3, v2
    v_lshlrev_b32 v114, 2, v3
    s_barrier
    s_branch L_round
L_epi:
    s_waitcnt lgkmcnt(0)
    v_readfirstlane_b32 s38, v243
    v_lshlrev_b32 v2, 2, v1
    v_add_u32 v3, s48, v2
    v_cvt_pk_bf16_f32 v8, v8, v12
    v_cvt_pk_bf16_f32 v9, v9, v13
    v_cvt_pk_bf16_f32 v10, v10, v14
    v_cvt_pk_bf16_f32 v11, v11, v15
    ds_write2_b32 v3, v8, v9 offset0:0 offset1:68
    ds_write2_b32 v3, v10, v11 offset0:136 offset1:204
    v_add_u32 v3, s49, v2
    v_cvt_pk_bf16_f32 v16, v16, v20
    v_cvt_pk_bf16_f32 v17, v17, v21
    v_cvt_pk_bf16_f32 v18, v18, v22
    v_cvt_pk_bf16_f32 v19, v19, v23
    ds_write2_b32 v3, v16, v17 offset0:0 offset1:68
    ds_write2_b32 v3, v18, v19 offset0:136 offset1:204
    v_add_u32 v3, s50, v2
    v_cvt_pk_bf16_f32 v24, v24, v28
    v_cvt_pk_bf16_f32 v25, v25, v29
    v_cvt_pk_bf16_f32 v26, v26, v30
    v_cvt_pk_bf16_f32 v27, v27, v31
    ds_write2_b32 v3, v24, v25 offset0:0 offset1:68
    ds_write2_b32 v3, v26, v27 offset0:136 offset1:204
    v_add_u32 v3, s51, v2
    v_cvt_pk_bf16_f32 v32, v32, v36
    v_cvt_pk_bf16_f32 v33, v33, v37
    v_cvt_pk_bf16_f32 v34, v34, v38
    v_cvt_pk_bf16_f32 v35, v35, v39
    ds_write2_b32 v3, v32, v33 offset0:0 offset1:68
    ds_write2_b32 v3, v34, v35 offset0:136 offset1:204
    v_add_u32 v3, s52, v2
    v_cvt_pk_bf16_f32 v40, v40, v44
    v_cvt_pk_bf16_f32 v41, v41, v45
    v_cvt_pk_bf16_f32 v42, v42, v46
    v_cvt_pk_bf16_f32 v43, v43, v47
    ds_write2_b32 v3, v40, v41 offset0:0 offset1:68
    ds_write2_b32 v3, v42, v43 offset0:136 offset1:204
    s_cmp_eq_u32 s38, 8
    s_cbranch_scc0 L_nob
    ds_read_b128 v[192:195], v240 offset:0
    ds_read_b128 v[208:211], v240 offset:256
    ds_read_b128 v[196:199], v240 offset:8192
    ds_read_b128 v[212:215], v240 offset:8448
    ds_read_b128 v[200:203], v240 offset:16384
    ds_read_b128 v[216:219], v240 offset:16640
    ds_read_b128 v[204:207], v240 offset:24576
    ds_read_b128 v[220:223], v240 offset:24832
    s_waitcnt lgkmcnt(8)
    s_barrier
    s_branch L_haveb
L_nob:
    s_waitcnt lgkmcnt(0)
    s_barrier
    ds_read_b128 v[192:195], v240 offset:0
    ds_read_b128 v[208:211], v240 offset:256
    ds_read_b128 v[196:199], v240 offset:8192
    ds_read_b128 v[212:215], v240 offset:8448
    ds_read_b128 v[200:203], v240 offset:16384
    ds_read_b128 v[216:219], v240 offset:16640
    ds_read_b128 v[204:207], v240 offset:24576
    ds_read_b128 v[220:223], v240 offset:24832
L_haveb:
    ds_read_b128 v[80:83], v241 offset:0
    ds_read_b128 v[84:87], v241 offset:64
    ds_read_b128 v[88:91], v241 offset:128
    ds_read_b128 v[92:95], v241 offset:192
    ds_read_b128 v[96:99], v241 offset:4352
    ds_read_b128 v[100:103], v241 offset:4416
    ds_read_b128 v[104:107], v241 offset:4480
    ds_read_b128 v[108:111], v241 offset:4544
    ds_read_b128 v[112:115], v241 offset:8704
    ds_read_b128 v[116:119], v241 offset:8768
    ds_read_b128 v[120:123], v241 offset:8832
    ds_read_b128 v[124:127], v241 offset:8896
    s_waitcnt lgkmcnt(11)
    v_mfma_f32_16x16x32_bf16 v[8:11], v[80:83], v[192:195], 0
    v_mfma_f32_16x16x32_bf16 v[12:15], v[80:83], v[208:211], 0
    ds_read_b128 v[128:131], v241 offset:13056
    ds_read_b128 v[132:135], v241 offset:13120
    ds_read_b128 v[136:139], v241 offset:13184
    ds_read_b128 v[140:143], v241 offset:13248
    s_waitcnt lgkmcnt(14)
    v_mfma_f32_16x16x32_bf16 v[8:11], v[84:87], v[196:199], v[8:11]
    v_mfma_f32_16x16x32_bf16 v[12:15], v[84:87], v[212:215], v[12:15]
    s_waitcnt lgkmcnt(13)
    v_mfma_f32_16x16x32_bf16 v[8:11], v[88:91], v[200:203], v[8:11]
    v_mfma_f32_16x16x32_bf16 v[12:15], v[88:91], v[216:219], v[12:15]
    s_waitcnt lgkmcnt(12)
    v_mfma_f32_16x16x32_bf16 v[8:11], v[92:95], v[204:207], v[8:11]
    v_mfma_f32_16x16x32_bf16 v[12:15], v[92:95], v[220:223], v[12:15]
    s_waitcnt lgkmcnt(11)
    v_mfma_f32_16x16x32_bf16 v[16:19], v[96:99], v[192:195], 0
    v_mfma_f32_16x16x32_bf16 v[20:23], v[96:99], v[208:211], 0
    ds_read_b128 v[144:147], v241 offset:17408
    ds_read_b128 v[148:151], v241 offset:17472
    ds_read_b128 v[152:155], v241 offset:17536
    ds_read_b128 v[156:159], v241 offset:17600
    s_waitcnt lgkmcnt(14)
    v_mfma_f32_16x16x32_bf16 v[16:19], v[100:103], v[196:199], v[16:19]
    v_mfma_f32_16x16x32_bf16 v[20:23], v[100:103], v[212:215], v[20:23]
    s_waitcnt lgkmcnt(13)
    v_mfma_f32_16x16x32_bf16 v[16:19], v[104:107], v[200:203], v[16:19]
    v_mfma_f32_16x16x32_bf16 v[20:23], v[104:107], v[216:219], v[20:23]
    v_cvt_pk_bf16_f32 v160, v8, v9
    v_cvt_pk_bf16_f32 v161, v10, v11
    v_cvt_pk_bf16_f32 v162, v12, v13
    v_cvt_pk_bf16_f32 v163, v14, v15
    buffer_store_dwordx4 v[160:163], v242, s[12:15], 0 offen sc1
    v_add_u32 v242, 1048576, v242
    s_waitcnt lgkmcnt(12)
    v_mfma_f32_16x16x32_bf16 v[16:19], v[108:111], v[204:207], v[16:19]
    v_mfma_f32_16x16x32_bf16 v[20:23], v[108:111], v[220:223], v[20:23]
    s_waitcnt lgkmcnt(11)
    v_mfma_f32_16x16x32_bf16 v[24:27], v[112:115], v[192:195], 0
    v_mfma_f32_16x16x32_bf16 v[28:31], v[112:115], v[208:211], 0
    s_waitcnt lgkmcnt(10)
    v_mfma_f32_16x16x32_bf16 v[24:27], v[116:119], v[196:199], v[24:27]
    v_mfma_f32_16x16x32_bf16 v[28:31], v[116:119], v[212:215], v[28:31]
    s_waitcnt lgkmcnt(9)
    v_mfma_f32_16x16x32_bf16 v[24:27], v[120:123], v[200:203], v[24:27]
    v_mfma_f32_16x16x32_bf16 v[28:31], v[120:123], v[216:219], v[28:31]
    v_cvt_pk_bf16_f32 v164, v16, v17
    v_cvt_pk_bf16_f32 v165, v18, v19
    v_cvt_pk_bf16_f32 v166, v20, v21
    v_cvt_pk_bf16_f32 v167, v22, v23
    buffer_store_dwordx4 v[164:167], v242, s[12:15], 0 offen sc1
    v_add_u32 v242, 1048576, v242
    s_waitcnt lgkmcnt(8)
    v_mfma_f32_16x16x32_bf16 v[24:27], v[124:127], v[204:207], v[24:27]
    v_mfma_f32_16x16x32_bf16 v[28:31], v[124:127], v[220:223], v[28:31]
    s_waitcnt lgkmcnt(7)
    v_mfma_f32_16x16x32_bf16 v[32:35], v[128:131], v[192:195], 0
    v_mfma_f32_16x16x32_bf16 v[36:39], v[128:131], v[208:211], 0
    s_waitcnt lgkmcnt(6)
    v_mfma_f32_16x16x32_bf16 v[32:35], v[132:135], v[196:199], v[32:35]
    v_mfma_f32_16x16x32_bf16 v[36:39], v[132:135], v[212:215], v[36:39]
    s_waitcnt lgkmcnt(5)
    v_mfma_f32_16x16x32_bf16 v[32:35], v[136:139], v[200:203], v[32:35]
    v_mfma_f32_16x16x32_bf16 v[36:39], v[136:139], v[216:219], v[36:39]
    v_cvt_pk_bf16_f32 v168, v24, v25
    v_cvt_pk_bf16_f32 v169, v26, v27
    v_cvt_pk_bf16_f32 v170, v28, v29
    v_cvt_pk_bf16_f32 v171, v30, v31
    buffer_store_dwordx4 v[168:171], v242, s[12:15], 0 offen sc1
    v_add_u32 v242, 1048576, v242
    s_waitcnt lgkmcnt(4)
    v_mfma_f32_16x16x32_bf16 v[32:35], v[140:143], v[204:207], v[32:35]
    v_mfma_f32_16x16x32_bf16 v[36:39], v[140:143], v[220:223], v[36:39]
    s_waitcnt lgkmcnt(3)
    v_mfma_f32_16x16x32_bf16 v[40:43], v[144:147], v[192:195], 0
    v_mfma_f32_16x16x32_bf16 v[44:47], v[144:147], v[208:211], 0
    s_waitcnt lgkmcnt(2)
    v_mfma_f32_16x16x32_bf16 v[40:43], v[148:151], v[196:199], v[40:43]
    v_mfma_f32_16x16x32_bf16 v[44:47], v[148:151], v[212:215], v[44:47]
    s_waitcnt lgkmcnt(1)
    v_mfma_f32_16x16x32_bf16 v[40:43], v[152:155], v[200:203], v[40:43]
    v_mfma_f32_16x16x32_bf16 v[44:47], v[152:155], v[216:219], v[44:47]
    v_cvt_pk_bf16_f32 v172, v32, v33
    v_cvt_pk_bf16_f32 v173, v34, v35
    v_cvt_pk_bf16_f32 v174, v36, v37
    v_cvt_pk_bf16_f32 v175, v38, v39
    buffer_store_dwordx4 v[172:175], v242, s[12:15], 0 offen sc1
    v_add_u32 v242, 1048576, v242
    s_waitcnt lgkmcnt(0)
    v_mfma_f32_16x16x32_bf16 v[40:43], v[156:159], v[204:207], v[40:43]
    v_mfma_f32_16x16x32_bf16 v[44:47], v[156:159], v[220:223], v[44:47]
    s_nop 7
    v_cvt_pk_bf16_f32 v160, v40, v41
    v_cvt_pk_bf16_f32 v161, v42, v43
    v_cvt_pk_bf16_f32 v162, v44, v45
    v_cvt_pk_bf16_f32 v163, v46, v47
    buffer_store_dwordx4 v[160:163], v242, s[12:15], 0 offen sc1
    s_cmp_eq_u32 s53, 0
    s_cbranch_scc0 L_fin
    v_mov_b32 v144, 0
    v_mov_b32 v145, 1
    s_mov_b64 exec, 1
    buffer_store_dword v145, v144, s[44:47], 0 offen sc1
    s_mov_b64 exec, -1
L_fin:
L_end:
    s_endpgm
.section .rodata,"a"
.p2align 6
.amdhsa_kernel standalone__tensor_product_equiv_tfn__graph_kernel
.amdhsa_next_free_vgpr 245
.amdhsa_next_free_sgpr 100
.amdhsa_accum_offset 248
.amdhsa_group_segment_fixed_size 0
.amdhsa_kernarg_size 88
.amdhsa_user_sgpr_count 2
.amdhsa_user_sgpr_kernarg_segment_ptr 1
.amdhsa_system_sgpr_workgroup_id_x 1
.amdhsa_float_denorm_mode_32 3
.end_amdhsa_kernel
```

```asm
; @launch grid=(256,1,1) block=(512,1,1) lds=161808
.amdgcn_target "amdgcn-amd-amdhsa--gfx950"
.text
.globl standalone__tensor_product_equiv_tfn__graph_kernel
.p2align 8
.type standalone__tensor_product_equiv_tfn__graph_kernel,@function
standalone__tensor_product_equiv_tfn__graph_kernel:
    s_cmp_ge_u32 s2, 256
    s_cbranch_scc1 L_end
    s_load_dwordx16 s[36:51], s[0:1], 0
    s_load_dwordx4 s[52:55], s[0:1], 64
    s_load_dwordx2 s[56:57], s[0:1], 80
    v_lshrrev_b32 v2, 6, v0
    v_and_b32 v1, 63, v0
    v_readfirstlane_b32 s16, v2
    s_and_b32 s17, s2, 7
    s_lshl_b32 s17, s17, 5
    s_lshr_b32 s26, s2, 3
    s_or_b32 s17, s17, s26
    v_lshlrev_b32 v7, 3, v0
    v_mov_b32 v2, 0
    v_mov_b32 v3, 0
    v_mov_b32 v4, 161792
    ds_write_b64 v7, v[2:3]
    ds_write_b32 v4, v2
    v_lshlrev_b32 v232, 4, v1
    s_mul_i32 s26, s16, 160
    v_add_u32 v6, s26, v1
    v_lshlrev_b32 v53, 2, v6
    v_lshlrev_b32 v54, 3, v6
    s_mul_i32 s26, s16, 1920
    v_add_u32 v55, s26, v232
    s_mul_i32 s26, s16, 5120
    v_add_u32 v56, s26, v232
    s_cmp_lt_u32 s16, 7
    s_cselect_b32 s60, -1, 3
    s_mov_b32 s61, 0
    s_cselect_b64 s[62:63], -1, 15
    s_cselect_b32 s34, -1, 0xff
    s_cselect_b32 s35, 0xffffff, s34
    s_mul_i32 s58, s17, 5000
    s_mul_i32 s59, s17, 10000
    s_lshl_b32 s29, s17, 6
    s_add_u32 s29, s29, 14417920
    s_waitcnt lgkmcnt(0)
    s_mov_b32 s64, s40
    s_mov_b32 s65, s41
    s_mov_b32 s66, 1280000
    s_mov_b32 s67, 0x00020000
    buffer_load_dword v144, v53, s[64:67], s58 offen offset:0
    buffer_load_dword v145, v53, s[64:67], s58 offen offset:256
    s_mov_b64 exec, s[60:61]
    buffer_load_dword v146, v53, s[64:67], s58 offen offset:512
    s_mov_b64 exec, -1
    s_getpc_b64 s[82:83]
L_pc:
    s_lshr_b32 s80, s2, 3
    s_lshl_b32 s80, s80, 3
    s_add_u32 s80, s80, s16
    s_lshl_b32 s81, s80, 6
    s_min_u32 s81, s81, L_end-L_pc
    s_load_dword s3, s[82:83], s81
    s_lshl_b32 s81, s80, 7
    s_load_dword s3, s[50:51], s81
    s_add_u32 s81, s81, 64
    s_load_dword s3, s[50:51], s81
    s_lshl_b32 s81, s80, 4
    s_load_dword s3, s[46:47], s81
    s_and_b32 s81, s80, 64
    s_load_dword s3, s[48:49], s81
    s_mov_b32 s68, s38
    s_mov_b32 s69, s39
    s_mov_b32 s70, 1280000
    s_mov_b32 s71, 0x00020000
    buffer_load_dword v147, v53, s[68:71], s58 offen offset:0
    buffer_load_dword v148, v53, s[68:71], s58 offen offset:256
    s_mov_b64 exec, s[60:61]
    buffer_load_dword v149, v53, s[68:71], s58 offen offset:512
    s_mov_b64 exec, -1
    s_mov_b32 s72, s42
    s_mov_b32 s73, s43
    s_mov_b32 s74, 2560000
    s_mov_b32 s75, 0x00020000
    buffer_load_dwordx2 v[152:153], v54, s[72:75], s59 offen offset:0
    buffer_load_dwordx2 v[156:157], v54, s[72:75], s59 offen offset:512
    s_mov_b64 exec, s[60:61]
    buffer_load_dwordx2 v[160:161], v54, s[72:75], s59 offen offset:1024
    s_mov_b64 exec, -1
    s_mov_b32 s8, s56
    s_mov_b32 s9, s57
    s_mov_b32 s10, 16777216
    s_mov_b32 s11, 0x00020000
    s_mov_b32 s76, s44
    s_mov_b32 s77, s45
    s_mov_b32 s78, 10240000
    s_mov_b32 s79, 0x00020000
    s_barrier
    s_add_u32 m0, s26, 61440
    s_mul_i32 s58, s17, 40000
    buffer_load_dwordx4 v56, s[76:79], s58 offen offset:0  lds
    buffer_load_dwordx4 v56, s[76:79], s58 offen offset:1024  lds
    buffer_load_dwordx4 v56, s[76:79], s58 offen offset:2048  lds
    buffer_load_dwordx4 v56, s[76:79], s58 offen offset:3072  lds
    s_add_u32 m0, s26, 65536
    s_add_u32 s58, s58, 4096
    s_mov_b64 exec, s[62:63]
    buffer_load_dwordx4 v56, s[76:79], s58 offen  lds
    s_mov_b64 exec, -1
    v_mov_b32 v6, 1
    v_lshrrev_b32 v7, 2, v1
    v_mul_u32_u24 v7, 16320, v7
    v_add_u32 v72, v7, v232
    s_cmp_eq_u32 s16, 7
    s_cselect_b32 s59, s29, 0x40000000
    v_add_u32 v7, s59, v72
    buffer_load_dwordx4 v[64:67], v7, s[8:11], 0 offen
    s_waitcnt vmcnt(12)
    v_bfe_u32 v2, v144, 3, 5
    v_and_b32 v3, 7, v144
    v_lshl_or_b32 v2, v3, 5, v2
    v_lshlrev_b32 v167, 2, v2
    ds_add_rtn_u32 v164, v167, v6 offset:3072
    v_bfe_u32 v2, v145, 3, 5
    v_and_b32 v3, 7, v145
    v_lshl_or_b32 v2, v3, 5, v2
    v_lshlrev_b32 v168, 2, v2
    ds_add_rtn_u32 v165, v168, v6 offset:3072
    s_mov_b64 exec, s[60:61]
    v_bfe_u32 v2, v146, 3, 5
    v_and_b32 v3, 7, v146
    v_lshl_or_b32 v2, v3, 5, v2
    v_lshlrev_b32 v169, 2, v2
    ds_add_rtn_u32 v166, v169, v6 offset:3072
    s_mov_b64 exec, -1
    s_movk_i32 s27, 5033
    s_waitcnt vmcnt(9)
    s_movk_i32 s59, -1250
    v_lshrrev_b32 v3, 7, v167
    v_mad_i32_i24 v2, v3, s59, v147
    v_add_u32 v3, 10000, v2
    v_min_u32 v2, v2, v3
    v_mul_u32_u24 v2, s27, v2
    v_lshrrev_b32 v2, 22, v2
    v_lshrrev_b32 v3, 8, v144
    v_mad_u32_u24 v2, v3, 12, v2
    v_lshl_or_b32 v154, v147, 10, v2
    v_lshrrev_b32 v3, 7, v168
    v_mad_i32_i24 v2, v3, s59, v148
    v_add_u32 v3, 10000, v2
    v_min_u32 v2, v2, v3
    v_mul_u32_u24 v2, s27, v2
    v_lshrrev_b32 v2, 22, v2
    v_lshrrev_b32 v3, 8, v145
    v_mad_u32_u24 v2, v3, 12, v2
    v_lshl_or_b32 v158, v148, 10, v2
    v_lshrrev_b32 v3, 7, v169
    v_mad_i32_i24 v2, v3, s59, v149
    v_add_u32 v3, 10000, v2
    v_min_u32 v2, v2, v3
    v_mul_u32_u24 v2, s27, v2
    v_lshrrev_b32 v2, 22, v2
    v_lshrrev_b32 v3, 8, v146
    v_mad_u32_u24 v2, v3, 12, v2
    v_lshl_or_b32 v162, v149, 10, v2
    s_waitcnt lgkmcnt(0)
    s_barrier
    ds_read_b128 v[172:175], v232 offset:3072
    s_waitcnt lgkmcnt(0)
    v_add_u32 v50, v172, v173
    v_add_u32 v51, v50, v174
    v_add_u32 v2, v51, v175
    v_mov_b32 v3, v2
    v_lshlrev_b32 v4, 2, v54
    v_lshrrev_b32 v5, 1, v0
    v_add_u32_dpp v3, v3, v3 row_shr:1 row_mask:0xf bank_mask:0xf
    s_lshr_b32 s59, s17, 4
    s_mul_i32 s59, s59, 16320
    v_add_u32_dpp v3, v3, v3 row_shr:2 row_mask:0xf bank_mask:0xf
    s_lshl2_add_u32 s59, s17, s59
    s_add_u32 s59, s59, 14417920
    v_add_u32_dpp v3, v3, v3 row_shr:4 row_mask:0xf bank_mask:0xf
    v_lshl_add_u32 v58, v5, 6, s59
    s_nop 0
    v_add_u32_dpp v3, v3, v3 row_shr:8 row_mask:0xf bank_mask:0xf
    s_nop 1
    v_add_u32_dpp v3, v3, v3 row_bcast:15 row_mask:0xa bank_mask:0xf
    s_nop 1
    v_add_u32_dpp v3, v3, v3 row_bcast:31 row_mask:0xc bank_mask:0xf
    v_sub_u32 v48, v3, v2
    v_add_u32 v49, v48, v172
    v_add_u32 v50, v48, v50
    v_add_u32 v51, v48, v51
    ds_write_b128 v232, v[48:51] offset:10752
    ds_read_b32 v167, v167 offset:10752
    ds_read_b32 v168, v168 offset:10752
    s_mov_b64 exec, s[60:61]
    ds_read_b32 v169, v169 offset:10752
    s_mov_b64 exec, -1
    v_lshl_or_b32 v60, v172, 16, v48
    v_lshl_or_b32 v61, v173, 16, v49
    v_lshl_or_b32 v62, v174, 16, v50
    v_lshl_or_b32 v63, v175, 16, v51
    s_mov_b32 s27, 46080
    s_waitcnt vmcnt(6) lgkmcnt(0)
    v_add_lshl_u32 v2, v167, v164, 1
    v_add_u32 v3, 0, v4
    ds_write_b16 v2, v3 offset:8192
    v_mad_u32_u24 v2, v2, 6, s27
    ds_write2_b32 v2, v152, v153 offset0:0 offset1:1
    ds_write_b32 v2, v154 offset:8
    v_add_lshl_u32 v2, v168, v165, 1
    v_add_u32 v3, 2048, v4
    ds_write_b16 v2, v3 offset:8192
    v_mad_u32_u24 v2, v2, 6, s27
    ds_write2_b32 v2, v156, v157 offset0:0 offset1:1
    ds_write_b32 v2, v158 offset:8
    s_mov_b64 exec, s[60:61]
    v_add_lshl_u32 v2, v169, v166, 1
    v_add_u32 v3, 4096, v4
    ds_write_b16 v2, v3 offset:8192
    v_mad_u32_u24 v2, v2, 6, s27
    ds_write2_b32 v2, v160, v161 offset0:0 offset1:1
    ds_write_b32 v2, v162 offset:8
    s_mov_b64 exec, -1
    v_lshrrev_b32 v2, 4, v56
    v_and_b32 v2, 0xffe, v2
    v_and_b32 v5, 1, v1
    v_lshlrev_b32 v5, 4, v5
    s_waitcnt lgkmcnt(0)
    s_barrier
    buffer_load_dword v59, v58, s[8:11], 0 offen
    s_mov_b32 s68, s46
    s_mov_b32 s69, s47
    s_mov_b32 s70, 4096
    s_mov_b32 s71, 0x00020000
    s_mov_b32 s64, s48
    s_mov_b32 s65, s49
    s_mov_b32 s66, 128
    s_mov_b32 s67, 0x00020000
    v_lshlrev_b32 v7, 1, v1
    s_lshl_b32 s58, s16, 9
    s_add_u32 m0, s58, 16384
    s_mov_b32 exec_hi, 0
    buffer_load_dwordx4 v232, s[68:71], s58 offen lds
    s_mov_b32 exec_hi, -1
    buffer_load_ushort v57, v7, s[64:67], 0 offen
    ds_read_b128 v[152:155], v55 offset:46080
    ds_read_b128 v[156:159], v55 offset:47104
    ds_read_u16 v164, v2 offset:8192
    ds_read_u16 v165, v2 offset:8256
    ds_read_u16 v166, v2 offset:8320
    ds_read_u16 v167, v2 offset:8384
    ds_read_u16 v168, v2 offset:8448
    s_mov_b32 s4, s36
    s_mov_b32 s5, s37
    s_mov_b32 s6, 10240000
    s_mov_b32 s7, 0x00020000
    s_mov_b32 s12, s52
    s_mov_b32 s13, s53
    s_mov_b32 s14, 10240000
    s_mov_b32 s15, 0x00020000
    s_mov_b32 s20, 0x0f0f0f0f
    s_mov_b32 s21, 0x0f0f0f0f
    s_mov_b32 s22, 0xf0f0f0f0
    s_mov_b32 s23, 0xf0f0f0f0
    s_mov_b32 s31, 0xfffffc00
    s_mov_b32 s32, 0x9c4028
    s_mov_b32 s33, 0xffe0
    s_mov_b32 s24, 0
    s_mov_b32 s25, 0
    v_mov_b32 v8, 0
    v_mov_b32 v9, 0
    v_mov_b32 v10, 0
    v_mov_b32 v11, 0
    v_mov_b32 v12, 0
    v_mov_b32 v13, 0
    v_mov_b32 v14, 0
    v_mov_b32 v15, 0
    v_mov_b32 v16, 0
    v_mov_b32 v17, 0
    v_mov_b32 v18, 0
    v_mov_b32 v19, 0
    v_mov_b32 v20, 0
    v_mov_b32 v21, 0
    v_mov_b32 v22, 0
    v_mov_b32 v23, 0
    v_mov_b32 v24, 0
    v_mov_b32 v25, 0
    v_mov_b32 v26, 0
    v_mov_b32 v27, 0
    v_mov_b32 v28, 0
    v_mov_b32 v29, 0
    v_mov_b32 v30, 0
    v_mov_b32 v31, 0
    v_mov_b32 v32, 0
    v_mov_b32 v33, 0
    v_mov_b32 v34, 0
    v_mov_b32 v35, 0
    v_mov_b32 v36, 0
    v_mov_b32 v37, 0
    v_mov_b32 v38, 0
    v_mov_b32 v39, 0
    v_mov_b32 v40, 0
    v_mov_b32 v41, 0
    v_mov_b32 v42, 0
    v_mov_b32 v43, 0
    v_mov_b32 v44, 0
    v_mov_b32 v45, 0
    v_mov_b32 v46, 0
    v_mov_b32 v47, 0
    v_mov_b32 v192, 0
    v_mov_b32 v193, 0
    v_mov_b32 v194, 0
    v_mov_b32 v195, 0
    v_mov_b32 v196, 0
    v_mov_b32 v197, 0
    v_mov_b32 v198, 0
    v_mov_b32 v199, 0
    v_mov_b32 v112, 0
    v_mov_b32 v238, 0
    s_cmp_lt_u32 s2, 16
    s_cbranch_scc1 L_map40
    v_writelane_b32 v112, 0, 0
    v_writelane_b32 v112, 5, 1
    v_writelane_b32 v112, 6, 2
    v_writelane_b32 v112, 3, 3
    v_writelane_b32 v112, 8, 4
    v_writelane_b32 v112, 7, 5
    v_writelane_b32 v112, 2, 6
    v_writelane_b32 v112, 4, 7
    v_writelane_b32 v112, 1, 8
    v_writelane_b32 v112, 16, 9
    v_writelane_b32 v112, 10, 10
    v_writelane_b32 v112, 15, 11
    v_writelane_b32 v112, 9, 12
    v_writelane_b32 v112, 24, 13
    v_writelane_b32 v112, 14, 14
    v_writelane_b32 v112, 11, 15
    v_writelane_b32 v112, 13, 16
    v_writelane_b32 v112, 12, 17
    v_writelane_b32 v112, 17, 18
    v_writelane_b32 v112, 23, 19
    v_writelane_b32 v112, 20, 20
    v_writelane_b32 v112, 22, 21
    v_writelane_b32 v112, 19, 22
    v_writelane_b32 v112, 18, 23
    v_writelane_b32 v112, 21, 24
    v_writelane_b32 v112, 28, 25
    v_writelane_b32 v112, 29, 26
    v_writelane_b32 v112, 31, 27
    v_writelane_b32 v112, 26, 28
    v_writelane_b32 v112, 25, 29
    v_writelane_b32 v112, 27, 30
    v_writelane_b32 v112, 30, 31
    v_writelane_b32 v112, 36, 32
    v_writelane_b32 v112, 33, 33
    v_writelane_b32 v112, 35, 34
    v_writelane_b32 v112, 34, 35
    v_writelane_b32 v112, 38, 36
    v_writelane_b32 v112, 39, 37
    v_writelane_b32 v112, 37, 38
    v_writelane_b32 v112, 32, 39
    s_branch L_mapd
L_map40:
    v_writelane_b32 v112, 7, 0
    v_writelane_b32 v112, 0, 1
    v_writelane_b32 v112, 5, 2
    v_writelane_b32 v112, 2, 3
    v_writelane_b32 v112, 4, 4
    v_writelane_b32 v112, 3, 5
    v_writelane_b32 v112, 1, 6
    v_writelane_b32 v112, 6, 7
    v_writelane_b32 v112, 12, 8
    v_writelane_b32 v112, 9, 9
    v_writelane_b32 v112, 14, 10
    v_writelane_b32 v112, 11, 11
    v_writelane_b32 v112, 15, 12
    v_writelane_b32 v112, 10, 13
    v_writelane_b32 v112, 8, 14
    v_writelane_b32 v112, 13, 15
    v_writelane_b32 v112, 21, 16
    v_writelane_b32 v112, 22, 17
    v_writelane_b32 v112, 19, 18
    v_writelane_b32 v112, 16, 19
    v_writelane_b32 v112, 23, 20
    v_writelane_b32 v112, 17, 21
    v_writelane_b32 v112, 18, 22
    v_writelane_b32 v112, 20, 23
    v_writelane_b32 v112, 26, 24
    v_writelane_b32 v112, 29, 25
    v_writelane_b32 v112, 27, 26
    v_writelane_b32 v112, 25, 27
    v_writelane_b32 v112, 28, 28
    v_writelane_b32 v112, 30, 29
    v_writelane_b32 v112, 24, 30
    v_writelane_b32 v112, 31, 31
    v_writelane_b32 v112, 38, 32
    v_writelane_b32 v112, 33, 33
    v_writelane_b32 v112, 36, 34
    v_writelane_b32 v112, 35, 35
    v_writelane_b32 v112, 34, 36
    v_writelane_b32 v112, 32, 37
    v_writelane_b32 v112, 37, 38
    v_writelane_b32 v112, 39, 39
L_mapd:
    v_and_b32 v2, 3, v1
    v_lshrrev_b32 v3, 2, v1
    v_lshl_add_u32 v234, v2, 4, v3
    v_lshrrev_b32 v2, 5, v1
    v_lshlrev_b32 v233, 4, v2
    s_mul_i32 s26, s16, 5
    v_add_u32 v113, s26, v1
    v_subrev_u32 v3, 40, v113
    v_min_u32 v113, v113, v3
    v_mul_u32_u24 v3, 205, v1
    v_lshrrev_b32 v3, 10, v3
    v_mul_u32_u24 v2, 5, v3
    v_sub_u32 v115, v1, v2
    v_lshlrev_b32 v114, 2, v3
    s_lshl_b32 s81, s16, 10
    s_add_u32 s81, s81, 8192
    s_mul_i32 s80, s16, 6912
    v_lshl_add_u32 v121, v1, 2, s81
    v_lshrrev_b32 v3, 1, v1
    v_lshl_add_u32 v122, v3, 2, s81
    v_and_b32 v2, 1, v1
    v_lshlrev_b32 v123, 4, v2
    v_lshrrev_b32 v3, 1, v0
    v_mul_u32_u24 v3, 1280, v3
    v_add_u32 v124, v3, v2
    v_mul_u32_u24 v125, 48, v113
    s_lshl_b32 s26, s16, 2
    v_lshl_add_u32 v126, v115, 5, s26
    v_lshl_add_u32 v127, v1, 5, s80
    s_and_b32 s26, s16, 3
    s_lshl_b32 s58, s26, 9
    s_add_u32 s58, s58, 129024
    v_lshrrev_b32 v3, 4, v1
    v_mul_u32_u24 v2, 1792, v3
    v_add3_u32 v240, v2, s58, v232
    s_lshr_b32 s58, s16, 2
    v_and_b32 v2, 15, v1
    v_mul_u32_u24 v241, 288, v2
    v_lshl_add_u32 v241, v3, 4, v241
    s_mul_i32 s59, s58, 23040
    v_add_u32 v241, s59, v241
    v_lshlrev_b32 v242, 18, v3
    v_lshl_add_u32 v242, v2, 4, v242
    s_mul_i32 s58, s58, 5242880
    s_lshl_b32 s59, s2, 10
    s_add_u32 s58, s58, s59
    s_lshl_b32 s59, s26, 8
    s_add_u32 s58, s58, s59
    v_add_u32 v242, s58, v242
    v_mov_b32 v244, 161792
    s_mov_b32 s72, s50
    s_mov_b32 s73, s51
    s_mov_b32 s74, 32768
    s_mov_b32 s75, 0x00020000
    s_mov_b32 s44, s54
    s_mov_b32 s45, s55
    s_mov_b32 s46, 256
    s_mov_b32 s47, 0x00020000
    s_waitcnt lgkmcnt(0)
    v_or_b32 v164, v164, v5
    v_or_b32 v165, v165, v5
    v_or_b32 v166, v166, v5
    v_or_b32 v167, v167, v5
    v_or_b32 v168, v168, v5
    s_mul_i32 s27, s17, 15360
    s_add_u32 s27, s27, 10485760
    s_mul_i32 s58, s17, 40960
    s_add_u32 s59, s58, 4096
    s_waitcnt vmcnt(4)
    s_barrier
    ds_read_b128 v[80:83], v164 offset:61440
    ds_read_b128 v[84:87], v165 offset:61440
    ds_read_b128 v[88:91], v166 offset:61440
    ds_read_b128 v[92:95], v167 offset:61440
    s_mov_b64 exec, s[62:63]
    ds_read_b128 v[96:99], v168 offset:61440
    s_mov_b64 exec, -1
    s_waitcnt vmcnt(2)
    buffer_store_dwordx4 v[152:155], v55, s[8:11], s27 offen sc1
    s_mov_b32 exec_hi, s35
    buffer_store_dwordx4 v[156:159], v55, s[8:11], s27 offen offset:1024 sc1
    s_mov_b32 exec_hi, -1
    s_waitcnt lgkmcnt(4)
    buffer_store_dwordx4 v[80:83], v56, s[8:11], s58 offen offset:0 sc1
    s_waitcnt lgkmcnt(3)
    buffer_store_dwordx4 v[84:87], v56, s[8:11], s58 offen offset:1024 sc1
    s_waitcnt lgkmcnt(2)
    buffer_store_dwordx4 v[88:91], v56, s[8:11], s58 offen offset:2048 sc1
    s_waitcnt lgkmcnt(1)
    buffer_store_dwordx4 v[92:95], v56, s[8:11], s58 offen offset:3072 sc1
    s_mov_b32 exec_lo, s34
    s_mov_b32 exec_hi, s63
    s_waitcnt lgkmcnt(0)
    buffer_store_dwordx4 v[96:99], v56, s[8:11], s59 offen offset:0 sc1
    s_mov_b64 exec, -1
    s_mov_b32 s30, 400000
    s_mov_b32 s53, 0
    s_brev_b32 s59, 1
    s_waitcnt vmcnt(7)
    v_not_b32 v64, v64
    v_and_or_b32 v60, v64, s59, v60
    v_not_b32 v65, v65
    v_and_or_b32 v61, v65, s59, v61
    v_not_b32 v66, v66
    v_and_or_b32 v62, v66, s59, v62
    v_not_b32 v67, v67
    v_and_or_b32 v63, v67, s59, v63
    v_and_b32 v2, 0x30, v1
    v_and_b32 v3, 3, v1
    v_lshl_add_u32 v2, v3, 2, v2
    v_bfe_u32 v7, v1, 2, 2
    v_add_lshl_u32 v2, v2, v7, 1
    ds_write_b16 v2, v57 offset:6656
    v_lshlrev_b32 v3, 3, v3
    ds_read_b64 v[216:217], v3 offset:6656
    ds_read_b64 v[218:219], v3 offset:6688
    ds_read_b64 v[220:221], v3 offset:6720
    ds_read_b64 v[222:223], v3 offset:6752
    s_lshl_b32 s58, s16, 12
    s_add_u32 m0, s58, 129024
    s_cmp_eq_u32 s16, 7
    s_waitcnt vmcnt(0) lgkmcnt(0)
    s_barrier
    s_cbranch_scc0 L_nrow2
    buffer_store_dwordx4 v[60:63], v72, s[8:11], s29 offen sc1
L_nrow2:
    s_barrier
    buffer_load_dwordx4 v232, s[72:75], s58 offen offset:0 lds
    buffer_load_dwordx4 v232, s[72:75], s58 offen offset:1024 lds
    buffer_load_dwordx4 v232, s[72:75], s58 offen offset:2048 lds
    buffer_load_dwordx4 v232, s[72:75], s58 offen offset:3072 lds
    v_and_b32 v3, 31, v1
    v_lshlrev_b32 v2, 7, v233
    v_lshl_add_u32 v2, v3, 2, v2
    v_add_u32 v3, 128, v2
    ds_read2st64_b32 v[144:145], v2 offset0:64 offset1:65
    ds_read2st64_b32 v[146:147], v2 offset0:66 offset1:67
    ds_read2st64_b32 v[148:149], v2 offset0:68 offset1:69
    ds_read2st64_b32 v[150:151], v2 offset0:70 offset1:71
    ds_read2st64_b32 v[152:153], v3 offset0:64 offset1:65
    ds_read2st64_b32 v[154:155], v3 offset0:66 offset1:67
    ds_read2st64_b32 v[156:157], v3 offset0:68 offset1:69
    ds_read2st64_b32 v[158:159], v3 offset0:70 offset1:71
    s_mov_b32 s56, 0xbfb8aa3b
    s_mov_b32 s57, 0xbfb8aa3b
    s_waitcnt lgkmcnt(7)
    v_lshlrev_b32 v160, 16, v144
    v_lshlrev_b32 v161, 16, v145
    v_and_b32 v162, 0xffff0000, v144
    v_and_b32 v163, 0xffff0000, v145
    v_pk_mul_f32 v[160:161], v[160:161], s[56:57]
    v_pk_mul_f32 v[162:163], v[162:163], s[56:57]
    v_cvt_pk_bf16_f32 v200, v160, v161
    v_cvt_pk_bf16_f32 v204, v162, v163
    s_waitcnt lgkmcnt(6)
    v_lshlrev_b32 v160, 16, v146
    v_lshlrev_b32 v161, 16, v147
    v_and_b32 v162, 0xffff0000, v146
    v_and_b32 v163, 0xffff0000, v147
    v_pk_mul_f32 v[160:161], v[160:161], s[56:57]
    v_pk_mul_f32 v[162:163], v[162:163], s[56:57]
    v_cvt_pk_bf16_f32 v201, v160, v161
    v_cvt_pk_bf16_f32 v205, v162, v163
    s_waitcnt lgkmcnt(5)
    v_lshlrev_b32 v160, 16, v148
    v_lshlrev_b32 v161, 16, v149
    v_and_b32 v162, 0xffff0000, v148
    v_and_b32 v163, 0xffff0000, v149
    v_pk_mul_f32 v[160:161], v[160:161], s[56:57]
    v_pk_mul_f32 v[162:163], v[162:163], s[56:57]
    v_cvt_pk_bf16_f32 v202, v160, v161
    v_cvt_pk_bf16_f32 v206, v162, v163
    s_waitcnt lgkmcnt(4)
    v_lshlrev_b32 v160, 16, v150
    v_lshlrev_b32 v161, 16, v151
    v_and_b32 v162, 0xffff0000, v150
    v_and_b32 v163, 0xffff0000, v151
    v_pk_mul_f32 v[160:161], v[160:161], s[56:57]
    v_pk_mul_f32 v[162:163], v[162:163], s[56:57]
    v_cvt_pk_bf16_f32 v203, v160, v161
    v_cvt_pk_bf16_f32 v207, v162, v163
    s_waitcnt lgkmcnt(3)
    v_lshlrev_b32 v160, 16, v152
    v_lshlrev_b32 v161, 16, v153
    v_and_b32 v162, 0xffff0000, v152
    v_and_b32 v163, 0xffff0000, v153
    v_pk_mul_f32 v[160:161], v[160:161], s[56:57]
    v_pk_mul_f32 v[162:163], v[162:163], s[56:57]
    v_cvt_pk_bf16_f32 v208, v160, v161
    v_cvt_pk_bf16_f32 v212, v162, v163
    s_waitcnt lgkmcnt(2)
    v_lshlrev_b32 v160, 16, v154
    v_lshlrev_b32 v161, 16, v155
    v_and_b32 v162, 0xffff0000, v154
    v_and_b32 v163, 0xffff0000, v155
    v_pk_mul_f32 v[160:161], v[160:161], s[56:57]
    v_pk_mul_f32 v[162:163], v[162:163], s[56:57]
    v_cvt_pk_bf16_f32 v209, v160, v161
    v_cvt_pk_bf16_f32 v213, v162, v163
    s_waitcnt lgkmcnt(1)
    v_lshlrev_b32 v160, 16, v156
    v_lshlrev_b32 v161, 16, v157
    v_and_b32 v162, 0xffff0000, v156
    v_and_b32 v163, 0xffff0000, v157
    v_pk_mul_f32 v[160:161], v[160:161], s[56:57]
    v_pk_mul_f32 v[162:163], v[162:163], s[56:57]
    v_cvt_pk_bf16_f32 v210, v160, v161
    v_cvt_pk_bf16_f32 v214, v162, v163
    s_waitcnt lgkmcnt(0)
    v_lshlrev_b32 v160, 16, v158
    v_lshlrev_b32 v161, 16, v159
    v_and_b32 v162, 0xffff0000, v158
    v_and_b32 v163, 0xffff0000, v159
    v_pk_mul_f32 v[160:161], v[160:161], s[56:57]
    v_pk_mul_f32 v[162:163], v[162:163], s[56:57]
    v_cvt_pk_bf16_f32 v211, v160, v161
    v_cvt_pk_bf16_f32 v215, v162, v163
    v_mov_b32 v80, 0xffffff
    v_mov_b32 v81, 0xffffff
    v_mov_b32 v82, 0xffffff
    v_mov_b32 v83, 0xffffff
    v_add_u32 v2, s81, v232
    ds_write_b128 v2, v[80:83]
    v_and_b32 v7, 1, v1
L_pa:
    buffer_load_dword v6, v58, s[8:11], 0 offen sc1
L_pwa:
    s_waitcnt vmcnt(0)
    v_xor_b32 v144, v6, v59
    v_cmpx_le_i32 vcc, 0, v144
    s_cbranch_execz L_pda
    s_sub_u32 s30, s30, 1
    s_cbranch_scc1 L_end
    s_and_b32 s58, s30, 7
    s_cbranch_scc1 L_pa
    v_mov_b32 v144, 0
    buffer_load_dword v145, v144, s[44:47], 0 offen sc1
    s_waitcnt vmcnt(0)
    v_readfirstlane_b32 s53, v145
    s_cmp_eq_u32 s53, 0
    s_cbranch_scc1 L_pa
    buffer_load_dword v6, v58, s[8:11], 0 offen sc1
    s_waitcnt vmcnt(0)
L_pda:
    s_mov_b64 exec, -1
    v_bfe_u32 v236, v6, 16, 11
    v_and_b32 v5, 0xffff, v6
    v_sub_u32 v2, v236, v7
    v_add_u32_dpp v236, v236, v236 row_shr:2 row_mask:0xf bank_mask:0xf
    v_add_u32 v5, v5, v124
    s_nop 0
    v_add_u32_dpp v236, v236, v236 row_shr:4 row_mask:0xf bank_mask:0xf
    s_nop 1
    v_add_u32_dpp v236, v236, v236 row_shr:8 row_mask:0xf bank_mask:0xf
    s_nop 1
    v_add_u32_dpp v236, v236, v236 row_bcast:15 row_mask:0xa bank_mask:0xf
    s_nop 1
    v_add_u32_dpp v236, v236, v236 row_bcast:31 row_mask:0xc bank_mask:0xf
    v_sub_u32 v3, v236, v2
    v_min_u32 v4, 216, v236
    v_lshl_add_u32 v6, v3, 2, s81
    v_sub_u32 v4, v4, v3
    v_sub_u32 v237, v5, v3
    v_sub_u32 v235, v3, v7
L_exp:
    v_cmpx_lt_i32 vcc, 0, v4
    ds_write_b32 v6, v5 offset:0
    v_add_u32 v5, 2, v5
    v_cmpx_lt_i32 vcc, 2, v4
    ds_write_b32 v6, v5 offset:8
    v_add_u32 v5, 2, v5
    v_cmpx_lt_i32 vcc, 4, v4
    ds_write_b32 v6, v5 offset:16
    v_add_u32 v5, 2, v5
    v_cmpx_lt_i32 vcc, 6, v4
    ds_write_b32 v6, v5 offset:24
    v_add_u32 v5, 2, v5
    v_cmpx_lt_i32 vcc, 8, v4
    ds_write_b32 v6, v5 offset:32
    v_add_u32 v5, 2, v5
    v_cmpx_lt_i32 vcc, 10, v4
    ds_write_b32 v6, v5 offset:40
    v_add_u32 v5, 2, v5
    v_cmpx_lt_i32 vcc, 12, v4
    s_cbranch_execnz L_exp_more
L_exp_done:
    s_mov_b64 exec, -1
    ds_read_b32 v99, v121 offset:768
    ds_read_b32 v98, v121 offset:512
    ds_read_b32 v97, v121 offset:256
    ds_read_b32 v96, v121 offset:0
    v_readlane_b32 s19, v236, 63
    s_mov_b32 s26, 10485760
    s_sub_i32 s28, s19, s24
    s_cmp_le_i32 s28, 192
    s_cbranch_scc1 L_sk3
    s_waitcnt lgkmcnt(3)
    v_mul_u32_u24 v99, 12, v99
    buffer_load_dwordx3 v[92:94], v99, s[8:11], s26 offen sc1
L_sk3:
    s_waitcnt lgkmcnt(2)
    v_mul_u32_u24 v98, 12, v98
    buffer_load_dwordx3 v[88:90], v98, s[8:11], s26 offen sc1
    s_waitcnt lgkmcnt(1)
    v_mul_u32_u24 v97, 12, v97
    buffer_load_dwordx3 v[84:86], v97, s[8:11], s26 offen sc1
    s_waitcnt lgkmcnt(0)
    v_mul_u32_u24 v96, 12, v96
    buffer_load_dwordx3 v[80:82], v96, s[8:11], s26 offen sc1
    ds_read_b32 v100, v122 offset:0
    ds_read_b32 v101, v122 offset:128
    ds_read_b32 v102, v122 offset:256
    ds_read_b32 v103, v122 offset:384
    ds_read_b32 v104, v122 offset:512
    ds_read_b32 v105, v122 offset:640
    ds_read_b32 v106, v122 offset:768
    s_max_i32 s28, s28, 0
    s_min_i32 s28, s28, 216
    s_barrier
    s_waitcnt lgkmcnt(6)
    v_lshl_or_b32 v100, v100, 5, v123
    s_add_u32 m0, s80, 46080
    s_cmp_le_u32 s28, 32
    buffer_load_dwordx4 v100, s[8:11], 0 offen sc1 lds
    s_waitcnt lgkmcnt(5)
    v_lshl_or_b32 v101, v101, 5, v123
    s_add_u32 m0, s80, 47104
    s_cmp_le_u32 s28, 64
    buffer_load_dwordx4 v101, s[8:11], 0 offen sc1 lds
    s_waitcnt lgkmcnt(0)
    v_lshl_or_b32 v102, v102, 5, v123
    v_lshl_or_b32 v103, v103, 5, v123
    v_lshl_or_b32 v104, v104, 5, v123
    v_lshl_or_b32 v105, v105, 5, v123
    v_lshl_or_b32 v106, v106, 5, v123
    s_sub_i32 s27, s28, 0
    v_cmp_gt_i32 s[36:37], s27, v1
    s_sub_i32 s27, s28, 64
    v_cmp_gt_i32 s[38:39], s27, v1
    s_sub_i32 s27, s28, 128
    v_cmp_gt_i32 s[40:41], s27, v1
    s_sub_i32 s27, s28, 192
    v_cmp_gt_i32 s[42:43], s27, v1
    v_mov_b32 v3, s19
    v_mov_b32 v4, 2048
    ds_max_u32 v4, v3
    v_mov_b32 v6, 1
    s_waitcnt vmcnt(5)
    s_mov_b64 exec, s[42:43]
    v_and_b32 v2, 0x3ff, v94
    v_lshlrev_b32 v95, 2, v2
    ds_add_rtn_u32 v111, v95, v6 offset:0
    s_waitcnt vmcnt(4)
    s_mov_b64 exec, s[40:41]
    v_and_b32 v2, 0x3ff, v90
    v_lshlrev_b32 v91, 2, v2
    ds_add_rtn_u32 v110, v91, v6 offset:0
    s_waitcnt vmcnt(3)
    s_mov_b64 exec, s[38:39]
    v_and_b32 v2, 0x3ff, v86
    v_lshlrev_b32 v87, 2, v2
    ds_add_rtn_u32 v109, v87, v6 offset:0
    s_waitcnt vmcnt(2)
    s_mov_b64 exec, s[36:37]
    v_and_b32 v2, 0x3ff, v82
    v_lshlrev_b32 v83, 2, v2
    ds_add_rtn_u32 v108, v83, v6 offset:0
    s_mov_b64 exec, -1
    s_waitcnt lgkmcnt(0)
    s_barrier
    ds_read_b128 v[148:151], v125 offset:0
    ds_read_b128 v[152:155], v125 offset:16
    ds_read_b128 v[156:159], v125 offset:32
    ds_read_b32 v4, v4
    s_lshl_b32 s26, s2, 3
    s_add_u32 s26, s26, s16
    s_add_u32 s26, s26, s24
    s_cmp_eq_u32 s26, 7
    s_cbranch_scc0 L_noall
    v_mov_b32 v144, 0
    v_mov_b32 v145, 1
    s_mov_b64 exec, 1
    buffer_store_dword v145, v144, s[44:47], 0 offen sc1
    s_mov_b64 exec, -1
L_noall:
    s_cmp_le_u32 s28, 64
    s_cbranch_scc1 L_efd
    s_add_u32 m0, s80, 48128
    s_cmp_le_u32 s28, 96
    buffer_load_dwordx4 v102, s[8:11], 0 offen sc1 lds
    s_cbranch_scc1 L_efd
    s_add_u32 m0, s80, 49152
    s_cmp_le_u32 s28, 128
    buffer_load_dwordx4 v103, s[8:11], 0 offen sc1 lds
    s_cbranch_scc1 L_efd
    s_add_u32 m0, s80, 50176
    s_cmp_le_u32 s28, 160
    buffer_load_dwordx4 v104, s[8:11], 0 offen sc1 lds
    s_cbranch_scc1 L_efd
    s_add_u32 m0, s80, 51200
    s_cmp_le_u32 s28, 192
    buffer_load_dwordx4 v105, s[8:11], 0 offen sc1 lds
    s_cbranch_scc1 L_efd
    s_add_u32 m0, s80, 52224
    s_cmp_le_u32 s28, 224
    s_mov_b32 exec_hi, 0xffff
    buffer_load_dwordx4 v106, s[8:11], 0 offen sc1 lds
    s_mov_b32 exec_hi, -1
L_efd:
    v_cmp_gt_u32 vcc, 40, v1
    s_waitcnt lgkmcnt(0)
    v_readfirstlane_b32 s26, v4
    v_add_u32 v3, v148, v149
    v_add3_u32 v3, v3, v150, v151
    v_add3_u32 v3, v3, v152, v153
    v_add3_u32 v3, v3, v154, v155
    v_add3_u32 v3, v3, v156, v157
    v_add3_u32 v3, v3, v158, v159
    v_lshl_or_b32 v3, v3, 6, v113
    v_cndmask_b32 v3, 0, v3, vcc
    s_max_u32 s25, s25, s26
    s_cmp_lg_u32 s24, 0
    s_cbranch_scc1 L_havepos
    v_readlane_b32 s64, v3, 0
    v_readlane_b32 s65, v3, 1
    v_readlane_b32 s66, v3, 2
    v_readlane_b32 s67, v3, 3
    v_readlane_b32 s68, v3, 4
    v_cmp_lt_u32 s[70:71], s64, v3
    v_cmp_lt_u32 s[72:73], s65, v3
    v_cmp_lt_u32 s[74:75], s66, v3
    v_cmp_lt_u32 s[76:77], s67, v3
    v_cmp_lt_u32 s[78:79], s68, v3
    s_bcnt1_i32_b64 s64, s[70:71]
    s_bcnt1_i32_b64 s65, s[72:73]
    s_bcnt1_i32_b64 s66, s[74:75]
    s_bcnt1_i32_b64 s67, s[76:77]
    s_bcnt1_i32_b64 s68, s[78:79]
    v_readlane_b32 s70, v112, s64
    v_readlane_b32 s71, v112, s65
    v_readlane_b32 s72, v112, s66
    v_readlane_b32 s73, v112, s67
    v_readlane_b32 s74, v112, s68
    v_writelane_b32 v238, s70, 0
    v_writelane_b32 v238, s71, 1
    v_writelane_b32 v238, s72, 2
    v_writelane_b32 v238, s73, 3
    v_writelane_b32 v238, s74, 4
    v_lshlrev_b32 v238, 2, v238
L_havepos:
    s_mov_b64 exec, 31
    ds_write_b32 v238, v3 offset:4096
    s_mov_b64 exec, -1
    v_lshlrev_b32 v4, 2, v1
    v_and_b32 v6, 7, v1
    v_cmp_gt_u32 s[34:35], s16, v6
    s_and_b64 s[34:35], s[34:35], vcc
    v_cmp_gt_u32 vcc, 60, v1
    s_waitcnt lgkmcnt(0)
    s_barrier
    ds_read_b32 v119, v126 offset:4096
    ds_read_b32 v4, v4 offset:4096
    s_waitcnt lgkmcnt(1)
    v_and_b32 v119, 63, v119
    v_mad_u32_u24 v3, v119, 48, v114
    ds_read_b32 v116, v3 offset:0
    s_waitcnt lgkmcnt(1)
    v_lshrrev_b32 v4, 6, v4
    v_cndmask_b32 v118, 0, v4, s[34:35]
    v_mul_u32_u24 v119, 1152, v119
    s_waitcnt lgkmcnt(0)
    v_cndmask_b32 v116, 0, v116, vcc
    v_mov_b32 v117, v116
    v_readlane_b32 s48, v119, 0
    v_readlane_b32 s49, v119, 1
    v_add_u32_dpp v117, v117, v117 row_shr:1 row_mask:0xf bank_mask:0xf
    v_add_u32_dpp v118, v118, v118 row_shr:1 row_mask:0xf bank_mask:0xf
    v_readlane_b32 s50, v119, 2
    v_add_u32_dpp v117, v117, v117 row_shr:2 row_mask:0xf bank_mask:0xf
    v_add_u32_dpp v118, v118, v118 row_shr:2 row_mask:0xf bank_mask:0xf
    v_readlane_b32 s51, v119, 3
    v_add_u32_dpp v117, v117, v117 row_shr:4 row_mask:0xf bank_mask:0xf
    v_add_u32_dpp v118, v118, v118 row_shr:4 row_mask:0xf bank_mask:0xf
    v_readlane_b32 s52, v119, 4
    v_add_u32_dpp v117, v117, v117 row_shr:8 row_mask:0xf bank_mask:0xf
    v_add_u32_dpp v118, v118, v118 row_shr:8 row_mask:0xf bank_mask:0xf
    v_lshlrev_b32 v4, 3, v115
    v_add_u32_dpp v117, v117, v117 row_bcast:15 row_mask:0xa bank_mask:0xf
    v_add_u32_dpp v118, v118, v118 row_bcast:15 row_mask:0xa bank_mask:0xf
    s_min_u32 s25, s25, 40000
    v_add_u32_dpp v117, v117, v117 row_bcast:31 row_mask:0xc bank_mask:0xf
    v_add_u32_dpp v118, v118, v118 row_bcast:31 row_mask:0xc bank_mask:0xf
    v_sub_u32 v116, v117, v116
    v_readlane_b32 s29, v118, 63
    v_readlane_b32 s18, v117, 63
    s_lshl_b32 s26, s29, 4
    s_add_u32 s26, s26, 101376
    v_lshl_add_u32 v116, v116, 4, s26
    v_lshl_or_b32 v116, v116, 10, v4
    s_mov_b64 exec, vcc
    ds_write_b32 v3, v116 offset:4608
    s_mov_b64 exec, -1
    s_min_u32 s18, s18, 1728
    v_lshl_add_u32 v230, v234, 4, s26
    v_and_b32 v2, 3, v1
    v_bfe_u32 v3, v1, 3, 2
    v_lshl_add_u32 v2, v3, 2, v2
    v_lshl_add_u32 v231, v2, 4, s26
    s_movk_i32 s27, 0x3ff
    s_waitcnt lgkmcnt(0)
    s_barrier
    s_mov_b64 exec, s[36:37]
    ds_read_b32 v96, v83 offset:4608
    s_mov_b64 exec, s[38:39]
    ds_read_b32 v97, v87 offset:4608
    s_mov_b64 exec, s[40:41]
    ds_read_b32 v98, v91 offset:4608
    s_mov_b64 exec, s[42:43]
    ds_read_b32 v99, v95 offset:4608
    s_mov_b64 exec, -1
    v_add_u32 v83, 0, v127
    v_add_u32 v87, 2048, v127
    v_add_u32 v91, 4096, v127
    v_add_u32 v95, 6144, v127
    s_waitcnt lgkmcnt(0)
    s_mov_b64 exec, s[36:37]
    v_bfi_b32 v82, s27, v96, v82
    v_lshrrev_b32 v96, 10, v96
    v_lshl_add_u32 v96, v108, 4, v96
    ds_write_b128 v96, v[80:83]
    s_mov_b64 exec, s[38:39]
    v_bfi_b32 v86, s27, v97, v86
    v_lshrrev_b32 v97, 10, v97
    v_lshl_add_u32 v97, v109, 4, v97
    ds_write_b128 v97, v[84:87]
    s_mov_b64 exec, s[40:41]
    v_bfi_b32 v90, s27, v98, v90
    v_lshrrev_b32 v98, 10, v98
    v_lshl_add_u32 v98, v110, 4, v98
    ds_write_b128 v98, v[88:91]
    s_mov_b64 exec, s[42:43]
    v_bfi_b32 v94, s27, v99, v94
    v_lshrrev_b32 v99, 10, v99
    v_lshl_add_u32 v99, v111, 4, v99
    ds_write_b128 v99, v[92:95]
    s_mov_b64 exec, -1
    v_cmp_gt_i32 vcc, s18, v234
    v_mov_b32 v4, s32
    s_waitcnt lgkmcnt(0)
    s_barrier
    ds_read_b128 v[224:227], v230
    ds_read_b32 v229, v231 offset:12
    ds_read_b32 v2, v231 offset:268
    s_waitcnt lgkmcnt(0)
    v_cndmask_b32 v228, v4, v226, vcc
    v_and_or_b32 v229, v229, s33, v233
    v_readlane_b32 s64, v228, 0
    v_readlane_b32 s65, v228, 4
    v_readlane_b32 s66, v228, 8
    v_readlane_b32 s67, v228, 12
    v_readlane_b32 s68, v228, 16
    v_readlane_b32 s69, v228, 20
    v_readlane_b32 s70, v228, 24
    v_readlane_b32 s71, v228, 28
    s_and_b32 s80, s64, s31
    buffer_load_dwordx4 v[48:51], v232, s[4:7], s80 offen
    s_and_b32 s81, s65, s31
    buffer_load_dwordx4 v[52:55], v232, s[4:7], s81 offen
    s_and_b32 s82, s66, s31
    buffer_load_dwordx4 v[56:59], v232, s[4:7], s82 offen
    s_and_b32 s83, s67, s31
    buffer_load_dwordx4 v[60:63], v232, s[4:7], s83 offen
    s_waitcnt vmcnt(4)
    s_barrier
    s_mov_b64 exec, s[20:21]
    ds_read_b128 v[192:195], v229 offset:46080
    s_mov_b64 exec, s[22:23]
    ds_read_b128 v[196:199], v229 offset:46080
    s_mov_b64 exec, -1
    v_and_or_b32 v229, v2, s33, v233
    s_waitcnt lgkmcnt(0)
    v_mfma_f32_32x32x16_bf16 v[80:95], v[192:195], v[200:203], 0
    v_mfma_f32_32x32x16_bf16 v[96:111], v[192:195], v[204:207], 0
    v_mfma_f32_32x32x16_bf16 v[80:95], v[196:199], v[208:211], v[80:95]
    v_mfma_f32_32x32x16_bf16 v[96:111], v[196:199], v[212:215], v[96:111]
    s_and_b32 s80, s68, s31
    buffer_load_dwordx4 v[64:67], v232, s[4:7], s80 offen
    s_and_b32 s81, s69, s31
    buffer_load_dwordx4 v[68:71], v232, s[4:7], s81 offen
    s_and_b32 s82, s70, s31
    buffer_load_dwordx4 v[72:75], v232, s[4:7], s82 offen
    s_and_b32 s83, s71, s31
    buffer_load_dwordx4 v[76:79], v232, s[4:7], s83 offen
    s_mov_b64 exec, s[20:21]
    ds_read_b128 v[192:195], v229 offset:46080
    s_mov_b64 exec, -1
    s_cmp_lg_u32 s24, 0
    s_cbranch_scc1 L_wdone
    v_lshrrev_b32 v7, 5, v0
    v_and_b32 v3, 31, v1
    v_lshlrev_b32 v7, 11, v7
    v_add_u32 v7, 129024, v7
    v_lshl_add_u32 v2, v3, 3, v7
    ds_read_b64 v[160:161], v2 offset:0
    ds_read_b64 v[162:163], v2 offset:256
    ds_read_b64 v[164:165], v2 offset:512
    ds_read_b64 v[166:167], v2 offset:768
    ds_read_b64 v[168:169], v2 offset:1024
    ds_read_b64 v[170:171], v2 offset:1280
    ds_read_b64 v[172:173], v2 offset:1536
    ds_read_b64 v[174:175], v2 offset:1792
    s_mov_b32 s58, 0x05040100
    s_mov_b32 s59, 0x07060302
    v_bfe_u32 v3, v0, 3, 2
    v_lshl_add_u32 v7, v3, 9, v7
    v_and_b32 v3, 7, v0
    v_lshl_add_u32 v7, v3, 5, v7
    v_mov_b32 v5, 161792
    v_mov_b32 v6, 1
    s_waitcnt lgkmcnt(0)
    v_perm_b32 v112, v162, v160, s58
    v_perm_b32 v113, v166, v164, s58
    v_perm_b32 v114, v170, v168, s58
    v_perm_b32 v115, v174, v172, s58
    ds_write_b128 v7, v[112:115] offset:0
    v_perm_b32 v116, v162, v160, s59
    v_perm_b32 v117, v166, v164, s59
    v_perm_b32 v118, v170, v168, s59
    v_perm_b32 v119, v174, v172, s59
    ds_write_b128 v7, v[116:119] offset:256
    v_perm_b32 v120, v163, v161, s58
    v_perm_b32 v121, v167, v165, s58
    v_perm_b32 v122, v171, v169, s58
    v_perm_b32 v123, v175, v173, s58
    ds_write_b128 v7, v[120:123] offset:16
    v_perm_b32 v124, v163, v161, s59
    v_perm_b32 v125, v167, v165, s59
    v_perm_b32 v126, v171, v169, s59
    v_perm_b32 v127, v175, v173, s59
    ds_write_b128 v7, v[124:127] offset:272
    s_mov_b64 exec, 1
    ds_add_u32 v5, v6
    s_mov_b64 exec, -1
L_wdone:
    s_cmp_eq_u32 s16, 7
    s_cselect_b32 s3, 64, 0x80000000
    s_mov_b32 s53, 1
    s_mov_b32 s30, s18
    s_waitcnt lgkmcnt(0)
L_sb:
    s_cmp_gt_i32 s30, s3
    s_cbranch_scc1 L_nofl
    s_load_dword s53, s[54:55], 0
L_nofl:
    v_mfma_f32_4x4x4_16b_bf16 v[144:147], v[224:225], v[216:217], 0
    v_mfma_f32_4x4x4_16b_bf16 v[148:151], v[224:225], v[218:219], 0
    v_mfma_f32_4x4x4_16b_bf16 v[152:155], v[224:225], v[220:221], 0
    v_mfma_f32_4x4x4_16b_bf16 v[156:159], v[224:225], v[222:223], 0
    v_add_u32 v230, 1024, v230
    s_sub_u32 s26, s30, 64
    v_cmp_gt_i32 s[34:35], s26, v234
    s_cmp_le_i32 s30, 0
    s_nop 0
    v_cvt_pk_bf16_f32 v184, v144, v148
    v_cvt_pk_bf16_f32 v185, v152, v156
    v_cvt_pk_bf16_f32 v186, v145, v149
    v_cvt_pk_bf16_f32 v187, v153, v157
    v_cvt_pk_bf16_f32 v188, v146, v150
    v_cvt_pk_bf16_f32 v189, v154, v158
    v_cvt_pk_bf16_f32 v190, v147, v151
    v_cvt_pk_bf16_f32 v191, v155, v159
    ds_read_b128 v[224:227], v230
    ds_read_b32 v243, v244
    s_cbranch_scc1 L_exit
    s_setprio 3
    s_waitcnt vmcnt(4)
    v_mfma_f32_4x4x4_16b_bf16 v[144:147], v[184:185], v[48:49], 0 cbsz:4 abid:0
    v_exp_f32 v176, v80
    v_mfma_f32_4x4x4_16b_bf16 v[148:151], v[184:185], v[50:51], 0 cbsz:4 abid:0
    v_exp_f32 v180, v96
    v_mfma_f32_4x4x4_16b_bf16 v[152:155], v[184:185], v[52:53], 0 cbsz:4 abid:1
    v_exp_f32 v177, v81
    v_mfma_f32_4x4x4_16b_bf16 v[156:159], v[184:185], v[54:55], 0 cbsz:4 abid:1
    v_exp_f32 v181, v97
    v_mfma_f32_4x4x4_16b_bf16 v[160:163], v[184:185], v[56:57], 0 cbsz:4 abid:2
    v_exp_f32 v178, v82
    v_mfma_f32_4x4x4_16b_bf16 v[164:167], v[184:185], v[58:59], 0 cbsz:4 abid:2
    v_exp_f32 v182, v98
    v_mfma_f32_4x4x4_16b_bf16 v[168:171], v[184:185], v[60:61], 0 cbsz:4 abid:3
    v_exp_f32 v179, v83
    v_mfma_f32_4x4x4_16b_bf16 v[172:175], v[184:185], v[62:63], 0 cbsz:4 abid:3
    v_exp_f32 v183, v99
    v_readlane_b32 s72, v228, 32
    v_readlane_b32 s73, v228, 36
    v_readlane_b32 s74, v228, 40
    v_readlane_b32 s75, v228, 44
    s_and_b32 s80, s72, s31
    v_pk_fma_f32 v[176:177], v[176:177], s[56:57], s[56:57]
    s_and_b32 s81, s73, s31
    v_pk_fma_f32 v[178:179], v[178:179], s[56:57], s[56:57]
    s_and_b32 s82, s74, s31
    v_pk_fma_f32 v[180:181], v[180:181], s[56:57], s[56:57]
    s_and_b32 s83, s75, s31
    v_pk_fma_f32 v[182:183], v[182:183], s[56:57], s[56:57]
    v_mfma_f32_32x32x16_bf16 v[112:127], v[192:195], v[200:203], 0
    v_rcp_f32 v176, v176
    v_rcp_f32 v177, v177
    v_rcp_f32 v178, v178
    v_rcp_f32 v179, v179
    v_rcp_f32 v180, v180
    buffer_load_dwordx4 v[48:51], v232, s[4:7], s80 offen
    v_rcp_f32 v181, v181
    buffer_load_dwordx4 v[52:55], v232, s[4:7], s81 offen
    v_rcp_f32 v182, v182
    buffer_load_dwordx4 v[56:59], v232, s[4:7], s82 offen
    v_rcp_f32 v183, v183
    buffer_load_dwordx4 v[60:63], v232, s[4:7], s83 offen
    s_cmp_le_i32 s30, 4
    s_mov_b64 exec, s[22:23]
    ds_read_b128 v[196:199], v229 offset:46080
    s_mov_b64 exec, -1
    ds_read_b32 v2, v231 offset:524
    v_pk_mul_f32 v[176:177], v[176:177], v[80:81]
    v_pk_mul_f32 v[178:179], v[178:179], v[82:83]
    v_pk_mul_f32 v[180:181], v[180:181], v[96:97]
    v_pk_mul_f32 v[182:183], v[182:183], v[98:99]
    s_set_gpr_idx_on s64, gpr_idx(SRC2,DST)
    v_pk_fma_f32 v[8:9], v[176:177], v[144:145], v[8:9] op_sel:[0,0,0] op_sel_hi:[0,1,1]
    v_pk_fma_f32 v[10:11], v[176:177], v[146:147], v[10:11] op_sel:[0,0,0] op_sel_hi:[0,1,1]
    v_pk_fma_f32 v[12:13], v[180:181], v[148:149], v[12:13] op_sel:[0,0,0] op_sel_hi:[0,1,1]
    v_pk_fma_f32 v[14:15], v[180:181], v[150:151], v[14:15] op_sel:[0,0,0] op_sel_hi:[0,1,1]
    s_set_gpr_idx_idx s65
    v_pk_fma_f32 v[8:9], v[176:177], v[152:153], v[8:9] op_sel:[1,0,0] op_sel_hi:[1,1,1]
    v_pk_fma_f32 v[10:11], v[176:177], v[154:155], v[10:11] op_sel:[1,0,0] op_sel_hi:[1,1,1]
    v_pk_fma_f32 v[12:13], v[180:181], v[156:157], v[12:13] op_sel:[1,0,0] op_sel_hi:[1,1,1]
    v_pk_fma_f32 v[14:15], v[180:181], v[158:159], v[14:15] op_sel:[1,0,0] op_sel_hi:[1,1,1]
    s_set_gpr_idx_idx s66
    v_pk_fma_f32 v[8:9], v[178:179], v[160:161], v[8:9] op_sel:[0,0,0] op_sel_hi:[0,1,1]
    v_pk_fma_f32 v[10:11], v[178:179], v[162:163], v[10:11] op_sel:[0,0,0] op_sel_hi:[0,1,1]
    v_pk_fma_f32 v[12:13], v[182:183], v[164:165], v[12:13] op_sel:[0,0,0] op_sel_hi:[0,1,1]
    v_pk_fma_f32 v[14:15], v[182:183], v[166:167], v[14:15] op_sel:[0,0,0] op_sel_hi:[0,1,1]
    s_set_gpr_idx_idx s67
    v_pk_fma_f32 v[8:9], v[178:179], v[168:169], v[8:9] op_sel:[1,0,0] op_sel_hi:[1,1,1]
    v_pk_fma_f32 v[10:11], v[178:179], v[170:171], v[10:11] op_sel:[1,0,0] op_sel_hi:[1,1,1]
    v_pk_fma_f32 v[12:13], v[182:183], v[172:173], v[12:13] op_sel:[1,0,0] op_sel_hi:[1,1,1]
    v_pk_fma_f32 v[14:15], v[182:183], v[174:175], v[14:15] op_sel:[1,0,0] op_sel_hi:[1,1,1]
    s_set_gpr_idx_off
    s_cbranch_scc1 L_exit
    s_waitcnt vmcnt(4)
    v_mfma_f32_4x4x4_16b_bf16 v[144:147], v[184:185], v[64:65], 0 cbsz:4 abid:4
    v_exp_f32 v176, v84
    v_mfma_f32_4x4x4_16b_bf16 v[148:151], v[184:185], v[66:67], 0 cbsz:4 abid:4
    v_exp_f32 v180, v100
    v_mfma_f32_4x4x4_16b_bf16 v[152:155], v[184:185], v[68:69], 0 cbsz:4 abid:5
    v_exp_f32 v177, v85
    v_mfma_f32_4x4x4_16b_bf16 v[156:159], v[184:185], v[70:71], 0 cbsz:4 abid:5
    v_exp_f32 v181, v101
    v_mfma_f32_4x4x4_16b_bf16 v[160:163], v[184:185], v[72:73], 0 cbsz:4 abid:6
    v_exp_f32 v178, v86
    v_mfma_f32_4x4x4_16b_bf16 v[164:167], v[184:185], v[74:75], 0 cbsz:4 abid:6
    v_exp_f32 v182, v102
    v_mfma_f32_4x4x4_16b_bf16 v[168:171], v[184:185], v[76:77], 0 cbsz:4 abid:7
    v_exp_f32 v179, v87
    v_mfma_f32_4x4x4_16b_bf16 v[172:175], v[184:185], v[78:79], 0 cbsz:4 abid:7
    v_exp_f32 v183, v103
    v_readlane_b32 s76, v228, 48
    v_readlane_b32 s77, v228, 52
    v_readlane_b32 s78, v228, 56
    v_readlane_b32 s79, v228, 60
    s_and_b32 s80, s76, s31
    v_pk_fma_f32 v[176:177], v[176:177], s[56:57], s[56:57]
    s_and_b32 s81, s77, s31
    v_pk_fma_f32 v[178:179], v[178:179], s[56:57], s[56:57]
    s_and_b32 s82, s78, s31
    v_pk_fma_f32 v[180:181], v[180:181], s[56:57], s[56:57]
    s_and_b32 s83, s79, s31
    v_pk_fma_f32 v[182:183], v[182:183], s[56:57], s[56:57]
    v_mfma_f32_32x32x16_bf16 v[128:143], v[192:195], v[204:207], 0
    v_rcp_f32 v176, v176
    v_rcp_f32 v177, v177
    v_rcp_f32 v178, v178
    v_rcp_f32 v179, v179
    v_rcp_f32 v180, v180
    buffer_load_dwordx4 v[64:67], v232, s[4:7], s80 offen
    v_rcp_f32 v181, v181
    buffer_load_dwordx4 v[68:71], v232, s[4:7], s81 offen
    v_rcp_f32 v182, v182
    buffer_load_dwordx4 v[72:75], v232, s[4:7], s82 offen
    v_rcp_f32 v183, v183
    buffer_load_dwordx4 v[76:79], v232, s[4:7], s83 offen
    s_cmp_le_i32 s30, 8
    s_waitcnt lgkmcnt(0)
    v_pk_mul_f32 v[176:177], v[176:177], v[84:85]
    v_pk_mul_f32 v[178:179], v[178:179], v[86:87]
    v_pk_mul_f32 v[180:181], v[180:181], v[100:101]
    v_pk_mul_f32 v[182:183], v[182:183], v[102:103]
    s_set_gpr_idx_on s68, gpr_idx(SRC2,DST)
    v_pk_fma_f32 v[8:9], v[176:177], v[144:145], v[8:9] op_sel:[0,0,0] op_sel_hi:[0,1,1]
    v_pk_fma_f32 v[10:11], v[176:177], v[146:147], v[10:11] op_sel:[0,0,0] op_sel_hi:[0,1,1]
    v_pk_fma_f32 v[12:13], v[180:181], v[148:149], v[12:13] op_sel:[0,0,0] op_sel_hi:[0,1,1]
    v_pk_fma_f32 v[14:15], v[180:181], v[150:151], v[14:15] op_sel:[0,0,0] op_sel_hi:[0,1,1]
    s_set_gpr_idx_idx s69
    v_pk_fma_f32 v[8:9], v[176:177], v[152:153], v[8:9] op_sel:[1,0,0] op_sel_hi:[1,1,1]
    v_pk_fma_f32 v[10:11], v[176:177], v[154:155], v[10:11] op_sel:[1,0,0] op_sel_hi:[1,1,1]
    v_pk_fma_f32 v[12:13], v[180:181], v[156:157], v[12:13] op_sel:[1,0,0] op_sel_hi:[1,1,1]
    v_pk_fma_f32 v[14:15], v[180:181], v[158:159], v[14:15] op_sel:[1,0,0] op_sel_hi:[1,1,1]
    s_set_gpr_idx_idx s70
    v_pk_fma_f32 v[8:9], v[178:179], v[160:161], v[8:9] op_sel:[0,0,0] op_sel_hi:[0,1,1]
    v_pk_fma_f32 v[10:11], v[178:179], v[162:163], v[10:11] op_sel:[0,0,0] op_sel_hi:[0,1,1]
    v_pk_fma_f32 v[12:13], v[182:183], v[164:165], v[12:13] op_sel:[0,0,0] op_sel_hi:[0,1,1]
    v_pk_fma_f32 v[14:15], v[182:183], v[166:167], v[14:15] op_sel:[0,0,0] op_sel_hi:[0,1,1]
    s_set_gpr_idx_idx s71
    v_pk_fma_f32 v[8:9], v[178:179], v[168:169], v[8:9] op_sel:[1,0,0] op_sel_hi:[1,1,1]
    v_pk_fma_f32 v[10:11], v[178:179], v[170:171], v[10:11] op_sel:[1,0,0] op_sel_hi:[1,1,1]
    v_pk_fma_f32 v[12:13], v[182:183], v[172:173], v[12:13] op_sel:[1,0,0] op_sel_hi:[1,1,1]
    v_pk_fma_f32 v[14:15], v[182:183], v[174:175], v[14:15] op_sel:[1,0,0] op_sel_hi:[1,1,1]
    s_set_gpr_idx_off
    s_cbranch_scc1 L_exit
    s_setprio 2
    s_waitcnt vmcnt(4)
    v_mfma_f32_4x4x4_16b_bf16 v[144:147], v[184:185], v[48:49], 0 cbsz:4 abid:8
    v_exp_f32 v176, v88
    v_mfma_f32_4x4x4_16b_bf16 v[148:151], v[184:185], v[50:51], 0 cbsz:4 abid:8
    v_exp_f32 v180, v104
    v_mfma_f32_4x4x4_16b_bf16 v[152:155], v[184:185], v[52:53], 0 cbsz:4 abid:9
    v_exp_f32 v177, v89
    v_mfma_f32_4x4x4_16b_bf16 v[156:159], v[184:185], v[54:55], 0 cbsz:4 abid:9
    v_exp_f32 v181, v105
    v_mfma_f32_4x4x4_16b_bf16 v[160:163], v[184:185], v[56:57], 0 cbsz:4 abid:10
    v_exp_f32 v178, v90
    v_mfma_f32_4x4x4_16b_bf16 v[164:167], v[184:185], v[58:59], 0 cbsz:4 abid:10
    v_exp_f32 v182, v106
    v_mfma_f32_4x4x4_16b_bf16 v[168:171], v[184:185], v[60:61], 0 cbsz:4 abid:11
    v_exp_f32 v179, v91
    v_mfma_f32_4x4x4_16b_bf16 v[172:175], v[184:185], v[62:63], 0 cbsz:4 abid:11
    v_exp_f32 v183, v107
    v_readlane_b32 s64, v228, 1
    v_readlane_b32 s65, v228, 5
    v_readlane_b32 s66, v228, 9
    v_readlane_b32 s67, v228, 13
    v_and_or_b32 v229, v2, s33, v233
    s_and_b32 s80, s64, s31
    v_pk_fma_f32 v[176:177], v[176:177], s[56:57], s[56:57]
    s_and_b32 s81, s65, s31
    v_pk_fma_f32 v[178:179], v[178:179], s[56:57], s[56:57]
    s_and_b32 s82, s66, s31
    v_pk_fma_f32 v[180:181], v[180:181], s[56:57], s[56:57]
    s_and_b32 s83, s67, s31
    v_pk_fma_f32 v[182:183], v[182:183], s[56:57], s[56:57]
    v_mfma_f32_32x32x16_bf16 v[112:127], v[196:199], v[208:211], v[112:127]
    v_rcp_f32 v176, v176
    v_rcp_f32 v177, v177
    v_rcp_f32 v178, v178
    v_rcp_f32 v179, v179
    v_rcp_f32 v180, v180
    buffer_load_dwordx4 v[48:51], v232, s[4:7], s80 offen
    v_rcp_f32 v181, v181
    buffer_load_dwordx4 v[52:55], v232, s[4:7], s81 offen
    v_rcp_f32 v182, v182
    buffer_load_dwordx4 v[56:59], v232, s[4:7], s82 offen
    v_rcp_f32 v183, v183
    buffer_load_dwordx4 v[60:63], v232, s[4:7], s83 offen
    s_cmp_le_i32 s30, 12
    s_mov_b64 exec, s[20:21]
    ds_read_b128 v[192:195], v229 offset:46080
    s_mov_b64 exec, -1
    v_pk_mul_f32 v[176:177], v[176:177], v[88:89]
    v_pk_mul_f32 v[178:179], v[178:179], v[90:91]
    v_pk_mul_f32 v[180:181], v[180:181], v[104:105]
    v_pk_mul_f32 v[182:183], v[182:183], v[106:107]
    s_set_gpr_idx_on s72, gpr_idx(SRC2,DST)
    v_pk_fma_f32 v[8:9], v[176:177], v[144:145], v[8:9] op_sel:[0,0,0] op_sel_hi:[0,1,1]
    v_pk_fma_f32 v[10:11], v[176:177], v[146:147], v[10:11] op_sel:[0,0,0] op_sel_hi:[0,1,1]
    v_pk_fma_f32 v[12:13], v[180:181], v[148:149], v[12:13] op_sel:[0,0,0] op_sel_hi:[0,1,1]
    v_pk_fma_f32 v[14:15], v[180:181], v[150:151], v[14:15] op_sel:[0,0,0] op_sel_hi:[0,1,1]
    s_set_gpr_idx_idx s73
    v_pk_fma_f32 v[8:9], v[176:177], v[152:153], v[8:9] op_sel:[1,0,0] op_sel_hi:[1,1,1]
    v_pk_fma_f32 v[10:11], v[176:177], v[154:155], v[10:11] op_sel:[1,0,0] op_sel_hi:[1,1,1]
    v_pk_fma_f32 v[12:13], v[180:181], v[156:157], v[12:13] op_sel:[1,0,0] op_sel_hi:[1,1,1]
    v_pk_fma_f32 v[14:15], v[180:181], v[158:159], v[14:15] op_sel:[1,0,0] op_sel_hi:[1,1,1]
    s_set_gpr_idx_idx s74
    v_pk_fma_f32 v[8:9], v[178:179], v[160:161], v[8:9] op_sel:[0,0,0] op_sel_hi:[0,1,1]
    v_pk_fma_f32 v[10:11], v[178:179], v[162:163], v[10:11] op_sel:[0,0,0] op_sel_hi:[0,1,1]
    v_pk_fma_f32 v[12:13], v[182:183], v[164:165], v[12:13] op_sel:[0,0,0] op_sel_hi:[0,1,1]
    v_pk_fma_f32 v[14:15], v[182:183], v[166:167], v[14:15] op_sel:[0,0,0] op_sel_hi:[0,1,1]
    s_set_gpr_idx_idx s75
    v_pk_fma_f32 v[8:9], v[178:179], v[168:169], v[8:9] op_sel:[1,0,0] op_sel_hi:[1,1,1]
    v_pk_fma_f32 v[10:11], v[178:179], v[170:171], v[10:11] op_sel:[1,0,0] op_sel_hi:[1,1,1]
    v_pk_fma_f32 v[12:13], v[182:183], v[172:173], v[12:13] op_sel:[1,0,0] op_sel_hi:[1,1,1]
    v_pk_fma_f32 v[14:15], v[182:183], v[174:175], v[14:15] op_sel:[1,0,0] op_sel_hi:[1,1,1]
    s_set_gpr_idx_off
    s_cbranch_scc1 L_exit
    s_waitcnt vmcnt(4)
    v_mfma_f32_4x4x4_16b_bf16 v[144:147], v[184:185], v[64:65], 0 cbsz:4 abid:12
    v_exp_f32 v176, v92
    v_mfma_f32_4x4x4_16b_bf16 v[148:151], v[184:185], v[66:67], 0 cbsz:4 abid:12
    v_exp_f32 v180, v108
    v_mfma_f32_4x4x4_16b_bf16 v[152:155], v[184:185], v[68:69], 0 cbsz:4 abid:13
    v_exp_f32 v177, v93
    v_mfma_f32_4x4x4_16b_bf16 v[156:159], v[184:185], v[70:71], 0 cbsz:4 abid:13
    v_exp_f32 v181, v109
    v_mfma_f32_4x4x4_16b_bf16 v[160:163], v[184:185], v[72:73], 0 cbsz:4 abid:14
    v_exp_f32 v178, v94
    v_mfma_f32_4x4x4_16b_bf16 v[164:167], v[184:185], v[74:75], 0 cbsz:4 abid:14
    v_exp_f32 v182, v110
    v_mfma_f32_4x4x4_16b_bf16 v[168:171], v[184:185], v[76:77], 0 cbsz:4 abid:15
    v_exp_f32 v179, v95
    v_mfma_f32_4x4x4_16b_bf16 v[172:175], v[184:185], v[78:79], 0 cbsz:4 abid:15
    v_exp_f32 v183, v111
    v_readlane_b32 s68, v228, 17
    v_readlane_b32 s69, v228, 21
    v_readlane_b32 s70, v228, 25
    v_readlane_b32 s71, v228, 29
    s_and_b32 s80, s68, s31
    v_pk_fma_f32 v[176:177], v[176:177], s[56:57], s[56:57]
    s_and_b32 s81, s69, s31
    v_pk_fma_f32 v[178:179], v[178:179], s[56:57], s[56:57]
    s_and_b32 s82, s70, s31
    v_pk_fma_f32 v[180:181], v[180:181], s[56:57], s[56:57]
    s_and_b32 s83, s71, s31
    v_pk_fma_f32 v[182:183], v[182:183], s[56:57], s[56:57]
    v_mfma_f32_32x32x16_bf16 v[128:143], v[196:199], v[212:215], v[128:143]
    v_rcp_f32 v176, v176
    v_rcp_f32 v177, v177
    v_rcp_f32 v178, v178
    v_rcp_f32 v179, v179
    v_rcp_f32 v180, v180
    buffer_load_dwordx4 v[64:67], v232, s[4:7], s80 offen
    v_rcp_f32 v181, v181
    buffer_load_dwordx4 v[68:71], v232, s[4:7], s81 offen
    v_rcp_f32 v182, v182
    buffer_load_dwordx4 v[72:75], v232, s[4:7], s82 offen
    v_rcp_f32 v183, v183
    buffer_load_dwordx4 v[76:79], v232, s[4:7], s83 offen
    s_cmp_le_i32 s30, 16
    s_waitcnt lgkmcnt(0)
    v_pk_mul_f32 v[176:177], v[176:177], v[92:93]
    v_pk_mul_f32 v[178:179], v[178:179], v[94:95]
    v_pk_mul_f32 v[180:181], v[180:181], v[108:109]
    v_pk_mul_f32 v[182:183], v[182:183], v[110:111]
    s_set_gpr_idx_on s76, gpr_idx(SRC2,DST)
    v_pk_fma_f32 v[8:9], v[176:177], v[144:145], v[8:9] op_sel:[0,0,0] op_sel_hi:[0,1,1]
    v_pk_fma_f32 v[10:11], v[176:177], v[146:147], v[10:11] op_sel:[0,0,0] op_sel_hi:[0,1,1]
    v_pk_fma_f32 v[12:13], v[180:181], v[148:149], v[12:13] op_sel:[0,0,0] op_sel_hi:[0,1,1]
    v_pk_fma_f32 v[14:15], v[180:181], v[150:151], v[14:15] op_sel:[0,0,0] op_sel_hi:[0,1,1]
    s_set_gpr_idx_idx s77
    v_pk_fma_f32 v[8:9], v[176:177], v[152:153], v[8:9] op_sel:[1,0,0] op_sel_hi:[1,1,1]
    v_pk_fma_f32 v[10:11], v[176:177], v[154:155], v[10:11] op_sel:[1,0,0] op_sel_hi:[1,1,1]
    v_pk_fma_f32 v[12:13], v[180:181], v[156:157], v[12:13] op_sel:[1,0,0] op_sel_hi:[1,1,1]
    v_pk_fma_f32 v[14:15], v[180:181], v[158:159], v[14:15] op_sel:[1,0,0] op_sel_hi:[1,1,1]
    s_set_gpr_idx_idx s78
    v_pk_fma_f32 v[8:9], v[178:179], v[160:161], v[8:9] op_sel:[0,0,0] op_sel_hi:[0,1,1]
    v_pk_fma_f32 v[10:11], v[178:179], v[162:163], v[10:11] op_sel:[0,0,0] op_sel_hi:[0,1,1]
    v_pk_fma_f32 v[12:13], v[182:183], v[164:165], v[12:13] op_sel:[0,0,0] op_sel_hi:[0,1,1]
    v_pk_fma_f32 v[14:15], v[182:183], v[166:167], v[14:15] op_sel:[0,0,0] op_sel_hi:[0,1,1]
    s_set_gpr_idx_idx s79
    v_pk_fma_f32 v[8:9], v[178:179], v[168:169], v[8:9] op_sel:[1,0,0] op_sel_hi:[1,1,1]
    v_pk_fma_f32 v[10:11], v[178:179], v[170:171], v[10:11] op_sel:[1,0,0] op_sel_hi:[1,1,1]
    v_pk_fma_f32 v[12:13], v[182:183], v[172:173], v[12:13] op_sel:[1,0,0] op_sel_hi:[1,1,1]
    v_pk_fma_f32 v[14:15], v[182:183], v[174:175], v[14:15] op_sel:[1,0,0] op_sel_hi:[1,1,1]
    s_set_gpr_idx_off
    s_cbranch_scc1 L_exit
    s_setprio 1
    s_waitcnt vmcnt(4)
    v_mfma_f32_4x4x4_16b_bf16 v[144:147], v[186:187], v[48:49], 0 cbsz:4 abid:0
    v_exp_f32 v176, v112
    v_mfma_f32_4x4x4_16b_bf16 v[148:151], v[186:187], v[50:51], 0 cbsz:4 abid:0
    v_exp_f32 v180, v128
    v_mfma_f32_4x4x4_16b_bf16 v[152:155], v[186:187], v[52:53], 0 cbsz:4 abid:1
    v_exp_f32 v177, v113
    v_mfma_f32_4x4x4_16b_bf16 v[156:159], v[186:187], v[54:55], 0 cbsz:4 abid:1
    v_exp_f32 v181, v129
    v_mfma_f32_4x4x4_16b_bf16 v[160:163], v[186:187], v[56:57], 0 cbsz:4 abid:2
    v_exp_f32 v178, v114
    v_mfma_f32_4x4x4_16b_bf16 v[164:167], v[186:187], v[58:59], 0 cbsz:4 abid:2
    v_exp_f32 v182, v130
    v_mfma_f32_4x4x4_16b_bf16 v[168:171], v[186:187], v[60:61], 0 cbsz:4 abid:3
    v_exp_f32 v179, v115
    v_mfma_f32_4x4x4_16b_bf16 v[172:175], v[186:187], v[62:63], 0 cbsz:4 abid:3
    v_exp_f32 v183, v131
    v_readlane_b32 s72, v228, 33
    v_readlane_b32 s73, v228, 37
    v_readlane_b32 s74, v228, 41
    v_readlane_b32 s75, v228, 45
    s_and_b32 s80, s72, s31
    v_pk_fma_f32 v[176:177], v[176:177], s[56:57], s[56:57]
    s_and_b32 s81, s73, s31
    v_pk_fma_f32 v[178:179], v[178:179], s[56:57], s[56:57]
    s_and_b32 s82, s74, s31
    v_pk_fma_f32 v[180:181], v[180:181], s[56:57], s[56:57]
    s_and_b32 s83, s75, s31
    v_pk_fma_f32 v[182:183], v[182:183], s[56:57], s[56:57]
    v_mfma_f32_32x32x16_bf16 v[80:95], v[192:195], v[200:203], 0
    v_rcp_f32 v176, v176
    v_rcp_f32 v177, v177
    v_rcp_f32 v178, v178
    v_rcp_f32 v179, v179
    v_rcp_f32 v180, v180
    buffer_load_dwordx4 v[48:51], v232, s[4:7], s80 offen
    v_rcp_f32 v181, v181
    buffer_load_dwordx4 v[52:55], v232, s[4:7], s81 offen
    v_rcp_f32 v182, v182
    buffer_load_dwordx4 v[56:59], v232, s[4:7], s82 offen
    v_rcp_f32 v183, v183
    buffer_load_dwordx4 v[60:63], v232, s[4:7], s83 offen
    s_cmp_le_i32 s30, 20
    s_mov_b64 exec, s[22:23]
    ds_read_b128 v[196:199], v229 offset:46080
    s_mov_b64 exec, -1
    ds_read_b32 v2, v231 offset:780
    v_pk_mul_f32 v[176:177], v[176:177], v[112:113]
    v_pk_mul_f32 v[178:179], v[178:179], v[114:115]
    v_pk_mul_f32 v[180:181], v[180:181], v[128:129]
    v_pk_mul_f32 v[182:183], v[182:183], v[130:131]
    s_set_gpr_idx_on s64, gpr_idx(SRC2,DST)
    v_pk_fma_f32 v[8:9], v[176:177], v[144:145], v[8:9] op_sel:[0,0,0] op_sel_hi:[0,1,1]
    v_pk_fma_f32 v[10:11], v[176:177], v[146:147], v[10:11] op_sel:[0,0,0] op_sel_hi:[0,1,1]
    v_pk_fma_f32 v[12:13], v[180:181], v[148:149], v[12:13] op_sel:[0,0,0] op_sel_hi:[0,1,1]
    v_pk_fma_f32 v[14:15], v[180:181], v[150:151], v[14:15] op_sel:[0,0,0] op_sel_hi:[0,1,1]
    s_set_gpr_idx_idx s65
    v_pk_fma_f32 v[8:9], v[176:177], v[152:153], v[8:9] op_sel:[1,0,0] op_sel_hi:[1,1,1]
    v_pk_fma_f32 v[10:11], v[176:177], v[154:155], v[10:11] op_sel:[1,0,0] op_sel_hi:[1,1,1]
    v_pk_fma_f32 v[12:13], v[180:181], v[156:157], v[12:13] op_sel:[1,0,0] op_sel_hi:[1,1,1]
    v_pk_fma_f32 v[14:15], v[180:181], v[158:159], v[14:15] op_sel:[1,0,0] op_sel_hi:[1,1,1]
    s_set_gpr_idx_idx s66
    v_pk_fma_f32 v[8:9], v[178:179], v[160:161], v[8:9] op_sel:[0,0,0] op_sel_hi:[0,1,1]
    v_pk_fma_f32 v[10:11], v[178:179], v[162:163], v[10:11] op_sel:[0,0,0] op_sel_hi:[0,1,1]
    v_pk_fma_f32 v[12:13], v[182:183], v[164:165], v[12:13] op_sel:[0,0,0] op_sel_hi:[0,1,1]
    v_pk_fma_f32 v[14:15], v[182:183], v[166:167], v[14:15] op_sel:[0,0,0] op_sel_hi:[0,1,1]
    s_set_gpr_idx_idx s67
    v_pk_fma_f32 v[8:9], v[178:179], v[168:169], v[8:9] op_sel:[1,0,0] op_sel_hi:[1,1,1]
    v_pk_fma_f32 v[10:11], v[178:179], v[170:171], v[10:11] op_sel:[1,0,0] op_sel_hi:[1,1,1]
    v_pk_fma_f32 v[12:13], v[182:183], v[172:173], v[12:13] op_sel:[1,0,0] op_sel_hi:[1,1,1]
    v_pk_fma_f32 v[14:15], v[182:183], v[174:175], v[14:15] op_sel:[1,0,0] op_sel_hi:[1,1,1]
    s_set_gpr_idx_off
    s_cbranch_scc1 L_exit
    s_waitcnt vmcnt(4)
    v_mfma_f32_4x4x4_16b_bf16 v[144:147], v[186:187], v[64:65], 0 cbsz:4 abid:4
    v_exp_f32 v176, v116
    v_mfma_f32_4x4x4_16b_bf16 v[148:151], v[186:187], v[66:67], 0 cbsz:4 abid:4
    v_exp_f32 v180, v132
    v_mfma_f32_4x4x4_16b_bf16 v[152:155], v[186:187], v[68:69], 0 cbsz:4 abid:5
    v_exp_f32 v177, v117
    v_mfma_f32_4x4x4_16b_bf16 v[156:159], v[186:187], v[70:71], 0 cbsz:4 abid:5
    v_exp_f32 v181, v133
    v_mfma_f32_4x4x4_16b_bf16 v[160:163], v[186:187], v[72:73], 0 cbsz:4 abid:6
    v_exp_f32 v178, v118
    v_mfma_f32_4x4x4_16b_bf16 v[164:167], v[186:187], v[74:75], 0 cbsz:4 abid:6
    v_exp_f32 v182, v134
    v_mfma_f32_4x4x4_16b_bf16 v[168:171], v[186:187], v[76:77], 0 cbsz:4 abid:7
    v_exp_f32 v179, v119
    v_mfma_f32_4x4x4_16b_bf16 v[172:175], v[186:187], v[78:79], 0 cbsz:4 abid:7
    v_exp_f32 v183, v135
    v_readlane_b32 s76, v228, 49
    v_readlane_b32 s77, v228, 53
    v_readlane_b32 s78, v228, 57
    v_readlane_b32 s79, v228, 61
    s_and_b32 s80, s76, s31
    v_pk_fma_f32 v[176:177], v[176:177], s[56:57], s[56:57]
    s_and_b32 s81, s77, s31
    v_pk_fma_f32 v[178:179], v[178:179], s[56:57], s[56:57]
    s_and_b32 s82, s78, s31
    v_pk_fma_f32 v[180:181], v[180:181], s[56:57], s[56:57]
    s_and_b32 s83, s79, s31
    v_pk_fma_f32 v[182:183], v[182:183], s[56:57], s[56:57]
    v_mfma_f32_32x32x16_bf16 v[96:111], v[192:195], v[204:207], 0
    v_rcp_f32 v176, v176
    v_rcp_f32 v177, v177
    v_rcp_f32 v178, v178
    v_rcp_f32 v179, v179
    v_rcp_f32 v180, v180
    buffer_load_dwordx4 v[64:67], v232, s[4:7], s80 offen
    v_rcp_f32 v181, v181
    buffer_load_dwordx4 v[68:71], v232, s[4:7], s81 offen
    v_rcp_f32 v182, v182
    buffer_load_dwordx4 v[72:75], v232, s[4:7], s82 offen
    v_rcp_f32 v183, v183
    buffer_load_dwordx4 v[76:79], v232, s[4:7], s83 offen
    s_cmp_le_i32 s30, 24
    s_waitcnt lgkmcnt(0)
    v_pk_mul_f32 v[176:177], v[176:177], v[116:117]
    v_pk_mul_f32 v[178:179], v[178:179], v[118:119]
    v_pk_mul_f32 v[180:181], v[180:181], v[132:133]
    v_pk_mul_f32 v[182:183], v[182:183], v[134:135]
    s_set_gpr_idx_on s68, gpr_idx(SRC2,DST)
    v_pk_fma_f32 v[8:9], v[176:177], v[144:145], v[8:9] op_sel:[0,0,0] op_sel_hi:[0,1,1]
    v_pk_fma_f32 v[10:11], v[176:177], v[146:147], v[10:11] op_sel:[0,0,0] op_sel_hi:[0,1,1]
    v_pk_fma_f32 v[12:13], v[180:181], v[148:149], v[12:13] op_sel:[0,0,0] op_sel_hi:[0,1,1]
    v_pk_fma_f32 v[14:15], v[180:181], v[150:151], v[14:15] op_sel:[0,0,0] op_sel_hi:[0,1,1]
    s_set_gpr_idx_idx s69
    v_pk_fma_f32 v[8:9], v[176:177], v[152:153], v[8:9] op_sel:[1,0,0] op_sel_hi:[1,1,1]
    v_pk_fma_f32 v[10:11], v[176:177], v[154:155], v[10:11] op_sel:[1,0,0] op_sel_hi:[1,1,1]
    v_pk_fma_f32 v[12:13], v[180:181], v[156:157], v[12:13] op_sel:[1,0,0] op_sel_hi:[1,1,1]
    v_pk_fma_f32 v[14:15], v[180:181], v[158:159], v[14:15] op_sel:[1,0,0] op_sel_hi:[1,1,1]
    s_set_gpr_idx_idx s70
    v_pk_fma_f32 v[8:9], v[178:179], v[160:161], v[8:9] op_sel:[0,0,0] op_sel_hi:[0,1,1]
    v_pk_fma_f32 v[10:11], v[178:179], v[162:163], v[10:11] op_sel:[0,0,0] op_sel_hi:[0,1,1]
    v_pk_fma_f32 v[12:13], v[182:183], v[164:165], v[12:13] op_sel:[0,0,0] op_sel_hi:[0,1,1]
    v_pk_fma_f32 v[14:15], v[182:183], v[166:167], v[14:15] op_sel:[0,0,0] op_sel_hi:[0,1,1]
    s_set_gpr_idx_idx s71
    v_pk_fma_f32 v[8:9], v[178:179], v[168:169], v[8:9] op_sel:[1,0,0] op_sel_hi:[1,1,1]
    v_pk_fma_f32 v[10:11], v[178:179], v[170:171], v[10:11] op_sel:[1,0,0] op_sel_hi:[1,1,1]
    v_pk_fma_f32 v[12:13], v[182:183], v[172:173], v[12:13] op_sel:[1,0,0] op_sel_hi:[1,1,1]
    v_pk_fma_f32 v[14:15], v[182:183], v[174:175], v[14:15] op_sel:[1,0,0] op_sel_hi:[1,1,1]
    s_set_gpr_idx_off
    s_cbranch_scc1 L_exit
    s_setprio 0
    s_waitcnt vmcnt(4)
    v_mfma_f32_4x4x4_16b_bf16 v[144:147], v[186:187], v[48:49], 0 cbsz:4 abid:8
    v_exp_f32 v176, v120
    v_mfma_f32_4x4x4_16b_bf16 v[148:151], v[186:187], v[50:51], 0 cbsz:4 abid:8
    v_exp_f32 v180, v136
    v_mfma_f32_4x4x4_16b_bf16 v[152:155], v[186:187], v[52:53], 0 cbsz:4 abid:9
    v_exp_f32 v177, v121
    v_mfma_f32_4x4x4_16b_bf16 v[156:159], v[186:187], v[54:55], 0 cbsz:4 abid:9
    v_exp_f32 v181, v137
    v_mfma_f32_4x4x4_16b_bf16 v[160:163], v[186:187], v[56:57], 0 cbsz:4 abid:10
    v_exp_f32 v178, v122
    v_mfma_f32_4x4x4_16b_bf16 v[164:167], v[186:187], v[58:59], 0 cbsz:4 abid:10
    v_exp_f32 v182, v138
    v_mfma_f32_4x4x4_16b_bf16 v[168:171], v[186:187], v[60:61], 0 cbsz:4 abid:11
    v_exp_f32 v179, v123
    v_mfma_f32_4x4x4_16b_bf16 v[172:175], v[186:187], v[62:63], 0 cbsz:4 abid:11
    v_exp_f32 v183, v139
    v_readlane_b32 s64, v228, 2
    v_readlane_b32 s65, v228, 6
    v_readlane_b32 s66, v228, 10
    v_readlane_b32 s67, v228, 14
    v_and_or_b32 v229, v2, s33, v233
    s_and_b32 s80, s64, s31
    v_pk_fma_f32 v[176:177], v[176:177], s[56:57], s[56:57]
    s_and_b32 s81, s65, s31
    v_pk_fma_f32 v[178:179], v[178:179], s[56:57], s[56:57]
    s_and_b32 s82, s66, s31
    v_pk_fma_f32 v[180:181], v[180:181], s[56:57], s[56:57]
    s_and_b32 s83, s67, s31
    v_pk_fma_f32 v[182:183], v[182:183], s[56:57], s[56:57]
    v_mfma_f32_32x32x16_bf16 v[80:95], v[196:199], v[208:211], v[80:95]
    v_rcp_f32 v176, v176
    v_rcp_f32 v177, v177
    v_rcp_f32 v178, v178
    v_rcp_f32 v179, v179
    v_rcp_f32 v180, v180
    buffer_load_dwordx4 v[48:51], v232, s[4:7], s80 offen
    v_rcp_f32 v181, v181
    buffer_load_dwordx4 v[52:55], v232, s[4:7], s81 offen
    v_rcp_f32 v182, v182
    buffer_load_dwordx4 v[56:59], v232, s[4:7], s82 offen
    v_rcp_f32 v183, v183
    buffer_load_dwordx4 v[60:63], v232, s[4:7], s83 offen
    s_cmp_le_i32 s30, 28
    s_mov_b64 exec, s[20:21]
    ds_read_b128 v[192:195], v229 offset:46080
    s_mov_b64 exec, -1
    v_pk_mul_f32 v[176:177], v[176:177], v[120:121]
    v_pk_mul_f32 v[178:179], v[178:179], v[122:123]
    v_pk_mul_f32 v[180:181], v[180:181], v[136:137]
    v_pk_mul_f32 v[182:183], v[182:183], v[138:139]
    s_set_gpr_idx_on s72, gpr_idx(SRC2,DST)
    v_pk_fma_f32 v[8:9], v[176:177], v[144:145], v[8:9] op_sel:[0,0,0] op_sel_hi:[0,1,1]
    v_pk_fma_f32 v[10:11], v[176:177], v[146:147], v[10:11] op_sel:[0,0,0] op_sel_hi:[0,1,1]
    v_pk_fma_f32 v[12:13], v[180:181], v[148:149], v[12:13] op_sel:[0,0,0] op_sel_hi:[0,1,1]
    v_pk_fma_f32 v[14:15], v[180:181], v[150:151], v[14:15] op_sel:[0,0,0] op_sel_hi:[0,1,1]
    s_set_gpr_idx_idx s73
    v_pk_fma_f32 v[8:9], v[176:177], v[152:153], v[8:9] op_sel:[1,0,0] op_sel_hi:[1,1,1]
    v_pk_fma_f32 v[10:11], v[176:177], v[154:155], v[10:11] op_sel:[1,0,0] op_sel_hi:[1,1,1]
    v_pk_fma_f32 v[12:13], v[180:181], v[156:157], v[12:13] op_sel:[1,0,0] op_sel_hi:[1,1,1]
    v_pk_fma_f32 v[14:15], v[180:181], v[158:159], v[14:15] op_sel:[1,0,0] op_sel_hi:[1,1,1]
    s_set_gpr_idx_idx s74
    v_pk_fma_f32 v[8:9], v[178:179], v[160:161], v[8:9] op_sel:[0,0,0] op_sel_hi:[0,1,1]
    v_pk_fma_f32 v[10:11], v[178:179], v[162:163], v[10:11] op_sel:[0,0,0] op_sel_hi:[0,1,1]
    v_pk_fma_f32 v[12:13], v[182:183], v[164:165], v[12:13] op_sel:[0,0,0] op_sel_hi:[0,1,1]
    v_pk_fma_f32 v[14:15], v[182:183], v[166:167], v[14:15] op_sel:[0,0,0] op_sel_hi:[0,1,1]
    s_set_gpr_idx_idx s75
    v_pk_fma_f32 v[8:9], v[178:179], v[168:169], v[8:9] op_sel:[1,0,0] op_sel_hi:[1,1,1]
    v_pk_fma_f32 v[10:11], v[178:179], v[170:171], v[10:11] op_sel:[1,0,0] op_sel_hi:[1,1,1]
    v_pk_fma_f32 v[12:13], v[182:183], v[172:173], v[12:13] op_sel:[1,0,0] op_sel_hi:[1,1,1]
    v_pk_fma_f32 v[14:15], v[182:183], v[174:175], v[14:15] op_sel:[1,0,0] op_sel_hi:[1,1,1]
    s_set_gpr_idx_off
    s_cbranch_scc1 L_exit
    s_waitcnt vmcnt(4)
    v_mfma_f32_4x4x4_16b_bf16 v[144:147], v[186:187], v[64:65], 0 cbsz:4 abid:12
    v_exp_f32 v176, v124
    v_mfma_f32_4x4x4_16b_bf16 v[148:151], v[186:187], v[66:67], 0 cbsz:4 abid:12
    v_exp_f32 v180, v140
    v_mfma_f32_4x4x4_16b_bf16 v[152:155], v[186:187], v[68:69], 0 cbsz:4 abid:13
    v_exp_f32 v177, v125
    v_mfma_f32_4x4x4_16b_bf16 v[156:159], v[186:187], v[70:71], 0 cbsz:4 abid:13
    v_exp_f32 v181, v141
    v_mfma_f32_4x4x4_16b_bf16 v[160:163], v[186:187], v[72:73], 0 cbsz:4 abid:14
    v_exp_f32 v178, v126
    v_mfma_f32_4x4x4_16b_bf16 v[164:167], v[186:187], v[74:75], 0 cbsz:4 abid:14
    v_exp_f32 v182, v142
    v_mfma_f32_4x4x4_16b_bf16 v[168:171], v[186:187], v[76:77], 0 cbsz:4 abid:15
    v_exp_f32 v179, v127
    v_mfma_f32_4x4x4_16b_bf16 v[172:175], v[186:187], v[78:79], 0 cbsz:4 abid:15
    v_exp_f32 v183, v143
    v_readlane_b32 s68, v228, 18
    v_readlane_b32 s69, v228, 22
    v_readlane_b32 s70, v228, 26
    v_readlane_b32 s71, v228, 30
    s_and_b32 s80, s68, s31
    v_pk_fma_f32 v[176:177], v[176:177], s[56:57], s[56:57]
    s_and_b32 s81, s69, s31
    v_pk_fma_f32 v[178:179], v[178:179], s[56:57], s[56:57]
    s_and_b32 s82, s70, s31
    v_pk_fma_f32 v[180:181], v[180:181], s[56:57], s[56:57]
    s_and_b32 s83, s71, s31
    v_pk_fma_f32 v[182:183], v[182:183], s[56:57], s[56:57]
    v_mfma_f32_32x32x16_bf16 v[96:111], v[196:199], v[212:215], v[96:111]
    v_rcp_f32 v176, v176
    v_rcp_f32 v177, v177
    v_rcp_f32 v178, v178
    v_rcp_f32 v179, v179
    v_rcp_f32 v180, v180
    buffer_load_dwordx4 v[64:67], v232, s[4:7], s80 offen
    v_rcp_f32 v181, v181
    buffer_load_dwordx4 v[68:71], v232, s[4:7], s81 offen
    v_rcp_f32 v182, v182
    buffer_load_dwordx4 v[72:75], v232, s[4:7], s82 offen
    v_rcp_f32 v183, v183
    buffer_load_dwordx4 v[76:79], v232, s[4:7], s83 offen
    s_cmp_le_i32 s30, 32
    s_waitcnt lgkmcnt(0)
    v_pk_mul_f32 v[176:177], v[176:177], v[124:125]
    v_pk_mul_f32 v[178:179], v[178:179], v[126:127]
    v_pk_mul_f32 v[180:181], v[180:181], v[140:141]
    v_pk_mul_f32 v[182:183], v[182:183], v[142:143]
    s_set_gpr_idx_on s76, gpr_idx(SRC2,DST)
    v_pk_fma_f32 v[8:9], v[176:177], v[144:145], v[8:9] op_sel:[0,0,0] op_sel_hi:[0,1,1]
    v_pk_fma_f32 v[10:11], v[176:177], v[146:147], v[10:11] op_sel:[0,0,0] op_sel_hi:[0,1,1]
    v_pk_fma_f32 v[12:13], v[180:181], v[148:149], v[12:13] op_sel:[0,0,0] op_sel_hi:[0,1,1]
    v_pk_fma_f32 v[14:15], v[180:181], v[150:151], v[14:15] op_sel:[0,0,0] op_sel_hi:[0,1,1]
    s_set_gpr_idx_idx s77
    v_pk_fma_f32 v[8:9], v[176:177], v[152:153], v[8:9] op_sel:[1,0,0] op_sel_hi:[1,1,1]
    v_pk_fma_f32 v[10:11], v[176:177], v[154:155], v[10:11] op_sel:[1,0,0] op_sel_hi:[1,1,1]
    v_pk_fma_f32 v[12:13], v[180:181], v[156:157], v[12:13] op_sel:[1,0,0] op_sel_hi:[1,1,1]
    v_pk_fma_f32 v[14:15], v[180:181], v[158:159], v[14:15] op_sel:[1,0,0] op_sel_hi:[1,1,1]
    s_set_gpr_idx_idx s78
    v_pk_fma_f32 v[8:9], v[178:179], v[160:161], v[8:9] op_sel:[0,0,0] op_sel_hi:[0,1,1]
    v_pk_fma_f32 v[10:11], v[178:179], v[162:163], v[10:11] op_sel:[0,0,0] op_sel_hi:[0,1,1]
    v_pk_fma_f32 v[12:13], v[182:183], v[164:165], v[12:13] op_sel:[0,0,0] op_sel_hi:[0,1,1]
    v_pk_fma_f32 v[14:15], v[182:183], v[166:167], v[14:15] op_sel:[0,0,0] op_sel_hi:[0,1,1]
    s_set_gpr_idx_idx s79
    v_pk_fma_f32 v[8:9], v[178:179], v[168:169], v[8:9] op_sel:[1,0,0] op_sel_hi:[1,1,1]
    v_pk_fma_f32 v[10:11], v[178:179], v[170:171], v[10:11] op_sel:[1,0,0] op_sel_hi:[1,1,1]
    v_pk_fma_f32 v[12:13], v[182:183], v[172:173], v[12:13] op_sel:[1,0,0] op_sel_hi:[1,1,1]
    v_pk_fma_f32 v[14:15], v[182:183], v[174:175], v[14:15] op_sel:[1,0,0] op_sel_hi:[1,1,1]
    s_set_gpr_idx_off
    s_cbranch_scc1 L_exit
    s_setprio 3
    s_waitcnt vmcnt(4)
    v_mfma_f32_4x4x4_16b_bf16 v[144:147], v[188:189], v[48:49], 0 cbsz:4 abid:0
    v_exp_f32 v176, v80
    v_mfma_f32_4x4x4_16b_bf16 v[148:151], v[188:189], v[50:51], 0 cbsz:4 abid:0
    v_exp_f32 v180, v96
    v_mfma_f32_4x4x4_16b_bf16 v[152:155], v[188:189], v[52:53], 0 cbsz:4 abid:1
    v_exp_f32 v177, v81
    v_mfma_f32_4x4x4_16b_bf16 v[156:159], v[188:189], v[54:55], 0 cbsz:4 abid:1
    v_exp_f32 v181, v97
    v_mfma_f32_4x4x4_16b_bf16 v[160:163], v[188:189], v[56:57], 0 cbsz:4 abid:2
    v_exp_f32 v178, v82
    v_mfma_f32_4x4x4_16b_bf16 v[164:167], v[188:189], v[58:59], 0 cbsz:4 abid:2
    v_exp_f32 v182, v98
    v_mfma_f32_4x4x4_16b_bf16 v[168:171], v[188:189], v[60:61], 0 cbsz:4 abid:3
    v_exp_f32 v179, v83
    v_mfma_f32_4x4x4_16b_bf16 v[172:175], v[188:189], v[62:63], 0 cbsz:4 abid:3
    v_exp_f32 v183, v99
    v_readlane_b32 s72, v228, 34
    v_readlane_b32 s73, v228, 38
    v_readlane_b32 s74, v228, 42
    v_readlane_b32 s75, v228, 46
    s_and_b32 s80, s72, s31
    v_pk_fma_f32 v[176:177], v[176:177], s[56:57], s[56:57]
    s_and_b32 s81, s73, s31
    v_pk_fma_f32 v[178:179], v[178:179], s[56:57], s[56:57]
    s_and_b32 s82, s74, s31
    v_pk_fma_f32 v[180:181], v[180:181], s[56:57], s[56:57]
    s_and_b32 s83, s75, s31
    v_pk_fma_f32 v[182:183], v[182:183], s[56:57], s[56:57]
    v_mfma_f32_32x32x16_bf16 v[112:127], v[192:195], v[200:203], 0
    v_rcp_f32 v176, v176
    v_rcp_f32 v177, v177
    v_rcp_f32 v178, v178
    v_rcp_f32 v179, v179
    v_rcp_f32 v180, v180
    buffer_load_dwordx4 v[48:51], v232, s[4:7], s80 offen
    v_rcp_f32 v181, v181
    buffer_load_dwordx4 v[52:55], v232, s[4:7], s81 offen
    v_rcp_f32 v182, v182
    buffer_load_dwordx4 v[56:59], v232, s[4:7], s82 offen
    v_rcp_f32 v183, v183
    buffer_load_dwordx4 v[60:63], v232, s[4:7], s83 offen
    s_cmp_le_i32 s30, 36
    s_mov_b64 exec, s[22:23]
    ds_read_b128 v[196:199], v229 offset:46080
    s_mov_b64 exec, -1
    ds_read_b32 v2, v231 offset:1036
    v_pk_mul_f32 v[176:177], v[176:177], v[80:81]
    v_pk_mul_f32 v[178:179], v[178:179], v[82:83]
    v_pk_mul_f32 v[180:181], v[180:181], v[96:97]
    v_pk_mul_f32 v[182:183], v[182:183], v[98:99]
    s_set_gpr_idx_on s64, gpr_idx(SRC2,DST)
    v_pk_fma_f32 v[8:9], v[176:177], v[144:145], v[8:9] op_sel:[0,0,0] op_sel_hi:[0,1,1]
    v_pk_fma_f32 v[10:11], v[176:177], v[146:147], v[10:11] op_sel:[0,0,0] op_sel_hi:[0,1,1]
    v_pk_fma_f32 v[12:13], v[180:181], v[148:149], v[12:13] op_sel:[0,0,0] op_sel_hi:[0,1,1]
    v_pk_fma_f32 v[14:15], v[180:181], v[150:151], v[14:15] op_sel:[0,0,0] op_sel_hi:[0,1,1]
    s_set_gpr_idx_idx s65
    v_pk_fma_f32 v[8:9], v[176:177], v[152:153], v[8:9] op_sel:[1,0,0] op_sel_hi:[1,1,1]
    v_pk_fma_f32 v[10:11], v[176:177], v[154:155], v[10:11] op_sel:[1,0,0] op_sel_hi:[1,1,1]
    v_pk_fma_f32 v[12:13], v[180:181], v[156:157], v[12:13] op_sel:[1,0,0] op_sel_hi:[1,1,1]
    v_pk_fma_f32 v[14:15], v[180:181], v[158:159], v[14:15] op_sel:[1,0,0] op_sel_hi:[1,1,1]
    s_set_gpr_idx_idx s66
    v_pk_fma_f32 v[8:9], v[178:179], v[160:161], v[8:9] op_sel:[0,0,0] op_sel_hi:[0,1,1]
    v_pk_fma_f32 v[10:11], v[178:179], v[162:163], v[10:11] op_sel:[0,0,0] op_sel_hi:[0,1,1]
    v_pk_fma_f32 v[12:13], v[182:183], v[164:165], v[12:13] op_sel:[0,0,0] op_sel_hi:[0,1,1]
    v_pk_fma_f32 v[14:15], v[182:183], v[166:167], v[14:15] op_sel:[0,0,0] op_sel_hi:[0,1,1]
    s_set_gpr_idx_idx s67
    v_pk_fma_f32 v[8:9], v[178:179], v[168:169], v[8:9] op_sel:[1,0,0] op_sel_hi:[1,1,1]
    v_pk_fma_f32 v[10:11], v[178:179], v[170:171], v[10:11] op_sel:[1,0,0] op_sel_hi:[1,1,1]
    v_pk_fma_f32 v[12:13], v[182:183], v[172:173], v[12:13] op_sel:[1,0,0] op_sel_hi:[1,1,1]
    v_pk_fma_f32 v[14:15], v[182:183], v[174:175], v[14:15] op_sel:[1,0,0] op_sel_hi:[1,1,1]
    s_set_gpr_idx_off
    s_cbranch_scc1 L_exit
    s_waitcnt vmcnt(4)
    v_mfma_f32_4x4x4_16b_bf16 v[144:147], v[188:189], v[64:65], 0 cbsz:4 abid:4
    v_exp_f32 v176, v84
    v_mfma_f32_4x4x4_16b_bf16 v[148:151], v[188:189], v[66:67], 0 cbsz:4 abid:4
    v_exp_f32 v180, v100
    v_mfma_f32_4x4x4_16b_bf16 v[152:155], v[188:189], v[68:69], 0 cbsz:4 abid:5
    v_exp_f32 v177, v85
    v_mfma_f32_4x4x4_16b_bf16 v[156:159], v[188:189], v[70:71], 0 cbsz:4 abid:5
    v_exp_f32 v181, v101
    v_mfma_f32_4x4x4_16b_bf16 v[160:163], v[188:189], v[72:73], 0 cbsz:4 abid:6
    v_exp_f32 v178, v86
    v_mfma_f32_4x4x4_16b_bf16 v[164:167], v[188:189], v[74:75], 0 cbsz:4 abid:6
    v_exp_f32 v182, v102
    v_mfma_f32_4x4x4_16b_bf16 v[168:171], v[188:189], v[76:77], 0 cbsz:4 abid:7
    v_exp_f32 v179, v87
    v_mfma_f32_4x4x4_16b_bf16 v[172:175], v[188:189], v[78:79], 0 cbsz:4 abid:7
    v_exp_f32 v183, v103
    v_readlane_b32 s76, v228, 50
    v_readlane_b32 s77, v228, 54
    v_readlane_b32 s78, v228, 58
    v_readlane_b32 s79, v228, 62
    s_and_b32 s80, s76, s31
    v_pk_fma_f32 v[176:177], v[176:177], s[56:57], s[56:57]
    s_and_b32 s81, s77, s31
    v_pk_fma_f32 v[178:179], v[178:179], s[56:57], s[56:57]
    s_and_b32 s82, s78, s31
    v_pk_fma_f32 v[180:181], v[180:181], s[56:57], s[56:57]
    s_and_b32 s83, s79, s31
    v_pk_fma_f32 v[182:183], v[182:183], s[56:57], s[56:57]
    v_mfma_f32_32x32x16_bf16 v[128:143], v[192:195], v[204:207], 0
    v_rcp_f32 v176, v176
    v_rcp_f32 v177, v177
    v_rcp_f32 v178, v178
    v_rcp_f32 v179, v179
    v_rcp_f32 v180, v180
    buffer_load_dwordx4 v[64:67], v232, s[4:7], s80 offen
    v_rcp_f32 v181, v181
    buffer_load_dwordx4 v[68:71], v232, s[4:7], s81 offen
    v_rcp_f32 v182, v182
    buffer_load_dwordx4 v[72:75], v232, s[4:7], s82 offen
    v_rcp_f32 v183, v183
    buffer_load_dwordx4 v[76:79], v232, s[4:7], s83 offen
    s_cmp_le_i32 s30, 40
    s_waitcnt lgkmcnt(0)
    v_pk_mul_f32 v[176:177], v[176:177], v[84:85]
    v_pk_mul_f32 v[178:179], v[178:179], v[86:87]
    v_pk_mul_f32 v[180:181], v[180:181], v[100:101]
    v_pk_mul_f32 v[182:183], v[182:183], v[102:103]
    s_set_gpr_idx_on s68, gpr_idx(SRC2,DST)
    v_pk_fma_f32 v[8:9], v[176:177], v[144:145], v[8:9] op_sel:[0,0,0] op_sel_hi:[0,1,1]
    v_pk_fma_f32 v[10:11], v[176:177], v[146:147], v[10:11] op_sel:[0,0,0] op_sel_hi:[0,1,1]
    v_pk_fma_f32 v[12:13], v[180:181], v[148:149], v[12:13] op_sel:[0,0,0] op_sel_hi:[0,1,1]
    v_pk_fma_f32 v[14:15], v[180:181], v[150:151], v[14:15] op_sel:[0,0,0] op_sel_hi:[0,1,1]
    s_set_gpr_idx_idx s69
    v_pk_fma_f32 v[8:9], v[176:177], v[152:153], v[8:9] op_sel:[1,0,0] op_sel_hi:[1,1,1]
    v_pk_fma_f32 v[10:11], v[176:177], v[154:155], v[10:11] op_sel:[1,0,0] op_sel_hi:[1,1,1]
    v_pk_fma_f32 v[12:13], v[180:181], v[156:157], v[12:13] op_sel:[1,0,0] op_sel_hi:[1,1,1]
    v_pk_fma_f32 v[14:15], v[180:181], v[158:159], v[14:15] op_sel:[1,0,0] op_sel_hi:[1,1,1]
    s_set_gpr_idx_idx s70
    v_pk_fma_f32 v[8:9], v[178:179], v[160:161], v[8:9] op_sel:[0,0,0] op_sel_hi:[0,1,1]
    v_pk_fma_f32 v[10:11], v[178:179], v[162:163], v[10:11] op_sel:[0,0,0] op_sel_hi:[0,1,1]
    v_pk_fma_f32 v[12:13], v[182:183], v[164:165], v[12:13] op_sel:[0,0,0] op_sel_hi:[0,1,1]
    v_pk_fma_f32 v[14:15], v[182:183], v[166:167], v[14:15] op_sel:[0,0,0] op_sel_hi:[0,1,1]
    s_set_gpr_idx_idx s71
    v_pk_fma_f32 v[8:9], v[178:179], v[168:169], v[8:9] op_sel:[1,0,0] op_sel_hi:[1,1,1]
    v_pk_fma_f32 v[10:11], v[178:179], v[170:171], v[10:11] op_sel:[1,0,0] op_sel_hi:[1,1,1]
    v_pk_fma_f32 v[12:13], v[182:183], v[172:173], v[12:13] op_sel:[1,0,0] op_sel_hi:[1,1,1]
    v_pk_fma_f32 v[14:15], v[182:183], v[174:175], v[14:15] op_sel:[1,0,0] op_sel_hi:[1,1,1]
    s_set_gpr_idx_off
    s_cbranch_scc1 L_exit
    s_setprio 2
    s_waitcnt vmcnt(4)
    v_mfma_f32_4x4x4_16b_bf16 v[144:147], v[188:189], v[48:49], 0 cbsz:4 abid:8
    v_exp_f32 v176, v88
    v_mfma_f32_4x4x4_16b_bf16 v[148:151], v[188:189], v[50:51], 0 cbsz:4 abid:8
    v_exp_f32 v180, v104
    v_mfma_f32_4x4x4_16b_bf16 v[152:155], v[188:189], v[52:53], 0 cbsz:4 abid:9
    v_exp_f32 v177, v89
    v_mfma_f32_4x4x4_16b_bf16 v[156:159], v[188:189], v[54:55], 0 cbsz:4 abid:9
    v_exp_f32 v181, v105
    v_mfma_f32_4x4x4_16b_bf16 v[160:163], v[188:189], v[56:57], 0 cbsz:4 abid:10
    v_exp_f32 v178, v90
    v_mfma_f32_4x4x4_16b_bf16 v[164:167], v[188:189], v[58:59], 0 cbsz:4 abid:10
    v_exp_f32 v182, v106
    v_mfma_f32_4x4x4_16b_bf16 v[168:171], v[188:189], v[60:61], 0 cbsz:4 abid:11
    v_exp_f32 v179, v91
    v_mfma_f32_4x4x4_16b_bf16 v[172:175], v[188:189], v[62:63], 0 cbsz:4 abid:11
    v_exp_f32 v183, v107
    v_readlane_b32 s64, v228, 3
    v_readlane_b32 s65, v228, 7
    v_readlane_b32 s66, v228, 11
    v_readlane_b32 s67, v228, 15
    v_and_or_b32 v229, v2, s33, v233
    s_and_b32 s80, s64, s31
    v_pk_fma_f32 v[176:177], v[176:177], s[56:57], s[56:57]
    s_and_b32 s81, s65, s31
    v_pk_fma_f32 v[178:179], v[178:179], s[56:57], s[56:57]
    s_and_b32 s82, s66, s31
    v_pk_fma_f32 v[180:181], v[180:181], s[56:57], s[56:57]
    s_and_b32 s83, s67, s31
    v_pk_fma_f32 v[182:183], v[182:183], s[56:57], s[56:57]
    v_mfma_f32_32x32x16_bf16 v[112:127], v[196:199], v[208:211], v[112:127]
    v_rcp_f32 v176, v176
    v_rcp_f32 v177, v177
    v_rcp_f32 v178, v178
    v_rcp_f32 v179, v179
    v_rcp_f32 v180, v180
    buffer_load_dwordx4 v[48:51], v232, s[4:7], s80 offen
    v_rcp_f32 v181, v181
    buffer_load_dwordx4 v[52:55], v232, s[4:7], s81 offen
    v_rcp_f32 v182, v182
    buffer_load_dwordx4 v[56:59], v232, s[4:7], s82 offen
    v_rcp_f32 v183, v183
    buffer_load_dwordx4 v[60:63], v232, s[4:7], s83 offen
    s_cmp_le_i32 s30, 44
    s_mov_b64 exec, s[20:21]
    ds_read_b128 v[192:195], v229 offset:46080
    s_mov_b64 exec, -1
    v_pk_mul_f32 v[176:177], v[176:177], v[88:89]
    v_pk_mul_f32 v[178:179], v[178:179], v[90:91]
    v_pk_mul_f32 v[180:181], v[180:181], v[104:105]
    v_pk_mul_f32 v[182:183], v[182:183], v[106:107]
    s_set_gpr_idx_on s72, gpr_idx(SRC2,DST)
    v_pk_fma_f32 v[8:9], v[176:177], v[144:145], v[8:9] op_sel:[0,0,0] op_sel_hi:[0,1,1]
    v_pk_fma_f32 v[10:11], v[176:177], v[146:147], v[10:11] op_sel:[0,0,0] op_sel_hi:[0,1,1]
    v_pk_fma_f32 v[12:13], v[180:181], v[148:149], v[12:13] op_sel:[0,0,0] op_sel_hi:[0,1,1]
    v_pk_fma_f32 v[14:15], v[180:181], v[150:151], v[14:15] op_sel:[0,0,0] op_sel_hi:[0,1,1]
    s_set_gpr_idx_idx s73
    v_pk_fma_f32 v[8:9], v[176:177], v[152:153], v[8:9] op_sel:[1,0,0] op_sel_hi:[1,1,1]
    v_pk_fma_f32 v[10:11], v[176:177], v[154:155], v[10:11] op_sel:[1,0,0] op_sel_hi:[1,1,1]
    v_pk_fma_f32 v[12:13], v[180:181], v[156:157], v[12:13] op_sel:[1,0,0] op_sel_hi:[1,1,1]
    v_pk_fma_f32 v[14:15], v[180:181], v[158:159], v[14:15] op_sel:[1,0,0] op_sel_hi:[1,1,1]
    s_set_gpr_idx_idx s74
    v_pk_fma_f32 v[8:9], v[178:179], v[160:161], v[8:9] op_sel:[0,0,0] op_sel_hi:[0,1,1]
    v_pk_fma_f32 v[10:11], v[178:179], v[162:163], v[10:11] op_sel:[0,0,0] op_sel_hi:[0,1,1]
    v_pk_fma_f32 v[12:13], v[182:183], v[164:165], v[12:13] op_sel:[0,0,0] op_sel_hi:[0,1,1]
    v_pk_fma_f32 v[14:15], v[182:183], v[166:167], v[14:15] op_sel:[0,0,0] op_sel_hi:[0,1,1]
    s_set_gpr_idx_idx s75
    v_pk_fma_f32 v[8:9], v[178:179], v[168:169], v[8:9] op_sel:[1,0,0] op_sel_hi:[1,1,1]
    v_pk_fma_f32 v[10:11], v[178:179], v[170:171], v[10:11] op_sel:[1,0,0] op_sel_hi:[1,1,1]
    v_pk_fma_f32 v[12:13], v[182:183], v[172:173], v[12:13] op_sel:[1,0,0] op_sel_hi:[1,1,1]
    v_pk_fma_f32 v[14:15], v[182:183], v[174:175], v[14:15] op_sel:[1,0,0] op_sel_hi:[1,1,1]
    s_set_gpr_idx_off
    s_cbranch_scc1 L_exit
    s_waitcnt vmcnt(4)
    v_mfma_f32_4x4x4_16b_bf16 v[144:147], v[188:189], v[64:65], 0 cbsz:4 abid:12
    v_exp_f32 v176, v92
    v_mfma_f32_4x4x4_16b_bf16 v[148:151], v[188:189], v[66:67], 0 cbsz:4 abid:12
    v_exp_f32 v180, v108
    v_mfma_f32_4x4x4_16b_bf16 v[152:155], v[188:189], v[68:69], 0 cbsz:4 abid:13
    v_exp_f32 v177, v93
    v_mfma_f32_4x4x4_16b_bf16 v[156:159], v[188:189], v[70:71], 0 cbsz:4 abid:13
    v_exp_f32 v181, v109
    v_mfma_f32_4x4x4_16b_bf16 v[160:163], v[188:189], v[72:73], 0 cbsz:4 abid:14
    v_exp_f32 v178, v94
    v_mfma_f32_4x4x4_16b_bf16 v[164:167], v[188:189], v[74:75], 0 cbsz:4 abid:14
    v_exp_f32 v182, v110
    v_mfma_f32_4x4x4_16b_bf16 v[168:171], v[188:189], v[76:77], 0 cbsz:4 abid:15
    v_exp_f32 v179, v95
    v_mfma_f32_4x4x4_16b_bf16 v[172:175], v[188:189], v[78:79], 0 cbsz:4 abid:15
    v_exp_f32 v183, v111
    v_readlane_b32 s68, v228, 19
    v_readlane_b32 s69, v228, 23
    v_readlane_b32 s70, v228, 27
    v_readlane_b32 s71, v228, 31
    s_and_b32 s80, s68, s31
    v_pk_fma_f32 v[176:177], v[176:177], s[56:57], s[56:57]
    s_and_b32 s81, s69, s31
    v_pk_fma_f32 v[178:179], v[178:179], s[56:57], s[56:57]
    s_and_b32 s82, s70, s31
    v_pk_fma_f32 v[180:181], v[180:181], s[56:57], s[56:57]
    s_and_b32 s83, s71, s31
    v_pk_fma_f32 v[182:183], v[182:183], s[56:57], s[56:57]
    v_mfma_f32_32x32x16_bf16 v[128:143], v[196:199], v[212:215], v[128:143]
    v_rcp_f32 v176, v176
    v_rcp_f32 v177, v177
    v_rcp_f32 v178, v178
    v_rcp_f32 v179, v179
    v_rcp_f32 v180, v180
    buffer_load_dwordx4 v[64:67], v232, s[4:7], s80 offen
    v_rcp_f32 v181, v181
    buffer_load_dwordx4 v[68:71], v232, s[4:7], s81 offen
    v_rcp_f32 v182, v182
    buffer_load_dwordx4 v[72:75], v232, s[4:7], s82 offen
    v_rcp_f32 v183, v183
    buffer_load_dwordx4 v[76:79], v232, s[4:7], s83 offen
    s_cmp_le_i32 s30, 48
    s_waitcnt lgkmcnt(0)
    v_pk_mul_f32 v[176:177], v[176:177], v[92:93]
    v_pk_mul_f32 v[178:179], v[178:179], v[94:95]
    v_pk_mul_f32 v[180:181], v[180:181], v[108:109]
    v_pk_mul_f32 v[182:183], v[182:183], v[110:111]
    s_set_gpr_idx_on s76, gpr_idx(SRC2,DST)
    v_pk_fma_f32 v[8:9], v[176:177], v[144:145], v[8:9] op_sel:[0,0,0] op_sel_hi:[0,1,1]
    v_pk_fma_f32 v[10:11], v[176:177], v[146:147], v[10:11] op_sel:[0,0,0] op_sel_hi:[0,1,1]
    v_pk_fma_f32 v[12:13], v[180:181], v[148:149], v[12:13] op_sel:[0,0,0] op_sel_hi:[0,1,1]
    v_pk_fma_f32 v[14:15], v[180:181], v[150:151], v[14:15] op_sel:[0,0,0] op_sel_hi:[0,1,1]
    s_set_gpr_idx_idx s77
    v_pk_fma_f32 v[8:9], v[176:177], v[152:153], v[8:9] op_sel:[1,0,0] op_sel_hi:[1,1,1]
    v_pk_fma_f32 v[10:11], v[176:177], v[154:155], v[10:11] op_sel:[1,0,0] op_sel_hi:[1,1,1]
    v_pk_fma_f32 v[12:13], v[180:181], v[156:157], v[12:13] op_sel:[1,0,0] op_sel_hi:[1,1,1]
    v_pk_fma_f32 v[14:15], v[180:181], v[158:159], v[14:15] op_sel:[1,0,0] op_sel_hi:[1,1,1]
    s_set_gpr_idx_idx s78
    v_pk_fma_f32 v[8:9], v[178:179], v[160:161], v[8:9] op_sel:[0,0,0] op_sel_hi:[0,1,1]
    v_pk_fma_f32 v[10:11], v[178:179], v[162:163], v[10:11] op_sel:[0,0,0] op_sel_hi:[0,1,1]
    v_pk_fma_f32 v[12:13], v[182:183], v[164:165], v[12:13] op_sel:[0,0,0] op_sel_hi:[0,1,1]
    v_pk_fma_f32 v[14:15], v[182:183], v[166:167], v[14:15] op_sel:[0,0,0] op_sel_hi:[0,1,1]
    s_set_gpr_idx_idx s79
    v_pk_fma_f32 v[8:9], v[178:179], v[168:169], v[8:9] op_sel:[1,0,0] op_sel_hi:[1,1,1]
    v_pk_fma_f32 v[10:11], v[178:179], v[170:171], v[10:11] op_sel:[1,0,0] op_sel_hi:[1,1,1]
    v_pk_fma_f32 v[12:13], v[182:183], v[172:173], v[12:13] op_sel:[1,0,0] op_sel_hi:[1,1,1]
    v_pk_fma_f32 v[14:15], v[182:183], v[174:175], v[14:15] op_sel:[1,0,0] op_sel_hi:[1,1,1]
    s_set_gpr_idx_off
    s_cbranch_scc1 L_exit
    s_setprio 1
    s_waitcnt vmcnt(4)
    v_mfma_f32_4x4x4_16b_bf16 v[144:147], v[190:191], v[48:49], 0 cbsz:4 abid:0
    v_exp_f32 v176, v112
    v_mfma_f32_4x4x4_16b_bf16 v[148:151], v[190:191], v[50:51], 0 cbsz:4 abid:0
    v_exp_f32 v180, v128
    v_mfma_f32_4x4x4_16b_bf16 v[152:155], v[190:191], v[52:53], 0 cbsz:4 abid:1
    v_exp_f32 v177, v113
    v_mfma_f32_4x4x4_16b_bf16 v[156:159], v[190:191], v[54:55], 0 cbsz:4 abid:1
    v_exp_f32 v181, v129
    v_mfma_f32_4x4x4_16b_bf16 v[160:163], v[190:191], v[56:57], 0 cbsz:4 abid:2
    v_exp_f32 v178, v114
    v_mfma_f32_4x4x4_16b_bf16 v[164:167], v[190:191], v[58:59], 0 cbsz:4 abid:2
    v_exp_f32 v182, v130
    v_mfma_f32_4x4x4_16b_bf16 v[168:171], v[190:191], v[60:61], 0 cbsz:4 abid:3
    v_exp_f32 v179, v115
    v_mfma_f32_4x4x4_16b_bf16 v[172:175], v[190:191], v[62:63], 0 cbsz:4 abid:3
    v_exp_f32 v183, v131
    v_readlane_b32 s72, v228, 35
    v_readlane_b32 s73, v228, 39
    v_readlane_b32 s74, v228, 43
    v_readlane_b32 s75, v228, 47
    s_and_b32 s80, s72, s31
    v_pk_fma_f32 v[176:177], v[176:177], s[56:57], s[56:57]
    s_and_b32 s81, s73, s31
    v_pk_fma_f32 v[178:179], v[178:179], s[56:57], s[56:57]
    s_and_b32 s82, s74, s31
    v_pk_fma_f32 v[180:181], v[180:181], s[56:57], s[56:57]
    s_and_b32 s83, s75, s31
    v_pk_fma_f32 v[182:183], v[182:183], s[56:57], s[56:57]
    v_mfma_f32_32x32x16_bf16 v[80:95], v[192:195], v[200:203], 0
    v_rcp_f32 v176, v176
    v_rcp_f32 v177, v177
    v_rcp_f32 v178, v178
    v_rcp_f32 v179, v179
    v_rcp_f32 v180, v180
    buffer_load_dwordx4 v[48:51], v232, s[4:7], s80 offen
    v_rcp_f32 v181, v181
    buffer_load_dwordx4 v[52:55], v232, s[4:7], s81 offen
    v_rcp_f32 v182, v182
    buffer_load_dwordx4 v[56:59], v232, s[4:7], s82 offen
    v_rcp_f32 v183, v183
    buffer_load_dwordx4 v[60:63], v232, s[4:7], s83 offen
    s_cmp_le_i32 s30, 52
    s_mov_b64 exec, s[22:23]
    ds_read_b128 v[196:199], v229 offset:46080
    s_mov_b64 exec, -1
    ds_read_b32 v2, v231 offset:1292
    v_pk_mul_f32 v[176:177], v[176:177], v[112:113]
    v_pk_mul_f32 v[178:179], v[178:179], v[114:115]
    v_pk_mul_f32 v[180:181], v[180:181], v[128:129]
    v_pk_mul_f32 v[182:183], v[182:183], v[130:131]
    s_set_gpr_idx_on s64, gpr_idx(SRC2,DST)
    v_pk_fma_f32 v[8:9], v[176:177], v[144:145], v[8:9] op_sel:[0,0,0] op_sel_hi:[0,1,1]
    v_pk_fma_f32 v[10:11], v[176:177], v[146:147], v[10:11] op_sel:[0,0,0] op_sel_hi:[0,1,1]
    v_pk_fma_f32 v[12:13], v[180:181], v[148:149], v[12:13] op_sel:[0,0,0] op_sel_hi:[0,1,1]
    v_pk_fma_f32 v[14:15], v[180:181], v[150:151], v[14:15] op_sel:[0,0,0] op_sel_hi:[0,1,1]
    s_set_gpr_idx_idx s65
    v_pk_fma_f32 v[8:9], v[176:177], v[152:153], v[8:9] op_sel:[1,0,0] op_sel_hi:[1,1,1]
    v_pk_fma_f32 v[10:11], v[176:177], v[154:155], v[10:11] op_sel:[1,0,0] op_sel_hi:[1,1,1]
    v_pk_fma_f32 v[12:13], v[180:181], v[156:157], v[12:13] op_sel:[1,0,0] op_sel_hi:[1,1,1]
    v_pk_fma_f32 v[14:15], v[180:181], v[158:159], v[14:15] op_sel:[1,0,0] op_sel_hi:[1,1,1]
    s_set_gpr_idx_idx s66
    v_pk_fma_f32 v[8:9], v[178:179], v[160:161], v[8:9] op_sel:[0,0,0] op_sel_hi:[0,1,1]
    v_pk_fma_f32 v[10:11], v[178:179], v[162:163], v[10:11] op_sel:[0,0,0] op_sel_hi:[0,1,1]
    v_pk_fma_f32 v[12:13], v[182:183], v[164:165], v[12:13] op_sel:[0,0,0] op_sel_hi:[0,1,1]
    v_pk_fma_f32 v[14:15], v[182:183], v[166:167], v[14:15] op_sel:[0,0,0] op_sel_hi:[0,1,1]
    s_set_gpr_idx_idx s67
    v_pk_fma_f32 v[8:9], v[178:179], v[168:169], v[8:9] op_sel:[1,0,0] op_sel_hi:[1,1,1]
    v_pk_fma_f32 v[10:11], v[178:179], v[170:171], v[10:11] op_sel:[1,0,0] op_sel_hi:[1,1,1]
    v_pk_fma_f32 v[12:13], v[182:183], v[172:173], v[12:13] op_sel:[1,0,0] op_sel_hi:[1,1,1]
    v_pk_fma_f32 v[14:15], v[182:183], v[174:175], v[14:15] op_sel:[1,0,0] op_sel_hi:[1,1,1]
    s_set_gpr_idx_off
    s_cbranch_scc1 L_exit
    s_waitcnt vmcnt(4)
    v_mfma_f32_4x4x4_16b_bf16 v[144:147], v[190:191], v[64:65], 0 cbsz:4 abid:4
    v_exp_f32 v176, v116
    v_mfma_f32_4x4x4_16b_bf16 v[148:151], v[190:191], v[66:67], 0 cbsz:4 abid:4
    v_exp_f32 v180, v132
    v_mfma_f32_4x4x4_16b_bf16 v[152:155], v[190:191], v[68:69], 0 cbsz:4 abid:5
    v_exp_f32 v177, v117
    v_mfma_f32_4x4x4_16b_bf16 v[156:159], v[190:191], v[70:71], 0 cbsz:4 abid:5
    v_exp_f32 v181, v133
    v_mfma_f32_4x4x4_16b_bf16 v[160:163], v[190:191], v[72:73], 0 cbsz:4 abid:6
    v_exp_f32 v178, v118
    v_mfma_f32_4x4x4_16b_bf16 v[164:167], v[190:191], v[74:75], 0 cbsz:4 abid:6
    v_exp_f32 v182, v134
    v_mfma_f32_4x4x4_16b_bf16 v[168:171], v[190:191], v[76:77], 0 cbsz:4 abid:7
    v_exp_f32 v179, v119
    v_mfma_f32_4x4x4_16b_bf16 v[172:175], v[190:191], v[78:79], 0 cbsz:4 abid:7
    v_exp_f32 v183, v135
    v_readlane_b32 s76, v228, 51
    v_readlane_b32 s77, v228, 55
    v_readlane_b32 s78, v228, 59
    v_readlane_b32 s79, v228, 63
    s_and_b32 s80, s76, s31
    v_pk_fma_f32 v[176:177], v[176:177], s[56:57], s[56:57]
    s_and_b32 s81, s77, s31
    v_pk_fma_f32 v[178:179], v[178:179], s[56:57], s[56:57]
    s_and_b32 s82, s78, s31
    v_pk_fma_f32 v[180:181], v[180:181], s[56:57], s[56:57]
    s_and_b32 s83, s79, s31
    v_pk_fma_f32 v[182:183], v[182:183], s[56:57], s[56:57]
    v_mfma_f32_32x32x16_bf16 v[96:111], v[192:195], v[204:207], 0
    v_rcp_f32 v176, v176
    v_rcp_f32 v177, v177
    v_rcp_f32 v178, v178
    v_rcp_f32 v179, v179
    v_rcp_f32 v180, v180
    buffer_load_dwordx4 v[64:67], v232, s[4:7], s80 offen
    v_rcp_f32 v181, v181
    buffer_load_dwordx4 v[68:71], v232, s[4:7], s81 offen
    v_rcp_f32 v182, v182
    buffer_load_dwordx4 v[72:75], v232, s[4:7], s82 offen
    v_rcp_f32 v183, v183
    buffer_load_dwordx4 v[76:79], v232, s[4:7], s83 offen
    s_cmp_le_i32 s30, 56
    s_waitcnt lgkmcnt(0)
    v_pk_mul_f32 v[176:177], v[176:177], v[116:117]
    v_pk_mul_f32 v[178:179], v[178:179], v[118:119]
    v_pk_mul_f32 v[180:181], v[180:181], v[132:133]
    v_pk_mul_f32 v[182:183], v[182:183], v[134:135]
    s_set_gpr_idx_on s68, gpr_idx(SRC2,DST)
    v_pk_fma_f32 v[8:9], v[176:177], v[144:145], v[8:9] op_sel:[0,0,0] op_sel_hi:[0,1,1]
    v_pk_fma_f32 v[10:11], v[176:177], v[146:147], v[10:11] op_sel:[0,0,0] op_sel_hi:[0,1,1]
    v_pk_fma_f32 v[12:13], v[180:181], v[148:149], v[12:13] op_sel:[0,0,0] op_sel_hi:[0,1,1]
    v_pk_fma_f32 v[14:15], v[180:181], v[150:151], v[14:15] op_sel:[0,0,0] op_sel_hi:[0,1,1]
    s_set_gpr_idx_idx s69
    v_pk_fma_f32 v[8:9], v[176:177], v[152:153], v[8:9] op_sel:[1,0,0] op_sel_hi:[1,1,1]
    v_pk_fma_f32 v[10:11], v[176:177], v[154:155], v[10:11] op_sel:[1,0,0] op_sel_hi:[1,1,1]
    v_pk_fma_f32 v[12:13], v[180:181], v[156:157], v[12:13] op_sel:[1,0,0] op_sel_hi:[1,1,1]
    v_pk_fma_f32 v[14:15], v[180:181], v[158:159], v[14:15] op_sel:[1,0,0] op_sel_hi:[1,1,1]
    s_set_gpr_idx_idx s70
    v_pk_fma_f32 v[8:9], v[178:179], v[160:161], v[8:9] op_sel:[0,0,0] op_sel_hi:[0,1,1]
    v_pk_fma_f32 v[10:11], v[178:179], v[162:163], v[10:11] op_sel:[0,0,0] op_sel_hi:[0,1,1]
    v_pk_fma_f32 v[12:13], v[182:183], v[164:165], v[12:13] op_sel:[0,0,0] op_sel_hi:[0,1,1]
    v_pk_fma_f32 v[14:15], v[182:183], v[166:167], v[14:15] op_sel:[0,0,0] op_sel_hi:[0,1,1]
    s_set_gpr_idx_idx s71
    v_pk_fma_f32 v[8:9], v[178:179], v[168:169], v[8:9] op_sel:[1,0,0] op_sel_hi:[1,1,1]
    v_pk_fma_f32 v[10:11], v[178:179], v[170:171], v[10:11] op_sel:[1,0,0] op_sel_hi:[1,1,1]
    v_pk_fma_f32 v[12:13], v[182:183], v[172:173], v[12:13] op_sel:[1,0,0] op_sel_hi:[1,1,1]
    v_pk_fma_f32 v[14:15], v[182:183], v[174:175], v[14:15] op_sel:[1,0,0] op_sel_hi:[1,1,1]
    s_set_gpr_idx_off
    s_cbranch_scc1 L_exit
    s_setprio 0
    v_cndmask_b32 v228, v4, v226, s[34:35]
    s_waitcnt vmcnt(4)
    v_mfma_f32_4x4x4_16b_bf16 v[144:147], v[190:191], v[48:49], 0 cbsz:4 abid:8
    v_exp_f32 v176, v120
    v_mfma_f32_4x4x4_16b_bf16 v[148:151], v[190:191], v[50:51], 0 cbsz:4 abid:8
    v_exp_f32 v180, v136
    v_mfma_f32_4x4x4_16b_bf16 v[152:155], v[190:191], v[52:53], 0 cbsz:4 abid:9
    v_exp_f32 v177, v121
    v_mfma_f32_4x4x4_16b_bf16 v[156:159], v[190:191], v[54:55], 0 cbsz:4 abid:9
    v_exp_f32 v181, v137
    v_mfma_f32_4x4x4_16b_bf16 v[160:163], v[190:191], v[56:57], 0 cbsz:4 abid:10
    v_exp_f32 v178, v122
    v_mfma_f32_4x4x4_16b_bf16 v[164:167], v[190:191], v[58:59], 0 cbsz:4 abid:10
    v_exp_f32 v182, v138
    v_mfma_f32_4x4x4_16b_bf16 v[168:171], v[190:191], v[60:61], 0 cbsz:4 abid:11
    v_exp_f32 v179, v123
    v_mfma_f32_4x4x4_16b_bf16 v[172:175], v[190:191], v[62:63], 0 cbsz:4 abid:11
    v_exp_f32 v183, v139
    v_readlane_b32 s64, v228, 0
    v_readlane_b32 s65, v228, 4
    v_readlane_b32 s66, v228, 8
    v_readlane_b32 s67, v228, 12
    v_and_or_b32 v229, v2, s33, v233
    s_and_b32 s80, s64, s31
    v_pk_fma_f32 v[176:177], v[176:177], s[56:57], s[56:57]
    s_and_b32 s81, s65, s31
    v_pk_fma_f32 v[178:179], v[178:179], s[56:57], s[56:57]
    s_and_b32 s82, s66, s31
    v_pk_fma_f32 v[180:181], v[180:181], s[56:57], s[56:57]
    s_and_b32 s83, s67, s31
    v_pk_fma_f32 v[182:183], v[182:183], s[56:57], s[56:57]
    v_mfma_f32_32x32x16_bf16 v[80:95], v[196:199], v[208:211], v[80:95]
    v_rcp_f32 v176, v176
    v_rcp_f32 v177, v177
    v_rcp_f32 v178, v178
    v_rcp_f32 v179, v179
    v_rcp_f32 v180, v180
    buffer_load_dwordx4 v[48:51], v232, s[4:7], s80 offen
    v_rcp_f32 v181, v181
    buffer_load_dwordx4 v[52:55], v232, s[4:7], s81 offen
    v_rcp_f32 v182, v182
    buffer_load_dwordx4 v[56:59], v232, s[4:7], s82 offen
    v_rcp_f32 v183, v183
    buffer_load_dwordx4 v[60:63], v232, s[4:7], s83 offen
    s_cmp_le_i32 s30, 60
    s_mov_b64 exec, s[20:21]
    ds_read_b128 v[192:195], v229 offset:46080
    s_mov_b64 exec, -1
    v_pk_mul_f32 v[176:177], v[176:177], v[120:121]
    v_pk_mul_f32 v[178:179], v[178:179], v[122:123]
    v_pk_mul_f32 v[180:181], v[180:181], v[136:137]
    v_pk_mul_f32 v[182:183], v[182:183], v[138:139]
    s_set_gpr_idx_on s72, gpr_idx(SRC2,DST)
    v_pk_fma_f32 v[8:9], v[176:177], v[144:145], v[8:9] op_sel:[0,0,0] op_sel_hi:[0,1,1]
    v_pk_fma_f32 v[10:11], v[176:177], v[146:147], v[10:11] op_sel:[0,0,0] op_sel_hi:[0,1,1]
    v_pk_fma_f32 v[12:13], v[180:181], v[148:149], v[12:13] op_sel:[0,0,0] op_sel_hi:[0,1,1]
    v_pk_fma_f32 v[14:15], v[180:181], v[150:151], v[14:15] op_sel:[0,0,0] op_sel_hi:[0,1,1]
    s_set_gpr_idx_idx s73
    v_pk_fma_f32 v[8:9], v[176:177], v[152:153], v[8:9] op_sel:[1,0,0] op_sel_hi:[1,1,1]
    v_pk_fma_f32 v[10:11], v[176:177], v[154:155], v[10:11] op_sel:[1,0,0] op_sel_hi:[1,1,1]
    v_pk_fma_f32 v[12:13], v[180:181], v[156:157], v[12:13] op_sel:[1,0,0] op_sel_hi:[1,1,1]
    v_pk_fma_f32 v[14:15], v[180:181], v[158:159], v[14:15] op_sel:[1,0,0] op_sel_hi:[1,1,1]
    s_set_gpr_idx_idx s74
    v_pk_fma_f32 v[8:9], v[178:179], v[160:161], v[8:9] op_sel:[0,0,0] op_sel_hi:[0,1,1]
    v_pk_fma_f32 v[10:11], v[178:179], v[162:163], v[10:11] op_sel:[0,0,0] op_sel_hi:[0,1,1]
    v_pk_fma_f32 v[12:13], v[182:183], v[164:165], v[12:13] op_sel:[0,0,0] op_sel_hi:[0,1,1]
    v_pk_fma_f32 v[14:15], v[182:183], v[166:167], v[14:15] op_sel:[0,0,0] op_sel_hi:[0,1,1]
    s_set_gpr_idx_idx s75
    v_pk_fma_f32 v[8:9], v[178:179], v[168:169], v[8:9] op_sel:[1,0,0] op_sel_hi:[1,1,1]
    v_pk_fma_f32 v[10:11], v[178:179], v[170:171], v[10:11] op_sel:[1,0,0] op_sel_hi:[1,1,1]
    v_pk_fma_f32 v[12:13], v[182:183], v[172:173], v[12:13] op_sel:[1,0,0] op_sel_hi:[1,1,1]
    v_pk_fma_f32 v[14:15], v[182:183], v[174:175], v[14:15] op_sel:[1,0,0] op_sel_hi:[1,1,1]
    s_set_gpr_idx_off
    s_cbranch_scc1 L_exit
    s_waitcnt vmcnt(4)
    v_mfma_f32_4x4x4_16b_bf16 v[144:147], v[190:191], v[64:65], 0 cbsz:4 abid:12
    v_exp_f32 v176, v124
    v_mfma_f32_4x4x4_16b_bf16 v[148:151], v[190:191], v[66:67], 0 cbsz:4 abid:12
    v_exp_f32 v180, v140
    v_mfma_f32_4x4x4_16b_bf16 v[152:155], v[190:191], v[68:69], 0 cbsz:4 abid:13
    v_exp_f32 v177, v125
    v_mfma_f32_4x4x4_16b_bf16 v[156:159], v[190:191], v[70:71], 0 cbsz:4 abid:13
    v_exp_f32 v181, v141
    v_mfma_f32_4x4x4_16b_bf16 v[160:163], v[190:191], v[72:73], 0 cbsz:4 abid:14
    v_exp_f32 v178, v126
    v_mfma_f32_4x4x4_16b_bf16 v[164:167], v[190:191], v[74:75], 0 cbsz:4 abid:14
    v_exp_f32 v182, v142
    v_mfma_f32_4x4x4_16b_bf16 v[168:171], v[190:191], v[76:77], 0 cbsz:4 abid:15
    v_exp_f32 v179, v127
    v_mfma_f32_4x4x4_16b_bf16 v[172:175], v[190:191], v[78:79], 0 cbsz:4 abid:15
    v_exp_f32 v183, v143
    v_readlane_b32 s68, v228, 16
    v_readlane_b32 s69, v228, 20
    v_readlane_b32 s70, v228, 24
    v_readlane_b32 s71, v228, 28
    s_and_b32 s80, s68, s31
    v_pk_fma_f32 v[176:177], v[176:177], s[56:57], s[56:57]
    s_and_b32 s81, s69, s31
    v_pk_fma_f32 v[178:179], v[178:179], s[56:57], s[56:57]
    s_and_b32 s82, s70, s31
    v_pk_fma_f32 v[180:181], v[180:181], s[56:57], s[56:57]
    s_and_b32 s83, s71, s31
    v_pk_fma_f32 v[182:183], v[182:183], s[56:57], s[56:57]
    v_mfma_f32_32x32x16_bf16 v[96:111], v[196:199], v[212:215], v[96:111]
    v_rcp_f32 v176, v176
    v_rcp_f32 v177, v177
    v_rcp_f32 v178, v178
    v_rcp_f32 v179, v179
    v_rcp_f32 v180, v180
    buffer_load_dwordx4 v[64:67], v232, s[4:7], s80 offen
    v_rcp_f32 v181, v181
    buffer_load_dwordx4 v[68:71], v232, s[4:7], s81 offen
    v_rcp_f32 v182, v182
    buffer_load_dwordx4 v[72:75], v232, s[4:7], s82 offen
    v_rcp_f32 v183, v183
    buffer_load_dwordx4 v[76:79], v232, s[4:7], s83 offen
    s_waitcnt lgkmcnt(0)
    v_pk_mul_f32 v[176:177], v[176:177], v[124:125]
    v_pk_mul_f32 v[178:179], v[178:179], v[126:127]
    v_pk_mul_f32 v[180:181], v[180:181], v[140:141]
    v_pk_mul_f32 v[182:183], v[182:183], v[142:143]
    s_set_gpr_idx_on s76, gpr_idx(SRC2,DST)
    v_pk_fma_f32 v[8:9], v[176:177], v[144:145], v[8:9] op_sel:[0,0,0] op_sel_hi:[0,1,1]
    v_pk_fma_f32 v[10:11], v[176:177], v[146:147], v[10:11] op_sel:[0,0,0] op_sel_hi:[0,1,1]
    v_pk_fma_f32 v[12:13], v[180:181], v[148:149], v[12:13] op_sel:[0,0,0] op_sel_hi:[0,1,1]
    v_pk_fma_f32 v[14:15], v[180:181], v[150:151], v[14:15] op_sel:[0,0,0] op_sel_hi:[0,1,1]
    s_set_gpr_idx_idx s77
    v_pk_fma_f32 v[8:9], v[176:177], v[152:153], v[8:9] op_sel:[1,0,0] op_sel_hi:[1,1,1]
    v_pk_fma_f32 v[10:11], v[176:177], v[154:155], v[10:11] op_sel:[1,0,0] op_sel_hi:[1,1,1]
    v_pk_fma_f32 v[12:13], v[180:181], v[156:157], v[12:13] op_sel:[1,0,0] op_sel_hi:[1,1,1]
    v_pk_fma_f32 v[14:15], v[180:181], v[158:159], v[14:15] op_sel:[1,0,0] op_sel_hi:[1,1,1]
    s_set_gpr_idx_idx s78
    v_pk_fma_f32 v[8:9], v[178:179], v[160:161], v[8:9] op_sel:[0,0,0] op_sel_hi:[0,1,1]
    v_pk_fma_f32 v[10:11], v[178:179], v[162:163], v[10:11] op_sel:[0,0,0] op_sel_hi:[0,1,1]
    v_pk_fma_f32 v[12:13], v[182:183], v[164:165], v[12:13] op_sel:[0,0,0] op_sel_hi:[0,1,1]
    v_pk_fma_f32 v[14:15], v[182:183], v[166:167], v[14:15] op_sel:[0,0,0] op_sel_hi:[0,1,1]
    s_set_gpr_idx_idx s79
    v_pk_fma_f32 v[8:9], v[178:179], v[168:169], v[8:9] op_sel:[1,0,0] op_sel_hi:[1,1,1]
    v_pk_fma_f32 v[10:11], v[178:179], v[170:171], v[10:11] op_sel:[1,0,0] op_sel_hi:[1,1,1]
    v_pk_fma_f32 v[12:13], v[182:183], v[172:173], v[12:13] op_sel:[1,0,0] op_sel_hi:[1,1,1]
    v_pk_fma_f32 v[14:15], v[182:183], v[174:175], v[14:15] op_sel:[1,0,0] op_sel_hi:[1,1,1]
    s_set_gpr_idx_off
    v_add_u32 v231, 1024, v231
    s_sub_u32 s30, s30, 64
    s_branch L_sb
L_exit:
    s_setprio 0
    s_add_u32 s24, s24, 216
    s_cmp_lt_u32 s24, s25
    s_cbranch_scc0 L_epi
    v_lshlrev_b32 v7, 3, v0
    v_mov_b32 v2, 0
    v_mov_b32 v3, 0
    ds_write_b64 v7, v[2:3]
    s_waitcnt vmcnt(0) lgkmcnt(0)
    s_nop 15
    s_mul_i32 s26, s16, 5
    v_add_u32 v113, s26, v1
    v_subrev_u32 v3, 40, v113
    v_min_u32 v113, v113, v3
    v_mul_u32_u24 v3, 205, v1
    v_lshrrev_b32 v3, 10, v3
    v_mul_u32_u24 v2, 5, v3
    v_sub_u32 v115, v1, v2
    v_lshlrev_b32 v114, 2, v3
    s_lshl_b32 s81, s16, 10
    s_add_u32 s81, s81, 8192
    s_mul_i32 s80, s16, 6912
    v_lshl_add_u32 v121, v1, 2, s81
    v_lshrrev_b32 v3, 1, v1
    v_lshl_add_u32 v122, v3, 2, s81
    v_and_b32 v2, 1, v1
    v_lshlrev_b32 v123, 4, v2
    v_lshrrev_b32 v3, 1, v0
    v_mul_u32_u24 v3, 1280, v3
    v_add_u32 v124, v3, v2
    v_mul_u32_u24 v125, 48, v113
    s_lshl_b32 s26, s16, 2
    v_lshl_add_u32 v126, v115, 5, s26
    v_lshl_add_u32 v127, v1, 5, s80
    v_mov_b32 v80, 0xffffff
    v_mov_b32 v81, 0xffffff
    v_mov_b32 v82, 0xffffff
    v_mov_b32 v83, 0xffffff
    v_add_u32 v2, s81, v232
    ds_write_b128 v2, v[80:83]
    s_barrier
    v_and_b32 v2, 1, v0
    v_max_u32 v3, s24, v235
    v_add_u32 v3, v3, v2
    s_add_u32 s27, s24, 216
    v_min_u32 v4, s27, v236
    v_add_u32 v5, v237, v3
    s_lshl_b32 s27, s24, 2
    s_sub_u32 s27, s81, s27
    v_lshl_add_u32 v6, v3, 2, s27
    v_sub_u32 v4, v4, v3
    s_branch L_exp
L_exp_more:
    v_add_u32 v6, 48, v6
    v_subrev_u32 v4, 12, v4
    s_branch L_exp
L_epi:
    s_waitcnt lgkmcnt(0)
    v_readfirstlane_b32 s38, v243
    v_lshlrev_b32 v2, 2, v1
    v_add_u32 v3, s48, v2
    v_cvt_pk_bf16_f32 v8, v8, v12
    v_cvt_pk_bf16_f32 v9, v9, v13
    v_cvt_pk_bf16_f32 v10, v10, v14
    v_cvt_pk_bf16_f32 v11, v11, v15
    ds_write2_b32 v3, v8, v9 offset0:0 offset1:72
    ds_write2_b32 v3, v10, v11 offset0:144 offset1:216
    v_add_u32 v3, s49, v2
    v_cvt_pk_bf16_f32 v16, v16, v20
    v_cvt_pk_bf16_f32 v17, v17, v21
    v_cvt_pk_bf16_f32 v18, v18, v22
    v_cvt_pk_bf16_f32 v19, v19, v23
    ds_write2_b32 v3, v16, v17 offset0:0 offset1:72
    ds_write2_b32 v3, v18, v19 offset0:144 offset1:216
    v_add_u32 v3, s50, v2
    v_cvt_pk_bf16_f32 v24, v24, v28
    v_cvt_pk_bf16_f32 v25, v25, v29
    v_cvt_pk_bf16_f32 v26, v26, v30
    v_cvt_pk_bf16_f32 v27, v27, v31
    ds_write2_b32 v3, v24, v25 offset0:0 offset1:72
    ds_write2_b32 v3, v26, v27 offset0:144 offset1:216
    v_add_u32 v3, s51, v2
    v_cvt_pk_bf16_f32 v32, v32, v36
    v_cvt_pk_bf16_f32 v33, v33, v37
    v_cvt_pk_bf16_f32 v34, v34, v38
    v_cvt_pk_bf16_f32 v35, v35, v39
    ds_write2_b32 v3, v32, v33 offset0:0 offset1:72
    ds_write2_b32 v3, v34, v35 offset0:144 offset1:216
    v_add_u32 v3, s52, v2
    v_cvt_pk_bf16_f32 v40, v40, v44
    v_cvt_pk_bf16_f32 v41, v41, v45
    v_cvt_pk_bf16_f32 v42, v42, v46
    v_cvt_pk_bf16_f32 v43, v43, v47
    ds_write2_b32 v3, v40, v41 offset0:0 offset1:72
    ds_write2_b32 v3, v42, v43 offset0:144 offset1:216
    s_cmp_eq_u32 s38, 8
    s_cbranch_scc0 L_nob
    ds_read_b128 v[192:195], v240 offset:0
    ds_read_b128 v[208:211], v240 offset:256
    ds_read_b128 v[196:199], v240 offset:8192
    ds_read_b128 v[212:215], v240 offset:8448
    ds_read_b128 v[200:203], v240 offset:16384
    ds_read_b128 v[216:219], v240 offset:16640
    ds_read_b128 v[204:207], v240 offset:24576
    ds_read_b128 v[220:223], v240 offset:24832
    s_waitcnt lgkmcnt(8)
    s_barrier
    s_branch L_haveb
L_nob:
    s_waitcnt lgkmcnt(0)
    s_barrier
    ds_read_b128 v[192:195], v240 offset:0
    ds_read_b128 v[208:211], v240 offset:256
    ds_read_b128 v[196:199], v240 offset:8192
    ds_read_b128 v[212:215], v240 offset:8448
    ds_read_b128 v[200:203], v240 offset:16384
    ds_read_b128 v[216:219], v240 offset:16640
    ds_read_b128 v[204:207], v240 offset:24576
    ds_read_b128 v[220:223], v240 offset:24832
L_haveb:
    ds_read_b128 v[80:83], v241 offset:0
    ds_read_b128 v[84:87], v241 offset:64
    ds_read_b128 v[88:91], v241 offset:128
    ds_read_b128 v[92:95], v241 offset:192
    ds_read_b128 v[96:99], v241 offset:4608
    ds_read_b128 v[100:103], v241 offset:4672
    ds_read_b128 v[104:107], v241 offset:4736
    ds_read_b128 v[108:111], v241 offset:4800
    ds_read_b128 v[112:115], v241 offset:9216
    ds_read_b128 v[116:119], v241 offset:9280
    ds_read_b128 v[120:123], v241 offset:9344
    ds_read_b128 v[124:127], v241 offset:9408
    s_waitcnt lgkmcnt(11)
    v_mfma_f32_16x16x32_bf16 v[8:11], v[80:83], v[192:195], 0
    v_mfma_f32_16x16x32_bf16 v[12:15], v[80:83], v[208:211], 0
    ds_read_b128 v[128:131], v241 offset:13824
    ds_read_b128 v[132:135], v241 offset:13888
    ds_read_b128 v[136:139], v241 offset:13952
    ds_read_b128 v[140:143], v241 offset:14016
    s_waitcnt lgkmcnt(14)
    v_mfma_f32_16x16x32_bf16 v[8:11], v[84:87], v[196:199], v[8:11]
    v_mfma_f32_16x16x32_bf16 v[12:15], v[84:87], v[212:215], v[12:15]
    s_waitcnt lgkmcnt(13)
    v_mfma_f32_16x16x32_bf16 v[8:11], v[88:91], v[200:203], v[8:11]
    v_mfma_f32_16x16x32_bf16 v[12:15], v[88:91], v[216:219], v[12:15]
    s_waitcnt lgkmcnt(12)
    v_mfma_f32_16x16x32_bf16 v[8:11], v[92:95], v[204:207], v[8:11]
    v_mfma_f32_16x16x32_bf16 v[12:15], v[92:95], v[220:223], v[12:15]
    s_waitcnt lgkmcnt(11)
    v_mfma_f32_16x16x32_bf16 v[16:19], v[96:99], v[192:195], 0
    v_mfma_f32_16x16x32_bf16 v[20:23], v[96:99], v[208:211], 0
    ds_read_b128 v[144:147], v241 offset:18432
    ds_read_b128 v[148:151], v241 offset:18496
    ds_read_b128 v[152:155], v241 offset:18560
    ds_read_b128 v[156:159], v241 offset:18624
    s_waitcnt lgkmcnt(14)
    v_mfma_f32_16x16x32_bf16 v[16:19], v[100:103], v[196:199], v[16:19]
    v_mfma_f32_16x16x32_bf16 v[20:23], v[100:103], v[212:215], v[20:23]
    s_waitcnt lgkmcnt(13)
    v_mfma_f32_16x16x32_bf16 v[16:19], v[104:107], v[200:203], v[16:19]
    v_mfma_f32_16x16x32_bf16 v[20:23], v[104:107], v[216:219], v[20:23]
    v_cvt_pk_bf16_f32 v160, v8, v9
    v_cvt_pk_bf16_f32 v161, v10, v11
    v_cvt_pk_bf16_f32 v162, v12, v13
    v_cvt_pk_bf16_f32 v163, v14, v15
    buffer_store_dwordx4 v[160:163], v242, s[12:15], 0 offen sc1
    v_add_u32 v242, 1048576, v242
    s_waitcnt lgkmcnt(12)
    v_mfma_f32_16x16x32_bf16 v[16:19], v[108:111], v[204:207], v[16:19]
    v_mfma_f32_16x16x32_bf16 v[20:23], v[108:111], v[220:223], v[20:23]
    s_waitcnt lgkmcnt(11)
    v_mfma_f32_16x16x32_bf16 v[24:27], v[112:115], v[192:195], 0
    v_mfma_f32_16x16x32_bf16 v[28:31], v[112:115], v[208:211], 0
    s_waitcnt lgkmcnt(10)
    v_mfma_f32_16x16x32_bf16 v[24:27], v[116:119], v[196:199], v[24:27]
    v_mfma_f32_16x16x32_bf16 v[28:31], v[116:119], v[212:215], v[28:31]
    s_waitcnt lgkmcnt(9)
    v_mfma_f32_16x16x32_bf16 v[24:27], v[120:123], v[200:203], v[24:27]
    v_mfma_f32_16x16x32_bf16 v[28:31], v[120:123], v[216:219], v[28:31]
    v_cvt_pk_bf16_f32 v164, v16, v17
    v_cvt_pk_bf16_f32 v165, v18, v19
    v_cvt_pk_bf16_f32 v166, v20, v21
    v_cvt_pk_bf16_f32 v167, v22, v23
    buffer_store_dwordx4 v[164:167], v242, s[12:15], 0 offen sc1
    v_add_u32 v242, 1048576, v242
    s_waitcnt lgkmcnt(8)
    v_mfma_f32_16x16x32_bf16 v[24:27], v[124:127], v[204:207], v[24:27]
    v_mfma_f32_16x16x32_bf16 v[28:31], v[124:127], v[220:223], v[28:31]
    s_waitcnt lgkmcnt(7)
    v_mfma_f32_16x16x32_bf16 v[32:35], v[128:131], v[192:195], 0
    v_mfma_f32_16x16x32_bf16 v[36:39], v[128:131], v[208:211], 0
    s_waitcnt lgkmcnt(6)
    v_mfma_f32_16x16x32_bf16 v[32:35], v[132:135], v[196:199], v[32:35]
    v_mfma_f32_16x16x32_bf16 v[36:39], v[132:135], v[212:215], v[36:39]
    s_waitcnt lgkmcnt(5)
    v_mfma_f32_16x16x32_bf16 v[32:35], v[136:139], v[200:203], v[32:35]
    v_mfma_f32_16x16x32_bf16 v[36:39], v[136:139], v[216:219], v[36:39]
    v_cvt_pk_bf16_f32 v168, v24, v25
    v_cvt_pk_bf16_f32 v169, v26, v27
    v_cvt_pk_bf16_f32 v170, v28, v29
    v_cvt_pk_bf16_f32 v171, v30, v31
    buffer_store_dwordx4 v[168:171], v242, s[12:15], 0 offen sc1
    v_add_u32 v242, 1048576, v242
    s_waitcnt lgkmcnt(4)
    v_mfma_f32_16x16x32_bf16 v[32:35], v[140:143], v[204:207], v[32:35]
    v_mfma_f32_16x16x32_bf16 v[36:39], v[140:143], v[220:223], v[36:39]
    s_waitcnt lgkmcnt(3)
    v_mfma_f32_16x16x32_bf16 v[40:43], v[144:147], v[192:195], 0
    v_mfma_f32_16x16x32_bf16 v[44:47], v[144:147], v[208:211], 0
    s_waitcnt lgkmcnt(2)
    v_mfma_f32_16x16x32_bf16 v[40:43], v[148:151], v[196:199], v[40:43]
    v_mfma_f32_16x16x32_bf16 v[44:47], v[148:151], v[212:215], v[44:47]
    s_waitcnt lgkmcnt(1)
    v_mfma_f32_16x16x32_bf16 v[40:43], v[152:155], v[200:203], v[40:43]
    v_mfma_f32_16x16x32_bf16 v[44:47], v[152:155], v[216:219], v[44:47]
    v_cvt_pk_bf16_f32 v172, v32, v33
    v_cvt_pk_bf16_f32 v173, v34, v35
    v_cvt_pk_bf16_f32 v174, v36, v37
    v_cvt_pk_bf16_f32 v175, v38, v39
    buffer_store_dwordx4 v[172:175], v242, s[12:15], 0 offen sc1
    v_add_u32 v242, 1048576, v242
    s_waitcnt lgkmcnt(0)
    v_mfma_f32_16x16x32_bf16 v[40:43], v[156:159], v[204:207], v[40:43]
    v_mfma_f32_16x16x32_bf16 v[44:47], v[156:159], v[220:223], v[44:47]
    s_nop 7
    v_cvt_pk_bf16_f32 v160, v40, v41
    v_cvt_pk_bf16_f32 v161, v42, v43
    v_cvt_pk_bf16_f32 v162, v44, v45
    v_cvt_pk_bf16_f32 v163, v46, v47
    buffer_store_dwordx4 v[160:163], v242, s[12:15], 0 offen sc1
    s_cmp_eq_u32 s53, 0
    s_cbranch_scc0 L_fin
    v_mov_b32 v144, 0
    v_mov_b32 v145, 1
    s_mov_b64 exec, 1
    buffer_store_dword v145, v144, s[44:47], 0 offen sc1
    s_mov_b64 exec, -1
L_fin:
L_end:
    s_endpgm
.section .rodata,"a"
.p2align 6
.amdhsa_kernel standalone__tensor_product_equiv_tfn__graph_kernel
.amdhsa_next_free_vgpr 245
.amdhsa_next_free_sgpr 100
.amdhsa_accum_offset 248
.amdhsa_group_segment_fixed_size 0
.amdhsa_kernarg_size 88
.amdhsa_user_sgpr_count 2
.amdhsa_user_sgpr_kernarg_segment_ptr 1
.amdhsa_system_sgpr_workgroup_id_x 1
.amdhsa_float_denorm_mode_32 3
.end_amdhsa_kernel
```

```asm
; @launch grid=(256,1,1) block=(512,1,1) lds=161808
.amdgcn_target "amdgcn-amd-amdhsa--gfx950"
.text
.globl standalone__tensor_product_equiv_tfn__graph_kernel
.p2align 8
.type standalone__tensor_product_equiv_tfn__graph_kernel,@function
standalone__tensor_product_equiv_tfn__graph_kernel:
    s_cmp_ge_u32 s2, 256
    s_cbranch_scc1 L_end
    s_load_dwordx16 s[36:51], s[0:1], 0
    s_load_dwordx4 s[52:55], s[0:1], 64
    s_load_dwordx2 s[56:57], s[0:1], 80
    v_lshrrev_b32 v2, 6, v0
    v_and_b32 v1, 63, v0
    v_readfirstlane_b32 s16, v2
    s_and_b32 s17, s2, 7
    s_lshl_b32 s17, s17, 5
    s_lshr_b32 s26, s2, 3
    s_or_b32 s17, s17, s26
    v_lshlrev_b32 v7, 3, v0
    v_mov_b32 v2, 0
    v_mov_b32 v3, 0
    v_mov_b32 v4, 161792
    ds_write_b64 v7, v[2:3]
    ds_write_b32 v4, v2
    v_lshlrev_b32 v232, 4, v1
    s_mul_i32 s26, s16, 160
    v_add_u32 v6, s26, v1
    v_lshlrev_b32 v53, 2, v6
    v_lshlrev_b32 v54, 3, v6
    s_mul_i32 s26, s16, 1920
    v_add_u32 v55, s26, v232
    s_mul_i32 s26, s16, 5120
    v_add_u32 v56, s26, v232
    s_cmp_lt_u32 s16, 7
    s_cselect_b32 s60, -1, 3
    s_mov_b32 s61, 0
    s_cselect_b64 s[62:63], -1, 15
    s_cselect_b32 s34, -1, 0xff
    s_cselect_b32 s35, 0xffffff, s34
    s_mul_i32 s58, s17, 5000
    s_mul_i32 s59, s17, 10000
    s_lshl_b32 s29, s17, 6
    s_add_u32 s29, s29, 14417920
    s_waitcnt lgkmcnt(0)
    s_mov_b32 s64, s40
    s_mov_b32 s65, s41
    s_mov_b32 s66, 1280000
    s_mov_b32 s67, 0x00020000
    buffer_load_dword v144, v53, s[64:67], s58 offen offset:0
    buffer_load_dword v145, v53, s[64:67], s58 offen offset:256
    s_mov_b64 exec, s[60:61]
    buffer_load_dword v146, v53, s[64:67], s58 offen offset:512
    s_mov_b64 exec, -1
    s_getpc_b64 s[82:83]
L_pc:
    s_lshr_b32 s80, s2, 3
    s_lshl_b32 s80, s80, 3
    s_add_u32 s80, s80, s16
    s_lshl_b32 s81, s80, 6
    s_min_u32 s81, s81, L_end-L_pc
    s_load_dword s3, s[82:83], s81
    s_lshl_b32 s81, s80, 7
    s_load_dword s3, s[50:51], s81
    s_add_u32 s81, s81, 64
    s_load_dword s3, s[50:51], s81
    s_lshl_b32 s81, s80, 4
    s_load_dword s3, s[46:47], s81
    s_and_b32 s81, s80, 64
    s_load_dword s3, s[48:49], s81
    s_mov_b32 s68, s38
    s_mov_b32 s69, s39
    s_mov_b32 s70, 1280000
    s_mov_b32 s71, 0x00020000
    buffer_load_dword v147, v53, s[68:71], s58 offen offset:0
    buffer_load_dword v148, v53, s[68:71], s58 offen offset:256
    s_mov_b64 exec, s[60:61]
    buffer_load_dword v149, v53, s[68:71], s58 offen offset:512
    s_mov_b64 exec, -1
    s_mov_b32 s72, s42
    s_mov_b32 s73, s43
    s_mov_b32 s74, 2560000
    s_mov_b32 s75, 0x00020000
    buffer_load_dwordx2 v[152:153], v54, s[72:75], s59 offen offset:0
    buffer_load_dwordx2 v[156:157], v54, s[72:75], s59 offen offset:512
    s_mov_b64 exec, s[60:61]
    buffer_load_dwordx2 v[160:161], v54, s[72:75], s59 offen offset:1024
    s_mov_b64 exec, -1
    s_mov_b32 s8, s56
    s_mov_b32 s9, s57
    s_mov_b32 s10, 16777216
    s_mov_b32 s11, 0x00020000
    s_mov_b32 s76, s44
    s_mov_b32 s77, s45
    s_mov_b32 s78, 10240000
    s_mov_b32 s79, 0x00020000
    s_barrier
    s_add_u32 m0, s26, 61440
    s_mul_i32 s58, s17, 40000
    buffer_load_dwordx4 v56, s[76:79], s58 offen offset:0  lds
    buffer_load_dwordx4 v56, s[76:79], s58 offen offset:1024  lds
    buffer_load_dwordx4 v56, s[76:79], s58 offen offset:2048  lds
    buffer_load_dwordx4 v56, s[76:79], s58 offen offset:3072  lds
    s_add_u32 m0, s26, 65536
    s_add_u32 s58, s58, 4096
    s_mov_b64 exec, s[62:63]
    buffer_load_dwordx4 v56, s[76:79], s58 offen  lds
    s_mov_b64 exec, -1
    v_mov_b32 v6, 1
    v_lshrrev_b32 v7, 2, v1
    v_mul_u32_u24 v7, 16320, v7
    v_add_u32 v72, v7, v232
    s_cmp_eq_u32 s16, 7
    s_cselect_b32 s59, s29, 0x40000000
    v_add_u32 v7, s59, v72
    buffer_load_dwordx4 v[64:67], v7, s[8:11], 0 offen sc1
    s_waitcnt vmcnt(12)
    v_bfe_u32 v2, v144, 3, 5
    v_and_b32 v3, 7, v144
    v_lshl_or_b32 v2, v3, 5, v2
    v_lshlrev_b32 v167, 2, v2
    ds_add_rtn_u32 v164, v167, v6 offset:3072
    v_bfe_u32 v2, v145, 3, 5
    v_and_b32 v3, 7, v145
    v_lshl_or_b32 v2, v3, 5, v2
    v_lshlrev_b32 v168, 2, v2
    ds_add_rtn_u32 v165, v168, v6 offset:3072
    s_mov_b64 exec, s[60:61]
    v_bfe_u32 v2, v146, 3, 5
    v_and_b32 v3, 7, v146
    v_lshl_or_b32 v2, v3, 5, v2
    v_lshlrev_b32 v169, 2, v2
    ds_add_rtn_u32 v166, v169, v6 offset:3072
    s_mov_b64 exec, -1
    s_movk_i32 s27, 5033
    s_waitcnt vmcnt(9)
    s_movk_i32 s59, -1250
    v_lshrrev_b32 v3, 7, v167
    v_mad_i32_i24 v2, v3, s59, v147
    v_add_u32 v3, 10000, v2
    v_min_u32 v2, v2, v3
    v_mul_u32_u24 v2, s27, v2
    v_lshrrev_b32 v2, 22, v2
    v_lshrrev_b32 v3, 8, v144
    v_mad_u32_u24 v2, v3, 12, v2
    v_lshl_or_b32 v154, v147, 10, v2
    v_lshrrev_b32 v3, 7, v168
    v_mad_i32_i24 v2, v3, s59, v148
    v_add_u32 v3, 10000, v2
    v_min_u32 v2, v2, v3
    v_mul_u32_u24 v2, s27, v2
    v_lshrrev_b32 v2, 22, v2
    v_lshrrev_b32 v3, 8, v145
    v_mad_u32_u24 v2, v3, 12, v2
    v_lshl_or_b32 v158, v148, 10, v2
    v_lshrrev_b32 v3, 7, v169
    v_mad_i32_i24 v2, v3, s59, v149
    v_add_u32 v3, 10000, v2
    v_min_u32 v2, v2, v3
    v_mul_u32_u24 v2, s27, v2
    v_lshrrev_b32 v2, 22, v2
    v_lshrrev_b32 v3, 8, v146
    v_mad_u32_u24 v2, v3, 12, v2
    v_lshl_or_b32 v162, v149, 10, v2
    s_waitcnt lgkmcnt(0)
    s_barrier
    ds_read_b128 v[172:175], v232 offset:3072
    s_waitcnt lgkmcnt(0)
    v_add_u32 v50, v172, v173
    v_add_u32 v51, v50, v174
    v_add_u32 v2, v51, v175
    v_mov_b32 v3, v2
    v_lshlrev_b32 v4, 2, v54
    v_lshrrev_b32 v5, 1, v0
    v_add_u32_dpp v3, v3, v3 row_shr:1 row_mask:0xf bank_mask:0xf
    s_lshr_b32 s59, s17, 4
    s_mul_i32 s59, s59, 16320
    v_add_u32_dpp v3, v3, v3 row_shr:2 row_mask:0xf bank_mask:0xf
    s_lshl2_add_u32 s59, s17, s59
    s_add_u32 s59, s59, 14417920
    v_add_u32_dpp v3, v3, v3 row_shr:4 row_mask:0xf bank_mask:0xf
    v_lshl_add_u32 v58, v5, 6, s59
    s_nop 0
    v_add_u32_dpp v3, v3, v3 row_shr:8 row_mask:0xf bank_mask:0xf
    s_nop 1
    v_add_u32_dpp v3, v3, v3 row_bcast:15 row_mask:0xa bank_mask:0xf
    s_nop 1
    v_add_u32_dpp v3, v3, v3 row_bcast:31 row_mask:0xc bank_mask:0xf
    v_sub_u32 v48, v3, v2
    v_add_u32 v49, v48, v172
    v_add_u32 v50, v48, v50
    v_add_u32 v51, v48, v51
    ds_write_b128 v232, v[48:51] offset:10752
    ds_read_b32 v167, v167 offset:10752
    ds_read_b32 v168, v168 offset:10752
    s_mov_b64 exec, s[60:61]
    ds_read_b32 v169, v169 offset:10752
    s_mov_b64 exec, -1
    v_lshl_or_b32 v60, v172, 16, v48
    v_lshl_or_b32 v61, v173, 16, v49
    v_lshl_or_b32 v62, v174, 16, v50
    v_lshl_or_b32 v63, v175, 16, v51
    s_mov_b32 s27, 46080
    s_waitcnt vmcnt(6) lgkmcnt(0)
    v_add_lshl_u32 v2, v167, v164, 1
    v_add_u32 v3, 0, v4
    ds_write_b16 v2, v3 offset:8192
    v_mad_u32_u24 v2, v2, 6, s27
    ds_write2_b32 v2, v152, v153 offset0:0 offset1:1
    ds_write_b32 v2, v154 offset:8
    v_add_lshl_u32 v2, v168, v165, 1
    v_add_u32 v3, 2048, v4
    ds_write_b16 v2, v3 offset:8192
    v_mad_u32_u24 v2, v2, 6, s27
    ds_write2_b32 v2, v156, v157 offset0:0 offset1:1
    ds_write_b32 v2, v158 offset:8
    s_mov_b64 exec, s[60:61]
    v_add_lshl_u32 v2, v169, v166, 1
    v_add_u32 v3, 4096, v4
    ds_write_b16 v2, v3 offset:8192
    v_mad_u32_u24 v2, v2, 6, s27
    ds_write2_b32 v2, v160, v161 offset0:0 offset1:1
    ds_write_b32 v2, v162 offset:8
    s_mov_b64 exec, -1
    v_lshrrev_b32 v2, 4, v56
    v_and_b32 v2, 0xffe, v2
    v_and_b32 v5, 1, v1
    v_lshlrev_b32 v5, 4, v5
    s_waitcnt lgkmcnt(0)
    s_barrier
    buffer_load_dword v59, v58, s[8:11], 0 offen sc1
    s_mov_b32 s68, s46
    s_mov_b32 s69, s47
    s_mov_b32 s70, 4096
    s_mov_b32 s71, 0x00020000
    s_mov_b32 s64, s48
    s_mov_b32 s65, s49
    s_mov_b32 s66, 128
    s_mov_b32 s67, 0x00020000
    v_lshlrev_b32 v7, 1, v1
    s_lshl_b32 s58, s16, 9
    s_add_u32 m0, s58, 16384
    s_mov_b32 exec_hi, 0
    buffer_load_dwordx4 v232, s[68:71], s58 offen lds
    s_mov_b32 exec_hi, -1
    buffer_load_ushort v57, v7, s[64:67], 0 offen
    ds_read_b128 v[152:155], v55 offset:46080
    ds_read_b128 v[156:159], v55 offset:47104
    ds_read_u16 v164, v2 offset:8192
    ds_read_u16 v165, v2 offset:8256
    ds_read_u16 v166, v2 offset:8320
    ds_read_u16 v167, v2 offset:8384
    ds_read_u16 v168, v2 offset:8448
    s_mov_b32 s4, s36
    s_mov_b32 s5, s37
    s_mov_b32 s6, 10240000
    s_mov_b32 s7, 0x00020000
    s_mov_b32 s12, s52
    s_mov_b32 s13, s53
    s_mov_b32 s14, 10240000
    s_mov_b32 s15, 0x00020000
    s_mov_b32 s20, 0x0f0f0f0f
    s_mov_b32 s21, 0x0f0f0f0f
    s_mov_b32 s22, 0xf0f0f0f0
    s_mov_b32 s23, 0xf0f0f0f0
    s_mov_b32 s31, 0xfffffc00
    s_mov_b32 s32, 0x9c4028
    s_mov_b32 s33, 0xffe0
    s_mov_b32 s24, 0
    s_mov_b32 s25, 0
    v_mov_b32 v8, 0
    v_mov_b32 v9, 0
    v_mov_b32 v10, 0
    v_mov_b32 v11, 0
    v_mov_b32 v12, 0
    v_mov_b32 v13, 0
    v_mov_b32 v14, 0
    v_mov_b32 v15, 0
    v_mov_b32 v16, 0
    v_mov_b32 v17, 0
    v_mov_b32 v18, 0
    v_mov_b32 v19, 0
    v_mov_b32 v20, 0
    v_mov_b32 v21, 0
    v_mov_b32 v22, 0
    v_mov_b32 v23, 0
    v_mov_b32 v24, 0
    v_mov_b32 v25, 0
    v_mov_b32 v26, 0
    v_mov_b32 v27, 0
    v_mov_b32 v28, 0
    v_mov_b32 v29, 0
    v_mov_b32 v30, 0
    v_mov_b32 v31, 0
    v_mov_b32 v32, 0
    v_mov_b32 v33, 0
    v_mov_b32 v34, 0
    v_mov_b32 v35, 0
    v_mov_b32 v36, 0
    v_mov_b32 v37, 0
    v_mov_b32 v38, 0
    v_mov_b32 v39, 0
    v_mov_b32 v40, 0
    v_mov_b32 v41, 0
    v_mov_b32 v42, 0
    v_mov_b32 v43, 0
    v_mov_b32 v44, 0
    v_mov_b32 v45, 0
    v_mov_b32 v46, 0
    v_mov_b32 v47, 0
    v_mov_b32 v192, 0
    v_mov_b32 v193, 0
    v_mov_b32 v194, 0
    v_mov_b32 v195, 0
    v_mov_b32 v196, 0
    v_mov_b32 v197, 0
    v_mov_b32 v198, 0
    v_mov_b32 v199, 0
    v_mov_b32 v112, 0
    v_mov_b32 v238, 0
    s_cmp_lt_u32 s2, 16
    s_cbranch_scc1 L_map40
    v_writelane_b32 v112, 0, 0
    v_writelane_b32 v112, 5, 1
    v_writelane_b32 v112, 6, 2
    v_writelane_b32 v112, 3, 3
    v_writelane_b32 v112, 8, 4
    v_writelane_b32 v112, 7, 5
    v_writelane_b32 v112, 2, 6
    v_writelane_b32 v112, 4, 7
    v_writelane_b32 v112, 1, 8
    v_writelane_b32 v112, 16, 9
    v_writelane_b32 v112, 10, 10
    v_writelane_b32 v112, 15, 11
    v_writelane_b32 v112, 9, 12
    v_writelane_b32 v112, 24, 13
    v_writelane_b32 v112, 14, 14
    v_writelane_b32 v112, 11, 15
    v_writelane_b32 v112, 13, 16
    v_writelane_b32 v112, 12, 17
    v_writelane_b32 v112, 17, 18
    v_writelane_b32 v112, 23, 19
    v_writelane_b32 v112, 20, 20
    v_writelane_b32 v112, 22, 21
    v_writelane_b32 v112, 19, 22
    v_writelane_b32 v112, 18, 23
    v_writelane_b32 v112, 21, 24
    v_writelane_b32 v112, 28, 25
    v_writelane_b32 v112, 29, 26
    v_writelane_b32 v112, 31, 27
    v_writelane_b32 v112, 26, 28
    v_writelane_b32 v112, 25, 29
    v_writelane_b32 v112, 27, 30
    v_writelane_b32 v112, 30, 31
    v_writelane_b32 v112, 36, 32
    v_writelane_b32 v112, 33, 33
    v_writelane_b32 v112, 35, 34
    v_writelane_b32 v112, 34, 35
    v_writelane_b32 v112, 38, 36
    v_writelane_b32 v112, 39, 37
    v_writelane_b32 v112, 37, 38
    v_writelane_b32 v112, 32, 39
    s_branch L_mapd
L_map40:
    v_writelane_b32 v112, 7, 0
    v_writelane_b32 v112, 0, 1
    v_writelane_b32 v112, 5, 2
    v_writelane_b32 v112, 2, 3
    v_writelane_b32 v112, 4, 4
    v_writelane_b32 v112, 3, 5
    v_writelane_b32 v112, 1, 6
    v_writelane_b32 v112, 6, 7
    v_writelane_b32 v112, 12, 8
    v_writelane_b32 v112, 9, 9
    v_writelane_b32 v112, 14, 10
    v_writelane_b32 v112, 11, 11
    v_writelane_b32 v112, 15, 12
    v_writelane_b32 v112, 10, 13
    v_writelane_b32 v112, 8, 14
    v_writelane_b32 v112, 13, 15
    v_writelane_b32 v112, 21, 16
    v_writelane_b32 v112, 22, 17
    v_writelane_b32 v112, 19, 18
    v_writelane_b32 v112, 16, 19
    v_writelane_b32 v112, 23, 20
    v_writelane_b32 v112, 17, 21
    v_writelane_b32 v112, 18, 22
    v_writelane_b32 v112, 20, 23
    v_writelane_b32 v112, 26, 24
    v_writelane_b32 v112, 29, 25
    v_writelane_b32 v112, 27, 26
    v_writelane_b32 v112, 25, 27
    v_writelane_b32 v112, 28, 28
    v_writelane_b32 v112, 30, 29
    v_writelane_b32 v112, 24, 30
    v_writelane_b32 v112, 31, 31
    v_writelane_b32 v112, 38, 32
    v_writelane_b32 v112, 33, 33
    v_writelane_b32 v112, 36, 34
    v_writelane_b32 v112, 35, 35
    v_writelane_b32 v112, 34, 36
    v_writelane_b32 v112, 32, 37
    v_writelane_b32 v112, 37, 38
    v_writelane_b32 v112, 39, 39
L_mapd:
    v_and_b32 v2, 3, v1
    v_lshrrev_b32 v3, 2, v1
    v_lshl_add_u32 v234, v2, 4, v3
    v_lshrrev_b32 v2, 5, v1
    v_lshlrev_b32 v233, 4, v2
    s_mul_i32 s26, s16, 5
    v_add_u32 v113, s26, v1
    v_subrev_u32 v3, 40, v113
    v_min_u32 v113, v113, v3
    v_mul_u32_u24 v3, 205, v1
    v_lshrrev_b32 v3, 10, v3
    v_mul_u32_u24 v2, 5, v3
    v_sub_u32 v115, v1, v2
    v_lshlrev_b32 v114, 2, v3
    s_lshl_b32 s81, s16, 10
    s_add_u32 s81, s81, 8192
    s_mul_i32 s80, s16, 6912
    v_lshl_add_u32 v121, v1, 2, s81
    v_lshrrev_b32 v3, 1, v1
    v_lshl_add_u32 v122, v3, 2, s81
    v_and_b32 v2, 1, v1
    v_lshlrev_b32 v123, 4, v2
    v_lshrrev_b32 v3, 1, v0
    v_mul_u32_u24 v3, 1280, v3
    v_add_u32 v124, v3, v2
    v_mul_u32_u24 v125, 48, v113
    s_lshl_b32 s26, s16, 2
    v_lshl_add_u32 v126, v115, 5, s26
    v_lshl_add_u32 v127, v1, 5, s80
    s_and_b32 s26, s16, 3
    s_lshl_b32 s58, s26, 9
    s_add_u32 s58, s58, 129024
    v_lshrrev_b32 v3, 4, v1
    v_mul_u32_u24 v2, 1792, v3
    v_add3_u32 v240, v2, s58, v232
    s_lshr_b32 s58, s16, 2
    v_and_b32 v2, 15, v1
    v_mul_u32_u24 v241, 288, v2
    v_lshl_add_u32 v241, v3, 4, v241
    s_mul_i32 s59, s58, 23040
    v_add_u32 v241, s59, v241
    v_lshlrev_b32 v242, 18, v3
    v_lshl_add_u32 v242, v2, 4, v242
    s_mul_i32 s58, s58, 5242880
    s_lshl_b32 s59, s2, 10
    s_add_u32 s58, s58, s59
    s_lshl_b32 s59, s26, 8
    s_add_u32 s58, s58, s59
    v_add_u32 v242, s58, v242
    v_mov_b32 v244, 161792
    s_mov_b32 s72, s50
    s_mov_b32 s73, s51
    s_mov_b32 s74, 32768
    s_mov_b32 s75, 0x00020000
    s_mov_b32 s44, s54
    s_mov_b32 s45, s55
    s_mov_b32 s46, 256
    s_mov_b32 s47, 0x00020000
    s_waitcnt lgkmcnt(0)
    v_or_b32 v164, v164, v5
    v_or_b32 v165, v165, v5
    v_or_b32 v166, v166, v5
    v_or_b32 v167, v167, v5
    v_or_b32 v168, v168, v5
    s_mul_i32 s27, s17, 15360
    s_add_u32 s27, s27, 10485760
    s_mul_i32 s58, s17, 40960
    s_add_u32 s59, s58, 4096
    s_waitcnt vmcnt(4)
    s_barrier
    ds_read_b128 v[80:83], v164 offset:61440
    ds_read_b128 v[84:87], v165 offset:61440
    ds_read_b128 v[88:91], v166 offset:61440
    ds_read_b128 v[92:95], v167 offset:61440
    s_mov_b64 exec, s[62:63]
    ds_read_b128 v[96:99], v168 offset:61440
    s_mov_b64 exec, -1
    s_waitcnt vmcnt(2)
    buffer_store_dwordx4 v[152:155], v55, s[8:11], s27 offen sc1
    s_mov_b32 exec_hi, s35
    buffer_store_dwordx4 v[156:159], v55, s[8:11], s27 offen offset:1024 sc1
    s_mov_b32 exec_hi, -1
    s_waitcnt lgkmcnt(4)
    buffer_store_dwordx4 v[80:83], v56, s[8:11], s58 offen offset:0 sc1
    s_waitcnt lgkmcnt(3)
    buffer_store_dwordx4 v[84:87], v56, s[8:11], s58 offen offset:1024 sc1
    s_waitcnt lgkmcnt(2)
    buffer_store_dwordx4 v[88:91], v56, s[8:11], s58 offen offset:2048 sc1
    s_waitcnt lgkmcnt(1)
    buffer_store_dwordx4 v[92:95], v56, s[8:11], s58 offen offset:3072 sc1
    s_mov_b32 exec_lo, s34
    s_mov_b32 exec_hi, s63
    s_waitcnt lgkmcnt(0)
    buffer_store_dwordx4 v[96:99], v56, s[8:11], s59 offen offset:0 sc1
    s_mov_b64 exec, -1
    s_mov_b32 s30, 400000
    s_mov_b32 s53, 0
    s_brev_b32 s59, 1
    s_waitcnt vmcnt(7)
    v_not_b32 v64, v64
    v_and_or_b32 v60, v64, s59, v60
    v_not_b32 v65, v65
    v_and_or_b32 v61, v65, s59, v61
    v_not_b32 v66, v66
    v_and_or_b32 v62, v66, s59, v62
    v_not_b32 v67, v67
    v_and_or_b32 v63, v67, s59, v63
    v_and_b32 v2, 0x30, v1
    v_and_b32 v3, 3, v1
    v_lshl_add_u32 v2, v3, 2, v2
    v_bfe_u32 v7, v1, 2, 2
    v_add_lshl_u32 v2, v2, v7, 1
    ds_write_b16 v2, v57 offset:6656
    v_lshlrev_b32 v3, 3, v3
    ds_read_b64 v[216:217], v3 offset:6656
    ds_read_b64 v[218:219], v3 offset:6688
    ds_read_b64 v[220:221], v3 offset:6720
    ds_read_b64 v[222:223], v3 offset:6752
    s_lshl_b32 s58, s16, 12
    s_add_u32 m0, s58, 129024
    s_cmp_eq_u32 s16, 7
    s_waitcnt vmcnt(0) lgkmcnt(0)
    s_barrier
    s_cbranch_scc0 L_nrow2
    buffer_store_dwordx4 v[60:63], v72, s[8:11], s29 offen sc1
L_nrow2:
    s_barrier
    buffer_load_dwordx4 v232, s[72:75], s58 offen offset:0 lds
    buffer_load_dwordx4 v232, s[72:75], s58 offen offset:1024 lds
    buffer_load_dwordx4 v232, s[72:75], s58 offen offset:2048 lds
    buffer_load_dwordx4 v232, s[72:75], s58 offen offset:3072 lds
    v_and_b32 v3, 31, v1
    v_lshlrev_b32 v2, 7, v233
    v_lshl_add_u32 v2, v3, 2, v2
    v_add_u32 v3, 128, v2
    ds_read2st64_b32 v[144:145], v2 offset0:64 offset1:65
    ds_read2st64_b32 v[146:147], v2 offset0:66 offset1:67
    ds_read2st64_b32 v[148:149], v2 offset0:68 offset1:69
    ds_read2st64_b32 v[150:151], v2 offset0:70 offset1:71
    ds_read2st64_b32 v[152:153], v3 offset0:64 offset1:65
    ds_read2st64_b32 v[154:155], v3 offset0:66 offset1:67
    ds_read2st64_b32 v[156:157], v3 offset0:68 offset1:69
    ds_read2st64_b32 v[158:159], v3 offset0:70 offset1:71
    s_mov_b32 s56, 0xbfb8aa3b
    s_mov_b32 s57, 0xbfb8aa3b
    s_waitcnt lgkmcnt(7)
    v_lshlrev_b32 v160, 16, v144
    v_lshlrev_b32 v161, 16, v145
    v_and_b32 v162, 0xffff0000, v144
    v_and_b32 v163, 0xffff0000, v145
    v_pk_mul_f32 v[160:161], v[160:161], s[56:57]
    v_pk_mul_f32 v[162:163], v[162:163], s[56:57]
    v_cvt_pk_bf16_f32 v200, v160, v161
    v_cvt_pk_bf16_f32 v204, v162, v163
    s_waitcnt lgkmcnt(6)
    v_lshlrev_b32 v160, 16, v146
    v_lshlrev_b32 v161, 16, v147
    v_and_b32 v162, 0xffff0000, v146
    v_and_b32 v163, 0xffff0000, v147
    v_pk_mul_f32 v[160:161], v[160:161], s[56:57]
    v_pk_mul_f32 v[162:163], v[162:163], s[56:57]
    v_cvt_pk_bf16_f32 v201, v160, v161
    v_cvt_pk_bf16_f32 v205, v162, v163
    s_waitcnt lgkmcnt(5)
    v_lshlrev_b32 v160, 16, v148
    v_lshlrev_b32 v161, 16, v149
    v_and_b32 v162, 0xffff0000, v148
    v_and_b32 v163, 0xffff0000, v149
    v_pk_mul_f32 v[160:161], v[160:161], s[56:57]
    v_pk_mul_f32 v[162:163], v[162:163], s[56:57]
    v_cvt_pk_bf16_f32 v202, v160, v161
    v_cvt_pk_bf16_f32 v206, v162, v163
    s_waitcnt lgkmcnt(4)
    v_lshlrev_b32 v160, 16, v150
    v_lshlrev_b32 v161, 16, v151
    v_and_b32 v162, 0xffff0000, v150
    v_and_b32 v163, 0xffff0000, v151
    v_pk_mul_f32 v[160:161], v[160:161], s[56:57]
    v_pk_mul_f32 v[162:163], v[162:163], s[56:57]
    v_cvt_pk_bf16_f32 v203, v160, v161
    v_cvt_pk_bf16_f32 v207, v162, v163
    s_waitcnt lgkmcnt(3)
    v_lshlrev_b32 v160, 16, v152
    v_lshlrev_b32 v161, 16, v153
    v_and_b32 v162, 0xffff0000, v152
    v_and_b32 v163, 0xffff0000, v153
    v_pk_mul_f32 v[160:161], v[160:161], s[56:57]
    v_pk_mul_f32 v[162:163], v[162:163], s[56:57]
    v_cvt_pk_bf16_f32 v208, v160, v161
    v_cvt_pk_bf16_f32 v212, v162, v163
    s_waitcnt lgkmcnt(2)
    v_lshlrev_b32 v160, 16, v154
    v_lshlrev_b32 v161, 16, v155
    v_and_b32 v162, 0xffff0000, v154
    v_and_b32 v163, 0xffff0000, v155
    v_pk_mul_f32 v[160:161], v[160:161], s[56:57]
    v_pk_mul_f32 v[162:163], v[162:163], s[56:57]
    v_cvt_pk_bf16_f32 v209, v160, v161
    v_cvt_pk_bf16_f32 v213, v162, v163
    s_waitcnt lgkmcnt(1)
    v_lshlrev_b32 v160, 16, v156
    v_lshlrev_b32 v161, 16, v157
    v_and_b32 v162, 0xffff0000, v156
    v_and_b32 v163, 0xffff0000, v157
    v_pk_mul_f32 v[160:161], v[160:161], s[56:57]
    v_pk_mul_f32 v[162:163], v[162:163], s[56:57]
    v_cvt_pk_bf16_f32 v210, v160, v161
    v_cvt_pk_bf16_f32 v214, v162, v163
    s_waitcnt lgkmcnt(0)
    v_lshlrev_b32 v160, 16, v158
    v_lshlrev_b32 v161, 16, v159
    v_and_b32 v162, 0xffff0000, v158
    v_and_b32 v163, 0xffff0000, v159
    v_pk_mul_f32 v[160:161], v[160:161], s[56:57]
    v_pk_mul_f32 v[162:163], v[162:163], s[56:57]
    v_cvt_pk_bf16_f32 v211, v160, v161
    v_cvt_pk_bf16_f32 v215, v162, v163
    v_mov_b32 v80, 0xffffff
    v_mov_b32 v81, 0xffffff
    v_mov_b32 v82, 0xffffff
    v_mov_b32 v83, 0xffffff
    v_add_u32 v2, s81, v232
    ds_write_b128 v2, v[80:83]
    v_and_b32 v7, 1, v1
L_pa:
    buffer_load_dword v6, v58, s[8:11], 0 offen sc1
L_pwa:
    s_waitcnt vmcnt(0)
    v_xor_b32 v144, v6, v59
    v_cmpx_le_i32 vcc, 0, v144
    s_cbranch_execz L_pda
    s_sub_u32 s30, s30, 1
    s_cbranch_scc1 L_end
    s_and_b32 s58, s30, 7
    s_cbranch_scc1 L_pa
    v_mov_b32 v144, 0
    buffer_load_dword v145, v144, s[44:47], 0 offen sc1
    s_waitcnt vmcnt(0)
    v_readfirstlane_b32 s53, v145
    s_cmp_eq_u32 s53, 0
    s_cbranch_scc1 L_pa
    buffer_load_dword v6, v58, s[8:11], 0 offen sc1
    s_waitcnt vmcnt(0)
L_pda:
    s_mov_b64 exec, -1
    v_bfe_u32 v236, v6, 16, 11
    v_and_b32 v5, 0xffff, v6
    v_sub_u32 v2, v236, v7
    v_add_u32_dpp v236, v236, v236 row_shr:2 row_mask:0xf bank_mask:0xf
    v_add_u32 v5, v5, v124
    s_nop 0
    v_add_u32_dpp v236, v236, v236 row_shr:4 row_mask:0xf bank_mask:0xf
    s_nop 1
    v_add_u32_dpp v236, v236, v236 row_shr:8 row_mask:0xf bank_mask:0xf
    s_nop 1
    v_add_u32_dpp v236, v236, v236 row_bcast:15 row_mask:0xa bank_mask:0xf
    s_nop 1
    v_add_u32_dpp v236, v236, v236 row_bcast:31 row_mask:0xc bank_mask:0xf
    v_sub_u32 v3, v236, v2
    v_min_u32 v4, 216, v236
    v_lshl_add_u32 v6, v3, 2, s81
    v_sub_u32 v4, v4, v3
    v_sub_u32 v237, v5, v3
    v_sub_u32 v235, v3, v7
L_exp:
    v_cmpx_lt_i32 vcc, 0, v4
    ds_write_b32 v6, v5 offset:0
    v_add_u32 v5, 2, v5
    v_cmpx_lt_i32 vcc, 2, v4
    ds_write_b32 v6, v5 offset:8
    v_add_u32 v5, 2, v5
    v_cmpx_lt_i32 vcc, 4, v4
    ds_write_b32 v6, v5 offset:16
    v_add_u32 v5, 2, v5
    v_cmpx_lt_i32 vcc, 6, v4
    ds_write_b32 v6, v5 offset:24
    v_add_u32 v5, 2, v5
    v_cmpx_lt_i32 vcc, 8, v4
    ds_write_b32 v6, v5 offset:32
    v_add_u32 v5, 2, v5
    v_cmpx_lt_i32 vcc, 10, v4
    ds_write_b32 v6, v5 offset:40
    v_add_u32 v5, 2, v5
    v_cmpx_lt_i32 vcc, 12, v4
    s_cbranch_execnz L_exp_more
L_exp_done:
    s_mov_b64 exec, -1
    ds_read_b32 v99, v121 offset:768
    ds_read_b32 v98, v121 offset:512
    ds_read_b32 v97, v121 offset:256
    ds_read_b32 v96, v121 offset:0
    v_readlane_b32 s19, v236, 63
    s_mov_b32 s26, 10485760
    s_sub_i32 s28, s19, s24
    s_cmp_le_i32 s28, 192
    s_cbranch_scc1 L_sk3
    s_waitcnt lgkmcnt(3)
    v_mul_u32_u24 v99, 12, v99
    buffer_load_dwordx3 v[92:94], v99, s[8:11], s26 offen sc1
L_sk3:
    s_waitcnt lgkmcnt(2)
    v_mul_u32_u24 v98, 12, v98
    buffer_load_dwordx3 v[88:90], v98, s[8:11], s26 offen sc1
    s_waitcnt lgkmcnt(1)
    v_mul_u32_u24 v97, 12, v97
    buffer_load_dwordx3 v[84:86], v97, s[8:11], s26 offen sc1
    s_waitcnt lgkmcnt(0)
    v_mul_u32_u24 v96, 12, v96
    buffer_load_dwordx3 v[80:82], v96, s[8:11], s26 offen sc1
    ds_read_b32 v100, v122 offset:0
    ds_read_b32 v101, v122 offset:128
    ds_read_b32 v102, v122 offset:256
    ds_read_b32 v103, v122 offset:384
    ds_read_b32 v104, v122 offset:512
    ds_read_b32 v105, v122 offset:640
    ds_read_b32 v106, v122 offset:768
    s_max_i32 s28, s28, 0
    s_min_i32 s28, s28, 216
    s_barrier
    s_waitcnt lgkmcnt(6)
    v_lshl_or_b32 v100, v100, 5, v123
    s_add_u32 m0, s80, 46080
    s_cmp_le_u32 s28, 32
    buffer_load_dwordx4 v100, s[8:11], 0 offen sc1 lds
    s_waitcnt lgkmcnt(5)
    v_lshl_or_b32 v101, v101, 5, v123
    s_add_u32 m0, s80, 47104
    s_cmp_le_u32 s28, 64
    buffer_load_dwordx4 v101, s[8:11], 0 offen sc1 lds
    s_waitcnt lgkmcnt(0)
    v_lshl_or_b32 v102, v102, 5, v123
    v_lshl_or_b32 v103, v103, 5, v123
    v_lshl_or_b32 v104, v104, 5, v123
    v_lshl_or_b32 v105, v105, 5, v123
    v_lshl_or_b32 v106, v106, 5, v123
    s_sub_i32 s27, s28, 0
    v_cmp_gt_i32 s[36:37], s27, v1
    s_sub_i32 s27, s28, 64
    v_cmp_gt_i32 s[38:39], s27, v1
    s_sub_i32 s27, s28, 128
    v_cmp_gt_i32 s[40:41], s27, v1
    s_sub_i32 s27, s28, 192
    v_cmp_gt_i32 s[42:43], s27, v1
    v_mov_b32 v3, s19
    v_mov_b32 v4, 2048
    ds_max_u32 v4, v3
    v_mov_b32 v6, 1
    s_waitcnt vmcnt(5)
    s_mov_b64 exec, s[42:43]
    v_and_b32 v2, 0x3ff, v94
    v_lshlrev_b32 v95, 2, v2
    ds_add_rtn_u32 v111, v95, v6 offset:0
    s_waitcnt vmcnt(4)
    s_mov_b64 exec, s[40:41]
    v_and_b32 v2, 0x3ff, v90
    v_lshlrev_b32 v91, 2, v2
    ds_add_rtn_u32 v110, v91, v6 offset:0
    s_waitcnt vmcnt(3)
    s_mov_b64 exec, s[38:39]
    v_and_b32 v2, 0x3ff, v86
    v_lshlrev_b32 v87, 2, v2
    ds_add_rtn_u32 v109, v87, v6 offset:0
    s_waitcnt vmcnt(2)
    s_mov_b64 exec, s[36:37]
    v_and_b32 v2, 0x3ff, v82
    v_lshlrev_b32 v83, 2, v2
    ds_add_rtn_u32 v108, v83, v6 offset:0
    s_mov_b64 exec, -1
    s_waitcnt lgkmcnt(0)
    s_barrier
    ds_read_b128 v[148:151], v125 offset:0
    ds_read_b128 v[152:155], v125 offset:16
    ds_read_b128 v[156:159], v125 offset:32
    ds_read_b32 v4, v4
    s_lshl_b32 s26, s2, 3
    s_add_u32 s26, s26, s16
    s_add_u32 s26, s26, s24
    s_cmp_eq_u32 s26, 7
    s_cbranch_scc0 L_noall
    v_mov_b32 v144, 0
    v_mov_b32 v145, 1
    s_mov_b64 exec, 1
    buffer_store_dword v145, v144, s[44:47], 0 offen sc1
    s_mov_b64 exec, -1
L_noall:
    s_cmp_le_u32 s28, 64
    s_cbranch_scc1 L_efd
    s_add_u32 m0, s80, 48128
    s_cmp_le_u32 s28, 96
    buffer_load_dwordx4 v102, s[8:11], 0 offen sc1 lds
    s_cbranch_scc1 L_efd
    s_add_u32 m0, s80, 49152
    s_cmp_le_u32 s28, 128
    buffer_load_dwordx4 v103, s[8:11], 0 offen sc1 lds
    s_cbranch_scc1 L_efd
    s_add_u32 m0, s80, 50176
    s_cmp_le_u32 s28, 160
    buffer_load_dwordx4 v104, s[8:11], 0 offen sc1 lds
    s_cbranch_scc1 L_efd
    s_add_u32 m0, s80, 51200
    s_cmp_le_u32 s28, 192
    buffer_load_dwordx4 v105, s[8:11], 0 offen sc1 lds
    s_cbranch_scc1 L_efd
    s_add_u32 m0, s80, 52224
    s_cmp_le_u32 s28, 224
    s_mov_b32 exec_hi, 0xffff
    buffer_load_dwordx4 v106, s[8:11], 0 offen sc1 lds
    s_mov_b32 exec_hi, -1
L_efd:
    v_cmp_gt_u32 vcc, 40, v1
    s_waitcnt lgkmcnt(0)
    v_readfirstlane_b32 s26, v4
    v_add_u32 v3, v148, v149
    v_add3_u32 v3, v3, v150, v151
    v_add3_u32 v3, v3, v152, v153
    v_add3_u32 v3, v3, v154, v155
    v_add3_u32 v3, v3, v156, v157
    v_add3_u32 v3, v3, v158, v159
    v_lshl_or_b32 v3, v3, 6, v113
    v_cndmask_b32 v3, 0, v3, vcc
    s_max_u32 s25, s25, s26
    s_cmp_lg_u32 s24, 0
    s_cbranch_scc1 L_havepos
    v_readlane_b32 s64, v3, 0
    v_readlane_b32 s65, v3, 1
    v_readlane_b32 s66, v3, 2
    v_readlane_b32 s67, v3, 3
    v_readlane_b32 s68, v3, 4
    v_cmp_lt_u32 s[70:71], s64, v3
    v_cmp_lt_u32 s[72:73], s65, v3
    v_cmp_lt_u32 s[74:75], s66, v3
    v_cmp_lt_u32 s[76:77], s67, v3
    v_cmp_lt_u32 s[78:79], s68, v3
    s_bcnt1_i32_b64 s64, s[70:71]
    s_bcnt1_i32_b64 s65, s[72:73]
    s_bcnt1_i32_b64 s66, s[74:75]
    s_bcnt1_i32_b64 s67, s[76:77]
    s_bcnt1_i32_b64 s68, s[78:79]
    v_readlane_b32 s70, v112, s64
    v_readlane_b32 s71, v112, s65
    v_readlane_b32 s72, v112, s66
    v_readlane_b32 s73, v112, s67
    v_readlane_b32 s74, v112, s68
    v_writelane_b32 v238, s70, 0
    v_writelane_b32 v238, s71, 1
    v_writelane_b32 v238, s72, 2
    v_writelane_b32 v238, s73, 3
    v_writelane_b32 v238, s74, 4
    v_lshlrev_b32 v238, 2, v238
L_havepos:
    s_mov_b64 exec, 31
    ds_write_b32 v238, v3 offset:4096
    s_mov_b64 exec, -1
    v_lshlrev_b32 v4, 2, v1
    v_and_b32 v6, 7, v1
    v_cmp_gt_u32 s[34:35], s16, v6
    s_and_b64 s[34:35], s[34:35], vcc
    v_cmp_gt_u32 vcc, 60, v1
    s_waitcnt lgkmcnt(0)
    s_barrier
    ds_read_b32 v119, v126 offset:4096
    ds_read_b32 v4, v4 offset:4096
    s_waitcnt lgkmcnt(1)
    v_and_b32 v119, 63, v119
    v_mad_u32_u24 v3, v119, 48, v114
    ds_read_b32 v116, v3 offset:0
    s_waitcnt lgkmcnt(1)
    v_lshrrev_b32 v4, 6, v4
    v_cndmask_b32 v118, 0, v4, s[34:35]
    v_mul_u32_u24 v119, 1152, v119
    s_waitcnt lgkmcnt(0)
    v_cndmask_b32 v116, 0, v116, vcc
    v_mov_b32 v117, v116
    v_readlane_b32 s48, v119, 0
    v_readlane_b32 s49, v119, 1
    v_add_u32_dpp v117, v117, v117 row_shr:1 row_mask:0xf bank_mask:0xf
    v_add_u32_dpp v118, v118, v118 row_shr:1 row_mask:0xf bank_mask:0xf
    v_readlane_b32 s50, v119, 2
    v_add_u32_dpp v117, v117, v117 row_shr:2 row_mask:0xf bank_mask:0xf
    v_add_u32_dpp v118, v118, v118 row_shr:2 row_mask:0xf bank_mask:0xf
    v_readlane_b32 s51, v119, 3
    v_add_u32_dpp v117, v117, v117 row_shr:4 row_mask:0xf bank_mask:0xf
    v_add_u32_dpp v118, v118, v118 row_shr:4 row_mask:0xf bank_mask:0xf
    v_readlane_b32 s52, v119, 4
    v_add_u32_dpp v117, v117, v117 row_shr:8 row_mask:0xf bank_mask:0xf
    v_add_u32_dpp v118, v118, v118 row_shr:8 row_mask:0xf bank_mask:0xf
    v_lshlrev_b32 v4, 3, v115
    v_add_u32_dpp v117, v117, v117 row_bcast:15 row_mask:0xa bank_mask:0xf
    v_add_u32_dpp v118, v118, v118 row_bcast:15 row_mask:0xa bank_mask:0xf
    s_min_u32 s25, s25, 40000
    v_add_u32_dpp v117, v117, v117 row_bcast:31 row_mask:0xc bank_mask:0xf
    v_add_u32_dpp v118, v118, v118 row_bcast:31 row_mask:0xc bank_mask:0xf
    v_sub_u32 v116, v117, v116
    v_readlane_b32 s29, v118, 63
    v_readlane_b32 s18, v117, 63
    s_lshl_b32 s26, s29, 4
    s_add_u32 s26, s26, 101376
    v_lshl_add_u32 v116, v116, 4, s26
    v_lshl_or_b32 v116, v116, 10, v4
    s_mov_b64 exec, vcc
    ds_write_b32 v3, v116 offset:4608
    s_mov_b64 exec, -1
    s_min_u32 s18, s18, 1728
    v_lshl_add_u32 v230, v234, 4, s26
    v_and_b32 v2, 3, v1
    v_bfe_u32 v3, v1, 3, 2
    v_lshl_add_u32 v2, v3, 2, v2
    v_lshl_add_u32 v231, v2, 4, s26
    s_movk_i32 s27, 1023
    s_waitcnt lgkmcnt(0)
    s_barrier
    s_mov_b64 exec, s[36:37]
    ds_read_b32 v96, v83 offset:4608
    s_mov_b64 exec, s[38:39]
    ds_read_b32 v97, v87 offset:4608
    s_mov_b64 exec, s[40:41]
    ds_read_b32 v98, v91 offset:4608
    s_mov_b64 exec, s[42:43]
    ds_read_b32 v99, v95 offset:4608
    s_mov_b64 exec, -1
    v_add_u32 v83, 0, v127
    v_add_u32 v87, 2048, v127
    v_add_u32 v91, 4096, v127
    v_add_u32 v95, 6144, v127
    s_waitcnt lgkmcnt(0)
    s_mov_b64 exec, s[36:37]
    v_bfi_b32 v82, s27, v96, v82
    v_lshrrev_b32 v96, 10, v96
    v_lshl_add_u32 v96, v108, 4, v96
    ds_write_b128 v96, v[80:83]
    s_mov_b64 exec, s[38:39]
    v_bfi_b32 v86, s27, v97, v86
    v_lshrrev_b32 v97, 10, v97
    v_lshl_add_u32 v97, v109, 4, v97
    ds_write_b128 v97, v[84:87]
    s_mov_b64 exec, s[40:41]
    v_bfi_b32 v90, s27, v98, v90
    v_lshrrev_b32 v98, 10, v98
    v_lshl_add_u32 v98, v110, 4, v98
    ds_write_b128 v98, v[88:91]
    s_mov_b64 exec, s[42:43]
    v_bfi_b32 v94, s27, v99, v94
    v_lshrrev_b32 v99, 10, v99
    v_lshl_add_u32 v99, v111, 4, v99
    ds_write_b128 v99, v[92:95]
    s_mov_b64 exec, -1
    v_cmp_gt_i32 vcc, s18, v234
    v_mov_b32 v4, s32
    s_waitcnt lgkmcnt(0)
    s_barrier
    ds_read_b128 v[224:227], v230
    ds_read_b32 v229, v231 offset:12
    ds_read_b32 v2, v231 offset:268
    s_mov_b32 s59, 101376
    s_waitcnt lgkmcnt(0)
    v_cndmask_b32 v228, v4, v226, vcc
    v_and_or_b32 v229, v229, s33, v233
    v_readlane_b32 s64, v228, 0
    v_readlane_b32 s65, v228, 4
    v_readlane_b32 s66, v228, 8
    v_readlane_b32 s67, v228, 12
    v_readlane_b32 s68, v228, 16
    v_readlane_b32 s69, v228, 20
    v_readlane_b32 s70, v228, 24
    v_readlane_b32 s71, v228, 28
    s_and_b32 s80, s64, s31
    buffer_load_dwordx4 v[48:51], v232, s[4:7], s80 offen
    s_and_b32 s81, s65, s31
    buffer_load_dwordx4 v[52:55], v232, s[4:7], s81 offen
    s_and_b32 s82, s66, s31
    buffer_load_dwordx4 v[56:59], v232, s[4:7], s82 offen
    s_and_b32 s83, s67, s31
    buffer_load_dwordx4 v[60:63], v232, s[4:7], s83 offen
    s_waitcnt vmcnt(4)
    s_barrier
    s_mov_b64 exec, s[20:21]
    ds_read_b128 v[192:195], v229 offset:46080
    s_mov_b64 exec, s[22:23]
    ds_read_b128 v[196:199], v229 offset:46080
    s_mov_b64 exec, -1
    v_and_or_b32 v229, v2, s33, v233
    s_waitcnt lgkmcnt(0)
    v_mfma_f32_32x32x16_bf16 v[80:95], v[192:195], v[200:203], 0
    v_mfma_f32_32x32x16_bf16 v[96:111], v[192:195], v[204:207], 0
    v_mfma_f32_32x32x16_bf16 v[80:95], v[196:199], v[208:211], v[80:95]
    v_mfma_f32_32x32x16_bf16 v[96:111], v[196:199], v[212:215], v[96:111]
    s_and_b32 s80, s68, s31
    buffer_load_dwordx4 v[64:67], v232, s[4:7], s80 offen
    s_and_b32 s81, s69, s31
    buffer_load_dwordx4 v[68:71], v232, s[4:7], s81 offen
    s_and_b32 s82, s70, s31
    buffer_load_dwordx4 v[72:75], v232, s[4:7], s82 offen
    s_and_b32 s83, s71, s31
    buffer_load_dwordx4 v[76:79], v232, s[4:7], s83 offen
    s_mov_b64 exec, s[20:21]
    ds_read_b128 v[192:195], v229 offset:46080
    s_mov_b64 exec, -1
    s_cmp_lg_u32 s24, 0
    s_cbranch_scc1 L_wdone
    v_lshrrev_b32 v7, 5, v0
    v_and_b32 v3, 31, v1
    v_lshlrev_b32 v7, 11, v7
    v_add_u32 v7, 129024, v7
    v_lshl_add_u32 v2, v3, 3, v7
    ds_read_b64 v[160:161], v2 offset:0
    ds_read_b64 v[162:163], v2 offset:256
    ds_read_b64 v[164:165], v2 offset:512
    ds_read_b64 v[166:167], v2 offset:768
    ds_read_b64 v[168:169], v2 offset:1024
    ds_read_b64 v[170:171], v2 offset:1280
    ds_read_b64 v[172:173], v2 offset:1536
    ds_read_b64 v[174:175], v2 offset:1792
    s_mov_b32 s58, 0x05040100
    s_mov_b32 s59, 0x07060302
    v_bfe_u32 v3, v0, 3, 2
    v_lshl_add_u32 v7, v3, 9, v7
    v_and_b32 v3, 7, v0
    v_lshl_add_u32 v7, v3, 5, v7
    v_mov_b32 v5, 161792
    v_mov_b32 v6, 1
    s_waitcnt lgkmcnt(0)
    v_perm_b32 v112, v162, v160, s58
    v_perm_b32 v113, v166, v164, s58
    v_perm_b32 v114, v170, v168, s58
    v_perm_b32 v115, v174, v172, s58
    ds_write_b128 v7, v[112:115] offset:0
    v_perm_b32 v116, v162, v160, s59
    v_perm_b32 v117, v166, v164, s59
    v_perm_b32 v118, v170, v168, s59
    v_perm_b32 v119, v174, v172, s59
    ds_write_b128 v7, v[116:119] offset:256
    v_perm_b32 v120, v163, v161, s58
    v_perm_b32 v121, v167, v165, s58
    v_perm_b32 v122, v171, v169, s58
    v_perm_b32 v123, v175, v173, s58
    ds_write_b128 v7, v[120:123] offset:16
    v_perm_b32 v124, v163, v161, s59
    v_perm_b32 v125, v167, v165, s59
    v_perm_b32 v126, v171, v169, s59
    v_perm_b32 v127, v175, v173, s59
    ds_write_b128 v7, v[124:127] offset:272
    s_mov_b64 exec, 1
    ds_add_u32 v5, v6
    s_mov_b64 exec, -1
L_wdone:
    s_mov_b32 s59, 101376
    s_cmp_eq_u32 s16, 7
    s_cselect_b32 s3, 64, 0x80000000
    s_mov_b32 s53, 1
    s_mov_b32 s30, s18
    s_waitcnt lgkmcnt(0)
L_sb:
    s_cmp_gt_i32 s30, s3
    s_cbranch_scc1 L_nofl
    s_load_dword s53, s[54:55], 0
L_nofl:
    v_mfma_f32_4x4x4_16b_bf16 v[144:147], v[224:225], v[216:217], 0
    v_mfma_f32_4x4x4_16b_bf16 v[148:151], v[224:225], v[218:219], 0
    v_mfma_f32_4x4x4_16b_bf16 v[152:155], v[224:225], v[220:221], 0
    v_mfma_f32_4x4x4_16b_bf16 v[156:159], v[224:225], v[222:223], 0
    v_add_u32 v230, 1024, v230
    s_sub_u32 s26, s30, 64
    v_cmp_gt_i32 s[34:35], s26, v234
    s_cmp_le_i32 s30, 0
    s_nop 0
    v_cvt_pk_bf16_f32 v184, v144, v148
    v_cvt_pk_bf16_f32 v185, v152, v156
    v_cvt_pk_bf16_f32 v186, v145, v149
    v_cvt_pk_bf16_f32 v187, v153, v157
    v_cvt_pk_bf16_f32 v188, v146, v150
    v_cvt_pk_bf16_f32 v189, v154, v158
    v_cvt_pk_bf16_f32 v190, v147, v151
    v_cvt_pk_bf16_f32 v191, v155, v159
    ds_read_b128 v[224:227], v230
    ds_read_b32 v243, v244
    s_cbranch_scc1 L_exit
    s_setprio 3
    s_waitcnt vmcnt(4)
    v_mfma_f32_4x4x4_16b_bf16 v[144:147], v[184:185], v[48:49], 0 cbsz:4 abid:0
    v_exp_f32 v176, v80
    v_mfma_f32_4x4x4_16b_bf16 v[148:151], v[184:185], v[50:51], 0 cbsz:4 abid:0
    v_exp_f32 v180, v96
    v_mfma_f32_4x4x4_16b_bf16 v[152:155], v[184:185], v[52:53], 0 cbsz:4 abid:1
    v_exp_f32 v177, v81
    v_mfma_f32_4x4x4_16b_bf16 v[156:159], v[184:185], v[54:55], 0 cbsz:4 abid:1
    v_exp_f32 v181, v97
    v_mfma_f32_4x4x4_16b_bf16 v[160:163], v[184:185], v[56:57], 0 cbsz:4 abid:2
    v_exp_f32 v178, v82
    v_mfma_f32_4x4x4_16b_bf16 v[164:167], v[184:185], v[58:59], 0 cbsz:4 abid:2
    v_exp_f32 v182, v98
    v_mfma_f32_4x4x4_16b_bf16 v[168:171], v[184:185], v[60:61], 0 cbsz:4 abid:3
    v_exp_f32 v179, v83
    v_mfma_f32_4x4x4_16b_bf16 v[172:175], v[184:185], v[62:63], 0 cbsz:4 abid:3
    v_exp_f32 v183, v99
    v_readlane_b32 s72, v228, 32
    v_readlane_b32 s73, v228, 36
    v_readlane_b32 s74, v228, 40
    v_readlane_b32 s75, v228, 44
    s_and_b32 s80, s72, s31
    v_pk_fma_f32 v[176:177], v[176:177], s[56:57], s[56:57]
    s_and_b32 s81, s73, s31
    v_pk_fma_f32 v[178:179], v[178:179], s[56:57], s[56:57]
    s_and_b32 s82, s74, s31
    v_pk_fma_f32 v[180:181], v[180:181], s[56:57], s[56:57]
    s_and_b32 s83, s75, s31
    v_pk_fma_f32 v[182:183], v[182:183], s[56:57], s[56:57]
    v_mfma_f32_32x32x16_bf16 v[112:127], v[192:195], v[200:203], 0
    v_rcp_f32 v176, v176
    v_rcp_f32 v177, v177
    v_rcp_f32 v178, v178
    v_rcp_f32 v179, v179
    v_rcp_f32 v180, v180
    buffer_load_dwordx4 v[48:51], v232, s[4:7], s80 offen
    v_rcp_f32 v181, v181
    buffer_load_dwordx4 v[52:55], v232, s[4:7], s81 offen
    v_rcp_f32 v182, v182
    buffer_load_dwordx4 v[56:59], v232, s[4:7], s82 offen
    v_rcp_f32 v183, v183
    buffer_load_dwordx4 v[60:63], v232, s[4:7], s83 offen
    s_cmp_le_i32 s30, 4
    s_mov_b64 exec, s[22:23]
    ds_read_b128 v[196:199], v229 offset:46080
    s_mov_b64 exec, -1
    ds_read_b32 v2, v231 offset:524
    v_pk_mul_f32 v[176:177], v[176:177], v[80:81]
    v_pk_mul_f32 v[178:179], v[178:179], v[82:83]
    v_pk_mul_f32 v[180:181], v[180:181], v[96:97]
    v_pk_mul_f32 v[182:183], v[182:183], v[98:99]
    s_set_gpr_idx_on s64, gpr_idx(SRC2,DST)
    v_pk_fma_f32 v[8:9], v[176:177], v[144:145], v[8:9] op_sel:[0,0,0] op_sel_hi:[0,1,1]
    v_pk_fma_f32 v[10:11], v[176:177], v[146:147], v[10:11] op_sel:[0,0,0] op_sel_hi:[0,1,1]
    v_pk_fma_f32 v[12:13], v[180:181], v[148:149], v[12:13] op_sel:[0,0,0] op_sel_hi:[0,1,1]
    v_pk_fma_f32 v[14:15], v[180:181], v[150:151], v[14:15] op_sel:[0,0,0] op_sel_hi:[0,1,1]
    s_set_gpr_idx_idx s65
    v_pk_fma_f32 v[8:9], v[176:177], v[152:153], v[8:9] op_sel:[1,0,0] op_sel_hi:[1,1,1]
    v_pk_fma_f32 v[10:11], v[176:177], v[154:155], v[10:11] op_sel:[1,0,0] op_sel_hi:[1,1,1]
    v_pk_fma_f32 v[12:13], v[180:181], v[156:157], v[12:13] op_sel:[1,0,0] op_sel_hi:[1,1,1]
    v_pk_fma_f32 v[14:15], v[180:181], v[158:159], v[14:15] op_sel:[1,0,0] op_sel_hi:[1,1,1]
    s_set_gpr_idx_idx s66
    v_pk_fma_f32 v[8:9], v[178:179], v[160:161], v[8:9] op_sel:[0,0,0] op_sel_hi:[0,1,1]
    v_pk_fma_f32 v[10:11], v[178:179], v[162:163], v[10:11] op_sel:[0,0,0] op_sel_hi:[0,1,1]
    v_pk_fma_f32 v[12:13], v[182:183], v[164:165], v[12:13] op_sel:[0,0,0] op_sel_hi:[0,1,1]
    v_pk_fma_f32 v[14:15], v[182:183], v[166:167], v[14:15] op_sel:[0,0,0] op_sel_hi:[0,1,1]
    s_set_gpr_idx_idx s67
    v_pk_fma_f32 v[8:9], v[178:179], v[168:169], v[8:9] op_sel:[1,0,0] op_sel_hi:[1,1,1]
    v_pk_fma_f32 v[10:11], v[178:179], v[170:171], v[10:11] op_sel:[1,0,0] op_sel_hi:[1,1,1]
    v_pk_fma_f32 v[12:13], v[182:183], v[172:173], v[12:13] op_sel:[1,0,0] op_sel_hi:[1,1,1]
    v_pk_fma_f32 v[14:15], v[182:183], v[174:175], v[14:15] op_sel:[1,0,0] op_sel_hi:[1,1,1]
    s_set_gpr_idx_off
    s_cbranch_scc1 L_exit
    s_waitcnt vmcnt(4)
    v_mfma_f32_4x4x4_16b_bf16 v[144:147], v[184:185], v[64:65], 0 cbsz:4 abid:4
    v_exp_f32 v176, v84
    v_mfma_f32_4x4x4_16b_bf16 v[148:151], v[184:185], v[66:67], 0 cbsz:4 abid:4
    v_exp_f32 v180, v100
    v_mfma_f32_4x4x4_16b_bf16 v[152:155], v[184:185], v[68:69], 0 cbsz:4 abid:5
    v_exp_f32 v177, v85
    v_mfma_f32_4x4x4_16b_bf16 v[156:159], v[184:185], v[70:71], 0 cbsz:4 abid:5
    v_exp_f32 v181, v101
    v_mfma_f32_4x4x4_16b_bf16 v[160:163], v[184:185], v[72:73], 0 cbsz:4 abid:6
    v_exp_f32 v178, v86
    v_mfma_f32_4x4x4_16b_bf16 v[164:167], v[184:185], v[74:75], 0 cbsz:4 abid:6
    v_exp_f32 v182, v102
    v_mfma_f32_4x4x4_16b_bf16 v[168:171], v[184:185], v[76:77], 0 cbsz:4 abid:7
    v_exp_f32 v179, v87
    v_mfma_f32_4x4x4_16b_bf16 v[172:175], v[184:185], v[78:79], 0 cbsz:4 abid:7
    v_exp_f32 v183, v103
    v_readlane_b32 s76, v228, 48
    v_readlane_b32 s77, v228, 52
    v_readlane_b32 s78, v228, 56
    v_readlane_b32 s79, v228, 60
    s_and_b32 s80, s76, s31
    v_pk_fma_f32 v[176:177], v[176:177], s[56:57], s[56:57]
    s_and_b32 s81, s77, s31
    v_pk_fma_f32 v[178:179], v[178:179], s[56:57], s[56:57]
    s_and_b32 s82, s78, s31
    v_pk_fma_f32 v[180:181], v[180:181], s[56:57], s[56:57]
    s_and_b32 s83, s79, s31
    v_pk_fma_f32 v[182:183], v[182:183], s[56:57], s[56:57]
    v_mfma_f32_32x32x16_bf16 v[128:143], v[192:195], v[204:207], 0
    v_rcp_f32 v176, v176
    v_rcp_f32 v177, v177
    v_rcp_f32 v178, v178
    v_rcp_f32 v179, v179
    v_rcp_f32 v180, v180
    buffer_load_dwordx4 v[64:67], v232, s[4:7], s80 offen
    v_rcp_f32 v181, v181
    buffer_load_dwordx4 v[68:71], v232, s[4:7], s81 offen
    v_rcp_f32 v182, v182
    buffer_load_dwordx4 v[72:75], v232, s[4:7], s82 offen
    v_rcp_f32 v183, v183
    buffer_load_dwordx4 v[76:79], v232, s[4:7], s83 offen
    s_cmp_le_i32 s30, 8
    s_waitcnt lgkmcnt(0)
    v_pk_mul_f32 v[176:177], v[176:177], v[84:85]
    v_pk_mul_f32 v[178:179], v[178:179], v[86:87]
    v_pk_mul_f32 v[180:181], v[180:181], v[100:101]
    v_pk_mul_f32 v[182:183], v[182:183], v[102:103]
    s_set_gpr_idx_on s68, gpr_idx(SRC2,DST)
    v_pk_fma_f32 v[8:9], v[176:177], v[144:145], v[8:9] op_sel:[0,0,0] op_sel_hi:[0,1,1]
    v_pk_fma_f32 v[10:11], v[176:177], v[146:147], v[10:11] op_sel:[0,0,0] op_sel_hi:[0,1,1]
    v_pk_fma_f32 v[12:13], v[180:181], v[148:149], v[12:13] op_sel:[0,0,0] op_sel_hi:[0,1,1]
    v_pk_fma_f32 v[14:15], v[180:181], v[150:151], v[14:15] op_sel:[0,0,0] op_sel_hi:[0,1,1]
    s_set_gpr_idx_idx s69
    v_pk_fma_f32 v[8:9], v[176:177], v[152:153], v[8:9] op_sel:[1,0,0] op_sel_hi:[1,1,1]
    v_pk_fma_f32 v[10:11], v[176:177], v[154:155], v[10:11] op_sel:[1,0,0] op_sel_hi:[1,1,1]
    v_pk_fma_f32 v[12:13], v[180:181], v[156:157], v[12:13] op_sel:[1,0,0] op_sel_hi:[1,1,1]
    v_pk_fma_f32 v[14:15], v[180:181], v[158:159], v[14:15] op_sel:[1,0,0] op_sel_hi:[1,1,1]
    s_set_gpr_idx_idx s70
    v_pk_fma_f32 v[8:9], v[178:179], v[160:161], v[8:9] op_sel:[0,0,0] op_sel_hi:[0,1,1]
    v_pk_fma_f32 v[10:11], v[178:179], v[162:163], v[10:11] op_sel:[0,0,0] op_sel_hi:[0,1,1]
    v_pk_fma_f32 v[12:13], v[182:183], v[164:165], v[12:13] op_sel:[0,0,0] op_sel_hi:[0,1,1]
    v_pk_fma_f32 v[14:15], v[182:183], v[166:167], v[14:15] op_sel:[0,0,0] op_sel_hi:[0,1,1]
    s_set_gpr_idx_idx s71
    v_pk_fma_f32 v[8:9], v[178:179], v[168:169], v[8:9] op_sel:[1,0,0] op_sel_hi:[1,1,1]
    v_pk_fma_f32 v[10:11], v[178:179], v[170:171], v[10:11] op_sel:[1,0,0] op_sel_hi:[1,1,1]
    v_pk_fma_f32 v[12:13], v[182:183], v[172:173], v[12:13] op_sel:[1,0,0] op_sel_hi:[1,1,1]
    v_pk_fma_f32 v[14:15], v[182:183], v[174:175], v[14:15] op_sel:[1,0,0] op_sel_hi:[1,1,1]
    s_set_gpr_idx_off
    s_cbranch_scc1 L_exit
    s_setprio 2
    s_waitcnt vmcnt(4)
    v_mfma_f32_4x4x4_16b_bf16 v[144:147], v[184:185], v[48:49], 0 cbsz:4 abid:8
    v_exp_f32 v176, v88
    v_mfma_f32_4x4x4_16b_bf16 v[148:151], v[184:185], v[50:51], 0 cbsz:4 abid:8
    v_exp_f32 v180, v104
    v_mfma_f32_4x4x4_16b_bf16 v[152:155], v[184:185], v[52:53], 0 cbsz:4 abid:9
    v_exp_f32 v177, v89
    v_mfma_f32_4x4x4_16b_bf16 v[156:159], v[184:185], v[54:55], 0 cbsz:4 abid:9
    v_exp_f32 v181, v105
    v_mfma_f32_4x4x4_16b_bf16 v[160:163], v[184:185], v[56:57], 0 cbsz:4 abid:10
    v_exp_f32 v178, v90
    v_mfma_f32_4x4x4_16b_bf16 v[164:167], v[184:185], v[58:59], 0 cbsz:4 abid:10
    v_exp_f32 v182, v106
    v_mfma_f32_4x4x4_16b_bf16 v[168:171], v[184:185], v[60:61], 0 cbsz:4 abid:11
    v_exp_f32 v179, v91
    v_mfma_f32_4x4x4_16b_bf16 v[172:175], v[184:185], v[62:63], 0 cbsz:4 abid:11
    v_exp_f32 v183, v107
    v_readlane_b32 s64, v228, 1
    v_readlane_b32 s65, v228, 5
    v_readlane_b32 s66, v228, 9
    v_readlane_b32 s67, v228, 13
    v_and_or_b32 v229, v2, s33, v233
    s_and_b32 s80, s64, s31
    v_pk_fma_f32 v[176:177], v[176:177], s[56:57], s[56:57]
    s_and_b32 s81, s65, s31
    v_pk_fma_f32 v[178:179], v[178:179], s[56:57], s[56:57]
    s_and_b32 s82, s66, s31
    v_pk_fma_f32 v[180:181], v[180:181], s[56:57], s[56:57]
    s_and_b32 s83, s67, s31
    v_pk_fma_f32 v[182:183], v[182:183], s[56:57], s[56:57]
    v_mfma_f32_32x32x16_bf16 v[112:127], v[196:199], v[208:211], v[112:127]
    v_rcp_f32 v176, v176
    v_rcp_f32 v177, v177
    v_rcp_f32 v178, v178
    v_rcp_f32 v179, v179
    v_rcp_f32 v180, v180
    buffer_load_dwordx4 v[48:51], v232, s[4:7], s80 offen
    v_rcp_f32 v181, v181
    buffer_load_dwordx4 v[52:55], v232, s[4:7], s81 offen
    v_rcp_f32 v182, v182
    buffer_load_dwordx4 v[56:59], v232, s[4:7], s82 offen
    v_rcp_f32 v183, v183
    buffer_load_dwordx4 v[60:63], v232, s[4:7], s83 offen
    s_cmp_le_i32 s30, 12
    s_mov_b64 exec, s[20:21]
    ds_read_b128 v[192:195], v229 offset:46080
    s_mov_b64 exec, -1
    v_pk_mul_f32 v[176:177], v[176:177], v[88:89]
    v_pk_mul_f32 v[178:179], v[178:179], v[90:91]
    v_pk_mul_f32 v[180:181], v[180:181], v[104:105]
    v_pk_mul_f32 v[182:183], v[182:183], v[106:107]
    s_set_gpr_idx_on s72, gpr_idx(SRC2,DST)
    v_pk_fma_f32 v[8:9], v[176:177], v[144:145], v[8:9] op_sel:[0,0,0] op_sel_hi:[0,1,1]
    v_pk_fma_f32 v[10:11], v[176:177], v[146:147], v[10:11] op_sel:[0,0,0] op_sel_hi:[0,1,1]
    v_pk_fma_f32 v[12:13], v[180:181], v[148:149], v[12:13] op_sel:[0,0,0] op_sel_hi:[0,1,1]
    v_pk_fma_f32 v[14:15], v[180:181], v[150:151], v[14:15] op_sel:[0,0,0] op_sel_hi:[0,1,1]
    s_set_gpr_idx_idx s73
    v_pk_fma_f32 v[8:9], v[176:177], v[152:153], v[8:9] op_sel:[1,0,0] op_sel_hi:[1,1,1]
    v_pk_fma_f32 v[10:11], v[176:177], v[154:155], v[10:11] op_sel:[1,0,0] op_sel_hi:[1,1,1]
    v_pk_fma_f32 v[12:13], v[180:181], v[156:157], v[12:13] op_sel:[1,0,0] op_sel_hi:[1,1,1]
    v_pk_fma_f32 v[14:15], v[180:181], v[158:159], v[14:15] op_sel:[1,0,0] op_sel_hi:[1,1,1]
    s_set_gpr_idx_idx s74
    v_pk_fma_f32 v[8:9], v[178:179], v[160:161], v[8:9] op_sel:[0,0,0] op_sel_hi:[0,1,1]
    v_pk_fma_f32 v[10:11], v[178:179], v[162:163], v[10:11] op_sel:[0,0,0] op_sel_hi:[0,1,1]
    v_pk_fma_f32 v[12:13], v[182:183], v[164:165], v[12:13] op_sel:[0,0,0] op_sel_hi:[0,1,1]
    v_pk_fma_f32 v[14:15], v[182:183], v[166:167], v[14:15] op_sel:[0,0,0] op_sel_hi:[0,1,1]
    s_set_gpr_idx_idx s75
    v_pk_fma_f32 v[8:9], v[178:179], v[168:169], v[8:9] op_sel:[1,0,0] op_sel_hi:[1,1,1]
    v_pk_fma_f32 v[10:11], v[178:179], v[170:171], v[10:11] op_sel:[1,0,0] op_sel_hi:[1,1,1]
    v_pk_fma_f32 v[12:13], v[182:183], v[172:173], v[12:13] op_sel:[1,0,0] op_sel_hi:[1,1,1]
    v_pk_fma_f32 v[14:15], v[182:183], v[174:175], v[14:15] op_sel:[1,0,0] op_sel_hi:[1,1,1]
    s_set_gpr_idx_off
    s_cbranch_scc1 L_exit
    s_waitcnt vmcnt(4)
    v_mfma_f32_4x4x4_16b_bf16 v[144:147], v[184:185], v[64:65], 0 cbsz:4 abid:12
    v_exp_f32 v176, v92
    v_mfma_f32_4x4x4_16b_bf16 v[148:151], v[184:185], v[66:67], 0 cbsz:4 abid:12
    v_exp_f32 v180, v108
    v_mfma_f32_4x4x4_16b_bf16 v[152:155], v[184:185], v[68:69], 0 cbsz:4 abid:13
    v_exp_f32 v177, v93
    v_mfma_f32_4x4x4_16b_bf16 v[156:159], v[184:185], v[70:71], 0 cbsz:4 abid:13
    v_exp_f32 v181, v109
    v_mfma_f32_4x4x4_16b_bf16 v[160:163], v[184:185], v[72:73], 0 cbsz:4 abid:14
    v_exp_f32 v178, v94
    v_mfma_f32_4x4x4_16b_bf16 v[164:167], v[184:185], v[74:75], 0 cbsz:4 abid:14
    v_exp_f32 v182, v110
    v_mfma_f32_4x4x4_16b_bf16 v[168:171], v[184:185], v[76:77], 0 cbsz:4 abid:15
    v_exp_f32 v179, v95
    v_mfma_f32_4x4x4_16b_bf16 v[172:175], v[184:185], v[78:79], 0 cbsz:4 abid:15
    v_exp_f32 v183, v111
    v_readlane_b32 s68, v228, 17
    v_readlane_b32 s69, v228, 21
    v_readlane_b32 s70, v228, 25
    v_readlane_b32 s71, v228, 29
    s_and_b32 s80, s68, s31
    v_pk_fma_f32 v[176:177], v[176:177], s[56:57], s[56:57]
    s_and_b32 s81, s69, s31
    v_pk_fma_f32 v[178:179], v[178:179], s[56:57], s[56:57]
    s_and_b32 s82, s70, s31
    v_pk_fma_f32 v[180:181], v[180:181], s[56:57], s[56:57]
    s_and_b32 s83, s71, s31
    v_pk_fma_f32 v[182:183], v[182:183], s[56:57], s[56:57]
    v_mfma_f32_32x32x16_bf16 v[128:143], v[196:199], v[212:215], v[128:143]
    v_rcp_f32 v176, v176
    v_rcp_f32 v177, v177
    v_rcp_f32 v178, v178
    v_rcp_f32 v179, v179
    v_rcp_f32 v180, v180
    buffer_load_dwordx4 v[64:67], v232, s[4:7], s80 offen
    v_rcp_f32 v181, v181
    buffer_load_dwordx4 v[68:71], v232, s[4:7], s81 offen
    v_rcp_f32 v182, v182
    buffer_load_dwordx4 v[72:75], v232, s[4:7], s82 offen
    v_rcp_f32 v183, v183
    buffer_load_dwordx4 v[76:79], v232, s[4:7], s83 offen
    s_cmp_le_i32 s30, 16
    s_waitcnt lgkmcnt(0)
    v_pk_mul_f32 v[176:177], v[176:177], v[92:93]
    v_pk_mul_f32 v[178:179], v[178:179], v[94:95]
    v_pk_mul_f32 v[180:181], v[180:181], v[108:109]
    v_pk_mul_f32 v[182:183], v[182:183], v[110:111]
    s_set_gpr_idx_on s76, gpr_idx(SRC2,DST)
    v_pk_fma_f32 v[8:9], v[176:177], v[144:145], v[8:9] op_sel:[0,0,0] op_sel_hi:[0,1,1]
    v_pk_fma_f32 v[10:11], v[176:177], v[146:147], v[10:11] op_sel:[0,0,0] op_sel_hi:[0,1,1]
    v_pk_fma_f32 v[12:13], v[180:181], v[148:149], v[12:13] op_sel:[0,0,0] op_sel_hi:[0,1,1]
    v_pk_fma_f32 v[14:15], v[180:181], v[150:151], v[14:15] op_sel:[0,0,0] op_sel_hi:[0,1,1]
    s_set_gpr_idx_idx s77
    v_pk_fma_f32 v[8:9], v[176:177], v[152:153], v[8:9] op_sel:[1,0,0] op_sel_hi:[1,1,1]
    v_pk_fma_f32 v[10:11], v[176:177], v[154:155], v[10:11] op_sel:[1,0,0] op_sel_hi:[1,1,1]
    v_pk_fma_f32 v[12:13], v[180:181], v[156:157], v[12:13] op_sel:[1,0,0] op_sel_hi:[1,1,1]
    v_pk_fma_f32 v[14:15], v[180:181], v[158:159], v[14:15] op_sel:[1,0,0] op_sel_hi:[1,1,1]
    s_set_gpr_idx_idx s78
    v_pk_fma_f32 v[8:9], v[178:179], v[160:161], v[8:9] op_sel:[0,0,0] op_sel_hi:[0,1,1]
    v_pk_fma_f32 v[10:11], v[178:179], v[162:163], v[10:11] op_sel:[0,0,0] op_sel_hi:[0,1,1]
    v_pk_fma_f32 v[12:13], v[182:183], v[164:165], v[12:13] op_sel:[0,0,0] op_sel_hi:[0,1,1]
    v_pk_fma_f32 v[14:15], v[182:183], v[166:167], v[14:15] op_sel:[0,0,0] op_sel_hi:[0,1,1]
    s_set_gpr_idx_idx s79
    v_pk_fma_f32 v[8:9], v[178:179], v[168:169], v[8:9] op_sel:[1,0,0] op_sel_hi:[1,1,1]
    v_pk_fma_f32 v[10:11], v[178:179], v[170:171], v[10:11] op_sel:[1,0,0] op_sel_hi:[1,1,1]
    v_pk_fma_f32 v[12:13], v[182:183], v[172:173], v[12:13] op_sel:[1,0,0] op_sel_hi:[1,1,1]
    v_pk_fma_f32 v[14:15], v[182:183], v[174:175], v[14:15] op_sel:[1,0,0] op_sel_hi:[1,1,1]
    s_set_gpr_idx_off
    s_cbranch_scc1 L_exit
    s_setprio 1
    s_waitcnt vmcnt(4)
    v_mfma_f32_4x4x4_16b_bf16 v[144:147], v[186:187], v[48:49], 0 cbsz:4 abid:0
    v_exp_f32 v176, v112
    v_mfma_f32_4x4x4_16b_bf16 v[148:151], v[186:187], v[50:51], 0 cbsz:4 abid:0
    v_exp_f32 v180, v128
    v_mfma_f32_4x4x4_16b_bf16 v[152:155], v[186:187], v[52:53], 0 cbsz:4 abid:1
    v_exp_f32 v177, v113
    v_mfma_f32_4x4x4_16b_bf16 v[156:159], v[186:187], v[54:55], 0 cbsz:4 abid:1
    v_exp_f32 v181, v129
    v_mfma_f32_4x4x4_16b_bf16 v[160:163], v[186:187], v[56:57], 0 cbsz:4 abid:2
    v_exp_f32 v178, v114
    v_mfma_f32_4x4x4_16b_bf16 v[164:167], v[186:187], v[58:59], 0 cbsz:4 abid:2
    v_exp_f32 v182, v130
    v_mfma_f32_4x4x4_16b_bf16 v[168:171], v[186:187], v[60:61], 0 cbsz:4 abid:3
    v_exp_f32 v179, v115
    v_mfma_f32_4x4x4_16b_bf16 v[172:175], v[186:187], v[62:63], 0 cbsz:4 abid:3
    v_exp_f32 v183, v131
    v_readlane_b32 s72, v228, 33
    v_readlane_b32 s73, v228, 37
    v_readlane_b32 s74, v228, 41
    v_readlane_b32 s75, v228, 45
    s_and_b32 s80, s72, s31
    v_pk_fma_f32 v[176:177], v[176:177], s[56:57], s[56:57]
    s_and_b32 s81, s73, s31
    v_pk_fma_f32 v[178:179], v[178:179], s[56:57], s[56:57]
    s_and_b32 s82, s74, s31
    v_pk_fma_f32 v[180:181], v[180:181], s[56:57], s[56:57]
    s_and_b32 s83, s75, s31
    v_pk_fma_f32 v[182:183], v[182:183], s[56:57], s[56:57]
    v_mfma_f32_32x32x16_bf16 v[80:95], v[192:195], v[200:203], 0
    v_rcp_f32 v176, v176
    v_rcp_f32 v177, v177
    v_rcp_f32 v178, v178
    v_rcp_f32 v179, v179
    v_rcp_f32 v180, v180
    buffer_load_dwordx4 v[48:51], v232, s[4:7], s80 offen
    v_rcp_f32 v181, v181
    buffer_load_dwordx4 v[52:55], v232, s[4:7], s81 offen
    v_rcp_f32 v182, v182
    buffer_load_dwordx4 v[56:59], v232, s[4:7], s82 offen
    v_rcp_f32 v183, v183
    buffer_load_dwordx4 v[60:63], v232, s[4:7], s83 offen
    s_cmp_le_i32 s30, 20
    s_mov_b64 exec, s[22:23]
    ds_read_b128 v[196:199], v229 offset:46080
    s_mov_b64 exec, -1
    ds_read_b32 v2, v231 offset:780
    v_pk_mul_f32 v[176:177], v[176:177], v[112:113]
    v_pk_mul_f32 v[178:179], v[178:179], v[114:115]
    v_pk_mul_f32 v[180:181], v[180:181], v[128:129]
    v_pk_mul_f32 v[182:183], v[182:183], v[130:131]
    s_set_gpr_idx_on s64, gpr_idx(SRC2,DST)
    v_pk_fma_f32 v[8:9], v[176:177], v[144:145], v[8:9] op_sel:[0,0,0] op_sel_hi:[0,1,1]
    v_pk_fma_f32 v[10:11], v[176:177], v[146:147], v[10:11] op_sel:[0,0,0] op_sel_hi:[0,1,1]
    v_pk_fma_f32 v[12:13], v[180:181], v[148:149], v[12:13] op_sel:[0,0,0] op_sel_hi:[0,1,1]
    v_pk_fma_f32 v[14:15], v[180:181], v[150:151], v[14:15] op_sel:[0,0,0] op_sel_hi:[0,1,1]
    s_set_gpr_idx_idx s65
    v_pk_fma_f32 v[8:9], v[176:177], v[152:153], v[8:9] op_sel:[1,0,0] op_sel_hi:[1,1,1]
    v_pk_fma_f32 v[10:11], v[176:177], v[154:155], v[10:11] op_sel:[1,0,0] op_sel_hi:[1,1,1]
    v_pk_fma_f32 v[12:13], v[180:181], v[156:157], v[12:13] op_sel:[1,0,0] op_sel_hi:[1,1,1]
    v_pk_fma_f32 v[14:15], v[180:181], v[158:159], v[14:15] op_sel:[1,0,0] op_sel_hi:[1,1,1]
    s_set_gpr_idx_idx s66
    v_pk_fma_f32 v[8:9], v[178:179], v[160:161], v[8:9] op_sel:[0,0,0] op_sel_hi:[0,1,1]
    v_pk_fma_f32 v[10:11], v[178:179], v[162:163], v[10:11] op_sel:[0,0,0] op_sel_hi:[0,1,1]
    v_pk_fma_f32 v[12:13], v[182:183], v[164:165], v[12:13] op_sel:[0,0,0] op_sel_hi:[0,1,1]
    v_pk_fma_f32 v[14:15], v[182:183], v[166:167], v[14:15] op_sel:[0,0,0] op_sel_hi:[0,1,1]
    s_set_gpr_idx_idx s67
    v_pk_fma_f32 v[8:9], v[178:179], v[168:169], v[8:9] op_sel:[1,0,0] op_sel_hi:[1,1,1]
    v_pk_fma_f32 v[10:11], v[178:179], v[170:171], v[10:11] op_sel:[1,0,0] op_sel_hi:[1,1,1]
    v_pk_fma_f32 v[12:13], v[182:183], v[172:173], v[12:13] op_sel:[1,0,0] op_sel_hi:[1,1,1]
    v_pk_fma_f32 v[14:15], v[182:183], v[174:175], v[14:15] op_sel:[1,0,0] op_sel_hi:[1,1,1]
    s_set_gpr_idx_off
    s_cbranch_scc1 L_exit
    s_waitcnt vmcnt(4)
    v_mfma_f32_4x4x4_16b_bf16 v[144:147], v[186:187], v[64:65], 0 cbsz:4 abid:4
    v_exp_f32 v176, v116
    v_mfma_f32_4x4x4_16b_bf16 v[148:151], v[186:187], v[66:67], 0 cbsz:4 abid:4
    v_exp_f32 v180, v132
    v_mfma_f32_4x4x4_16b_bf16 v[152:155], v[186:187], v[68:69], 0 cbsz:4 abid:5
    v_exp_f32 v177, v117
    v_mfma_f32_4x4x4_16b_bf16 v[156:159], v[186:187], v[70:71], 0 cbsz:4 abid:5
    v_exp_f32 v181, v133
    v_mfma_f32_4x4x4_16b_bf16 v[160:163], v[186:187], v[72:73], 0 cbsz:4 abid:6
    v_exp_f32 v178, v118
    v_mfma_f32_4x4x4_16b_bf16 v[164:167], v[186:187], v[74:75], 0 cbsz:4 abid:6
    v_exp_f32 v182, v134
    v_mfma_f32_4x4x4_16b_bf16 v[168:171], v[186:187], v[76:77], 0 cbsz:4 abid:7
    v_exp_f32 v179, v119
    v_mfma_f32_4x4x4_16b_bf16 v[172:175], v[186:187], v[78:79], 0 cbsz:4 abid:7
    v_exp_f32 v183, v135
    v_readlane_b32 s76, v228, 49
    v_readlane_b32 s77, v228, 53
    v_readlane_b32 s78, v228, 57
    v_readlane_b32 s79, v228, 61
    s_and_b32 s80, s76, s31
    v_pk_fma_f32 v[176:177], v[176:177], s[56:57], s[56:57]
    s_and_b32 s81, s77, s31
    v_pk_fma_f32 v[178:179], v[178:179], s[56:57], s[56:57]
    s_and_b32 s82, s78, s31
    v_pk_fma_f32 v[180:181], v[180:181], s[56:57], s[56:57]
    s_and_b32 s83, s79, s31
    v_pk_fma_f32 v[182:183], v[182:183], s[56:57], s[56:57]
    v_mfma_f32_32x32x16_bf16 v[96:111], v[192:195], v[204:207], 0
    v_rcp_f32 v176, v176
    v_rcp_f32 v177, v177
    v_rcp_f32 v178, v178
    v_rcp_f32 v179, v179
    v_rcp_f32 v180, v180
    buffer_load_dwordx4 v[64:67], v232, s[4:7], s80 offen
    v_rcp_f32 v181, v181
    buffer_load_dwordx4 v[68:71], v232, s[4:7], s81 offen
    v_rcp_f32 v182, v182
    buffer_load_dwordx4 v[72:75], v232, s[4:7], s82 offen
    v_rcp_f32 v183, v183
    buffer_load_dwordx4 v[76:79], v232, s[4:7], s83 offen
    s_cmp_le_i32 s30, 24
    s_waitcnt lgkmcnt(0)
    v_pk_mul_f32 v[176:177], v[176:177], v[116:117]
    v_pk_mul_f32 v[178:179], v[178:179], v[118:119]
    v_pk_mul_f32 v[180:181], v[180:181], v[132:133]
    v_pk_mul_f32 v[182:183], v[182:183], v[134:135]
    s_set_gpr_idx_on s68, gpr_idx(SRC2,DST)
    v_pk_fma_f32 v[8:9], v[176:177], v[144:145], v[8:9] op_sel:[0,0,0] op_sel_hi:[0,1,1]
    v_pk_fma_f32 v[10:11], v[176:177], v[146:147], v[10:11] op_sel:[0,0,0] op_sel_hi:[0,1,1]
    v_pk_fma_f32 v[12:13], v[180:181], v[148:149], v[12:13] op_sel:[0,0,0] op_sel_hi:[0,1,1]
    v_pk_fma_f32 v[14:15], v[180:181], v[150:151], v[14:15] op_sel:[0,0,0] op_sel_hi:[0,1,1]
    s_set_gpr_idx_idx s69
    v_pk_fma_f32 v[8:9], v[176:177], v[152:153], v[8:9] op_sel:[1,0,0] op_sel_hi:[1,1,1]
    v_pk_fma_f32 v[10:11], v[176:177], v[154:155], v[10:11] op_sel:[1,0,0] op_sel_hi:[1,1,1]
    v_pk_fma_f32 v[12:13], v[180:181], v[156:157], v[12:13] op_sel:[1,0,0] op_sel_hi:[1,1,1]
    v_pk_fma_f32 v[14:15], v[180:181], v[158:159], v[14:15] op_sel:[1,0,0] op_sel_hi:[1,1,1]
    s_set_gpr_idx_idx s70
    v_pk_fma_f32 v[8:9], v[178:179], v[160:161], v[8:9] op_sel:[0,0,0] op_sel_hi:[0,1,1]
    v_pk_fma_f32 v[10:11], v[178:179], v[162:163], v[10:11] op_sel:[0,0,0] op_sel_hi:[0,1,1]
    v_pk_fma_f32 v[12:13], v[182:183], v[164:165], v[12:13] op_sel:[0,0,0] op_sel_hi:[0,1,1]
    v_pk_fma_f32 v[14:15], v[182:183], v[166:167], v[14:15] op_sel:[0,0,0] op_sel_hi:[0,1,1]
    s_set_gpr_idx_idx s71
    v_pk_fma_f32 v[8:9], v[178:179], v[168:169], v[8:9] op_sel:[1,0,0] op_sel_hi:[1,1,1]
    v_pk_fma_f32 v[10:11], v[178:179], v[170:171], v[10:11] op_sel:[1,0,0] op_sel_hi:[1,1,1]
    v_pk_fma_f32 v[12:13], v[182:183], v[172:173], v[12:13] op_sel:[1,0,0] op_sel_hi:[1,1,1]
    v_pk_fma_f32 v[14:15], v[182:183], v[174:175], v[14:15] op_sel:[1,0,0] op_sel_hi:[1,1,1]
    s_set_gpr_idx_off
    s_cbranch_scc1 L_exit
    s_setprio 0
    s_waitcnt vmcnt(4)
    v_mfma_f32_4x4x4_16b_bf16 v[144:147], v[186:187], v[48:49], 0 cbsz:4 abid:8
    v_exp_f32 v176, v120
    v_mfma_f32_4x4x4_16b_bf16 v[148:151], v[186:187], v[50:51], 0 cbsz:4 abid:8
    v_exp_f32 v180, v136
    v_mfma_f32_4x4x4_16b_bf16 v[152:155], v[186:187], v[52:53], 0 cbsz:4 abid:9
    v_exp_f32 v177, v121
    v_mfma_f32_4x4x4_16b_bf16 v[156:159], v[186:187], v[54:55], 0 cbsz:4 abid:9
    v_exp_f32 v181, v137
    v_mfma_f32_4x4x4_16b_bf16 v[160:163], v[186:187], v[56:57], 0 cbsz:4 abid:10
    v_exp_f32 v178, v122
    v_mfma_f32_4x4x4_16b_bf16 v[164:167], v[186:187], v[58:59], 0 cbsz:4 abid:10
    v_exp_f32 v182, v138
    v_mfma_f32_4x4x4_16b_bf16 v[168:171], v[186:187], v[60:61], 0 cbsz:4 abid:11
    v_exp_f32 v179, v123
    v_mfma_f32_4x4x4_16b_bf16 v[172:175], v[186:187], v[62:63], 0 cbsz:4 abid:11
    v_exp_f32 v183, v139
    v_readlane_b32 s64, v228, 2
    v_readlane_b32 s65, v228, 6
    v_readlane_b32 s66, v228, 10
    v_readlane_b32 s67, v228, 14
    v_and_or_b32 v229, v2, s33, v233
    s_and_b32 s80, s64, s31
    v_pk_fma_f32 v[176:177], v[176:177], s[56:57], s[56:57]
    s_and_b32 s81, s65, s31
    v_pk_fma_f32 v[178:179], v[178:179], s[56:57], s[56:57]
    s_and_b32 s82, s66, s31
    v_pk_fma_f32 v[180:181], v[180:181], s[56:57], s[56:57]
    s_and_b32 s83, s67, s31
    v_pk_fma_f32 v[182:183], v[182:183], s[56:57], s[56:57]
    v_mfma_f32_32x32x16_bf16 v[80:95], v[196:199], v[208:211], v[80:95]
    v_rcp_f32 v176, v176
    v_rcp_f32 v177, v177
    v_rcp_f32 v178, v178
    v_rcp_f32 v179, v179
    v_rcp_f32 v180, v180
    buffer_load_dwordx4 v[48:51], v232, s[4:7], s80 offen
    v_rcp_f32 v181, v181
    buffer_load_dwordx4 v[52:55], v232, s[4:7], s81 offen
    v_rcp_f32 v182, v182
    buffer_load_dwordx4 v[56:59], v232, s[4:7], s82 offen
    v_rcp_f32 v183, v183
    buffer_load_dwordx4 v[60:63], v232, s[4:7], s83 offen
    s_cmp_le_i32 s30, 28
    s_mov_b64 exec, s[20:21]
    ds_read_b128 v[192:195], v229 offset:46080
    s_mov_b64 exec, -1
    v_pk_mul_f32 v[176:177], v[176:177], v[120:121]
    v_pk_mul_f32 v[178:179], v[178:179], v[122:123]
    v_pk_mul_f32 v[180:181], v[180:181], v[136:137]
    v_pk_mul_f32 v[182:183], v[182:183], v[138:139]
    s_set_gpr_idx_on s72, gpr_idx(SRC2,DST)
    v_pk_fma_f32 v[8:9], v[176:177], v[144:145], v[8:9] op_sel:[0,0,0] op_sel_hi:[0,1,1]
    v_pk_fma_f32 v[10:11], v[176:177], v[146:147], v[10:11] op_sel:[0,0,0] op_sel_hi:[0,1,1]
    v_pk_fma_f32 v[12:13], v[180:181], v[148:149], v[12:13] op_sel:[0,0,0] op_sel_hi:[0,1,1]
    v_pk_fma_f32 v[14:15], v[180:181], v[150:151], v[14:15] op_sel:[0,0,0] op_sel_hi:[0,1,1]
    s_set_gpr_idx_idx s73
    v_pk_fma_f32 v[8:9], v[176:177], v[152:153], v[8:9] op_sel:[1,0,0] op_sel_hi:[1,1,1]
    v_pk_fma_f32 v[10:11], v[176:177], v[154:155], v[10:11] op_sel:[1,0,0] op_sel_hi:[1,1,1]
    v_pk_fma_f32 v[12:13], v[180:181], v[156:157], v[12:13] op_sel:[1,0,0] op_sel_hi:[1,1,1]
    v_pk_fma_f32 v[14:15], v[180:181], v[158:159], v[14:15] op_sel:[1,0,0] op_sel_hi:[1,1,1]
    s_set_gpr_idx_idx s74
    v_pk_fma_f32 v[8:9], v[178:179], v[160:161], v[8:9] op_sel:[0,0,0] op_sel_hi:[0,1,1]
    v_pk_fma_f32 v[10:11], v[178:179], v[162:163], v[10:11] op_sel:[0,0,0] op_sel_hi:[0,1,1]
    v_pk_fma_f32 v[12:13], v[182:183], v[164:165], v[12:13] op_sel:[0,0,0] op_sel_hi:[0,1,1]
    v_pk_fma_f32 v[14:15], v[182:183], v[166:167], v[14:15] op_sel:[0,0,0] op_sel_hi:[0,1,1]
    s_set_gpr_idx_idx s75
    v_pk_fma_f32 v[8:9], v[178:179], v[168:169], v[8:9] op_sel:[1,0,0] op_sel_hi:[1,1,1]
    v_pk_fma_f32 v[10:11], v[178:179], v[170:171], v[10:11] op_sel:[1,0,0] op_sel_hi:[1,1,1]
    v_pk_fma_f32 v[12:13], v[182:183], v[172:173], v[12:13] op_sel:[1,0,0] op_sel_hi:[1,1,1]
    v_pk_fma_f32 v[14:15], v[182:183], v[174:175], v[14:15] op_sel:[1,0,0] op_sel_hi:[1,1,1]
    s_set_gpr_idx_off
    s_cbranch_scc1 L_exit
    s_waitcnt vmcnt(4)
    v_mfma_f32_4x4x4_16b_bf16 v[144:147], v[186:187], v[64:65], 0 cbsz:4 abid:12
    v_exp_f32 v176, v124
    v_mfma_f32_4x4x4_16b_bf16 v[148:151], v[186:187], v[66:67], 0 cbsz:4 abid:12
    v_exp_f32 v180, v140
    v_mfma_f32_4x4x4_16b_bf16 v[152:155], v[186:187], v[68:69], 0 cbsz:4 abid:13
    v_exp_f32 v177, v125
    v_mfma_f32_4x4x4_16b_bf16 v[156:159], v[186:187], v[70:71], 0 cbsz:4 abid:13
    v_exp_f32 v181, v141
    v_mfma_f32_4x4x4_16b_bf16 v[160:163], v[186:187], v[72:73], 0 cbsz:4 abid:14
    v_exp_f32 v178, v126
    v_mfma_f32_4x4x4_16b_bf16 v[164:167], v[186:187], v[74:75], 0 cbsz:4 abid:14
    v_exp_f32 v182, v142
    v_mfma_f32_4x4x4_16b_bf16 v[168:171], v[186:187], v[76:77], 0 cbsz:4 abid:15
    v_exp_f32 v179, v127
    v_mfma_f32_4x4x4_16b_bf16 v[172:175], v[186:187], v[78:79], 0 cbsz:4 abid:15
    v_exp_f32 v183, v143
    v_readlane_b32 s68, v228, 18
    v_readlane_b32 s69, v228, 22
    v_readlane_b32 s70, v228, 26
    v_readlane_b32 s71, v228, 30
    s_and_b32 s80, s68, s31
    v_pk_fma_f32 v[176:177], v[176:177], s[56:57], s[56:57]
    s_and_b32 s81, s69, s31
    v_pk_fma_f32 v[178:179], v[178:179], s[56:57], s[56:57]
    s_and_b32 s82, s70, s31
    v_pk_fma_f32 v[180:181], v[180:181], s[56:57], s[56:57]
    s_and_b32 s83, s71, s31
    v_pk_fma_f32 v[182:183], v[182:183], s[56:57], s[56:57]
    v_mfma_f32_32x32x16_bf16 v[96:111], v[196:199], v[212:215], v[96:111]
    v_rcp_f32 v176, v176
    v_rcp_f32 v177, v177
    v_rcp_f32 v178, v178
    v_rcp_f32 v179, v179
    v_rcp_f32 v180, v180
    buffer_load_dwordx4 v[64:67], v232, s[4:7], s80 offen
    v_rcp_f32 v181, v181
    buffer_load_dwordx4 v[68:71], v232, s[4:7], s81 offen
    v_rcp_f32 v182, v182
    buffer_load_dwordx4 v[72:75], v232, s[4:7], s82 offen
    v_rcp_f32 v183, v183
    buffer_load_dwordx4 v[76:79], v232, s[4:7], s83 offen
    s_cmp_le_i32 s30, 32
    s_waitcnt lgkmcnt(0)
    v_pk_mul_f32 v[176:177], v[176:177], v[124:125]
    v_pk_mul_f32 v[178:179], v[178:179], v[126:127]
    v_pk_mul_f32 v[180:181], v[180:181], v[140:141]
    v_pk_mul_f32 v[182:183], v[182:183], v[142:143]
    s_set_gpr_idx_on s76, gpr_idx(SRC2,DST)
    v_pk_fma_f32 v[8:9], v[176:177], v[144:145], v[8:9] op_sel:[0,0,0] op_sel_hi:[0,1,1]
    v_pk_fma_f32 v[10:11], v[176:177], v[146:147], v[10:11] op_sel:[0,0,0] op_sel_hi:[0,1,1]
    v_pk_fma_f32 v[12:13], v[180:181], v[148:149], v[12:13] op_sel:[0,0,0] op_sel_hi:[0,1,1]
    v_pk_fma_f32 v[14:15], v[180:181], v[150:151], v[14:15] op_sel:[0,0,0] op_sel_hi:[0,1,1]
    s_set_gpr_idx_idx s77
    v_pk_fma_f32 v[8:9], v[176:177], v[152:153], v[8:9] op_sel:[1,0,0] op_sel_hi:[1,1,1]
    v_pk_fma_f32 v[10:11], v[176:177], v[154:155], v[10:11] op_sel:[1,0,0] op_sel_hi:[1,1,1]
    v_pk_fma_f32 v[12:13], v[180:181], v[156:157], v[12:13] op_sel:[1,0,0] op_sel_hi:[1,1,1]
    v_pk_fma_f32 v[14:15], v[180:181], v[158:159], v[14:15] op_sel:[1,0,0] op_sel_hi:[1,1,1]
    s_set_gpr_idx_idx s78
    v_pk_fma_f32 v[8:9], v[178:179], v[160:161], v[8:9] op_sel:[0,0,0] op_sel_hi:[0,1,1]
    v_pk_fma_f32 v[10:11], v[178:179], v[162:163], v[10:11] op_sel:[0,0,0] op_sel_hi:[0,1,1]
    v_pk_fma_f32 v[12:13], v[182:183], v[164:165], v[12:13] op_sel:[0,0,0] op_sel_hi:[0,1,1]
    v_pk_fma_f32 v[14:15], v[182:183], v[166:167], v[14:15] op_sel:[0,0,0] op_sel_hi:[0,1,1]
    s_set_gpr_idx_idx s79
    v_pk_fma_f32 v[8:9], v[178:179], v[168:169], v[8:9] op_sel:[1,0,0] op_sel_hi:[1,1,1]
    v_pk_fma_f32 v[10:11], v[178:179], v[170:171], v[10:11] op_sel:[1,0,0] op_sel_hi:[1,1,1]
    v_pk_fma_f32 v[12:13], v[182:183], v[172:173], v[12:13] op_sel:[1,0,0] op_sel_hi:[1,1,1]
    v_pk_fma_f32 v[14:15], v[182:183], v[174:175], v[14:15] op_sel:[1,0,0] op_sel_hi:[1,1,1]
    s_set_gpr_idx_off
    s_cbranch_scc1 L_exit
    s_setprio 3
    s_waitcnt vmcnt(4)
    v_mfma_f32_4x4x4_16b_bf16 v[144:147], v[188:189], v[48:49], 0 cbsz:4 abid:0
    v_exp_f32 v176, v80
    v_mfma_f32_4x4x4_16b_bf16 v[148:151], v[188:189], v[50:51], 0 cbsz:4 abid:0
    v_exp_f32 v180, v96
    v_mfma_f32_4x4x4_16b_bf16 v[152:155], v[188:189], v[52:53], 0 cbsz:4 abid:1
    v_exp_f32 v177, v81
    v_mfma_f32_4x4x4_16b_bf16 v[156:159], v[188:189], v[54:55], 0 cbsz:4 abid:1
    v_exp_f32 v181, v97
    v_mfma_f32_4x4x4_16b_bf16 v[160:163], v[188:189], v[56:57], 0 cbsz:4 abid:2
    v_exp_f32 v178, v82
    v_mfma_f32_4x4x4_16b_bf16 v[164:167], v[188:189], v[58:59], 0 cbsz:4 abid:2
    v_exp_f32 v182, v98
    v_mfma_f32_4x4x4_16b_bf16 v[168:171], v[188:189], v[60:61], 0 cbsz:4 abid:3
    v_exp_f32 v179, v83
    v_mfma_f32_4x4x4_16b_bf16 v[172:175], v[188:189], v[62:63], 0 cbsz:4 abid:3
    v_exp_f32 v183, v99
    v_readlane_b32 s72, v228, 34
    v_readlane_b32 s73, v228, 38
    v_readlane_b32 s74, v228, 42
    v_readlane_b32 s75, v228, 46
    s_and_b32 s80, s72, s31
    v_pk_fma_f32 v[176:177], v[176:177], s[56:57], s[56:57]
    s_and_b32 s81, s73, s31
    v_pk_fma_f32 v[178:179], v[178:179], s[56:57], s[56:57]
    s_and_b32 s82, s74, s31
    v_pk_fma_f32 v[180:181], v[180:181], s[56:57], s[56:57]
    s_and_b32 s83, s75, s31
    v_pk_fma_f32 v[182:183], v[182:183], s[56:57], s[56:57]
    v_mfma_f32_32x32x16_bf16 v[112:127], v[192:195], v[200:203], 0
    v_rcp_f32 v176, v176
    v_rcp_f32 v177, v177
    v_rcp_f32 v178, v178
    v_rcp_f32 v179, v179
    v_rcp_f32 v180, v180
    buffer_load_dwordx4 v[48:51], v232, s[4:7], s80 offen
    v_rcp_f32 v181, v181
    buffer_load_dwordx4 v[52:55], v232, s[4:7], s81 offen
    v_rcp_f32 v182, v182
    buffer_load_dwordx4 v[56:59], v232, s[4:7], s82 offen
    v_rcp_f32 v183, v183
    buffer_load_dwordx4 v[60:63], v232, s[4:7], s83 offen
    s_cmp_le_i32 s30, 36
    s_mov_b64 exec, s[22:23]
    ds_read_b128 v[196:199], v229 offset:46080
    s_mov_b64 exec, -1
    ds_read_b32 v2, v231 offset:1036
    v_pk_mul_f32 v[176:177], v[176:177], v[80:81]
    v_pk_mul_f32 v[178:179], v[178:179], v[82:83]
    v_pk_mul_f32 v[180:181], v[180:181], v[96:97]
    v_pk_mul_f32 v[182:183], v[182:183], v[98:99]
    s_set_gpr_idx_on s64, gpr_idx(SRC2,DST)
    v_pk_fma_f32 v[8:9], v[176:177], v[144:145], v[8:9] op_sel:[0,0,0] op_sel_hi:[0,1,1]
    v_pk_fma_f32 v[10:11], v[176:177], v[146:147], v[10:11] op_sel:[0,0,0] op_sel_hi:[0,1,1]
    v_pk_fma_f32 v[12:13], v[180:181], v[148:149], v[12:13] op_sel:[0,0,0] op_sel_hi:[0,1,1]
    v_pk_fma_f32 v[14:15], v[180:181], v[150:151], v[14:15] op_sel:[0,0,0] op_sel_hi:[0,1,1]
    s_set_gpr_idx_idx s65
    v_pk_fma_f32 v[8:9], v[176:177], v[152:153], v[8:9] op_sel:[1,0,0] op_sel_hi:[1,1,1]
    v_pk_fma_f32 v[10:11], v[176:177], v[154:155], v[10:11] op_sel:[1,0,0] op_sel_hi:[1,1,1]
    v_pk_fma_f32 v[12:13], v[180:181], v[156:157], v[12:13] op_sel:[1,0,0] op_sel_hi:[1,1,1]
    v_pk_fma_f32 v[14:15], v[180:181], v[158:159], v[14:15] op_sel:[1,0,0] op_sel_hi:[1,1,1]
    s_set_gpr_idx_idx s66
    v_pk_fma_f32 v[8:9], v[178:179], v[160:161], v[8:9] op_sel:[0,0,0] op_sel_hi:[0,1,1]
    v_pk_fma_f32 v[10:11], v[178:179], v[162:163], v[10:11] op_sel:[0,0,0] op_sel_hi:[0,1,1]
    v_pk_fma_f32 v[12:13], v[182:183], v[164:165], v[12:13] op_sel:[0,0,0] op_sel_hi:[0,1,1]
    v_pk_fma_f32 v[14:15], v[182:183], v[166:167], v[14:15] op_sel:[0,0,0] op_sel_hi:[0,1,1]
    s_set_gpr_idx_idx s67
    v_pk_fma_f32 v[8:9], v[178:179], v[168:169], v[8:9] op_sel:[1,0,0] op_sel_hi:[1,1,1]
    v_pk_fma_f32 v[10:11], v[178:179], v[170:171], v[10:11] op_sel:[1,0,0] op_sel_hi:[1,1,1]
    v_pk_fma_f32 v[12:13], v[182:183], v[172:173], v[12:13] op_sel:[1,0,0] op_sel_hi:[1,1,1]
    v_pk_fma_f32 v[14:15], v[182:183], v[174:175], v[14:15] op_sel:[1,0,0] op_sel_hi:[1,1,1]
    s_set_gpr_idx_off
    s_cbranch_scc1 L_exit
    s_waitcnt vmcnt(4)
    v_mfma_f32_4x4x4_16b_bf16 v[144:147], v[188:189], v[64:65], 0 cbsz:4 abid:4
    v_exp_f32 v176, v84
    v_mfma_f32_4x4x4_16b_bf16 v[148:151], v[188:189], v[66:67], 0 cbsz:4 abid:4
    v_exp_f32 v180, v100
    v_mfma_f32_4x4x4_16b_bf16 v[152:155], v[188:189], v[68:69], 0 cbsz:4 abid:5
    v_exp_f32 v177, v85
    v_mfma_f32_4x4x4_16b_bf16 v[156:159], v[188:189], v[70:71], 0 cbsz:4 abid:5
    v_exp_f32 v181, v101
    v_mfma_f32_4x4x4_16b_bf16 v[160:163], v[188:189], v[72:73], 0 cbsz:4 abid:6
    v_exp_f32 v178, v86
    v_mfma_f32_4x4x4_16b_bf16 v[164:167], v[188:189], v[74:75], 0 cbsz:4 abid:6
    v_exp_f32 v182, v102
    v_mfma_f32_4x4x4_16b_bf16 v[168:171], v[188:189], v[76:77], 0 cbsz:4 abid:7
    v_exp_f32 v179, v87
    v_mfma_f32_4x4x4_16b_bf16 v[172:175], v[188:189], v[78:79], 0 cbsz:4 abid:7
    v_exp_f32 v183, v103
    v_readlane_b32 s76, v228, 50
    v_readlane_b32 s77, v228, 54
    v_readlane_b32 s78, v228, 58
    v_readlane_b32 s79, v228, 62
    s_and_b32 s80, s76, s31
    v_pk_fma_f32 v[176:177], v[176:177], s[56:57], s[56:57]
    s_and_b32 s81, s77, s31
    v_pk_fma_f32 v[178:179], v[178:179], s[56:57], s[56:57]
    s_and_b32 s82, s78, s31
    v_pk_fma_f32 v[180:181], v[180:181], s[56:57], s[56:57]
    s_and_b32 s83, s79, s31
    v_pk_fma_f32 v[182:183], v[182:183], s[56:57], s[56:57]
    v_mfma_f32_32x32x16_bf16 v[128:143], v[192:195], v[204:207], 0
    v_rcp_f32 v176, v176
    v_rcp_f32 v177, v177
    v_rcp_f32 v178, v178
    v_rcp_f32 v179, v179
    v_rcp_f32 v180, v180
    buffer_load_dwordx4 v[64:67], v232, s[4:7], s80 offen
    v_rcp_f32 v181, v181
    buffer_load_dwordx4 v[68:71], v232, s[4:7], s81 offen
    v_rcp_f32 v182, v182
    buffer_load_dwordx4 v[72:75], v232, s[4:7], s82 offen
    v_rcp_f32 v183, v183
    buffer_load_dwordx4 v[76:79], v232, s[4:7], s83 offen
    s_cmp_le_i32 s30, 40
    s_waitcnt lgkmcnt(0)
    v_pk_mul_f32 v[176:177], v[176:177], v[84:85]
    v_pk_mul_f32 v[178:179], v[178:179], v[86:87]
    v_pk_mul_f32 v[180:181], v[180:181], v[100:101]
    v_pk_mul_f32 v[182:183], v[182:183], v[102:103]
    s_set_gpr_idx_on s68, gpr_idx(SRC2,DST)
    v_pk_fma_f32 v[8:9], v[176:177], v[144:145], v[8:9] op_sel:[0,0,0] op_sel_hi:[0,1,1]
    v_pk_fma_f32 v[10:11], v[176:177], v[146:147], v[10:11] op_sel:[0,0,0] op_sel_hi:[0,1,1]
    v_pk_fma_f32 v[12:13], v[180:181], v[148:149], v[12:13] op_sel:[0,0,0] op_sel_hi:[0,1,1]
    v_pk_fma_f32 v[14:15], v[180:181], v[150:151], v[14:15] op_sel:[0,0,0] op_sel_hi:[0,1,1]
    s_set_gpr_idx_idx s69
    v_pk_fma_f32 v[8:9], v[176:177], v[152:153], v[8:9] op_sel:[1,0,0] op_sel_hi:[1,1,1]
    v_pk_fma_f32 v[10:11], v[176:177], v[154:155], v[10:11] op_sel:[1,0,0] op_sel_hi:[1,1,1]
    v_pk_fma_f32 v[12:13], v[180:181], v[156:157], v[12:13] op_sel:[1,0,0] op_sel_hi:[1,1,1]
    v_pk_fma_f32 v[14:15], v[180:181], v[158:159], v[14:15] op_sel:[1,0,0] op_sel_hi:[1,1,1]
    s_set_gpr_idx_idx s70
    v_pk_fma_f32 v[8:9], v[178:179], v[160:161], v[8:9] op_sel:[0,0,0] op_sel_hi:[0,1,1]
    v_pk_fma_f32 v[10:11], v[178:179], v[162:163], v[10:11] op_sel:[0,0,0] op_sel_hi:[0,1,1]
    v_pk_fma_f32 v[12:13], v[182:183], v[164:165], v[12:13] op_sel:[0,0,0] op_sel_hi:[0,1,1]
    v_pk_fma_f32 v[14:15], v[182:183], v[166:167], v[14:15] op_sel:[0,0,0] op_sel_hi:[0,1,1]
    s_set_gpr_idx_idx s71
    v_pk_fma_f32 v[8:9], v[178:179], v[168:169], v[8:9] op_sel:[1,0,0] op_sel_hi:[1,1,1]
    v_pk_fma_f32 v[10:11], v[178:179], v[170:171], v[10:11] op_sel:[1,0,0] op_sel_hi:[1,1,1]
    v_pk_fma_f32 v[12:13], v[182:183], v[172:173], v[12:13] op_sel:[1,0,0] op_sel_hi:[1,1,1]
    v_pk_fma_f32 v[14:15], v[182:183], v[174:175], v[14:15] op_sel:[1,0,0] op_sel_hi:[1,1,1]
    s_set_gpr_idx_off
    s_cbranch_scc1 L_exit
    s_setprio 2
    s_waitcnt vmcnt(4)
    v_mfma_f32_4x4x4_16b_bf16 v[144:147], v[188:189], v[48:49], 0 cbsz:4 abid:8
    v_exp_f32 v176, v88
    v_mfma_f32_4x4x4_16b_bf16 v[148:151], v[188:189], v[50:51], 0 cbsz:4 abid:8
    v_exp_f32 v180, v104
    v_mfma_f32_4x4x4_16b_bf16 v[152:155], v[188:189], v[52:53], 0 cbsz:4 abid:9
    v_exp_f32 v177, v89
    v_mfma_f32_4x4x4_16b_bf16 v[156:159], v[188:189], v[54:55], 0 cbsz:4 abid:9
    v_exp_f32 v181, v105
    v_mfma_f32_4x4x4_16b_bf16 v[160:163], v[188:189], v[56:57], 0 cbsz:4 abid:10
    v_exp_f32 v178, v90
    v_mfma_f32_4x4x4_16b_bf16 v[164:167], v[188:189], v[58:59], 0 cbsz:4 abid:10
    v_exp_f32 v182, v106
    v_mfma_f32_4x4x4_16b_bf16 v[168:171], v[188:189], v[60:61], 0 cbsz:4 abid:11
    v_exp_f32 v179, v91
    v_mfma_f32_4x4x4_16b_bf16 v[172:175], v[188:189], v[62:63], 0 cbsz:4 abid:11
    v_exp_f32 v183, v107
    v_readlane_b32 s64, v228, 3
    v_readlane_b32 s65, v228, 7
    v_readlane_b32 s66, v228, 11
    v_readlane_b32 s67, v228, 15
    v_and_or_b32 v229, v2, s33, v233
    s_and_b32 s80, s64, s31
    v_pk_fma_f32 v[176:177], v[176:177], s[56:57], s[56:57]
    s_and_b32 s81, s65, s31
    v_pk_fma_f32 v[178:179], v[178:179], s[56:57], s[56:57]
    s_and_b32 s82, s66, s31
    v_pk_fma_f32 v[180:181], v[180:181], s[56:57], s[56:57]
    s_and_b32 s83, s67, s31
    v_pk_fma_f32 v[182:183], v[182:183], s[56:57], s[56:57]
    v_mfma_f32_32x32x16_bf16 v[112:127], v[196:199], v[208:211], v[112:127]
    v_rcp_f32 v176, v176
    v_rcp_f32 v177, v177
    v_rcp_f32 v178, v178
    v_rcp_f32 v179, v179
    v_rcp_f32 v180, v180
    buffer_load_dwordx4 v[48:51], v232, s[4:7], s80 offen
    v_rcp_f32 v181, v181
    buffer_load_dwordx4 v[52:55], v232, s[4:7], s81 offen
    v_rcp_f32 v182, v182
    buffer_load_dwordx4 v[56:59], v232, s[4:7], s82 offen
    v_rcp_f32 v183, v183
    buffer_load_dwordx4 v[60:63], v232, s[4:7], s83 offen
    s_cmp_le_i32 s30, 44
    s_mov_b64 exec, s[20:21]
    ds_read_b128 v[192:195], v229 offset:46080
    s_mov_b64 exec, -1
    v_pk_mul_f32 v[176:177], v[176:177], v[88:89]
    v_pk_mul_f32 v[178:179], v[178:179], v[90:91]
    v_pk_mul_f32 v[180:181], v[180:181], v[104:105]
    v_pk_mul_f32 v[182:183], v[182:183], v[106:107]
    s_set_gpr_idx_on s72, gpr_idx(SRC2,DST)
    v_pk_fma_f32 v[8:9], v[176:177], v[144:145], v[8:9] op_sel:[0,0,0] op_sel_hi:[0,1,1]
    v_pk_fma_f32 v[10:11], v[176:177], v[146:147], v[10:11] op_sel:[0,0,0] op_sel_hi:[0,1,1]
    v_pk_fma_f32 v[12:13], v[180:181], v[148:149], v[12:13] op_sel:[0,0,0] op_sel_hi:[0,1,1]
    v_pk_fma_f32 v[14:15], v[180:181], v[150:151], v[14:15] op_sel:[0,0,0] op_sel_hi:[0,1,1]
    s_set_gpr_idx_idx s73
    v_pk_fma_f32 v[8:9], v[176:177], v[152:153], v[8:9] op_sel:[1,0,0] op_sel_hi:[1,1,1]
    v_pk_fma_f32 v[10:11], v[176:177], v[154:155], v[10:11] op_sel:[1,0,0] op_sel_hi:[1,1,1]
    v_pk_fma_f32 v[12:13], v[180:181], v[156:157], v[12:13] op_sel:[1,0,0] op_sel_hi:[1,1,1]
    v_pk_fma_f32 v[14:15], v[180:181], v[158:159], v[14:15] op_sel:[1,0,0] op_sel_hi:[1,1,1]
    s_set_gpr_idx_idx s74
    v_pk_fma_f32 v[8:9], v[178:179], v[160:161], v[8:9] op_sel:[0,0,0] op_sel_hi:[0,1,1]
    v_pk_fma_f32 v[10:11], v[178:179], v[162:163], v[10:11] op_sel:[0,0,0] op_sel_hi:[0,1,1]
    v_pk_fma_f32 v[12:13], v[182:183], v[164:165], v[12:13] op_sel:[0,0,0] op_sel_hi:[0,1,1]
    v_pk_fma_f32 v[14:15], v[182:183], v[166:167], v[14:15] op_sel:[0,0,0] op_sel_hi:[0,1,1]
    s_set_gpr_idx_idx s75
    v_pk_fma_f32 v[8:9], v[178:179], v[168:169], v[8:9] op_sel:[1,0,0] op_sel_hi:[1,1,1]
    v_pk_fma_f32 v[10:11], v[178:179], v[170:171], v[10:11] op_sel:[1,0,0] op_sel_hi:[1,1,1]
    v_pk_fma_f32 v[12:13], v[182:183], v[172:173], v[12:13] op_sel:[1,0,0] op_sel_hi:[1,1,1]
    v_pk_fma_f32 v[14:15], v[182:183], v[174:175], v[14:15] op_sel:[1,0,0] op_sel_hi:[1,1,1]
    s_set_gpr_idx_off
    s_cbranch_scc1 L_exit
    s_waitcnt vmcnt(4)
    v_mfma_f32_4x4x4_16b_bf16 v[144:147], v[188:189], v[64:65], 0 cbsz:4 abid:12
    v_exp_f32 v176, v92
    v_mfma_f32_4x4x4_16b_bf16 v[148:151], v[188:189], v[66:67], 0 cbsz:4 abid:12
    v_exp_f32 v180, v108
    v_mfma_f32_4x4x4_16b_bf16 v[152:155], v[188:189], v[68:69], 0 cbsz:4 abid:13
    v_exp_f32 v177, v93
    v_mfma_f32_4x4x4_16b_bf16 v[156:159], v[188:189], v[70:71], 0 cbsz:4 abid:13
    v_exp_f32 v181, v109
    v_mfma_f32_4x4x4_16b_bf16 v[160:163], v[188:189], v[72:73], 0 cbsz:4 abid:14
    v_exp_f32 v178, v94
    v_mfma_f32_4x4x4_16b_bf16 v[164:167], v[188:189], v[74:75], 0 cbsz:4 abid:14
    v_exp_f32 v182, v110
    v_mfma_f32_4x4x4_16b_bf16 v[168:171], v[188:189], v[76:77], 0 cbsz:4 abid:15
    v_exp_f32 v179, v95
    v_mfma_f32_4x4x4_16b_bf16 v[172:175], v[188:189], v[78:79], 0 cbsz:4 abid:15
    v_exp_f32 v183, v111
    v_readlane_b32 s68, v228, 19
    v_readlane_b32 s69, v228, 23
    v_readlane_b32 s70, v228, 27
    v_readlane_b32 s71, v228, 31
    s_and_b32 s80, s68, s31
    v_pk_fma_f32 v[176:177], v[176:177], s[56:57], s[56:57]
    s_and_b32 s81, s69, s31
    v_pk_fma_f32 v[178:179], v[178:179], s[56:57], s[56:57]
    s_and_b32 s82, s70, s31
    v_pk_fma_f32 v[180:181], v[180:181], s[56:57], s[56:57]
    s_and_b32 s83, s71, s31
    v_pk_fma_f32 v[182:183], v[182:183], s[56:57], s[56:57]
    v_mfma_f32_32x32x16_bf16 v[128:143], v[196:199], v[212:215], v[128:143]
    v_rcp_f32 v176, v176
    v_rcp_f32 v177, v177
    v_rcp_f32 v178, v178
    v_rcp_f32 v179, v179
    v_rcp_f32 v180, v180
    buffer_load_dwordx4 v[64:67], v232, s[4:7], s80 offen
    v_rcp_f32 v181, v181
    buffer_load_dwordx4 v[68:71], v232, s[4:7], s81 offen
    v_rcp_f32 v182, v182
    buffer_load_dwordx4 v[72:75], v232, s[4:7], s82 offen
    v_rcp_f32 v183, v183
    buffer_load_dwordx4 v[76:79], v232, s[4:7], s83 offen
    s_cmp_le_i32 s30, 48
    s_waitcnt lgkmcnt(0)
    v_pk_mul_f32 v[176:177], v[176:177], v[92:93]
    v_pk_mul_f32 v[178:179], v[178:179], v[94:95]
    v_pk_mul_f32 v[180:181], v[180:181], v[108:109]
    v_pk_mul_f32 v[182:183], v[182:183], v[110:111]
    s_set_gpr_idx_on s76, gpr_idx(SRC2,DST)
    v_pk_fma_f32 v[8:9], v[176:177], v[144:145], v[8:9] op_sel:[0,0,0] op_sel_hi:[0,1,1]
    v_pk_fma_f32 v[10:11], v[176:177], v[146:147], v[10:11] op_sel:[0,0,0] op_sel_hi:[0,1,1]
    v_pk_fma_f32 v[12:13], v[180:181], v[148:149], v[12:13] op_sel:[0,0,0] op_sel_hi:[0,1,1]
    v_pk_fma_f32 v[14:15], v[180:181], v[150:151], v[14:15] op_sel:[0,0,0] op_sel_hi:[0,1,1]
    s_set_gpr_idx_idx s77
    v_pk_fma_f32 v[8:9], v[176:177], v[152:153], v[8:9] op_sel:[1,0,0] op_sel_hi:[1,1,1]
    v_pk_fma_f32 v[10:11], v[176:177], v[154:155], v[10:11] op_sel:[1,0,0] op_sel_hi:[1,1,1]
    v_pk_fma_f32 v[12:13], v[180:181], v[156:157], v[12:13] op_sel:[1,0,0] op_sel_hi:[1,1,1]
    v_pk_fma_f32 v[14:15], v[180:181], v[158:159], v[14:15] op_sel:[1,0,0] op_sel_hi:[1,1,1]
    s_set_gpr_idx_idx s78
    v_pk_fma_f32 v[8:9], v[178:179], v[160:161], v[8:9] op_sel:[0,0,0] op_sel_hi:[0,1,1]
    v_pk_fma_f32 v[10:11], v[178:179], v[162:163], v[10:11] op_sel:[0,0,0] op_sel_hi:[0,1,1]
    v_pk_fma_f32 v[12:13], v[182:183], v[164:165], v[12:13] op_sel:[0,0,0] op_sel_hi:[0,1,1]
    v_pk_fma_f32 v[14:15], v[182:183], v[166:167], v[14:15] op_sel:[0,0,0] op_sel_hi:[0,1,1]
    s_set_gpr_idx_idx s79
    v_pk_fma_f32 v[8:9], v[178:179], v[168:169], v[8:9] op_sel:[1,0,0] op_sel_hi:[1,1,1]
    v_pk_fma_f32 v[10:11], v[178:179], v[170:171], v[10:11] op_sel:[1,0,0] op_sel_hi:[1,1,1]
    v_pk_fma_f32 v[12:13], v[182:183], v[172:173], v[12:13] op_sel:[1,0,0] op_sel_hi:[1,1,1]
    v_pk_fma_f32 v[14:15], v[182:183], v[174:175], v[14:15] op_sel:[1,0,0] op_sel_hi:[1,1,1]
    s_set_gpr_idx_off
    s_cbranch_scc1 L_exit
    s_setprio 1
    s_waitcnt vmcnt(4)
    v_mfma_f32_4x4x4_16b_bf16 v[144:147], v[190:191], v[48:49], 0 cbsz:4 abid:0
    v_exp_f32 v176, v112
    v_mfma_f32_4x4x4_16b_bf16 v[148:151], v[190:191], v[50:51], 0 cbsz:4 abid:0
    v_exp_f32 v180, v128
    v_mfma_f32_4x4x4_16b_bf16 v[152:155], v[190:191], v[52:53], 0 cbsz:4 abid:1
    v_exp_f32 v177, v113
    v_mfma_f32_4x4x4_16b_bf16 v[156:159], v[190:191], v[54:55], 0 cbsz:4 abid:1
    v_exp_f32 v181, v129
    v_mfma_f32_4x4x4_16b_bf16 v[160:163], v[190:191], v[56:57], 0 cbsz:4 abid:2
    v_exp_f32 v178, v114
    v_mfma_f32_4x4x4_16b_bf16 v[164:167], v[190:191], v[58:59], 0 cbsz:4 abid:2
    v_exp_f32 v182, v130
    v_mfma_f32_4x4x4_16b_bf16 v[168:171], v[190:191], v[60:61], 0 cbsz:4 abid:3
    v_exp_f32 v179, v115
    v_mfma_f32_4x4x4_16b_bf16 v[172:175], v[190:191], v[62:63], 0 cbsz:4 abid:3
    v_exp_f32 v183, v131
    v_readlane_b32 s72, v228, 35
    v_readlane_b32 s73, v228, 39
    v_readlane_b32 s74, v228, 43
    v_readlane_b32 s75, v228, 47
    s_and_b32 s80, s72, s31
    v_pk_fma_f32 v[176:177], v[176:177], s[56:57], s[56:57]
    s_and_b32 s81, s73, s31
    v_pk_fma_f32 v[178:179], v[178:179], s[56:57], s[56:57]
    s_and_b32 s82, s74, s31
    v_pk_fma_f32 v[180:181], v[180:181], s[56:57], s[56:57]
    s_and_b32 s83, s75, s31
    v_pk_fma_f32 v[182:183], v[182:183], s[56:57], s[56:57]
    v_mfma_f32_32x32x16_bf16 v[80:95], v[192:195], v[200:203], 0
    v_rcp_f32 v176, v176
    v_rcp_f32 v177, v177
    v_rcp_f32 v178, v178
    v_rcp_f32 v179, v179
    v_rcp_f32 v180, v180
    buffer_load_dwordx4 v[48:51], v232, s[4:7], s80 offen
    v_rcp_f32 v181, v181
    buffer_load_dwordx4 v[52:55], v232, s[4:7], s81 offen
    v_rcp_f32 v182, v182
    buffer_load_dwordx4 v[56:59], v232, s[4:7], s82 offen
    v_rcp_f32 v183, v183
    buffer_load_dwordx4 v[60:63], v232, s[4:7], s83 offen
    s_cmp_le_i32 s30, 52
    s_mov_b64 exec, s[22:23]
    ds_read_b128 v[196:199], v229 offset:46080
    s_mov_b64 exec, -1
    ds_read_b32 v2, v231 offset:1292
    v_pk_mul_f32 v[176:177], v[176:177], v[112:113]
    v_pk_mul_f32 v[178:179], v[178:179], v[114:115]
    v_pk_mul_f32 v[180:181], v[180:181], v[128:129]
    v_pk_mul_f32 v[182:183], v[182:183], v[130:131]
    s_set_gpr_idx_on s64, gpr_idx(SRC2,DST)
    v_pk_fma_f32 v[8:9], v[176:177], v[144:145], v[8:9] op_sel:[0,0,0] op_sel_hi:[0,1,1]
    v_pk_fma_f32 v[10:11], v[176:177], v[146:147], v[10:11] op_sel:[0,0,0] op_sel_hi:[0,1,1]
    v_pk_fma_f32 v[12:13], v[180:181], v[148:149], v[12:13] op_sel:[0,0,0] op_sel_hi:[0,1,1]
    v_pk_fma_f32 v[14:15], v[180:181], v[150:151], v[14:15] op_sel:[0,0,0] op_sel_hi:[0,1,1]
    s_set_gpr_idx_idx s65
    v_pk_fma_f32 v[8:9], v[176:177], v[152:153], v[8:9] op_sel:[1,0,0] op_sel_hi:[1,1,1]
    v_pk_fma_f32 v[10:11], v[176:177], v[154:155], v[10:11] op_sel:[1,0,0] op_sel_hi:[1,1,1]
    v_pk_fma_f32 v[12:13], v[180:181], v[156:157], v[12:13] op_sel:[1,0,0] op_sel_hi:[1,1,1]
    v_pk_fma_f32 v[14:15], v[180:181], v[158:159], v[14:15] op_sel:[1,0,0] op_sel_hi:[1,1,1]
    s_set_gpr_idx_idx s66
    v_pk_fma_f32 v[8:9], v[178:179], v[160:161], v[8:9] op_sel:[0,0,0] op_sel_hi:[0,1,1]
    v_pk_fma_f32 v[10:11], v[178:179], v[162:163], v[10:11] op_sel:[0,0,0] op_sel_hi:[0,1,1]
    v_pk_fma_f32 v[12:13], v[182:183], v[164:165], v[12:13] op_sel:[0,0,0] op_sel_hi:[0,1,1]
    v_pk_fma_f32 v[14:15], v[182:183], v[166:167], v[14:15] op_sel:[0,0,0] op_sel_hi:[0,1,1]
    s_set_gpr_idx_idx s67
    v_pk_fma_f32 v[8:9], v[178:179], v[168:169], v[8:9] op_sel:[1,0,0] op_sel_hi:[1,1,1]
    v_pk_fma_f32 v[10:11], v[178:179], v[170:171], v[10:11] op_sel:[1,0,0] op_sel_hi:[1,1,1]
    v_pk_fma_f32 v[12:13], v[182:183], v[172:173], v[12:13] op_sel:[1,0,0] op_sel_hi:[1,1,1]
    v_pk_fma_f32 v[14:15], v[182:183], v[174:175], v[14:15] op_sel:[1,0,0] op_sel_hi:[1,1,1]
    s_set_gpr_idx_off
    s_cbranch_scc1 L_exit
    s_waitcnt vmcnt(4)
    v_mfma_f32_4x4x4_16b_bf16 v[144:147], v[190:191], v[64:65], 0 cbsz:4 abid:4
    v_exp_f32 v176, v116
    v_mfma_f32_4x4x4_16b_bf16 v[148:151], v[190:191], v[66:67], 0 cbsz:4 abid:4
    v_exp_f32 v180, v132
    v_mfma_f32_4x4x4_16b_bf16 v[152:155], v[190:191], v[68:69], 0 cbsz:4 abid:5
    v_exp_f32 v177, v117
    v_mfma_f32_4x4x4_16b_bf16 v[156:159], v[190:191], v[70:71], 0 cbsz:4 abid:5
    v_exp_f32 v181, v133
    v_mfma_f32_4x4x4_16b_bf16 v[160:163], v[190:191], v[72:73], 0 cbsz:4 abid:6
    v_exp_f32 v178, v118
    v_mfma_f32_4x4x4_16b_bf16 v[164:167], v[190:191], v[74:75], 0 cbsz:4 abid:6
    v_exp_f32 v182, v134
    v_mfma_f32_4x4x4_16b_bf16 v[168:171], v[190:191], v[76:77], 0 cbsz:4 abid:7
    v_exp_f32 v179, v119
    v_mfma_f32_4x4x4_16b_bf16 v[172:175], v[190:191], v[78:79], 0 cbsz:4 abid:7
    v_exp_f32 v183, v135
    v_readlane_b32 s76, v228, 51
    v_readlane_b32 s77, v228, 55
    v_readlane_b32 s78, v228, 59
    v_readlane_b32 s79, v228, 63
    s_and_b32 s80, s76, s31
    v_pk_fma_f32 v[176:177], v[176:177], s[56:57], s[56:57]
    s_and_b32 s81, s77, s31
    v_pk_fma_f32 v[178:179], v[178:179], s[56:57], s[56:57]
    s_and_b32 s82, s78, s31
    v_pk_fma_f32 v[180:181], v[180:181], s[56:57], s[56:57]
    s_and_b32 s83, s79, s31
    v_pk_fma_f32 v[182:183], v[182:183], s[56:57], s[56:57]
    v_mfma_f32_32x32x16_bf16 v[96:111], v[192:195], v[204:207], 0
    v_rcp_f32 v176, v176
    v_rcp_f32 v177, v177
    v_rcp_f32 v178, v178
    v_rcp_f32 v179, v179
    v_rcp_f32 v180, v180
    buffer_load_dwordx4 v[64:67], v232, s[4:7], s80 offen
    v_rcp_f32 v181, v181
    buffer_load_dwordx4 v[68:71], v232, s[4:7], s81 offen
    v_rcp_f32 v182, v182
    buffer_load_dwordx4 v[72:75], v232, s[4:7], s82 offen
    v_rcp_f32 v183, v183
    buffer_load_dwordx4 v[76:79], v232, s[4:7], s83 offen
    s_cmp_le_i32 s30, 56
    s_waitcnt lgkmcnt(0)
    v_pk_mul_f32 v[176:177], v[176:177], v[116:117]
    v_pk_mul_f32 v[178:179], v[178:179], v[118:119]
    v_pk_mul_f32 v[180:181], v[180:181], v[132:133]
    v_pk_mul_f32 v[182:183], v[182:183], v[134:135]
    s_set_gpr_idx_on s68, gpr_idx(SRC2,DST)
    v_pk_fma_f32 v[8:9], v[176:177], v[144:145], v[8:9] op_sel:[0,0,0] op_sel_hi:[0,1,1]
    v_pk_fma_f32 v[10:11], v[176:177], v[146:147], v[10:11] op_sel:[0,0,0] op_sel_hi:[0,1,1]
    v_pk_fma_f32 v[12:13], v[180:181], v[148:149], v[12:13] op_sel:[0,0,0] op_sel_hi:[0,1,1]
    v_pk_fma_f32 v[14:15], v[180:181], v[150:151], v[14:15] op_sel:[0,0,0] op_sel_hi:[0,1,1]
    s_set_gpr_idx_idx s69
    v_pk_fma_f32 v[8:9], v[176:177], v[152:153], v[8:9] op_sel:[1,0,0] op_sel_hi:[1,1,1]
    v_pk_fma_f32 v[10:11], v[176:177], v[154:155], v[10:11] op_sel:[1,0,0] op_sel_hi:[1,1,1]
    v_pk_fma_f32 v[12:13], v[180:181], v[156:157], v[12:13] op_sel:[1,0,0] op_sel_hi:[1,1,1]
    v_pk_fma_f32 v[14:15], v[180:181], v[158:159], v[14:15] op_sel:[1,0,0] op_sel_hi:[1,1,1]
    s_set_gpr_idx_idx s70
    v_pk_fma_f32 v[8:9], v[178:179], v[160:161], v[8:9] op_sel:[0,0,0] op_sel_hi:[0,1,1]
    v_pk_fma_f32 v[10:11], v[178:179], v[162:163], v[10:11] op_sel:[0,0,0] op_sel_hi:[0,1,1]
    v_pk_fma_f32 v[12:13], v[182:183], v[164:165], v[12:13] op_sel:[0,0,0] op_sel_hi:[0,1,1]
    v_pk_fma_f32 v[14:15], v[182:183], v[166:167], v[14:15] op_sel:[0,0,0] op_sel_hi:[0,1,1]
    s_set_gpr_idx_idx s71
    v_pk_fma_f32 v[8:9], v[178:179], v[168:169], v[8:9] op_sel:[1,0,0] op_sel_hi:[1,1,1]
    v_pk_fma_f32 v[10:11], v[178:179], v[170:171], v[10:11] op_sel:[1,0,0] op_sel_hi:[1,1,1]
    v_pk_fma_f32 v[12:13], v[182:183], v[172:173], v[12:13] op_sel:[1,0,0] op_sel_hi:[1,1,1]
    v_pk_fma_f32 v[14:15], v[182:183], v[174:175], v[14:15] op_sel:[1,0,0] op_sel_hi:[1,1,1]
    s_set_gpr_idx_off
    s_cbranch_scc1 L_exit
    s_setprio 0
    v_cndmask_b32 v228, v4, v226, s[34:35]
    s_waitcnt vmcnt(4)
    v_mfma_f32_4x4x4_16b_bf16 v[144:147], v[190:191], v[48:49], 0 cbsz:4 abid:8
    v_exp_f32 v176, v120
    v_mfma_f32_4x4x4_16b_bf16 v[148:151], v[190:191], v[50:51], 0 cbsz:4 abid:8
    v_exp_f32 v180, v136
    v_mfma_f32_4x4x4_16b_bf16 v[152:155], v[190:191], v[52:53], 0 cbsz:4 abid:9
    v_exp_f32 v177, v121
    v_mfma_f32_4x4x4_16b_bf16 v[156:159], v[190:191], v[54:55], 0 cbsz:4 abid:9
    v_exp_f32 v181, v137
    v_mfma_f32_4x4x4_16b_bf16 v[160:163], v[190:191], v[56:57], 0 cbsz:4 abid:10
    v_exp_f32 v178, v122
    v_mfma_f32_4x4x4_16b_bf16 v[164:167], v[190:191], v[58:59], 0 cbsz:4 abid:10
    v_exp_f32 v182, v138
    v_mfma_f32_4x4x4_16b_bf16 v[168:171], v[190:191], v[60:61], 0 cbsz:4 abid:11
    v_exp_f32 v179, v123
    v_mfma_f32_4x4x4_16b_bf16 v[172:175], v[190:191], v[62:63], 0 cbsz:4 abid:11
    v_exp_f32 v183, v139
    v_readlane_b32 s64, v228, 0
    v_readlane_b32 s65, v228, 4
    v_readlane_b32 s66, v228, 8
    v_readlane_b32 s67, v228, 12
    v_and_or_b32 v229, v2, s33, v233
    s_and_b32 s80, s64, s31
    v_pk_fma_f32 v[176:177], v[176:177], s[56:57], s[56:57]
    s_and_b32 s81, s65, s31
    v_pk_fma_f32 v[178:179], v[178:179], s[56:57], s[56:57]
    s_and_b32 s82, s66, s31
    v_pk_fma_f32 v[180:181], v[180:181], s[56:57], s[56:57]
    s_and_b32 s83, s67, s31
    v_pk_fma_f32 v[182:183], v[182:183], s[56:57], s[56:57]
    v_mfma_f32_32x32x16_bf16 v[80:95], v[196:199], v[208:211], v[80:95]
    v_rcp_f32 v176, v176
    v_rcp_f32 v177, v177
    v_rcp_f32 v178, v178
    v_rcp_f32 v179, v179
    v_rcp_f32 v180, v180
    buffer_load_dwordx4 v[48:51], v232, s[4:7], s80 offen
    v_rcp_f32 v181, v181
    buffer_load_dwordx4 v[52:55], v232, s[4:7], s81 offen
    v_rcp_f32 v182, v182
    buffer_load_dwordx4 v[56:59], v232, s[4:7], s82 offen
    v_rcp_f32 v183, v183
    buffer_load_dwordx4 v[60:63], v232, s[4:7], s83 offen
    s_cmp_le_i32 s30, 60
    s_mov_b64 exec, s[20:21]
    ds_read_b128 v[192:195], v229 offset:46080
    s_mov_b64 exec, -1
    v_pk_mul_f32 v[176:177], v[176:177], v[120:121]
    v_pk_mul_f32 v[178:179], v[178:179], v[122:123]
    v_pk_mul_f32 v[180:181], v[180:181], v[136:137]
    v_pk_mul_f32 v[182:183], v[182:183], v[138:139]
    s_set_gpr_idx_on s72, gpr_idx(SRC2,DST)
    v_pk_fma_f32 v[8:9], v[176:177], v[144:145], v[8:9] op_sel:[0,0,0] op_sel_hi:[0,1,1]
    v_pk_fma_f32 v[10:11], v[176:177], v[146:147], v[10:11] op_sel:[0,0,0] op_sel_hi:[0,1,1]
    v_pk_fma_f32 v[12:13], v[180:181], v[148:149], v[12:13] op_sel:[0,0,0] op_sel_hi:[0,1,1]
    v_pk_fma_f32 v[14:15], v[180:181], v[150:151], v[14:15] op_sel:[0,0,0] op_sel_hi:[0,1,1]
    s_set_gpr_idx_idx s73
    v_pk_fma_f32 v[8:9], v[176:177], v[152:153], v[8:9] op_sel:[1,0,0] op_sel_hi:[1,1,1]
    v_pk_fma_f32 v[10:11], v[176:177], v[154:155], v[10:11] op_sel:[1,0,0] op_sel_hi:[1,1,1]
    v_pk_fma_f32 v[12:13], v[180:181], v[156:157], v[12:13] op_sel:[1,0,0] op_sel_hi:[1,1,1]
    v_pk_fma_f32 v[14:15], v[180:181], v[158:159], v[14:15] op_sel:[1,0,0] op_sel_hi:[1,1,1]
    s_set_gpr_idx_idx s74
    v_pk_fma_f32 v[8:9], v[178:179], v[160:161], v[8:9] op_sel:[0,0,0] op_sel_hi:[0,1,1]
    v_pk_fma_f32 v[10:11], v[178:179], v[162:163], v[10:11] op_sel:[0,0,0] op_sel_hi:[0,1,1]
    v_pk_fma_f32 v[12:13], v[182:183], v[164:165], v[12:13] op_sel:[0,0,0] op_sel_hi:[0,1,1]
    v_pk_fma_f32 v[14:15], v[182:183], v[166:167], v[14:15] op_sel:[0,0,0] op_sel_hi:[0,1,1]
    s_set_gpr_idx_idx s75
    v_pk_fma_f32 v[8:9], v[178:179], v[168:169], v[8:9] op_sel:[1,0,0] op_sel_hi:[1,1,1]
    v_pk_fma_f32 v[10:11], v[178:179], v[170:171], v[10:11] op_sel:[1,0,0] op_sel_hi:[1,1,1]
    v_pk_fma_f32 v[12:13], v[182:183], v[172:173], v[12:13] op_sel:[1,0,0] op_sel_hi:[1,1,1]
    v_pk_fma_f32 v[14:15], v[182:183], v[174:175], v[14:15] op_sel:[1,0,0] op_sel_hi:[1,1,1]
    s_set_gpr_idx_off
    s_cbranch_scc1 L_exit
    s_waitcnt vmcnt(4)
    v_mfma_f32_4x4x4_16b_bf16 v[144:147], v[190:191], v[64:65], 0 cbsz:4 abid:12
    v_exp_f32 v176, v124
    v_mfma_f32_4x4x4_16b_bf16 v[148:151], v[190:191], v[66:67], 0 cbsz:4 abid:12
    v_exp_f32 v180, v140
    v_mfma_f32_4x4x4_16b_bf16 v[152:155], v[190:191], v[68:69], 0 cbsz:4 abid:13
    v_exp_f32 v177, v125
    v_mfma_f32_4x4x4_16b_bf16 v[156:159], v[190:191], v[70:71], 0 cbsz:4 abid:13
    v_exp_f32 v181, v141
    v_mfma_f32_4x4x4_16b_bf16 v[160:163], v[190:191], v[72:73], 0 cbsz:4 abid:14
    v_exp_f32 v178, v126
    v_mfma_f32_4x4x4_16b_bf16 v[164:167], v[190:191], v[74:75], 0 cbsz:4 abid:14
    v_exp_f32 v182, v142
    v_mfma_f32_4x4x4_16b_bf16 v[168:171], v[190:191], v[76:77], 0 cbsz:4 abid:15
    v_exp_f32 v179, v127
    v_mfma_f32_4x4x4_16b_bf16 v[172:175], v[190:191], v[78:79], 0 cbsz:4 abid:15
    v_exp_f32 v183, v143
    v_readlane_b32 s68, v228, 16
    v_readlane_b32 s69, v228, 20
    v_readlane_b32 s70, v228, 24
    v_readlane_b32 s71, v228, 28
    s_and_b32 s80, s68, s31
    v_pk_fma_f32 v[176:177], v[176:177], s[56:57], s[56:57]
    s_and_b32 s81, s69, s31
    v_pk_fma_f32 v[178:179], v[178:179], s[56:57], s[56:57]
    s_and_b32 s82, s70, s31
    v_pk_fma_f32 v[180:181], v[180:181], s[56:57], s[56:57]
    s_and_b32 s83, s71, s31
    v_pk_fma_f32 v[182:183], v[182:183], s[56:57], s[56:57]
    v_mfma_f32_32x32x16_bf16 v[96:111], v[196:199], v[212:215], v[96:111]
    v_rcp_f32 v176, v176
    v_rcp_f32 v177, v177
    v_rcp_f32 v178, v178
    v_rcp_f32 v179, v179
    v_rcp_f32 v180, v180
    buffer_load_dwordx4 v[64:67], v232, s[4:7], s80 offen
    v_rcp_f32 v181, v181
    buffer_load_dwordx4 v[68:71], v232, s[4:7], s81 offen
    v_rcp_f32 v182, v182
    buffer_load_dwordx4 v[72:75], v232, s[4:7], s82 offen
    v_rcp_f32 v183, v183
    buffer_load_dwordx4 v[76:79], v232, s[4:7], s83 offen
    s_waitcnt lgkmcnt(0)
    v_pk_mul_f32 v[176:177], v[176:177], v[124:125]
    v_pk_mul_f32 v[178:179], v[178:179], v[126:127]
    v_pk_mul_f32 v[180:181], v[180:181], v[140:141]
    v_pk_mul_f32 v[182:183], v[182:183], v[142:143]
    s_set_gpr_idx_on s76, gpr_idx(SRC2,DST)
    v_pk_fma_f32 v[8:9], v[176:177], v[144:145], v[8:9] op_sel:[0,0,0] op_sel_hi:[0,1,1]
    v_pk_fma_f32 v[10:11], v[176:177], v[146:147], v[10:11] op_sel:[0,0,0] op_sel_hi:[0,1,1]
    v_pk_fma_f32 v[12:13], v[180:181], v[148:149], v[12:13] op_sel:[0,0,0] op_sel_hi:[0,1,1]
    v_pk_fma_f32 v[14:15], v[180:181], v[150:151], v[14:15] op_sel:[0,0,0] op_sel_hi:[0,1,1]
    s_set_gpr_idx_idx s77
    v_pk_fma_f32 v[8:9], v[176:177], v[152:153], v[8:9] op_sel:[1,0,0] op_sel_hi:[1,1,1]
    v_pk_fma_f32 v[10:11], v[176:177], v[154:155], v[10:11] op_sel:[1,0,0] op_sel_hi:[1,1,1]
    v_pk_fma_f32 v[12:13], v[180:181], v[156:157], v[12:13] op_sel:[1,0,0] op_sel_hi:[1,1,1]
    v_pk_fma_f32 v[14:15], v[180:181], v[158:159], v[14:15] op_sel:[1,0,0] op_sel_hi:[1,1,1]
    s_set_gpr_idx_idx s78
    v_pk_fma_f32 v[8:9], v[178:179], v[160:161], v[8:9] op_sel:[0,0,0] op_sel_hi:[0,1,1]
    v_pk_fma_f32 v[10:11], v[178:179], v[162:163], v[10:11] op_sel:[0,0,0] op_sel_hi:[0,1,1]
    v_pk_fma_f32 v[12:13], v[182:183], v[164:165], v[12:13] op_sel:[0,0,0] op_sel_hi:[0,1,1]
    v_pk_fma_f32 v[14:15], v[182:183], v[166:167], v[14:15] op_sel:[0,0,0] op_sel_hi:[0,1,1]
    s_set_gpr_idx_idx s79
    v_pk_fma_f32 v[8:9], v[178:179], v[168:169], v[8:9] op_sel:[1,0,0] op_sel_hi:[1,1,1]
    v_pk_fma_f32 v[10:11], v[178:179], v[170:171], v[10:11] op_sel:[1,0,0] op_sel_hi:[1,1,1]
    v_pk_fma_f32 v[12:13], v[182:183], v[172:173], v[12:13] op_sel:[1,0,0] op_sel_hi:[1,1,1]
    v_pk_fma_f32 v[14:15], v[182:183], v[174:175], v[14:15] op_sel:[1,0,0] op_sel_hi:[1,1,1]
    s_set_gpr_idx_off
    v_add_u32 v231, 1024, v231
    s_sub_u32 s30, s30, 64
    s_branch L_sb
L_exit:
    s_setprio 0
    s_add_u32 s24, s24, 216
    s_cmp_lt_u32 s24, s25
    s_cbranch_scc0 L_epi
    v_lshlrev_b32 v7, 3, v0
    v_mov_b32 v2, 0
    v_mov_b32 v3, 0
    ds_write_b64 v7, v[2:3]
    s_waitcnt vmcnt(0) lgkmcnt(0)
    s_nop 15
    s_mul_i32 s26, s16, 5
    v_add_u32 v113, s26, v1
    v_subrev_u32 v3, 40, v113
    v_min_u32 v113, v113, v3
    v_mul_u32_u24 v3, 205, v1
    v_lshrrev_b32 v3, 10, v3
    v_mul_u32_u24 v2, 5, v3
    v_sub_u32 v115, v1, v2
    v_lshlrev_b32 v114, 2, v3
    s_lshl_b32 s81, s16, 10
    s_add_u32 s81, s81, 8192
    s_mul_i32 s80, s16, 6912
    v_lshl_add_u32 v121, v1, 2, s81
    v_lshrrev_b32 v3, 1, v1
    v_lshl_add_u32 v122, v3, 2, s81
    v_and_b32 v2, 1, v1
    v_lshlrev_b32 v123, 4, v2
    v_lshrrev_b32 v3, 1, v0
    v_mul_u32_u24 v3, 1280, v3
    v_add_u32 v124, v3, v2
    v_mul_u32_u24 v125, 48, v113
    s_lshl_b32 s26, s16, 2
    v_lshl_add_u32 v126, v115, 5, s26
    v_lshl_add_u32 v127, v1, 5, s80
    v_mov_b32 v80, 0xffffff
    v_mov_b32 v81, 0xffffff
    v_mov_b32 v82, 0xffffff
    v_mov_b32 v83, 0xffffff
    v_add_u32 v2, s81, v232
    ds_write_b128 v2, v[80:83]
    s_barrier
    v_and_b32 v2, 1, v0
    v_max_u32 v3, s24, v235
    v_add_u32 v3, v3, v2
    s_add_u32 s27, s24, 216
    v_min_u32 v4, s27, v236
    v_add_u32 v5, v237, v3
    s_lshl_b32 s27, s24, 2
    s_sub_u32 s27, s81, s27
    v_lshl_add_u32 v6, v3, 2, s27
    v_sub_u32 v4, v4, v3
    s_branch L_exp
L_exp_more:
    v_add_u32 v6, 48, v6
    v_subrev_u32 v4, 12, v4
    s_branch L_exp
L_epi:
    s_waitcnt lgkmcnt(0)
    v_readfirstlane_b32 s38, v243
    v_lshlrev_b32 v2, 2, v1
    v_add_u32 v3, s48, v2
    v_cvt_pk_bf16_f32 v8, v8, v12
    v_cvt_pk_bf16_f32 v9, v9, v13
    v_cvt_pk_bf16_f32 v10, v10, v14
    v_cvt_pk_bf16_f32 v11, v11, v15
    ds_write2_b32 v3, v8, v9 offset0:0 offset1:72
    ds_write2_b32 v3, v10, v11 offset0:144 offset1:216
    v_add_u32 v3, s49, v2
    v_cvt_pk_bf16_f32 v16, v16, v20
    v_cvt_pk_bf16_f32 v17, v17, v21
    v_cvt_pk_bf16_f32 v18, v18, v22
    v_cvt_pk_bf16_f32 v19, v19, v23
    ds_write2_b32 v3, v16, v17 offset0:0 offset1:72
    ds_write2_b32 v3, v18, v19 offset0:144 offset1:216
    v_add_u32 v3, s50, v2
    v_cvt_pk_bf16_f32 v24, v24, v28
    v_cvt_pk_bf16_f32 v25, v25, v29
    v_cvt_pk_bf16_f32 v26, v26, v30
    v_cvt_pk_bf16_f32 v27, v27, v31
    ds_write2_b32 v3, v24, v25 offset0:0 offset1:72
    ds_write2_b32 v3, v26, v27 offset0:144 offset1:216
    v_add_u32 v3, s51, v2
    v_cvt_pk_bf16_f32 v32, v32, v36
    v_cvt_pk_bf16_f32 v33, v33, v37
    v_cvt_pk_bf16_f32 v34, v34, v38
    v_cvt_pk_bf16_f32 v35, v35, v39
    ds_write2_b32 v3, v32, v33 offset0:0 offset1:72
    ds_write2_b32 v3, v34, v35 offset0:144 offset1:216
    v_add_u32 v3, s52, v2
    v_cvt_pk_bf16_f32 v40, v40, v44
    v_cvt_pk_bf16_f32 v41, v41, v45
    v_cvt_pk_bf16_f32 v42, v42, v46
    v_cvt_pk_bf16_f32 v43, v43, v47
    ds_write2_b32 v3, v40, v41 offset0:0 offset1:72
    ds_write2_b32 v3, v42, v43 offset0:144 offset1:216
    s_cmp_eq_u32 s38, 8
    s_cbranch_scc0 L_nob
    ds_read_b128 v[192:195], v240 offset:0
    ds_read_b128 v[208:211], v240 offset:256
    ds_read_b128 v[196:199], v240 offset:8192
    ds_read_b128 v[212:215], v240 offset:8448
    ds_read_b128 v[200:203], v240 offset:16384
    ds_read_b128 v[216:219], v240 offset:16640
    ds_read_b128 v[204:207], v240 offset:24576
    ds_read_b128 v[220:223], v240 offset:24832
    s_waitcnt lgkmcnt(8)
    s_barrier
    s_branch L_haveb
L_nob:
    s_waitcnt lgkmcnt(0)
    s_barrier
    ds_read_b128 v[192:195], v240 offset:0
    ds_read_b128 v[208:211], v240 offset:256
    ds_read_b128 v[196:199], v240 offset:8192
    ds_read_b128 v[212:215], v240 offset:8448
    ds_read_b128 v[200:203], v240 offset:16384
    ds_read_b128 v[216:219], v240 offset:16640
    ds_read_b128 v[204:207], v240 offset:24576
    ds_read_b128 v[220:223], v240 offset:24832
L_haveb:
    ds_read_b128 v[80:83], v241 offset:0
    ds_read_b128 v[84:87], v241 offset:64
    ds_read_b128 v[88:91], v241 offset:128
    ds_read_b128 v[92:95], v241 offset:192
    ds_read_b128 v[96:99], v241 offset:4608
    ds_read_b128 v[100:103], v241 offset:4672
    ds_read_b128 v[104:107], v241 offset:4736
    ds_read_b128 v[108:111], v241 offset:4800
    ds_read_b128 v[112:115], v241 offset:9216
    ds_read_b128 v[116:119], v241 offset:9280
    ds_read_b128 v[120:123], v241 offset:9344
    ds_read_b128 v[124:127], v241 offset:9408
    s_waitcnt lgkmcnt(11)
    v_mfma_f32_16x16x32_bf16 v[8:11], v[80:83], v[192:195], 0
    v_mfma_f32_16x16x32_bf16 v[12:15], v[80:83], v[208:211], 0
    ds_read_b128 v[128:131], v241 offset:13824
    ds_read_b128 v[132:135], v241 offset:13888
    ds_read_b128 v[136:139], v241 offset:13952
    ds_read_b128 v[140:143], v241 offset:14016
    s_waitcnt lgkmcnt(14)
    v_mfma_f32_16x16x32_bf16 v[8:11], v[84:87], v[196:199], v[8:11]
    v_mfma_f32_16x16x32_bf16 v[12:15], v[84:87], v[212:215], v[12:15]
    s_waitcnt lgkmcnt(13)
    v_mfma_f32_16x16x32_bf16 v[8:11], v[88:91], v[200:203], v[8:11]
    v_mfma_f32_16x16x32_bf16 v[12:15], v[88:91], v[216:219], v[12:15]
    s_waitcnt lgkmcnt(12)
    v_mfma_f32_16x16x32_bf16 v[8:11], v[92:95], v[204:207], v[8:11]
    v_mfma_f32_16x16x32_bf16 v[12:15], v[92:95], v[220:223], v[12:15]
    s_waitcnt lgkmcnt(11)
    v_mfma_f32_16x16x32_bf16 v[16:19], v[96:99], v[192:195], 0
    v_mfma_f32_16x16x32_bf16 v[20:23], v[96:99], v[208:211], 0
    ds_read_b128 v[144:147], v241 offset:18432
    ds_read_b128 v[148:151], v241 offset:18496
    ds_read_b128 v[152:155], v241 offset:18560
    ds_read_b128 v[156:159], v241 offset:18624
    s_waitcnt lgkmcnt(14)
    v_mfma_f32_16x16x32_bf16 v[16:19], v[100:103], v[196:199], v[16:19]
    v_mfma_f32_16x16x32_bf16 v[20:23], v[100:103], v[212:215], v[20:23]
    s_waitcnt lgkmcnt(13)
    v_mfma_f32_16x16x32_bf16 v[16:19], v[104:107], v[200:203], v[16:19]
    v_mfma_f32_16x16x32_bf16 v[20:23], v[104:107], v[216:219], v[20:23]
    v_cvt_pk_bf16_f32 v160, v8, v9
    v_cvt_pk_bf16_f32 v161, v10, v11
    v_cvt_pk_bf16_f32 v162, v12, v13
    v_cvt_pk_bf16_f32 v163, v14, v15
    buffer_store_dwordx4 v[160:163], v242, s[12:15], 0 offen sc1
    v_add_u32 v242, 1048576, v242
    s_waitcnt lgkmcnt(12)
    v_mfma_f32_16x16x32_bf16 v[16:19], v[108:111], v[204:207], v[16:19]
    v_mfma_f32_16x16x32_bf16 v[20:23], v[108:111], v[220:223], v[20:23]
    s_waitcnt lgkmcnt(11)
    v_mfma_f32_16x16x32_bf16 v[24:27], v[112:115], v[192:195], 0
    v_mfma_f32_16x16x32_bf16 v[28:31], v[112:115], v[208:211], 0
    s_waitcnt lgkmcnt(10)
    v_mfma_f32_16x16x32_bf16 v[24:27], v[116:119], v[196:199], v[24:27]
    v_mfma_f32_16x16x32_bf16 v[28:31], v[116:119], v[212:215], v[28:31]
    s_waitcnt lgkmcnt(9)
    v_mfma_f32_16x16x32_bf16 v[24:27], v[120:123], v[200:203], v[24:27]
    v_mfma_f32_16x16x32_bf16 v[28:31], v[120:123], v[216:219], v[28:31]
    v_cvt_pk_bf16_f32 v164, v16, v17
    v_cvt_pk_bf16_f32 v165, v18, v19
    v_cvt_pk_bf16_f32 v166, v20, v21
    v_cvt_pk_bf16_f32 v167, v22, v23
    buffer_store_dwordx4 v[164:167], v242, s[12:15], 0 offen sc1
    v_add_u32 v242, 1048576, v242
    s_waitcnt lgkmcnt(8)
    v_mfma_f32_16x16x32_bf16 v[24:27], v[124:127], v[204:207], v[24:27]
    v_mfma_f32_16x16x32_bf16 v[28:31], v[124:127], v[220:223], v[28:31]
    s_waitcnt lgkmcnt(7)
    v_mfma_f32_16x16x32_bf16 v[32:35], v[128:131], v[192:195], 0
    v_mfma_f32_16x16x32_bf16 v[36:39], v[128:131], v[208:211], 0
    s_waitcnt lgkmcnt(6)
    v_mfma_f32_16x16x32_bf16 v[32:35], v[132:135], v[196:199], v[32:35]
    v_mfma_f32_16x16x32_bf16 v[36:39], v[132:135], v[212:215], v[36:39]
    s_waitcnt lgkmcnt(5)
    v_mfma_f32_16x16x32_bf16 v[32:35], v[136:139], v[200:203], v[32:35]
    v_mfma_f32_16x16x32_bf16 v[36:39], v[136:139], v[216:219], v[36:39]
    v_cvt_pk_bf16_f32 v168, v24, v25
    v_cvt_pk_bf16_f32 v169, v26, v27
    v_cvt_pk_bf16_f32 v170, v28, v29
    v_cvt_pk_bf16_f32 v171, v30, v31
    buffer_store_dwordx4 v[168:171], v242, s[12:15], 0 offen sc1
    v_add_u32 v242, 1048576, v242
    s_waitcnt lgkmcnt(4)
    v_mfma_f32_16x16x32_bf16 v[32:35], v[140:143], v[204:207], v[32:35]
    v_mfma_f32_16x16x32_bf16 v[36:39], v[140:143], v[220:223], v[36:39]
    s_waitcnt lgkmcnt(3)
    v_mfma_f32_16x16x32_bf16 v[40:43], v[144:147], v[192:195], 0
    v_mfma_f32_16x16x32_bf16 v[44:47], v[144:147], v[208:211], 0
    s_waitcnt lgkmcnt(2)
    v_mfma_f32_16x16x32_bf16 v[40:43], v[148:151], v[196:199], v[40:43]
    v_mfma_f32_16x16x32_bf16 v[44:47], v[148:151], v[212:215], v[44:47]
    s_waitcnt lgkmcnt(1)
    v_mfma_f32_16x16x32_bf16 v[40:43], v[152:155], v[200:203], v[40:43]
    v_mfma_f32_16x16x32_bf16 v[44:47], v[152:155], v[216:219], v[44:47]
    v_cvt_pk_bf16_f32 v172, v32, v33
    v_cvt_pk_bf16_f32 v173, v34, v35
    v_cvt_pk_bf16_f32 v174, v36, v37
    v_cvt_pk_bf16_f32 v175, v38, v39
    buffer_store_dwordx4 v[172:175], v242, s[12:15], 0 offen sc1
    v_add_u32 v242, 1048576, v242
    s_waitcnt lgkmcnt(0)
    v_mfma_f32_16x16x32_bf16 v[40:43], v[156:159], v[204:207], v[40:43]
    v_mfma_f32_16x16x32_bf16 v[44:47], v[156:159], v[220:223], v[44:47]
    s_nop 7
    v_cvt_pk_bf16_f32 v160, v40, v41
    v_cvt_pk_bf16_f32 v161, v42, v43
    v_cvt_pk_bf16_f32 v162, v44, v45
    v_cvt_pk_bf16_f32 v163, v46, v47
    buffer_store_dwordx4 v[160:163], v242, s[12:15], 0 offen sc1
    s_cmp_eq_u32 s53, 0
    s_cbranch_scc0 L_fin
    v_mov_b32 v144, 0
    v_mov_b32 v145, 1
    s_mov_b64 exec, 1
    buffer_store_dword v145, v144, s[44:47], 0 offen sc1
    s_mov_b64 exec, -1
L_fin:
L_end:
    s_endpgm
.section .rodata,"a"
.p2align 6
.amdhsa_kernel standalone__tensor_product_equiv_tfn__graph_kernel
.amdhsa_next_free_vgpr 245
.amdhsa_next_free_sgpr 100
.amdhsa_accum_offset 248
.amdhsa_group_segment_fixed_size 0
.amdhsa_kernarg_size 88
.amdhsa_user_sgpr_count 2
.amdhsa_user_sgpr_kernarg_segment_ptr 1
.amdhsa_system_sgpr_workgroup_id_x 1
.amdhsa_float_denorm_mode_32 3
.end_amdhsa_kernel
```

```asm
; @launch grid=(256,1,1) block=(512,1,1) lds=161808
.amdgcn_target "amdgcn-amd-amdhsa--gfx950"
.text
.globl standalone__tensor_product_equiv_tfn__graph_kernel
.p2align 8
.type standalone__tensor_product_equiv_tfn__graph_kernel,@function
standalone__tensor_product_equiv_tfn__graph_kernel:
    s_cmp_ge_u32 s2, 256
    s_cbranch_scc1 L_end
    s_load_dwordx16 s[36:51], s[0:1], 0
    s_load_dwordx4 s[52:55], s[0:1], 64
    s_load_dwordx2 s[56:57], s[0:1], 80
    v_lshrrev_b32 v2, 6, v0
    v_and_b32 v1, 63, v0
    v_readfirstlane_b32 s16, v2
    s_and_b32 s17, s2, 7
    s_lshl_b32 s17, s17, 5
    s_lshr_b32 s26, s2, 3
    s_or_b32 s17, s17, s26
    v_lshlrev_b32 v7, 3, v0
    v_mov_b32 v2, 0
    v_mov_b32 v3, 0
    v_mov_b32 v4, 161792
    ds_write_b64 v7, v[2:3]
    ds_write_b32 v4, v2
    v_lshlrev_b32 v232, 4, v1
    s_mul_i32 s26, s16, 160
    v_add_u32 v6, s26, v1
    v_lshlrev_b32 v53, 2, v6
    v_lshlrev_b32 v54, 3, v6
    s_mul_i32 s26, s16, 1920
    v_add_u32 v55, s26, v232
    s_mul_i32 s26, s16, 5120
    v_add_u32 v56, s26, v232
    s_cmp_lt_u32 s16, 7
    s_cselect_b32 s60, -1, 3
    s_mov_b32 s61, 0
    s_cselect_b64 s[62:63], -1, 15
    s_cselect_b32 s34, -1, 0xff
    s_cselect_b32 s35, 0xffffff, s34
    s_mul_i32 s58, s17, 5000
    s_mul_i32 s59, s17, 10000
    s_lshl_b32 s29, s17, 6
    s_add_u32 s29, s29, 14417920
    s_waitcnt lgkmcnt(0)
    s_mov_b32 s64, s40
    s_mov_b32 s65, s41
    s_mov_b32 s66, 1280000
    s_mov_b32 s67, 0x00020000
    buffer_load_dword v144, v53, s[64:67], s58 offen offset:0
    buffer_load_dword v145, v53, s[64:67], s58 offen offset:256
    s_mov_b64 exec, s[60:61]
    buffer_load_dword v146, v53, s[64:67], s58 offen offset:512
    s_mov_b64 exec, -1
    s_getpc_b64 s[82:83]
L_pc:
    s_lshr_b32 s80, s2, 3
    s_lshl_b32 s80, s80, 3
    s_add_u32 s80, s80, s16
    s_lshl_b32 s81, s80, 6
    s_min_u32 s81, s81, L_end-L_pc
    s_load_dword s3, s[82:83], s81
    s_lshl_b32 s81, s80, 7
    s_load_dword s3, s[50:51], s81
    s_add_u32 s81, s81, 64
    s_load_dword s3, s[50:51], s81
    s_lshl_b32 s81, s80, 4
    s_load_dword s3, s[46:47], s81
    s_and_b32 s81, s80, 64
    s_load_dword s3, s[48:49], s81
    s_mov_b32 s68, s38
    s_mov_b32 s69, s39
    s_mov_b32 s70, 1280000
    s_mov_b32 s71, 0x00020000
    buffer_load_dword v147, v53, s[68:71], s58 offen offset:0
    buffer_load_dword v148, v53, s[68:71], s58 offen offset:256
    s_mov_b64 exec, s[60:61]
    buffer_load_dword v149, v53, s[68:71], s58 offen offset:512
    s_mov_b64 exec, -1
    s_mov_b32 s72, s42
    s_mov_b32 s73, s43
    s_mov_b32 s74, 2560000
    s_mov_b32 s75, 0x00020000
    buffer_load_dwordx2 v[152:153], v54, s[72:75], s59 offen offset:0
    buffer_load_dwordx2 v[156:157], v54, s[72:75], s59 offen offset:512
    s_mov_b64 exec, s[60:61]
    buffer_load_dwordx2 v[160:161], v54, s[72:75], s59 offen offset:1024
    s_mov_b64 exec, -1
    s_mov_b32 s8, s56
    s_mov_b32 s9, s57
    s_mov_b32 s10, 16777216
    s_mov_b32 s11, 0x00020000
    s_mov_b32 s76, s44
    s_mov_b32 s77, s45
    s_mov_b32 s78, 10240000
    s_mov_b32 s79, 0x00020000
    s_barrier
    s_add_u32 m0, s26, 61440
    s_mul_i32 s58, s17, 40000
    buffer_load_dwordx4 v56, s[76:79], s58 offen offset:0  lds
    buffer_load_dwordx4 v56, s[76:79], s58 offen offset:1024  lds
    buffer_load_dwordx4 v56, s[76:79], s58 offen offset:2048  lds
    buffer_load_dwordx4 v56, s[76:79], s58 offen offset:3072  lds
    s_add_u32 m0, s26, 65536
    s_add_u32 s58, s58, 4096
    s_mov_b64 exec, s[62:63]
    buffer_load_dwordx4 v56, s[76:79], s58 offen  lds
    s_mov_b64 exec, -1
    v_mov_b32 v6, 1
    v_lshrrev_b32 v7, 2, v1
    v_mul_u32_u24 v7, 16320, v7
    v_add_u32 v72, v7, v232
    s_cmp_eq_u32 s16, 7
    s_cselect_b32 s59, s29, 0x40000000
    v_add_u32 v7, s59, v72
    buffer_load_dwordx4 v[64:67], v7, s[8:11], 0 offen sc1
    s_waitcnt vmcnt(12)
    v_bfe_u32 v2, v144, 3, 5
    v_and_b32 v3, 7, v144
    v_lshl_or_b32 v2, v3, 5, v2
    v_lshlrev_b32 v167, 2, v2
    ds_add_rtn_u32 v164, v167, v6 offset:3072
    v_bfe_u32 v2, v145, 3, 5
    v_and_b32 v3, 7, v145
    v_lshl_or_b32 v2, v3, 5, v2
    v_lshlrev_b32 v168, 2, v2
    ds_add_rtn_u32 v165, v168, v6 offset:3072
    s_mov_b64 exec, s[60:61]
    v_bfe_u32 v2, v146, 3, 5
    v_and_b32 v3, 7, v146
    v_lshl_or_b32 v2, v3, 5, v2
    v_lshlrev_b32 v169, 2, v2
    ds_add_rtn_u32 v166, v169, v6 offset:3072
    s_mov_b64 exec, -1
    s_movk_i32 s27, 5033
    s_waitcnt vmcnt(9)
    s_movk_i32 s59, -1250
    v_lshrrev_b32 v3, 7, v167
    v_mad_i32_i24 v2, v3, s59, v147
    v_add_u32 v3, 10000, v2
    v_min_u32 v2, v2, v3
    v_mul_u32_u24 v2, s27, v2
    v_lshrrev_b32 v2, 22, v2
    v_lshrrev_b32 v3, 8, v144
    v_mad_u32_u24 v2, v3, 12, v2
    v_lshl_or_b32 v154, v147, 10, v2
    v_lshrrev_b32 v3, 7, v168
    v_mad_i32_i24 v2, v3, s59, v148
    v_add_u32 v3, 10000, v2
    v_min_u32 v2, v2, v3
    v_mul_u32_u24 v2, s27, v2
    v_lshrrev_b32 v2, 22, v2
    v_lshrrev_b32 v3, 8, v145
    v_mad_u32_u24 v2, v3, 12, v2
    v_lshl_or_b32 v158, v148, 10, v2
    v_lshrrev_b32 v3, 7, v169
    v_mad_i32_i24 v2, v3, s59, v149
    v_add_u32 v3, 10000, v2
    v_min_u32 v2, v2, v3
    v_mul_u32_u24 v2, s27, v2
    v_lshrrev_b32 v2, 22, v2
    v_lshrrev_b32 v3, 8, v146
    v_mad_u32_u24 v2, v3, 12, v2
    v_lshl_or_b32 v162, v149, 10, v2
    s_waitcnt lgkmcnt(0)
    s_barrier
    ds_read_b128 v[172:175], v232 offset:3072
    s_waitcnt lgkmcnt(0)
    v_add_u32 v50, v172, v173
    v_add_u32 v51, v50, v174
    v_add_u32 v2, v51, v175
    v_mov_b32 v3, v2
    v_lshlrev_b32 v4, 2, v54
    v_lshrrev_b32 v5, 1, v0
    v_add_u32_dpp v3, v3, v3 row_shr:1 row_mask:0xf bank_mask:0xf
    s_lshr_b32 s59, s17, 4
    s_mul_i32 s59, s59, 16320
    v_add_u32_dpp v3, v3, v3 row_shr:2 row_mask:0xf bank_mask:0xf
    s_lshl2_add_u32 s59, s17, s59
    s_add_u32 s59, s59, 14417920
    v_add_u32_dpp v3, v3, v3 row_shr:4 row_mask:0xf bank_mask:0xf
    v_lshl_add_u32 v58, v5, 6, s59
    s_nop 0
    v_add_u32_dpp v3, v3, v3 row_shr:8 row_mask:0xf bank_mask:0xf
    s_nop 1
    v_add_u32_dpp v3, v3, v3 row_bcast:15 row_mask:0xa bank_mask:0xf
    s_nop 1
    v_add_u32_dpp v3, v3, v3 row_bcast:31 row_mask:0xc bank_mask:0xf
    v_sub_u32 v48, v3, v2
    v_add_u32 v49, v48, v172
    v_add_u32 v50, v48, v50
    v_add_u32 v51, v48, v51
    ds_write_b128 v232, v[48:51] offset:10752
    ds_read_b32 v167, v167 offset:10752
    ds_read_b32 v168, v168 offset:10752
    s_mov_b64 exec, s[60:61]
    ds_read_b32 v169, v169 offset:10752
    s_mov_b64 exec, -1
    v_lshl_or_b32 v60, v172, 16, v48
    v_lshl_or_b32 v61, v173, 16, v49
    v_lshl_or_b32 v62, v174, 16, v50
    v_lshl_or_b32 v63, v175, 16, v51
    s_mov_b32 s27, 46080
    s_waitcnt vmcnt(6) lgkmcnt(0)
    v_add_lshl_u32 v2, v167, v164, 1
    v_add_u32 v3, 0, v4
    ds_write_b16 v2, v3 offset:8192
    v_mad_u32_u24 v2, v2, 6, s27
    ds_write2_b32 v2, v152, v153 offset0:0 offset1:1
    ds_write_b32 v2, v154 offset:8
    v_add_lshl_u32 v2, v168, v165, 1
    v_add_u32 v3, 2048, v4
    ds_write_b16 v2, v3 offset:8192
    v_mad_u32_u24 v2, v2, 6, s27
    ds_write2_b32 v2, v156, v157 offset0:0 offset1:1
    ds_write_b32 v2, v158 offset:8
    s_mov_b64 exec, s[60:61]
    v_add_lshl_u32 v2, v169, v166, 1
    v_add_u32 v3, 4096, v4
    ds_write_b16 v2, v3 offset:8192
    v_mad_u32_u24 v2, v2, 6, s27
    ds_write2_b32 v2, v160, v161 offset0:0 offset1:1
    ds_write_b32 v2, v162 offset:8
    s_mov_b64 exec, -1
    v_lshrrev_b32 v2, 4, v56
    v_and_b32 v2, 0xffe, v2
    v_and_b32 v5, 1, v1
    v_lshlrev_b32 v5, 4, v5
    s_waitcnt lgkmcnt(0)
    s_barrier
    buffer_load_dword v59, v58, s[8:11], 0 offen sc1
    s_mov_b32 s68, s46
    s_mov_b32 s69, s47
    s_mov_b32 s70, 4096
    s_mov_b32 s71, 0x00020000
    s_mov_b32 s64, s48
    s_mov_b32 s65, s49
    s_mov_b32 s66, 128
    s_mov_b32 s67, 0x00020000
    v_lshlrev_b32 v7, 1, v1
    s_lshl_b32 s58, s16, 9
    s_add_u32 m0, s58, 16384
    s_mov_b32 exec_hi, 0
    buffer_load_dwordx4 v232, s[68:71], s58 offen lds
    s_mov_b32 exec_hi, -1
    buffer_load_ushort v57, v7, s[64:67], 0 offen
    ds_read_b128 v[152:155], v55 offset:46080
    ds_read_b128 v[156:159], v55 offset:47104
    ds_read_u16 v164, v2 offset:8192
    ds_read_u16 v165, v2 offset:8256
    ds_read_u16 v166, v2 offset:8320
    ds_read_u16 v167, v2 offset:8384
    ds_read_u16 v168, v2 offset:8448
    s_mov_b32 s4, s36
    s_mov_b32 s5, s37
    s_mov_b32 s6, 10240000
    s_mov_b32 s7, 0x00020000
    s_mov_b32 s12, s52
    s_mov_b32 s13, s53
    s_mov_b32 s14, 10240000
    s_mov_b32 s15, 0x00020000
    s_mov_b32 s20, 0x0f0f0f0f
    s_mov_b32 s21, 0x0f0f0f0f
    s_mov_b32 s22, 0xf0f0f0f0
    s_mov_b32 s23, 0xf0f0f0f0
    s_mov_b32 s31, 0xfffffc00
    s_mov_b32 s32, 0x9c4028
    s_mov_b32 s33, 0xffe0
    s_mov_b32 s24, 0
    s_mov_b32 s25, 0
    v_mov_b32 v8, 0
    v_mov_b32 v9, 0
    v_mov_b32 v10, 0
    v_mov_b32 v11, 0
    v_mov_b32 v12, 0
    v_mov_b32 v13, 0
    v_mov_b32 v14, 0
    v_mov_b32 v15, 0
    v_mov_b32 v16, 0
    v_mov_b32 v17, 0
    v_mov_b32 v18, 0
    v_mov_b32 v19, 0
    v_mov_b32 v20, 0
    v_mov_b32 v21, 0
    v_mov_b32 v22, 0
    v_mov_b32 v23, 0
    v_mov_b32 v24, 0
    v_mov_b32 v25, 0
    v_mov_b32 v26, 0
    v_mov_b32 v27, 0
    v_mov_b32 v28, 0
    v_mov_b32 v29, 0
    v_mov_b32 v30, 0
    v_mov_b32 v31, 0
    v_mov_b32 v32, 0
    v_mov_b32 v33, 0
    v_mov_b32 v34, 0
    v_mov_b32 v35, 0
    v_mov_b32 v36, 0
    v_mov_b32 v37, 0
    v_mov_b32 v38, 0
    v_mov_b32 v39, 0
    v_mov_b32 v40, 0
    v_mov_b32 v41, 0
    v_mov_b32 v42, 0
    v_mov_b32 v43, 0
    v_mov_b32 v44, 0
    v_mov_b32 v45, 0
    v_mov_b32 v46, 0
    v_mov_b32 v47, 0
    v_mov_b32 v192, 0
    v_mov_b32 v193, 0
    v_mov_b32 v194, 0
    v_mov_b32 v195, 0
    v_mov_b32 v196, 0
    v_mov_b32 v197, 0
    v_mov_b32 v198, 0
    v_mov_b32 v199, 0
    v_mov_b32 v112, 0
    v_mov_b32 v238, 0
    s_cmp_lt_u32 s2, 16
    s_cbranch_scc1 L_map40
    v_writelane_b32 v112, 0, 0
    v_writelane_b32 v112, 5, 1
    v_writelane_b32 v112, 6, 2
    v_writelane_b32 v112, 3, 3
    v_writelane_b32 v112, 8, 4
    v_writelane_b32 v112, 7, 5
    v_writelane_b32 v112, 2, 6
    v_writelane_b32 v112, 4, 7
    v_writelane_b32 v112, 1, 8
    v_writelane_b32 v112, 16, 9
    v_writelane_b32 v112, 10, 10
    v_writelane_b32 v112, 15, 11
    v_writelane_b32 v112, 9, 12
    v_writelane_b32 v112, 24, 13
    v_writelane_b32 v112, 14, 14
    v_writelane_b32 v112, 11, 15
    v_writelane_b32 v112, 13, 16
    v_writelane_b32 v112, 12, 17
    v_writelane_b32 v112, 17, 18
    v_writelane_b32 v112, 23, 19
    v_writelane_b32 v112, 20, 20
    v_writelane_b32 v112, 22, 21
    v_writelane_b32 v112, 19, 22
    v_writelane_b32 v112, 18, 23
    v_writelane_b32 v112, 21, 24
    v_writelane_b32 v112, 28, 25
    v_writelane_b32 v112, 29, 26
    v_writelane_b32 v112, 31, 27
    v_writelane_b32 v112, 26, 28
    v_writelane_b32 v112, 25, 29
    v_writelane_b32 v112, 27, 30
    v_writelane_b32 v112, 30, 31
    v_writelane_b32 v112, 36, 32
    v_writelane_b32 v112, 33, 33
    v_writelane_b32 v112, 35, 34
    v_writelane_b32 v112, 34, 35
    v_writelane_b32 v112, 38, 36
    v_writelane_b32 v112, 39, 37
    v_writelane_b32 v112, 37, 38
    v_writelane_b32 v112, 32, 39
    s_branch L_mapd
L_map40:
    v_writelane_b32 v112, 7, 0
    v_writelane_b32 v112, 0, 1
    v_writelane_b32 v112, 5, 2
    v_writelane_b32 v112, 2, 3
    v_writelane_b32 v112, 4, 4
    v_writelane_b32 v112, 3, 5
    v_writelane_b32 v112, 1, 6
    v_writelane_b32 v112, 6, 7
    v_writelane_b32 v112, 12, 8
    v_writelane_b32 v112, 9, 9
    v_writelane_b32 v112, 14, 10
    v_writelane_b32 v112, 11, 11
    v_writelane_b32 v112, 15, 12
    v_writelane_b32 v112, 10, 13
    v_writelane_b32 v112, 8, 14
    v_writelane_b32 v112, 13, 15
    v_writelane_b32 v112, 21, 16
    v_writelane_b32 v112, 22, 17
    v_writelane_b32 v112, 19, 18
    v_writelane_b32 v112, 16, 19
    v_writelane_b32 v112, 23, 20
    v_writelane_b32 v112, 17, 21
    v_writelane_b32 v112, 18, 22
    v_writelane_b32 v112, 20, 23
    v_writelane_b32 v112, 26, 24
    v_writelane_b32 v112, 29, 25
    v_writelane_b32 v112, 27, 26
    v_writelane_b32 v112, 25, 27
    v_writelane_b32 v112, 28, 28
    v_writelane_b32 v112, 30, 29
    v_writelane_b32 v112, 24, 30
    v_writelane_b32 v112, 31, 31
    v_writelane_b32 v112, 38, 32
    v_writelane_b32 v112, 33, 33
    v_writelane_b32 v112, 36, 34
    v_writelane_b32 v112, 35, 35
    v_writelane_b32 v112, 34, 36
    v_writelane_b32 v112, 32, 37
    v_writelane_b32 v112, 37, 38
    v_writelane_b32 v112, 39, 39
L_mapd:
    v_and_b32 v2, 3, v1
    v_lshrrev_b32 v3, 2, v1
    v_lshl_add_u32 v234, v2, 4, v3
    v_lshrrev_b32 v2, 5, v1
    v_lshlrev_b32 v233, 4, v2
    s_mul_i32 s26, s16, 5
    v_add_u32 v113, s26, v1
    v_subrev_u32 v3, 40, v113
    v_min_u32 v113, v113, v3
    v_mul_u32_u24 v3, 205, v1
    v_lshrrev_b32 v3, 10, v3
    v_mul_u32_u24 v2, 5, v3
    v_sub_u32 v115, v1, v2
    v_lshlrev_b32 v114, 2, v3
    s_lshl_b32 s81, s16, 10
    s_add_u32 s81, s81, 8192
    s_mul_i32 s80, s16, 6912
    v_lshl_add_u32 v121, v1, 2, s81
    v_lshrrev_b32 v3, 1, v1
    v_lshl_add_u32 v122, v3, 2, s81
    v_and_b32 v2, 1, v1
    v_lshlrev_b32 v123, 4, v2
    v_lshrrev_b32 v3, 1, v0
    v_mul_u32_u24 v3, 1280, v3
    v_add_u32 v124, v3, v2
    v_mul_u32_u24 v125, 48, v113
    s_lshl_b32 s26, s16, 2
    v_lshl_add_u32 v126, v115, 5, s26
    v_lshl_add_u32 v127, v1, 5, s80
    s_and_b32 s26, s16, 3
    s_lshl_b32 s58, s26, 9
    s_add_u32 s58, s58, 129024
    v_lshrrev_b32 v3, 4, v1
    v_mul_u32_u24 v2, 1792, v3
    v_add3_u32 v240, v2, s58, v232
    s_lshr_b32 s58, s16, 2
    v_and_b32 v2, 15, v1
    v_mul_u32_u24 v241, 288, v2
    v_lshl_add_u32 v241, v3, 4, v241
    s_mul_i32 s59, s58, 23040
    v_add_u32 v241, s59, v241
    v_lshlrev_b32 v242, 18, v3
    v_lshl_add_u32 v242, v2, 4, v242
    s_mul_i32 s58, s58, 5242880
    s_lshl_b32 s59, s2, 10
    s_add_u32 s58, s58, s59
    s_lshl_b32 s59, s26, 8
    s_add_u32 s58, s58, s59
    v_add_u32 v242, s58, v242
    v_mov_b32 v244, 161792
    s_mov_b32 s72, s50
    s_mov_b32 s73, s51
    s_mov_b32 s74, 32768
    s_mov_b32 s75, 0x00020000
    s_mov_b32 s44, s54
    s_mov_b32 s45, s55
    s_mov_b32 s46, 256
    s_mov_b32 s47, 0x00020000
    s_waitcnt lgkmcnt(0)
    v_or_b32 v164, v164, v5
    v_or_b32 v165, v165, v5
    v_or_b32 v166, v166, v5
    v_or_b32 v167, v167, v5
    v_or_b32 v168, v168, v5
    s_mul_i32 s27, s17, 15360
    s_add_u32 s27, s27, 10485760
    s_mul_i32 s58, s17, 40960
    s_add_u32 s59, s58, 4096
    s_waitcnt vmcnt(4)
    s_barrier
    ds_read_b128 v[80:83], v164 offset:61440
    ds_read_b128 v[84:87], v165 offset:61440
    ds_read_b128 v[88:91], v166 offset:61440
    ds_read_b128 v[92:95], v167 offset:61440
    s_mov_b64 exec, s[62:63]
    ds_read_b128 v[96:99], v168 offset:61440
    s_mov_b64 exec, -1
    s_waitcnt vmcnt(2)
    buffer_store_dwordx4 v[152:155], v55, s[8:11], s27 offen sc1
    s_mov_b32 exec_hi, s35
    buffer_store_dwordx4 v[156:159], v55, s[8:11], s27 offen offset:1024 sc1
    s_mov_b32 exec_hi, -1
    s_waitcnt lgkmcnt(4)
    buffer_store_dwordx4 v[80:83], v56, s[8:11], s58 offen offset:0 sc1
    s_waitcnt lgkmcnt(3)
    buffer_store_dwordx4 v[84:87], v56, s[8:11], s58 offen offset:1024 sc1
    s_waitcnt lgkmcnt(2)
    buffer_store_dwordx4 v[88:91], v56, s[8:11], s58 offen offset:2048 sc1
    s_waitcnt lgkmcnt(1)
    buffer_store_dwordx4 v[92:95], v56, s[8:11], s58 offen offset:3072 sc1
    s_mov_b32 exec_lo, s34
    s_mov_b32 exec_hi, s63
    s_waitcnt lgkmcnt(0)
    buffer_store_dwordx4 v[96:99], v56, s[8:11], s59 offen offset:0 sc1
    s_mov_b64 exec, -1
    s_mov_b32 s30, 400000
    s_mov_b32 s53, 0
    s_brev_b32 s59, 1
    s_waitcnt vmcnt(7)
    v_not_b32 v64, v64
    v_and_or_b32 v60, v64, s59, v60
    v_not_b32 v65, v65
    v_and_or_b32 v61, v65, s59, v61
    v_not_b32 v66, v66
    v_and_or_b32 v62, v66, s59, v62
    v_not_b32 v67, v67
    v_and_or_b32 v63, v67, s59, v63
    v_and_b32 v2, 0x30, v1
    v_and_b32 v3, 3, v1
    v_lshl_add_u32 v2, v3, 2, v2
    v_bfe_u32 v7, v1, 2, 2
    v_add_lshl_u32 v2, v2, v7, 1
    ds_write_b16 v2, v57 offset:6656
    v_lshlrev_b32 v3, 3, v3
    ds_read_b64 v[216:217], v3 offset:6656
    ds_read_b64 v[218:219], v3 offset:6688
    ds_read_b64 v[220:221], v3 offset:6720
    ds_read_b64 v[222:223], v3 offset:6752
    s_lshl_b32 s58, s16, 12
    s_add_u32 m0, s58, 129024
    s_cmp_eq_u32 s16, 7
    s_waitcnt vmcnt(0) lgkmcnt(0)
    s_barrier
    s_cbranch_scc0 L_nrow2
    buffer_store_dwordx4 v[60:63], v72, s[8:11], s29 offen sc1
L_nrow2:
    s_barrier
    buffer_load_dwordx4 v232, s[72:75], s58 offen offset:0 lds
    buffer_load_dwordx4 v232, s[72:75], s58 offen offset:1024 lds
    buffer_load_dwordx4 v232, s[72:75], s58 offen offset:2048 lds
    buffer_load_dwordx4 v232, s[72:75], s58 offen offset:3072 lds
    v_and_b32 v3, 31, v1
    v_lshlrev_b32 v2, 7, v233
    v_lshl_add_u32 v2, v3, 2, v2
    v_add_u32 v3, 128, v2
    ds_read2st64_b32 v[144:145], v2 offset0:64 offset1:65
    ds_read2st64_b32 v[146:147], v2 offset0:66 offset1:67
    ds_read2st64_b32 v[148:149], v2 offset0:68 offset1:69
    ds_read2st64_b32 v[150:151], v2 offset0:70 offset1:71
    ds_read2st64_b32 v[152:153], v3 offset0:64 offset1:65
    ds_read2st64_b32 v[154:155], v3 offset0:66 offset1:67
    ds_read2st64_b32 v[156:157], v3 offset0:68 offset1:69
    ds_read2st64_b32 v[158:159], v3 offset0:70 offset1:71
    s_mov_b32 s56, 0xbfb8aa3b
    s_mov_b32 s57, 0xbfb8aa3b
    s_waitcnt lgkmcnt(7)
    v_lshlrev_b32 v160, 16, v144
    v_lshlrev_b32 v161, 16, v145
    v_and_b32 v162, 0xffff0000, v144
    v_and_b32 v163, 0xffff0000, v145
    v_pk_mul_f32 v[160:161], v[160:161], s[56:57]
    v_pk_mul_f32 v[162:163], v[162:163], s[56:57]
    v_cvt_pk_bf16_f32 v200, v160, v161
    v_cvt_pk_bf16_f32 v204, v162, v163
    s_waitcnt lgkmcnt(6)
    v_lshlrev_b32 v160, 16, v146
    v_lshlrev_b32 v161, 16, v147
    v_and_b32 v162, 0xffff0000, v146
    v_and_b32 v163, 0xffff0000, v147
    v_pk_mul_f32 v[160:161], v[160:161], s[56:57]
    v_pk_mul_f32 v[162:163], v[162:163], s[56:57]
    v_cvt_pk_bf16_f32 v201, v160, v161
    v_cvt_pk_bf16_f32 v205, v162, v163
    s_waitcnt lgkmcnt(5)
    v_lshlrev_b32 v160, 16, v148
    v_lshlrev_b32 v161, 16, v149
    v_and_b32 v162, 0xffff0000, v148
    v_and_b32 v163, 0xffff0000, v149
    v_pk_mul_f32 v[160:161], v[160:161], s[56:57]
    v_pk_mul_f32 v[162:163], v[162:163], s[56:57]
    v_cvt_pk_bf16_f32 v202, v160, v161
    v_cvt_pk_bf16_f32 v206, v162, v163
    s_waitcnt lgkmcnt(4)
    v_lshlrev_b32 v160, 16, v150
    v_lshlrev_b32 v161, 16, v151
    v_and_b32 v162, 0xffff0000, v150
    v_and_b32 v163, 0xffff0000, v151
    v_pk_mul_f32 v[160:161], v[160:161], s[56:57]
    v_pk_mul_f32 v[162:163], v[162:163], s[56:57]
    v_cvt_pk_bf16_f32 v203, v160, v161
    v_cvt_pk_bf16_f32 v207, v162, v163
    s_waitcnt lgkmcnt(3)
    v_lshlrev_b32 v160, 16, v152
    v_lshlrev_b32 v161, 16, v153
    v_and_b32 v162, 0xffff0000, v152
    v_and_b32 v163, 0xffff0000, v153
    v_pk_mul_f32 v[160:161], v[160:161], s[56:57]
    v_pk_mul_f32 v[162:163], v[162:163], s[56:57]
    v_cvt_pk_bf16_f32 v208, v160, v161
    v_cvt_pk_bf16_f32 v212, v162, v163
    s_waitcnt lgkmcnt(2)
    v_lshlrev_b32 v160, 16, v154
    v_lshlrev_b32 v161, 16, v155
    v_and_b32 v162, 0xffff0000, v154
    v_and_b32 v163, 0xffff0000, v155
    v_pk_mul_f32 v[160:161], v[160:161], s[56:57]
    v_pk_mul_f32 v[162:163], v[162:163], s[56:57]
    v_cvt_pk_bf16_f32 v209, v160, v161
    v_cvt_pk_bf16_f32 v213, v162, v163
    s_waitcnt lgkmcnt(1)
    v_lshlrev_b32 v160, 16, v156
    v_lshlrev_b32 v161, 16, v157
    v_and_b32 v162, 0xffff0000, v156
    v_and_b32 v163, 0xffff0000, v157
    v_pk_mul_f32 v[160:161], v[160:161], s[56:57]
    v_pk_mul_f32 v[162:163], v[162:163], s[56:57]
    v_cvt_pk_bf16_f32 v210, v160, v161
    v_cvt_pk_bf16_f32 v214, v162, v163
    s_waitcnt lgkmcnt(0)
    v_lshlrev_b32 v160, 16, v158
    v_lshlrev_b32 v161, 16, v159
    v_and_b32 v162, 0xffff0000, v158
    v_and_b32 v163, 0xffff0000, v159
    v_pk_mul_f32 v[160:161], v[160:161], s[56:57]
    v_pk_mul_f32 v[162:163], v[162:163], s[56:57]
    v_cvt_pk_bf16_f32 v211, v160, v161
    v_cvt_pk_bf16_f32 v215, v162, v163
    v_mov_b32 v80, 0xffffff
    v_mov_b32 v81, 0xffffff
    v_mov_b32 v82, 0xffffff
    v_mov_b32 v83, 0xffffff
    v_add_u32 v2, s81, v232
    ds_write_b128 v2, v[80:83]
    v_and_b32 v7, 1, v1
L_pa:
    buffer_load_dword v6, v58, s[8:11], 0 offen sc1
L_pwa:
    s_waitcnt vmcnt(0)
    v_xor_b32 v144, v6, v59
    v_cmpx_le_i32 vcc, 0, v144
    s_cbranch_execz L_pda
    s_sub_u32 s30, s30, 1
    s_cbranch_scc1 L_end
    s_and_b32 s58, s30, 7
    s_cbranch_scc1 L_pa
    v_mov_b32 v144, 0
    buffer_load_dword v145, v144, s[44:47], 0 offen sc1
    s_waitcnt vmcnt(0)
    v_readfirstlane_b32 s53, v145
    s_cmp_eq_u32 s53, 0
    s_cbranch_scc1 L_pa
    buffer_load_dword v6, v58, s[8:11], 0 offen sc1
    s_waitcnt vmcnt(0)
L_pda:
    s_mov_b64 exec, -1
    v_bfe_u32 v236, v6, 16, 11
    v_and_b32 v5, 0xffff, v6
    v_sub_u32 v2, v236, v7
    v_add_u32_dpp v236, v236, v236 row_shr:2 row_mask:0xf bank_mask:0xf
    v_add_u32 v5, v5, v124
    s_nop 0
    v_add_u32_dpp v236, v236, v236 row_shr:4 row_mask:0xf bank_mask:0xf
    s_nop 1
    v_add_u32_dpp v236, v236, v236 row_shr:8 row_mask:0xf bank_mask:0xf
    s_nop 1
    v_add_u32_dpp v236, v236, v236 row_bcast:15 row_mask:0xa bank_mask:0xf
    s_nop 1
    v_add_u32_dpp v236, v236, v236 row_bcast:31 row_mask:0xc bank_mask:0xf
    v_sub_u32 v3, v236, v2
    v_min_u32 v4, 216, v236
    v_lshl_add_u32 v6, v3, 2, s81
    v_sub_u32 v4, v4, v3
    v_sub_u32 v237, v5, v3
    v_sub_u32 v235, v3, v7
L_exp:
    v_cmpx_lt_i32 vcc, 0, v4
    ds_write_b32 v6, v5 offset:0
    v_add_u32 v5, 2, v5
    v_cmpx_lt_i32 vcc, 2, v4
    ds_write_b32 v6, v5 offset:8
    v_add_u32 v5, 2, v5
    v_cmpx_lt_i32 vcc, 4, v4
    ds_write_b32 v6, v5 offset:16
    v_add_u32 v5, 2, v5
    v_cmpx_lt_i32 vcc, 6, v4
    ds_write_b32 v6, v5 offset:24
    v_add_u32 v5, 2, v5
    v_cmpx_lt_i32 vcc, 8, v4
    ds_write_b32 v6, v5 offset:32
    v_add_u32 v5, 2, v5
    v_cmpx_lt_i32 vcc, 10, v4
    ds_write_b32 v6, v5 offset:40
    v_add_u32 v5, 2, v5
    v_cmpx_lt_i32 vcc, 12, v4
    s_cbranch_execnz L_exp_more
L_exp_done:
    s_mov_b64 exec, -1
    ds_read_b32 v99, v121 offset:768
    ds_read_b32 v98, v121 offset:512
    ds_read_b32 v97, v121 offset:256
    ds_read_b32 v96, v121 offset:0
    v_readlane_b32 s19, v236, 63
    s_mov_b32 s26, 10485760
    s_sub_i32 s28, s19, s24
    s_cmp_le_i32 s28, 192
    s_cbranch_scc1 L_sk3
    s_waitcnt lgkmcnt(3)
    v_mul_u32_u24 v99, 12, v99
    buffer_load_dwordx3 v[92:94], v99, s[8:11], s26 offen sc1
L_sk3:
    s_waitcnt lgkmcnt(2)
    v_mul_u32_u24 v98, 12, v98
    buffer_load_dwordx3 v[88:90], v98, s[8:11], s26 offen sc1
    s_waitcnt lgkmcnt(1)
    v_mul_u32_u24 v97, 12, v97
    buffer_load_dwordx3 v[84:86], v97, s[8:11], s26 offen sc1
    s_waitcnt lgkmcnt(0)
    v_mul_u32_u24 v96, 12, v96
    buffer_load_dwordx3 v[80:82], v96, s[8:11], s26 offen sc1
    ds_read_b32 v100, v122 offset:0
    ds_read_b32 v101, v122 offset:128
    ds_read_b32 v102, v122 offset:256
    ds_read_b32 v103, v122 offset:384
    ds_read_b32 v104, v122 offset:512
    ds_read_b32 v105, v122 offset:640
    ds_read_b32 v106, v122 offset:768
    s_max_i32 s28, s28, 0
    s_min_i32 s28, s28, 216
    s_barrier
    s_waitcnt lgkmcnt(6)
    v_lshl_or_b32 v100, v100, 5, v123
    s_add_u32 m0, s80, 46080
    s_cmp_le_u32 s28, 32
    buffer_load_dwordx4 v100, s[8:11], 0 offen sc1 lds
    s_waitcnt lgkmcnt(5)
    v_lshl_or_b32 v101, v101, 5, v123
    s_add_u32 m0, s80, 47104
    s_cmp_le_u32 s28, 64
    buffer_load_dwordx4 v101, s[8:11], 0 offen sc1 lds
    s_waitcnt lgkmcnt(0)
    v_lshl_or_b32 v102, v102, 5, v123
    v_lshl_or_b32 v103, v103, 5, v123
    v_lshl_or_b32 v104, v104, 5, v123
    v_lshl_or_b32 v105, v105, 5, v123
    v_lshl_or_b32 v106, v106, 5, v123
    s_sub_i32 s27, s28, 0
    v_cmp_gt_i32 s[36:37], s27, v1
    s_sub_i32 s27, s28, 64
    v_cmp_gt_i32 s[38:39], s27, v1
    s_sub_i32 s27, s28, 128
    v_cmp_gt_i32 s[40:41], s27, v1
    s_sub_i32 s27, s28, 192
    v_cmp_gt_i32 s[42:43], s27, v1
    v_mov_b32 v3, s19
    v_mov_b32 v4, 2048
    ds_max_u32 v4, v3
    v_mov_b32 v6, 1
    s_waitcnt vmcnt(5)
    s_mov_b64 exec, s[42:43]
    v_and_b32 v2, 0x3ff, v94
    v_lshlrev_b32 v95, 2, v2
    ds_add_rtn_u32 v111, v95, v6 offset:0
    s_waitcnt vmcnt(4)
    s_mov_b64 exec, s[40:41]
    v_and_b32 v2, 0x3ff, v90
    v_lshlrev_b32 v91, 2, v2
    ds_add_rtn_u32 v110, v91, v6 offset:0
    s_waitcnt vmcnt(3)
    s_mov_b64 exec, s[38:39]
    v_and_b32 v2, 0x3ff, v86
    v_lshlrev_b32 v87, 2, v2
    ds_add_rtn_u32 v109, v87, v6 offset:0
    s_waitcnt vmcnt(2)
    s_mov_b64 exec, s[36:37]
    v_and_b32 v2, 0x3ff, v82
    v_lshlrev_b32 v83, 2, v2
    ds_add_rtn_u32 v108, v83, v6 offset:0
    s_mov_b64 exec, -1
    s_waitcnt lgkmcnt(0)
    s_barrier
    ds_read_b128 v[148:151], v125 offset:0
    ds_read_b128 v[152:155], v125 offset:16
    ds_read_b128 v[156:159], v125 offset:32
    ds_read_b32 v4, v4
    s_lshl_b32 s26, s2, 3
    s_add_u32 s26, s26, s16
    s_add_u32 s26, s26, s24
    s_cmp_eq_u32 s26, 7
    s_cbranch_scc0 L_noall
    v_mov_b32 v144, 0
    v_mov_b32 v145, 1
    s_mov_b64 exec, 1
    buffer_store_dword v145, v144, s[44:47], 0 offen sc1
    s_mov_b64 exec, -1
L_noall:
    s_cmp_le_u32 s28, 64
    s_cbranch_scc1 L_efd
    s_add_u32 m0, s80, 48128
    s_cmp_le_u32 s28, 96
    buffer_load_dwordx4 v102, s[8:11], 0 offen sc1 lds
    s_cbranch_scc1 L_efd
    s_add_u32 m0, s80, 49152
    s_cmp_le_u32 s28, 128
    buffer_load_dwordx4 v103, s[8:11], 0 offen sc1 lds
    s_cbranch_scc1 L_efd
    s_add_u32 m0, s80, 50176
    s_cmp_le_u32 s28, 160
    buffer_load_dwordx4 v104, s[8:11], 0 offen sc1 lds
    s_cbranch_scc1 L_efd
    s_add_u32 m0, s80, 51200
    s_cmp_le_u32 s28, 192
    buffer_load_dwordx4 v105, s[8:11], 0 offen sc1 lds
    s_cbranch_scc1 L_efd
    s_add_u32 m0, s80, 52224
    s_cmp_le_u32 s28, 224
    s_mov_b32 exec_hi, 0xffff
    buffer_load_dwordx4 v106, s[8:11], 0 offen sc1 lds
    s_mov_b32 exec_hi, -1
L_efd:
    v_cmp_gt_u32 vcc, 40, v1
    s_waitcnt lgkmcnt(0)
    v_readfirstlane_b32 s26, v4
    v_add_u32 v3, v148, v149
    v_add3_u32 v3, v3, v150, v151
    v_add3_u32 v3, v3, v152, v153
    v_add3_u32 v3, v3, v154, v155
    v_add3_u32 v3, v3, v156, v157
    v_add3_u32 v3, v3, v158, v159
    v_lshl_or_b32 v3, v3, 6, v113
    v_cndmask_b32 v3, 0, v3, vcc
    s_max_u32 s25, s25, s26
    s_cmp_lg_u32 s24, 0
    s_cbranch_scc1 L_havepos
    v_readlane_b32 s64, v3, 0
    v_readlane_b32 s65, v3, 1
    v_readlane_b32 s66, v3, 2
    v_readlane_b32 s67, v3, 3
    v_readlane_b32 s68, v3, 4
    v_cmp_lt_u32 s[70:71], s64, v3
    v_cmp_lt_u32 s[72:73], s65, v3
    v_cmp_lt_u32 s[74:75], s66, v3
    v_cmp_lt_u32 s[76:77], s67, v3
    v_cmp_lt_u32 s[78:79], s68, v3
    s_bcnt1_i32_b64 s64, s[70:71]
    s_bcnt1_i32_b64 s65, s[72:73]
    s_bcnt1_i32_b64 s66, s[74:75]
    s_bcnt1_i32_b64 s67, s[76:77]
    s_bcnt1_i32_b64 s68, s[78:79]
    v_readlane_b32 s70, v112, s64
    v_readlane_b32 s71, v112, s65
    v_readlane_b32 s72, v112, s66
    v_readlane_b32 s73, v112, s67
    v_readlane_b32 s74, v112, s68
    v_writelane_b32 v238, s70, 0
    v_writelane_b32 v238, s71, 1
    v_writelane_b32 v238, s72, 2
    v_writelane_b32 v238, s73, 3
    v_writelane_b32 v238, s74, 4
    v_lshlrev_b32 v238, 2, v238
L_havepos:
    s_mov_b64 exec, 31
    ds_write_b32 v238, v3 offset:4096
    s_mov_b64 exec, -1
    v_lshlrev_b32 v4, 2, v1
    v_and_b32 v6, 7, v1
    v_cmp_gt_u32 s[34:35], s16, v6
    s_and_b64 s[34:35], s[34:35], vcc
    v_cmp_gt_u32 vcc, 60, v1
    s_waitcnt lgkmcnt(0)
    s_barrier
    ds_read_b32 v119, v126 offset:4096
    ds_read_b32 v4, v4 offset:4096
    s_waitcnt lgkmcnt(1)
    v_and_b32 v119, 63, v119
    v_mad_u32_u24 v3, v119, 48, v114
    ds_read_b32 v116, v3 offset:0
    s_waitcnt lgkmcnt(1)
    v_lshrrev_b32 v4, 6, v4
    v_cndmask_b32 v118, 0, v4, s[34:35]
    v_mul_u32_u24 v119, 1152, v119
    s_waitcnt lgkmcnt(0)
    v_cndmask_b32 v116, 0, v116, vcc
    v_mov_b32 v117, v116
    v_readlane_b32 s48, v119, 0
    v_readlane_b32 s49, v119, 1
    v_add_u32_dpp v117, v117, v117 row_shr:1 row_mask:0xf bank_mask:0xf
    v_add_u32_dpp v118, v118, v118 row_shr:1 row_mask:0xf bank_mask:0xf
    v_readlane_b32 s50, v119, 2
    v_add_u32_dpp v117, v117, v117 row_shr:2 row_mask:0xf bank_mask:0xf
    v_add_u32_dpp v118, v118, v118 row_shr:2 row_mask:0xf bank_mask:0xf
    v_readlane_b32 s51, v119, 3
    v_add_u32_dpp v117, v117, v117 row_shr:4 row_mask:0xf bank_mask:0xf
    v_add_u32_dpp v118, v118, v118 row_shr:4 row_mask:0xf bank_mask:0xf
    v_readlane_b32 s52, v119, 4
    v_add_u32_dpp v117, v117, v117 row_shr:8 row_mask:0xf bank_mask:0xf
    v_add_u32_dpp v118, v118, v118 row_shr:8 row_mask:0xf bank_mask:0xf
    v_lshlrev_b32 v4, 3, v115
    v_add_u32_dpp v117, v117, v117 row_bcast:15 row_mask:0xa bank_mask:0xf
    v_add_u32_dpp v118, v118, v118 row_bcast:15 row_mask:0xa bank_mask:0xf
    s_min_u32 s25, s25, 40000
    v_add_u32_dpp v117, v117, v117 row_bcast:31 row_mask:0xc bank_mask:0xf
    v_add_u32_dpp v118, v118, v118 row_bcast:31 row_mask:0xc bank_mask:0xf
    v_sub_u32 v116, v117, v116
    v_readlane_b32 s29, v118, 63
    v_readlane_b32 s18, v117, 63
    s_lshl_b32 s26, s29, 4
    s_add_u32 s26, s26, 101376
    v_lshl_add_u32 v116, v116, 4, s26
    v_lshl_or_b32 v116, v116, 10, v4
    s_mov_b64 exec, vcc
    ds_write_b32 v3, v116 offset:4608
    s_mov_b64 exec, -1
    s_min_u32 s18, s18, 1728
    v_lshl_add_u32 v230, v234, 4, s26
    v_and_b32 v2, 3, v1
    v_bfe_u32 v3, v1, 3, 2
    v_lshl_add_u32 v2, v3, 2, v2
    v_lshl_add_u32 v231, v2, 4, s26
    s_movk_i32 s27, 1023
    s_waitcnt lgkmcnt(0)
    s_barrier
    s_mov_b64 exec, s[36:37]
    ds_read_b32 v96, v83 offset:4608
    s_mov_b64 exec, s[38:39]
    ds_read_b32 v97, v87 offset:4608
    s_mov_b64 exec, s[40:41]
    ds_read_b32 v98, v91 offset:4608
    s_mov_b64 exec, s[42:43]
    ds_read_b32 v99, v95 offset:4608
    s_mov_b64 exec, -1
    v_add_u32 v83, 0, v127
    v_add_u32 v87, 2048, v127
    v_add_u32 v91, 4096, v127
    v_add_u32 v95, 6144, v127
    s_waitcnt lgkmcnt(0)
    s_mov_b64 exec, s[36:37]
    v_bfi_b32 v82, s27, v96, v82
    v_lshrrev_b32 v96, 10, v96
    v_lshl_add_u32 v96, v108, 4, v96
    ds_write_b128 v96, v[80:83]
    s_mov_b64 exec, s[38:39]
    v_bfi_b32 v86, s27, v97, v86
    v_lshrrev_b32 v97, 10, v97
    v_lshl_add_u32 v97, v109, 4, v97
    ds_write_b128 v97, v[84:87]
    s_mov_b64 exec, s[40:41]
    v_bfi_b32 v90, s27, v98, v90
    v_lshrrev_b32 v98, 10, v98
    v_lshl_add_u32 v98, v110, 4, v98
    ds_write_b128 v98, v[88:91]
    s_mov_b64 exec, s[42:43]
    v_bfi_b32 v94, s27, v99, v94
    v_lshrrev_b32 v99, 10, v99
    v_lshl_add_u32 v99, v111, 4, v99
    ds_write_b128 v99, v[92:95]
    s_mov_b64 exec, -1
    v_cmp_gt_i32 vcc, s18, v234
    v_mov_b32 v4, s32
    s_waitcnt lgkmcnt(0)
    s_barrier
    ds_read_b128 v[224:227], v230
    ds_read_b32 v229, v231 offset:12
    ds_read_b32 v2, v231 offset:268
    s_mov_b32 s59, 101376
    s_waitcnt lgkmcnt(0)
    v_cndmask_b32 v228, v4, v226, vcc
    v_and_or_b32 v229, v229, s33, v233
    v_readlane_b32 s64, v228, 0
    v_readlane_b32 s65, v228, 4
    v_readlane_b32 s66, v228, 8
    v_readlane_b32 s67, v228, 12
    v_readlane_b32 s68, v228, 16
    v_readlane_b32 s69, v228, 20
    v_readlane_b32 s70, v228, 24
    v_readlane_b32 s71, v228, 28
    s_and_b32 s80, s64, s31
    buffer_load_dwordx4 v[48:51], v232, s[4:7], s80 offen
    s_and_b32 s81, s65, s31
    buffer_load_dwordx4 v[52:55], v232, s[4:7], s81 offen
    s_and_b32 s82, s66, s31
    buffer_load_dwordx4 v[56:59], v232, s[4:7], s82 offen
    s_and_b32 s83, s67, s31
    buffer_load_dwordx4 v[60:63], v232, s[4:7], s83 offen
    s_waitcnt vmcnt(4)
    s_barrier
    s_mov_b64 exec, s[20:21]
    ds_read_b128 v[192:195], v229 offset:46080
    s_mov_b64 exec, s[22:23]
    ds_read_b128 v[196:199], v229 offset:46080
    s_mov_b64 exec, -1
    v_and_or_b32 v229, v2, s33, v233
    s_waitcnt lgkmcnt(0)
    v_mfma_f32_32x32x16_bf16 v[80:95], v[192:195], v[200:203], 0
    v_mfma_f32_32x32x16_bf16 v[96:111], v[192:195], v[204:207], 0
    v_mfma_f32_32x32x16_bf16 v[80:95], v[196:199], v[208:211], v[80:95]
    v_mfma_f32_32x32x16_bf16 v[96:111], v[196:199], v[212:215], v[96:111]
    s_and_b32 s80, s68, s31
    buffer_load_dwordx4 v[64:67], v232, s[4:7], s80 offen
    s_and_b32 s81, s69, s31
    buffer_load_dwordx4 v[68:71], v232, s[4:7], s81 offen
    s_and_b32 s82, s70, s31
    buffer_load_dwordx4 v[72:75], v232, s[4:7], s82 offen
    s_and_b32 s83, s71, s31
    buffer_load_dwordx4 v[76:79], v232, s[4:7], s83 offen
    s_mov_b64 exec, s[20:21]
    ds_read_b128 v[192:195], v229 offset:46080
    s_mov_b64 exec, -1
    s_cmp_lg_u32 s24, 0
    s_cbranch_scc1 L_wdone
    v_lshrrev_b32 v7, 5, v0
    v_and_b32 v3, 31, v1
    v_lshlrev_b32 v7, 11, v7
    v_add_u32 v7, 129024, v7
    v_lshl_add_u32 v2, v3, 3, v7
    ds_read_b64 v[160:161], v2 offset:0
    ds_read_b64 v[162:163], v2 offset:256
    ds_read_b64 v[164:165], v2 offset:512
    ds_read_b64 v[166:167], v2 offset:768
    ds_read_b64 v[168:169], v2 offset:1024
    ds_read_b64 v[170:171], v2 offset:1280
    ds_read_b64 v[172:173], v2 offset:1536
    ds_read_b64 v[174:175], v2 offset:1792
    s_mov_b32 s58, 0x05040100
    s_mov_b32 s59, 0x07060302
    v_bfe_u32 v3, v0, 3, 2
    v_lshl_add_u32 v7, v3, 9, v7
    v_and_b32 v3, 7, v0
    v_lshl_add_u32 v7, v3, 5, v7
    v_mov_b32 v5, 161792
    v_mov_b32 v6, 1
    s_waitcnt lgkmcnt(0)
    v_perm_b32 v112, v162, v160, s58
    v_perm_b32 v113, v166, v164, s58
    v_perm_b32 v114, v170, v168, s58
    v_perm_b32 v115, v174, v172, s58
    ds_write_b128 v7, v[112:115] offset:0
    v_perm_b32 v116, v162, v160, s59
    v_perm_b32 v117, v166, v164, s59
    v_perm_b32 v118, v170, v168, s59
    v_perm_b32 v119, v174, v172, s59
    ds_write_b128 v7, v[116:119] offset:256
    v_perm_b32 v120, v163, v161, s58
    v_perm_b32 v121, v167, v165, s58
    v_perm_b32 v122, v171, v169, s58
    v_perm_b32 v123, v175, v173, s58
    ds_write_b128 v7, v[120:123] offset:16
    v_perm_b32 v124, v163, v161, s59
    v_perm_b32 v125, v167, v165, s59
    v_perm_b32 v126, v171, v169, s59
    v_perm_b32 v127, v175, v173, s59
    ds_write_b128 v7, v[124:127] offset:272
    s_mov_b64 exec, 1
    ds_add_u32 v5, v6
    s_mov_b64 exec, -1
L_wdone:
    s_mov_b32 s59, 101376
    s_cmp_eq_u32 s16, 7
    s_cselect_b32 s3, 64, 0x80000000
    s_mov_b32 s53, 1
    s_mov_b32 s30, s18
    s_waitcnt lgkmcnt(0)
L_sb:
    s_cmp_gt_i32 s30, s3
    s_cbranch_scc1 L_nofl
    s_load_dword s53, s[54:55], 0
L_nofl:
    v_mfma_f32_4x4x4_16b_bf16 v[144:147], v[224:225], v[216:217], 0
    v_mfma_f32_4x4x4_16b_bf16 v[148:151], v[224:225], v[218:219], 0
    v_mfma_f32_4x4x4_16b_bf16 v[152:155], v[224:225], v[220:221], 0
    v_mfma_f32_4x4x4_16b_bf16 v[156:159], v[224:225], v[222:223], 0
    v_add_u32 v230, 1024, v230
    s_sub_u32 s26, s30, 64
    v_cmp_gt_i32 s[34:35], s26, v234
    s_cmp_le_i32 s30, 0
    s_nop 0
    v_cvt_pk_bf16_f32 v184, v144, v148
    v_cvt_pk_bf16_f32 v185, v152, v156
    v_cvt_pk_bf16_f32 v186, v145, v149
    v_cvt_pk_bf16_f32 v187, v153, v157
    v_cvt_pk_bf16_f32 v188, v146, v150
    v_cvt_pk_bf16_f32 v189, v154, v158
    v_cvt_pk_bf16_f32 v190, v147, v151
    v_cvt_pk_bf16_f32 v191, v155, v159
    ds_read_b128 v[224:227], v230
    ds_read_b32 v243, v244
    s_cbranch_scc1 L_exit
    s_setprio 3
    v_mfma_f32_32x32x16_bf16 v[112:127], v[192:195], v[200:203], 0
    v_exp_f32 v176, v80
    v_exp_f32 v177, v81
    v_exp_f32 v178, v82
    v_exp_f32 v179, v83
    v_exp_f32 v180, v96
    v_exp_f32 v181, v97
    v_exp_f32 v182, v98
    v_exp_f32 v183, v99
    v_pk_fma_f32 v[176:177], v[176:177], s[56:57], s[56:57]
    v_pk_fma_f32 v[178:179], v[178:179], s[56:57], s[56:57]
    v_pk_fma_f32 v[180:181], v[180:181], s[56:57], s[56:57]
    v_pk_fma_f32 v[182:183], v[182:183], s[56:57], s[56:57]
    s_waitcnt vmcnt(4)
    v_mfma_f32_4x4x4_16b_bf16 v[144:147], v[184:185], v[48:49], 0 cbsz:4 abid:0
    v_rcp_f32 v176, v176
    v_mfma_f32_4x4x4_16b_bf16 v[148:151], v[184:185], v[50:51], 0 cbsz:4 abid:0
    v_rcp_f32 v177, v177
    v_mfma_f32_4x4x4_16b_bf16 v[152:155], v[184:185], v[52:53], 0 cbsz:4 abid:1
    v_rcp_f32 v178, v178
    v_mfma_f32_4x4x4_16b_bf16 v[156:159], v[184:185], v[54:55], 0 cbsz:4 abid:1
    v_rcp_f32 v179, v179
    v_mfma_f32_4x4x4_16b_bf16 v[160:163], v[184:185], v[56:57], 0 cbsz:4 abid:2
    v_rcp_f32 v180, v180
    v_mfma_f32_4x4x4_16b_bf16 v[164:167], v[184:185], v[58:59], 0 cbsz:4 abid:2
    v_rcp_f32 v181, v181
    v_mfma_f32_4x4x4_16b_bf16 v[168:171], v[184:185], v[60:61], 0 cbsz:4 abid:3
    v_rcp_f32 v182, v182
    v_mfma_f32_4x4x4_16b_bf16 v[172:175], v[184:185], v[62:63], 0 cbsz:4 abid:3
    v_rcp_f32 v183, v183
    v_readlane_b32 s72, v228, 32
    v_readlane_b32 s73, v228, 36
    v_readlane_b32 s74, v228, 40
    v_readlane_b32 s75, v228, 44
    v_pk_mul_f32 v[176:177], v[176:177], v[80:81]
    v_pk_mul_f32 v[178:179], v[178:179], v[82:83]
    v_pk_mul_f32 v[180:181], v[180:181], v[96:97]
    v_pk_mul_f32 v[182:183], v[182:183], v[98:99]
    s_set_gpr_idx_on s64, gpr_idx(SRC2,DST)
    v_pk_fma_f32 v[8:9], v[176:177], v[144:145], v[8:9] op_sel:[0,0,0] op_sel_hi:[0,1,1]
    v_pk_fma_f32 v[10:11], v[176:177], v[146:147], v[10:11] op_sel:[0,0,0] op_sel_hi:[0,1,1]
    v_pk_fma_f32 v[12:13], v[180:181], v[148:149], v[12:13] op_sel:[0,0,0] op_sel_hi:[0,1,1]
    v_pk_fma_f32 v[14:15], v[180:181], v[150:151], v[14:15] op_sel:[0,0,0] op_sel_hi:[0,1,1]
    s_set_gpr_idx_idx s65
    v_pk_fma_f32 v[8:9], v[176:177], v[152:153], v[8:9] op_sel:[1,0,0] op_sel_hi:[1,1,1]
    v_pk_fma_f32 v[10:11], v[176:177], v[154:155], v[10:11] op_sel:[1,0,0] op_sel_hi:[1,1,1]
    v_pk_fma_f32 v[12:13], v[180:181], v[156:157], v[12:13] op_sel:[1,0,0] op_sel_hi:[1,1,1]
    v_pk_fma_f32 v[14:15], v[180:181], v[158:159], v[14:15] op_sel:[1,0,0] op_sel_hi:[1,1,1]
    s_set_gpr_idx_idx s66
    v_pk_fma_f32 v[8:9], v[178:179], v[160:161], v[8:9] op_sel:[0,0,0] op_sel_hi:[0,1,1]
    v_pk_fma_f32 v[10:11], v[178:179], v[162:163], v[10:11] op_sel:[0,0,0] op_sel_hi:[0,1,1]
    v_pk_fma_f32 v[12:13], v[182:183], v[164:165], v[12:13] op_sel:[0,0,0] op_sel_hi:[0,1,1]
    v_pk_fma_f32 v[14:15], v[182:183], v[166:167], v[14:15] op_sel:[0,0,0] op_sel_hi:[0,1,1]
    s_set_gpr_idx_idx s67
    v_pk_fma_f32 v[8:9], v[178:179], v[168:169], v[8:9] op_sel:[1,0,0] op_sel_hi:[1,1,1]
    v_pk_fma_f32 v[10:11], v[178:179], v[170:171], v[10:11] op_sel:[1,0,0] op_sel_hi:[1,1,1]
    v_pk_fma_f32 v[12:13], v[182:183], v[172:173], v[12:13] op_sel:[1,0,0] op_sel_hi:[1,1,1]
    v_pk_fma_f32 v[14:15], v[182:183], v[174:175], v[14:15] op_sel:[1,0,0] op_sel_hi:[1,1,1]
    s_set_gpr_idx_off
    s_and_b32 s80, s72, s31
    s_and_b32 s81, s73, s31
    s_and_b32 s82, s74, s31
    s_and_b32 s83, s75, s31
    buffer_load_dwordx4 v[48:51], v232, s[4:7], s80 offen
    buffer_load_dwordx4 v[52:55], v232, s[4:7], s81 offen
    buffer_load_dwordx4 v[56:59], v232, s[4:7], s82 offen
    buffer_load_dwordx4 v[60:63], v232, s[4:7], s83 offen
    s_cmp_le_i32 s30, 4
    s_mov_b64 exec, s[22:23]
    ds_read_b128 v[196:199], v229 offset:46080
    s_mov_b64 exec, -1
    ds_read_b32 v2, v231 offset:524
    s_cbranch_scc1 L_exit
    s_setprio 2
    v_mfma_f32_32x32x16_bf16 v[128:143], v[192:195], v[204:207], 0
    v_exp_f32 v176, v84
    v_exp_f32 v177, v85
    v_exp_f32 v178, v86
    v_exp_f32 v179, v87
    v_exp_f32 v180, v100
    v_exp_f32 v181, v101
    v_exp_f32 v182, v102
    v_exp_f32 v183, v103
    v_pk_fma_f32 v[176:177], v[176:177], s[56:57], s[56:57]
    v_pk_fma_f32 v[178:179], v[178:179], s[56:57], s[56:57]
    v_pk_fma_f32 v[180:181], v[180:181], s[56:57], s[56:57]
    v_pk_fma_f32 v[182:183], v[182:183], s[56:57], s[56:57]
    s_waitcnt vmcnt(4)
    v_mfma_f32_4x4x4_16b_bf16 v[144:147], v[184:185], v[64:65], 0 cbsz:4 abid:4
    v_rcp_f32 v176, v176
    v_mfma_f32_4x4x4_16b_bf16 v[148:151], v[184:185], v[66:67], 0 cbsz:4 abid:4
    v_rcp_f32 v177, v177
    v_mfma_f32_4x4x4_16b_bf16 v[152:155], v[184:185], v[68:69], 0 cbsz:4 abid:5
    v_rcp_f32 v178, v178
    v_mfma_f32_4x4x4_16b_bf16 v[156:159], v[184:185], v[70:71], 0 cbsz:4 abid:5
    v_rcp_f32 v179, v179
    v_mfma_f32_4x4x4_16b_bf16 v[160:163], v[184:185], v[72:73], 0 cbsz:4 abid:6
    v_rcp_f32 v180, v180
    v_mfma_f32_4x4x4_16b_bf16 v[164:167], v[184:185], v[74:75], 0 cbsz:4 abid:6
    v_rcp_f32 v181, v181
    v_mfma_f32_4x4x4_16b_bf16 v[168:171], v[184:185], v[76:77], 0 cbsz:4 abid:7
    v_rcp_f32 v182, v182
    v_mfma_f32_4x4x4_16b_bf16 v[172:175], v[184:185], v[78:79], 0 cbsz:4 abid:7
    v_rcp_f32 v183, v183
    v_readlane_b32 s76, v228, 48
    v_readlane_b32 s77, v228, 52
    v_readlane_b32 s78, v228, 56
    v_readlane_b32 s79, v228, 60
    v_pk_mul_f32 v[176:177], v[176:177], v[84:85]
    v_pk_mul_f32 v[178:179], v[178:179], v[86:87]
    v_pk_mul_f32 v[180:181], v[180:181], v[100:101]
    v_pk_mul_f32 v[182:183], v[182:183], v[102:103]
    s_set_gpr_idx_on s68, gpr_idx(SRC2,DST)
    v_pk_fma_f32 v[8:9], v[176:177], v[144:145], v[8:9] op_sel:[0,0,0] op_sel_hi:[0,1,1]
    v_pk_fma_f32 v[10:11], v[176:177], v[146:147], v[10:11] op_sel:[0,0,0] op_sel_hi:[0,1,1]
    v_pk_fma_f32 v[12:13], v[180:181], v[148:149], v[12:13] op_sel:[0,0,0] op_sel_hi:[0,1,1]
    v_pk_fma_f32 v[14:15], v[180:181], v[150:151], v[14:15] op_sel:[0,0,0] op_sel_hi:[0,1,1]
    s_set_gpr_idx_idx s69
    v_pk_fma_f32 v[8:9], v[176:177], v[152:153], v[8:9] op_sel:[1,0,0] op_sel_hi:[1,1,1]
    v_pk_fma_f32 v[10:11], v[176:177], v[154:155], v[10:11] op_sel:[1,0,0] op_sel_hi:[1,1,1]
    v_pk_fma_f32 v[12:13], v[180:181], v[156:157], v[12:13] op_sel:[1,0,0] op_sel_hi:[1,1,1]
    v_pk_fma_f32 v[14:15], v[180:181], v[158:159], v[14:15] op_sel:[1,0,0] op_sel_hi:[1,1,1]
    s_set_gpr_idx_idx s70
    v_pk_fma_f32 v[8:9], v[178:179], v[160:161], v[8:9] op_sel:[0,0,0] op_sel_hi:[0,1,1]
    v_pk_fma_f32 v[10:11], v[178:179], v[162:163], v[10:11] op_sel:[0,0,0] op_sel_hi:[0,1,1]
    v_pk_fma_f32 v[12:13], v[182:183], v[164:165], v[12:13] op_sel:[0,0,0] op_sel_hi:[0,1,1]
    v_pk_fma_f32 v[14:15], v[182:183], v[166:167], v[14:15] op_sel:[0,0,0] op_sel_hi:[0,1,1]
    s_set_gpr_idx_idx s71
    v_pk_fma_f32 v[8:9], v[178:179], v[168:169], v[8:9] op_sel:[1,0,0] op_sel_hi:[1,1,1]
    v_pk_fma_f32 v[10:11], v[178:179], v[170:171], v[10:11] op_sel:[1,0,0] op_sel_hi:[1,1,1]
    v_pk_fma_f32 v[12:13], v[182:183], v[172:173], v[12:13] op_sel:[1,0,0] op_sel_hi:[1,1,1]
    v_pk_fma_f32 v[14:15], v[182:183], v[174:175], v[14:15] op_sel:[1,0,0] op_sel_hi:[1,1,1]
    s_set_gpr_idx_off
    s_and_b32 s80, s76, s31
    s_and_b32 s81, s77, s31
    s_and_b32 s82, s78, s31
    s_and_b32 s83, s79, s31
    buffer_load_dwordx4 v[64:67], v232, s[4:7], s80 offen
    buffer_load_dwordx4 v[68:71], v232, s[4:7], s81 offen
    buffer_load_dwordx4 v[72:75], v232, s[4:7], s82 offen
    buffer_load_dwordx4 v[76:79], v232, s[4:7], s83 offen
    s_cmp_le_i32 s30, 8
    s_waitcnt lgkmcnt(0)
    s_cbranch_scc1 L_exit
    s_setprio 1
    v_mfma_f32_32x32x16_bf16 v[112:127], v[196:199], v[208:211], v[112:127]
    v_exp_f32 v176, v88
    v_exp_f32 v177, v89
    v_exp_f32 v178, v90
    v_exp_f32 v179, v91
    v_exp_f32 v180, v104
    v_exp_f32 v181, v105
    v_exp_f32 v182, v106
    v_exp_f32 v183, v107
    v_pk_fma_f32 v[176:177], v[176:177], s[56:57], s[56:57]
    v_pk_fma_f32 v[178:179], v[178:179], s[56:57], s[56:57]
    v_pk_fma_f32 v[180:181], v[180:181], s[56:57], s[56:57]
    v_pk_fma_f32 v[182:183], v[182:183], s[56:57], s[56:57]
    s_waitcnt vmcnt(4)
    v_mfma_f32_4x4x4_16b_bf16 v[144:147], v[184:185], v[48:49], 0 cbsz:4 abid:8
    v_rcp_f32 v176, v176
    v_mfma_f32_4x4x4_16b_bf16 v[148:151], v[184:185], v[50:51], 0 cbsz:4 abid:8
    v_rcp_f32 v177, v177
    v_mfma_f32_4x4x4_16b_bf16 v[152:155], v[184:185], v[52:53], 0 cbsz:4 abid:9
    v_rcp_f32 v178, v178
    v_mfma_f32_4x4x4_16b_bf16 v[156:159], v[184:185], v[54:55], 0 cbsz:4 abid:9
    v_rcp_f32 v179, v179
    v_mfma_f32_4x4x4_16b_bf16 v[160:163], v[184:185], v[56:57], 0 cbsz:4 abid:10
    v_rcp_f32 v180, v180
    v_mfma_f32_4x4x4_16b_bf16 v[164:167], v[184:185], v[58:59], 0 cbsz:4 abid:10
    v_rcp_f32 v181, v181
    v_mfma_f32_4x4x4_16b_bf16 v[168:171], v[184:185], v[60:61], 0 cbsz:4 abid:11
    v_rcp_f32 v182, v182
    v_mfma_f32_4x4x4_16b_bf16 v[172:175], v[184:185], v[62:63], 0 cbsz:4 abid:11
    v_rcp_f32 v183, v183
    v_readlane_b32 s64, v228, 1
    v_readlane_b32 s65, v228, 5
    v_readlane_b32 s66, v228, 9
    v_readlane_b32 s67, v228, 13
    v_and_or_b32 v229, v2, s33, v233
    v_pk_mul_f32 v[176:177], v[176:177], v[88:89]
    v_pk_mul_f32 v[178:179], v[178:179], v[90:91]
    v_pk_mul_f32 v[180:181], v[180:181], v[104:105]
    v_pk_mul_f32 v[182:183], v[182:183], v[106:107]
    s_set_gpr_idx_on s72, gpr_idx(SRC2,DST)
    v_pk_fma_f32 v[8:9], v[176:177], v[144:145], v[8:9] op_sel:[0,0,0] op_sel_hi:[0,1,1]
    v_pk_fma_f32 v[10:11], v[176:177], v[146:147], v[10:11] op_sel:[0,0,0] op_sel_hi:[0,1,1]
    v_pk_fma_f32 v[12:13], v[180:181], v[148:149], v[12:13] op_sel:[0,0,0] op_sel_hi:[0,1,1]
    v_pk_fma_f32 v[14:15], v[180:181], v[150:151], v[14:15] op_sel:[0,0,0] op_sel_hi:[0,1,1]
    s_set_gpr_idx_idx s73
    v_pk_fma_f32 v[8:9], v[176:177], v[152:153], v[8:9] op_sel:[1,0,0] op_sel_hi:[1,1,1]
    v_pk_fma_f32 v[10:11], v[176:177], v[154:155], v[10:11] op_sel:[1,0,0] op_sel_hi:[1,1,1]
    v_pk_fma_f32 v[12:13], v[180:181], v[156:157], v[12:13] op_sel:[1,0,0] op_sel_hi:[1,1,1]
    v_pk_fma_f32 v[14:15], v[180:181], v[158:159], v[14:15] op_sel:[1,0,0] op_sel_hi:[1,1,1]
    s_set_gpr_idx_idx s74
    v_pk_fma_f32 v[8:9], v[178:179], v[160:161], v[8:9] op_sel:[0,0,0] op_sel_hi:[0,1,1]
    v_pk_fma_f32 v[10:11], v[178:179], v[162:163], v[10:11] op_sel:[0,0,0] op_sel_hi:[0,1,1]
    v_pk_fma_f32 v[12:13], v[182:183], v[164:165], v[12:13] op_sel:[0,0,0] op_sel_hi:[0,1,1]
    v_pk_fma_f32 v[14:15], v[182:183], v[166:167], v[14:15] op_sel:[0,0,0] op_sel_hi:[0,1,1]
    s_set_gpr_idx_idx s75
    v_pk_fma_f32 v[8:9], v[178:179], v[168:169], v[8:9] op_sel:[1,0,0] op_sel_hi:[1,1,1]
    v_pk_fma_f32 v[10:11], v[178:179], v[170:171], v[10:11] op_sel:[1,0,0] op_sel_hi:[1,1,1]
    v_pk_fma_f32 v[12:13], v[182:183], v[172:173], v[12:13] op_sel:[1,0,0] op_sel_hi:[1,1,1]
    v_pk_fma_f32 v[14:15], v[182:183], v[174:175], v[14:15] op_sel:[1,0,0] op_sel_hi:[1,1,1]
    s_set_gpr_idx_off
    s_and_b32 s80, s64, s31
    s_and_b32 s81, s65, s31
    s_and_b32 s82, s66, s31
    s_and_b32 s83, s67, s31
    buffer_load_dwordx4 v[48:51], v232, s[4:7], s80 offen
    buffer_load_dwordx4 v[52:55], v232, s[4:7], s81 offen
    buffer_load_dwordx4 v[56:59], v232, s[4:7], s82 offen
    buffer_load_dwordx4 v[60:63], v232, s[4:7], s83 offen
    s_cmp_le_i32 s30, 12
    s_mov_b64 exec, s[20:21]
    ds_read_b128 v[192:195], v229 offset:46080
    s_mov_b64 exec, -1
    s_cbranch_scc1 L_exit
    s_setprio 0
    v_mfma_f32_32x32x16_bf16 v[128:143], v[196:199], v[212:215], v[128:143]
    v_exp_f32 v176, v92
    v_exp_f32 v177, v93
    v_exp_f32 v178, v94
    v_exp_f32 v179, v95
    v_exp_f32 v180, v108
    v_exp_f32 v181, v109
    v_exp_f32 v182, v110
    v_exp_f32 v183, v111
    v_pk_fma_f32 v[176:177], v[176:177], s[56:57], s[56:57]
    v_pk_fma_f32 v[178:179], v[178:179], s[56:57], s[56:57]
    v_pk_fma_f32 v[180:181], v[180:181], s[56:57], s[56:57]
    v_pk_fma_f32 v[182:183], v[182:183], s[56:57], s[56:57]
    s_waitcnt vmcnt(4)
    v_mfma_f32_4x4x4_16b_bf16 v[144:147], v[184:185], v[64:65], 0 cbsz:4 abid:12
    v_rcp_f32 v176, v176
    v_mfma_f32_4x4x4_16b_bf16 v[148:151], v[184:185], v[66:67], 0 cbsz:4 abid:12
    v_rcp_f32 v177, v177
    v_mfma_f32_4x4x4_16b_bf16 v[152:155], v[184:185], v[68:69], 0 cbsz:4 abid:13
    v_rcp_f32 v178, v178
    v_mfma_f32_4x4x4_16b_bf16 v[156:159], v[184:185], v[70:71], 0 cbsz:4 abid:13
    v_rcp_f32 v179, v179
    v_mfma_f32_4x4x4_16b_bf16 v[160:163], v[184:185], v[72:73], 0 cbsz:4 abid:14
    v_rcp_f32 v180, v180
    v_mfma_f32_4x4x4_16b_bf16 v[164:167], v[184:185], v[74:75], 0 cbsz:4 abid:14
    v_rcp_f32 v181, v181
    v_mfma_f32_4x4x4_16b_bf16 v[168:171], v[184:185], v[76:77], 0 cbsz:4 abid:15
    v_rcp_f32 v182, v182
    v_mfma_f32_4x4x4_16b_bf16 v[172:175], v[184:185], v[78:79], 0 cbsz:4 abid:15
    v_rcp_f32 v183, v183
    v_readlane_b32 s68, v228, 17
    v_readlane_b32 s69, v228, 21
    v_readlane_b32 s70, v228, 25
    v_readlane_b32 s71, v228, 29
    v_pk_mul_f32 v[176:177], v[176:177], v[92:93]
    v_pk_mul_f32 v[178:179], v[178:179], v[94:95]
    v_pk_mul_f32 v[180:181], v[180:181], v[108:109]
    v_pk_mul_f32 v[182:183], v[182:183], v[110:111]
    s_set_gpr_idx_on s76, gpr_idx(SRC2,DST)
    v_pk_fma_f32 v[8:9], v[176:177], v[144:145], v[8:9] op_sel:[0,0,0] op_sel_hi:[0,1,1]
    v_pk_fma_f32 v[10:11], v[176:177], v[146:147], v[10:11] op_sel:[0,0,0] op_sel_hi:[0,1,1]
    v_pk_fma_f32 v[12:13], v[180:181], v[148:149], v[12:13] op_sel:[0,0,0] op_sel_hi:[0,1,1]
    v_pk_fma_f32 v[14:15], v[180:181], v[150:151], v[14:15] op_sel:[0,0,0] op_sel_hi:[0,1,1]
    s_set_gpr_idx_idx s77
    v_pk_fma_f32 v[8:9], v[176:177], v[152:153], v[8:9] op_sel:[1,0,0] op_sel_hi:[1,1,1]
    v_pk_fma_f32 v[10:11], v[176:177], v[154:155], v[10:11] op_sel:[1,0,0] op_sel_hi:[1,1,1]
    v_pk_fma_f32 v[12:13], v[180:181], v[156:157], v[12:13] op_sel:[1,0,0] op_sel_hi:[1,1,1]
    v_pk_fma_f32 v[14:15], v[180:181], v[158:159], v[14:15] op_sel:[1,0,0] op_sel_hi:[1,1,1]
    s_set_gpr_idx_idx s78
    v_pk_fma_f32 v[8:9], v[178:179], v[160:161], v[8:9] op_sel:[0,0,0] op_sel_hi:[0,1,1]
    v_pk_fma_f32 v[10:11], v[178:179], v[162:163], v[10:11] op_sel:[0,0,0] op_sel_hi:[0,1,1]
    v_pk_fma_f32 v[12:13], v[182:183], v[164:165], v[12:13] op_sel:[0,0,0] op_sel_hi:[0,1,1]
    v_pk_fma_f32 v[14:15], v[182:183], v[166:167], v[14:15] op_sel:[0,0,0] op_sel_hi:[0,1,1]
    s_set_gpr_idx_idx s79
    v_pk_fma_f32 v[8:9], v[178:179], v[168:169], v[8:9] op_sel:[1,0,0] op_sel_hi:[1,1,1]
    v_pk_fma_f32 v[10:11], v[178:179], v[170:171], v[10:11] op_sel:[1,0,0] op_sel_hi:[1,1,1]
    v_pk_fma_f32 v[12:13], v[182:183], v[172:173], v[12:13] op_sel:[1,0,0] op_sel_hi:[1,1,1]
    v_pk_fma_f32 v[14:15], v[182:183], v[174:175], v[14:15] op_sel:[1,0,0] op_sel_hi:[1,1,1]
    s_set_gpr_idx_off
    s_and_b32 s80, s68, s31
    s_and_b32 s81, s69, s31
    s_and_b32 s82, s70, s31
    s_and_b32 s83, s71, s31
    buffer_load_dwordx4 v[64:67], v232, s[4:7], s80 offen
    buffer_load_dwordx4 v[68:71], v232, s[4:7], s81 offen
    buffer_load_dwordx4 v[72:75], v232, s[4:7], s82 offen
    buffer_load_dwordx4 v[76:79], v232, s[4:7], s83 offen
    s_cmp_le_i32 s30, 16
    s_waitcnt lgkmcnt(0)
    s_cbranch_scc1 L_exit
    s_setprio 3
    v_mfma_f32_32x32x16_bf16 v[80:95], v[192:195], v[200:203], 0
    v_exp_f32 v176, v112
    v_exp_f32 v177, v113
    v_exp_f32 v178, v114
    v_exp_f32 v179, v115
    v_exp_f32 v180, v128
    v_exp_f32 v181, v129
    v_exp_f32 v182, v130
    v_exp_f32 v183, v131
    v_pk_fma_f32 v[176:177], v[176:177], s[56:57], s[56:57]
    v_pk_fma_f32 v[178:179], v[178:179], s[56:57], s[56:57]
    v_pk_fma_f32 v[180:181], v[180:181], s[56:57], s[56:57]
    v_pk_fma_f32 v[182:183], v[182:183], s[56:57], s[56:57]
    s_waitcnt vmcnt(4)
    v_mfma_f32_4x4x4_16b_bf16 v[144:147], v[186:187], v[48:49], 0 cbsz:4 abid:0
    v_rcp_f32 v176, v176
    v_mfma_f32_4x4x4_16b_bf16 v[148:151], v[186:187], v[50:51], 0 cbsz:4 abid:0
    v_rcp_f32 v177, v177
    v_mfma_f32_4x4x4_16b_bf16 v[152:155], v[186:187], v[52:53], 0 cbsz:4 abid:1
    v_rcp_f32 v178, v178
    v_mfma_f32_4x4x4_16b_bf16 v[156:159], v[186:187], v[54:55], 0 cbsz:4 abid:1
    v_rcp_f32 v179, v179
    v_mfma_f32_4x4x4_16b_bf16 v[160:163], v[186:187], v[56:57], 0 cbsz:4 abid:2
    v_rcp_f32 v180, v180
    v_mfma_f32_4x4x4_16b_bf16 v[164:167], v[186:187], v[58:59], 0 cbsz:4 abid:2
    v_rcp_f32 v181, v181
    v_mfma_f32_4x4x4_16b_bf16 v[168:171], v[186:187], v[60:61], 0 cbsz:4 abid:3
    v_rcp_f32 v182, v182
    v_mfma_f32_4x4x4_16b_bf16 v[172:175], v[186:187], v[62:63], 0 cbsz:4 abid:3
    v_rcp_f32 v183, v183
    v_readlane_b32 s72, v228, 33
    v_readlane_b32 s73, v228, 37
    v_readlane_b32 s74, v228, 41
    v_readlane_b32 s75, v228, 45
    v_pk_mul_f32 v[176:177], v[176:177], v[112:113]
    v_pk_mul_f32 v[178:179], v[178:179], v[114:115]
    v_pk_mul_f32 v[180:181], v[180:181], v[128:129]
    v_pk_mul_f32 v[182:183], v[182:183], v[130:131]
    s_set_gpr_idx_on s64, gpr_idx(SRC2,DST)
    v_pk_fma_f32 v[8:9], v[176:177], v[144:145], v[8:9] op_sel:[0,0,0] op_sel_hi:[0,1,1]
    v_pk_fma_f32 v[10:11], v[176:177], v[146:147], v[10:11] op_sel:[0,0,0] op_sel_hi:[0,1,1]
    v_pk_fma_f32 v[12:13], v[180:181], v[148:149], v[12:13] op_sel:[0,0,0] op_sel_hi:[0,1,1]
    v_pk_fma_f32 v[14:15], v[180:181], v[150:151], v[14:15] op_sel:[0,0,0] op_sel_hi:[0,1,1]
    s_set_gpr_idx_idx s65
    v_pk_fma_f32 v[8:9], v[176:177], v[152:153], v[8:9] op_sel:[1,0,0] op_sel_hi:[1,1,1]
    v_pk_fma_f32 v[10:11], v[176:177], v[154:155], v[10:11] op_sel:[1,0,0] op_sel_hi:[1,1,1]
    v_pk_fma_f32 v[12:13], v[180:181], v[156:157], v[12:13] op_sel:[1,0,0] op_sel_hi:[1,1,1]
    v_pk_fma_f32 v[14:15], v[180:181], v[158:159], v[14:15] op_sel:[1,0,0] op_sel_hi:[1,1,1]
    s_set_gpr_idx_idx s66
    v_pk_fma_f32 v[8:9], v[178:179], v[160:161], v[8:9] op_sel:[0,0,0] op_sel_hi:[0,1,1]
    v_pk_fma_f32 v[10:11], v[178:179], v[162:163], v[10:11] op_sel:[0,0,0] op_sel_hi:[0,1,1]
    v_pk_fma_f32 v[12:13], v[182:183], v[164:165], v[12:13] op_sel:[0,0,0] op_sel_hi:[0,1,1]
    v_pk_fma_f32 v[14:15], v[182:183], v[166:167], v[14:15] op_sel:[0,0,0] op_sel_hi:[0,1,1]
    s_set_gpr_idx_idx s67
    v_pk_fma_f32 v[8:9], v[178:179], v[168:169], v[8:9] op_sel:[1,0,0] op_sel_hi:[1,1,1]
    v_pk_fma_f32 v[10:11], v[178:179], v[170:171], v[10:11] op_sel:[1,0,0] op_sel_hi:[1,1,1]
    v_pk_fma_f32 v[12:13], v[182:183], v[172:173], v[12:13] op_sel:[1,0,0] op_sel_hi:[1,1,1]
    v_pk_fma_f32 v[14:15], v[182:183], v[174:175], v[14:15] op_sel:[1,0,0] op_sel_hi:[1,1,1]
    s_set_gpr_idx_off
    s_and_b32 s80, s72, s31
    s_and_b32 s81, s73, s31
    s_and_b32 s82, s74, s31
    s_and_b32 s83, s75, s31
    buffer_load_dwordx4 v[48:51], v232, s[4:7], s80 offen
    buffer_load_dwordx4 v[52:55], v232, s[4:7], s81 offen
    buffer_load_dwordx4 v[56:59], v232, s[4:7], s82 offen
    buffer_load_dwordx4 v[60:63], v232, s[4:7], s83 offen
    s_cmp_le_i32 s30, 20
    s_mov_b64 exec, s[22:23]
    ds_read_b128 v[196:199], v229 offset:46080
    s_mov_b64 exec, -1
    ds_read_b32 v2, v231 offset:780
    s_cbranch_scc1 L_exit
    s_setprio 2
    v_mfma_f32_32x32x16_bf16 v[96:111], v[192:195], v[204:207], 0
    v_exp_f32 v176, v116
    v_exp_f32 v177, v117
    v_exp_f32 v178, v118
    v_exp_f32 v179, v119
    v_exp_f32 v180, v132
    v_exp_f32 v181, v133
    v_exp_f32 v182, v134
    v_exp_f32 v183, v135
    v_pk_fma_f32 v[176:177], v[176:177], s[56:57], s[56:57]
    v_pk_fma_f32 v[178:179], v[178:179], s[56:57], s[56:57]
    v_pk_fma_f32 v[180:181], v[180:181], s[56:57], s[56:57]
    v_pk_fma_f32 v[182:183], v[182:183], s[56:57], s[56:57]
    s_waitcnt vmcnt(4)
    v_mfma_f32_4x4x4_16b_bf16 v[144:147], v[186:187], v[64:65], 0 cbsz:4 abid:4
    v_rcp_f32 v176, v176
    v_mfma_f32_4x4x4_16b_bf16 v[148:151], v[186:187], v[66:67], 0 cbsz:4 abid:4
    v_rcp_f32 v177, v177
    v_mfma_f32_4x4x4_16b_bf16 v[152:155], v[186:187], v[68:69], 0 cbsz:4 abid:5
    v_rcp_f32 v178, v178
    v_mfma_f32_4x4x4_16b_bf16 v[156:159], v[186:187], v[70:71], 0 cbsz:4 abid:5
    v_rcp_f32 v179, v179
    v_mfma_f32_4x4x4_16b_bf16 v[160:163], v[186:187], v[72:73], 0 cbsz:4 abid:6
    v_rcp_f32 v180, v180
    v_mfma_f32_4x4x4_16b_bf16 v[164:167], v[186:187], v[74:75], 0 cbsz:4 abid:6
    v_rcp_f32 v181, v181
    v_mfma_f32_4x4x4_16b_bf16 v[168:171], v[186:187], v[76:77], 0 cbsz:4 abid:7
    v_rcp_f32 v182, v182
    v_mfma_f32_4x4x4_16b_bf16 v[172:175], v[186:187], v[78:79], 0 cbsz:4 abid:7
    v_rcp_f32 v183, v183
    v_readlane_b32 s76, v228, 49
    v_readlane_b32 s77, v228, 53
    v_readlane_b32 s78, v228, 57
    v_readlane_b32 s79, v228, 61
    v_pk_mul_f32 v[176:177], v[176:177], v[116:117]
    v_pk_mul_f32 v[178:179], v[178:179], v[118:119]
    v_pk_mul_f32 v[180:181], v[180:181], v[132:133]
    v_pk_mul_f32 v[182:183], v[182:183], v[134:135]
    s_set_gpr_idx_on s68, gpr_idx(SRC2,DST)
    v_pk_fma_f32 v[8:9], v[176:177], v[144:145], v[8:9] op_sel:[0,0,0] op_sel_hi:[0,1,1]
    v_pk_fma_f32 v[10:11], v[176:177], v[146:147], v[10:11] op_sel:[0,0,0] op_sel_hi:[0,1,1]
    v_pk_fma_f32 v[12:13], v[180:181], v[148:149], v[12:13] op_sel:[0,0,0] op_sel_hi:[0,1,1]
    v_pk_fma_f32 v[14:15], v[180:181], v[150:151], v[14:15] op_sel:[0,0,0] op_sel_hi:[0,1,1]
    s_set_gpr_idx_idx s69
    v_pk_fma_f32 v[8:9], v[176:177], v[152:153], v[8:9] op_sel:[1,0,0] op_sel_hi:[1,1,1]
    v_pk_fma_f32 v[10:11], v[176:177], v[154:155], v[10:11] op_sel:[1,0,0] op_sel_hi:[1,1,1]
    v_pk_fma_f32 v[12:13], v[180:181], v[156:157], v[12:13] op_sel:[1,0,0] op_sel_hi:[1,1,1]
    v_pk_fma_f32 v[14:15], v[180:181], v[158:159], v[14:15] op_sel:[1,0,0] op_sel_hi:[1,1,1]
    s_set_gpr_idx_idx s70
    v_pk_fma_f32 v[8:9], v[178:179], v[160:161], v[8:9] op_sel:[0,0,0] op_sel_hi:[0,1,1]
    v_pk_fma_f32 v[10:11], v[178:179], v[162:163], v[10:11] op_sel:[0,0,0] op_sel_hi:[0,1,1]
    v_pk_fma_f32 v[12:13], v[182:183], v[164:165], v[12:13] op_sel:[0,0,0] op_sel_hi:[0,1,1]
    v_pk_fma_f32 v[14:15], v[182:183], v[166:167], v[14:15] op_sel:[0,0,0] op_sel_hi:[0,1,1]
    s_set_gpr_idx_idx s71
    v_pk_fma_f32 v[8:9], v[178:179], v[168:169], v[8:9] op_sel:[1,0,0] op_sel_hi:[1,1,1]
    v_pk_fma_f32 v[10:11], v[178:179], v[170:171], v[10:11] op_sel:[1,0,0] op_sel_hi:[1,1,1]
    v_pk_fma_f32 v[12:13], v[182:183], v[172:173], v[12:13] op_sel:[1,0,0] op_sel_hi:[1,1,1]
    v_pk_fma_f32 v[14:15], v[182:183], v[174:175], v[14:15] op_sel:[1,0,0] op_sel_hi:[1,1,1]
    s_set_gpr_idx_off
    s_and_b32 s80, s76, s31
    s_and_b32 s81, s77, s31
    s_and_b32 s82, s78, s31
    s_and_b32 s83, s79, s31
    buffer_load_dwordx4 v[64:67], v232, s[4:7], s80 offen
    buffer_load_dwordx4 v[68:71], v232, s[4:7], s81 offen
    buffer_load_dwordx4 v[72:75], v232, s[4:7], s82 offen
    buffer_load_dwordx4 v[76:79], v232, s[4:7], s83 offen
    s_cmp_le_i32 s30, 24
    s_waitcnt lgkmcnt(0)
    s_cbranch_scc1 L_exit
    s_setprio 1
    v_mfma_f32_32x32x16_bf16 v[80:95], v[196:199], v[208:211], v[80:95]
    v_exp_f32 v176, v120
    v_exp_f32 v177, v121
    v_exp_f32 v178, v122
    v_exp_f32 v179, v123
    v_exp_f32 v180, v136
    v_exp_f32 v181, v137
    v_exp_f32 v182, v138
    v_exp_f32 v183, v139
    v_pk_fma_f32 v[176:177], v[176:177], s[56:57], s[56:57]
    v_pk_fma_f32 v[178:179], v[178:179], s[56:57], s[56:57]
    v_pk_fma_f32 v[180:181], v[180:181], s[56:57], s[56:57]
    v_pk_fma_f32 v[182:183], v[182:183], s[56:57], s[56:57]
    s_waitcnt vmcnt(4)
    v_mfma_f32_4x4x4_16b_bf16 v[144:147], v[186:187], v[48:49], 0 cbsz:4 abid:8
    v_rcp_f32 v176, v176
    v_mfma_f32_4x4x4_16b_bf16 v[148:151], v[186:187], v[50:51], 0 cbsz:4 abid:8
    v_rcp_f32 v177, v177
    v_mfma_f32_4x4x4_16b_bf16 v[152:155], v[186:187], v[52:53], 0 cbsz:4 abid:9
    v_rcp_f32 v178, v178
    v_mfma_f32_4x4x4_16b_bf16 v[156:159], v[186:187], v[54:55], 0 cbsz:4 abid:9
    v_rcp_f32 v179, v179
    v_mfma_f32_4x4x4_16b_bf16 v[160:163], v[186:187], v[56:57], 0 cbsz:4 abid:10
    v_rcp_f32 v180, v180
    v_mfma_f32_4x4x4_16b_bf16 v[164:167], v[186:187], v[58:59], 0 cbsz:4 abid:10
    v_rcp_f32 v181, v181
    v_mfma_f32_4x4x4_16b_bf16 v[168:171], v[186:187], v[60:61], 0 cbsz:4 abid:11
    v_rcp_f32 v182, v182
    v_mfma_f32_4x4x4_16b_bf16 v[172:175], v[186:187], v[62:63], 0 cbsz:4 abid:11
    v_rcp_f32 v183, v183
    v_readlane_b32 s64, v228, 2
    v_readlane_b32 s65, v228, 6
    v_readlane_b32 s66, v228, 10
    v_readlane_b32 s67, v228, 14
    v_and_or_b32 v229, v2, s33, v233
    v_pk_mul_f32 v[176:177], v[176:177], v[120:121]
    v_pk_mul_f32 v[178:179], v[178:179], v[122:123]
    v_pk_mul_f32 v[180:181], v[180:181], v[136:137]
    v_pk_mul_f32 v[182:183], v[182:183], v[138:139]
    s_set_gpr_idx_on s72, gpr_idx(SRC2,DST)
    v_pk_fma_f32 v[8:9], v[176:177], v[144:145], v[8:9] op_sel:[0,0,0] op_sel_hi:[0,1,1]
    v_pk_fma_f32 v[10:11], v[176:177], v[146:147], v[10:11] op_sel:[0,0,0] op_sel_hi:[0,1,1]
    v_pk_fma_f32 v[12:13], v[180:181], v[148:149], v[12:13] op_sel:[0,0,0] op_sel_hi:[0,1,1]
    v_pk_fma_f32 v[14:15], v[180:181], v[150:151], v[14:15] op_sel:[0,0,0] op_sel_hi:[0,1,1]
    s_set_gpr_idx_idx s73
    v_pk_fma_f32 v[8:9], v[176:177], v[152:153], v[8:9] op_sel:[1,0,0] op_sel_hi:[1,1,1]
    v_pk_fma_f32 v[10:11], v[176:177], v[154:155], v[10:11] op_sel:[1,0,0] op_sel_hi:[1,1,1]
    v_pk_fma_f32 v[12:13], v[180:181], v[156:157], v[12:13] op_sel:[1,0,0] op_sel_hi:[1,1,1]
    v_pk_fma_f32 v[14:15], v[180:181], v[158:159], v[14:15] op_sel:[1,0,0] op_sel_hi:[1,1,1]
    s_set_gpr_idx_idx s74
    v_pk_fma_f32 v[8:9], v[178:179], v[160:161], v[8:9] op_sel:[0,0,0] op_sel_hi:[0,1,1]
    v_pk_fma_f32 v[10:11], v[178:179], v[162:163], v[10:11] op_sel:[0,0,0] op_sel_hi:[0,1,1]
    v_pk_fma_f32 v[12:13], v[182:183], v[164:165], v[12:13] op_sel:[0,0,0] op_sel_hi:[0,1,1]
    v_pk_fma_f32 v[14:15], v[182:183], v[166:167], v[14:15] op_sel:[0,0,0] op_sel_hi:[0,1,1]
    s_set_gpr_idx_idx s75
    v_pk_fma_f32 v[8:9], v[178:179], v[168:169], v[8:9] op_sel:[1,0,0] op_sel_hi:[1,1,1]
    v_pk_fma_f32 v[10:11], v[178:179], v[170:171], v[10:11] op_sel:[1,0,0] op_sel_hi:[1,1,1]
    v_pk_fma_f32 v[12:13], v[182:183], v[172:173], v[12:13] op_sel:[1,0,0] op_sel_hi:[1,1,1]
    v_pk_fma_f32 v[14:15], v[182:183], v[174:175], v[14:15] op_sel:[1,0,0] op_sel_hi:[1,1,1]
    s_set_gpr_idx_off
    s_and_b32 s80, s64, s31
    s_and_b32 s81, s65, s31
    s_and_b32 s82, s66, s31
    s_and_b32 s83, s67, s31
    buffer_load_dwordx4 v[48:51], v232, s[4:7], s80 offen
    buffer_load_dwordx4 v[52:55], v232, s[4:7], s81 offen
    buffer_load_dwordx4 v[56:59], v232, s[4:7], s82 offen
    buffer_load_dwordx4 v[60:63], v232, s[4:7], s83 offen
    s_cmp_le_i32 s30, 28
    s_mov_b64 exec, s[20:21]
    ds_read_b128 v[192:195], v229 offset:46080
    s_mov_b64 exec, -1
    s_cbranch_scc1 L_exit
    s_setprio 0
    v_mfma_f32_32x32x16_bf16 v[96:111], v[196:199], v[212:215], v[96:111]
    v_exp_f32 v176, v124
    v_exp_f32 v177, v125
    v_exp_f32 v178, v126
    v_exp_f32 v179, v127
    v_exp_f32 v180, v140
    v_exp_f32 v181, v141
    v_exp_f32 v182, v142
    v_exp_f32 v183, v143
    v_pk_fma_f32 v[176:177], v[176:177], s[56:57], s[56:57]
    v_pk_fma_f32 v[178:179], v[178:179], s[56:57], s[56:57]
    v_pk_fma_f32 v[180:181], v[180:181], s[56:57], s[56:57]
    v_pk_fma_f32 v[182:183], v[182:183], s[56:57], s[56:57]
    s_waitcnt vmcnt(4)
    v_mfma_f32_4x4x4_16b_bf16 v[144:147], v[186:187], v[64:65], 0 cbsz:4 abid:12
    v_rcp_f32 v176, v176
    v_mfma_f32_4x4x4_16b_bf16 v[148:151], v[186:187], v[66:67], 0 cbsz:4 abid:12
    v_rcp_f32 v177, v177
    v_mfma_f32_4x4x4_16b_bf16 v[152:155], v[186:187], v[68:69], 0 cbsz:4 abid:13
    v_rcp_f32 v178, v178
    v_mfma_f32_4x4x4_16b_bf16 v[156:159], v[186:187], v[70:71], 0 cbsz:4 abid:13
    v_rcp_f32 v179, v179
    v_mfma_f32_4x4x4_16b_bf16 v[160:163], v[186:187], v[72:73], 0 cbsz:4 abid:14
    v_rcp_f32 v180, v180
    v_mfma_f32_4x4x4_16b_bf16 v[164:167], v[186:187], v[74:75], 0 cbsz:4 abid:14
    v_rcp_f32 v181, v181
    v_mfma_f32_4x4x4_16b_bf16 v[168:171], v[186:187], v[76:77], 0 cbsz:4 abid:15
    v_rcp_f32 v182, v182
    v_mfma_f32_4x4x4_16b_bf16 v[172:175], v[186:187], v[78:79], 0 cbsz:4 abid:15
    v_rcp_f32 v183, v183
    v_readlane_b32 s68, v228, 18
    v_readlane_b32 s69, v228, 22
    v_readlane_b32 s70, v228, 26
    v_readlane_b32 s71, v228, 30
    v_pk_mul_f32 v[176:177], v[176:177], v[124:125]
    v_pk_mul_f32 v[178:179], v[178:179], v[126:127]
    v_pk_mul_f32 v[180:181], v[180:181], v[140:141]
    v_pk_mul_f32 v[182:183], v[182:183], v[142:143]
    s_set_gpr_idx_on s76, gpr_idx(SRC2,DST)
    v_pk_fma_f32 v[8:9], v[176:177], v[144:145], v[8:9] op_sel:[0,0,0] op_sel_hi:[0,1,1]
    v_pk_fma_f32 v[10:11], v[176:177], v[146:147], v[10:11] op_sel:[0,0,0] op_sel_hi:[0,1,1]
    v_pk_fma_f32 v[12:13], v[180:181], v[148:149], v[12:13] op_sel:[0,0,0] op_sel_hi:[0,1,1]
    v_pk_fma_f32 v[14:15], v[180:181], v[150:151], v[14:15] op_sel:[0,0,0] op_sel_hi:[0,1,1]
    s_set_gpr_idx_idx s77
    v_pk_fma_f32 v[8:9], v[176:177], v[152:153], v[8:9] op_sel:[1,0,0] op_sel_hi:[1,1,1]
    v_pk_fma_f32 v[10:11], v[176:177], v[154:155], v[10:11] op_sel:[1,0,0] op_sel_hi:[1,1,1]
    v_pk_fma_f32 v[12:13], v[180:181], v[156:157], v[12:13] op_sel:[1,0,0] op_sel_hi:[1,1,1]
    v_pk_fma_f32 v[14:15], v[180:181], v[158:159], v[14:15] op_sel:[1,0,0] op_sel_hi:[1,1,1]
    s_set_gpr_idx_idx s78
    v_pk_fma_f32 v[8:9], v[178:179], v[160:161], v[8:9] op_sel:[0,0,0] op_sel_hi:[0,1,1]
    v_pk_fma_f32 v[10:11], v[178:179], v[162:163], v[10:11] op_sel:[0,0,0] op_sel_hi:[0,1,1]
    v_pk_fma_f32 v[12:13], v[182:183], v[164:165], v[12:13] op_sel:[0,0,0] op_sel_hi:[0,1,1]
    v_pk_fma_f32 v[14:15], v[182:183], v[166:167], v[14:15] op_sel:[0,0,0] op_sel_hi:[0,1,1]
    s_set_gpr_idx_idx s79
    v_pk_fma_f32 v[8:9], v[178:179], v[168:169], v[8:9] op_sel:[1,0,0] op_sel_hi:[1,1,1]
    v_pk_fma_f32 v[10:11], v[178:179], v[170:171], v[10:11] op_sel:[1,0,0] op_sel_hi:[1,1,1]
    v_pk_fma_f32 v[12:13], v[182:183], v[172:173], v[12:13] op_sel:[1,0,0] op_sel_hi:[1,1,1]
    v_pk_fma_f32 v[14:15], v[182:183], v[174:175], v[14:15] op_sel:[1,0,0] op_sel_hi:[1,1,1]
    s_set_gpr_idx_off
    s_and_b32 s80, s68, s31
    s_and_b32 s81, s69, s31
    s_and_b32 s82, s70, s31
    s_and_b32 s83, s71, s31
    buffer_load_dwordx4 v[64:67], v232, s[4:7], s80 offen
    buffer_load_dwordx4 v[68:71], v232, s[4:7], s81 offen
    buffer_load_dwordx4 v[72:75], v232, s[4:7], s82 offen
    buffer_load_dwordx4 v[76:79], v232, s[4:7], s83 offen
    s_cmp_le_i32 s30, 32
    s_waitcnt lgkmcnt(0)
    s_cbranch_scc1 L_exit
    s_setprio 3
    v_mfma_f32_32x32x16_bf16 v[112:127], v[192:195], v[200:203], 0
    v_exp_f32 v176, v80
    v_exp_f32 v177, v81
    v_exp_f32 v178, v82
    v_exp_f32 v179, v83
    v_exp_f32 v180, v96
    v_exp_f32 v181, v97
    v_exp_f32 v182, v98
    v_exp_f32 v183, v99
    v_pk_fma_f32 v[176:177], v[176:177], s[56:57], s[56:57]
    v_pk_fma_f32 v[178:179], v[178:179], s[56:57], s[56:57]
    v_pk_fma_f32 v[180:181], v[180:181], s[56:57], s[56:57]
    v_pk_fma_f32 v[182:183], v[182:183], s[56:57], s[56:57]
    s_waitcnt vmcnt(4)
    v_mfma_f32_4x4x4_16b_bf16 v[144:147], v[188:189], v[48:49], 0 cbsz:4 abid:0
    v_rcp_f32 v176, v176
    v_mfma_f32_4x4x4_16b_bf16 v[148:151], v[188:189], v[50:51], 0 cbsz:4 abid:0
    v_rcp_f32 v177, v177
    v_mfma_f32_4x4x4_16b_bf16 v[152:155], v[188:189], v[52:53], 0 cbsz:4 abid:1
    v_rcp_f32 v178, v178
    v_mfma_f32_4x4x4_16b_bf16 v[156:159], v[188:189], v[54:55], 0 cbsz:4 abid:1
    v_rcp_f32 v179, v179
    v_mfma_f32_4x4x4_16b_bf16 v[160:163], v[188:189], v[56:57], 0 cbsz:4 abid:2
    v_rcp_f32 v180, v180
    v_mfma_f32_4x4x4_16b_bf16 v[164:167], v[188:189], v[58:59], 0 cbsz:4 abid:2
    v_rcp_f32 v181, v181
    v_mfma_f32_4x4x4_16b_bf16 v[168:171], v[188:189], v[60:61], 0 cbsz:4 abid:3
    v_rcp_f32 v182, v182
    v_mfma_f32_4x4x4_16b_bf16 v[172:175], v[188:189], v[62:63], 0 cbsz:4 abid:3
    v_rcp_f32 v183, v183
    v_readlane_b32 s72, v228, 34
    v_readlane_b32 s73, v228, 38
    v_readlane_b32 s74, v228, 42
    v_readlane_b32 s75, v228, 46
    v_pk_mul_f32 v[176:177], v[176:177], v[80:81]
    v_pk_mul_f32 v[178:179], v[178:179], v[82:83]
    v_pk_mul_f32 v[180:181], v[180:181], v[96:97]
    v_pk_mul_f32 v[182:183], v[182:183], v[98:99]
    s_set_gpr_idx_on s64, gpr_idx(SRC2,DST)
    v_pk_fma_f32 v[8:9], v[176:177], v[144:145], v[8:9] op_sel:[0,0,0] op_sel_hi:[0,1,1]
    v_pk_fma_f32 v[10:11], v[176:177], v[146:147], v[10:11] op_sel:[0,0,0] op_sel_hi:[0,1,1]
    v_pk_fma_f32 v[12:13], v[180:181], v[148:149], v[12:13] op_sel:[0,0,0] op_sel_hi:[0,1,1]
    v_pk_fma_f32 v[14:15], v[180:181], v[150:151], v[14:15] op_sel:[0,0,0] op_sel_hi:[0,1,1]
    s_set_gpr_idx_idx s65
    v_pk_fma_f32 v[8:9], v[176:177], v[152:153], v[8:9] op_sel:[1,0,0] op_sel_hi:[1,1,1]
    v_pk_fma_f32 v[10:11], v[176:177], v[154:155], v[10:11] op_sel:[1,0,0] op_sel_hi:[1,1,1]
    v_pk_fma_f32 v[12:13], v[180:181], v[156:157], v[12:13] op_sel:[1,0,0] op_sel_hi:[1,1,1]
    v_pk_fma_f32 v[14:15], v[180:181], v[158:159], v[14:15] op_sel:[1,0,0] op_sel_hi:[1,1,1]
    s_set_gpr_idx_idx s66
    v_pk_fma_f32 v[8:9], v[178:179], v[160:161], v[8:9] op_sel:[0,0,0] op_sel_hi:[0,1,1]
    v_pk_fma_f32 v[10:11], v[178:179], v[162:163], v[10:11] op_sel:[0,0,0] op_sel_hi:[0,1,1]
    v_pk_fma_f32 v[12:13], v[182:183], v[164:165], v[12:13] op_sel:[0,0,0] op_sel_hi:[0,1,1]
    v_pk_fma_f32 v[14:15], v[182:183], v[166:167], v[14:15] op_sel:[0,0,0] op_sel_hi:[0,1,1]
    s_set_gpr_idx_idx s67
    v_pk_fma_f32 v[8:9], v[178:179], v[168:169], v[8:9] op_sel:[1,0,0] op_sel_hi:[1,1,1]
    v_pk_fma_f32 v[10:11], v[178:179], v[170:171], v[10:11] op_sel:[1,0,0] op_sel_hi:[1,1,1]
    v_pk_fma_f32 v[12:13], v[182:183], v[172:173], v[12:13] op_sel:[1,0,0] op_sel_hi:[1,1,1]
    v_pk_fma_f32 v[14:15], v[182:183], v[174:175], v[14:15] op_sel:[1,0,0] op_sel_hi:[1,1,1]
    s_set_gpr_idx_off
    s_and_b32 s80, s72, s31
    s_and_b32 s81, s73, s31
    s_and_b32 s82, s74, s31
    s_and_b32 s83, s75, s31
    buffer_load_dwordx4 v[48:51], v232, s[4:7], s80 offen
    buffer_load_dwordx4 v[52:55], v232, s[4:7], s81 offen
    buffer_load_dwordx4 v[56:59], v232, s[4:7], s82 offen
    buffer_load_dwordx4 v[60:63], v232, s[4:7], s83 offen
    s_cmp_le_i32 s30, 36
    s_mov_b64 exec, s[22:23]
    ds_read_b128 v[196:199], v229 offset:46080
    s_mov_b64 exec, -1
    ds_read_b32 v2, v231 offset:1036
    s_cbranch_scc1 L_exit
    s_setprio 2
    v_mfma_f32_32x32x16_bf16 v[128:143], v[192:195], v[204:207], 0
    v_exp_f32 v176, v84
    v_exp_f32 v177, v85
    v_exp_f32 v178, v86
    v_exp_f32 v179, v87
    v_exp_f32 v180, v100
    v_exp_f32 v181, v101
    v_exp_f32 v182, v102
    v_exp_f32 v183, v103
    v_pk_fma_f32 v[176:177], v[176:177], s[56:57], s[56:57]
    v_pk_fma_f32 v[178:179], v[178:179], s[56:57], s[56:57]
    v_pk_fma_f32 v[180:181], v[180:181], s[56:57], s[56:57]
    v_pk_fma_f32 v[182:183], v[182:183], s[56:57], s[56:57]
    s_waitcnt vmcnt(4)
    v_mfma_f32_4x4x4_16b_bf16 v[144:147], v[188:189], v[64:65], 0 cbsz:4 abid:4
    v_rcp_f32 v176, v176
    v_mfma_f32_4x4x4_16b_bf16 v[148:151], v[188:189], v[66:67], 0 cbsz:4 abid:4
    v_rcp_f32 v177, v177
    v_mfma_f32_4x4x4_16b_bf16 v[152:155], v[188:189], v[68:69], 0 cbsz:4 abid:5
    v_rcp_f32 v178, v178
    v_mfma_f32_4x4x4_16b_bf16 v[156:159], v[188:189], v[70:71], 0 cbsz:4 abid:5
    v_rcp_f32 v179, v179
    v_mfma_f32_4x4x4_16b_bf16 v[160:163], v[188:189], v[72:73], 0 cbsz:4 abid:6
    v_rcp_f32 v180, v180
    v_mfma_f32_4x4x4_16b_bf16 v[164:167], v[188:189], v[74:75], 0 cbsz:4 abid:6
    v_rcp_f32 v181, v181
    v_mfma_f32_4x4x4_16b_bf16 v[168:171], v[188:189], v[76:77], 0 cbsz:4 abid:7
    v_rcp_f32 v182, v182
    v_mfma_f32_4x4x4_16b_bf16 v[172:175], v[188:189], v[78:79], 0 cbsz:4 abid:7
    v_rcp_f32 v183, v183
    v_readlane_b32 s76, v228, 50
    v_readlane_b32 s77, v228, 54
    v_readlane_b32 s78, v228, 58
    v_readlane_b32 s79, v228, 62
    v_pk_mul_f32 v[176:177], v[176:177], v[84:85]
    v_pk_mul_f32 v[178:179], v[178:179], v[86:87]
    v_pk_mul_f32 v[180:181], v[180:181], v[100:101]
    v_pk_mul_f32 v[182:183], v[182:183], v[102:103]
    s_set_gpr_idx_on s68, gpr_idx(SRC2,DST)
    v_pk_fma_f32 v[8:9], v[176:177], v[144:145], v[8:9] op_sel:[0,0,0] op_sel_hi:[0,1,1]
    v_pk_fma_f32 v[10:11], v[176:177], v[146:147], v[10:11] op_sel:[0,0,0] op_sel_hi:[0,1,1]
    v_pk_fma_f32 v[12:13], v[180:181], v[148:149], v[12:13] op_sel:[0,0,0] op_sel_hi:[0,1,1]
    v_pk_fma_f32 v[14:15], v[180:181], v[150:151], v[14:15] op_sel:[0,0,0] op_sel_hi:[0,1,1]
    s_set_gpr_idx_idx s69
    v_pk_fma_f32 v[8:9], v[176:177], v[152:153], v[8:9] op_sel:[1,0,0] op_sel_hi:[1,1,1]
    v_pk_fma_f32 v[10:11], v[176:177], v[154:155], v[10:11] op_sel:[1,0,0] op_sel_hi:[1,1,1]
    v_pk_fma_f32 v[12:13], v[180:181], v[156:157], v[12:13] op_sel:[1,0,0] op_sel_hi:[1,1,1]
    v_pk_fma_f32 v[14:15], v[180:181], v[158:159], v[14:15] op_sel:[1,0,0] op_sel_hi:[1,1,1]
    s_set_gpr_idx_idx s70
    v_pk_fma_f32 v[8:9], v[178:179], v[160:161], v[8:9] op_sel:[0,0,0] op_sel_hi:[0,1,1]
    v_pk_fma_f32 v[10:11], v[178:179], v[162:163], v[10:11] op_sel:[0,0,0] op_sel_hi:[0,1,1]
    v_pk_fma_f32 v[12:13], v[182:183], v[164:165], v[12:13] op_sel:[0,0,0] op_sel_hi:[0,1,1]
    v_pk_fma_f32 v[14:15], v[182:183], v[166:167], v[14:15] op_sel:[0,0,0] op_sel_hi:[0,1,1]
    s_set_gpr_idx_idx s71
    v_pk_fma_f32 v[8:9], v[178:179], v[168:169], v[8:9] op_sel:[1,0,0] op_sel_hi:[1,1,1]
    v_pk_fma_f32 v[10:11], v[178:179], v[170:171], v[10:11] op_sel:[1,0,0] op_sel_hi:[1,1,1]
    v_pk_fma_f32 v[12:13], v[182:183], v[172:173], v[12:13] op_sel:[1,0,0] op_sel_hi:[1,1,1]
    v_pk_fma_f32 v[14:15], v[182:183], v[174:175], v[14:15] op_sel:[1,0,0] op_sel_hi:[1,1,1]
    s_set_gpr_idx_off
    s_and_b32 s80, s76, s31
    s_and_b32 s81, s77, s31
    s_and_b32 s82, s78, s31
    s_and_b32 s83, s79, s31
    buffer_load_dwordx4 v[64:67], v232, s[4:7], s80 offen
    buffer_load_dwordx4 v[68:71], v232, s[4:7], s81 offen
    buffer_load_dwordx4 v[72:75], v232, s[4:7], s82 offen
    buffer_load_dwordx4 v[76:79], v232, s[4:7], s83 offen
    s_cmp_le_i32 s30, 40
    s_waitcnt lgkmcnt(0)
    s_cbranch_scc1 L_exit
    s_setprio 1
    v_mfma_f32_32x32x16_bf16 v[112:127], v[196:199], v[208:211], v[112:127]
    v_exp_f32 v176, v88
    v_exp_f32 v177, v89
    v_exp_f32 v178, v90
    v_exp_f32 v179, v91
    v_exp_f32 v180, v104
    v_exp_f32 v181, v105
    v_exp_f32 v182, v106
    v_exp_f32 v183, v107
    v_pk_fma_f32 v[176:177], v[176:177], s[56:57], s[56:57]
    v_pk_fma_f32 v[178:179], v[178:179], s[56:57], s[56:57]
    v_pk_fma_f32 v[180:181], v[180:181], s[56:57], s[56:57]
    v_pk_fma_f32 v[182:183], v[182:183], s[56:57], s[56:57]
    s_waitcnt vmcnt(4)
    v_mfma_f32_4x4x4_16b_bf16 v[144:147], v[188:189], v[48:49], 0 cbsz:4 abid:8
    v_rcp_f32 v176, v176
    v_mfma_f32_4x4x4_16b_bf16 v[148:151], v[188:189], v[50:51], 0 cbsz:4 abid:8
    v_rcp_f32 v177, v177
    v_mfma_f32_4x4x4_16b_bf16 v[152:155], v[188:189], v[52:53], 0 cbsz:4 abid:9
    v_rcp_f32 v178, v178
    v_mfma_f32_4x4x4_16b_bf16 v[156:159], v[188:189], v[54:55], 0 cbsz:4 abid:9
    v_rcp_f32 v179, v179
    v_mfma_f32_4x4x4_16b_bf16 v[160:163], v[188:189], v[56:57], 0 cbsz:4 abid:10
    v_rcp_f32 v180, v180
    v_mfma_f32_4x4x4_16b_bf16 v[164:167], v[188:189], v[58:59], 0 cbsz:4 abid:10
    v_rcp_f32 v181, v181
    v_mfma_f32_4x4x4_16b_bf16 v[168:171], v[188:189], v[60:61], 0 cbsz:4 abid:11
    v_rcp_f32 v182, v182
    v_mfma_f32_4x4x4_16b_bf16 v[172:175], v[188:189], v[62:63], 0 cbsz:4 abid:11
    v_rcp_f32 v183, v183
    v_readlane_b32 s64, v228, 3
    v_readlane_b32 s65, v228, 7
    v_readlane_b32 s66, v228, 11
    v_readlane_b32 s67, v228, 15
    v_and_or_b32 v229, v2, s33, v233
    v_pk_mul_f32 v[176:177], v[176:177], v[88:89]
    v_pk_mul_f32 v[178:179], v[178:179], v[90:91]
    v_pk_mul_f32 v[180:181], v[180:181], v[104:105]
    v_pk_mul_f32 v[182:183], v[182:183], v[106:107]
    s_set_gpr_idx_on s72, gpr_idx(SRC2,DST)
    v_pk_fma_f32 v[8:9], v[176:177], v[144:145], v[8:9] op_sel:[0,0,0] op_sel_hi:[0,1,1]
    v_pk_fma_f32 v[10:11], v[176:177], v[146:147], v[10:11] op_sel:[0,0,0] op_sel_hi:[0,1,1]
    v_pk_fma_f32 v[12:13], v[180:181], v[148:149], v[12:13] op_sel:[0,0,0] op_sel_hi:[0,1,1]
    v_pk_fma_f32 v[14:15], v[180:181], v[150:151], v[14:15] op_sel:[0,0,0] op_sel_hi:[0,1,1]
    s_set_gpr_idx_idx s73
    v_pk_fma_f32 v[8:9], v[176:177], v[152:153], v[8:9] op_sel:[1,0,0] op_sel_hi:[1,1,1]
    v_pk_fma_f32 v[10:11], v[176:177], v[154:155], v[10:11] op_sel:[1,0,0] op_sel_hi:[1,1,1]
    v_pk_fma_f32 v[12:13], v[180:181], v[156:157], v[12:13] op_sel:[1,0,0] op_sel_hi:[1,1,1]
    v_pk_fma_f32 v[14:15], v[180:181], v[158:159], v[14:15] op_sel:[1,0,0] op_sel_hi:[1,1,1]
    s_set_gpr_idx_idx s74
    v_pk_fma_f32 v[8:9], v[178:179], v[160:161], v[8:9] op_sel:[0,0,0] op_sel_hi:[0,1,1]
    v_pk_fma_f32 v[10:11], v[178:179], v[162:163], v[10:11] op_sel:[0,0,0] op_sel_hi:[0,1,1]
    v_pk_fma_f32 v[12:13], v[182:183], v[164:165], v[12:13] op_sel:[0,0,0] op_sel_hi:[0,1,1]
    v_pk_fma_f32 v[14:15], v[182:183], v[166:167], v[14:15] op_sel:[0,0,0] op_sel_hi:[0,1,1]
    s_set_gpr_idx_idx s75
    v_pk_fma_f32 v[8:9], v[178:179], v[168:169], v[8:9] op_sel:[1,0,0] op_sel_hi:[1,1,1]
    v_pk_fma_f32 v[10:11], v[178:179], v[170:171], v[10:11] op_sel:[1,0,0] op_sel_hi:[1,1,1]
    v_pk_fma_f32 v[12:13], v[182:183], v[172:173], v[12:13] op_sel:[1,0,0] op_sel_hi:[1,1,1]
    v_pk_fma_f32 v[14:15], v[182:183], v[174:175], v[14:15] op_sel:[1,0,0] op_sel_hi:[1,1,1]
    s_set_gpr_idx_off
    s_and_b32 s80, s64, s31
    s_and_b32 s81, s65, s31
    s_and_b32 s82, s66, s31
    s_and_b32 s83, s67, s31
    buffer_load_dwordx4 v[48:51], v232, s[4:7], s80 offen
    buffer_load_dwordx4 v[52:55], v232, s[4:7], s81 offen
    buffer_load_dwordx4 v[56:59], v232, s[4:7], s82 offen
    buffer_load_dwordx4 v[60:63], v232, s[4:7], s83 offen
    s_cmp_le_i32 s30, 44
    s_mov_b64 exec, s[20:21]
    ds_read_b128 v[192:195], v229 offset:46080
    s_mov_b64 exec, -1
    s_cbranch_scc1 L_exit
    s_setprio 0
    v_mfma_f32_32x32x16_bf16 v[128:143], v[196:199], v[212:215], v[128:143]
    v_exp_f32 v176, v92
    v_exp_f32 v177, v93
    v_exp_f32 v178, v94
    v_exp_f32 v179, v95
    v_exp_f32 v180, v108
    v_exp_f32 v181, v109
    v_exp_f32 v182, v110
    v_exp_f32 v183, v111
    v_pk_fma_f32 v[176:177], v[176:177], s[56:57], s[56:57]
    v_pk_fma_f32 v[178:179], v[178:179], s[56:57], s[56:57]
    v_pk_fma_f32 v[180:181], v[180:181], s[56:57], s[56:57]
    v_pk_fma_f32 v[182:183], v[182:183], s[56:57], s[56:57]
    s_waitcnt vmcnt(4)
    v_mfma_f32_4x4x4_16b_bf16 v[144:147], v[188:189], v[64:65], 0 cbsz:4 abid:12
    v_rcp_f32 v176, v176
    v_mfma_f32_4x4x4_16b_bf16 v[148:151], v[188:189], v[66:67], 0 cbsz:4 abid:12
    v_rcp_f32 v177, v177
    v_mfma_f32_4x4x4_16b_bf16 v[152:155], v[188:189], v[68:69], 0 cbsz:4 abid:13
    v_rcp_f32 v178, v178
    v_mfma_f32_4x4x4_16b_bf16 v[156:159], v[188:189], v[70:71], 0 cbsz:4 abid:13
    v_rcp_f32 v179, v179
    v_mfma_f32_4x4x4_16b_bf16 v[160:163], v[188:189], v[72:73], 0 cbsz:4 abid:14
    v_rcp_f32 v180, v180
    v_mfma_f32_4x4x4_16b_bf16 v[164:167], v[188:189], v[74:75], 0 cbsz:4 abid:14
    v_rcp_f32 v181, v181
    v_mfma_f32_4x4x4_16b_bf16 v[168:171], v[188:189], v[76:77], 0 cbsz:4 abid:15
    v_rcp_f32 v182, v182
    v_mfma_f32_4x4x4_16b_bf16 v[172:175], v[188:189], v[78:79], 0 cbsz:4 abid:15
    v_rcp_f32 v183, v183
    v_readlane_b32 s68, v228, 19
    v_readlane_b32 s69, v228, 23
    v_readlane_b32 s70, v228, 27
    v_readlane_b32 s71, v228, 31
    v_pk_mul_f32 v[176:177], v[176:177], v[92:93]
    v_pk_mul_f32 v[178:179], v[178:179], v[94:95]
    v_pk_mul_f32 v[180:181], v[180:181], v[108:109]
    v_pk_mul_f32 v[182:183], v[182:183], v[110:111]
    s_set_gpr_idx_on s76, gpr_idx(SRC2,DST)
    v_pk_fma_f32 v[8:9], v[176:177], v[144:145], v[8:9] op_sel:[0,0,0] op_sel_hi:[0,1,1]
    v_pk_fma_f32 v[10:11], v[176:177], v[146:147], v[10:11] op_sel:[0,0,0] op_sel_hi:[0,1,1]
    v_pk_fma_f32 v[12:13], v[180:181], v[148:149], v[12:13] op_sel:[0,0,0] op_sel_hi:[0,1,1]
    v_pk_fma_f32 v[14:15], v[180:181], v[150:151], v[14:15] op_sel:[0,0,0] op_sel_hi:[0,1,1]
    s_set_gpr_idx_idx s77
    v_pk_fma_f32 v[8:9], v[176:177], v[152:153], v[8:9] op_sel:[1,0,0] op_sel_hi:[1,1,1]
    v_pk_fma_f32 v[10:11], v[176:177], v[154:155], v[10:11] op_sel:[1,0,0] op_sel_hi:[1,1,1]
    v_pk_fma_f32 v[12:13], v[180:181], v[156:157], v[12:13] op_sel:[1,0,0] op_sel_hi:[1,1,1]
    v_pk_fma_f32 v[14:15], v[180:181], v[158:159], v[14:15] op_sel:[1,0,0] op_sel_hi:[1,1,1]
    s_set_gpr_idx_idx s78
    v_pk_fma_f32 v[8:9], v[178:179], v[160:161], v[8:9] op_sel:[0,0,0] op_sel_hi:[0,1,1]
    v_pk_fma_f32 v[10:11], v[178:179], v[162:163], v[10:11] op_sel:[0,0,0] op_sel_hi:[0,1,1]
    v_pk_fma_f32 v[12:13], v[182:183], v[164:165], v[12:13] op_sel:[0,0,0] op_sel_hi:[0,1,1]
    v_pk_fma_f32 v[14:15], v[182:183], v[166:167], v[14:15] op_sel:[0,0,0] op_sel_hi:[0,1,1]
    s_set_gpr_idx_idx s79
    v_pk_fma_f32 v[8:9], v[178:179], v[168:169], v[8:9] op_sel:[1,0,0] op_sel_hi:[1,1,1]
    v_pk_fma_f32 v[10:11], v[178:179], v[170:171], v[10:11] op_sel:[1,0,0] op_sel_hi:[1,1,1]
    v_pk_fma_f32 v[12:13], v[182:183], v[172:173], v[12:13] op_sel:[1,0,0] op_sel_hi:[1,1,1]
    v_pk_fma_f32 v[14:15], v[182:183], v[174:175], v[14:15] op_sel:[1,0,0] op_sel_hi:[1,1,1]
    s_set_gpr_idx_off
    s_and_b32 s80, s68, s31
    s_and_b32 s81, s69, s31
    s_and_b32 s82, s70, s31
    s_and_b32 s83, s71, s31
    buffer_load_dwordx4 v[64:67], v232, s[4:7], s80 offen
    buffer_load_dwordx4 v[68:71], v232, s[4:7], s81 offen
    buffer_load_dwordx4 v[72:75], v232, s[4:7], s82 offen
    buffer_load_dwordx4 v[76:79], v232, s[4:7], s83 offen
    s_cmp_le_i32 s30, 48
    s_waitcnt lgkmcnt(0)
    s_cbranch_scc1 L_exit
    s_setprio 3
    v_mfma_f32_32x32x16_bf16 v[80:95], v[192:195], v[200:203], 0
    v_exp_f32 v176, v112
    v_exp_f32 v177, v113
    v_exp_f32 v178, v114
    v_exp_f32 v179, v115
    v_exp_f32 v180, v128
    v_exp_f32 v181, v129
    v_exp_f32 v182, v130
    v_exp_f32 v183, v131
    v_pk_fma_f32 v[176:177], v[176:177], s[56:57], s[56:57]
    v_pk_fma_f32 v[178:179], v[178:179], s[56:57], s[56:57]
    v_pk_fma_f32 v[180:181], v[180:181], s[56:57], s[56:57]
    v_pk_fma_f32 v[182:183], v[182:183], s[56:57], s[56:57]
    s_waitcnt vmcnt(4)
    v_mfma_f32_4x4x4_16b_bf16 v[144:147], v[190:191], v[48:49], 0 cbsz:4 abid:0
    v_rcp_f32 v176, v176
    v_mfma_f32_4x4x4_16b_bf16 v[148:151], v[190:191], v[50:51], 0 cbsz:4 abid:0
    v_rcp_f32 v177, v177
    v_mfma_f32_4x4x4_16b_bf16 v[152:155], v[190:191], v[52:53], 0 cbsz:4 abid:1
    v_rcp_f32 v178, v178
    v_mfma_f32_4x4x4_16b_bf16 v[156:159], v[190:191], v[54:55], 0 cbsz:4 abid:1
    v_rcp_f32 v179, v179
    v_mfma_f32_4x4x4_16b_bf16 v[160:163], v[190:191], v[56:57], 0 cbsz:4 abid:2
    v_rcp_f32 v180, v180
    v_mfma_f32_4x4x4_16b_bf16 v[164:167], v[190:191], v[58:59], 0 cbsz:4 abid:2
    v_rcp_f32 v181, v181
    v_mfma_f32_4x4x4_16b_bf16 v[168:171], v[190:191], v[60:61], 0 cbsz:4 abid:3
    v_rcp_f32 v182, v182
    v_mfma_f32_4x4x4_16b_bf16 v[172:175], v[190:191], v[62:63], 0 cbsz:4 abid:3
    v_rcp_f32 v183, v183
    v_readlane_b32 s72, v228, 35
    v_readlane_b32 s73, v228, 39
    v_readlane_b32 s74, v228, 43
    v_readlane_b32 s75, v228, 47
    v_pk_mul_f32 v[176:177], v[176:177], v[112:113]
    v_pk_mul_f32 v[178:179], v[178:179], v[114:115]
    v_pk_mul_f32 v[180:181], v[180:181], v[128:129]
    v_pk_mul_f32 v[182:183], v[182:183], v[130:131]
    s_set_gpr_idx_on s64, gpr_idx(SRC2,DST)
    v_pk_fma_f32 v[8:9], v[176:177], v[144:145], v[8:9] op_sel:[0,0,0] op_sel_hi:[0,1,1]
    v_pk_fma_f32 v[10:11], v[176:177], v[146:147], v[10:11] op_sel:[0,0,0] op_sel_hi:[0,1,1]
    v_pk_fma_f32 v[12:13], v[180:181], v[148:149], v[12:13] op_sel:[0,0,0] op_sel_hi:[0,1,1]
    v_pk_fma_f32 v[14:15], v[180:181], v[150:151], v[14:15] op_sel:[0,0,0] op_sel_hi:[0,1,1]
    s_set_gpr_idx_idx s65
    v_pk_fma_f32 v[8:9], v[176:177], v[152:153], v[8:9] op_sel:[1,0,0] op_sel_hi:[1,1,1]
    v_pk_fma_f32 v[10:11], v[176:177], v[154:155], v[10:11] op_sel:[1,0,0] op_sel_hi:[1,1,1]
    v_pk_fma_f32 v[12:13], v[180:181], v[156:157], v[12:13] op_sel:[1,0,0] op_sel_hi:[1,1,1]
    v_pk_fma_f32 v[14:15], v[180:181], v[158:159], v[14:15] op_sel:[1,0,0] op_sel_hi:[1,1,1]
    s_set_gpr_idx_idx s66
    v_pk_fma_f32 v[8:9], v[178:179], v[160:161], v[8:9] op_sel:[0,0,0] op_sel_hi:[0,1,1]
    v_pk_fma_f32 v[10:11], v[178:179], v[162:163], v[10:11] op_sel:[0,0,0] op_sel_hi:[0,1,1]
    v_pk_fma_f32 v[12:13], v[182:183], v[164:165], v[12:13] op_sel:[0,0,0] op_sel_hi:[0,1,1]
    v_pk_fma_f32 v[14:15], v[182:183], v[166:167], v[14:15] op_sel:[0,0,0] op_sel_hi:[0,1,1]
    s_set_gpr_idx_idx s67
    v_pk_fma_f32 v[8:9], v[178:179], v[168:169], v[8:9] op_sel:[1,0,0] op_sel_hi:[1,1,1]
    v_pk_fma_f32 v[10:11], v[178:179], v[170:171], v[10:11] op_sel:[1,0,0] op_sel_hi:[1,1,1]
    v_pk_fma_f32 v[12:13], v[182:183], v[172:173], v[12:13] op_sel:[1,0,0] op_sel_hi:[1,1,1]
    v_pk_fma_f32 v[14:15], v[182:183], v[174:175], v[14:15] op_sel:[1,0,0] op_sel_hi:[1,1,1]
    s_set_gpr_idx_off
    s_and_b32 s80, s72, s31
    s_and_b32 s81, s73, s31
    s_and_b32 s82, s74, s31
    s_and_b32 s83, s75, s31
    buffer_load_dwordx4 v[48:51], v232, s[4:7], s80 offen
    buffer_load_dwordx4 v[52:55], v232, s[4:7], s81 offen
    buffer_load_dwordx4 v[56:59], v232, s[4:7], s82 offen
    buffer_load_dwordx4 v[60:63], v232, s[4:7], s83 offen
    s_cmp_le_i32 s30, 52
    s_mov_b64 exec, s[22:23]
    ds_read_b128 v[196:199], v229 offset:46080
    s_mov_b64 exec, -1
    ds_read_b32 v2, v231 offset:1292
    s_cbranch_scc1 L_exit
    s_setprio 2
    v_mfma_f32_32x32x16_bf16 v[96:111], v[192:195], v[204:207], 0
    v_exp_f32 v176, v116
    v_exp_f32 v177, v117
    v_exp_f32 v178, v118
    v_exp_f32 v179, v119
    v_exp_f32 v180, v132
    v_exp_f32 v181, v133
    v_exp_f32 v182, v134
    v_exp_f32 v183, v135
    v_pk_fma_f32 v[176:177], v[176:177], s[56:57], s[56:57]
    v_pk_fma_f32 v[178:179], v[178:179], s[56:57], s[56:57]
    v_pk_fma_f32 v[180:181], v[180:181], s[56:57], s[56:57]
    v_pk_fma_f32 v[182:183], v[182:183], s[56:57], s[56:57]
    s_waitcnt vmcnt(4)
    v_mfma_f32_4x4x4_16b_bf16 v[144:147], v[190:191], v[64:65], 0 cbsz:4 abid:4
    v_rcp_f32 v176, v176
    v_mfma_f32_4x4x4_16b_bf16 v[148:151], v[190:191], v[66:67], 0 cbsz:4 abid:4
    v_rcp_f32 v177, v177
    v_mfma_f32_4x4x4_16b_bf16 v[152:155], v[190:191], v[68:69], 0 cbsz:4 abid:5
    v_rcp_f32 v178, v178
    v_mfma_f32_4x4x4_16b_bf16 v[156:159], v[190:191], v[70:71], 0 cbsz:4 abid:5
    v_rcp_f32 v179, v179
    v_mfma_f32_4x4x4_16b_bf16 v[160:163], v[190:191], v[72:73], 0 cbsz:4 abid:6
    v_rcp_f32 v180, v180
    v_mfma_f32_4x4x4_16b_bf16 v[164:167], v[190:191], v[74:75], 0 cbsz:4 abid:6
    v_rcp_f32 v181, v181
    v_mfma_f32_4x4x4_16b_bf16 v[168:171], v[190:191], v[76:77], 0 cbsz:4 abid:7
    v_rcp_f32 v182, v182
    v_mfma_f32_4x4x4_16b_bf16 v[172:175], v[190:191], v[78:79], 0 cbsz:4 abid:7
    v_rcp_f32 v183, v183
    v_readlane_b32 s76, v228, 51
    v_readlane_b32 s77, v228, 55
    v_readlane_b32 s78, v228, 59
    v_readlane_b32 s79, v228, 63
    v_pk_mul_f32 v[176:177], v[176:177], v[116:117]
    v_pk_mul_f32 v[178:179], v[178:179], v[118:119]
    v_pk_mul_f32 v[180:181], v[180:181], v[132:133]
    v_pk_mul_f32 v[182:183], v[182:183], v[134:135]
    s_set_gpr_idx_on s68, gpr_idx(SRC2,DST)
    v_pk_fma_f32 v[8:9], v[176:177], v[144:145], v[8:9] op_sel:[0,0,0] op_sel_hi:[0,1,1]
    v_pk_fma_f32 v[10:11], v[176:177], v[146:147], v[10:11] op_sel:[0,0,0] op_sel_hi:[0,1,1]
    v_pk_fma_f32 v[12:13], v[180:181], v[148:149], v[12:13] op_sel:[0,0,0] op_sel_hi:[0,1,1]
    v_pk_fma_f32 v[14:15], v[180:181], v[150:151], v[14:15] op_sel:[0,0,0] op_sel_hi:[0,1,1]
    s_set_gpr_idx_idx s69
    v_pk_fma_f32 v[8:9], v[176:177], v[152:153], v[8:9] op_sel:[1,0,0] op_sel_hi:[1,1,1]
    v_pk_fma_f32 v[10:11], v[176:177], v[154:155], v[10:11] op_sel:[1,0,0] op_sel_hi:[1,1,1]
    v_pk_fma_f32 v[12:13], v[180:181], v[156:157], v[12:13] op_sel:[1,0,0] op_sel_hi:[1,1,1]
    v_pk_fma_f32 v[14:15], v[180:181], v[158:159], v[14:15] op_sel:[1,0,0] op_sel_hi:[1,1,1]
    s_set_gpr_idx_idx s70
    v_pk_fma_f32 v[8:9], v[178:179], v[160:161], v[8:9] op_sel:[0,0,0] op_sel_hi:[0,1,1]
    v_pk_fma_f32 v[10:11], v[178:179], v[162:163], v[10:11] op_sel:[0,0,0] op_sel_hi:[0,1,1]
    v_pk_fma_f32 v[12:13], v[182:183], v[164:165], v[12:13] op_sel:[0,0,0] op_sel_hi:[0,1,1]
    v_pk_fma_f32 v[14:15], v[182:183], v[166:167], v[14:15] op_sel:[0,0,0] op_sel_hi:[0,1,1]
    s_set_gpr_idx_idx s71
    v_pk_fma_f32 v[8:9], v[178:179], v[168:169], v[8:9] op_sel:[1,0,0] op_sel_hi:[1,1,1]
    v_pk_fma_f32 v[10:11], v[178:179], v[170:171], v[10:11] op_sel:[1,0,0] op_sel_hi:[1,1,1]
    v_pk_fma_f32 v[12:13], v[182:183], v[172:173], v[12:13] op_sel:[1,0,0] op_sel_hi:[1,1,1]
    v_pk_fma_f32 v[14:15], v[182:183], v[174:175], v[14:15] op_sel:[1,0,0] op_sel_hi:[1,1,1]
    s_set_gpr_idx_off
    s_and_b32 s80, s76, s31
    s_and_b32 s81, s77, s31
    s_and_b32 s82, s78, s31
    s_and_b32 s83, s79, s31
    buffer_load_dwordx4 v[64:67], v232, s[4:7], s80 offen
    buffer_load_dwordx4 v[68:71], v232, s[4:7], s81 offen
    buffer_load_dwordx4 v[72:75], v232, s[4:7], s82 offen
    buffer_load_dwordx4 v[76:79], v232, s[4:7], s83 offen
    s_cmp_le_i32 s30, 56
    s_waitcnt lgkmcnt(0)
    s_cbranch_scc1 L_exit
    s_setprio 1
    v_cndmask_b32 v228, v4, v226, s[34:35]
    v_mfma_f32_32x32x16_bf16 v[80:95], v[196:199], v[208:211], v[80:95]
    v_exp_f32 v176, v120
    v_exp_f32 v177, v121
    v_exp_f32 v178, v122
    v_exp_f32 v179, v123
    v_exp_f32 v180, v136
    v_exp_f32 v181, v137
    v_exp_f32 v182, v138
    v_exp_f32 v183, v139
    v_pk_fma_f32 v[176:177], v[176:177], s[56:57], s[56:57]
    v_pk_fma_f32 v[178:179], v[178:179], s[56:57], s[56:57]
    v_pk_fma_f32 v[180:181], v[180:181], s[56:57], s[56:57]
    v_pk_fma_f32 v[182:183], v[182:183], s[56:57], s[56:57]
    s_waitcnt vmcnt(4)
    v_mfma_f32_4x4x4_16b_bf16 v[144:147], v[190:191], v[48:49], 0 cbsz:4 abid:8
    v_rcp_f32 v176, v176
    v_mfma_f32_4x4x4_16b_bf16 v[148:151], v[190:191], v[50:51], 0 cbsz:4 abid:8
    v_rcp_f32 v177, v177
    v_mfma_f32_4x4x4_16b_bf16 v[152:155], v[190:191], v[52:53], 0 cbsz:4 abid:9
    v_rcp_f32 v178, v178
    v_mfma_f32_4x4x4_16b_bf16 v[156:159], v[190:191], v[54:55], 0 cbsz:4 abid:9
    v_rcp_f32 v179, v179
    v_mfma_f32_4x4x4_16b_bf16 v[160:163], v[190:191], v[56:57], 0 cbsz:4 abid:10
    v_rcp_f32 v180, v180
    v_mfma_f32_4x4x4_16b_bf16 v[164:167], v[190:191], v[58:59], 0 cbsz:4 abid:10
    v_rcp_f32 v181, v181
    v_mfma_f32_4x4x4_16b_bf16 v[168:171], v[190:191], v[60:61], 0 cbsz:4 abid:11
    v_rcp_f32 v182, v182
    v_mfma_f32_4x4x4_16b_bf16 v[172:175], v[190:191], v[62:63], 0 cbsz:4 abid:11
    v_rcp_f32 v183, v183
    v_readlane_b32 s64, v228, 0
    v_readlane_b32 s65, v228, 4
    v_readlane_b32 s66, v228, 8
    v_readlane_b32 s67, v228, 12
    v_and_or_b32 v229, v2, s33, v233
    v_pk_mul_f32 v[176:177], v[176:177], v[120:121]
    v_pk_mul_f32 v[178:179], v[178:179], v[122:123]
    v_pk_mul_f32 v[180:181], v[180:181], v[136:137]
    v_pk_mul_f32 v[182:183], v[182:183], v[138:139]
    s_set_gpr_idx_on s72, gpr_idx(SRC2,DST)
    v_pk_fma_f32 v[8:9], v[176:177], v[144:145], v[8:9] op_sel:[0,0,0] op_sel_hi:[0,1,1]
    v_pk_fma_f32 v[10:11], v[176:177], v[146:147], v[10:11] op_sel:[0,0,0] op_sel_hi:[0,1,1]
    v_pk_fma_f32 v[12:13], v[180:181], v[148:149], v[12:13] op_sel:[0,0,0] op_sel_hi:[0,1,1]
    v_pk_fma_f32 v[14:15], v[180:181], v[150:151], v[14:15] op_sel:[0,0,0] op_sel_hi:[0,1,1]
    s_set_gpr_idx_idx s73
    v_pk_fma_f32 v[8:9], v[176:177], v[152:153], v[8:9] op_sel:[1,0,0] op_sel_hi:[1,1,1]
    v_pk_fma_f32 v[10:11], v[176:177], v[154:155], v[10:11] op_sel:[1,0,0] op_sel_hi:[1,1,1]
    v_pk_fma_f32 v[12:13], v[180:181], v[156:157], v[12:13] op_sel:[1,0,0] op_sel_hi:[1,1,1]
    v_pk_fma_f32 v[14:15], v[180:181], v[158:159], v[14:15] op_sel:[1,0,0] op_sel_hi:[1,1,1]
    s_set_gpr_idx_idx s74
    v_pk_fma_f32 v[8:9], v[178:179], v[160:161], v[8:9] op_sel:[0,0,0] op_sel_hi:[0,1,1]
    v_pk_fma_f32 v[10:11], v[178:179], v[162:163], v[10:11] op_sel:[0,0,0] op_sel_hi:[0,1,1]
    v_pk_fma_f32 v[12:13], v[182:183], v[164:165], v[12:13] op_sel:[0,0,0] op_sel_hi:[0,1,1]
    v_pk_fma_f32 v[14:15], v[182:183], v[166:167], v[14:15] op_sel:[0,0,0] op_sel_hi:[0,1,1]
    s_set_gpr_idx_idx s75
    v_pk_fma_f32 v[8:9], v[178:179], v[168:169], v[8:9] op_sel:[1,0,0] op_sel_hi:[1,1,1]
    v_pk_fma_f32 v[10:11], v[178:179], v[170:171], v[10:11] op_sel:[1,0,0] op_sel_hi:[1,1,1]
    v_pk_fma_f32 v[12:13], v[182:183], v[172:173], v[12:13] op_sel:[1,0,0] op_sel_hi:[1,1,1]
    v_pk_fma_f32 v[14:15], v[182:183], v[174:175], v[14:15] op_sel:[1,0,0] op_sel_hi:[1,1,1]
    s_set_gpr_idx_off
    s_and_b32 s80, s64, s31
    s_and_b32 s81, s65, s31
    s_and_b32 s82, s66, s31
    s_and_b32 s83, s67, s31
    buffer_load_dwordx4 v[48:51], v232, s[4:7], s80 offen
    buffer_load_dwordx4 v[52:55], v232, s[4:7], s81 offen
    buffer_load_dwordx4 v[56:59], v232, s[4:7], s82 offen
    buffer_load_dwordx4 v[60:63], v232, s[4:7], s83 offen
    s_cmp_le_i32 s30, 60
    s_mov_b64 exec, s[20:21]
    ds_read_b128 v[192:195], v229 offset:46080
    s_mov_b64 exec, -1
    s_cbranch_scc1 L_exit
    s_setprio 0
    v_mfma_f32_32x32x16_bf16 v[96:111], v[196:199], v[212:215], v[96:111]
    v_exp_f32 v176, v124
    v_exp_f32 v177, v125
    v_exp_f32 v178, v126
    v_exp_f32 v179, v127
    v_exp_f32 v180, v140
    v_exp_f32 v181, v141
    v_exp_f32 v182, v142
    v_exp_f32 v183, v143
    v_pk_fma_f32 v[176:177], v[176:177], s[56:57], s[56:57]
    v_pk_fma_f32 v[178:179], v[178:179], s[56:57], s[56:57]
    v_pk_fma_f32 v[180:181], v[180:181], s[56:57], s[56:57]
    v_pk_fma_f32 v[182:183], v[182:183], s[56:57], s[56:57]
    s_waitcnt vmcnt(4)
    v_mfma_f32_4x4x4_16b_bf16 v[144:147], v[190:191], v[64:65], 0 cbsz:4 abid:12
    v_rcp_f32 v176, v176
    v_mfma_f32_4x4x4_16b_bf16 v[148:151], v[190:191], v[66:67], 0 cbsz:4 abid:12
    v_rcp_f32 v177, v177
    v_mfma_f32_4x4x4_16b_bf16 v[152:155], v[190:191], v[68:69], 0 cbsz:4 abid:13
    v_rcp_f32 v178, v178
    v_mfma_f32_4x4x4_16b_bf16 v[156:159], v[190:191], v[70:71], 0 cbsz:4 abid:13
    v_rcp_f32 v179, v179
    v_mfma_f32_4x4x4_16b_bf16 v[160:163], v[190:191], v[72:73], 0 cbsz:4 abid:14
    v_rcp_f32 v180, v180
    v_mfma_f32_4x4x4_16b_bf16 v[164:167], v[190:191], v[74:75], 0 cbsz:4 abid:14
    v_rcp_f32 v181, v181
    v_mfma_f32_4x4x4_16b_bf16 v[168:171], v[190:191], v[76:77], 0 cbsz:4 abid:15
    v_rcp_f32 v182, v182
    v_mfma_f32_4x4x4_16b_bf16 v[172:175], v[190:191], v[78:79], 0 cbsz:4 abid:15
    v_rcp_f32 v183, v183
    v_readlane_b32 s68, v228, 16
    v_readlane_b32 s69, v228, 20
    v_readlane_b32 s70, v228, 24
    v_readlane_b32 s71, v228, 28
    v_pk_mul_f32 v[176:177], v[176:177], v[124:125]
    v_pk_mul_f32 v[178:179], v[178:179], v[126:127]
    v_pk_mul_f32 v[180:181], v[180:181], v[140:141]
    v_pk_mul_f32 v[182:183], v[182:183], v[142:143]
    s_set_gpr_idx_on s76, gpr_idx(SRC2,DST)
    v_pk_fma_f32 v[8:9], v[176:177], v[144:145], v[8:9] op_sel:[0,0,0] op_sel_hi:[0,1,1]
    v_pk_fma_f32 v[10:11], v[176:177], v[146:147], v[10:11] op_sel:[0,0,0] op_sel_hi:[0,1,1]
    v_pk_fma_f32 v[12:13], v[180:181], v[148:149], v[12:13] op_sel:[0,0,0] op_sel_hi:[0,1,1]
    v_pk_fma_f32 v[14:15], v[180:181], v[150:151], v[14:15] op_sel:[0,0,0] op_sel_hi:[0,1,1]
    s_set_gpr_idx_idx s77
    v_pk_fma_f32 v[8:9], v[176:177], v[152:153], v[8:9] op_sel:[1,0,0] op_sel_hi:[1,1,1]
    v_pk_fma_f32 v[10:11], v[176:177], v[154:155], v[10:11] op_sel:[1,0,0] op_sel_hi:[1,1,1]
    v_pk_fma_f32 v[12:13], v[180:181], v[156:157], v[12:13] op_sel:[1,0,0] op_sel_hi:[1,1,1]
    v_pk_fma_f32 v[14:15], v[180:181], v[158:159], v[14:15] op_sel:[1,0,0] op_sel_hi:[1,1,1]
    s_set_gpr_idx_idx s78
    v_pk_fma_f32 v[8:9], v[178:179], v[160:161], v[8:9] op_sel:[0,0,0] op_sel_hi:[0,1,1]
    v_pk_fma_f32 v[10:11], v[178:179], v[162:163], v[10:11] op_sel:[0,0,0] op_sel_hi:[0,1,1]
    v_pk_fma_f32 v[12:13], v[182:183], v[164:165], v[12:13] op_sel:[0,0,0] op_sel_hi:[0,1,1]
    v_pk_fma_f32 v[14:15], v[182:183], v[166:167], v[14:15] op_sel:[0,0,0] op_sel_hi:[0,1,1]
    s_set_gpr_idx_idx s79
    v_pk_fma_f32 v[8:9], v[178:179], v[168:169], v[8:9] op_sel:[1,0,0] op_sel_hi:[1,1,1]
    v_pk_fma_f32 v[10:11], v[178:179], v[170:171], v[10:11] op_sel:[1,0,0] op_sel_hi:[1,1,1]
    v_pk_fma_f32 v[12:13], v[182:183], v[172:173], v[12:13] op_sel:[1,0,0] op_sel_hi:[1,1,1]
    v_pk_fma_f32 v[14:15], v[182:183], v[174:175], v[14:15] op_sel:[1,0,0] op_sel_hi:[1,1,1]
    s_set_gpr_idx_off
    s_and_b32 s80, s68, s31
    s_and_b32 s81, s69, s31
    s_and_b32 s82, s70, s31
    s_and_b32 s83, s71, s31
    buffer_load_dwordx4 v[64:67], v232, s[4:7], s80 offen
    buffer_load_dwordx4 v[68:71], v232, s[4:7], s81 offen
    buffer_load_dwordx4 v[72:75], v232, s[4:7], s82 offen
    buffer_load_dwordx4 v[76:79], v232, s[4:7], s83 offen
    s_waitcnt lgkmcnt(0)
    v_add_u32 v231, 1024, v231
    s_sub_u32 s30, s30, 64
    s_branch L_sb
L_exit:
    s_setprio 0
    s_add_u32 s24, s24, 216
    s_cmp_lt_u32 s24, s25
    s_cbranch_scc0 L_epi
    v_lshlrev_b32 v7, 3, v0
    v_mov_b32 v2, 0
    v_mov_b32 v3, 0
    ds_write_b64 v7, v[2:3]
    s_waitcnt vmcnt(0) lgkmcnt(0)
    s_nop 15
    s_mul_i32 s26, s16, 5
    v_add_u32 v113, s26, v1
    v_subrev_u32 v3, 40, v113
    v_min_u32 v113, v113, v3
    v_mul_u32_u24 v3, 205, v1
    v_lshrrev_b32 v3, 10, v3
    v_mul_u32_u24 v2, 5, v3
    v_sub_u32 v115, v1, v2
    v_lshlrev_b32 v114, 2, v3
    s_lshl_b32 s81, s16, 10
    s_add_u32 s81, s81, 8192
    s_mul_i32 s80, s16, 6912
    v_lshl_add_u32 v121, v1, 2, s81
    v_lshrrev_b32 v3, 1, v1
    v_lshl_add_u32 v122, v3, 2, s81
    v_and_b32 v2, 1, v1
    v_lshlrev_b32 v123, 4, v2
    v_lshrrev_b32 v3, 1, v0
    v_mul_u32_u24 v3, 1280, v3
    v_add_u32 v124, v3, v2
    v_mul_u32_u24 v125, 48, v113
    s_lshl_b32 s26, s16, 2
    v_lshl_add_u32 v126, v115, 5, s26
    v_lshl_add_u32 v127, v1, 5, s80
    v_mov_b32 v80, 0xffffff
    v_mov_b32 v81, 0xffffff
    v_mov_b32 v82, 0xffffff
    v_mov_b32 v83, 0xffffff
    v_add_u32 v2, s81, v232
    ds_write_b128 v2, v[80:83]
    s_barrier
    v_and_b32 v2, 1, v0
    v_max_u32 v3, s24, v235
    v_add_u32 v3, v3, v2
    s_add_u32 s27, s24, 216
    v_min_u32 v4, s27, v236
    v_add_u32 v5, v237, v3
    s_lshl_b32 s27, s24, 2
    s_sub_u32 s27, s81, s27
    v_lshl_add_u32 v6, v3, 2, s27
    v_sub_u32 v4, v4, v3
    s_branch L_exp
L_exp_more:
    v_add_u32 v6, 48, v6
    v_subrev_u32 v4, 12, v4
    s_branch L_exp
L_epi:
    s_waitcnt lgkmcnt(0)
    v_readfirstlane_b32 s38, v243
    v_lshlrev_b32 v2, 2, v1
    v_add_u32 v3, s48, v2
    v_cvt_pk_bf16_f32 v8, v8, v12
    v_cvt_pk_bf16_f32 v9, v9, v13
    v_cvt_pk_bf16_f32 v10, v10, v14
    v_cvt_pk_bf16_f32 v11, v11, v15
    ds_write2_b32 v3, v8, v9 offset0:0 offset1:72
    ds_write2_b32 v3, v10, v11 offset0:144 offset1:216
    v_add_u32 v3, s49, v2
    v_cvt_pk_bf16_f32 v16, v16, v20
    v_cvt_pk_bf16_f32 v17, v17, v21
    v_cvt_pk_bf16_f32 v18, v18, v22
    v_cvt_pk_bf16_f32 v19, v19, v23
    ds_write2_b32 v3, v16, v17 offset0:0 offset1:72
    ds_write2_b32 v3, v18, v19 offset0:144 offset1:216
    v_add_u32 v3, s50, v2
    v_cvt_pk_bf16_f32 v24, v24, v28
    v_cvt_pk_bf16_f32 v25, v25, v29
    v_cvt_pk_bf16_f32 v26, v26, v30
    v_cvt_pk_bf16_f32 v27, v27, v31
    ds_write2_b32 v3, v24, v25 offset0:0 offset1:72
    ds_write2_b32 v3, v26, v27 offset0:144 offset1:216
    v_add_u32 v3, s51, v2
    v_cvt_pk_bf16_f32 v32, v32, v36
    v_cvt_pk_bf16_f32 v33, v33, v37
    v_cvt_pk_bf16_f32 v34, v34, v38
    v_cvt_pk_bf16_f32 v35, v35, v39
    ds_write2_b32 v3, v32, v33 offset0:0 offset1:72
    ds_write2_b32 v3, v34, v35 offset0:144 offset1:216
    v_add_u32 v3, s52, v2
    v_cvt_pk_bf16_f32 v40, v40, v44
    v_cvt_pk_bf16_f32 v41, v41, v45
    v_cvt_pk_bf16_f32 v42, v42, v46
    v_cvt_pk_bf16_f32 v43, v43, v47
    ds_write2_b32 v3, v40, v41 offset0:0 offset1:72
    ds_write2_b32 v3, v42, v43 offset0:144 offset1:216
    s_cmp_eq_u32 s38, 8
    s_cbranch_scc0 L_nob
    ds_read_b128 v[192:195], v240 offset:0
    ds_read_b128 v[208:211], v240 offset:256
    ds_read_b128 v[196:199], v240 offset:8192
    ds_read_b128 v[212:215], v240 offset:8448
    ds_read_b128 v[200:203], v240 offset:16384
    ds_read_b128 v[216:219], v240 offset:16640
    ds_read_b128 v[204:207], v240 offset:24576
    ds_read_b128 v[220:223], v240 offset:24832
    s_waitcnt lgkmcnt(8)
    s_barrier
    s_branch L_haveb
L_nob:
    s_waitcnt lgkmcnt(0)
    s_barrier
    ds_read_b128 v[192:195], v240 offset:0
    ds_read_b128 v[208:211], v240 offset:256
    ds_read_b128 v[196:199], v240 offset:8192
    ds_read_b128 v[212:215], v240 offset:8448
    ds_read_b128 v[200:203], v240 offset:16384
    ds_read_b128 v[216:219], v240 offset:16640
    ds_read_b128 v[204:207], v240 offset:24576
    ds_read_b128 v[220:223], v240 offset:24832
L_haveb:
    ds_read_b128 v[80:83], v241 offset:0
    ds_read_b128 v[84:87], v241 offset:64
    ds_read_b128 v[88:91], v241 offset:128
    ds_read_b128 v[92:95], v241 offset:192
    ds_read_b128 v[96:99], v241 offset:4608
    ds_read_b128 v[100:103], v241 offset:4672
    ds_read_b128 v[104:107], v241 offset:4736
    ds_read_b128 v[108:111], v241 offset:4800
    ds_read_b128 v[112:115], v241 offset:9216
    ds_read_b128 v[116:119], v241 offset:9280
    ds_read_b128 v[120:123], v241 offset:9344
    ds_read_b128 v[124:127], v241 offset:9408
    s_waitcnt lgkmcnt(11)
    v_mfma_f32_16x16x32_bf16 v[8:11], v[80:83], v[192:195], 0
    v_mfma_f32_16x16x32_bf16 v[12:15], v[80:83], v[208:211], 0
    ds_read_b128 v[128:131], v241 offset:13824
    ds_read_b128 v[132:135], v241 offset:13888
    ds_read_b128 v[136:139], v241 offset:13952
    ds_read_b128 v[140:143], v241 offset:14016
    s_waitcnt lgkmcnt(14)
    v_mfma_f32_16x16x32_bf16 v[8:11], v[84:87], v[196:199], v[8:11]
    v_mfma_f32_16x16x32_bf16 v[12:15], v[84:87], v[212:215], v[12:15]
    s_waitcnt lgkmcnt(13)
    v_mfma_f32_16x16x32_bf16 v[8:11], v[88:91], v[200:203], v[8:11]
    v_mfma_f32_16x16x32_bf16 v[12:15], v[88:91], v[216:219], v[12:15]
    s_waitcnt lgkmcnt(12)
    v_mfma_f32_16x16x32_bf16 v[8:11], v[92:95], v[204:207], v[8:11]
    v_mfma_f32_16x16x32_bf16 v[12:15], v[92:95], v[220:223], v[12:15]
    s_waitcnt lgkmcnt(11)
    v_mfma_f32_16x16x32_bf16 v[16:19], v[96:99], v[192:195], 0
    v_mfma_f32_16x16x32_bf16 v[20:23], v[96:99], v[208:211], 0
    ds_read_b128 v[144:147], v241 offset:18432
    ds_read_b128 v[148:151], v241 offset:18496
    ds_read_b128 v[152:155], v241 offset:18560
    ds_read_b128 v[156:159], v241 offset:18624
    s_waitcnt lgkmcnt(14)
    v_mfma_f32_16x16x32_bf16 v[16:19], v[100:103], v[196:199], v[16:19]
    v_mfma_f32_16x16x32_bf16 v[20:23], v[100:103], v[212:215], v[20:23]
    s_waitcnt lgkmcnt(13)
    v_mfma_f32_16x16x32_bf16 v[16:19], v[104:107], v[200:203], v[16:19]
    v_mfma_f32_16x16x32_bf16 v[20:23], v[104:107], v[216:219], v[20:23]
    v_cvt_pk_bf16_f32 v160, v8, v9
    v_cvt_pk_bf16_f32 v161, v10, v11
    v_cvt_pk_bf16_f32 v162, v12, v13
    v_cvt_pk_bf16_f32 v163, v14, v15
    buffer_store_dwordx4 v[160:163], v242, s[12:15], 0 offen sc1
    v_add_u32 v242, 1048576, v242
    s_waitcnt lgkmcnt(12)
    v_mfma_f32_16x16x32_bf16 v[16:19], v[108:111], v[204:207], v[16:19]
    v_mfma_f32_16x16x32_bf16 v[20:23], v[108:111], v[220:223], v[20:23]
    s_waitcnt lgkmcnt(11)
    v_mfma_f32_16x16x32_bf16 v[24:27], v[112:115], v[192:195], 0
    v_mfma_f32_16x16x32_bf16 v[28:31], v[112:115], v[208:211], 0
    s_waitcnt lgkmcnt(10)
    v_mfma_f32_16x16x32_bf16 v[24:27], v[116:119], v[196:199], v[24:27]
    v_mfma_f32_16x16x32_bf16 v[28:31], v[116:119], v[212:215], v[28:31]
    s_waitcnt lgkmcnt(9)
    v_mfma_f32_16x16x32_bf16 v[24:27], v[120:123], v[200:203], v[24:27]
    v_mfma_f32_16x16x32_bf16 v[28:31], v[120:123], v[216:219], v[28:31]
    v_cvt_pk_bf16_f32 v164, v16, v17
    v_cvt_pk_bf16_f32 v165, v18, v19
    v_cvt_pk_bf16_f32 v166, v20, v21
    v_cvt_pk_bf16_f32 v167, v22, v23
    buffer_store_dwordx4 v[164:167], v242, s[12:15], 0 offen sc1
    v_add_u32 v242, 1048576, v242
    s_waitcnt lgkmcnt(8)
    v_mfma_f32_16x16x32_bf16 v[24:27], v[124:127], v[204:207], v[24:27]
    v_mfma_f32_16x16x32_bf16 v[28:31], v[124:127], v[220:223], v[28:31]
    s_waitcnt lgkmcnt(7)
    v_mfma_f32_16x16x32_bf16 v[32:35], v[128:131], v[192:195], 0
    v_mfma_f32_16x16x32_bf16 v[36:39], v[128:131], v[208:211], 0
    s_waitcnt lgkmcnt(6)
    v_mfma_f32_16x16x32_bf16 v[32:35], v[132:135], v[196:199], v[32:35]
    v_mfma_f32_16x16x32_bf16 v[36:39], v[132:135], v[212:215], v[36:39]
    s_waitcnt lgkmcnt(5)
    v_mfma_f32_16x16x32_bf16 v[32:35], v[136:139], v[200:203], v[32:35]
    v_mfma_f32_16x16x32_bf16 v[36:39], v[136:139], v[216:219], v[36:39]
    v_cvt_pk_bf16_f32 v168, v24, v25
    v_cvt_pk_bf16_f32 v169, v26, v27
    v_cvt_pk_bf16_f32 v170, v28, v29
    v_cvt_pk_bf16_f32 v171, v30, v31
    buffer_store_dwordx4 v[168:171], v242, s[12:15], 0 offen sc1
    v_add_u32 v242, 1048576, v242
    s_waitcnt lgkmcnt(4)
    v_mfma_f32_16x16x32_bf16 v[32:35], v[140:143], v[204:207], v[32:35]
    v_mfma_f32_16x16x32_bf16 v[36:39], v[140:143], v[220:223], v[36:39]
    s_waitcnt lgkmcnt(3)
    v_mfma_f32_16x16x32_bf16 v[40:43], v[144:147], v[192:195], 0
    v_mfma_f32_16x16x32_bf16 v[44:47], v[144:147], v[208:211], 0
    s_waitcnt lgkmcnt(2)
    v_mfma_f32_16x16x32_bf16 v[40:43], v[148:151], v[196:199], v[40:43]
    v_mfma_f32_16x16x32_bf16 v[44:47], v[148:151], v[212:215], v[44:47]
    s_waitcnt lgkmcnt(1)
    v_mfma_f32_16x16x32_bf16 v[40:43], v[152:155], v[200:203], v[40:43]
    v_mfma_f32_16x16x32_bf16 v[44:47], v[152:155], v[216:219], v[44:47]
    v_cvt_pk_bf16_f32 v172, v32, v33
    v_cvt_pk_bf16_f32 v173, v34, v35
    v_cvt_pk_bf16_f32 v174, v36, v37
    v_cvt_pk_bf16_f32 v175, v38, v39
    buffer_store_dwordx4 v[172:175], v242, s[12:15], 0 offen sc1
    v_add_u32 v242, 1048576, v242
    s_waitcnt lgkmcnt(0)
    v_mfma_f32_16x16x32_bf16 v[40:43], v[156:159], v[204:207], v[40:43]
    v_mfma_f32_16x16x32_bf16 v[44:47], v[156:159], v[220:223], v[44:47]
    s_nop 7
    v_cvt_pk_bf16_f32 v160, v40, v41
    v_cvt_pk_bf16_f32 v161, v42, v43
    v_cvt_pk_bf16_f32 v162, v44, v45
    v_cvt_pk_bf16_f32 v163, v46, v47
    buffer_store_dwordx4 v[160:163], v242, s[12:15], 0 offen sc1
    s_cmp_eq_u32 s53, 0
    s_cbranch_scc0 L_fin
    v_mov_b32 v144, 0
    v_mov_b32 v145, 1
    s_mov_b64 exec, 1
    buffer_store_dword v145, v144, s[44:47], 0 offen sc1
    s_mov_b64 exec, -1
L_fin:
L_end:
    s_endpgm
.section .rodata,"a"
.p2align 6
.amdhsa_kernel standalone__tensor_product_equiv_tfn__graph_kernel
.amdhsa_next_free_vgpr 245
.amdhsa_next_free_sgpr 100
.amdhsa_accum_offset 248
.amdhsa_group_segment_fixed_size 0
.amdhsa_kernarg_size 88
.amdhsa_user_sgpr_count 2
.amdhsa_user_sgpr_kernarg_segment_ptr 1
.amdhsa_system_sgpr_workgroup_id_x 1
.amdhsa_float_denorm_mode_32 3
.end_amdhsa_kernel
```

```asm
; @launch grid=(256,1,1) block=(512,1,1) lds=161808
.amdgcn_target "amdgcn-amd-amdhsa--gfx950"
.text
.globl standalone__tensor_product_equiv_tfn__graph_kernel
.p2align 8
.type standalone__tensor_product_equiv_tfn__graph_kernel,@function
standalone__tensor_product_equiv_tfn__graph_kernel:
    s_cmp_ge_u32 s2, 256
    s_cbranch_scc1 L_end
    s_load_dwordx16 s[36:51], s[0:1], 0
    s_load_dwordx4 s[52:55], s[0:1], 64
    s_load_dwordx2 s[56:57], s[0:1], 80
    v_lshrrev_b32 v2, 6, v0
    v_and_b32 v1, 63, v0
    v_readfirstlane_b32 s16, v2
    s_and_b32 s17, s2, 7
    s_lshl_b32 s17, s17, 5
    s_lshr_b32 s26, s2, 3
    s_or_b32 s17, s17, s26
    v_lshlrev_b32 v7, 3, v0
    v_mov_b32 v2, 0
    v_mov_b32 v3, 0
    v_mov_b32 v4, 161792
    ds_write_b64 v7, v[2:3]
    ds_write_b32 v4, v2
    v_lshlrev_b32 v232, 4, v1
    s_mul_i32 s26, s16, 160
    v_add_u32 v6, s26, v1
    v_lshlrev_b32 v53, 2, v6
    v_lshlrev_b32 v54, 3, v6
    s_mul_i32 s26, s16, 1920
    v_add_u32 v55, s26, v232
    s_mul_i32 s26, s16, 5120
    v_add_u32 v56, s26, v232
    s_cmp_lt_u32 s16, 7
    s_cselect_b32 s60, -1, 3
    s_mov_b32 s61, 0
    s_cselect_b64 s[62:63], -1, 15
    s_cselect_b32 s34, -1, 0xff
    s_cselect_b32 s35, 0xffffff, s34
    s_mul_i32 s58, s17, 5000
    s_mul_i32 s59, s17, 10000
    s_lshl_b32 s29, s17, 6
    s_add_u32 s29, s29, 14417920
    s_waitcnt lgkmcnt(0)
    s_mov_b32 s64, s40
    s_mov_b32 s65, s41
    s_mov_b32 s66, 1280000
    s_mov_b32 s67, 0x00020000
    buffer_load_dword v144, v53, s[64:67], s58 offen offset:0
    buffer_load_dword v145, v53, s[64:67], s58 offen offset:256
    s_mov_b64 exec, s[60:61]
    buffer_load_dword v146, v53, s[64:67], s58 offen offset:512
    s_mov_b64 exec, -1
    s_getpc_b64 s[82:83]
L_pc:
    s_lshr_b32 s80, s2, 3
    s_lshl_b32 s80, s80, 3
    s_add_u32 s80, s80, s16
    s_lshl_b32 s81, s80, 6
    s_min_u32 s81, s81, L_end-L_pc
    s_load_dword s3, s[82:83], s81
    s_lshl_b32 s81, s80, 7
    s_load_dword s3, s[50:51], s81
    s_add_u32 s81, s81, 64
    s_load_dword s3, s[50:51], s81
    s_mov_b32 s68, s38
    s_mov_b32 s69, s39
    s_mov_b32 s70, 1280000
    s_mov_b32 s71, 0x00020000
    buffer_load_dword v147, v53, s[68:71], s58 offen offset:0
    buffer_load_dword v148, v53, s[68:71], s58 offen offset:256
    s_mov_b64 exec, s[60:61]
    buffer_load_dword v149, v53, s[68:71], s58 offen offset:512
    s_mov_b64 exec, -1
    s_mov_b32 s72, s42
    s_mov_b32 s73, s43
    s_mov_b32 s74, 2560000
    s_mov_b32 s75, 0x00020000
    buffer_load_dwordx2 v[152:153], v54, s[72:75], s59 offen offset:0
    buffer_load_dwordx2 v[156:157], v54, s[72:75], s59 offen offset:512
    s_mov_b64 exec, s[60:61]
    buffer_load_dwordx2 v[160:161], v54, s[72:75], s59 offen offset:1024
    s_mov_b64 exec, -1
    s_mov_b32 s8, s56
    s_mov_b32 s9, s57
    s_mov_b32 s10, 16777216
    s_mov_b32 s11, 0x00020000
    s_mov_b32 s76, s44
    s_mov_b32 s77, s45
    s_mov_b32 s78, 10240000
    s_mov_b32 s79, 0x00020000
    s_barrier
    s_add_u32 m0, s26, 61440
    s_mul_i32 s58, s17, 40000
    buffer_load_dwordx4 v56, s[76:79], s58 offen offset:0  lds
    buffer_load_dwordx4 v56, s[76:79], s58 offen offset:1024  lds
    buffer_load_dwordx4 v56, s[76:79], s58 offen offset:2048  lds
    buffer_load_dwordx4 v56, s[76:79], s58 offen offset:3072  lds
    s_add_u32 m0, s26, 65536
    s_add_u32 s58, s58, 4096
    s_mov_b64 exec, s[62:63]
    buffer_load_dwordx4 v56, s[76:79], s58 offen  lds
    s_mov_b64 exec, -1
    v_mov_b32 v6, 1
    v_lshrrev_b32 v7, 2, v1
    v_mul_u32_u24 v7, 16320, v7
    v_add_u32 v72, v7, v232
    s_cmp_eq_u32 s16, 7
    s_cselect_b32 s59, s29, 0x40000000
    v_add_u32 v7, s59, v72
    buffer_load_dwordx4 v[64:67], v7, s[8:11], 0 offen sc1
    s_waitcnt vmcnt(12)
    v_bfe_u32 v2, v144, 3, 5
    v_and_b32 v3, 7, v144
    v_lshl_or_b32 v2, v3, 5, v2
    v_lshlrev_b32 v167, 2, v2
    ds_add_rtn_u32 v164, v167, v6 offset:3072
    v_bfe_u32 v2, v145, 3, 5
    v_and_b32 v3, 7, v145
    v_lshl_or_b32 v2, v3, 5, v2
    v_lshlrev_b32 v168, 2, v2
    ds_add_rtn_u32 v165, v168, v6 offset:3072
    s_mov_b64 exec, s[60:61]
    v_bfe_u32 v2, v146, 3, 5
    v_and_b32 v3, 7, v146
    v_lshl_or_b32 v2, v3, 5, v2
    v_lshlrev_b32 v169, 2, v2
    ds_add_rtn_u32 v166, v169, v6 offset:3072
    s_mov_b64 exec, -1
    s_movk_i32 s27, 5033
    s_waitcnt vmcnt(9)
    s_movk_i32 s59, -1250
    v_lshrrev_b32 v3, 7, v167
    v_mad_i32_i24 v2, v3, s59, v147
    v_add_u32 v3, 10000, v2
    v_min_u32 v2, v2, v3
    v_mul_u32_u24 v2, s27, v2
    v_lshrrev_b32 v2, 22, v2
    v_lshrrev_b32 v3, 8, v144
    v_mad_u32_u24 v2, v3, 12, v2
    v_lshl_or_b32 v154, v147, 10, v2
    v_lshrrev_b32 v3, 7, v168
    v_mad_i32_i24 v2, v3, s59, v148
    v_add_u32 v3, 10000, v2
    v_min_u32 v2, v2, v3
    v_mul_u32_u24 v2, s27, v2
    v_lshrrev_b32 v2, 22, v2
    v_lshrrev_b32 v3, 8, v145
    v_mad_u32_u24 v2, v3, 12, v2
    v_lshl_or_b32 v158, v148, 10, v2
    v_lshrrev_b32 v3, 7, v169
    v_mad_i32_i24 v2, v3, s59, v149
    v_add_u32 v3, 10000, v2
    v_min_u32 v2, v2, v3
    v_mul_u32_u24 v2, s27, v2
    v_lshrrev_b32 v2, 22, v2
    v_lshrrev_b32 v3, 8, v146
    v_mad_u32_u24 v2, v3, 12, v2
    v_lshl_or_b32 v162, v149, 10, v2
    s_waitcnt lgkmcnt(0)
    s_barrier
    ds_read_b128 v[172:175], v232 offset:3072
    s_waitcnt lgkmcnt(0)
    v_add_u32 v50, v172, v173
    v_add_u32 v51, v50, v174
    v_add_u32 v2, v51, v175
    v_mov_b32 v3, v2
    v_lshlrev_b32 v4, 2, v54
    v_lshrrev_b32 v5, 1, v0
    v_add_u32_dpp v3, v3, v3 row_shr:1 row_mask:0xf bank_mask:0xf
    s_lshr_b32 s59, s17, 4
    s_mul_i32 s59, s59, 16320
    v_add_u32_dpp v3, v3, v3 row_shr:2 row_mask:0xf bank_mask:0xf
    s_lshl2_add_u32 s59, s17, s59
    s_add_u32 s59, s59, 14417920
    v_add_u32_dpp v3, v3, v3 row_shr:4 row_mask:0xf bank_mask:0xf
    v_lshl_add_u32 v58, v5, 6, s59
    s_nop 0
    v_add_u32_dpp v3, v3, v3 row_shr:8 row_mask:0xf bank_mask:0xf
    s_nop 1
    v_add_u32_dpp v3, v3, v3 row_bcast:15 row_mask:0xa bank_mask:0xf
    s_nop 1
    v_add_u32_dpp v3, v3, v3 row_bcast:31 row_mask:0xc bank_mask:0xf
    v_sub_u32 v48, v3, v2
    v_add_u32 v49, v48, v172
    v_add_u32 v50, v48, v50
    v_add_u32 v51, v48, v51
    ds_write_b128 v232, v[48:51] offset:10752
    ds_read_b32 v167, v167 offset:10752
    ds_read_b32 v168, v168 offset:10752
    s_mov_b64 exec, s[60:61]
    ds_read_b32 v169, v169 offset:10752
    s_mov_b64 exec, -1
    v_lshl_or_b32 v60, v172, 16, v48
    v_lshl_or_b32 v61, v173, 16, v49
    v_lshl_or_b32 v62, v174, 16, v50
    v_lshl_or_b32 v63, v175, 16, v51
    s_mov_b32 s27, 46080
    s_waitcnt vmcnt(6) lgkmcnt(0)
    v_add_lshl_u32 v2, v167, v164, 1
    v_add_u32 v3, 0, v4
    ds_write_b16 v2, v3 offset:8192
    v_mad_u32_u24 v2, v2, 6, s27
    ds_write2_b32 v2, v152, v153 offset0:0 offset1:1
    ds_write_b32 v2, v154 offset:8
    v_add_lshl_u32 v2, v168, v165, 1
    v_add_u32 v3, 2048, v4
    ds_write_b16 v2, v3 offset:8192
    v_mad_u32_u24 v2, v2, 6, s27
    ds_write2_b32 v2, v156, v157 offset0:0 offset1:1
    ds_write_b32 v2, v158 offset:8
    s_mov_b64 exec, s[60:61]
    v_add_lshl_u32 v2, v169, v166, 1
    v_add_u32 v3, 4096, v4
    ds_write_b16 v2, v3 offset:8192
    v_mad_u32_u24 v2, v2, 6, s27
    ds_write2_b32 v2, v160, v161 offset0:0 offset1:1
    ds_write_b32 v2, v162 offset:8
    s_mov_b64 exec, -1
    v_lshrrev_b32 v2, 4, v56
    v_and_b32 v2, 0xffe, v2
    v_and_b32 v5, 1, v1
    v_lshlrev_b32 v5, 4, v5
    s_waitcnt lgkmcnt(0)
    s_barrier
    buffer_load_dword v59, v58, s[8:11], 0 offen sc1
    s_mov_b32 s68, s46
    s_mov_b32 s69, s47
    s_mov_b32 s70, 4096
    s_mov_b32 s71, 0x00020000
    s_mov_b32 s64, s48
    s_mov_b32 s65, s49
    s_mov_b32 s66, 128
    s_mov_b32 s67, 0x00020000
    v_lshlrev_b32 v7, 1, v1
    s_lshl_b32 s58, s16, 9
    s_add_u32 m0, s58, 16384
    s_mov_b32 exec_hi, 0
    buffer_load_dwordx4 v232, s[68:71], s58 offen lds
    s_mov_b32 exec_hi, -1
    buffer_load_ushort v57, v7, s[64:67], 0 offen
    ds_read_b128 v[152:155], v55 offset:46080
    ds_read_b128 v[156:159], v55 offset:47104
    ds_read_u16 v164, v2 offset:8192
    ds_read_u16 v165, v2 offset:8256
    ds_read_u16 v166, v2 offset:8320
    ds_read_u16 v167, v2 offset:8384
    ds_read_u16 v168, v2 offset:8448
    s_mov_b32 s4, s36
    s_mov_b32 s5, s37
    s_mov_b32 s6, 10240000
    s_mov_b32 s7, 0x00020000
    s_mov_b32 s12, s52
    s_mov_b32 s13, s53
    s_mov_b32 s14, 10240000
    s_mov_b32 s15, 0x00020000
    s_mov_b32 s20, 0x0f0f0f0f
    s_mov_b32 s21, 0x0f0f0f0f
    s_mov_b32 s22, 0xf0f0f0f0
    s_mov_b32 s23, 0xf0f0f0f0
    s_mov_b32 s31, 0xfffffc00
    s_mov_b32 s32, 0x9c4028
    s_mov_b32 s33, 0xffe0
    s_mov_b32 s24, 0
    s_mov_b32 s25, 0
    v_mov_b32 v8, 0
    v_mov_b32 v9, 0
    v_mov_b32 v10, 0
    v_mov_b32 v11, 0
    v_mov_b32 v12, 0
    v_mov_b32 v13, 0
    v_mov_b32 v14, 0
    v_mov_b32 v15, 0
    v_mov_b32 v16, 0
    v_mov_b32 v17, 0
    v_mov_b32 v18, 0
    v_mov_b32 v19, 0
    v_mov_b32 v20, 0
    v_mov_b32 v21, 0
    v_mov_b32 v22, 0
    v_mov_b32 v23, 0
    v_mov_b32 v24, 0
    v_mov_b32 v25, 0
    v_mov_b32 v26, 0
    v_mov_b32 v27, 0
    v_mov_b32 v28, 0
    v_mov_b32 v29, 0
    v_mov_b32 v30, 0
    v_mov_b32 v31, 0
    v_mov_b32 v32, 0
    v_mov_b32 v33, 0
    v_mov_b32 v34, 0
    v_mov_b32 v35, 0
    v_mov_b32 v36, 0
    v_mov_b32 v37, 0
    v_mov_b32 v38, 0
    v_mov_b32 v39, 0
    v_mov_b32 v40, 0
    v_mov_b32 v41, 0
    v_mov_b32 v42, 0
    v_mov_b32 v43, 0
    v_mov_b32 v44, 0
    v_mov_b32 v45, 0
    v_mov_b32 v46, 0
    v_mov_b32 v47, 0
    v_mov_b32 v192, 0
    v_mov_b32 v193, 0
    v_mov_b32 v194, 0
    v_mov_b32 v195, 0
    v_mov_b32 v196, 0
    v_mov_b32 v197, 0
    v_mov_b32 v198, 0
    v_mov_b32 v199, 0
    v_mov_b32 v112, 0
    v_mov_b32 v238, 0
    s_cmp_lt_u32 s2, 16
    s_cbranch_scc1 L_map40
    v_writelane_b32 v112, 0, 0
    v_writelane_b32 v112, 5, 1
    v_writelane_b32 v112, 6, 2
    v_writelane_b32 v112, 3, 3
    v_writelane_b32 v112, 8, 4
    v_writelane_b32 v112, 7, 5
    v_writelane_b32 v112, 2, 6
    v_writelane_b32 v112, 4, 7
    v_writelane_b32 v112, 1, 8
    v_writelane_b32 v112, 16, 9
    v_writelane_b32 v112, 10, 10
    v_writelane_b32 v112, 15, 11
    v_writelane_b32 v112, 9, 12
    v_writelane_b32 v112, 24, 13
    v_writelane_b32 v112, 14, 14
    v_writelane_b32 v112, 11, 15
    v_writelane_b32 v112, 13, 16
    v_writelane_b32 v112, 12, 17
    v_writelane_b32 v112, 17, 18
    v_writelane_b32 v112, 23, 19
    v_writelane_b32 v112, 20, 20
    v_writelane_b32 v112, 22, 21
    v_writelane_b32 v112, 19, 22
    v_writelane_b32 v112, 18, 23
    v_writelane_b32 v112, 21, 24
    v_writelane_b32 v112, 28, 25
    v_writelane_b32 v112, 29, 26
    v_writelane_b32 v112, 31, 27
    v_writelane_b32 v112, 26, 28
    v_writelane_b32 v112, 25, 29
    v_writelane_b32 v112, 27, 30
    v_writelane_b32 v112, 30, 31
    v_writelane_b32 v112, 36, 32
    v_writelane_b32 v112, 33, 33
    v_writelane_b32 v112, 35, 34
    v_writelane_b32 v112, 34, 35
    v_writelane_b32 v112, 38, 36
    v_writelane_b32 v112, 39, 37
    v_writelane_b32 v112, 37, 38
    v_writelane_b32 v112, 32, 39
    s_branch L_mapd
L_map40:
    v_writelane_b32 v112, 7, 0
    v_writelane_b32 v112, 0, 1
    v_writelane_b32 v112, 5, 2
    v_writelane_b32 v112, 2, 3
    v_writelane_b32 v112, 4, 4
    v_writelane_b32 v112, 3, 5
    v_writelane_b32 v112, 1, 6
    v_writelane_b32 v112, 6, 7
    v_writelane_b32 v112, 12, 8
    v_writelane_b32 v112, 9, 9
    v_writelane_b32 v112, 14, 10
    v_writelane_b32 v112, 11, 11
    v_writelane_b32 v112, 15, 12
    v_writelane_b32 v112, 10, 13
    v_writelane_b32 v112, 8, 14
    v_writelane_b32 v112, 13, 15
    v_writelane_b32 v112, 21, 16
    v_writelane_b32 v112, 22, 17
    v_writelane_b32 v112, 19, 18
    v_writelane_b32 v112, 16, 19
    v_writelane_b32 v112, 23, 20
    v_writelane_b32 v112, 17, 21
    v_writelane_b32 v112, 18, 22
    v_writelane_b32 v112, 20, 23
    v_writelane_b32 v112, 26, 24
    v_writelane_b32 v112, 29, 25
    v_writelane_b32 v112, 27, 26
    v_writelane_b32 v112, 25, 27
    v_writelane_b32 v112, 28, 28
    v_writelane_b32 v112, 30, 29
    v_writelane_b32 v112, 24, 30
    v_writelane_b32 v112, 31, 31
    v_writelane_b32 v112, 38, 32
    v_writelane_b32 v112, 33, 33
    v_writelane_b32 v112, 36, 34
    v_writelane_b32 v112, 35, 35
    v_writelane_b32 v112, 34, 36
    v_writelane_b32 v112, 32, 37
    v_writelane_b32 v112, 37, 38
    v_writelane_b32 v112, 39, 39
L_mapd:
    v_and_b32 v2, 3, v1
    v_lshrrev_b32 v3, 2, v1
    v_lshl_add_u32 v234, v2, 4, v3
    v_lshrrev_b32 v2, 5, v1
    v_lshlrev_b32 v233, 4, v2
    s_mul_i32 s26, s16, 5
    v_add_u32 v113, s26, v1
    v_subrev_u32 v3, 40, v113
    v_min_u32 v113, v113, v3
    v_mul_u32_u24 v3, 205, v1
    v_lshrrev_b32 v3, 10, v3
    v_mul_u32_u24 v2, 5, v3
    v_sub_u32 v115, v1, v2
    v_lshlrev_b32 v114, 2, v3
    s_lshl_b32 s81, s16, 10
    s_add_u32 s81, s81, 8192
    s_mul_i32 s80, s16, 6912
    v_lshl_add_u32 v121, v1, 2, s81
    v_lshrrev_b32 v3, 1, v1
    v_lshl_add_u32 v122, v3, 2, s81
    v_and_b32 v2, 1, v1
    v_lshlrev_b32 v123, 4, v2
    v_lshrrev_b32 v3, 1, v0
    v_mul_u32_u24 v3, 1280, v3
    v_add_u32 v124, v3, v2
    v_mul_u32_u24 v125, 48, v113
    s_lshl_b32 s26, s16, 2
    v_lshl_add_u32 v126, v115, 5, s26
    v_lshl_add_u32 v127, v1, 5, s80
    s_lshr_b32 s26, s2, 6
    s_mul_i32 s26, s26, 65
    s_sub_u32 s26, s2, s26
    s_lshl3_add_u32 s26, s26, s16
    s_cmp_eq_u32 s26, 7
    s_cselect_b32 s82, 0, 1
    s_and_b32 s26, s16, 3
    s_lshl_b32 s58, s26, 9
    s_add_u32 s58, s58, 129024
    v_lshrrev_b32 v3, 4, v1
    v_mul_u32_u24 v2, 1792, v3
    v_add3_u32 v240, v2, s58, v232
    s_lshr_b32 s58, s16, 2
    v_and_b32 v2, 15, v1
    v_mul_u32_u24 v241, 288, v2
    v_lshl_add_u32 v241, v3, 4, v241
    s_mul_i32 s59, s58, 23040
    v_add_u32 v241, s59, v241
    v_lshlrev_b32 v242, 18, v3
    v_lshl_add_u32 v242, v2, 4, v242
    s_mul_i32 s58, s58, 5242880
    s_lshl_b32 s59, s2, 10
    s_add_u32 s58, s58, s59
    s_lshl_b32 s59, s26, 8
    s_add_u32 s58, s58, s59
    v_add_u32 v242, s58, v242
    v_mov_b32 v244, 161792
    s_mov_b32 s72, s50
    s_mov_b32 s73, s51
    s_mov_b32 s74, 32768
    s_mov_b32 s75, 0x00020000
    s_mov_b32 s44, s54
    s_mov_b32 s45, s55
    s_mov_b32 s46, 256
    s_mov_b32 s47, 0x00020000
    s_waitcnt lgkmcnt(0)
    v_or_b32 v164, v164, v5
    v_or_b32 v165, v165, v5
    v_or_b32 v166, v166, v5
    v_or_b32 v167, v167, v5
    v_or_b32 v168, v168, v5
    s_mul_i32 s27, s17, 15360
    s_add_u32 s27, s27, 10485760
    s_mul_i32 s58, s17, 40960
    s_add_u32 s59, s58, 4096
    s_waitcnt vmcnt(4)
    s_barrier
    ds_read_b128 v[80:83], v164 offset:61440
    ds_read_b128 v[84:87], v165 offset:61440
    ds_read_b128 v[88:91], v166 offset:61440
    ds_read_b128 v[92:95], v167 offset:61440
    s_mov_b64 exec, s[62:63]
    ds_read_b128 v[96:99], v168 offset:61440
    s_mov_b64 exec, -1
    s_waitcnt vmcnt(2)
    buffer_store_dwordx4 v[152:155], v55, s[8:11], s27 offen sc1
    s_mov_b32 exec_hi, s35
    buffer_store_dwordx4 v[156:159], v55, s[8:11], s27 offen offset:1024 sc1
    s_mov_b32 exec_hi, -1
    s_waitcnt lgkmcnt(4)
    buffer_store_dwordx4 v[80:83], v56, s[8:11], s58 offen offset:0 sc1
    s_waitcnt lgkmcnt(3)
    buffer_store_dwordx4 v[84:87], v56, s[8:11], s58 offen offset:1024 sc1
    s_waitcnt lgkmcnt(2)
    buffer_store_dwordx4 v[88:91], v56, s[8:11], s58 offen offset:2048 sc1
    s_waitcnt lgkmcnt(1)
    buffer_store_dwordx4 v[92:95], v56, s[8:11], s58 offen offset:3072 sc1
    s_mov_b32 exec_lo, s34
    s_mov_b32 exec_hi, s63
    s_waitcnt lgkmcnt(0)
    buffer_store_dwordx4 v[96:99], v56, s[8:11], s59 offen offset:0 sc1
    s_mov_b64 exec, -1
    s_mov_b32 s30, 400000
    s_mov_b32 s53, 0
    s_brev_b32 s59, 1
    s_waitcnt vmcnt(7)
    v_not_b32 v64, v64
    v_and_or_b32 v60, v64, s59, v60
    v_not_b32 v65, v65
    v_and_or_b32 v61, v65, s59, v61
    v_not_b32 v66, v66
    v_and_or_b32 v62, v66, s59, v62
    v_not_b32 v67, v67
    v_and_or_b32 v63, v67, s59, v63
    v_and_b32 v2, 0x30, v1
    v_and_b32 v3, 3, v1
    v_lshl_add_u32 v2, v3, 2, v2
    v_bfe_u32 v7, v1, 2, 2
    v_add_lshl_u32 v2, v2, v7, 1
    ds_write_b16 v2, v57 offset:6656
    v_lshlrev_b32 v3, 3, v3
    ds_read_b64 v[216:217], v3 offset:6656
    ds_read_b64 v[218:219], v3 offset:6688
    ds_read_b64 v[220:221], v3 offset:6720
    ds_read_b64 v[222:223], v3 offset:6752
    s_lshl_b32 s58, s16, 12
    s_add_u32 m0, s58, 129024
    s_cmp_eq_u32 s16, 7
    s_waitcnt vmcnt(0) lgkmcnt(0)
    s_barrier
    s_cbranch_scc0 L_nrow2
    buffer_store_dwordx4 v[60:63], v72, s[8:11], s29 offen sc1
L_nrow2:
    s_barrier
    buffer_load_dwordx4 v232, s[72:75], s58 offen offset:0 lds
    buffer_load_dwordx4 v232, s[72:75], s58 offen offset:1024 lds
    buffer_load_dwordx4 v232, s[72:75], s58 offen offset:2048 lds
    buffer_load_dwordx4 v232, s[72:75], s58 offen offset:3072 lds
    v_and_b32 v3, 31, v1
    v_lshlrev_b32 v2, 7, v233
    v_lshl_add_u32 v2, v3, 2, v2
    v_add_u32 v3, 128, v2
    ds_read2st64_b32 v[144:145], v2 offset0:64 offset1:65
    ds_read2st64_b32 v[146:147], v2 offset0:66 offset1:67
    ds_read2st64_b32 v[148:149], v2 offset0:68 offset1:69
    ds_read2st64_b32 v[150:151], v2 offset0:70 offset1:71
    ds_read2st64_b32 v[152:153], v3 offset0:64 offset1:65
    ds_read2st64_b32 v[154:155], v3 offset0:66 offset1:67
    ds_read2st64_b32 v[156:157], v3 offset0:68 offset1:69
    ds_read2st64_b32 v[158:159], v3 offset0:70 offset1:71
    s_mov_b32 s56, 0xbfb8aa3b
    s_mov_b32 s57, 0xbfb8aa3b
    s_waitcnt lgkmcnt(7)
    v_lshlrev_b32 v160, 16, v144
    v_lshlrev_b32 v161, 16, v145
    v_and_b32 v162, 0xffff0000, v144
    v_and_b32 v163, 0xffff0000, v145
    v_pk_mul_f32 v[160:161], v[160:161], s[56:57]
    v_pk_mul_f32 v[162:163], v[162:163], s[56:57]
    v_cvt_pk_bf16_f32 v200, v160, v161
    v_cvt_pk_bf16_f32 v204, v162, v163
    s_waitcnt lgkmcnt(6)
    v_lshlrev_b32 v160, 16, v146
    v_lshlrev_b32 v161, 16, v147
    v_and_b32 v162, 0xffff0000, v146
    v_and_b32 v163, 0xffff0000, v147
    v_pk_mul_f32 v[160:161], v[160:161], s[56:57]
    v_pk_mul_f32 v[162:163], v[162:163], s[56:57]
    v_cvt_pk_bf16_f32 v201, v160, v161
    v_cvt_pk_bf16_f32 v205, v162, v163
    s_waitcnt lgkmcnt(5)
    v_lshlrev_b32 v160, 16, v148
    v_lshlrev_b32 v161, 16, v149
    v_and_b32 v162, 0xffff0000, v148
    v_and_b32 v163, 0xffff0000, v149
    v_pk_mul_f32 v[160:161], v[160:161], s[56:57]
    v_pk_mul_f32 v[162:163], v[162:163], s[56:57]
    v_cvt_pk_bf16_f32 v202, v160, v161
    v_cvt_pk_bf16_f32 v206, v162, v163
    s_waitcnt lgkmcnt(4)
    v_lshlrev_b32 v160, 16, v150
    v_lshlrev_b32 v161, 16, v151
    v_and_b32 v162, 0xffff0000, v150
    v_and_b32 v163, 0xffff0000, v151
    v_pk_mul_f32 v[160:161], v[160:161], s[56:57]
    v_pk_mul_f32 v[162:163], v[162:163], s[56:57]
    v_cvt_pk_bf16_f32 v203, v160, v161
    v_cvt_pk_bf16_f32 v207, v162, v163
    s_waitcnt lgkmcnt(3)
    v_lshlrev_b32 v160, 16, v152
    v_lshlrev_b32 v161, 16, v153
    v_and_b32 v162, 0xffff0000, v152
    v_and_b32 v163, 0xffff0000, v153
    v_pk_mul_f32 v[160:161], v[160:161], s[56:57]
    v_pk_mul_f32 v[162:163], v[162:163], s[56:57]
    v_cvt_pk_bf16_f32 v208, v160, v161
    v_cvt_pk_bf16_f32 v212, v162, v163
    s_waitcnt lgkmcnt(2)
    v_lshlrev_b32 v160, 16, v154
    v_lshlrev_b32 v161, 16, v155
    v_and_b32 v162, 0xffff0000, v154
    v_and_b32 v163, 0xffff0000, v155
    v_pk_mul_f32 v[160:161], v[160:161], s[56:57]
    v_pk_mul_f32 v[162:163], v[162:163], s[56:57]
    v_cvt_pk_bf16_f32 v209, v160, v161
    v_cvt_pk_bf16_f32 v213, v162, v163
    s_waitcnt lgkmcnt(1)
    v_lshlrev_b32 v160, 16, v156
    v_lshlrev_b32 v161, 16, v157
    v_and_b32 v162, 0xffff0000, v156
    v_and_b32 v163, 0xffff0000, v157
    v_pk_mul_f32 v[160:161], v[160:161], s[56:57]
    v_pk_mul_f32 v[162:163], v[162:163], s[56:57]
    v_cvt_pk_bf16_f32 v210, v160, v161
    v_cvt_pk_bf16_f32 v214, v162, v163
    s_waitcnt lgkmcnt(0)
    v_lshlrev_b32 v160, 16, v158
    v_lshlrev_b32 v161, 16, v159
    v_and_b32 v162, 0xffff0000, v158
    v_and_b32 v163, 0xffff0000, v159
    v_pk_mul_f32 v[160:161], v[160:161], s[56:57]
    v_pk_mul_f32 v[162:163], v[162:163], s[56:57]
    v_cvt_pk_bf16_f32 v211, v160, v161
    v_cvt_pk_bf16_f32 v215, v162, v163
    v_mov_b32 v80, 0xffffff
    v_mov_b32 v81, 0xffffff
    v_mov_b32 v82, 0xffffff
    v_mov_b32 v83, 0xffffff
    v_add_u32 v2, s81, v232
    ds_write_b128 v2, v[80:83]
    v_and_b32 v7, 1, v1
L_pa:
    buffer_load_dword v6, v58, s[8:11], 0 offen sc1
L_pwa:
    s_waitcnt vmcnt(0)
    v_xor_b32 v144, v6, v59
    v_cmpx_le_i32 vcc, 0, v144
    s_cbranch_execz L_pda
    s_sub_u32 s30, s30, 1
    s_cbranch_scc1 L_end
    s_and_b32 s58, s30, 7
    s_cbranch_scc1 L_pa
    v_mov_b32 v144, 0
    buffer_load_dword v145, v144, s[44:47], 0 offen sc1
    s_waitcnt vmcnt(0)
    v_readfirstlane_b32 s53, v145
    s_cmp_eq_u32 s53, 0
    s_cbranch_scc1 L_pa
    buffer_load_dword v6, v58, s[8:11], 0 offen sc1
    s_waitcnt vmcnt(0)
L_pda:
    s_mov_b64 exec, -1
    v_bfe_u32 v236, v6, 16, 11
    v_and_b32 v5, 0xffff, v6
    v_sub_u32 v2, v236, v7
    v_add_u32_dpp v236, v236, v236 row_shr:2 row_mask:0xf bank_mask:0xf
    v_add_u32 v5, v5, v124
    s_nop 0
    v_add_u32_dpp v236, v236, v236 row_shr:4 row_mask:0xf bank_mask:0xf
    s_nop 1
    v_add_u32_dpp v236, v236, v236 row_shr:8 row_mask:0xf bank_mask:0xf
    s_nop 1
    v_add_u32_dpp v236, v236, v236 row_bcast:15 row_mask:0xa bank_mask:0xf
    s_nop 1
    v_add_u32_dpp v236, v236, v236 row_bcast:31 row_mask:0xc bank_mask:0xf
    v_sub_u32 v3, v236, v2
    v_min_u32 v4, 216, v236
    v_lshl_add_u32 v6, v3, 2, s81
    v_sub_u32 v4, v4, v3
    v_sub_u32 v237, v5, v3
    v_sub_u32 v235, v3, v7
L_exp:
    v_cmpx_lt_i32 vcc, 0, v4
    ds_write_b32 v6, v5 offset:0
    v_add_u32 v5, 2, v5
    v_cmpx_lt_i32 vcc, 2, v4
    ds_write_b32 v6, v5 offset:8
    v_add_u32 v5, 2, v5
    v_cmpx_lt_i32 vcc, 4, v4
    ds_write_b32 v6, v5 offset:16
    v_add_u32 v5, 2, v5
    v_cmpx_lt_i32 vcc, 6, v4
    ds_write_b32 v6, v5 offset:24
    v_add_u32 v5, 2, v5
    v_cmpx_lt_i32 vcc, 8, v4
    ds_write_b32 v6, v5 offset:32
    v_add_u32 v5, 2, v5
    v_cmpx_lt_i32 vcc, 10, v4
    ds_write_b32 v6, v5 offset:40
    v_add_u32 v5, 2, v5
    v_cmpx_lt_i32 vcc, 12, v4
    s_cbranch_execnz L_exp_more
L_exp_done:
    s_mov_b64 exec, -1
    ds_read_b32 v99, v121 offset:768
    ds_read_b32 v98, v121 offset:512
    ds_read_b32 v97, v121 offset:256
    ds_read_b32 v96, v121 offset:0
    v_readlane_b32 s19, v236, 63
    s_mov_b32 s26, 10485760
    s_sub_i32 s28, s19, s24
    s_cmp_le_i32 s28, 192
    s_cbranch_scc1 L_sk3
    s_waitcnt lgkmcnt(3)
    v_mul_u32_u24 v99, 12, v99
    buffer_load_dwordx3 v[92:94], v99, s[8:11], s26 offen sc1
L_sk3:
    s_waitcnt lgkmcnt(2)
    v_mul_u32_u24 v98, 12, v98
    buffer_load_dwordx3 v[88:90], v98, s[8:11], s26 offen sc1
    s_waitcnt lgkmcnt(1)
    v_mul_u32_u24 v97, 12, v97
    buffer_load_dwordx3 v[84:86], v97, s[8:11], s26 offen sc1
    s_waitcnt lgkmcnt(0)
    v_mul_u32_u24 v96, 12, v96
    buffer_load_dwordx3 v[80:82], v96, s[8:11], s26 offen sc1
    ds_read_b32 v100, v122 offset:0
    ds_read_b32 v101, v122 offset:128
    ds_read_b32 v102, v122 offset:256
    ds_read_b32 v103, v122 offset:384
    ds_read_b32 v104, v122 offset:512
    ds_read_b32 v105, v122 offset:640
    ds_read_b32 v106, v122 offset:768
    s_max_i32 s28, s28, 0
    s_min_i32 s28, s28, 216
    s_barrier
    s_waitcnt lgkmcnt(6)
    v_lshl_or_b32 v100, v100, 5, v123
    s_add_u32 m0, s80, 46080
    s_cmp_le_u32 s28, 32
    buffer_load_dwordx4 v100, s[8:11], 0 offen sc1 lds
    s_waitcnt lgkmcnt(5)
    v_lshl_or_b32 v101, v101, 5, v123
    s_add_u32 m0, s80, 47104
    s_cmp_le_u32 s28, 64
    buffer_load_dwordx4 v101, s[8:11], 0 offen sc1 lds
    s_waitcnt lgkmcnt(0)
    v_lshl_or_b32 v102, v102, 5, v123
    v_lshl_or_b32 v103, v103, 5, v123
    v_lshl_or_b32 v104, v104, 5, v123
    v_lshl_or_b32 v105, v105, 5, v123
    v_lshl_or_b32 v106, v106, 5, v123
    s_sub_i32 s27, s28, 0
    v_cmp_gt_i32 s[36:37], s27, v1
    s_sub_i32 s27, s28, 64
    v_cmp_gt_i32 s[38:39], s27, v1
    s_sub_i32 s27, s28, 128
    v_cmp_gt_i32 s[40:41], s27, v1
    s_sub_i32 s27, s28, 192
    v_cmp_gt_i32 s[42:43], s27, v1
    v_mov_b32 v3, s19
    v_mov_b32 v4, 2048
    ds_max_u32 v4, v3
    v_mov_b32 v6, 1
    s_waitcnt vmcnt(5)
    s_mov_b64 exec, s[42:43]
    v_and_b32 v2, 0x3ff, v94
    v_lshlrev_b32 v95, 2, v2
    ds_add_rtn_u32 v111, v95, v6 offset:0
    s_waitcnt vmcnt(4)
    s_mov_b64 exec, s[40:41]
    v_and_b32 v2, 0x3ff, v90
    v_lshlrev_b32 v91, 2, v2
    ds_add_rtn_u32 v110, v91, v6 offset:0
    s_waitcnt vmcnt(3)
    s_mov_b64 exec, s[38:39]
    v_and_b32 v2, 0x3ff, v86
    v_lshlrev_b32 v87, 2, v2
    ds_add_rtn_u32 v109, v87, v6 offset:0
    s_waitcnt vmcnt(2)
    s_mov_b64 exec, s[36:37]
    v_and_b32 v2, 0x3ff, v82
    v_lshlrev_b32 v83, 2, v2
    ds_add_rtn_u32 v108, v83, v6 offset:0
    s_mov_b64 exec, -1
    s_waitcnt lgkmcnt(0)
    s_barrier
    ds_read_b128 v[148:151], v125 offset:0
    ds_read_b128 v[152:155], v125 offset:16
    ds_read_b128 v[156:159], v125 offset:32
    ds_read_b32 v4, v4
    s_cmp_eq_u32 s24, s82
    s_cbranch_scc0 L_noall
    v_mov_b32 v144, 0
    v_mov_b32 v145, 1
    s_mov_b64 exec, 1
    buffer_store_dword v145, v144, s[44:47], 0 offen sc1
    s_mov_b64 exec, -1
L_noall:
    s_cmp_le_u32 s28, 64
    s_cbranch_scc1 L_efd
    s_add_u32 m0, s80, 48128
    s_cmp_le_u32 s28, 96
    buffer_load_dwordx4 v102, s[8:11], 0 offen sc1 lds
    s_cbranch_scc1 L_efd
    s_add_u32 m0, s80, 49152
    s_cmp_le_u32 s28, 128
    buffer_load_dwordx4 v103, s[8:11], 0 offen sc1 lds
    s_cbranch_scc1 L_efd
    s_add_u32 m0, s80, 50176
    s_cmp_le_u32 s28, 160
    buffer_load_dwordx4 v104, s[8:11], 0 offen sc1 lds
    s_cbranch_scc1 L_efd
    s_add_u32 m0, s80, 51200
    s_cmp_le_u32 s28, 192
    buffer_load_dwordx4 v105, s[8:11], 0 offen sc1 lds
    s_cbranch_scc1 L_efd
    s_add_u32 m0, s80, 52224
    s_cmp_le_u32 s28, 224
    s_mov_b32 exec_hi, 0xffff
    buffer_load_dwordx4 v106, s[8:11], 0 offen sc1 lds
    s_mov_b32 exec_hi, -1
L_efd:
    v_cmp_gt_u32 vcc, 40, v1
    s_waitcnt lgkmcnt(0)
    v_readfirstlane_b32 s26, v4
    v_add_u32 v3, v148, v149
    v_add3_u32 v3, v3, v150, v151
    v_add3_u32 v3, v3, v152, v153
    v_add3_u32 v3, v3, v154, v155
    v_add3_u32 v3, v3, v156, v157
    v_add3_u32 v3, v3, v158, v159
    v_lshl_or_b32 v3, v3, 6, v113
    v_cndmask_b32 v3, 0, v3, vcc
    s_max_u32 s25, s25, s26
    s_cmp_lg_u32 s24, 0
    s_cbranch_scc1 L_havepos
    v_readlane_b32 s64, v3, 0
    v_readlane_b32 s65, v3, 1
    v_readlane_b32 s66, v3, 2
    v_readlane_b32 s67, v3, 3
    v_readlane_b32 s68, v3, 4
    v_cmp_lt_u32 s[70:71], s64, v3
    v_cmp_lt_u32 s[72:73], s65, v3
    v_cmp_lt_u32 s[74:75], s66, v3
    v_cmp_lt_u32 s[76:77], s67, v3
    v_cmp_lt_u32 s[78:79], s68, v3
    s_bcnt1_i32_b64 s64, s[70:71]
    s_bcnt1_i32_b64 s65, s[72:73]
    s_bcnt1_i32_b64 s66, s[74:75]
    s_bcnt1_i32_b64 s67, s[76:77]
    s_bcnt1_i32_b64 s68, s[78:79]
    v_readlane_b32 s70, v112, s64
    v_readlane_b32 s71, v112, s65
    v_readlane_b32 s72, v112, s66
    v_readlane_b32 s73, v112, s67
    v_readlane_b32 s74, v112, s68
    v_writelane_b32 v238, s70, 0
    v_writelane_b32 v238, s71, 1
    v_writelane_b32 v238, s72, 2
    v_writelane_b32 v238, s73, 3
    v_writelane_b32 v238, s74, 4
    v_lshlrev_b32 v238, 2, v238
L_havepos:
    s_mov_b64 exec, 31
    ds_write_b32 v238, v3 offset:4096
    s_mov_b64 exec, -1
    v_lshlrev_b32 v4, 2, v1
    v_and_b32 v6, 7, v1
    v_cmp_gt_u32 s[34:35], s16, v6
    s_and_b64 s[34:35], s[34:35], vcc
    v_cmp_gt_u32 vcc, 60, v1
    s_waitcnt lgkmcnt(0)
    s_barrier
    ds_read_b32 v119, v126 offset:4096
    ds_read_b32 v4, v4 offset:4096
    s_waitcnt lgkmcnt(1)
    v_and_b32 v119, 63, v119
    v_mad_u32_u24 v3, v119, 48, v114
    ds_read_b32 v116, v3 offset:0
    s_waitcnt lgkmcnt(1)
    v_lshrrev_b32 v4, 6, v4
    v_cndmask_b32 v118, 0, v4, s[34:35]
    v_mul_u32_u24 v119, 1152, v119
    s_waitcnt lgkmcnt(0)
    v_cndmask_b32 v116, 0, v116, vcc
    v_mov_b32 v117, v116
    v_readlane_b32 s48, v119, 0
    v_readlane_b32 s49, v119, 1
    v_add_u32_dpp v117, v117, v117 row_shr:1 row_mask:0xf bank_mask:0xf
    v_add_u32_dpp v118, v118, v118 row_shr:1 row_mask:0xf bank_mask:0xf
    v_readlane_b32 s50, v119, 2
    v_add_u32_dpp v117, v117, v117 row_shr:2 row_mask:0xf bank_mask:0xf
    v_add_u32_dpp v118, v118, v118 row_shr:2 row_mask:0xf bank_mask:0xf
    v_readlane_b32 s51, v119, 3
    v_add_u32_dpp v117, v117, v117 row_shr:4 row_mask:0xf bank_mask:0xf
    v_add_u32_dpp v118, v118, v118 row_shr:4 row_mask:0xf bank_mask:0xf
    v_readlane_b32 s52, v119, 4
    v_add_u32_dpp v117, v117, v117 row_shr:8 row_mask:0xf bank_mask:0xf
    v_add_u32_dpp v118, v118, v118 row_shr:8 row_mask:0xf bank_mask:0xf
    v_lshlrev_b32 v4, 3, v115
    v_add_u32_dpp v117, v117, v117 row_bcast:15 row_mask:0xa bank_mask:0xf
    v_add_u32_dpp v118, v118, v118 row_bcast:15 row_mask:0xa bank_mask:0xf
    s_min_u32 s25, s25, 40000
    v_add_u32_dpp v117, v117, v117 row_bcast:31 row_mask:0xc bank_mask:0xf
    v_add_u32_dpp v118, v118, v118 row_bcast:31 row_mask:0xc bank_mask:0xf
    v_sub_u32 v116, v117, v116
    v_readlane_b32 s29, v118, 63
    v_readlane_b32 s18, v117, 63
    s_lshl_b32 s26, s29, 4
    s_add_u32 s26, s26, 101376
    v_lshl_add_u32 v116, v116, 4, s26
    v_lshl_or_b32 v116, v116, 10, v4
    s_mov_b64 exec, vcc
    ds_write_b32 v3, v116 offset:4608
    s_mov_b64 exec, -1
    s_min_u32 s18, s18, 1728
    v_lshl_add_u32 v230, v234, 4, s26
    v_and_b32 v2, 3, v1
    v_bfe_u32 v3, v1, 3, 2
    v_lshl_add_u32 v2, v3, 2, v2
    v_lshl_add_u32 v231, v2, 4, s26
    s_movk_i32 s27, 1023
    s_waitcnt lgkmcnt(0)
    s_barrier
    s_mov_b64 exec, s[36:37]
    ds_read_b32 v96, v83 offset:4608
    s_mov_b64 exec, s[38:39]
    ds_read_b32 v97, v87 offset:4608
    s_mov_b64 exec, s[40:41]
    ds_read_b32 v98, v91 offset:4608
    s_mov_b64 exec, s[42:43]
    ds_read_b32 v99, v95 offset:4608
    s_mov_b64 exec, -1
    v_add_u32 v83, 0, v127
    v_add_u32 v87, 2048, v127
    v_add_u32 v91, 4096, v127
    v_add_u32 v95, 6144, v127
    s_waitcnt lgkmcnt(0)
    s_mov_b64 exec, s[36:37]
    v_bfi_b32 v82, s27, v96, v82
    v_lshrrev_b32 v96, 10, v96
    v_lshl_add_u32 v96, v108, 4, v96
    ds_write_b128 v96, v[80:83]
    s_mov_b64 exec, s[38:39]
    v_bfi_b32 v86, s27, v97, v86
    v_lshrrev_b32 v97, 10, v97
    v_lshl_add_u32 v97, v109, 4, v97
    ds_write_b128 v97, v[84:87]
    s_mov_b64 exec, s[40:41]
    v_bfi_b32 v90, s27, v98, v90
    v_lshrrev_b32 v98, 10, v98
    v_lshl_add_u32 v98, v110, 4, v98
    ds_write_b128 v98, v[88:91]
    s_mov_b64 exec, s[42:43]
    v_bfi_b32 v94, s27, v99, v94
    v_lshrrev_b32 v99, 10, v99
    v_lshl_add_u32 v99, v111, 4, v99
    ds_write_b128 v99, v[92:95]
    s_mov_b64 exec, -1
    v_cmp_gt_i32 vcc, s18, v234
    v_mov_b32 v4, s32
    s_waitcnt lgkmcnt(0)
    s_barrier
    ds_read_b128 v[224:227], v230
    ds_read_b32 v229, v231 offset:12
    ds_read_b32 v2, v231 offset:268
    s_mov_b32 s59, 101376
    s_waitcnt lgkmcnt(0)
    v_cndmask_b32 v228, v4, v226, vcc
    v_and_or_b32 v229, v229, s33, v233
    v_readlane_b32 s64, v228, 0
    v_readlane_b32 s65, v228, 4
    v_readlane_b32 s66, v228, 8
    v_readlane_b32 s67, v228, 12
    v_readlane_b32 s68, v228, 16
    v_readlane_b32 s69, v228, 20
    v_readlane_b32 s70, v228, 24
    v_readlane_b32 s71, v228, 28
    s_and_b32 s80, s64, s31
    buffer_load_dwordx4 v[48:51], v232, s[4:7], s80 offen
    s_and_b32 s81, s65, s31
    buffer_load_dwordx4 v[52:55], v232, s[4:7], s81 offen
    s_and_b32 s82, s66, s31
    buffer_load_dwordx4 v[56:59], v232, s[4:7], s82 offen
    s_and_b32 s83, s67, s31
    buffer_load_dwordx4 v[60:63], v232, s[4:7], s83 offen
    s_waitcnt vmcnt(4)
    s_barrier
    s_mov_b64 exec, s[20:21]
    ds_read_b128 v[192:195], v229 offset:46080
    s_mov_b64 exec, s[22:23]
    ds_read_b128 v[196:199], v229 offset:46080
    s_mov_b64 exec, -1
    v_and_or_b32 v229, v2, s33, v233
    s_waitcnt lgkmcnt(0)
    v_mfma_f32_32x32x16_bf16 v[80:95], v[192:195], v[200:203], 0
    v_mfma_f32_32x32x16_bf16 v[96:111], v[192:195], v[204:207], 0
    v_mfma_f32_32x32x16_bf16 v[80:95], v[196:199], v[208:211], v[80:95]
    v_mfma_f32_32x32x16_bf16 v[96:111], v[196:199], v[212:215], v[96:111]
    s_and_b32 s80, s68, s31
    buffer_load_dwordx4 v[64:67], v232, s[4:7], s80 offen
    s_and_b32 s81, s69, s31
    buffer_load_dwordx4 v[68:71], v232, s[4:7], s81 offen
    s_and_b32 s82, s70, s31
    buffer_load_dwordx4 v[72:75], v232, s[4:7], s82 offen
    s_and_b32 s83, s71, s31
    buffer_load_dwordx4 v[76:79], v232, s[4:7], s83 offen
    s_mov_b64 exec, s[20:21]
    ds_read_b128 v[192:195], v229 offset:46080
    s_mov_b64 exec, -1
    s_cmp_lg_u32 s24, 0
    s_cbranch_scc1 L_wdone
    v_lshrrev_b32 v7, 5, v0
    v_and_b32 v3, 31, v1
    v_lshlrev_b32 v7, 11, v7
    v_add_u32 v7, 129024, v7
    v_lshl_add_u32 v2, v3, 3, v7
    ds_read_b64 v[160:161], v2 offset:0
    ds_read_b64 v[162:163], v2 offset:256
    ds_read_b64 v[164:165], v2 offset:512
    ds_read_b64 v[166:167], v2 offset:768
    ds_read_b64 v[168:169], v2 offset:1024
    ds_read_b64 v[170:171], v2 offset:1280
    ds_read_b64 v[172:173], v2 offset:1536
    ds_read_b64 v[174:175], v2 offset:1792
    s_mov_b32 s58, 0x05040100
    s_mov_b32 s59, 0x07060302
    v_bfe_u32 v3, v0, 3, 2
    v_lshl_add_u32 v7, v3, 9, v7
    v_and_b32 v3, 7, v0
    v_lshl_add_u32 v7, v3, 5, v7
    v_mov_b32 v5, 161792
    v_mov_b32 v6, 1
    s_waitcnt lgkmcnt(0)
    v_perm_b32 v112, v162, v160, s58
    v_perm_b32 v113, v166, v164, s58
    v_perm_b32 v114, v170, v168, s58
    v_perm_b32 v115, v174, v172, s58
    ds_write_b128 v7, v[112:115] offset:0
    v_perm_b32 v116, v162, v160, s59
    v_perm_b32 v117, v166, v164, s59
    v_perm_b32 v118, v170, v168, s59
    v_perm_b32 v119, v174, v172, s59
    ds_write_b128 v7, v[116:119] offset:256
    v_perm_b32 v120, v163, v161, s58
    v_perm_b32 v121, v167, v165, s58
    v_perm_b32 v122, v171, v169, s58
    v_perm_b32 v123, v175, v173, s58
    ds_write_b128 v7, v[120:123] offset:16
    v_perm_b32 v124, v163, v161, s59
    v_perm_b32 v125, v167, v165, s59
    v_perm_b32 v126, v171, v169, s59
    v_perm_b32 v127, v175, v173, s59
    ds_write_b128 v7, v[124:127] offset:272
    s_mov_b64 exec, 1
    ds_add_u32 v5, v6
    s_mov_b64 exec, -1
L_wdone:
    s_mov_b32 s59, 101376
    s_cmp_eq_u32 s16, 7
    s_cselect_b32 s3, 64, 0x80000000
    s_mov_b32 s53, 1
    s_mov_b32 s30, s18
    s_waitcnt lgkmcnt(0)
L_sb:
    s_cmp_gt_i32 s30, s3
    s_cbranch_scc1 L_nofl
    s_load_dword s53, s[54:55], 0
L_nofl:
    v_mfma_f32_4x4x4_16b_bf16 v[144:147], v[224:225], v[216:217], 0
    v_mfma_f32_4x4x4_16b_bf16 v[148:151], v[224:225], v[218:219], 0
    v_mfma_f32_4x4x4_16b_bf16 v[152:155], v[224:225], v[220:221], 0
    v_mfma_f32_4x4x4_16b_bf16 v[156:159], v[224:225], v[222:223], 0
    v_add_u32 v230, 1024, v230
    s_sub_u32 s26, s30, 64
    v_cmp_gt_i32 s[34:35], s26, v234
    s_cmp_le_i32 s30, 0
    s_nop 0
    v_cvt_pk_bf16_f32 v184, v144, v148
    v_cvt_pk_bf16_f32 v185, v152, v156
    v_cvt_pk_bf16_f32 v186, v145, v149
    v_cvt_pk_bf16_f32 v187, v153, v157
    v_cvt_pk_bf16_f32 v188, v146, v150
    v_cvt_pk_bf16_f32 v189, v154, v158
    v_cvt_pk_bf16_f32 v190, v147, v151
    v_cvt_pk_bf16_f32 v191, v155, v159
    ds_read_b128 v[224:227], v230
    ds_read_b32 v243, v244
    s_cbranch_scc1 L_exit
    s_setprio 3
    v_mfma_f32_32x32x16_bf16 v[112:127], v[192:195], v[200:203], 0
    v_exp_f32 v176, v80
    v_exp_f32 v177, v81
    v_exp_f32 v178, v82
    v_exp_f32 v179, v83
    v_exp_f32 v180, v96
    v_exp_f32 v181, v97
    v_exp_f32 v182, v98
    v_exp_f32 v183, v99
    v_pk_fma_f32 v[176:177], v[176:177], s[56:57], s[56:57]
    v_pk_fma_f32 v[178:179], v[178:179], s[56:57], s[56:57]
    v_pk_fma_f32 v[180:181], v[180:181], s[56:57], s[56:57]
    v_pk_fma_f32 v[182:183], v[182:183], s[56:57], s[56:57]
    s_waitcnt vmcnt(4)
    v_mfma_f32_4x4x4_16b_bf16 v[144:147], v[184:185], v[48:49], 0 cbsz:4 abid:0
    v_rcp_f32 v176, v176
    v_mfma_f32_4x4x4_16b_bf16 v[148:151], v[184:185], v[50:51], 0 cbsz:4 abid:0
    v_rcp_f32 v177, v177
    v_mfma_f32_4x4x4_16b_bf16 v[152:155], v[184:185], v[52:53], 0 cbsz:4 abid:1
    v_rcp_f32 v178, v178
    v_mfma_f32_4x4x4_16b_bf16 v[156:159], v[184:185], v[54:55], 0 cbsz:4 abid:1
    v_rcp_f32 v179, v179
    v_mfma_f32_4x4x4_16b_bf16 v[160:163], v[184:185], v[56:57], 0 cbsz:4 abid:2
    v_rcp_f32 v180, v180
    v_mfma_f32_4x4x4_16b_bf16 v[164:167], v[184:185], v[58:59], 0 cbsz:4 abid:2
    v_rcp_f32 v181, v181
    v_mfma_f32_4x4x4_16b_bf16 v[168:171], v[184:185], v[60:61], 0 cbsz:4 abid:3
    v_rcp_f32 v182, v182
    v_mfma_f32_4x4x4_16b_bf16 v[172:175], v[184:185], v[62:63], 0 cbsz:4 abid:3
    v_rcp_f32 v183, v183
    v_readlane_b32 s72, v228, 32
    v_readlane_b32 s73, v228, 36
    v_readlane_b32 s74, v228, 40
    v_readlane_b32 s75, v228, 44
    v_pk_mul_f32 v[176:177], v[176:177], v[80:81]
    v_pk_mul_f32 v[178:179], v[178:179], v[82:83]
    v_pk_mul_f32 v[180:181], v[180:181], v[96:97]
    v_pk_mul_f32 v[182:183], v[182:183], v[98:99]
    s_set_gpr_idx_on s64, gpr_idx(SRC2,DST)
    v_pk_fma_f32 v[8:9], v[176:177], v[144:145], v[8:9] op_sel:[0,0,0] op_sel_hi:[0,1,1]
    v_pk_fma_f32 v[10:11], v[176:177], v[146:147], v[10:11] op_sel:[0,0,0] op_sel_hi:[0,1,1]
    v_pk_fma_f32 v[12:13], v[180:181], v[148:149], v[12:13] op_sel:[0,0,0] op_sel_hi:[0,1,1]
    v_pk_fma_f32 v[14:15], v[180:181], v[150:151], v[14:15] op_sel:[0,0,0] op_sel_hi:[0,1,1]
    s_set_gpr_idx_idx s65
    v_pk_fma_f32 v[8:9], v[176:177], v[152:153], v[8:9] op_sel:[1,0,0] op_sel_hi:[1,1,1]
    v_pk_fma_f32 v[10:11], v[176:177], v[154:155], v[10:11] op_sel:[1,0,0] op_sel_hi:[1,1,1]
    v_pk_fma_f32 v[12:13], v[180:181], v[156:157], v[12:13] op_sel:[1,0,0] op_sel_hi:[1,1,1]
    v_pk_fma_f32 v[14:15], v[180:181], v[158:159], v[14:15] op_sel:[1,0,0] op_sel_hi:[1,1,1]
    s_set_gpr_idx_idx s66
    v_pk_fma_f32 v[8:9], v[178:179], v[160:161], v[8:9] op_sel:[0,0,0] op_sel_hi:[0,1,1]
    v_pk_fma_f32 v[10:11], v[178:179], v[162:163], v[10:11] op_sel:[0,0,0] op_sel_hi:[0,1,1]
    v_pk_fma_f32 v[12:13], v[182:183], v[164:165], v[12:13] op_sel:[0,0,0] op_sel_hi:[0,1,1]
    v_pk_fma_f32 v[14:15], v[182:183], v[166:167], v[14:15] op_sel:[0,0,0] op_sel_hi:[0,1,1]
    s_set_gpr_idx_idx s67
    v_pk_fma_f32 v[8:9], v[178:179], v[168:169], v[8:9] op_sel:[1,0,0] op_sel_hi:[1,1,1]
    v_pk_fma_f32 v[10:11], v[178:179], v[170:171], v[10:11] op_sel:[1,0,0] op_sel_hi:[1,1,1]
    v_pk_fma_f32 v[12:13], v[182:183], v[172:173], v[12:13] op_sel:[1,0,0] op_sel_hi:[1,1,1]
    v_pk_fma_f32 v[14:15], v[182:183], v[174:175], v[14:15] op_sel:[1,0,0] op_sel_hi:[1,1,1]
    s_set_gpr_idx_off
    s_and_b32 s80, s72, s31
    s_and_b32 s81, s73, s31
    s_and_b32 s82, s74, s31
    s_and_b32 s83, s75, s31
    buffer_load_dwordx4 v[48:51], v232, s[4:7], s80 offen
    buffer_load_dwordx4 v[52:55], v232, s[4:7], s81 offen
    buffer_load_dwordx4 v[56:59], v232, s[4:7], s82 offen
    buffer_load_dwordx4 v[60:63], v232, s[4:7], s83 offen
    s_cmp_le_i32 s30, 4
    s_mov_b64 exec, s[22:23]
    ds_read_b128 v[196:199], v229 offset:46080
    s_mov_b64 exec, -1
    ds_read_b32 v2, v231 offset:524
    s_cbranch_scc1 L_exit
    s_setprio 2
    v_mfma_f32_32x32x16_bf16 v[128:143], v[192:195], v[204:207], 0
    v_exp_f32 v176, v84
    v_exp_f32 v177, v85
    v_exp_f32 v178, v86
    v_exp_f32 v179, v87
    v_exp_f32 v180, v100
    v_exp_f32 v181, v101
    v_exp_f32 v182, v102
    v_exp_f32 v183, v103
    v_pk_fma_f32 v[176:177], v[176:177], s[56:57], s[56:57]
    v_pk_fma_f32 v[178:179], v[178:179], s[56:57], s[56:57]
    v_pk_fma_f32 v[180:181], v[180:181], s[56:57], s[56:57]
    v_pk_fma_f32 v[182:183], v[182:183], s[56:57], s[56:57]
    s_waitcnt vmcnt(4)
    v_mfma_f32_4x4x4_16b_bf16 v[144:147], v[184:185], v[64:65], 0 cbsz:4 abid:4
    v_rcp_f32 v176, v176
    v_mfma_f32_4x4x4_16b_bf16 v[148:151], v[184:185], v[66:67], 0 cbsz:4 abid:4
    v_rcp_f32 v177, v177
    v_mfma_f32_4x4x4_16b_bf16 v[152:155], v[184:185], v[68:69], 0 cbsz:4 abid:5
    v_rcp_f32 v178, v178
    v_mfma_f32_4x4x4_16b_bf16 v[156:159], v[184:185], v[70:71], 0 cbsz:4 abid:5
    v_rcp_f32 v179, v179
    v_mfma_f32_4x4x4_16b_bf16 v[160:163], v[184:185], v[72:73], 0 cbsz:4 abid:6
    v_rcp_f32 v180, v180
    v_mfma_f32_4x4x4_16b_bf16 v[164:167], v[184:185], v[74:75], 0 cbsz:4 abid:6
    v_rcp_f32 v181, v181
    v_mfma_f32_4x4x4_16b_bf16 v[168:171], v[184:185], v[76:77], 0 cbsz:4 abid:7
    v_rcp_f32 v182, v182
    v_mfma_f32_4x4x4_16b_bf16 v[172:175], v[184:185], v[78:79], 0 cbsz:4 abid:7
    v_rcp_f32 v183, v183
    v_readlane_b32 s76, v228, 48
    v_readlane_b32 s77, v228, 52
    v_readlane_b32 s78, v228, 56
    v_readlane_b32 s79, v228, 60
    v_pk_mul_f32 v[176:177], v[176:177], v[84:85]
    v_pk_mul_f32 v[178:179], v[178:179], v[86:87]
    v_pk_mul_f32 v[180:181], v[180:181], v[100:101]
    v_pk_mul_f32 v[182:183], v[182:183], v[102:103]
    s_set_gpr_idx_on s68, gpr_idx(SRC2,DST)
    v_pk_fma_f32 v[8:9], v[176:177], v[144:145], v[8:9] op_sel:[0,0,0] op_sel_hi:[0,1,1]
    v_pk_fma_f32 v[10:11], v[176:177], v[146:147], v[10:11] op_sel:[0,0,0] op_sel_hi:[0,1,1]
    v_pk_fma_f32 v[12:13], v[180:181], v[148:149], v[12:13] op_sel:[0,0,0] op_sel_hi:[0,1,1]
    v_pk_fma_f32 v[14:15], v[180:181], v[150:151], v[14:15] op_sel:[0,0,0] op_sel_hi:[0,1,1]
    s_set_gpr_idx_idx s69
    v_pk_fma_f32 v[8:9], v[176:177], v[152:153], v[8:9] op_sel:[1,0,0] op_sel_hi:[1,1,1]
    v_pk_fma_f32 v[10:11], v[176:177], v[154:155], v[10:11] op_sel:[1,0,0] op_sel_hi:[1,1,1]
    v_pk_fma_f32 v[12:13], v[180:181], v[156:157], v[12:13] op_sel:[1,0,0] op_sel_hi:[1,1,1]
    v_pk_fma_f32 v[14:15], v[180:181], v[158:159], v[14:15] op_sel:[1,0,0] op_sel_hi:[1,1,1]
    s_set_gpr_idx_idx s70
    v_pk_fma_f32 v[8:9], v[178:179], v[160:161], v[8:9] op_sel:[0,0,0] op_sel_hi:[0,1,1]
    v_pk_fma_f32 v[10:11], v[178:179], v[162:163], v[10:11] op_sel:[0,0,0] op_sel_hi:[0,1,1]
    v_pk_fma_f32 v[12:13], v[182:183], v[164:165], v[12:13] op_sel:[0,0,0] op_sel_hi:[0,1,1]
    v_pk_fma_f32 v[14:15], v[182:183], v[166:167], v[14:15] op_sel:[0,0,0] op_sel_hi:[0,1,1]
    s_set_gpr_idx_idx s71
    v_pk_fma_f32 v[8:9], v[178:179], v[168:169], v[8:9] op_sel:[1,0,0] op_sel_hi:[1,1,1]
    v_pk_fma_f32 v[10:11], v[178:179], v[170:171], v[10:11] op_sel:[1,0,0] op_sel_hi:[1,1,1]
    v_pk_fma_f32 v[12:13], v[182:183], v[172:173], v[12:13] op_sel:[1,0,0] op_sel_hi:[1,1,1]
    v_pk_fma_f32 v[14:15], v[182:183], v[174:175], v[14:15] op_sel:[1,0,0] op_sel_hi:[1,1,1]
    s_set_gpr_idx_off
    s_and_b32 s80, s76, s31
    s_and_b32 s81, s77, s31
    s_and_b32 s82, s78, s31
    s_and_b32 s83, s79, s31
    buffer_load_dwordx4 v[64:67], v232, s[4:7], s80 offen
    buffer_load_dwordx4 v[68:71], v232, s[4:7], s81 offen
    buffer_load_dwordx4 v[72:75], v232, s[4:7], s82 offen
    buffer_load_dwordx4 v[76:79], v232, s[4:7], s83 offen
    s_cmp_le_i32 s30, 8
    s_waitcnt lgkmcnt(0)
    s_cbranch_scc1 L_exit
    s_setprio 1
    v_mfma_f32_32x32x16_bf16 v[112:127], v[196:199], v[208:211], v[112:127]
    v_exp_f32 v176, v88
    v_exp_f32 v177, v89
    v_exp_f32 v178, v90
    v_exp_f32 v179, v91
    v_exp_f32 v180, v104
    v_exp_f32 v181, v105
    v_exp_f32 v182, v106
    v_exp_f32 v183, v107
    v_pk_fma_f32 v[176:177], v[176:177], s[56:57], s[56:57]
    v_pk_fma_f32 v[178:179], v[178:179], s[56:57], s[56:57]
    v_pk_fma_f32 v[180:181], v[180:181], s[56:57], s[56:57]
    v_pk_fma_f32 v[182:183], v[182:183], s[56:57], s[56:57]
    s_waitcnt vmcnt(4)
    v_mfma_f32_4x4x4_16b_bf16 v[144:147], v[184:185], v[48:49], 0 cbsz:4 abid:8
    v_rcp_f32 v176, v176
    v_mfma_f32_4x4x4_16b_bf16 v[148:151], v[184:185], v[50:51], 0 cbsz:4 abid:8
    v_rcp_f32 v177, v177
    v_mfma_f32_4x4x4_16b_bf16 v[152:155], v[184:185], v[52:53], 0 cbsz:4 abid:9
    v_rcp_f32 v178, v178
    v_mfma_f32_4x4x4_16b_bf16 v[156:159], v[184:185], v[54:55], 0 cbsz:4 abid:9
    v_rcp_f32 v179, v179
    v_mfma_f32_4x4x4_16b_bf16 v[160:163], v[184:185], v[56:57], 0 cbsz:4 abid:10
    v_rcp_f32 v180, v180
    v_mfma_f32_4x4x4_16b_bf16 v[164:167], v[184:185], v[58:59], 0 cbsz:4 abid:10
    v_rcp_f32 v181, v181
    v_mfma_f32_4x4x4_16b_bf16 v[168:171], v[184:185], v[60:61], 0 cbsz:4 abid:11
    v_rcp_f32 v182, v182
    v_mfma_f32_4x4x4_16b_bf16 v[172:175], v[184:185], v[62:63], 0 cbsz:4 abid:11
    v_rcp_f32 v183, v183
    v_readlane_b32 s64, v228, 1
    v_readlane_b32 s65, v228, 5
    v_readlane_b32 s66, v228, 9
    v_readlane_b32 s67, v228, 13
    v_and_or_b32 v229, v2, s33, v233
    v_pk_mul_f32 v[176:177], v[176:177], v[88:89]
    v_pk_mul_f32 v[178:179], v[178:179], v[90:91]
    v_pk_mul_f32 v[180:181], v[180:181], v[104:105]
    v_pk_mul_f32 v[182:183], v[182:183], v[106:107]
    s_set_gpr_idx_on s72, gpr_idx(SRC2,DST)
    v_pk_fma_f32 v[8:9], v[176:177], v[144:145], v[8:9] op_sel:[0,0,0] op_sel_hi:[0,1,1]
    v_pk_fma_f32 v[10:11], v[176:177], v[146:147], v[10:11] op_sel:[0,0,0] op_sel_hi:[0,1,1]
    v_pk_fma_f32 v[12:13], v[180:181], v[148:149], v[12:13] op_sel:[0,0,0] op_sel_hi:[0,1,1]
    v_pk_fma_f32 v[14:15], v[180:181], v[150:151], v[14:15] op_sel:[0,0,0] op_sel_hi:[0,1,1]
    s_set_gpr_idx_idx s73
    v_pk_fma_f32 v[8:9], v[176:177], v[152:153], v[8:9] op_sel:[1,0,0] op_sel_hi:[1,1,1]
    v_pk_fma_f32 v[10:11], v[176:177], v[154:155], v[10:11] op_sel:[1,0,0] op_sel_hi:[1,1,1]
    v_pk_fma_f32 v[12:13], v[180:181], v[156:157], v[12:13] op_sel:[1,0,0] op_sel_hi:[1,1,1]
    v_pk_fma_f32 v[14:15], v[180:181], v[158:159], v[14:15] op_sel:[1,0,0] op_sel_hi:[1,1,1]
    s_set_gpr_idx_idx s74
    v_pk_fma_f32 v[8:9], v[178:179], v[160:161], v[8:9] op_sel:[0,0,0] op_sel_hi:[0,1,1]
    v_pk_fma_f32 v[10:11], v[178:179], v[162:163], v[10:11] op_sel:[0,0,0] op_sel_hi:[0,1,1]
    v_pk_fma_f32 v[12:13], v[182:183], v[164:165], v[12:13] op_sel:[0,0,0] op_sel_hi:[0,1,1]
    v_pk_fma_f32 v[14:15], v[182:183], v[166:167], v[14:15] op_sel:[0,0,0] op_sel_hi:[0,1,1]
    s_set_gpr_idx_idx s75
    v_pk_fma_f32 v[8:9], v[178:179], v[168:169], v[8:9] op_sel:[1,0,0] op_sel_hi:[1,1,1]
    v_pk_fma_f32 v[10:11], v[178:179], v[170:171], v[10:11] op_sel:[1,0,0] op_sel_hi:[1,1,1]
    v_pk_fma_f32 v[12:13], v[182:183], v[172:173], v[12:13] op_sel:[1,0,0] op_sel_hi:[1,1,1]
    v_pk_fma_f32 v[14:15], v[182:183], v[174:175], v[14:15] op_sel:[1,0,0] op_sel_hi:[1,1,1]
    s_set_gpr_idx_off
    s_and_b32 s80, s64, s31
    s_and_b32 s81, s65, s31
    s_and_b32 s82, s66, s31
    s_and_b32 s83, s67, s31
    buffer_load_dwordx4 v[48:51], v232, s[4:7], s80 offen
    buffer_load_dwordx4 v[52:55], v232, s[4:7], s81 offen
    buffer_load_dwordx4 v[56:59], v232, s[4:7], s82 offen
    buffer_load_dwordx4 v[60:63], v232, s[4:7], s83 offen
    s_cmp_le_i32 s30, 12
    s_mov_b64 exec, s[20:21]
    ds_read_b128 v[192:195], v229 offset:46080
    s_mov_b64 exec, -1
    s_cbranch_scc1 L_exit
    s_setprio 0
    v_mfma_f32_32x32x16_bf16 v[128:143], v[196:199], v[212:215], v[128:143]
    v_exp_f32 v176, v92
    v_exp_f32 v177, v93
    v_exp_f32 v178, v94
    v_exp_f32 v179, v95
    v_exp_f32 v180, v108
    v_exp_f32 v181, v109
    v_exp_f32 v182, v110
    v_exp_f32 v183, v111
    v_pk_fma_f32 v[176:177], v[176:177], s[56:57], s[56:57]
    v_pk_fma_f32 v[178:179], v[178:179], s[56:57], s[56:57]
    v_pk_fma_f32 v[180:181], v[180:181], s[56:57], s[56:57]
    v_pk_fma_f32 v[182:183], v[182:183], s[56:57], s[56:57]
    s_waitcnt vmcnt(4)
    v_mfma_f32_4x4x4_16b_bf16 v[144:147], v[184:185], v[64:65], 0 cbsz:4 abid:12
    v_rcp_f32 v176, v176
    v_mfma_f32_4x4x4_16b_bf16 v[148:151], v[184:185], v[66:67], 0 cbsz:4 abid:12
    v_rcp_f32 v177, v177
    v_mfma_f32_4x4x4_16b_bf16 v[152:155], v[184:185], v[68:69], 0 cbsz:4 abid:13
    v_rcp_f32 v178, v178
    v_mfma_f32_4x4x4_16b_bf16 v[156:159], v[184:185], v[70:71], 0 cbsz:4 abid:13
    v_rcp_f32 v179, v179
    v_mfma_f32_4x4x4_16b_bf16 v[160:163], v[184:185], v[72:73], 0 cbsz:4 abid:14
    v_rcp_f32 v180, v180
    v_mfma_f32_4x4x4_16b_bf16 v[164:167], v[184:185], v[74:75], 0 cbsz:4 abid:14
    v_rcp_f32 v181, v181
    v_mfma_f32_4x4x4_16b_bf16 v[168:171], v[184:185], v[76:77], 0 cbsz:4 abid:15
    v_rcp_f32 v182, v182
    v_mfma_f32_4x4x4_16b_bf16 v[172:175], v[184:185], v[78:79], 0 cbsz:4 abid:15
    v_rcp_f32 v183, v183
    v_readlane_b32 s68, v228, 17
    v_readlane_b32 s69, v228, 21
    v_readlane_b32 s70, v228, 25
    v_readlane_b32 s71, v228, 29
    v_pk_mul_f32 v[176:177], v[176:177], v[92:93]
    v_pk_mul_f32 v[178:179], v[178:179], v[94:95]
    v_pk_mul_f32 v[180:181], v[180:181], v[108:109]
    v_pk_mul_f32 v[182:183], v[182:183], v[110:111]
    s_set_gpr_idx_on s76, gpr_idx(SRC2,DST)
    v_pk_fma_f32 v[8:9], v[176:177], v[144:145], v[8:9] op_sel:[0,0,0] op_sel_hi:[0,1,1]
    v_pk_fma_f32 v[10:11], v[176:177], v[146:147], v[10:11] op_sel:[0,0,0] op_sel_hi:[0,1,1]
    v_pk_fma_f32 v[12:13], v[180:181], v[148:149], v[12:13] op_sel:[0,0,0] op_sel_hi:[0,1,1]
    v_pk_fma_f32 v[14:15], v[180:181], v[150:151], v[14:15] op_sel:[0,0,0] op_sel_hi:[0,1,1]
    s_set_gpr_idx_idx s77
    v_pk_fma_f32 v[8:9], v[176:177], v[152:153], v[8:9] op_sel:[1,0,0] op_sel_hi:[1,1,1]
    v_pk_fma_f32 v[10:11], v[176:177], v[154:155], v[10:11] op_sel:[1,0,0] op_sel_hi:[1,1,1]
    v_pk_fma_f32 v[12:13], v[180:181], v[156:157], v[12:13] op_sel:[1,0,0] op_sel_hi:[1,1,1]
    v_pk_fma_f32 v[14:15], v[180:181], v[158:159], v[14:15] op_sel:[1,0,0] op_sel_hi:[1,1,1]
    s_set_gpr_idx_idx s78
    v_pk_fma_f32 v[8:9], v[178:179], v[160:161], v[8:9] op_sel:[0,0,0] op_sel_hi:[0,1,1]
    v_pk_fma_f32 v[10:11], v[178:179], v[162:163], v[10:11] op_sel:[0,0,0] op_sel_hi:[0,1,1]
    v_pk_fma_f32 v[12:13], v[182:183], v[164:165], v[12:13] op_sel:[0,0,0] op_sel_hi:[0,1,1]
    v_pk_fma_f32 v[14:15], v[182:183], v[166:167], v[14:15] op_sel:[0,0,0] op_sel_hi:[0,1,1]
    s_set_gpr_idx_idx s79
    v_pk_fma_f32 v[8:9], v[178:179], v[168:169], v[8:9] op_sel:[1,0,0] op_sel_hi:[1,1,1]
    v_pk_fma_f32 v[10:11], v[178:179], v[170:171], v[10:11] op_sel:[1,0,0] op_sel_hi:[1,1,1]
    v_pk_fma_f32 v[12:13], v[182:183], v[172:173], v[12:13] op_sel:[1,0,0] op_sel_hi:[1,1,1]
    v_pk_fma_f32 v[14:15], v[182:183], v[174:175], v[14:15] op_sel:[1,0,0] op_sel_hi:[1,1,1]
    s_set_gpr_idx_off
    s_and_b32 s80, s68, s31
    s_and_b32 s81, s69, s31
    s_and_b32 s82, s70, s31
    s_and_b32 s83, s71, s31
    buffer_load_dwordx4 v[64:67], v232, s[4:7], s80 offen
    buffer_load_dwordx4 v[68:71], v232, s[4:7], s81 offen
    buffer_load_dwordx4 v[72:75], v232, s[4:7], s82 offen
    buffer_load_dwordx4 v[76:79], v232, s[4:7], s83 offen
    s_cmp_le_i32 s30, 16
    s_waitcnt lgkmcnt(0)
    s_cbranch_scc1 L_exit
    s_setprio 3
    v_mfma_f32_32x32x16_bf16 v[80:95], v[192:195], v[200:203], 0
    v_exp_f32 v176, v112
    v_exp_f32 v177, v113
    v_exp_f32 v178, v114
    v_exp_f32 v179, v115
    v_exp_f32 v180, v128
    v_exp_f32 v181, v129
    v_exp_f32 v182, v130
    v_exp_f32 v183, v131
    v_pk_fma_f32 v[176:177], v[176:177], s[56:57], s[56:57]
    v_pk_fma_f32 v[178:179], v[178:179], s[56:57], s[56:57]
    v_pk_fma_f32 v[180:181], v[180:181], s[56:57], s[56:57]
    v_pk_fma_f32 v[182:183], v[182:183], s[56:57], s[56:57]
    s_waitcnt vmcnt(4)
    v_mfma_f32_4x4x4_16b_bf16 v[144:147], v[186:187], v[48:49], 0 cbsz:4 abid:0
    v_rcp_f32 v176, v176
    v_mfma_f32_4x4x4_16b_bf16 v[148:151], v[186:187], v[50:51], 0 cbsz:4 abid:0
    v_rcp_f32 v177, v177
    v_mfma_f32_4x4x4_16b_bf16 v[152:155], v[186:187], v[52:53], 0 cbsz:4 abid:1
    v_rcp_f32 v178, v178
    v_mfma_f32_4x4x4_16b_bf16 v[156:159], v[186:187], v[54:55], 0 cbsz:4 abid:1
    v_rcp_f32 v179, v179
    v_mfma_f32_4x4x4_16b_bf16 v[160:163], v[186:187], v[56:57], 0 cbsz:4 abid:2
    v_rcp_f32 v180, v180
    v_mfma_f32_4x4x4_16b_bf16 v[164:167], v[186:187], v[58:59], 0 cbsz:4 abid:2
    v_rcp_f32 v181, v181
    v_mfma_f32_4x4x4_16b_bf16 v[168:171], v[186:187], v[60:61], 0 cbsz:4 abid:3
    v_rcp_f32 v182, v182
    v_mfma_f32_4x4x4_16b_bf16 v[172:175], v[186:187], v[62:63], 0 cbsz:4 abid:3
    v_rcp_f32 v183, v183
    v_readlane_b32 s72, v228, 33
    v_readlane_b32 s73, v228, 37
    v_readlane_b32 s74, v228, 41
    v_readlane_b32 s75, v228, 45
    v_pk_mul_f32 v[176:177], v[176:177], v[112:113]
    v_pk_mul_f32 v[178:179], v[178:179], v[114:115]
    v_pk_mul_f32 v[180:181], v[180:181], v[128:129]
    v_pk_mul_f32 v[182:183], v[182:183], v[130:131]
    s_set_gpr_idx_on s64, gpr_idx(SRC2,DST)
    v_pk_fma_f32 v[8:9], v[176:177], v[144:145], v[8:9] op_sel:[0,0,0] op_sel_hi:[0,1,1]
    v_pk_fma_f32 v[10:11], v[176:177], v[146:147], v[10:11] op_sel:[0,0,0] op_sel_hi:[0,1,1]
    v_pk_fma_f32 v[12:13], v[180:181], v[148:149], v[12:13] op_sel:[0,0,0] op_sel_hi:[0,1,1]
    v_pk_fma_f32 v[14:15], v[180:181], v[150:151], v[14:15] op_sel:[0,0,0] op_sel_hi:[0,1,1]
    s_set_gpr_idx_idx s65
    v_pk_fma_f32 v[8:9], v[176:177], v[152:153], v[8:9] op_sel:[1,0,0] op_sel_hi:[1,1,1]
    v_pk_fma_f32 v[10:11], v[176:177], v[154:155], v[10:11] op_sel:[1,0,0] op_sel_hi:[1,1,1]
    v_pk_fma_f32 v[12:13], v[180:181], v[156:157], v[12:13] op_sel:[1,0,0] op_sel_hi:[1,1,1]
    v_pk_fma_f32 v[14:15], v[180:181], v[158:159], v[14:15] op_sel:[1,0,0] op_sel_hi:[1,1,1]
    s_set_gpr_idx_idx s66
    v_pk_fma_f32 v[8:9], v[178:179], v[160:161], v[8:9] op_sel:[0,0,0] op_sel_hi:[0,1,1]
    v_pk_fma_f32 v[10:11], v[178:179], v[162:163], v[10:11] op_sel:[0,0,0] op_sel_hi:[0,1,1]
    v_pk_fma_f32 v[12:13], v[182:183], v[164:165], v[12:13] op_sel:[0,0,0] op_sel_hi:[0,1,1]
    v_pk_fma_f32 v[14:15], v[182:183], v[166:167], v[14:15] op_sel:[0,0,0] op_sel_hi:[0,1,1]
    s_set_gpr_idx_idx s67
    v_pk_fma_f32 v[8:9], v[178:179], v[168:169], v[8:9] op_sel:[1,0,0] op_sel_hi:[1,1,1]
    v_pk_fma_f32 v[10:11], v[178:179], v[170:171], v[10:11] op_sel:[1,0,0] op_sel_hi:[1,1,1]
    v_pk_fma_f32 v[12:13], v[182:183], v[172:173], v[12:13] op_sel:[1,0,0] op_sel_hi:[1,1,1]
    v_pk_fma_f32 v[14:15], v[182:183], v[174:175], v[14:15] op_sel:[1,0,0] op_sel_hi:[1,1,1]
    s_set_gpr_idx_off
    s_and_b32 s80, s72, s31
    s_and_b32 s81, s73, s31
    s_and_b32 s82, s74, s31
    s_and_b32 s83, s75, s31
    buffer_load_dwordx4 v[48:51], v232, s[4:7], s80 offen
    buffer_load_dwordx4 v[52:55], v232, s[4:7], s81 offen
    buffer_load_dwordx4 v[56:59], v232, s[4:7], s82 offen
    buffer_load_dwordx4 v[60:63], v232, s[4:7], s83 offen
    s_cmp_le_i32 s30, 20
    s_mov_b64 exec, s[22:23]
    ds_read_b128 v[196:199], v229 offset:46080
    s_mov_b64 exec, -1
    ds_read_b32 v2, v231 offset:780
    s_cbranch_scc1 L_exit
    s_setprio 2
    v_mfma_f32_32x32x16_bf16 v[96:111], v[192:195], v[204:207], 0
    v_exp_f32 v176, v116
    v_exp_f32 v177, v117
    v_exp_f32 v178, v118
    v_exp_f32 v179, v119
    v_exp_f32 v180, v132
    v_exp_f32 v181, v133
    v_exp_f32 v182, v134
    v_exp_f32 v183, v135
    v_pk_fma_f32 v[176:177], v[176:177], s[56:57], s[56:57]
    v_pk_fma_f32 v[178:179], v[178:179], s[56:57], s[56:57]
    v_pk_fma_f32 v[180:181], v[180:181], s[56:57], s[56:57]
    v_pk_fma_f32 v[182:183], v[182:183], s[56:57], s[56:57]
    s_waitcnt vmcnt(4)
    v_mfma_f32_4x4x4_16b_bf16 v[144:147], v[186:187], v[64:65], 0 cbsz:4 abid:4
    v_rcp_f32 v176, v176
    v_mfma_f32_4x4x4_16b_bf16 v[148:151], v[186:187], v[66:67], 0 cbsz:4 abid:4
    v_rcp_f32 v177, v177
    v_mfma_f32_4x4x4_16b_bf16 v[152:155], v[186:187], v[68:69], 0 cbsz:4 abid:5
    v_rcp_f32 v178, v178
    v_mfma_f32_4x4x4_16b_bf16 v[156:159], v[186:187], v[70:71], 0 cbsz:4 abid:5
    v_rcp_f32 v179, v179
    v_mfma_f32_4x4x4_16b_bf16 v[160:163], v[186:187], v[72:73], 0 cbsz:4 abid:6
    v_rcp_f32 v180, v180
    v_mfma_f32_4x4x4_16b_bf16 v[164:167], v[186:187], v[74:75], 0 cbsz:4 abid:6
    v_rcp_f32 v181, v181
    v_mfma_f32_4x4x4_16b_bf16 v[168:171], v[186:187], v[76:77], 0 cbsz:4 abid:7
    v_rcp_f32 v182, v182
    v_mfma_f32_4x4x4_16b_bf16 v[172:175], v[186:187], v[78:79], 0 cbsz:4 abid:7
    v_rcp_f32 v183, v183
    v_readlane_b32 s76, v228, 49
    v_readlane_b32 s77, v228, 53
    v_readlane_b32 s78, v228, 57
    v_readlane_b32 s79, v228, 61
    v_pk_mul_f32 v[176:177], v[176:177], v[116:117]
    v_pk_mul_f32 v[178:179], v[178:179], v[118:119]
    v_pk_mul_f32 v[180:181], v[180:181], v[132:133]
    v_pk_mul_f32 v[182:183], v[182:183], v[134:135]
    s_set_gpr_idx_on s68, gpr_idx(SRC2,DST)
    v_pk_fma_f32 v[8:9], v[176:177], v[144:145], v[8:9] op_sel:[0,0,0] op_sel_hi:[0,1,1]
    v_pk_fma_f32 v[10:11], v[176:177], v[146:147], v[10:11] op_sel:[0,0,0] op_sel_hi:[0,1,1]
    v_pk_fma_f32 v[12:13], v[180:181], v[148:149], v[12:13] op_sel:[0,0,0] op_sel_hi:[0,1,1]
    v_pk_fma_f32 v[14:15], v[180:181], v[150:151], v[14:15] op_sel:[0,0,0] op_sel_hi:[0,1,1]
    s_set_gpr_idx_idx s69
    v_pk_fma_f32 v[8:9], v[176:177], v[152:153], v[8:9] op_sel:[1,0,0] op_sel_hi:[1,1,1]
    v_pk_fma_f32 v[10:11], v[176:177], v[154:155], v[10:11] op_sel:[1,0,0] op_sel_hi:[1,1,1]
    v_pk_fma_f32 v[12:13], v[180:181], v[156:157], v[12:13] op_sel:[1,0,0] op_sel_hi:[1,1,1]
    v_pk_fma_f32 v[14:15], v[180:181], v[158:159], v[14:15] op_sel:[1,0,0] op_sel_hi:[1,1,1]
    s_set_gpr_idx_idx s70
    v_pk_fma_f32 v[8:9], v[178:179], v[160:161], v[8:9] op_sel:[0,0,0] op_sel_hi:[0,1,1]
    v_pk_fma_f32 v[10:11], v[178:179], v[162:163], v[10:11] op_sel:[0,0,0] op_sel_hi:[0,1,1]
    v_pk_fma_f32 v[12:13], v[182:183], v[164:165], v[12:13] op_sel:[0,0,0] op_sel_hi:[0,1,1]
    v_pk_fma_f32 v[14:15], v[182:183], v[166:167], v[14:15] op_sel:[0,0,0] op_sel_hi:[0,1,1]
    s_set_gpr_idx_idx s71
    v_pk_fma_f32 v[8:9], v[178:179], v[168:169], v[8:9] op_sel:[1,0,0] op_sel_hi:[1,1,1]
    v_pk_fma_f32 v[10:11], v[178:179], v[170:171], v[10:11] op_sel:[1,0,0] op_sel_hi:[1,1,1]
    v_pk_fma_f32 v[12:13], v[182:183], v[172:173], v[12:13] op_sel:[1,0,0] op_sel_hi:[1,1,1]
    v_pk_fma_f32 v[14:15], v[182:183], v[174:175], v[14:15] op_sel:[1,0,0] op_sel_hi:[1,1,1]
    s_set_gpr_idx_off
    s_and_b32 s80, s76, s31
    s_and_b32 s81, s77, s31
    s_and_b32 s82, s78, s31
    s_and_b32 s83, s79, s31
    buffer_load_dwordx4 v[64:67], v232, s[4:7], s80 offen
    buffer_load_dwordx4 v[68:71], v232, s[4:7], s81 offen
    buffer_load_dwordx4 v[72:75], v232, s[4:7], s82 offen
    buffer_load_dwordx4 v[76:79], v232, s[4:7], s83 offen
    s_cmp_le_i32 s30, 24
    s_waitcnt lgkmcnt(0)
    s_cbranch_scc1 L_exit
    s_setprio 1
    v_mfma_f32_32x32x16_bf16 v[80:95], v[196:199], v[208:211], v[80:95]
    v_exp_f32 v176, v120
    v_exp_f32 v177, v121
    v_exp_f32 v178, v122
    v_exp_f32 v179, v123
    v_exp_f32 v180, v136
    v_exp_f32 v181, v137
    v_exp_f32 v182, v138
    v_exp_f32 v183, v139
    v_pk_fma_f32 v[176:177], v[176:177], s[56:57], s[56:57]
    v_pk_fma_f32 v[178:179], v[178:179], s[56:57], s[56:57]
    v_pk_fma_f32 v[180:181], v[180:181], s[56:57], s[56:57]
    v_pk_fma_f32 v[182:183], v[182:183], s[56:57], s[56:57]
    s_waitcnt vmcnt(4)
    v_mfma_f32_4x4x4_16b_bf16 v[144:147], v[186:187], v[48:49], 0 cbsz:4 abid:8
    v_rcp_f32 v176, v176
    v_mfma_f32_4x4x4_16b_bf16 v[148:151], v[186:187], v[50:51], 0 cbsz:4 abid:8
    v_rcp_f32 v177, v177
    v_mfma_f32_4x4x4_16b_bf16 v[152:155], v[186:187], v[52:53], 0 cbsz:4 abid:9
    v_rcp_f32 v178, v178
    v_mfma_f32_4x4x4_16b_bf16 v[156:159], v[186:187], v[54:55], 0 cbsz:4 abid:9
    v_rcp_f32 v179, v179
    v_mfma_f32_4x4x4_16b_bf16 v[160:163], v[186:187], v[56:57], 0 cbsz:4 abid:10
    v_rcp_f32 v180, v180
    v_mfma_f32_4x4x4_16b_bf16 v[164:167], v[186:187], v[58:59], 0 cbsz:4 abid:10
    v_rcp_f32 v181, v181
    v_mfma_f32_4x4x4_16b_bf16 v[168:171], v[186:187], v[60:61], 0 cbsz:4 abid:11
    v_rcp_f32 v182, v182
    v_mfma_f32_4x4x4_16b_bf16 v[172:175], v[186:187], v[62:63], 0 cbsz:4 abid:11
    v_rcp_f32 v183, v183
    v_readlane_b32 s64, v228, 2
    v_readlane_b32 s65, v228, 6
    v_readlane_b32 s66, v228, 10
    v_readlane_b32 s67, v228, 14
    v_and_or_b32 v229, v2, s33, v233
    v_pk_mul_f32 v[176:177], v[176:177], v[120:121]
    v_pk_mul_f32 v[178:179], v[178:179], v[122:123]
    v_pk_mul_f32 v[180:181], v[180:181], v[136:137]
    v_pk_mul_f32 v[182:183], v[182:183], v[138:139]
    s_set_gpr_idx_on s72, gpr_idx(SRC2,DST)
    v_pk_fma_f32 v[8:9], v[176:177], v[144:145], v[8:9] op_sel:[0,0,0] op_sel_hi:[0,1,1]
    v_pk_fma_f32 v[10:11], v[176:177], v[146:147], v[10:11] op_sel:[0,0,0] op_sel_hi:[0,1,1]
    v_pk_fma_f32 v[12:13], v[180:181], v[148:149], v[12:13] op_sel:[0,0,0] op_sel_hi:[0,1,1]
    v_pk_fma_f32 v[14:15], v[180:181], v[150:151], v[14:15] op_sel:[0,0,0] op_sel_hi:[0,1,1]
    s_set_gpr_idx_idx s73
    v_pk_fma_f32 v[8:9], v[176:177], v[152:153], v[8:9] op_sel:[1,0,0] op_sel_hi:[1,1,1]
    v_pk_fma_f32 v[10:11], v[176:177], v[154:155], v[10:11] op_sel:[1,0,0] op_sel_hi:[1,1,1]
    v_pk_fma_f32 v[12:13], v[180:181], v[156:157], v[12:13] op_sel:[1,0,0] op_sel_hi:[1,1,1]
    v_pk_fma_f32 v[14:15], v[180:181], v[158:159], v[14:15] op_sel:[1,0,0] op_sel_hi:[1,1,1]
    s_set_gpr_idx_idx s74
    v_pk_fma_f32 v[8:9], v[178:179], v[160:161], v[8:9] op_sel:[0,0,0] op_sel_hi:[0,1,1]
    v_pk_fma_f32 v[10:11], v[178:179], v[162:163], v[10:11] op_sel:[0,0,0] op_sel_hi:[0,1,1]
    v_pk_fma_f32 v[12:13], v[182:183], v[164:165], v[12:13] op_sel:[0,0,0] op_sel_hi:[0,1,1]
    v_pk_fma_f32 v[14:15], v[182:183], v[166:167], v[14:15] op_sel:[0,0,0] op_sel_hi:[0,1,1]
    s_set_gpr_idx_idx s75
    v_pk_fma_f32 v[8:9], v[178:179], v[168:169], v[8:9] op_sel:[1,0,0] op_sel_hi:[1,1,1]
    v_pk_fma_f32 v[10:11], v[178:179], v[170:171], v[10:11] op_sel:[1,0,0] op_sel_hi:[1,1,1]
    v_pk_fma_f32 v[12:13], v[182:183], v[172:173], v[12:13] op_sel:[1,0,0] op_sel_hi:[1,1,1]
    v_pk_fma_f32 v[14:15], v[182:183], v[174:175], v[14:15] op_sel:[1,0,0] op_sel_hi:[1,1,1]
    s_set_gpr_idx_off
    s_and_b32 s80, s64, s31
    s_and_b32 s81, s65, s31
    s_and_b32 s82, s66, s31
    s_and_b32 s83, s67, s31
    buffer_load_dwordx4 v[48:51], v232, s[4:7], s80 offen
    buffer_load_dwordx4 v[52:55], v232, s[4:7], s81 offen
    buffer_load_dwordx4 v[56:59], v232, s[4:7], s82 offen
    buffer_load_dwordx4 v[60:63], v232, s[4:7], s83 offen
    s_cmp_le_i32 s30, 28
    s_mov_b64 exec, s[20:21]
    ds_read_b128 v[192:195], v229 offset:46080
    s_mov_b64 exec, -1
    s_cbranch_scc1 L_exit
    s_setprio 0
    v_mfma_f32_32x32x16_bf16 v[96:111], v[196:199], v[212:215], v[96:111]
    v_exp_f32 v176, v124
    v_exp_f32 v177, v125
    v_exp_f32 v178, v126
    v_exp_f32 v179, v127
    v_exp_f32 v180, v140
    v_exp_f32 v181, v141
    v_exp_f32 v182, v142
    v_exp_f32 v183, v143
    v_pk_fma_f32 v[176:177], v[176:177], s[56:57], s[56:57]
    v_pk_fma_f32 v[178:179], v[178:179], s[56:57], s[56:57]
    v_pk_fma_f32 v[180:181], v[180:181], s[56:57], s[56:57]
    v_pk_fma_f32 v[182:183], v[182:183], s[56:57], s[56:57]
    s_waitcnt vmcnt(4)
    v_mfma_f32_4x4x4_16b_bf16 v[144:147], v[186:187], v[64:65], 0 cbsz:4 abid:12
    v_rcp_f32 v176, v176
    v_mfma_f32_4x4x4_16b_bf16 v[148:151], v[186:187], v[66:67], 0 cbsz:4 abid:12
    v_rcp_f32 v177, v177
    v_mfma_f32_4x4x4_16b_bf16 v[152:155], v[186:187], v[68:69], 0 cbsz:4 abid:13
    v_rcp_f32 v178, v178
    v_mfma_f32_4x4x4_16b_bf16 v[156:159], v[186:187], v[70:71], 0 cbsz:4 abid:13
    v_rcp_f32 v179, v179
    v_mfma_f32_4x4x4_16b_bf16 v[160:163], v[186:187], v[72:73], 0 cbsz:4 abid:14
    v_rcp_f32 v180, v180
    v_mfma_f32_4x4x4_16b_bf16 v[164:167], v[186:187], v[74:75], 0 cbsz:4 abid:14
    v_rcp_f32 v181, v181
    v_mfma_f32_4x4x4_16b_bf16 v[168:171], v[186:187], v[76:77], 0 cbsz:4 abid:15
    v_rcp_f32 v182, v182
    v_mfma_f32_4x4x4_16b_bf16 v[172:175], v[186:187], v[78:79], 0 cbsz:4 abid:15
    v_rcp_f32 v183, v183
    v_readlane_b32 s68, v228, 18
    v_readlane_b32 s69, v228, 22
    v_readlane_b32 s70, v228, 26
    v_readlane_b32 s71, v228, 30
    v_pk_mul_f32 v[176:177], v[176:177], v[124:125]
    v_pk_mul_f32 v[178:179], v[178:179], v[126:127]
    v_pk_mul_f32 v[180:181], v[180:181], v[140:141]
    v_pk_mul_f32 v[182:183], v[182:183], v[142:143]
    s_set_gpr_idx_on s76, gpr_idx(SRC2,DST)
    v_pk_fma_f32 v[8:9], v[176:177], v[144:145], v[8:9] op_sel:[0,0,0] op_sel_hi:[0,1,1]
    v_pk_fma_f32 v[10:11], v[176:177], v[146:147], v[10:11] op_sel:[0,0,0] op_sel_hi:[0,1,1]
    v_pk_fma_f32 v[12:13], v[180:181], v[148:149], v[12:13] op_sel:[0,0,0] op_sel_hi:[0,1,1]
    v_pk_fma_f32 v[14:15], v[180:181], v[150:151], v[14:15] op_sel:[0,0,0] op_sel_hi:[0,1,1]
    s_set_gpr_idx_idx s77
    v_pk_fma_f32 v[8:9], v[176:177], v[152:153], v[8:9] op_sel:[1,0,0] op_sel_hi:[1,1,1]
    v_pk_fma_f32 v[10:11], v[176:177], v[154:155], v[10:11] op_sel:[1,0,0] op_sel_hi:[1,1,1]
    v_pk_fma_f32 v[12:13], v[180:181], v[156:157], v[12:13] op_sel:[1,0,0] op_sel_hi:[1,1,1]
    v_pk_fma_f32 v[14:15], v[180:181], v[158:159], v[14:15] op_sel:[1,0,0] op_sel_hi:[1,1,1]
    s_set_gpr_idx_idx s78
    v_pk_fma_f32 v[8:9], v[178:179], v[160:161], v[8:9] op_sel:[0,0,0] op_sel_hi:[0,1,1]
    v_pk_fma_f32 v[10:11], v[178:179], v[162:163], v[10:11] op_sel:[0,0,0] op_sel_hi:[0,1,1]
    v_pk_fma_f32 v[12:13], v[182:183], v[164:165], v[12:13] op_sel:[0,0,0] op_sel_hi:[0,1,1]
    v_pk_fma_f32 v[14:15], v[182:183], v[166:167], v[14:15] op_sel:[0,0,0] op_sel_hi:[0,1,1]
    s_set_gpr_idx_idx s79
    v_pk_fma_f32 v[8:9], v[178:179], v[168:169], v[8:9] op_sel:[1,0,0] op_sel_hi:[1,1,1]
    v_pk_fma_f32 v[10:11], v[178:179], v[170:171], v[10:11] op_sel:[1,0,0] op_sel_hi:[1,1,1]
    v_pk_fma_f32 v[12:13], v[182:183], v[172:173], v[12:13] op_sel:[1,0,0] op_sel_hi:[1,1,1]
    v_pk_fma_f32 v[14:15], v[182:183], v[174:175], v[14:15] op_sel:[1,0,0] op_sel_hi:[1,1,1]
    s_set_gpr_idx_off
    s_and_b32 s80, s68, s31
    s_and_b32 s81, s69, s31
    s_and_b32 s82, s70, s31
    s_and_b32 s83, s71, s31
    buffer_load_dwordx4 v[64:67], v232, s[4:7], s80 offen
    buffer_load_dwordx4 v[68:71], v232, s[4:7], s81 offen
    buffer_load_dwordx4 v[72:75], v232, s[4:7], s82 offen
    buffer_load_dwordx4 v[76:79], v232, s[4:7], s83 offen
    s_cmp_le_i32 s30, 32
    s_waitcnt lgkmcnt(0)
    s_cbranch_scc1 L_exit
    s_setprio 3
    v_mfma_f32_32x32x16_bf16 v[112:127], v[192:195], v[200:203], 0
    v_exp_f32 v176, v80
    v_exp_f32 v177, v81
    v_exp_f32 v178, v82
    v_exp_f32 v179, v83
    v_exp_f32 v180, v96
    v_exp_f32 v181, v97
    v_exp_f32 v182, v98
    v_exp_f32 v183, v99
    v_pk_fma_f32 v[176:177], v[176:177], s[56:57], s[56:57]
    v_pk_fma_f32 v[178:179], v[178:179], s[56:57], s[56:57]
    v_pk_fma_f32 v[180:181], v[180:181], s[56:57], s[56:57]
    v_pk_fma_f32 v[182:183], v[182:183], s[56:57], s[56:57]
    s_waitcnt vmcnt(4)
    v_mfma_f32_4x4x4_16b_bf16 v[144:147], v[188:189], v[48:49], 0 cbsz:4 abid:0
    v_rcp_f32 v176, v176
    v_mfma_f32_4x4x4_16b_bf16 v[148:151], v[188:189], v[50:51], 0 cbsz:4 abid:0
    v_rcp_f32 v177, v177
    v_mfma_f32_4x4x4_16b_bf16 v[152:155], v[188:189], v[52:53], 0 cbsz:4 abid:1
    v_rcp_f32 v178, v178
    v_mfma_f32_4x4x4_16b_bf16 v[156:159], v[188:189], v[54:55], 0 cbsz:4 abid:1
    v_rcp_f32 v179, v179
    v_mfma_f32_4x4x4_16b_bf16 v[160:163], v[188:189], v[56:57], 0 cbsz:4 abid:2
    v_rcp_f32 v180, v180
    v_mfma_f32_4x4x4_16b_bf16 v[164:167], v[188:189], v[58:59], 0 cbsz:4 abid:2
    v_rcp_f32 v181, v181
    v_mfma_f32_4x4x4_16b_bf16 v[168:171], v[188:189], v[60:61], 0 cbsz:4 abid:3
    v_rcp_f32 v182, v182
    v_mfma_f32_4x4x4_16b_bf16 v[172:175], v[188:189], v[62:63], 0 cbsz:4 abid:3
    v_rcp_f32 v183, v183
    v_readlane_b32 s72, v228, 34
    v_readlane_b32 s73, v228, 38
    v_readlane_b32 s74, v228, 42
    v_readlane_b32 s75, v228, 46
    v_pk_mul_f32 v[176:177], v[176:177], v[80:81]
    v_pk_mul_f32 v[178:179], v[178:179], v[82:83]
    v_pk_mul_f32 v[180:181], v[180:181], v[96:97]
    v_pk_mul_f32 v[182:183], v[182:183], v[98:99]
    s_set_gpr_idx_on s64, gpr_idx(SRC2,DST)
    v_pk_fma_f32 v[8:9], v[176:177], v[144:145], v[8:9] op_sel:[0,0,0] op_sel_hi:[0,1,1]
    v_pk_fma_f32 v[10:11], v[176:177], v[146:147], v[10:11] op_sel:[0,0,0] op_sel_hi:[0,1,1]
    v_pk_fma_f32 v[12:13], v[180:181], v[148:149], v[12:13] op_sel:[0,0,0] op_sel_hi:[0,1,1]
    v_pk_fma_f32 v[14:15], v[180:181], v[150:151], v[14:15] op_sel:[0,0,0] op_sel_hi:[0,1,1]
    s_set_gpr_idx_idx s65
    v_pk_fma_f32 v[8:9], v[176:177], v[152:153], v[8:9] op_sel:[1,0,0] op_sel_hi:[1,1,1]
    v_pk_fma_f32 v[10:11], v[176:177], v[154:155], v[10:11] op_sel:[1,0,0] op_sel_hi:[1,1,1]
    v_pk_fma_f32 v[12:13], v[180:181], v[156:157], v[12:13] op_sel:[1,0,0] op_sel_hi:[1,1,1]
    v_pk_fma_f32 v[14:15], v[180:181], v[158:159], v[14:15] op_sel:[1,0,0] op_sel_hi:[1,1,1]
    s_set_gpr_idx_idx s66
    v_pk_fma_f32 v[8:9], v[178:179], v[160:161], v[8:9] op_sel:[0,0,0] op_sel_hi:[0,1,1]
    v_pk_fma_f32 v[10:11], v[178:179], v[162:163], v[10:11] op_sel:[0,0,0] op_sel_hi:[0,1,1]
    v_pk_fma_f32 v[12:13], v[182:183], v[164:165], v[12:13] op_sel:[0,0,0] op_sel_hi:[0,1,1]
    v_pk_fma_f32 v[14:15], v[182:183], v[166:167], v[14:15] op_sel:[0,0,0] op_sel_hi:[0,1,1]
    s_set_gpr_idx_idx s67
    v_pk_fma_f32 v[8:9], v[178:179], v[168:169], v[8:9] op_sel:[1,0,0] op_sel_hi:[1,1,1]
    v_pk_fma_f32 v[10:11], v[178:179], v[170:171], v[10:11] op_sel:[1,0,0] op_sel_hi:[1,1,1]
    v_pk_fma_f32 v[12:13], v[182:183], v[172:173], v[12:13] op_sel:[1,0,0] op_sel_hi:[1,1,1]
    v_pk_fma_f32 v[14:15], v[182:183], v[174:175], v[14:15] op_sel:[1,0,0] op_sel_hi:[1,1,1]
    s_set_gpr_idx_off
    s_and_b32 s80, s72, s31
    s_and_b32 s81, s73, s31
    s_and_b32 s82, s74, s31
    s_and_b32 s83, s75, s31
    buffer_load_dwordx4 v[48:51], v232, s[4:7], s80 offen
    buffer_load_dwordx4 v[52:55], v232, s[4:7], s81 offen
    buffer_load_dwordx4 v[56:59], v232, s[4:7], s82 offen
    buffer_load_dwordx4 v[60:63], v232, s[4:7], s83 offen
    s_cmp_le_i32 s30, 36
    s_mov_b64 exec, s[22:23]
    ds_read_b128 v[196:199], v229 offset:46080
    s_mov_b64 exec, -1
    ds_read_b32 v2, v231 offset:1036
    s_cbranch_scc1 L_exit
    s_setprio 2
    v_mfma_f32_32x32x16_bf16 v[128:143], v[192:195], v[204:207], 0
    v_exp_f32 v176, v84
    v_exp_f32 v177, v85
    v_exp_f32 v178, v86
    v_exp_f32 v179, v87
    v_exp_f32 v180, v100
    v_exp_f32 v181, v101
    v_exp_f32 v182, v102
    v_exp_f32 v183, v103
    v_pk_fma_f32 v[176:177], v[176:177], s[56:57], s[56:57]
    v_pk_fma_f32 v[178:179], v[178:179], s[56:57], s[56:57]
    v_pk_fma_f32 v[180:181], v[180:181], s[56:57], s[56:57]
    v_pk_fma_f32 v[182:183], v[182:183], s[56:57], s[56:57]
    s_waitcnt vmcnt(4)
    v_mfma_f32_4x4x4_16b_bf16 v[144:147], v[188:189], v[64:65], 0 cbsz:4 abid:4
    v_rcp_f32 v176, v176
    v_mfma_f32_4x4x4_16b_bf16 v[148:151], v[188:189], v[66:67], 0 cbsz:4 abid:4
    v_rcp_f32 v177, v177
    v_mfma_f32_4x4x4_16b_bf16 v[152:155], v[188:189], v[68:69], 0 cbsz:4 abid:5
    v_rcp_f32 v178, v178
    v_mfma_f32_4x4x4_16b_bf16 v[156:159], v[188:189], v[70:71], 0 cbsz:4 abid:5
    v_rcp_f32 v179, v179
    v_mfma_f32_4x4x4_16b_bf16 v[160:163], v[188:189], v[72:73], 0 cbsz:4 abid:6
    v_rcp_f32 v180, v180
    v_mfma_f32_4x4x4_16b_bf16 v[164:167], v[188:189], v[74:75], 0 cbsz:4 abid:6
    v_rcp_f32 v181, v181
    v_mfma_f32_4x4x4_16b_bf16 v[168:171], v[188:189], v[76:77], 0 cbsz:4 abid:7
    v_rcp_f32 v182, v182
    v_mfma_f32_4x4x4_16b_bf16 v[172:175], v[188:189], v[78:79], 0 cbsz:4 abid:7
    v_rcp_f32 v183, v183
    v_readlane_b32 s76, v228, 50
    v_readlane_b32 s77, v228, 54
    v_readlane_b32 s78, v228, 58
    v_readlane_b32 s79, v228, 62
    v_pk_mul_f32 v[176:177], v[176:177], v[84:85]
    v_pk_mul_f32 v[178:179], v[178:179], v[86:87]
    v_pk_mul_f32 v[180:181], v[180:181], v[100:101]
    v_pk_mul_f32 v[182:183], v[182:183], v[102:103]
    s_set_gpr_idx_on s68, gpr_idx(SRC2,DST)
    v_pk_fma_f32 v[8:9], v[176:177], v[144:145], v[8:9] op_sel:[0,0,0] op_sel_hi:[0,1,1]
    v_pk_fma_f32 v[10:11], v[176:177], v[146:147], v[10:11] op_sel:[0,0,0] op_sel_hi:[0,1,1]
    v_pk_fma_f32 v[12:13], v[180:181], v[148:149], v[12:13] op_sel:[0,0,0] op_sel_hi:[0,1,1]
    v_pk_fma_f32 v[14:15], v[180:181], v[150:151], v[14:15] op_sel:[0,0,0] op_sel_hi:[0,1,1]
    s_set_gpr_idx_idx s69
    v_pk_fma_f32 v[8:9], v[176:177], v[152:153], v[8:9] op_sel:[1,0,0] op_sel_hi:[1,1,1]
    v_pk_fma_f32 v[10:11], v[176:177], v[154:155], v[10:11] op_sel:[1,0,0] op_sel_hi:[1,1,1]
    v_pk_fma_f32 v[12:13], v[180:181], v[156:157], v[12:13] op_sel:[1,0,0] op_sel_hi:[1,1,1]
    v_pk_fma_f32 v[14:15], v[180:181], v[158:159], v[14:15] op_sel:[1,0,0] op_sel_hi:[1,1,1]
    s_set_gpr_idx_idx s70
    v_pk_fma_f32 v[8:9], v[178:179], v[160:161], v[8:9] op_sel:[0,0,0] op_sel_hi:[0,1,1]
    v_pk_fma_f32 v[10:11], v[178:179], v[162:163], v[10:11] op_sel:[0,0,0] op_sel_hi:[0,1,1]
    v_pk_fma_f32 v[12:13], v[182:183], v[164:165], v[12:13] op_sel:[0,0,0] op_sel_hi:[0,1,1]
    v_pk_fma_f32 v[14:15], v[182:183], v[166:167], v[14:15] op_sel:[0,0,0] op_sel_hi:[0,1,1]
    s_set_gpr_idx_idx s71
    v_pk_fma_f32 v[8:9], v[178:179], v[168:169], v[8:9] op_sel:[1,0,0] op_sel_hi:[1,1,1]
    v_pk_fma_f32 v[10:11], v[178:179], v[170:171], v[10:11] op_sel:[1,0,0] op_sel_hi:[1,1,1]
    v_pk_fma_f32 v[12:13], v[182:183], v[172:173], v[12:13] op_sel:[1,0,0] op_sel_hi:[1,1,1]
    v_pk_fma_f32 v[14:15], v[182:183], v[174:175], v[14:15] op_sel:[1,0,0] op_sel_hi:[1,1,1]
    s_set_gpr_idx_off
    s_and_b32 s80, s76, s31
    s_and_b32 s81, s77, s31
    s_and_b32 s82, s78, s31
    s_and_b32 s83, s79, s31
    buffer_load_dwordx4 v[64:67], v232, s[4:7], s80 offen
    buffer_load_dwordx4 v[68:71], v232, s[4:7], s81 offen
    buffer_load_dwordx4 v[72:75], v232, s[4:7], s82 offen
    buffer_load_dwordx4 v[76:79], v232, s[4:7], s83 offen
    s_cmp_le_i32 s30, 40
    s_waitcnt lgkmcnt(0)
    s_cbranch_scc1 L_exit
    s_setprio 1
    v_mfma_f32_32x32x16_bf16 v[112:127], v[196:199], v[208:211], v[112:127]
    v_exp_f32 v176, v88
    v_exp_f32 v177, v89
    v_exp_f32 v178, v90
    v_exp_f32 v179, v91
    v_exp_f32 v180, v104
    v_exp_f32 v181, v105
    v_exp_f32 v182, v106
    v_exp_f32 v183, v107
    v_pk_fma_f32 v[176:177], v[176:177], s[56:57], s[56:57]
    v_pk_fma_f32 v[178:179], v[178:179], s[56:57], s[56:57]
    v_pk_fma_f32 v[180:181], v[180:181], s[56:57], s[56:57]
    v_pk_fma_f32 v[182:183], v[182:183], s[56:57], s[56:57]
    s_waitcnt vmcnt(4)
    v_mfma_f32_4x4x4_16b_bf16 v[144:147], v[188:189], v[48:49], 0 cbsz:4 abid:8
    v_rcp_f32 v176, v176
    v_mfma_f32_4x4x4_16b_bf16 v[148:151], v[188:189], v[50:51], 0 cbsz:4 abid:8
    v_rcp_f32 v177, v177
    v_mfma_f32_4x4x4_16b_bf16 v[152:155], v[188:189], v[52:53], 0 cbsz:4 abid:9
    v_rcp_f32 v178, v178
    v_mfma_f32_4x4x4_16b_bf16 v[156:159], v[188:189], v[54:55], 0 cbsz:4 abid:9
    v_rcp_f32 v179, v179
    v_mfma_f32_4x4x4_16b_bf16 v[160:163], v[188:189], v[56:57], 0 cbsz:4 abid:10
    v_rcp_f32 v180, v180
    v_mfma_f32_4x4x4_16b_bf16 v[164:167], v[188:189], v[58:59], 0 cbsz:4 abid:10
    v_rcp_f32 v181, v181
    v_mfma_f32_4x4x4_16b_bf16 v[168:171], v[188:189], v[60:61], 0 cbsz:4 abid:11
    v_rcp_f32 v182, v182
    v_mfma_f32_4x4x4_16b_bf16 v[172:175], v[188:189], v[62:63], 0 cbsz:4 abid:11
    v_rcp_f32 v183, v183
    v_readlane_b32 s64, v228, 3
    v_readlane_b32 s65, v228, 7
    v_readlane_b32 s66, v228, 11
    v_readlane_b32 s67, v228, 15
    v_and_or_b32 v229, v2, s33, v233
    v_pk_mul_f32 v[176:177], v[176:177], v[88:89]
    v_pk_mul_f32 v[178:179], v[178:179], v[90:91]
    v_pk_mul_f32 v[180:181], v[180:181], v[104:105]
    v_pk_mul_f32 v[182:183], v[182:183], v[106:107]
    s_set_gpr_idx_on s72, gpr_idx(SRC2,DST)
    v_pk_fma_f32 v[8:9], v[176:177], v[144:145], v[8:9] op_sel:[0,0,0] op_sel_hi:[0,1,1]
    v_pk_fma_f32 v[10:11], v[176:177], v[146:147], v[10:11] op_sel:[0,0,0] op_sel_hi:[0,1,1]
    v_pk_fma_f32 v[12:13], v[180:181], v[148:149], v[12:13] op_sel:[0,0,0] op_sel_hi:[0,1,1]
    v_pk_fma_f32 v[14:15], v[180:181], v[150:151], v[14:15] op_sel:[0,0,0] op_sel_hi:[0,1,1]
    s_set_gpr_idx_idx s73
    v_pk_fma_f32 v[8:9], v[176:177], v[152:153], v[8:9] op_sel:[1,0,0] op_sel_hi:[1,1,1]
    v_pk_fma_f32 v[10:11], v[176:177], v[154:155], v[10:11] op_sel:[1,0,0] op_sel_hi:[1,1,1]
    v_pk_fma_f32 v[12:13], v[180:181], v[156:157], v[12:13] op_sel:[1,0,0] op_sel_hi:[1,1,1]
    v_pk_fma_f32 v[14:15], v[180:181], v[158:159], v[14:15] op_sel:[1,0,0] op_sel_hi:[1,1,1]
    s_set_gpr_idx_idx s74
    v_pk_fma_f32 v[8:9], v[178:179], v[160:161], v[8:9] op_sel:[0,0,0] op_sel_hi:[0,1,1]
    v_pk_fma_f32 v[10:11], v[178:179], v[162:163], v[10:11] op_sel:[0,0,0] op_sel_hi:[0,1,1]
    v_pk_fma_f32 v[12:13], v[182:183], v[164:165], v[12:13] op_sel:[0,0,0] op_sel_hi:[0,1,1]
    v_pk_fma_f32 v[14:15], v[182:183], v[166:167], v[14:15] op_sel:[0,0,0] op_sel_hi:[0,1,1]
    s_set_gpr_idx_idx s75
    v_pk_fma_f32 v[8:9], v[178:179], v[168:169], v[8:9] op_sel:[1,0,0] op_sel_hi:[1,1,1]
    v_pk_fma_f32 v[10:11], v[178:179], v[170:171], v[10:11] op_sel:[1,0,0] op_sel_hi:[1,1,1]
    v_pk_fma_f32 v[12:13], v[182:183], v[172:173], v[12:13] op_sel:[1,0,0] op_sel_hi:[1,1,1]
    v_pk_fma_f32 v[14:15], v[182:183], v[174:175], v[14:15] op_sel:[1,0,0] op_sel_hi:[1,1,1]
    s_set_gpr_idx_off
    s_and_b32 s80, s64, s31
    s_and_b32 s81, s65, s31
    s_and_b32 s82, s66, s31
    s_and_b32 s83, s67, s31
    buffer_load_dwordx4 v[48:51], v232, s[4:7], s80 offen
    buffer_load_dwordx4 v[52:55], v232, s[4:7], s81 offen
    buffer_load_dwordx4 v[56:59], v232, s[4:7], s82 offen
    buffer_load_dwordx4 v[60:63], v232, s[4:7], s83 offen
    s_cmp_le_i32 s30, 44
    s_mov_b64 exec, s[20:21]
    ds_read_b128 v[192:195], v229 offset:46080
    s_mov_b64 exec, -1
    s_cbranch_scc1 L_exit
    s_setprio 0
    v_mfma_f32_32x32x16_bf16 v[128:143], v[196:199], v[212:215], v[128:143]
    v_exp_f32 v176, v92
    v_exp_f32 v177, v93
    v_exp_f32 v178, v94
    v_exp_f32 v179, v95
    v_exp_f32 v180, v108
    v_exp_f32 v181, v109
    v_exp_f32 v182, v110
    v_exp_f32 v183, v111
    v_pk_fma_f32 v[176:177], v[176:177], s[56:57], s[56:57]
    v_pk_fma_f32 v[178:179], v[178:179], s[56:57], s[56:57]
    v_pk_fma_f32 v[180:181], v[180:181], s[56:57], s[56:57]
    v_pk_fma_f32 v[182:183], v[182:183], s[56:57], s[56:57]
    s_waitcnt vmcnt(4)
    v_mfma_f32_4x4x4_16b_bf16 v[144:147], v[188:189], v[64:65], 0 cbsz:4 abid:12
    v_rcp_f32 v176, v176
    v_mfma_f32_4x4x4_16b_bf16 v[148:151], v[188:189], v[66:67], 0 cbsz:4 abid:12
    v_rcp_f32 v177, v177
    v_mfma_f32_4x4x4_16b_bf16 v[152:155], v[188:189], v[68:69], 0 cbsz:4 abid:13
    v_rcp_f32 v178, v178
    v_mfma_f32_4x4x4_16b_bf16 v[156:159], v[188:189], v[70:71], 0 cbsz:4 abid:13
    v_rcp_f32 v179, v179
    v_mfma_f32_4x4x4_16b_bf16 v[160:163], v[188:189], v[72:73], 0 cbsz:4 abid:14
    v_rcp_f32 v180, v180
    v_mfma_f32_4x4x4_16b_bf16 v[164:167], v[188:189], v[74:75], 0 cbsz:4 abid:14
    v_rcp_f32 v181, v181
    v_mfma_f32_4x4x4_16b_bf16 v[168:171], v[188:189], v[76:77], 0 cbsz:4 abid:15
    v_rcp_f32 v182, v182
    v_mfma_f32_4x4x4_16b_bf16 v[172:175], v[188:189], v[78:79], 0 cbsz:4 abid:15
    v_rcp_f32 v183, v183
    v_readlane_b32 s68, v228, 19
    v_readlane_b32 s69, v228, 23
    v_readlane_b32 s70, v228, 27
    v_readlane_b32 s71, v228, 31
    v_pk_mul_f32 v[176:177], v[176:177], v[92:93]
    v_pk_mul_f32 v[178:179], v[178:179], v[94:95]
    v_pk_mul_f32 v[180:181], v[180:181], v[108:109]
    v_pk_mul_f32 v[182:183], v[182:183], v[110:111]
    s_set_gpr_idx_on s76, gpr_idx(SRC2,DST)
    v_pk_fma_f32 v[8:9], v[176:177], v[144:145], v[8:9] op_sel:[0,0,0] op_sel_hi:[0,1,1]
    v_pk_fma_f32 v[10:11], v[176:177], v[146:147], v[10:11] op_sel:[0,0,0] op_sel_hi:[0,1,1]
    v_pk_fma_f32 v[12:13], v[180:181], v[148:149], v[12:13] op_sel:[0,0,0] op_sel_hi:[0,1,1]
    v_pk_fma_f32 v[14:15], v[180:181], v[150:151], v[14:15] op_sel:[0,0,0] op_sel_hi:[0,1,1]
    s_set_gpr_idx_idx s77
    v_pk_fma_f32 v[8:9], v[176:177], v[152:153], v[8:9] op_sel:[1,0,0] op_sel_hi:[1,1,1]
    v_pk_fma_f32 v[10:11], v[176:177], v[154:155], v[10:11] op_sel:[1,0,0] op_sel_hi:[1,1,1]
    v_pk_fma_f32 v[12:13], v[180:181], v[156:157], v[12:13] op_sel:[1,0,0] op_sel_hi:[1,1,1]
    v_pk_fma_f32 v[14:15], v[180:181], v[158:159], v[14:15] op_sel:[1,0,0] op_sel_hi:[1,1,1]
    s_set_gpr_idx_idx s78
    v_pk_fma_f32 v[8:9], v[178:179], v[160:161], v[8:9] op_sel:[0,0,0] op_sel_hi:[0,1,1]
    v_pk_fma_f32 v[10:11], v[178:179], v[162:163], v[10:11] op_sel:[0,0,0] op_sel_hi:[0,1,1]
    v_pk_fma_f32 v[12:13], v[182:183], v[164:165], v[12:13] op_sel:[0,0,0] op_sel_hi:[0,1,1]
    v_pk_fma_f32 v[14:15], v[182:183], v[166:167], v[14:15] op_sel:[0,0,0] op_sel_hi:[0,1,1]
    s_set_gpr_idx_idx s79
    v_pk_fma_f32 v[8:9], v[178:179], v[168:169], v[8:9] op_sel:[1,0,0] op_sel_hi:[1,1,1]
    v_pk_fma_f32 v[10:11], v[178:179], v[170:171], v[10:11] op_sel:[1,0,0] op_sel_hi:[1,1,1]
    v_pk_fma_f32 v[12:13], v[182:183], v[172:173], v[12:13] op_sel:[1,0,0] op_sel_hi:[1,1,1]
    v_pk_fma_f32 v[14:15], v[182:183], v[174:175], v[14:15] op_sel:[1,0,0] op_sel_hi:[1,1,1]
    s_set_gpr_idx_off
    s_and_b32 s80, s68, s31
    s_and_b32 s81, s69, s31
    s_and_b32 s82, s70, s31
    s_and_b32 s83, s71, s31
    buffer_load_dwordx4 v[64:67], v232, s[4:7], s80 offen
    buffer_load_dwordx4 v[68:71], v232, s[4:7], s81 offen
    buffer_load_dwordx4 v[72:75], v232, s[4:7], s82 offen
    buffer_load_dwordx4 v[76:79], v232, s[4:7], s83 offen
    s_cmp_le_i32 s30, 48
    s_waitcnt lgkmcnt(0)
    s_cbranch_scc1 L_exit
    s_setprio 3
    v_mfma_f32_32x32x16_bf16 v[80:95], v[192:195], v[200:203], 0
    v_exp_f32 v176, v112
    v_exp_f32 v177, v113
    v_exp_f32 v178, v114
    v_exp_f32 v179, v115
    v_exp_f32 v180, v128
    v_exp_f32 v181, v129
    v_exp_f32 v182, v130
    v_exp_f32 v183, v131
    v_pk_fma_f32 v[176:177], v[176:177], s[56:57], s[56:57]
    v_pk_fma_f32 v[178:179], v[178:179], s[56:57], s[56:57]
    v_pk_fma_f32 v[180:181], v[180:181], s[56:57], s[56:57]
    v_pk_fma_f32 v[182:183], v[182:183], s[56:57], s[56:57]
    s_waitcnt vmcnt(4)
    v_mfma_f32_4x4x4_16b_bf16 v[144:147], v[190:191], v[48:49], 0 cbsz:4 abid:0
    v_rcp_f32 v176, v176
    v_mfma_f32_4x4x4_16b_bf16 v[148:151], v[190:191], v[50:51], 0 cbsz:4 abid:0
    v_rcp_f32 v177, v177
    v_mfma_f32_4x4x4_16b_bf16 v[152:155], v[190:191], v[52:53], 0 cbsz:4 abid:1
    v_rcp_f32 v178, v178
    v_mfma_f32_4x4x4_16b_bf16 v[156:159], v[190:191], v[54:55], 0 cbsz:4 abid:1
    v_rcp_f32 v179, v179
    v_mfma_f32_4x4x4_16b_bf16 v[160:163], v[190:191], v[56:57], 0 cbsz:4 abid:2
    v_rcp_f32 v180, v180
    v_mfma_f32_4x4x4_16b_bf16 v[164:167], v[190:191], v[58:59], 0 cbsz:4 abid:2
    v_rcp_f32 v181, v181
    v_mfma_f32_4x4x4_16b_bf16 v[168:171], v[190:191], v[60:61], 0 cbsz:4 abid:3
    v_rcp_f32 v182, v182
    v_mfma_f32_4x4x4_16b_bf16 v[172:175], v[190:191], v[62:63], 0 cbsz:4 abid:3
    v_rcp_f32 v183, v183
    v_readlane_b32 s72, v228, 35
    v_readlane_b32 s73, v228, 39
    v_readlane_b32 s74, v228, 43
    v_readlane_b32 s75, v228, 47
    v_pk_mul_f32 v[176:177], v[176:177], v[112:113]
    v_pk_mul_f32 v[178:179], v[178:179], v[114:115]
    v_pk_mul_f32 v[180:181], v[180:181], v[128:129]
    v_pk_mul_f32 v[182:183], v[182:183], v[130:131]
    s_set_gpr_idx_on s64, gpr_idx(SRC2,DST)
    v_pk_fma_f32 v[8:9], v[176:177], v[144:145], v[8:9] op_sel:[0,0,0] op_sel_hi:[0,1,1]
    v_pk_fma_f32 v[10:11], v[176:177], v[146:147], v[10:11] op_sel:[0,0,0] op_sel_hi:[0,1,1]
    v_pk_fma_f32 v[12:13], v[180:181], v[148:149], v[12:13] op_sel:[0,0,0] op_sel_hi:[0,1,1]
    v_pk_fma_f32 v[14:15], v[180:181], v[150:151], v[14:15] op_sel:[0,0,0] op_sel_hi:[0,1,1]
    s_set_gpr_idx_idx s65
    v_pk_fma_f32 v[8:9], v[176:177], v[152:153], v[8:9] op_sel:[1,0,0] op_sel_hi:[1,1,1]
    v_pk_fma_f32 v[10:11], v[176:177], v[154:155], v[10:11] op_sel:[1,0,0] op_sel_hi:[1,1,1]
    v_pk_fma_f32 v[12:13], v[180:181], v[156:157], v[12:13] op_sel:[1,0,0] op_sel_hi:[1,1,1]
    v_pk_fma_f32 v[14:15], v[180:181], v[158:159], v[14:15] op_sel:[1,0,0] op_sel_hi:[1,1,1]
    s_set_gpr_idx_idx s66
    v_pk_fma_f32 v[8:9], v[178:179], v[160:161], v[8:9] op_sel:[0,0,0] op_sel_hi:[0,1,1]
    v_pk_fma_f32 v[10:11], v[178:179], v[162:163], v[10:11] op_sel:[0,0,0] op_sel_hi:[0,1,1]
    v_pk_fma_f32 v[12:13], v[182:183], v[164:165], v[12:13] op_sel:[0,0,0] op_sel_hi:[0,1,1]
    v_pk_fma_f32 v[14:15], v[182:183], v[166:167], v[14:15] op_sel:[0,0,0] op_sel_hi:[0,1,1]
    s_set_gpr_idx_idx s67
    v_pk_fma_f32 v[8:9], v[178:179], v[168:169], v[8:9] op_sel:[1,0,0] op_sel_hi:[1,1,1]
    v_pk_fma_f32 v[10:11], v[178:179], v[170:171], v[10:11] op_sel:[1,0,0] op_sel_hi:[1,1,1]
    v_pk_fma_f32 v[12:13], v[182:183], v[172:173], v[12:13] op_sel:[1,0,0] op_sel_hi:[1,1,1]
    v_pk_fma_f32 v[14:15], v[182:183], v[174:175], v[14:15] op_sel:[1,0,0] op_sel_hi:[1,1,1]
    s_set_gpr_idx_off
    s_and_b32 s80, s72, s31
    s_and_b32 s81, s73, s31
    s_and_b32 s82, s74, s31
    s_and_b32 s83, s75, s31
    buffer_load_dwordx4 v[48:51], v232, s[4:7], s80 offen
    buffer_load_dwordx4 v[52:55], v232, s[4:7], s81 offen
    buffer_load_dwordx4 v[56:59], v232, s[4:7], s82 offen
    buffer_load_dwordx4 v[60:63], v232, s[4:7], s83 offen
    s_cmp_le_i32 s30, 52
    s_mov_b64 exec, s[22:23]
    ds_read_b128 v[196:199], v229 offset:46080
    s_mov_b64 exec, -1
    ds_read_b32 v2, v231 offset:1292
    s_cbranch_scc1 L_exit
    s_setprio 2
    v_mfma_f32_32x32x16_bf16 v[96:111], v[192:195], v[204:207], 0
    v_exp_f32 v176, v116
    v_exp_f32 v177, v117
    v_exp_f32 v178, v118
    v_exp_f32 v179, v119
    v_exp_f32 v180, v132
    v_exp_f32 v181, v133
    v_exp_f32 v182, v134
    v_exp_f32 v183, v135
    v_pk_fma_f32 v[176:177], v[176:177], s[56:57], s[56:57]
    v_pk_fma_f32 v[178:179], v[178:179], s[56:57], s[56:57]
    v_pk_fma_f32 v[180:181], v[180:181], s[56:57], s[56:57]
    v_pk_fma_f32 v[182:183], v[182:183], s[56:57], s[56:57]
    s_waitcnt vmcnt(4)
    v_mfma_f32_4x4x4_16b_bf16 v[144:147], v[190:191], v[64:65], 0 cbsz:4 abid:4
    v_rcp_f32 v176, v176
    v_mfma_f32_4x4x4_16b_bf16 v[148:151], v[190:191], v[66:67], 0 cbsz:4 abid:4
    v_rcp_f32 v177, v177
    v_mfma_f32_4x4x4_16b_bf16 v[152:155], v[190:191], v[68:69], 0 cbsz:4 abid:5
    v_rcp_f32 v178, v178
    v_mfma_f32_4x4x4_16b_bf16 v[156:159], v[190:191], v[70:71], 0 cbsz:4 abid:5
    v_rcp_f32 v179, v179
    v_mfma_f32_4x4x4_16b_bf16 v[160:163], v[190:191], v[72:73], 0 cbsz:4 abid:6
    v_rcp_f32 v180, v180
    v_mfma_f32_4x4x4_16b_bf16 v[164:167], v[190:191], v[74:75], 0 cbsz:4 abid:6
    v_rcp_f32 v181, v181
    v_mfma_f32_4x4x4_16b_bf16 v[168:171], v[190:191], v[76:77], 0 cbsz:4 abid:7
    v_rcp_f32 v182, v182
    v_mfma_f32_4x4x4_16b_bf16 v[172:175], v[190:191], v[78:79], 0 cbsz:4 abid:7
    v_rcp_f32 v183, v183
    v_readlane_b32 s76, v228, 51
    v_readlane_b32 s77, v228, 55
    v_readlane_b32 s78, v228, 59
    v_readlane_b32 s79, v228, 63
    v_pk_mul_f32 v[176:177], v[176:177], v[116:117]
    v_pk_mul_f32 v[178:179], v[178:179], v[118:119]
    v_pk_mul_f32 v[180:181], v[180:181], v[132:133]
    v_pk_mul_f32 v[182:183], v[182:183], v[134:135]
    s_set_gpr_idx_on s68, gpr_idx(SRC2,DST)
    v_pk_fma_f32 v[8:9], v[176:177], v[144:145], v[8:9] op_sel:[0,0,0] op_sel_hi:[0,1,1]
    v_pk_fma_f32 v[10:11], v[176:177], v[146:147], v[10:11] op_sel:[0,0,0] op_sel_hi:[0,1,1]
    v_pk_fma_f32 v[12:13], v[180:181], v[148:149], v[12:13] op_sel:[0,0,0] op_sel_hi:[0,1,1]
    v_pk_fma_f32 v[14:15], v[180:181], v[150:151], v[14:15] op_sel:[0,0,0] op_sel_hi:[0,1,1]
    s_set_gpr_idx_idx s69
    v_pk_fma_f32 v[8:9], v[176:177], v[152:153], v[8:9] op_sel:[1,0,0] op_sel_hi:[1,1,1]
    v_pk_fma_f32 v[10:11], v[176:177], v[154:155], v[10:11] op_sel:[1,0,0] op_sel_hi:[1,1,1]
    v_pk_fma_f32 v[12:13], v[180:181], v[156:157], v[12:13] op_sel:[1,0,0] op_sel_hi:[1,1,1]
    v_pk_fma_f32 v[14:15], v[180:181], v[158:159], v[14:15] op_sel:[1,0,0] op_sel_hi:[1,1,1]
    s_set_gpr_idx_idx s70
    v_pk_fma_f32 v[8:9], v[178:179], v[160:161], v[8:9] op_sel:[0,0,0] op_sel_hi:[0,1,1]
    v_pk_fma_f32 v[10:11], v[178:179], v[162:163], v[10:11] op_sel:[0,0,0] op_sel_hi:[0,1,1]
    v_pk_fma_f32 v[12:13], v[182:183], v[164:165], v[12:13] op_sel:[0,0,0] op_sel_hi:[0,1,1]
    v_pk_fma_f32 v[14:15], v[182:183], v[166:167], v[14:15] op_sel:[0,0,0] op_sel_hi:[0,1,1]
    s_set_gpr_idx_idx s71
    v_pk_fma_f32 v[8:9], v[178:179], v[168:169], v[8:9] op_sel:[1,0,0] op_sel_hi:[1,1,1]
    v_pk_fma_f32 v[10:11], v[178:179], v[170:171], v[10:11] op_sel:[1,0,0] op_sel_hi:[1,1,1]
    v_pk_fma_f32 v[12:13], v[182:183], v[172:173], v[12:13] op_sel:[1,0,0] op_sel_hi:[1,1,1]
    v_pk_fma_f32 v[14:15], v[182:183], v[174:175], v[14:15] op_sel:[1,0,0] op_sel_hi:[1,1,1]
    s_set_gpr_idx_off
    s_and_b32 s80, s76, s31
    s_and_b32 s81, s77, s31
    s_and_b32 s82, s78, s31
    s_and_b32 s83, s79, s31
    buffer_load_dwordx4 v[64:67], v232, s[4:7], s80 offen
    buffer_load_dwordx4 v[68:71], v232, s[4:7], s81 offen
    buffer_load_dwordx4 v[72:75], v232, s[4:7], s82 offen
    buffer_load_dwordx4 v[76:79], v232, s[4:7], s83 offen
    s_cmp_le_i32 s30, 56
    s_waitcnt lgkmcnt(0)
    s_cbranch_scc1 L_exit
    s_setprio 1
    v_cndmask_b32 v228, v4, v226, s[34:35]
    v_mfma_f32_32x32x16_bf16 v[80:95], v[196:199], v[208:211], v[80:95]
    v_exp_f32 v176, v120
    v_exp_f32 v177, v121
    v_exp_f32 v178, v122
    v_exp_f32 v179, v123
    v_exp_f32 v180, v136
    v_exp_f32 v181, v137
    v_exp_f32 v182, v138
    v_exp_f32 v183, v139
    v_pk_fma_f32 v[176:177], v[176:177], s[56:57], s[56:57]
    v_pk_fma_f32 v[178:179], v[178:179], s[56:57], s[56:57]
    v_pk_fma_f32 v[180:181], v[180:181], s[56:57], s[56:57]
    v_pk_fma_f32 v[182:183], v[182:183], s[56:57], s[56:57]
    s_waitcnt vmcnt(4)
    v_mfma_f32_4x4x4_16b_bf16 v[144:147], v[190:191], v[48:49], 0 cbsz:4 abid:8
    v_rcp_f32 v176, v176
    v_mfma_f32_4x4x4_16b_bf16 v[148:151], v[190:191], v[50:51], 0 cbsz:4 abid:8
    v_rcp_f32 v177, v177
    v_mfma_f32_4x4x4_16b_bf16 v[152:155], v[190:191], v[52:53], 0 cbsz:4 abid:9
    v_rcp_f32 v178, v178
    v_mfma_f32_4x4x4_16b_bf16 v[156:159], v[190:191], v[54:55], 0 cbsz:4 abid:9
    v_rcp_f32 v179, v179
    v_mfma_f32_4x4x4_16b_bf16 v[160:163], v[190:191], v[56:57], 0 cbsz:4 abid:10
    v_rcp_f32 v180, v180
    v_mfma_f32_4x4x4_16b_bf16 v[164:167], v[190:191], v[58:59], 0 cbsz:4 abid:10
    v_rcp_f32 v181, v181
    v_mfma_f32_4x4x4_16b_bf16 v[168:171], v[190:191], v[60:61], 0 cbsz:4 abid:11
    v_rcp_f32 v182, v182
    v_mfma_f32_4x4x4_16b_bf16 v[172:175], v[190:191], v[62:63], 0 cbsz:4 abid:11
    v_rcp_f32 v183, v183
    v_readlane_b32 s64, v228, 0
    v_readlane_b32 s65, v228, 4
    v_readlane_b32 s66, v228, 8
    v_readlane_b32 s67, v228, 12
    v_and_or_b32 v229, v2, s33, v233
    v_pk_mul_f32 v[176:177], v[176:177], v[120:121]
    v_pk_mul_f32 v[178:179], v[178:179], v[122:123]
    v_pk_mul_f32 v[180:181], v[180:181], v[136:137]
    v_pk_mul_f32 v[182:183], v[182:183], v[138:139]
    s_set_gpr_idx_on s72, gpr_idx(SRC2,DST)
    v_pk_fma_f32 v[8:9], v[176:177], v[144:145], v[8:9] op_sel:[0,0,0] op_sel_hi:[0,1,1]
    v_pk_fma_f32 v[10:11], v[176:177], v[146:147], v[10:11] op_sel:[0,0,0] op_sel_hi:[0,1,1]
    v_pk_fma_f32 v[12:13], v[180:181], v[148:149], v[12:13] op_sel:[0,0,0] op_sel_hi:[0,1,1]
    v_pk_fma_f32 v[14:15], v[180:181], v[150:151], v[14:15] op_sel:[0,0,0] op_sel_hi:[0,1,1]
    s_set_gpr_idx_idx s73
    v_pk_fma_f32 v[8:9], v[176:177], v[152:153], v[8:9] op_sel:[1,0,0] op_sel_hi:[1,1,1]
    v_pk_fma_f32 v[10:11], v[176:177], v[154:155], v[10:11] op_sel:[1,0,0] op_sel_hi:[1,1,1]
    v_pk_fma_f32 v[12:13], v[180:181], v[156:157], v[12:13] op_sel:[1,0,0] op_sel_hi:[1,1,1]
    v_pk_fma_f32 v[14:15], v[180:181], v[158:159], v[14:15] op_sel:[1,0,0] op_sel_hi:[1,1,1]
    s_set_gpr_idx_idx s74
    v_pk_fma_f32 v[8:9], v[178:179], v[160:161], v[8:9] op_sel:[0,0,0] op_sel_hi:[0,1,1]
    v_pk_fma_f32 v[10:11], v[178:179], v[162:163], v[10:11] op_sel:[0,0,0] op_sel_hi:[0,1,1]
    v_pk_fma_f32 v[12:13], v[182:183], v[164:165], v[12:13] op_sel:[0,0,0] op_sel_hi:[0,1,1]
    v_pk_fma_f32 v[14:15], v[182:183], v[166:167], v[14:15] op_sel:[0,0,0] op_sel_hi:[0,1,1]
    s_set_gpr_idx_idx s75
    v_pk_fma_f32 v[8:9], v[178:179], v[168:169], v[8:9] op_sel:[1,0,0] op_sel_hi:[1,1,1]
    v_pk_fma_f32 v[10:11], v[178:179], v[170:171], v[10:11] op_sel:[1,0,0] op_sel_hi:[1,1,1]
    v_pk_fma_f32 v[12:13], v[182:183], v[172:173], v[12:13] op_sel:[1,0,0] op_sel_hi:[1,1,1]
    v_pk_fma_f32 v[14:15], v[182:183], v[174:175], v[14:15] op_sel:[1,0,0] op_sel_hi:[1,1,1]
    s_set_gpr_idx_off
    s_and_b32 s80, s64, s31
    s_and_b32 s81, s65, s31
    s_and_b32 s82, s66, s31
    s_and_b32 s83, s67, s31
    buffer_load_dwordx4 v[48:51], v232, s[4:7], s80 offen
    buffer_load_dwordx4 v[52:55], v232, s[4:7], s81 offen
    buffer_load_dwordx4 v[56:59], v232, s[4:7], s82 offen
    buffer_load_dwordx4 v[60:63], v232, s[4:7], s83 offen
    s_cmp_le_i32 s30, 60
    s_mov_b64 exec, s[20:21]
    ds_read_b128 v[192:195], v229 offset:46080
    s_mov_b64 exec, -1
    s_cbranch_scc1 L_exit
    s_setprio 0
    v_mfma_f32_32x32x16_bf16 v[96:111], v[196:199], v[212:215], v[96:111]
    v_exp_f32 v176, v124
    v_exp_f32 v177, v125
    v_exp_f32 v178, v126
    v_exp_f32 v179, v127
    v_exp_f32 v180, v140
    v_exp_f32 v181, v141
    v_exp_f32 v182, v142
    v_exp_f32 v183, v143
    v_pk_fma_f32 v[176:177], v[176:177], s[56:57], s[56:57]
    v_pk_fma_f32 v[178:179], v[178:179], s[56:57], s[56:57]
    v_pk_fma_f32 v[180:181], v[180:181], s[56:57], s[56:57]
    v_pk_fma_f32 v[182:183], v[182:183], s[56:57], s[56:57]
    s_waitcnt vmcnt(4)
    v_mfma_f32_4x4x4_16b_bf16 v[144:147], v[190:191], v[64:65], 0 cbsz:4 abid:12
    v_rcp_f32 v176, v176
    v_mfma_f32_4x4x4_16b_bf16 v[148:151], v[190:191], v[66:67], 0 cbsz:4 abid:12
    v_rcp_f32 v177, v177
    v_mfma_f32_4x4x4_16b_bf16 v[152:155], v[190:191], v[68:69], 0 cbsz:4 abid:13
    v_rcp_f32 v178, v178
    v_mfma_f32_4x4x4_16b_bf16 v[156:159], v[190:191], v[70:71], 0 cbsz:4 abid:13
    v_rcp_f32 v179, v179
    v_mfma_f32_4x4x4_16b_bf16 v[160:163], v[190:191], v[72:73], 0 cbsz:4 abid:14
    v_rcp_f32 v180, v180
    v_mfma_f32_4x4x4_16b_bf16 v[164:167], v[190:191], v[74:75], 0 cbsz:4 abid:14
    v_rcp_f32 v181, v181
    v_mfma_f32_4x4x4_16b_bf16 v[168:171], v[190:191], v[76:77], 0 cbsz:4 abid:15
    v_rcp_f32 v182, v182
    v_mfma_f32_4x4x4_16b_bf16 v[172:175], v[190:191], v[78:79], 0 cbsz:4 abid:15
    v_rcp_f32 v183, v183
    v_readlane_b32 s68, v228, 16
    v_readlane_b32 s69, v228, 20
    v_readlane_b32 s70, v228, 24
    v_readlane_b32 s71, v228, 28
    v_pk_mul_f32 v[176:177], v[176:177], v[124:125]
    v_pk_mul_f32 v[178:179], v[178:179], v[126:127]
    v_pk_mul_f32 v[180:181], v[180:181], v[140:141]
    v_pk_mul_f32 v[182:183], v[182:183], v[142:143]
    s_set_gpr_idx_on s76, gpr_idx(SRC2,DST)
    v_pk_fma_f32 v[8:9], v[176:177], v[144:145], v[8:9] op_sel:[0,0,0] op_sel_hi:[0,1,1]
    v_pk_fma_f32 v[10:11], v[176:177], v[146:147], v[10:11] op_sel:[0,0,0] op_sel_hi:[0,1,1]
    v_pk_fma_f32 v[12:13], v[180:181], v[148:149], v[12:13] op_sel:[0,0,0] op_sel_hi:[0,1,1]
    v_pk_fma_f32 v[14:15], v[180:181], v[150:151], v[14:15] op_sel:[0,0,0] op_sel_hi:[0,1,1]
    s_set_gpr_idx_idx s77
    v_pk_fma_f32 v[8:9], v[176:177], v[152:153], v[8:9] op_sel:[1,0,0] op_sel_hi:[1,1,1]
    v_pk_fma_f32 v[10:11], v[176:177], v[154:155], v[10:11] op_sel:[1,0,0] op_sel_hi:[1,1,1]
    v_pk_fma_f32 v[12:13], v[180:181], v[156:157], v[12:13] op_sel:[1,0,0] op_sel_hi:[1,1,1]
    v_pk_fma_f32 v[14:15], v[180:181], v[158:159], v[14:15] op_sel:[1,0,0] op_sel_hi:[1,1,1]
    s_set_gpr_idx_idx s78
    v_pk_fma_f32 v[8:9], v[178:179], v[160:161], v[8:9] op_sel:[0,0,0] op_sel_hi:[0,1,1]
    v_pk_fma_f32 v[10:11], v[178:179], v[162:163], v[10:11] op_sel:[0,0,0] op_sel_hi:[0,1,1]
    v_pk_fma_f32 v[12:13], v[182:183], v[164:165], v[12:13] op_sel:[0,0,0] op_sel_hi:[0,1,1]
    v_pk_fma_f32 v[14:15], v[182:183], v[166:167], v[14:15] op_sel:[0,0,0] op_sel_hi:[0,1,1]
    s_set_gpr_idx_idx s79
    v_pk_fma_f32 v[8:9], v[178:179], v[168:169], v[8:9] op_sel:[1,0,0] op_sel_hi:[1,1,1]
    v_pk_fma_f32 v[10:11], v[178:179], v[170:171], v[10:11] op_sel:[1,0,0] op_sel_hi:[1,1,1]
    v_pk_fma_f32 v[12:13], v[182:183], v[172:173], v[12:13] op_sel:[1,0,0] op_sel_hi:[1,1,1]
    v_pk_fma_f32 v[14:15], v[182:183], v[174:175], v[14:15] op_sel:[1,0,0] op_sel_hi:[1,1,1]
    s_set_gpr_idx_off
    s_and_b32 s80, s68, s31
    s_and_b32 s81, s69, s31
    s_and_b32 s82, s70, s31
    s_and_b32 s83, s71, s31
    buffer_load_dwordx4 v[64:67], v232, s[4:7], s80 offen
    buffer_load_dwordx4 v[68:71], v232, s[4:7], s81 offen
    buffer_load_dwordx4 v[72:75], v232, s[4:7], s82 offen
    buffer_load_dwordx4 v[76:79], v232, s[4:7], s83 offen
    s_waitcnt lgkmcnt(0)
    v_add_u32 v231, 1024, v231
    s_sub_u32 s30, s30, 64
    s_branch L_sb
L_exit:
    s_setprio 0
    s_add_u32 s24, s24, 216
    s_cmp_lt_u32 s24, s25
    s_cbranch_scc0 L_epi
    v_lshlrev_b32 v7, 3, v0
    v_mov_b32 v2, 0
    v_mov_b32 v3, 0
    ds_write_b64 v7, v[2:3]
    s_waitcnt vmcnt(0) lgkmcnt(0)
    s_nop 15
    s_mul_i32 s26, s16, 5
    v_add_u32 v113, s26, v1
    v_subrev_u32 v3, 40, v113
    v_min_u32 v113, v113, v3
    v_mul_u32_u24 v3, 205, v1
    v_lshrrev_b32 v3, 10, v3
    v_mul_u32_u24 v2, 5, v3
    v_sub_u32 v115, v1, v2
    v_lshlrev_b32 v114, 2, v3
    s_lshl_b32 s81, s16, 10
    s_add_u32 s81, s81, 8192
    s_mul_i32 s80, s16, 6912
    v_lshl_add_u32 v121, v1, 2, s81
    v_lshrrev_b32 v3, 1, v1
    v_lshl_add_u32 v122, v3, 2, s81
    v_and_b32 v2, 1, v1
    v_lshlrev_b32 v123, 4, v2
    v_lshrrev_b32 v3, 1, v0
    v_mul_u32_u24 v3, 1280, v3
    v_add_u32 v124, v3, v2
    v_mul_u32_u24 v125, 48, v113
    s_lshl_b32 s26, s16, 2
    v_lshl_add_u32 v126, v115, 5, s26
    v_lshl_add_u32 v127, v1, 5, s80
    s_lshr_b32 s26, s2, 6
    s_mul_i32 s26, s26, 65
    s_sub_u32 s26, s2, s26
    s_lshl3_add_u32 s26, s26, s16
    s_cmp_eq_u32 s26, 7
    s_cselect_b32 s82, 0, 1
    v_mov_b32 v80, 0xffffff
    v_mov_b32 v81, 0xffffff
    v_mov_b32 v82, 0xffffff
    v_mov_b32 v83, 0xffffff
    v_add_u32 v2, s81, v232
    ds_write_b128 v2, v[80:83]
    s_barrier
    v_and_b32 v2, 1, v0
    v_max_u32 v3, s24, v235
    v_add_u32 v3, v3, v2
    s_add_u32 s27, s24, 216
    v_min_u32 v4, s27, v236
    v_add_u32 v5, v237, v3
    s_lshl_b32 s27, s24, 2
    s_sub_u32 s27, s81, s27
    v_lshl_add_u32 v6, v3, 2, s27
    v_sub_u32 v4, v4, v3
    s_branch L_exp
L_exp_more:
    v_add_u32 v6, 48, v6
    v_subrev_u32 v4, 12, v4
    s_branch L_exp
L_epi:
    s_waitcnt lgkmcnt(0)
    v_readfirstlane_b32 s38, v243
    v_lshlrev_b32 v2, 2, v1
    v_add_u32 v3, s48, v2
    v_cvt_pk_bf16_f32 v8, v8, v12
    v_cvt_pk_bf16_f32 v9, v9, v13
    v_cvt_pk_bf16_f32 v10, v10, v14
    v_cvt_pk_bf16_f32 v11, v11, v15
    ds_write2_b32 v3, v8, v9 offset0:0 offset1:72
    ds_write2_b32 v3, v10, v11 offset0:144 offset1:216
    v_add_u32 v3, s49, v2
    v_cvt_pk_bf16_f32 v16, v16, v20
    v_cvt_pk_bf16_f32 v17, v17, v21
    v_cvt_pk_bf16_f32 v18, v18, v22
    v_cvt_pk_bf16_f32 v19, v19, v23
    ds_write2_b32 v3, v16, v17 offset0:0 offset1:72
    ds_write2_b32 v3, v18, v19 offset0:144 offset1:216
    v_add_u32 v3, s50, v2
    v_cvt_pk_bf16_f32 v24, v24, v28
    v_cvt_pk_bf16_f32 v25, v25, v29
    v_cvt_pk_bf16_f32 v26, v26, v30
    v_cvt_pk_bf16_f32 v27, v27, v31
    ds_write2_b32 v3, v24, v25 offset0:0 offset1:72
    ds_write2_b32 v3, v26, v27 offset0:144 offset1:216
    v_add_u32 v3, s51, v2
    v_cvt_pk_bf16_f32 v32, v32, v36
    v_cvt_pk_bf16_f32 v33, v33, v37
    v_cvt_pk_bf16_f32 v34, v34, v38
    v_cvt_pk_bf16_f32 v35, v35, v39
    ds_write2_b32 v3, v32, v33 offset0:0 offset1:72
    ds_write2_b32 v3, v34, v35 offset0:144 offset1:216
    v_add_u32 v3, s52, v2
    v_cvt_pk_bf16_f32 v40, v40, v44
    v_cvt_pk_bf16_f32 v41, v41, v45
    v_cvt_pk_bf16_f32 v42, v42, v46
    v_cvt_pk_bf16_f32 v43, v43, v47
    ds_write2_b32 v3, v40, v41 offset0:0 offset1:72
    ds_write2_b32 v3, v42, v43 offset0:144 offset1:216
    s_cmp_eq_u32 s38, 8
    s_cbranch_scc0 L_nob
    ds_read_b128 v[192:195], v240 offset:0
    ds_read_b128 v[208:211], v240 offset:256
    ds_read_b128 v[196:199], v240 offset:8192
    ds_read_b128 v[212:215], v240 offset:8448
    ds_read_b128 v[200:203], v240 offset:16384
    ds_read_b128 v[216:219], v240 offset:16640
    ds_read_b128 v[204:207], v240 offset:24576
    ds_read_b128 v[220:223], v240 offset:24832
    s_waitcnt lgkmcnt(8)
    s_barrier
    s_branch L_haveb
L_nob:
    s_waitcnt lgkmcnt(0)
    s_barrier
    ds_read_b128 v[192:195], v240 offset:0
    ds_read_b128 v[208:211], v240 offset:256
    ds_read_b128 v[196:199], v240 offset:8192
    ds_read_b128 v[212:215], v240 offset:8448
    ds_read_b128 v[200:203], v240 offset:16384
    ds_read_b128 v[216:219], v240 offset:16640
    ds_read_b128 v[204:207], v240 offset:24576
    ds_read_b128 v[220:223], v240 offset:24832
L_haveb:
    ds_read_b128 v[80:83], v241 offset:0
    ds_read_b128 v[84:87], v241 offset:64
    ds_read_b128 v[88:91], v241 offset:128
    ds_read_b128 v[92:95], v241 offset:192
    ds_read_b128 v[96:99], v241 offset:4608
    ds_read_b128 v[100:103], v241 offset:4672
    ds_read_b128 v[104:107], v241 offset:4736
    ds_read_b128 v[108:111], v241 offset:4800
    ds_read_b128 v[112:115], v241 offset:9216
    ds_read_b128 v[116:119], v241 offset:9280
    ds_read_b128 v[120:123], v241 offset:9344
    ds_read_b128 v[124:127], v241 offset:9408
    s_waitcnt lgkmcnt(11)
    v_mfma_f32_16x16x32_bf16 v[8:11], v[80:83], v[192:195], 0
    v_mfma_f32_16x16x32_bf16 v[12:15], v[80:83], v[208:211], 0
    ds_read_b128 v[128:131], v241 offset:13824
    ds_read_b128 v[132:135], v241 offset:13888
    ds_read_b128 v[136:139], v241 offset:13952
    ds_read_b128 v[140:143], v241 offset:14016
    s_waitcnt lgkmcnt(14)
    v_mfma_f32_16x16x32_bf16 v[8:11], v[84:87], v[196:199], v[8:11]
    v_mfma_f32_16x16x32_bf16 v[12:15], v[84:87], v[212:215], v[12:15]
    s_waitcnt lgkmcnt(13)
    v_mfma_f32_16x16x32_bf16 v[8:11], v[88:91], v[200:203], v[8:11]
    v_mfma_f32_16x16x32_bf16 v[12:15], v[88:91], v[216:219], v[12:15]
    s_waitcnt lgkmcnt(12)
    v_mfma_f32_16x16x32_bf16 v[8:11], v[92:95], v[204:207], v[8:11]
    v_mfma_f32_16x16x32_bf16 v[12:15], v[92:95], v[220:223], v[12:15]
    s_waitcnt lgkmcnt(11)
    v_mfma_f32_16x16x32_bf16 v[16:19], v[96:99], v[192:195], 0
    v_mfma_f32_16x16x32_bf16 v[20:23], v[96:99], v[208:211], 0
    ds_read_b128 v[144:147], v241 offset:18432
    ds_read_b128 v[148:151], v241 offset:18496
    ds_read_b128 v[152:155], v241 offset:18560
    ds_read_b128 v[156:159], v241 offset:18624
    s_waitcnt lgkmcnt(14)
    v_mfma_f32_16x16x32_bf16 v[16:19], v[100:103], v[196:199], v[16:19]
    v_mfma_f32_16x16x32_bf16 v[20:23], v[100:103], v[212:215], v[20:23]
    s_waitcnt lgkmcnt(13)
    v_mfma_f32_16x16x32_bf16 v[16:19], v[104:107], v[200:203], v[16:19]
    v_mfma_f32_16x16x32_bf16 v[20:23], v[104:107], v[216:219], v[20:23]
    v_cvt_pk_bf16_f32 v160, v8, v9
    v_cvt_pk_bf16_f32 v161, v10, v11
    v_cvt_pk_bf16_f32 v162, v12, v13
    v_cvt_pk_bf16_f32 v163, v14, v15
    buffer_store_dwordx4 v[160:163], v242, s[12:15], 0 offen sc1
    v_add_u32 v242, 1048576, v242
    s_waitcnt lgkmcnt(12)
    v_mfma_f32_16x16x32_bf16 v[16:19], v[108:111], v[204:207], v[16:19]
    v_mfma_f32_16x16x32_bf16 v[20:23], v[108:111], v[220:223], v[20:23]
    s_waitcnt lgkmcnt(11)
    v_mfma_f32_16x16x32_bf16 v[24:27], v[112:115], v[192:195], 0
    v_mfma_f32_16x16x32_bf16 v[28:31], v[112:115], v[208:211], 0
    s_waitcnt lgkmcnt(10)
    v_mfma_f32_16x16x32_bf16 v[24:27], v[116:119], v[196:199], v[24:27]
    v_mfma_f32_16x16x32_bf16 v[28:31], v[116:119], v[212:215], v[28:31]
    s_waitcnt lgkmcnt(9)
    v_mfma_f32_16x16x32_bf16 v[24:27], v[120:123], v[200:203], v[24:27]
    v_mfma_f32_16x16x32_bf16 v[28:31], v[120:123], v[216:219], v[28:31]
    v_cvt_pk_bf16_f32 v164, v16, v17
    v_cvt_pk_bf16_f32 v165, v18, v19
    v_cvt_pk_bf16_f32 v166, v20, v21
    v_cvt_pk_bf16_f32 v167, v22, v23
    buffer_store_dwordx4 v[164:167], v242, s[12:15], 0 offen sc1
    v_add_u32 v242, 1048576, v242
    s_waitcnt lgkmcnt(8)
    v_mfma_f32_16x16x32_bf16 v[24:27], v[124:127], v[204:207], v[24:27]
    v_mfma_f32_16x16x32_bf16 v[28:31], v[124:127], v[220:223], v[28:31]
    s_waitcnt lgkmcnt(7)
    v_mfma_f32_16x16x32_bf16 v[32:35], v[128:131], v[192:195], 0
    v_mfma_f32_16x16x32_bf16 v[36:39], v[128:131], v[208:211], 0
    s_waitcnt lgkmcnt(6)
    v_mfma_f32_16x16x32_bf16 v[32:35], v[132:135], v[196:199], v[32:35]
    v_mfma_f32_16x16x32_bf16 v[36:39], v[132:135], v[212:215], v[36:39]
    s_waitcnt lgkmcnt(5)
    v_mfma_f32_16x16x32_bf16 v[32:35], v[136:139], v[200:203], v[32:35]
    v_mfma_f32_16x16x32_bf16 v[36:39], v[136:139], v[216:219], v[36:39]
    v_cvt_pk_bf16_f32 v168, v24, v25
    v_cvt_pk_bf16_f32 v169, v26, v27
    v_cvt_pk_bf16_f32 v170, v28, v29
    v_cvt_pk_bf16_f32 v171, v30, v31
    buffer_store_dwordx4 v[168:171], v242, s[12:15], 0 offen sc1
    v_add_u32 v242, 1048576, v242
    s_waitcnt lgkmcnt(4)
    v_mfma_f32_16x16x32_bf16 v[32:35], v[140:143], v[204:207], v[32:35]
    v_mfma_f32_16x16x32_bf16 v[36:39], v[140:143], v[220:223], v[36:39]
    s_waitcnt lgkmcnt(3)
    v_mfma_f32_16x16x32_bf16 v[40:43], v[144:147], v[192:195], 0
    v_mfma_f32_16x16x32_bf16 v[44:47], v[144:147], v[208:211], 0
    s_waitcnt lgkmcnt(2)
    v_mfma_f32_16x16x32_bf16 v[40:43], v[148:151], v[196:199], v[40:43]
    v_mfma_f32_16x16x32_bf16 v[44:47], v[148:151], v[212:215], v[44:47]
    s_waitcnt lgkmcnt(1)
    v_mfma_f32_16x16x32_bf16 v[40:43], v[152:155], v[200:203], v[40:43]
    v_mfma_f32_16x16x32_bf16 v[44:47], v[152:155], v[216:219], v[44:47]
    v_cvt_pk_bf16_f32 v172, v32, v33
    v_cvt_pk_bf16_f32 v173, v34, v35
    v_cvt_pk_bf16_f32 v174, v36, v37
    v_cvt_pk_bf16_f32 v175, v38, v39
    buffer_store_dwordx4 v[172:175], v242, s[12:15], 0 offen sc1
    v_add_u32 v242, 1048576, v242
    s_waitcnt lgkmcnt(0)
    v_mfma_f32_16x16x32_bf16 v[40:43], v[156:159], v[204:207], v[40:43]
    v_mfma_f32_16x16x32_bf16 v[44:47], v[156:159], v[220:223], v[44:47]
    s_nop 7
    v_cvt_pk_bf16_f32 v160, v40, v41
    v_cvt_pk_bf16_f32 v161, v42, v43
    v_cvt_pk_bf16_f32 v162, v44, v45
    v_cvt_pk_bf16_f32 v163, v46, v47
    buffer_store_dwordx4 v[160:163], v242, s[12:15], 0 offen sc1
    s_cmp_eq_u32 s53, 0
    s_cbranch_scc0 L_fin
    v_mov_b32 v144, 0
    v_mov_b32 v145, 1
    s_mov_b64 exec, 1
    buffer_store_dword v145, v144, s[44:47], 0 offen sc1
    s_mov_b64 exec, -1
L_fin:
L_end:
    s_endpgm
.section .rodata,"a"
.p2align 6
.amdhsa_kernel standalone__tensor_product_equiv_tfn__graph_kernel
.amdhsa_next_free_vgpr 245
.amdhsa_next_free_sgpr 100
.amdhsa_accum_offset 248
.amdhsa_group_segment_fixed_size 0
.amdhsa_kernarg_size 88
.amdhsa_user_sgpr_count 2
.amdhsa_user_sgpr_kernarg_segment_ptr 1
.amdhsa_system_sgpr_workgroup_id_x 1
.amdhsa_float_denorm_mode_32 3
.end_amdhsa_kernel
```

```asm
; @launch grid=(256,1,1) block=(512,1,1) lds=161808
.amdgcn_target "amdgcn-amd-amdhsa--gfx950"
.text
.globl standalone__tensor_product_equiv_tfn__graph_kernel
.p2align 8
.type standalone__tensor_product_equiv_tfn__graph_kernel,@function
standalone__tensor_product_equiv_tfn__graph_kernel:
    s_cmp_ge_u32 s2, 256
    s_cbranch_scc1 L_end
    s_load_dwordx16 s[36:51], s[0:1], 0
    s_load_dwordx2 s[52:53], s[0:1], 64
    s_load_dwordx2 s[56:57], s[0:1], 80
    v_lshrrev_b32 v2, 6, v0
    v_and_b32 v1, 63, v0
    v_readfirstlane_b32 s16, v2
    s_and_b32 s17, s2, 7
    s_lshl_b32 s17, s17, 5
    s_lshr_b32 s26, s2, 3
    s_or_b32 s17, s17, s26
    v_lshlrev_b32 v7, 3, v0
    v_mov_b32 v2, 0
    v_mov_b32 v3, 0
    v_mov_b32 v4, 161792
    ds_write_b64 v7, v[2:3]
    ds_write_b32 v4, v2
    v_lshlrev_b32 v232, 4, v1
    s_mul_i32 s26, s16, 160
    v_add_u32 v6, s26, v1
    v_lshlrev_b32 v53, 2, v6
    v_lshlrev_b32 v54, 3, v6
    s_mul_i32 s26, s16, 1920
    v_add_u32 v55, s26, v232
    s_mul_i32 s26, s16, 5120
    v_add_u32 v56, s26, v232
    s_cmp_lt_u32 s16, 7
    s_cselect_b32 s60, -1, 3
    s_mov_b32 s61, 0
    s_cselect_b64 s[62:63], -1, 15
    s_cselect_b32 s34, -1, 0xff
    s_cselect_b32 s35, 0xffffff, s34
    s_mul_i32 s58, s17, 5000
    s_mul_i32 s59, s17, 10000
    s_lshl_b32 s29, s17, 6
    s_add_u32 s29, s29, 14417920
    s_waitcnt lgkmcnt(0)
    s_mov_b32 s64, s40
    s_mov_b32 s65, s41
    s_mov_b32 s66, 1280000
    s_mov_b32 s67, 0x00020000
    buffer_load_dword v144, v53, s[64:67], s58 offen offset:0
    buffer_load_dword v145, v53, s[64:67], s58 offen offset:256
    s_mov_b64 exec, s[60:61]
    buffer_load_dword v146, v53, s[64:67], s58 offen offset:512
    s_mov_b64 exec, -1
    s_getpc_b64 s[82:83]
L_pc:
    s_lshr_b32 s80, s2, 3
    s_lshl_b32 s80, s80, 3
    s_add_u32 s80, s80, s16
    s_lshl_b32 s81, s80, 6
    s_min_u32 s81, s81, L_end-L_pc
    s_load_dword s3, s[82:83], s81
    s_lshl_b32 s81, s80, 7
    s_load_dword s3, s[50:51], s81
    s_add_u32 s81, s81, 64
    s_load_dword s3, s[50:51], s81
    s_mov_b32 s68, s38
    s_mov_b32 s69, s39
    s_mov_b32 s70, 1280000
    s_mov_b32 s71, 0x00020000
    buffer_load_dword v147, v53, s[68:71], s58 offen offset:0
    buffer_load_dword v148, v53, s[68:71], s58 offen offset:256
    s_mov_b64 exec, s[60:61]
    buffer_load_dword v149, v53, s[68:71], s58 offen offset:512
    s_mov_b64 exec, -1
    s_mov_b32 s72, s42
    s_mov_b32 s73, s43
    s_mov_b32 s74, 2560000
    s_mov_b32 s75, 0x00020000
    buffer_load_dwordx2 v[152:153], v54, s[72:75], s59 offen offset:0
    buffer_load_dwordx2 v[156:157], v54, s[72:75], s59 offen offset:512
    s_mov_b64 exec, s[60:61]
    buffer_load_dwordx2 v[160:161], v54, s[72:75], s59 offen offset:1024
    s_mov_b64 exec, -1
    s_mov_b32 s8, s56
    s_mov_b32 s9, s57
    s_mov_b32 s10, 16777216
    s_mov_b32 s11, 0x00020000
    s_mov_b32 s76, s44
    s_mov_b32 s77, s45
    s_mov_b32 s78, 10240000
    s_mov_b32 s79, 0x00020000
    s_barrier
    s_add_u32 m0, s26, 61440
    s_mul_i32 s58, s17, 40000
    buffer_load_dwordx4 v56, s[76:79], s58 offen offset:0  lds
    buffer_load_dwordx4 v56, s[76:79], s58 offen offset:1024  lds
    buffer_load_dwordx4 v56, s[76:79], s58 offen offset:2048  lds
    buffer_load_dwordx4 v56, s[76:79], s58 offen offset:3072  lds
    s_add_u32 m0, s26, 65536
    s_add_u32 s58, s58, 4096
    s_mov_b64 exec, s[62:63]
    buffer_load_dwordx4 v56, s[76:79], s58 offen  lds
    s_mov_b64 exec, -1
    v_mov_b32 v6, 1
    v_lshrrev_b32 v7, 2, v1
    v_mul_u32_u24 v7, 16320, v7
    v_add_u32 v245, v7, v232
    s_cmp_eq_u32 s16, 7
    s_cselect_b32 s59, s29, 0x40000000
    v_add_u32 v7, s59, v245
    buffer_load_dwordx4 v[64:67], v7, s[8:11], 0 offen sc1
    s_waitcnt vmcnt(12)
    v_bfe_u32 v2, v144, 3, 5
    v_and_b32 v3, 7, v144
    v_lshl_or_b32 v2, v3, 5, v2
    v_lshlrev_b32 v167, 2, v2
    ds_add_rtn_u32 v164, v167, v6 offset:3072
    v_bfe_u32 v2, v145, 3, 5
    v_and_b32 v3, 7, v145
    v_lshl_or_b32 v2, v3, 5, v2
    v_lshlrev_b32 v168, 2, v2
    ds_add_rtn_u32 v165, v168, v6 offset:3072
    s_mov_b64 exec, s[60:61]
    v_bfe_u32 v2, v146, 3, 5
    v_and_b32 v3, 7, v146
    v_lshl_or_b32 v2, v3, 5, v2
    v_lshlrev_b32 v169, 2, v2
    ds_add_rtn_u32 v166, v169, v6 offset:3072
    s_mov_b64 exec, -1
    s_movk_i32 s27, 5033
    s_waitcnt vmcnt(9)
    s_movk_i32 s59, -1250
    v_lshrrev_b32 v3, 7, v167
    v_mad_i32_i24 v2, v3, s59, v147
    v_add_u32 v3, 10000, v2
    v_min_u32 v2, v2, v3
    v_mul_u32_u24 v2, s27, v2
    v_lshrrev_b32 v2, 22, v2
    v_lshrrev_b32 v3, 8, v144
    v_mad_u32_u24 v2, v3, 12, v2
    v_lshl_or_b32 v154, v147, 10, v2
    v_lshrrev_b32 v3, 7, v168
    v_mad_i32_i24 v2, v3, s59, v148
    v_add_u32 v3, 10000, v2
    v_min_u32 v2, v2, v3
    v_mul_u32_u24 v2, s27, v2
    v_lshrrev_b32 v2, 22, v2
    v_lshrrev_b32 v3, 8, v145
    v_mad_u32_u24 v2, v3, 12, v2
    v_lshl_or_b32 v158, v148, 10, v2
    v_lshrrev_b32 v3, 7, v169
    v_mad_i32_i24 v2, v3, s59, v149
    v_add_u32 v3, 10000, v2
    v_min_u32 v2, v2, v3
    v_mul_u32_u24 v2, s27, v2
    v_lshrrev_b32 v2, 22, v2
    v_lshrrev_b32 v3, 8, v146
    v_mad_u32_u24 v2, v3, 12, v2
    v_lshl_or_b32 v162, v149, 10, v2
    s_waitcnt lgkmcnt(0)
    s_barrier
    ds_read_b128 v[172:175], v232 offset:3072
    s_waitcnt lgkmcnt(0)
    v_add_u32 v50, v172, v173
    v_add_u32 v51, v50, v174
    v_add_u32 v2, v51, v175
    v_mov_b32 v3, v2
    v_lshlrev_b32 v4, 2, v54
    v_lshrrev_b32 v5, 1, v0
    v_add_u32_dpp v3, v3, v3 row_shr:1 row_mask:0xf bank_mask:0xf
    s_lshr_b32 s59, s17, 4
    s_mul_i32 s59, s59, 16320
    v_add_u32_dpp v3, v3, v3 row_shr:2 row_mask:0xf bank_mask:0xf
    s_lshl2_add_u32 s59, s17, s59
    s_add_u32 s59, s59, 14417920
    v_add_u32_dpp v3, v3, v3 row_shr:4 row_mask:0xf bank_mask:0xf
    v_lshl_add_u32 v58, v5, 6, s59
    s_nop 0
    v_add_u32_dpp v3, v3, v3 row_shr:8 row_mask:0xf bank_mask:0xf
    s_nop 1
    v_add_u32_dpp v3, v3, v3 row_bcast:15 row_mask:0xa bank_mask:0xf
    s_nop 1
    v_add_u32_dpp v3, v3, v3 row_bcast:31 row_mask:0xc bank_mask:0xf
    v_sub_u32 v48, v3, v2
    v_add_u32 v49, v48, v172
    v_add_u32 v50, v48, v50
    v_add_u32 v51, v48, v51
    ds_write_b128 v232, v[48:51] offset:10752
    ds_read_b32 v167, v167 offset:10752
    ds_read_b32 v168, v168 offset:10752
    s_mov_b64 exec, s[60:61]
    ds_read_b32 v169, v169 offset:10752
    s_mov_b64 exec, -1
    v_lshl_or_b32 v60, v172, 16, v48
    v_lshl_or_b32 v61, v173, 16, v49
    v_lshl_or_b32 v62, v174, 16, v50
    v_lshl_or_b32 v63, v175, 16, v51
    s_mov_b32 s27, 46080
    s_waitcnt vmcnt(6) lgkmcnt(0)
    v_add_lshl_u32 v2, v167, v164, 1
    v_add_u32 v3, 0, v4
    ds_write_b16 v2, v3 offset:8192
    v_mad_u32_u24 v2, v2, 6, s27
    ds_write2_b32 v2, v152, v153 offset0:0 offset1:1
    ds_write_b32 v2, v154 offset:8
    v_add_lshl_u32 v2, v168, v165, 1
    v_add_u32 v3, 2048, v4
    ds_write_b16 v2, v3 offset:8192
    v_mad_u32_u24 v2, v2, 6, s27
    ds_write2_b32 v2, v156, v157 offset0:0 offset1:1
    ds_write_b32 v2, v158 offset:8
    s_mov_b64 exec, s[60:61]
    v_add_lshl_u32 v2, v169, v166, 1
    v_add_u32 v3, 4096, v4
    ds_write_b16 v2, v3 offset:8192
    v_mad_u32_u24 v2, v2, 6, s27
    ds_write2_b32 v2, v160, v161 offset0:0 offset1:1
    ds_write_b32 v2, v162 offset:8
    s_mov_b64 exec, -1
    v_lshrrev_b32 v2, 4, v56
    v_and_b32 v2, 0xffe, v2
    v_and_b32 v5, 1, v1
    v_lshlrev_b32 v5, 4, v5
    s_waitcnt lgkmcnt(0)
    s_barrier
    buffer_load_dword v59, v58, s[8:11], 0 offen sc1
    s_mov_b32 s68, s46
    s_mov_b32 s69, s47
    s_mov_b32 s70, 4096
    s_mov_b32 s71, 0x00020000
    s_mov_b32 s64, s48
    s_mov_b32 s65, s49
    s_mov_b32 s66, 128
    s_mov_b32 s67, 0x00020000
    v_lshlrev_b32 v7, 1, v1
    s_lshl_b32 s58, s16, 9
    s_add_u32 m0, s58, 16384
    s_mov_b32 exec_hi, 0
    buffer_load_dwordx4 v232, s[68:71], s58 offen lds
    s_mov_b32 exec_hi, -1
    buffer_load_ushort v57, v7, s[64:67], 0 offen
    ds_read_b128 v[152:155], v55 offset:46080
    ds_read_b128 v[156:159], v55 offset:47104
    ds_read_u16 v164, v2 offset:8192
    ds_read_u16 v165, v2 offset:8256
    ds_read_u16 v166, v2 offset:8320
    ds_read_u16 v167, v2 offset:8384
    ds_read_u16 v168, v2 offset:8448
    s_mov_b32 s4, s36
    s_mov_b32 s5, s37
    s_mov_b32 s6, 10240000
    s_mov_b32 s7, 0x00020000
    s_mov_b32 s12, s52
    s_mov_b32 s13, s53
    s_mov_b32 s14, 10240000
    s_mov_b32 s15, 0x00020000
    s_mov_b32 s20, 0x0f0f0f0f
    s_mov_b32 s21, 0x0f0f0f0f
    s_mov_b32 s22, 0xf0f0f0f0
    s_mov_b32 s23, 0xf0f0f0f0
    s_mov_b32 s31, 0xfffffc00
    s_mov_b32 s32, 0x9c4028
    s_mov_b32 s33, 0xffe0
    s_mov_b32 s24, 0
    s_mov_b32 s25, 0
    v_mov_b32 v8, 0
    v_mov_b32 v9, 0
    v_mov_b32 v10, 0
    v_mov_b32 v11, 0
    v_mov_b32 v12, 0
    v_mov_b32 v13, 0
    v_mov_b32 v14, 0
    v_mov_b32 v15, 0
    v_mov_b32 v16, 0
    v_mov_b32 v17, 0
    v_mov_b32 v18, 0
    v_mov_b32 v19, 0
    v_mov_b32 v20, 0
    v_mov_b32 v21, 0
    v_mov_b32 v22, 0
    v_mov_b32 v23, 0
    v_mov_b32 v24, 0
    v_mov_b32 v25, 0
    v_mov_b32 v26, 0
    v_mov_b32 v27, 0
    v_mov_b32 v28, 0
    v_mov_b32 v29, 0
    v_mov_b32 v30, 0
    v_mov_b32 v31, 0
    v_mov_b32 v32, 0
    v_mov_b32 v33, 0
    v_mov_b32 v34, 0
    v_mov_b32 v35, 0
    v_mov_b32 v36, 0
    v_mov_b32 v37, 0
    v_mov_b32 v38, 0
    v_mov_b32 v39, 0
    v_mov_b32 v40, 0
    v_mov_b32 v41, 0
    v_mov_b32 v42, 0
    v_mov_b32 v43, 0
    v_mov_b32 v44, 0
    v_mov_b32 v45, 0
    v_mov_b32 v46, 0
    v_mov_b32 v47, 0
    v_mov_b32 v192, 0
    v_mov_b32 v193, 0
    v_mov_b32 v194, 0
    v_mov_b32 v195, 0
    v_mov_b32 v196, 0
    v_mov_b32 v197, 0
    v_mov_b32 v198, 0
    v_mov_b32 v199, 0
    v_mov_b32 v112, 0
    v_mov_b32 v238, 0
    s_cmp_lt_u32 s2, 16
    s_cbranch_scc1 L_map40
    v_writelane_b32 v112, 0, 0
    v_writelane_b32 v112, 5, 1
    v_writelane_b32 v112, 6, 2
    v_writelane_b32 v112, 3, 3
    v_writelane_b32 v112, 8, 4
    v_writelane_b32 v112, 7, 5
    v_writelane_b32 v112, 2, 6
    v_writelane_b32 v112, 4, 7
    v_writelane_b32 v112, 1, 8
    v_writelane_b32 v112, 16, 9
    v_writelane_b32 v112, 10, 10
    v_writelane_b32 v112, 15, 11
    v_writelane_b32 v112, 9, 12
    v_writelane_b32 v112, 24, 13
    v_writelane_b32 v112, 14, 14
    v_writelane_b32 v112, 11, 15
    v_writelane_b32 v112, 13, 16
    v_writelane_b32 v112, 12, 17
    v_writelane_b32 v112, 17, 18
    v_writelane_b32 v112, 23, 19
    v_writelane_b32 v112, 20, 20
    v_writelane_b32 v112, 22, 21
    v_writelane_b32 v112, 19, 22
    v_writelane_b32 v112, 18, 23
    v_writelane_b32 v112, 21, 24
    v_writelane_b32 v112, 28, 25
    v_writelane_b32 v112, 29, 26
    v_writelane_b32 v112, 31, 27
    v_writelane_b32 v112, 26, 28
    v_writelane_b32 v112, 25, 29
    v_writelane_b32 v112, 27, 30
    v_writelane_b32 v112, 30, 31
    v_writelane_b32 v112, 36, 32
    v_writelane_b32 v112, 33, 33
    v_writelane_b32 v112, 35, 34
    v_writelane_b32 v112, 34, 35
    v_writelane_b32 v112, 38, 36
    v_writelane_b32 v112, 39, 37
    v_writelane_b32 v112, 37, 38
    v_writelane_b32 v112, 32, 39
    s_branch L_mapd
L_map40:
    v_writelane_b32 v112, 7, 0
    v_writelane_b32 v112, 0, 1
    v_writelane_b32 v112, 5, 2
    v_writelane_b32 v112, 2, 3
    v_writelane_b32 v112, 4, 4
    v_writelane_b32 v112, 3, 5
    v_writelane_b32 v112, 1, 6
    v_writelane_b32 v112, 6, 7
    v_writelane_b32 v112, 12, 8
    v_writelane_b32 v112, 9, 9
    v_writelane_b32 v112, 14, 10
    v_writelane_b32 v112, 11, 11
    v_writelane_b32 v112, 15, 12
    v_writelane_b32 v112, 10, 13
    v_writelane_b32 v112, 8, 14
    v_writelane_b32 v112, 13, 15
    v_writelane_b32 v112, 21, 16
    v_writelane_b32 v112, 22, 17
    v_writelane_b32 v112, 19, 18
    v_writelane_b32 v112, 16, 19
    v_writelane_b32 v112, 23, 20
    v_writelane_b32 v112, 17, 21
    v_writelane_b32 v112, 18, 22
    v_writelane_b32 v112, 20, 23
    v_writelane_b32 v112, 26, 24
    v_writelane_b32 v112, 29, 25
    v_writelane_b32 v112, 27, 26
    v_writelane_b32 v112, 25, 27
    v_writelane_b32 v112, 28, 28
    v_writelane_b32 v112, 30, 29
    v_writelane_b32 v112, 24, 30
    v_writelane_b32 v112, 31, 31
    v_writelane_b32 v112, 38, 32
    v_writelane_b32 v112, 33, 33
    v_writelane_b32 v112, 36, 34
    v_writelane_b32 v112, 35, 35
    v_writelane_b32 v112, 34, 36
    v_writelane_b32 v112, 32, 37
    v_writelane_b32 v112, 37, 38
    v_writelane_b32 v112, 39, 39
L_mapd:
    v_and_b32 v2, 3, v1
    v_lshrrev_b32 v3, 2, v1
    v_lshl_add_u32 v234, v2, 4, v3
    v_lshrrev_b32 v2, 5, v1
    v_lshlrev_b32 v233, 4, v2
    s_mul_i32 s26, s16, 5
    v_add_u32 v113, s26, v1
    v_subrev_u32 v3, 40, v113
    v_min_u32 v113, v113, v3
    v_mul_u32_u24 v3, 205, v1
    v_lshrrev_b32 v3, 10, v3
    v_mul_u32_u24 v2, 5, v3
    v_sub_u32 v115, v1, v2
    v_lshlrev_b32 v114, 2, v3
    s_lshl_b32 s81, s16, 10
    s_add_u32 s81, s81, 8192
    s_mul_i32 s80, s16, 6912
    v_lshl_add_u32 v121, v1, 2, s81
    v_lshrrev_b32 v3, 1, v1
    v_lshl_add_u32 v122, v3, 2, s81
    v_and_b32 v2, 1, v1
    v_lshlrev_b32 v123, 4, v2
    v_lshrrev_b32 v3, 1, v0
    v_mul_u32_u24 v3, 1280, v3
    v_add_u32 v124, v3, v2
    v_mul_u32_u24 v125, 48, v113
    s_lshl_b32 s26, s16, 2
    v_lshl_add_u32 v126, v115, 5, s26
    v_lshl_add_u32 v127, v1, 5, s80
    s_cmp_eq_u32 s16, 7
    s_cselect_b32 s54, 0, 1
    s_and_b32 s26, s16, 3
    s_lshl_b32 s58, s26, 9
    s_add_u32 s58, s58, 129024
    v_lshrrev_b32 v3, 4, v1
    v_mul_u32_u24 v2, 1792, v3
    v_add3_u32 v240, v2, s58, v232
    s_lshr_b32 s58, s16, 2
    v_and_b32 v2, 15, v1
    v_mul_u32_u24 v241, 288, v2
    v_lshl_add_u32 v241, v3, 4, v241
    s_mul_i32 s59, s58, 23040
    v_add_u32 v241, s59, v241
    v_lshlrev_b32 v242, 18, v3
    v_lshl_add_u32 v242, v2, 4, v242
    s_mul_i32 s58, s58, 5242880
    s_lshl_b32 s59, s2, 10
    s_add_u32 s58, s58, s59
    s_lshl_b32 s59, s26, 8
    s_add_u32 s58, s58, s59
    v_add_u32 v242, s58, v242
    v_mov_b32 v244, 161792
    s_mov_b32 s72, s50
    s_mov_b32 s73, s51
    s_mov_b32 s74, 32768
    s_mov_b32 s75, 0x00020000
    s_waitcnt lgkmcnt(0)
    v_or_b32 v164, v164, v5
    v_or_b32 v165, v165, v5
    v_or_b32 v166, v166, v5
    v_or_b32 v167, v167, v5
    v_or_b32 v168, v168, v5
    s_mul_i32 s27, s17, 15360
    s_add_u32 s27, s27, 10485760
    s_mul_i32 s58, s17, 40960
    s_add_u32 s59, s58, 4096
    s_waitcnt vmcnt(4)
    s_barrier
    ds_read_b128 v[80:83], v164 offset:61440
    ds_read_b128 v[84:87], v165 offset:61440
    ds_read_b128 v[88:91], v166 offset:61440
    ds_read_b128 v[92:95], v167 offset:61440
    s_mov_b64 exec, s[62:63]
    ds_read_b128 v[96:99], v168 offset:61440
    s_mov_b64 exec, -1
    s_waitcnt vmcnt(2)
    buffer_store_dwordx4 v[152:155], v55, s[8:11], s27 offen sc1
    s_mov_b32 exec_hi, s35
    buffer_store_dwordx4 v[156:159], v55, s[8:11], s27 offen offset:1024 sc1
    s_mov_b32 exec_hi, -1
    s_waitcnt lgkmcnt(4)
    buffer_store_dwordx4 v[80:83], v56, s[8:11], s58 offen offset:0 sc1
    s_waitcnt lgkmcnt(3)
    buffer_store_dwordx4 v[84:87], v56, s[8:11], s58 offen offset:1024 sc1
    s_waitcnt lgkmcnt(2)
    buffer_store_dwordx4 v[88:91], v56, s[8:11], s58 offen offset:2048 sc1
    s_waitcnt lgkmcnt(1)
    buffer_store_dwordx4 v[92:95], v56, s[8:11], s58 offen offset:3072 sc1
    s_mov_b32 exec_lo, s34
    s_mov_b32 exec_hi, s63
    s_waitcnt lgkmcnt(0)
    buffer_store_dwordx4 v[96:99], v56, s[8:11], s59 offen offset:0 sc1
    s_mov_b64 exec, -1
    s_mov_b32 s30, 400000
    s_mov_b32 s53, s29
    s_mov_b32 s59, 0xc0000000
    s_waitcnt vmcnt(7)
    v_and_or_b32 v60, v64, s59, v60
    v_xor_b32 v246, 0x40000000, v60
    v_xor_b32 v60, 0x80000000, v60
    v_and_or_b32 v61, v65, s59, v61
    v_xor_b32 v247, 0x40000000, v61
    v_xor_b32 v61, 0x80000000, v61
    v_and_or_b32 v62, v66, s59, v62
    v_xor_b32 v248, 0x40000000, v62
    v_xor_b32 v62, 0x80000000, v62
    v_and_or_b32 v63, v67, s59, v63
    v_xor_b32 v249, 0x40000000, v63
    v_xor_b32 v63, 0x80000000, v63
    v_and_b32 v2, 0x30, v1
    v_and_b32 v3, 3, v1
    v_lshl_add_u32 v2, v3, 2, v2
    v_bfe_u32 v7, v1, 2, 2
    v_add_lshl_u32 v2, v2, v7, 1
    ds_write_b16 v2, v57 offset:6656
    v_lshlrev_b32 v3, 3, v3
    ds_read_b64 v[216:217], v3 offset:6656
    ds_read_b64 v[218:219], v3 offset:6688
    ds_read_b64 v[220:221], v3 offset:6720
    ds_read_b64 v[222:223], v3 offset:6752
    s_lshl_b32 s58, s16, 12
    s_add_u32 m0, s58, 129024
    s_cmp_eq_u32 s16, 7
    s_waitcnt vmcnt(0) lgkmcnt(0)
    s_barrier
    s_cbranch_scc0 L_nrow2
    buffer_store_dwordx4 v[60:63], v245, s[8:11], s29 offen sc1
L_nrow2:
    s_barrier
    buffer_load_dwordx4 v232, s[72:75], s58 offen offset:0 lds
    buffer_load_dwordx4 v232, s[72:75], s58 offen offset:1024 lds
    buffer_load_dwordx4 v232, s[72:75], s58 offen offset:2048 lds
    buffer_load_dwordx4 v232, s[72:75], s58 offen offset:3072 lds
    v_and_b32 v3, 31, v1
    v_lshlrev_b32 v2, 7, v233
    v_lshl_add_u32 v2, v3, 2, v2
    v_add_u32 v3, 128, v2
    ds_read2st64_b32 v[144:145], v2 offset0:64 offset1:65
    ds_read2st64_b32 v[146:147], v2 offset0:66 offset1:67
    ds_read2st64_b32 v[148:149], v2 offset0:68 offset1:69
    ds_read2st64_b32 v[150:151], v2 offset0:70 offset1:71
    ds_read2st64_b32 v[152:153], v3 offset0:64 offset1:65
    ds_read2st64_b32 v[154:155], v3 offset0:66 offset1:67
    ds_read2st64_b32 v[156:157], v3 offset0:68 offset1:69
    ds_read2st64_b32 v[158:159], v3 offset0:70 offset1:71
    s_mov_b32 s56, 0xbfb8aa3b
    s_mov_b32 s57, 0xbfb8aa3b
    s_waitcnt lgkmcnt(7)
    v_lshlrev_b32 v160, 16, v144
    v_lshlrev_b32 v161, 16, v145
    v_and_b32 v162, 0xffff0000, v144
    v_and_b32 v163, 0xffff0000, v145
    v_pk_mul_f32 v[160:161], v[160:161], s[56:57]
    v_pk_mul_f32 v[162:163], v[162:163], s[56:57]
    v_cvt_pk_bf16_f32 v200, v160, v161
    v_cvt_pk_bf16_f32 v204, v162, v163
    s_waitcnt lgkmcnt(6)
    v_lshlrev_b32 v160, 16, v146
    v_lshlrev_b32 v161, 16, v147
    v_and_b32 v162, 0xffff0000, v146
    v_and_b32 v163, 0xffff0000, v147
    v_pk_mul_f32 v[160:161], v[160:161], s[56:57]
    v_pk_mul_f32 v[162:163], v[162:163], s[56:57]
    v_cvt_pk_bf16_f32 v201, v160, v161
    v_cvt_pk_bf16_f32 v205, v162, v163
    s_waitcnt lgkmcnt(5)
    v_lshlrev_b32 v160, 16, v148
    v_lshlrev_b32 v161, 16, v149
    v_and_b32 v162, 0xffff0000, v148
    v_and_b32 v163, 0xffff0000, v149
    v_pk_mul_f32 v[160:161], v[160:161], s[56:57]
    v_pk_mul_f32 v[162:163], v[162:163], s[56:57]
    v_cvt_pk_bf16_f32 v202, v160, v161
    v_cvt_pk_bf16_f32 v206, v162, v163
    s_waitcnt lgkmcnt(4)
    v_lshlrev_b32 v160, 16, v150
    v_lshlrev_b32 v161, 16, v151
    v_and_b32 v162, 0xffff0000, v150
    v_and_b32 v163, 0xffff0000, v151
    v_pk_mul_f32 v[160:161], v[160:161], s[56:57]
    v_pk_mul_f32 v[162:163], v[162:163], s[56:57]
    v_cvt_pk_bf16_f32 v203, v160, v161
    v_cvt_pk_bf16_f32 v207, v162, v163
    s_waitcnt lgkmcnt(3)
    v_lshlrev_b32 v160, 16, v152
    v_lshlrev_b32 v161, 16, v153
    v_and_b32 v162, 0xffff0000, v152
    v_and_b32 v163, 0xffff0000, v153
    v_pk_mul_f32 v[160:161], v[160:161], s[56:57]
    v_pk_mul_f32 v[162:163], v[162:163], s[56:57]
    v_cvt_pk_bf16_f32 v208, v160, v161
    v_cvt_pk_bf16_f32 v212, v162, v163
    s_waitcnt lgkmcnt(2)
    v_lshlrev_b32 v160, 16, v154
    v_lshlrev_b32 v161, 16, v155
    v_and_b32 v162, 0xffff0000, v154
    v_and_b32 v163, 0xffff0000, v155
    v_pk_mul_f32 v[160:161], v[160:161], s[56:57]
    v_pk_mul_f32 v[162:163], v[162:163], s[56:57]
    v_cvt_pk_bf16_f32 v209, v160, v161
    v_cvt_pk_bf16_f32 v213, v162, v163
    s_waitcnt lgkmcnt(1)
    v_lshlrev_b32 v160, 16, v156
    v_lshlrev_b32 v161, 16, v157
    v_and_b32 v162, 0xffff0000, v156
    v_and_b32 v163, 0xffff0000, v157
    v_pk_mul_f32 v[160:161], v[160:161], s[56:57]
    v_pk_mul_f32 v[162:163], v[162:163], s[56:57]
    v_cvt_pk_bf16_f32 v210, v160, v161
    v_cvt_pk_bf16_f32 v214, v162, v163
    s_waitcnt lgkmcnt(0)
    v_lshlrev_b32 v160, 16, v158
    v_lshlrev_b32 v161, 16, v159
    v_and_b32 v162, 0xffff0000, v158
    v_and_b32 v163, 0xffff0000, v159
    v_pk_mul_f32 v[160:161], v[160:161], s[56:57]
    v_pk_mul_f32 v[162:163], v[162:163], s[56:57]
    v_cvt_pk_bf16_f32 v211, v160, v161
    v_cvt_pk_bf16_f32 v215, v162, v163
    v_mov_b32 v80, 0xffffff
    v_mov_b32 v81, 0xffffff
    v_mov_b32 v82, 0xffffff
    v_mov_b32 v83, 0xffffff
    v_add_u32 v2, s81, v232
    ds_write_b128 v2, v[80:83]
    v_and_b32 v7, 1, v1
L_pa:
    buffer_load_dword v6, v58, s[8:11], 0 offen sc1
    s_waitcnt vmcnt(0)
    v_xor_b32 v144, v6, v59
    v_cmpx_gt_u32 vcc, 0x40000000, v144
    s_cbranch_execz L_pda
    s_sub_u32 s30, s30, 1
    s_cbranch_scc0 L_pa
    s_endpgm
L_pda:
    s_mov_b64 exec, -1
    v_bfe_u32 v236, v6, 16, 11
    v_and_b32 v5, 0xffff, v6
    v_sub_u32 v2, v236, v7
    v_add_u32_dpp v236, v236, v236 row_shr:2 row_mask:0xf bank_mask:0xf
    v_add_u32 v5, v5, v124
    s_nop 0
    v_add_u32_dpp v236, v236, v236 row_shr:4 row_mask:0xf bank_mask:0xf
    s_nop 1
    v_add_u32_dpp v236, v236, v236 row_shr:8 row_mask:0xf bank_mask:0xf
    s_nop 1
    v_add_u32_dpp v236, v236, v236 row_bcast:15 row_mask:0xa bank_mask:0xf
    s_nop 1
    v_add_u32_dpp v236, v236, v236 row_bcast:31 row_mask:0xc bank_mask:0xf
    v_sub_u32 v3, v236, v2
    v_min_u32 v4, 216, v236
    v_lshl_add_u32 v6, v3, 2, s81
    v_sub_u32 v4, v4, v3
    v_sub_u32 v237, v5, v3
    v_sub_u32 v235, v3, v7
L_exp:
    v_cmpx_lt_i32 vcc, 0, v4
    ds_write_b32 v6, v5 offset:0
    v_add_u32 v5, 2, v5
    v_cmpx_lt_i32 vcc, 2, v4
    ds_write_b32 v6, v5 offset:8
    v_add_u32 v5, 2, v5
    v_cmpx_lt_i32 vcc, 4, v4
    ds_write_b32 v6, v5 offset:16
    v_add_u32 v5, 2, v5
    v_cmpx_lt_i32 vcc, 6, v4
    ds_write_b32 v6, v5 offset:24
    v_add_u32 v5, 2, v5
    v_cmpx_lt_i32 vcc, 8, v4
    ds_write_b32 v6, v5 offset:32
    v_add_u32 v5, 2, v5
    v_cmpx_lt_i32 vcc, 10, v4
    ds_write_b32 v6, v5 offset:40
    v_add_u32 v5, 2, v5
    v_cmpx_lt_i32 vcc, 12, v4
    s_cbranch_execnz L_exp_more
L_exp_done:
    s_mov_b64 exec, -1
    ds_read_b32 v99, v121 offset:768
    ds_read_b32 v98, v121 offset:512
    ds_read_b32 v97, v121 offset:256
    ds_read_b32 v96, v121 offset:0
    v_readlane_b32 s19, v236, 63
    s_mov_b32 s26, 10485760
    s_sub_i32 s28, s19, s24
    s_cmp_le_i32 s28, 192
    s_cbranch_scc1 L_sk3
    s_waitcnt lgkmcnt(3)
    v_mul_u32_u24 v99, 12, v99
    buffer_load_dwordx3 v[92:94], v99, s[8:11], s26 offen sc1
L_sk3:
    s_waitcnt lgkmcnt(2)
    v_mul_u32_u24 v98, 12, v98
    buffer_load_dwordx3 v[88:90], v98, s[8:11], s26 offen sc1
    s_waitcnt lgkmcnt(1)
    v_mul_u32_u24 v97, 12, v97
    buffer_load_dwordx3 v[84:86], v97, s[8:11], s26 offen sc1
    s_waitcnt lgkmcnt(0)
    v_mul_u32_u24 v96, 12, v96
    buffer_load_dwordx3 v[80:82], v96, s[8:11], s26 offen sc1
    ds_read_b32 v100, v122 offset:0
    ds_read_b32 v101, v122 offset:128
    ds_read_b32 v102, v122 offset:256
    ds_read_b32 v103, v122 offset:384
    ds_read_b32 v104, v122 offset:512
    ds_read_b32 v105, v122 offset:640
    ds_read_b32 v106, v122 offset:768
    s_max_i32 s28, s28, 0
    s_min_i32 s28, s28, 216
    s_barrier
    s_waitcnt lgkmcnt(6)
    v_lshl_or_b32 v100, v100, 5, v123
    s_add_u32 m0, s80, 46080
    s_cmp_le_u32 s28, 32
    buffer_load_dwordx4 v100, s[8:11], 0 offen sc1 lds
    s_waitcnt lgkmcnt(5)
    v_lshl_or_b32 v101, v101, 5, v123
    s_add_u32 m0, s80, 47104
    s_cmp_le_u32 s28, 64
    buffer_load_dwordx4 v101, s[8:11], 0 offen sc1 lds
    s_waitcnt lgkmcnt(0)
    v_lshl_or_b32 v102, v102, 5, v123
    v_lshl_or_b32 v103, v103, 5, v123
    v_lshl_or_b32 v104, v104, 5, v123
    v_lshl_or_b32 v105, v105, 5, v123
    v_lshl_or_b32 v106, v106, 5, v123
    s_sub_i32 s27, s28, 0
    v_cmp_gt_i32 s[36:37], s27, v1
    s_sub_i32 s27, s28, 64
    v_cmp_gt_i32 s[38:39], s27, v1
    s_sub_i32 s27, s28, 128
    v_cmp_gt_i32 s[40:41], s27, v1
    s_sub_i32 s27, s28, 192
    v_cmp_gt_i32 s[42:43], s27, v1
    v_mov_b32 v3, s19
    v_mov_b32 v4, 2048
    ds_max_u32 v4, v3
    v_mov_b32 v6, 1
    s_mov_b64 exec, 1
    ds_add_u32 v4, v3 offset:4
    s_mov_b64 exec, -1
    s_waitcnt vmcnt(5)
    s_mov_b64 exec, s[42:43]
    v_and_b32 v2, 0x3ff, v94
    v_lshlrev_b32 v95, 2, v2
    ds_add_rtn_u32 v111, v95, v6 offset:0
    s_waitcnt vmcnt(4)
    s_mov_b64 exec, s[40:41]
    v_and_b32 v2, 0x3ff, v90
    v_lshlrev_b32 v91, 2, v2
    ds_add_rtn_u32 v110, v91, v6 offset:0
    s_waitcnt vmcnt(3)
    s_mov_b64 exec, s[38:39]
    v_and_b32 v2, 0x3ff, v86
    v_lshlrev_b32 v87, 2, v2
    ds_add_rtn_u32 v109, v87, v6 offset:0
    s_waitcnt vmcnt(2)
    s_mov_b64 exec, s[36:37]
    v_and_b32 v2, 0x3ff, v82
    v_lshlrev_b32 v83, 2, v2
    ds_add_rtn_u32 v108, v83, v6 offset:0
    s_mov_b64 exec, -1
    s_waitcnt lgkmcnt(0)
    s_barrier
    ds_read_b128 v[148:151], v125 offset:0
    ds_read_b128 v[152:155], v125 offset:16
    ds_read_b128 v[156:159], v125 offset:32
    ds_read_b64 v[4:5], v4
    s_cmp_eq_u32 s24, s54
    s_cbranch_scc0 L_no2
    buffer_store_dwordx4 v[246:249], v245, s[8:11], s53 offen sc1
L_no2:
    s_cmp_le_u32 s28, 64
    s_cbranch_scc1 L_efd
    s_add_u32 m0, s80, 48128
    s_cmp_le_u32 s28, 96
    buffer_load_dwordx4 v102, s[8:11], 0 offen sc1 lds
    s_cbranch_scc1 L_efd
    s_add_u32 m0, s80, 49152
    s_cmp_le_u32 s28, 128
    buffer_load_dwordx4 v103, s[8:11], 0 offen sc1 lds
    s_cbranch_scc1 L_efd
    s_add_u32 m0, s80, 50176
    s_cmp_le_u32 s28, 160
    buffer_load_dwordx4 v104, s[8:11], 0 offen sc1 lds
    s_cbranch_scc1 L_efd
    s_add_u32 m0, s80, 51200
    s_cmp_le_u32 s28, 192
    buffer_load_dwordx4 v105, s[8:11], 0 offen sc1 lds
    s_cbranch_scc1 L_efd
    s_add_u32 m0, s80, 52224
    s_cmp_le_u32 s28, 224
    s_mov_b32 exec_hi, 0xffff
    buffer_load_dwordx4 v106, s[8:11], 0 offen sc1 lds
    s_mov_b32 exec_hi, -1
L_efd:
    v_cmp_gt_u32 vcc, 40, v1
    s_waitcnt lgkmcnt(0)
    v_readfirstlane_b32 s26, v4
    v_readfirstlane_b32 s27, v5
    v_add_u32 v3, v148, v149
    v_add3_u32 v3, v3, v150, v151
    v_add3_u32 v3, v3, v152, v153
    v_add3_u32 v3, v3, v154, v155
    v_add3_u32 v3, v3, v156, v157
    v_add3_u32 v3, v3, v158, v159
    v_lshl_or_b32 v3, v3, 6, v113
    v_cndmask_b32 v3, 0, v3, vcc
    s_max_u32 s25, s25, s26
    s_cmp_lg_u32 s24, 0
    s_cbranch_scc1 L_havepos
    v_readlane_b32 s64, v3, 0
    v_readlane_b32 s65, v3, 1
    v_readlane_b32 s66, v3, 2
    v_readlane_b32 s67, v3, 3
    v_readlane_b32 s68, v3, 4
    v_cmp_lt_u32 s[70:71], s64, v3
    v_cmp_lt_u32 s[72:73], s65, v3
    v_cmp_lt_u32 s[74:75], s66, v3
    v_cmp_lt_u32 s[76:77], s67, v3
    v_cmp_lt_u32 s[78:79], s68, v3
    s_bcnt1_i32_b64 s64, s[70:71]
    s_bcnt1_i32_b64 s65, s[72:73]
    s_bcnt1_i32_b64 s66, s[74:75]
    s_bcnt1_i32_b64 s67, s[76:77]
    s_bcnt1_i32_b64 s68, s[78:79]
    v_readlane_b32 s70, v112, s64
    v_readlane_b32 s71, v112, s65
    v_readlane_b32 s72, v112, s66
    v_readlane_b32 s73, v112, s67
    v_readlane_b32 s74, v112, s68
    v_writelane_b32 v238, s70, 0
    v_writelane_b32 v238, s71, 1
    v_writelane_b32 v238, s72, 2
    v_writelane_b32 v238, s73, 3
    v_writelane_b32 v238, s74, 4
    v_lshlrev_b32 v238, 2, v238
L_havepos:
    s_mov_b64 exec, 31
    ds_write_b32 v238, v3 offset:4096
    s_mov_b64 exec, -1
    v_lshlrev_b32 v4, 2, v1
    v_and_b32 v6, 7, v1
    v_cmp_gt_u32 s[34:35], s16, v6
    s_and_b64 s[34:35], s[34:35], vcc
    v_cmp_gt_u32 vcc, 60, v1
    s_cmp_gt_u32 s27, 1270
    s_cselect_b32 s26, 44, 0
    v_add_u32 v114, s26, v114
    v_subrev_u32 v2, 48, v114
    v_min_u32 v114, v114, v2
    s_waitcnt lgkmcnt(0)
    s_barrier
    ds_read_b32 v119, v126 offset:4096
    ds_read_b32 v4, v4 offset:4096
    s_waitcnt lgkmcnt(1)
    v_and_b32 v119, 63, v119
    v_mad_u32_u24 v3, v119, 48, v114
    ds_read_b32 v116, v3 offset:0
    s_waitcnt lgkmcnt(1)
    v_lshrrev_b32 v4, 6, v4
    v_cndmask_b32 v118, 0, v4, s[34:35]
    v_mul_u32_u24 v119, 1152, v119
    s_waitcnt lgkmcnt(0)
    v_cndmask_b32 v116, 0, v116, vcc
    v_mov_b32 v117, v116
    v_readlane_b32 s48, v119, 0
    v_readlane_b32 s49, v119, 1
    v_add_u32_dpp v117, v117, v117 row_shr:1 row_mask:0xf bank_mask:0xf
    v_add_u32_dpp v118, v118, v118 row_shr:1 row_mask:0xf bank_mask:0xf
    v_readlane_b32 s50, v119, 2
    v_add_u32_dpp v117, v117, v117 row_shr:2 row_mask:0xf bank_mask:0xf
    v_add_u32_dpp v118, v118, v118 row_shr:2 row_mask:0xf bank_mask:0xf
    v_readlane_b32 s51, v119, 3
    v_add_u32_dpp v117, v117, v117 row_shr:4 row_mask:0xf bank_mask:0xf
    v_add_u32_dpp v118, v118, v118 row_shr:4 row_mask:0xf bank_mask:0xf
    v_readlane_b32 s52, v119, 4
    v_add_u32_dpp v117, v117, v117 row_shr:8 row_mask:0xf bank_mask:0xf
    v_add_u32_dpp v118, v118, v118 row_shr:8 row_mask:0xf bank_mask:0xf
    v_lshlrev_b32 v4, 3, v115
    v_add_u32_dpp v117, v117, v117 row_bcast:15 row_mask:0xa bank_mask:0xf
    v_add_u32_dpp v118, v118, v118 row_bcast:15 row_mask:0xa bank_mask:0xf
    s_min_u32 s25, s25, 40000
    v_add_u32_dpp v117, v117, v117 row_bcast:31 row_mask:0xc bank_mask:0xf
    v_add_u32_dpp v118, v118, v118 row_bcast:31 row_mask:0xc bank_mask:0xf
    v_sub_u32 v116, v117, v116
    v_readlane_b32 s29, v118, 63
    v_readlane_b32 s18, v117, 63
    s_lshl_b32 s26, s29, 4
    s_add_u32 s26, s26, 101376
    v_lshl_add_u32 v116, v116, 4, s26
    v_lshl_or_b32 v116, v116, 10, v4
    s_mov_b64 exec, vcc
    ds_write_b32 v3, v116 offset:4608
    s_mov_b64 exec, -1
    s_min_u32 s18, s18, 1728
    v_lshl_add_u32 v230, v234, 4, s26
    v_and_b32 v2, 3, v1
    v_bfe_u32 v3, v1, 3, 2
    v_lshl_add_u32 v2, v3, 2, v2
    v_lshl_add_u32 v231, v2, 4, s26
    s_movk_i32 s27, 1023
    s_waitcnt lgkmcnt(0)
    s_barrier
    s_mov_b64 exec, s[36:37]
    ds_read_b32 v96, v83 offset:4608
    s_mov_b64 exec, s[38:39]
    ds_read_b32 v97, v87 offset:4608
    s_mov_b64 exec, s[40:41]
    ds_read_b32 v98, v91 offset:4608
    s_mov_b64 exec, s[42:43]
    ds_read_b32 v99, v95 offset:4608
    s_mov_b64 exec, -1
    v_add_u32 v83, 0, v127
    v_add_u32 v87, 2048, v127
    v_add_u32 v91, 4096, v127
    v_add_u32 v95, 6144, v127
    s_waitcnt lgkmcnt(0)
    s_mov_b64 exec, s[36:37]
    v_bfi_b32 v82, s27, v96, v82
    v_lshrrev_b32 v96, 10, v96
    v_lshl_add_u32 v96, v108, 4, v96
    ds_write_b128 v96, v[80:83]
    s_mov_b64 exec, s[38:39]
    v_bfi_b32 v86, s27, v97, v86
    v_lshrrev_b32 v97, 10, v97
    v_lshl_add_u32 v97, v109, 4, v97
    ds_write_b128 v97, v[84:87]
    s_mov_b64 exec, s[40:41]
    v_bfi_b32 v90, s27, v98, v90
    v_lshrrev_b32 v98, 10, v98
    v_lshl_add_u32 v98, v110, 4, v98
    ds_write_b128 v98, v[88:91]
    s_mov_b64 exec, s[42:43]
    v_bfi_b32 v94, s27, v99, v94
    v_lshrrev_b32 v99, 10, v99
    v_lshl_add_u32 v99, v111, 4, v99
    ds_write_b128 v99, v[92:95]
    s_mov_b64 exec, -1
    v_cmp_gt_i32 vcc, s18, v234
    v_mov_b32 v4, s32
    s_waitcnt lgkmcnt(0)
    s_barrier
    ds_read_b128 v[224:227], v230
    ds_read_b32 v229, v231 offset:12
    ds_read_b32 v2, v231 offset:268
    s_mov_b32 s59, 101376
    s_waitcnt lgkmcnt(0)
    v_cndmask_b32 v228, v4, v226, vcc
    v_and_or_b32 v229, v229, s33, v233
    v_readlane_b32 s64, v228, 0
    v_readlane_b32 s65, v228, 4
    v_readlane_b32 s66, v228, 8
    v_readlane_b32 s67, v228, 12
    v_readlane_b32 s68, v228, 16
    v_readlane_b32 s69, v228, 20
    v_readlane_b32 s70, v228, 24
    v_readlane_b32 s71, v228, 28
    s_and_b32 s80, s64, s31
    buffer_load_dwordx4 v[48:51], v232, s[4:7], s80 offen
    s_and_b32 s81, s65, s31
    buffer_load_dwordx4 v[52:55], v232, s[4:7], s81 offen
    s_and_b32 s82, s66, s31
    buffer_load_dwordx4 v[56:59], v232, s[4:7], s82 offen
    s_and_b32 s83, s67, s31
    buffer_load_dwordx4 v[60:63], v232, s[4:7], s83 offen
    s_waitcnt vmcnt(4)
    s_barrier
    s_mov_b64 exec, s[20:21]
    ds_read_b128 v[192:195], v229 offset:46080
    s_mov_b64 exec, s[22:23]
    ds_read_b128 v[196:199], v229 offset:46080
    s_mov_b64 exec, -1
    v_and_or_b32 v229, v2, s33, v233
    s_waitcnt lgkmcnt(0)
    v_mfma_f32_32x32x16_bf16 v[80:95], v[192:195], v[200:203], 0
    v_mfma_f32_32x32x16_bf16 v[96:111], v[192:195], v[204:207], 0
    v_mfma_f32_32x32x16_bf16 v[80:95], v[196:199], v[208:211], v[80:95]
    v_mfma_f32_32x32x16_bf16 v[96:111], v[196:199], v[212:215], v[96:111]
    s_and_b32 s80, s68, s31
    buffer_load_dwordx4 v[64:67], v232, s[4:7], s80 offen
    s_and_b32 s81, s69, s31
    buffer_load_dwordx4 v[68:71], v232, s[4:7], s81 offen
    s_and_b32 s82, s70, s31
    buffer_load_dwordx4 v[72:75], v232, s[4:7], s82 offen
    s_and_b32 s83, s71, s31
    buffer_load_dwordx4 v[76:79], v232, s[4:7], s83 offen
    s_mov_b64 exec, s[20:21]
    ds_read_b128 v[192:195], v229 offset:46080
    s_mov_b64 exec, -1
    s_cmp_lg_u32 s24, 0
    s_cbranch_scc1 L_wdone
    v_lshrrev_b32 v7, 5, v0
    v_and_b32 v3, 31, v1
    v_lshlrev_b32 v7, 11, v7
    v_add_u32 v7, 129024, v7
    v_lshl_add_u32 v2, v3, 3, v7
    ds_read_b64 v[160:161], v2 offset:0
    ds_read_b64 v[162:163], v2 offset:256
    ds_read_b64 v[164:165], v2 offset:512
    ds_read_b64 v[166:167], v2 offset:768
    ds_read_b64 v[168:169], v2 offset:1024
    ds_read_b64 v[170:171], v2 offset:1280
    ds_read_b64 v[172:173], v2 offset:1536
    ds_read_b64 v[174:175], v2 offset:1792
    s_mov_b32 s58, 0x05040100
    s_mov_b32 s59, 0x07060302
    v_bfe_u32 v3, v0, 3, 2
    v_lshl_add_u32 v7, v3, 9, v7
    v_and_b32 v3, 7, v0
    v_lshl_add_u32 v7, v3, 5, v7
    v_mov_b32 v5, 161792
    v_mov_b32 v6, 1
    s_waitcnt lgkmcnt(0)
    v_perm_b32 v112, v162, v160, s58
    v_perm_b32 v113, v166, v164, s58
    v_perm_b32 v114, v170, v168, s58
    v_perm_b32 v115, v174, v172, s58
    ds_write_b128 v7, v[112:115] offset:0
    v_perm_b32 v116, v162, v160, s59
    v_perm_b32 v117, v166, v164, s59
    v_perm_b32 v118, v170, v168, s59
    v_perm_b32 v119, v174, v172, s59
    ds_write_b128 v7, v[116:119] offset:256
    v_perm_b32 v120, v163, v161, s58
    v_perm_b32 v121, v167, v165, s58
    v_perm_b32 v122, v171, v169, s58
    v_perm_b32 v123, v175, v173, s58
    ds_write_b128 v7, v[120:123] offset:16
    v_perm_b32 v124, v163, v161, s59
    v_perm_b32 v125, v167, v165, s59
    v_perm_b32 v126, v171, v169, s59
    v_perm_b32 v127, v175, v173, s59
    ds_write_b128 v7, v[124:127] offset:272
    s_mov_b64 exec, 1
    ds_add_u32 v5, v6
    s_mov_b64 exec, -1
L_wdone:
    s_mov_b32 s59, 101376
    s_mov_b32 s30, s18
    s_waitcnt lgkmcnt(0)
L_sb:
    v_mfma_f32_4x4x4_16b_bf16 v[144:147], v[224:225], v[216:217], 0
    v_mfma_f32_4x4x4_16b_bf16 v[148:151], v[224:225], v[218:219], 0
    v_mfma_f32_4x4x4_16b_bf16 v[152:155], v[224:225], v[220:221], 0
    v_mfma_f32_4x4x4_16b_bf16 v[156:159], v[224:225], v[222:223], 0
    v_add_u32 v230, 1024, v230
    s_sub_u32 s26, s30, 64
    v_cmp_gt_i32 s[34:35], s26, v234
    s_cmp_le_i32 s30, 0
    s_nop 0
    v_cvt_pk_bf16_f32 v184, v144, v148
    v_cvt_pk_bf16_f32 v185, v152, v156
    v_cvt_pk_bf16_f32 v186, v145, v149
    v_cvt_pk_bf16_f32 v187, v153, v157
    v_cvt_pk_bf16_f32 v188, v146, v150
    v_cvt_pk_bf16_f32 v189, v154, v158
    v_cvt_pk_bf16_f32 v190, v147, v151
    v_cvt_pk_bf16_f32 v191, v155, v159
    ds_read_b128 v[224:227], v230
    ds_read_b32 v243, v244
    s_cbranch_scc1 L_exit
    s_setprio 3
    v_mfma_f32_32x32x16_bf16 v[112:127], v[192:195], v[200:203], 0
    v_exp_f32 v176, v80
    v_exp_f32 v177, v81
    v_exp_f32 v178, v82
    v_exp_f32 v179, v83
    v_exp_f32 v180, v96
    v_exp_f32 v181, v97
    v_exp_f32 v182, v98
    v_exp_f32 v183, v99
    v_pk_fma_f32 v[176:177], v[176:177], s[56:57], s[56:57]
    v_pk_fma_f32 v[178:179], v[178:179], s[56:57], s[56:57]
    v_pk_fma_f32 v[180:181], v[180:181], s[56:57], s[56:57]
    v_pk_fma_f32 v[182:183], v[182:183], s[56:57], s[56:57]
    s_waitcnt vmcnt(4)
    v_mfma_f32_4x4x4_16b_bf16 v[144:147], v[184:185], v[48:49], 0 cbsz:4 abid:0
    v_rcp_f32 v176, v176
    v_mfma_f32_4x4x4_16b_bf16 v[148:151], v[184:185], v[50:51], 0 cbsz:4 abid:0
    v_rcp_f32 v177, v177
    v_mfma_f32_4x4x4_16b_bf16 v[152:155], v[184:185], v[52:53], 0 cbsz:4 abid:1
    v_rcp_f32 v178, v178
    v_mfma_f32_4x4x4_16b_bf16 v[156:159], v[184:185], v[54:55], 0 cbsz:4 abid:1
    v_rcp_f32 v179, v179
    v_mfma_f32_4x4x4_16b_bf16 v[160:163], v[184:185], v[56:57], 0 cbsz:4 abid:2
    v_rcp_f32 v180, v180
    v_mfma_f32_4x4x4_16b_bf16 v[164:167], v[184:185], v[58:59], 0 cbsz:4 abid:2
    v_rcp_f32 v181, v181
    v_mfma_f32_4x4x4_16b_bf16 v[168:171], v[184:185], v[60:61], 0 cbsz:4 abid:3
    v_rcp_f32 v182, v182
    v_mfma_f32_4x4x4_16b_bf16 v[172:175], v[184:185], v[62:63], 0 cbsz:4 abid:3
    v_rcp_f32 v183, v183
    v_readlane_b32 s72, v228, 32
    v_readlane_b32 s73, v228, 36
    v_readlane_b32 s74, v228, 40
    v_readlane_b32 s75, v228, 44
    v_pk_mul_f32 v[176:177], v[176:177], v[80:81]
    v_pk_mul_f32 v[178:179], v[178:179], v[82:83]
    v_pk_mul_f32 v[180:181], v[180:181], v[96:97]
    v_pk_mul_f32 v[182:183], v[182:183], v[98:99]
    s_set_gpr_idx_on s64, gpr_idx(SRC2,DST)
    v_pk_fma_f32 v[8:9], v[176:177], v[144:145], v[8:9] op_sel:[0,0,0] op_sel_hi:[0,1,1]
    v_pk_fma_f32 v[10:11], v[176:177], v[146:147], v[10:11] op_sel:[0,0,0] op_sel_hi:[0,1,1]
    v_pk_fma_f32 v[12:13], v[180:181], v[148:149], v[12:13] op_sel:[0,0,0] op_sel_hi:[0,1,1]
    v_pk_fma_f32 v[14:15], v[180:181], v[150:151], v[14:15] op_sel:[0,0,0] op_sel_hi:[0,1,1]
    s_set_gpr_idx_idx s65
    v_pk_fma_f32 v[8:9], v[176:177], v[152:153], v[8:9] op_sel:[1,0,0] op_sel_hi:[1,1,1]
    v_pk_fma_f32 v[10:11], v[176:177], v[154:155], v[10:11] op_sel:[1,0,0] op_sel_hi:[1,1,1]
    v_pk_fma_f32 v[12:13], v[180:181], v[156:157], v[12:13] op_sel:[1,0,0] op_sel_hi:[1,1,1]
    v_pk_fma_f32 v[14:15], v[180:181], v[158:159], v[14:15] op_sel:[1,0,0] op_sel_hi:[1,1,1]
    s_set_gpr_idx_idx s66
    v_pk_fma_f32 v[8:9], v[178:179], v[160:161], v[8:9] op_sel:[0,0,0] op_sel_hi:[0,1,1]
    v_pk_fma_f32 v[10:11], v[178:179], v[162:163], v[10:11] op_sel:[0,0,0] op_sel_hi:[0,1,1]
    v_pk_fma_f32 v[12:13], v[182:183], v[164:165], v[12:13] op_sel:[0,0,0] op_sel_hi:[0,1,1]
    v_pk_fma_f32 v[14:15], v[182:183], v[166:167], v[14:15] op_sel:[0,0,0] op_sel_hi:[0,1,1]
    s_set_gpr_idx_idx s67
    v_pk_fma_f32 v[8:9], v[178:179], v[168:169], v[8:9] op_sel:[1,0,0] op_sel_hi:[1,1,1]
    v_pk_fma_f32 v[10:11], v[178:179], v[170:171], v[10:11] op_sel:[1,0,0] op_sel_hi:[1,1,1]
    v_pk_fma_f32 v[12:13], v[182:183], v[172:173], v[12:13] op_sel:[1,0,0] op_sel_hi:[1,1,1]
    v_pk_fma_f32 v[14:15], v[182:183], v[174:175], v[14:15] op_sel:[1,0,0] op_sel_hi:[1,1,1]
    s_set_gpr_idx_off
    s_and_b32 s80, s72, s31
    s_and_b32 s81, s73, s31
    s_and_b32 s82, s74, s31
    s_and_b32 s83, s75, s31
    buffer_load_dwordx4 v[48:51], v232, s[4:7], s80 offen
    buffer_load_dwordx4 v[52:55], v232, s[4:7], s81 offen
    buffer_load_dwordx4 v[56:59], v232, s[4:7], s82 offen
    buffer_load_dwordx4 v[60:63], v232, s[4:7], s83 offen
    s_cmp_le_i32 s30, 4
    s_mov_b64 exec, s[22:23]
    ds_read_b128 v[196:199], v229 offset:46080
    s_mov_b64 exec, -1
    ds_read_b32 v2, v231 offset:524
    s_cbranch_scc1 L_exit
    s_setprio 2
    v_mfma_f32_32x32x16_bf16 v[128:143], v[192:195], v[204:207], 0
    v_exp_f32 v176, v84
    v_exp_f32 v177, v85
    v_exp_f32 v178, v86
    v_exp_f32 v179, v87
    v_exp_f32 v180, v100
    v_exp_f32 v181, v101
    v_exp_f32 v182, v102
    v_exp_f32 v183, v103
    v_pk_fma_f32 v[176:177], v[176:177], s[56:57], s[56:57]
    v_pk_fma_f32 v[178:179], v[178:179], s[56:57], s[56:57]
    v_pk_fma_f32 v[180:181], v[180:181], s[56:57], s[56:57]
    v_pk_fma_f32 v[182:183], v[182:183], s[56:57], s[56:57]
    s_waitcnt vmcnt(4)
    v_mfma_f32_4x4x4_16b_bf16 v[144:147], v[184:185], v[64:65], 0 cbsz:4 abid:4
    v_rcp_f32 v176, v176
    v_mfma_f32_4x4x4_16b_bf16 v[148:151], v[184:185], v[66:67], 0 cbsz:4 abid:4
    v_rcp_f32 v177, v177
    v_mfma_f32_4x4x4_16b_bf16 v[152:155], v[184:185], v[68:69], 0 cbsz:4 abid:5
    v_rcp_f32 v178, v178
    v_mfma_f32_4x4x4_16b_bf16 v[156:159], v[184:185], v[70:71], 0 cbsz:4 abid:5
    v_rcp_f32 v179, v179
    v_mfma_f32_4x4x4_16b_bf16 v[160:163], v[184:185], v[72:73], 0 cbsz:4 abid:6
    v_rcp_f32 v180, v180
    v_mfma_f32_4x4x4_16b_bf16 v[164:167], v[184:185], v[74:75], 0 cbsz:4 abid:6
    v_rcp_f32 v181, v181
    v_mfma_f32_4x4x4_16b_bf16 v[168:171], v[184:185], v[76:77], 0 cbsz:4 abid:7
    v_rcp_f32 v182, v182
    v_mfma_f32_4x4x4_16b_bf16 v[172:175], v[184:185], v[78:79], 0 cbsz:4 abid:7
    v_rcp_f32 v183, v183
    v_readlane_b32 s76, v228, 48
    v_readlane_b32 s77, v228, 52
    v_readlane_b32 s78, v228, 56
    v_readlane_b32 s79, v228, 60
    v_pk_mul_f32 v[176:177], v[176:177], v[84:85]
    v_pk_mul_f32 v[178:179], v[178:179], v[86:87]
    v_pk_mul_f32 v[180:181], v[180:181], v[100:101]
    v_pk_mul_f32 v[182:183], v[182:183], v[102:103]
    s_set_gpr_idx_on s68, gpr_idx(SRC2,DST)
    v_pk_fma_f32 v[8:9], v[176:177], v[144:145], v[8:9] op_sel:[0,0,0] op_sel_hi:[0,1,1]
    v_pk_fma_f32 v[10:11], v[176:177], v[146:147], v[10:11] op_sel:[0,0,0] op_sel_hi:[0,1,1]
    v_pk_fma_f32 v[12:13], v[180:181], v[148:149], v[12:13] op_sel:[0,0,0] op_sel_hi:[0,1,1]
    v_pk_fma_f32 v[14:15], v[180:181], v[150:151], v[14:15] op_sel:[0,0,0] op_sel_hi:[0,1,1]
    s_set_gpr_idx_idx s69
    v_pk_fma_f32 v[8:9], v[176:177], v[152:153], v[8:9] op_sel:[1,0,0] op_sel_hi:[1,1,1]
    v_pk_fma_f32 v[10:11], v[176:177], v[154:155], v[10:11] op_sel:[1,0,0] op_sel_hi:[1,1,1]
    v_pk_fma_f32 v[12:13], v[180:181], v[156:157], v[12:13] op_sel:[1,0,0] op_sel_hi:[1,1,1]
    v_pk_fma_f32 v[14:15], v[180:181], v[158:159], v[14:15] op_sel:[1,0,0] op_sel_hi:[1,1,1]
    s_set_gpr_idx_idx s70
    v_pk_fma_f32 v[8:9], v[178:179], v[160:161], v[8:9] op_sel:[0,0,0] op_sel_hi:[0,1,1]
    v_pk_fma_f32 v[10:11], v[178:179], v[162:163], v[10:11] op_sel:[0,0,0] op_sel_hi:[0,1,1]
    v_pk_fma_f32 v[12:13], v[182:183], v[164:165], v[12:13] op_sel:[0,0,0] op_sel_hi:[0,1,1]
    v_pk_fma_f32 v[14:15], v[182:183], v[166:167], v[14:15] op_sel:[0,0,0] op_sel_hi:[0,1,1]
    s_set_gpr_idx_idx s71
    v_pk_fma_f32 v[8:9], v[178:179], v[168:169], v[8:9] op_sel:[1,0,0] op_sel_hi:[1,1,1]
    v_pk_fma_f32 v[10:11], v[178:179], v[170:171], v[10:11] op_sel:[1,0,0] op_sel_hi:[1,1,1]
    v_pk_fma_f32 v[12:13], v[182:183], v[172:173], v[12:13] op_sel:[1,0,0] op_sel_hi:[1,1,1]
    v_pk_fma_f32 v[14:15], v[182:183], v[174:175], v[14:15] op_sel:[1,0,0] op_sel_hi:[1,1,1]
    s_set_gpr_idx_off
    s_and_b32 s80, s76, s31
    s_and_b32 s81, s77, s31
    s_and_b32 s82, s78, s31
    s_and_b32 s83, s79, s31
    buffer_load_dwordx4 v[64:67], v232, s[4:7], s80 offen
    buffer_load_dwordx4 v[68:71], v232, s[4:7], s81 offen
    buffer_load_dwordx4 v[72:75], v232, s[4:7], s82 offen
    buffer_load_dwordx4 v[76:79], v232, s[4:7], s83 offen
    s_cmp_le_i32 s30, 8
    s_waitcnt lgkmcnt(0)
    s_cbranch_scc1 L_exit
    s_setprio 1
    v_mfma_f32_32x32x16_bf16 v[112:127], v[196:199], v[208:211], v[112:127]
    v_exp_f32 v176, v88
    v_exp_f32 v177, v89
    v_exp_f32 v178, v90
    v_exp_f32 v179, v91
    v_exp_f32 v180, v104
    v_exp_f32 v181, v105
    v_exp_f32 v182, v106
    v_exp_f32 v183, v107
    v_pk_fma_f32 v[176:177], v[176:177], s[56:57], s[56:57]
    v_pk_fma_f32 v[178:179], v[178:179], s[56:57], s[56:57]
    v_pk_fma_f32 v[180:181], v[180:181], s[56:57], s[56:57]
    v_pk_fma_f32 v[182:183], v[182:183], s[56:57], s[56:57]
    s_waitcnt vmcnt(4)
    v_mfma_f32_4x4x4_16b_bf16 v[144:147], v[184:185], v[48:49], 0 cbsz:4 abid:8
    v_rcp_f32 v176, v176
    v_mfma_f32_4x4x4_16b_bf16 v[148:151], v[184:185], v[50:51], 0 cbsz:4 abid:8
    v_rcp_f32 v177, v177
    v_mfma_f32_4x4x4_16b_bf16 v[152:155], v[184:185], v[52:53], 0 cbsz:4 abid:9
    v_rcp_f32 v178, v178
    v_mfma_f32_4x4x4_16b_bf16 v[156:159], v[184:185], v[54:55], 0 cbsz:4 abid:9
    v_rcp_f32 v179, v179
    v_mfma_f32_4x4x4_16b_bf16 v[160:163], v[184:185], v[56:57], 0 cbsz:4 abid:10
    v_rcp_f32 v180, v180
    v_mfma_f32_4x4x4_16b_bf16 v[164:167], v[184:185], v[58:59], 0 cbsz:4 abid:10
    v_rcp_f32 v181, v181
    v_mfma_f32_4x4x4_16b_bf16 v[168:171], v[184:185], v[60:61], 0 cbsz:4 abid:11
    v_rcp_f32 v182, v182
    v_mfma_f32_4x4x4_16b_bf16 v[172:175], v[184:185], v[62:63], 0 cbsz:4 abid:11
    v_rcp_f32 v183, v183
    v_readlane_b32 s64, v228, 1
    v_readlane_b32 s65, v228, 5
    v_readlane_b32 s66, v228, 9
    v_readlane_b32 s67, v228, 13
    v_and_or_b32 v229, v2, s33, v233
    v_pk_mul_f32 v[176:177], v[176:177], v[88:89]
    v_pk_mul_f32 v[178:179], v[178:179], v[90:91]
    v_pk_mul_f32 v[180:181], v[180:181], v[104:105]
    v_pk_mul_f32 v[182:183], v[182:183], v[106:107]
    s_set_gpr_idx_on s72, gpr_idx(SRC2,DST)
    v_pk_fma_f32 v[8:9], v[176:177], v[144:145], v[8:9] op_sel:[0,0,0] op_sel_hi:[0,1,1]
    v_pk_fma_f32 v[10:11], v[176:177], v[146:147], v[10:11] op_sel:[0,0,0] op_sel_hi:[0,1,1]
    v_pk_fma_f32 v[12:13], v[180:181], v[148:149], v[12:13] op_sel:[0,0,0] op_sel_hi:[0,1,1]
    v_pk_fma_f32 v[14:15], v[180:181], v[150:151], v[14:15] op_sel:[0,0,0] op_sel_hi:[0,1,1]
    s_set_gpr_idx_idx s73
    v_pk_fma_f32 v[8:9], v[176:177], v[152:153], v[8:9] op_sel:[1,0,0] op_sel_hi:[1,1,1]
    v_pk_fma_f32 v[10:11], v[176:177], v[154:155], v[10:11] op_sel:[1,0,0] op_sel_hi:[1,1,1]
    v_pk_fma_f32 v[12:13], v[180:181], v[156:157], v[12:13] op_sel:[1,0,0] op_sel_hi:[1,1,1]
    v_pk_fma_f32 v[14:15], v[180:181], v[158:159], v[14:15] op_sel:[1,0,0] op_sel_hi:[1,1,1]
    s_set_gpr_idx_idx s74
    v_pk_fma_f32 v[8:9], v[178:179], v[160:161], v[8:9] op_sel:[0,0,0] op_sel_hi:[0,1,1]
    v_pk_fma_f32 v[10:11], v[178:179], v[162:163], v[10:11] op_sel:[0,0,0] op_sel_hi:[0,1,1]
    v_pk_fma_f32 v[12:13], v[182:183], v[164:165], v[12:13] op_sel:[0,0,0] op_sel_hi:[0,1,1]
    v_pk_fma_f32 v[14:15], v[182:183], v[166:167], v[14:15] op_sel:[0,0,0] op_sel_hi:[0,1,1]
    s_set_gpr_idx_idx s75
    v_pk_fma_f32 v[8:9], v[178:179], v[168:169], v[8:9] op_sel:[1,0,0] op_sel_hi:[1,1,1]
    v_pk_fma_f32 v[10:11], v[178:179], v[170:171], v[10:11] op_sel:[1,0,0] op_sel_hi:[1,1,1]
    v_pk_fma_f32 v[12:13], v[182:183], v[172:173], v[12:13] op_sel:[1,0,0] op_sel_hi:[1,1,1]
    v_pk_fma_f32 v[14:15], v[182:183], v[174:175], v[14:15] op_sel:[1,0,0] op_sel_hi:[1,1,1]
    s_set_gpr_idx_off
    s_and_b32 s80, s64, s31
    s_and_b32 s81, s65, s31
    s_and_b32 s82, s66, s31
    s_and_b32 s83, s67, s31
    buffer_load_dwordx4 v[48:51], v232, s[4:7], s80 offen
    buffer_load_dwordx4 v[52:55], v232, s[4:7], s81 offen
    buffer_load_dwordx4 v[56:59], v232, s[4:7], s82 offen
    buffer_load_dwordx4 v[60:63], v232, s[4:7], s83 offen
    s_cmp_le_i32 s30, 12
    s_mov_b64 exec, s[20:21]
    ds_read_b128 v[192:195], v229 offset:46080
    s_mov_b64 exec, -1
    s_cbranch_scc1 L_exit
    s_setprio 0
    v_mfma_f32_32x32x16_bf16 v[128:143], v[196:199], v[212:215], v[128:143]
    v_exp_f32 v176, v92
    v_exp_f32 v177, v93
    v_exp_f32 v178, v94
    v_exp_f32 v179, v95
    v_exp_f32 v180, v108
    v_exp_f32 v181, v109
    v_exp_f32 v182, v110
    v_exp_f32 v183, v111
    v_pk_fma_f32 v[176:177], v[176:177], s[56:57], s[56:57]
    v_pk_fma_f32 v[178:179], v[178:179], s[56:57], s[56:57]
    v_pk_fma_f32 v[180:181], v[180:181], s[56:57], s[56:57]
    v_pk_fma_f32 v[182:183], v[182:183], s[56:57], s[56:57]
    s_waitcnt vmcnt(4)
    v_mfma_f32_4x4x4_16b_bf16 v[144:147], v[184:185], v[64:65], 0 cbsz:4 abid:12
    v_rcp_f32 v176, v176
    v_mfma_f32_4x4x4_16b_bf16 v[148:151], v[184:185], v[66:67], 0 cbsz:4 abid:12
    v_rcp_f32 v177, v177
    v_mfma_f32_4x4x4_16b_bf16 v[152:155], v[184:185], v[68:69], 0 cbsz:4 abid:13
    v_rcp_f32 v178, v178
    v_mfma_f32_4x4x4_16b_bf16 v[156:159], v[184:185], v[70:71], 0 cbsz:4 abid:13
    v_rcp_f32 v179, v179
    v_mfma_f32_4x4x4_16b_bf16 v[160:163], v[184:185], v[72:73], 0 cbsz:4 abid:14
    v_rcp_f32 v180, v180
    v_mfma_f32_4x4x4_16b_bf16 v[164:167], v[184:185], v[74:75], 0 cbsz:4 abid:14
    v_rcp_f32 v181, v181
    v_mfma_f32_4x4x4_16b_bf16 v[168:171], v[184:185], v[76:77], 0 cbsz:4 abid:15
    v_rcp_f32 v182, v182
    v_mfma_f32_4x4x4_16b_bf16 v[172:175], v[184:185], v[78:79], 0 cbsz:4 abid:15
    v_rcp_f32 v183, v183
    v_readlane_b32 s68, v228, 17
    v_readlane_b32 s69, v228, 21
    v_readlane_b32 s70, v228, 25
    v_readlane_b32 s71, v228, 29
    v_pk_mul_f32 v[176:177], v[176:177], v[92:93]
    v_pk_mul_f32 v[178:179], v[178:179], v[94:95]
    v_pk_mul_f32 v[180:181], v[180:181], v[108:109]
    v_pk_mul_f32 v[182:183], v[182:183], v[110:111]
    s_set_gpr_idx_on s76, gpr_idx(SRC2,DST)
    v_pk_fma_f32 v[8:9], v[176:177], v[144:145], v[8:9] op_sel:[0,0,0] op_sel_hi:[0,1,1]
    v_pk_fma_f32 v[10:11], v[176:177], v[146:147], v[10:11] op_sel:[0,0,0] op_sel_hi:[0,1,1]
    v_pk_fma_f32 v[12:13], v[180:181], v[148:149], v[12:13] op_sel:[0,0,0] op_sel_hi:[0,1,1]
    v_pk_fma_f32 v[14:15], v[180:181], v[150:151], v[14:15] op_sel:[0,0,0] op_sel_hi:[0,1,1]
    s_set_gpr_idx_idx s77
    v_pk_fma_f32 v[8:9], v[176:177], v[152:153], v[8:9] op_sel:[1,0,0] op_sel_hi:[1,1,1]
    v_pk_fma_f32 v[10:11], v[176:177], v[154:155], v[10:11] op_sel:[1,0,0] op_sel_hi:[1,1,1]
    v_pk_fma_f32 v[12:13], v[180:181], v[156:157], v[12:13] op_sel:[1,0,0] op_sel_hi:[1,1,1]
    v_pk_fma_f32 v[14:15], v[180:181], v[158:159], v[14:15] op_sel:[1,0,0] op_sel_hi:[1,1,1]
    s_set_gpr_idx_idx s78
    v_pk_fma_f32 v[8:9], v[178:179], v[160:161], v[8:9] op_sel:[0,0,0] op_sel_hi:[0,1,1]
    v_pk_fma_f32 v[10:11], v[178:179], v[162:163], v[10:11] op_sel:[0,0,0] op_sel_hi:[0,1,1]
    v_pk_fma_f32 v[12:13], v[182:183], v[164:165], v[12:13] op_sel:[0,0,0] op_sel_hi:[0,1,1]
    v_pk_fma_f32 v[14:15], v[182:183], v[166:167], v[14:15] op_sel:[0,0,0] op_sel_hi:[0,1,1]
    s_set_gpr_idx_idx s79
    v_pk_fma_f32 v[8:9], v[178:179], v[168:169], v[8:9] op_sel:[1,0,0] op_sel_hi:[1,1,1]
    v_pk_fma_f32 v[10:11], v[178:179], v[170:171], v[10:11] op_sel:[1,0,0] op_sel_hi:[1,1,1]
    v_pk_fma_f32 v[12:13], v[182:183], v[172:173], v[12:13] op_sel:[1,0,0] op_sel_hi:[1,1,1]
    v_pk_fma_f32 v[14:15], v[182:183], v[174:175], v[14:15] op_sel:[1,0,0] op_sel_hi:[1,1,1]
    s_set_gpr_idx_off
    s_and_b32 s80, s68, s31
    s_and_b32 s81, s69, s31
    s_and_b32 s82, s70, s31
    s_and_b32 s83, s71, s31
    buffer_load_dwordx4 v[64:67], v232, s[4:7], s80 offen
    buffer_load_dwordx4 v[68:71], v232, s[4:7], s81 offen
    buffer_load_dwordx4 v[72:75], v232, s[4:7], s82 offen
    buffer_load_dwordx4 v[76:79], v232, s[4:7], s83 offen
    s_cmp_le_i32 s30, 16
    s_waitcnt lgkmcnt(0)
    s_cbranch_scc1 L_exit
    s_setprio 3
    v_mfma_f32_32x32x16_bf16 v[80:95], v[192:195], v[200:203], 0
    v_exp_f32 v176, v112
    v_exp_f32 v177, v113
    v_exp_f32 v178, v114
    v_exp_f32 v179, v115
    v_exp_f32 v180, v128
    v_exp_f32 v181, v129
    v_exp_f32 v182, v130
    v_exp_f32 v183, v131
    v_pk_fma_f32 v[176:177], v[176:177], s[56:57], s[56:57]
    v_pk_fma_f32 v[178:179], v[178:179], s[56:57], s[56:57]
    v_pk_fma_f32 v[180:181], v[180:181], s[56:57], s[56:57]
    v_pk_fma_f32 v[182:183], v[182:183], s[56:57], s[56:57]
    s_waitcnt vmcnt(4)
    v_mfma_f32_4x4x4_16b_bf16 v[144:147], v[186:187], v[48:49], 0 cbsz:4 abid:0
    v_rcp_f32 v176, v176
    v_mfma_f32_4x4x4_16b_bf16 v[148:151], v[186:187], v[50:51], 0 cbsz:4 abid:0
    v_rcp_f32 v177, v177
    v_mfma_f32_4x4x4_16b_bf16 v[152:155], v[186:187], v[52:53], 0 cbsz:4 abid:1
    v_rcp_f32 v178, v178
    v_mfma_f32_4x4x4_16b_bf16 v[156:159], v[186:187], v[54:55], 0 cbsz:4 abid:1
    v_rcp_f32 v179, v179
    v_mfma_f32_4x4x4_16b_bf16 v[160:163], v[186:187], v[56:57], 0 cbsz:4 abid:2
    v_rcp_f32 v180, v180
    v_mfma_f32_4x4x4_16b_bf16 v[164:167], v[186:187], v[58:59], 0 cbsz:4 abid:2
    v_rcp_f32 v181, v181
    v_mfma_f32_4x4x4_16b_bf16 v[168:171], v[186:187], v[60:61], 0 cbsz:4 abid:3
    v_rcp_f32 v182, v182
    v_mfma_f32_4x4x4_16b_bf16 v[172:175], v[186:187], v[62:63], 0 cbsz:4 abid:3
    v_rcp_f32 v183, v183
    v_readlane_b32 s72, v228, 33
    v_readlane_b32 s73, v228, 37
    v_readlane_b32 s74, v228, 41
    v_readlane_b32 s75, v228, 45
    v_pk_mul_f32 v[176:177], v[176:177], v[112:113]
    v_pk_mul_f32 v[178:179], v[178:179], v[114:115]
    v_pk_mul_f32 v[180:181], v[180:181], v[128:129]
    v_pk_mul_f32 v[182:183], v[182:183], v[130:131]
    s_set_gpr_idx_on s64, gpr_idx(SRC2,DST)
    v_pk_fma_f32 v[8:9], v[176:177], v[144:145], v[8:9] op_sel:[0,0,0] op_sel_hi:[0,1,1]
    v_pk_fma_f32 v[10:11], v[176:177], v[146:147], v[10:11] op_sel:[0,0,0] op_sel_hi:[0,1,1]
    v_pk_fma_f32 v[12:13], v[180:181], v[148:149], v[12:13] op_sel:[0,0,0] op_sel_hi:[0,1,1]
    v_pk_fma_f32 v[14:15], v[180:181], v[150:151], v[14:15] op_sel:[0,0,0] op_sel_hi:[0,1,1]
    s_set_gpr_idx_idx s65
    v_pk_fma_f32 v[8:9], v[176:177], v[152:153], v[8:9] op_sel:[1,0,0] op_sel_hi:[1,1,1]
    v_pk_fma_f32 v[10:11], v[176:177], v[154:155], v[10:11] op_sel:[1,0,0] op_sel_hi:[1,1,1]
    v_pk_fma_f32 v[12:13], v[180:181], v[156:157], v[12:13] op_sel:[1,0,0] op_sel_hi:[1,1,1]
    v_pk_fma_f32 v[14:15], v[180:181], v[158:159], v[14:15] op_sel:[1,0,0] op_sel_hi:[1,1,1]
    s_set_gpr_idx_idx s66
    v_pk_fma_f32 v[8:9], v[178:179], v[160:161], v[8:9] op_sel:[0,0,0] op_sel_hi:[0,1,1]
    v_pk_fma_f32 v[10:11], v[178:179], v[162:163], v[10:11] op_sel:[0,0,0] op_sel_hi:[0,1,1]
    v_pk_fma_f32 v[12:13], v[182:183], v[164:165], v[12:13] op_sel:[0,0,0] op_sel_hi:[0,1,1]
    v_pk_fma_f32 v[14:15], v[182:183], v[166:167], v[14:15] op_sel:[0,0,0] op_sel_hi:[0,1,1]
    s_set_gpr_idx_idx s67
    v_pk_fma_f32 v[8:9], v[178:179], v[168:169], v[8:9] op_sel:[1,0,0] op_sel_hi:[1,1,1]
    v_pk_fma_f32 v[10:11], v[178:179], v[170:171], v[10:11] op_sel:[1,0,0] op_sel_hi:[1,1,1]
    v_pk_fma_f32 v[12:13], v[182:183], v[172:173], v[12:13] op_sel:[1,0,0] op_sel_hi:[1,1,1]
    v_pk_fma_f32 v[14:15], v[182:183], v[174:175], v[14:15] op_sel:[1,0,0] op_sel_hi:[1,1,1]
    s_set_gpr_idx_off
    s_and_b32 s80, s72, s31
    s_and_b32 s81, s73, s31
    s_and_b32 s82, s74, s31
    s_and_b32 s83, s75, s31
    buffer_load_dwordx4 v[48:51], v232, s[4:7], s80 offen
    buffer_load_dwordx4 v[52:55], v232, s[4:7], s81 offen
    buffer_load_dwordx4 v[56:59], v232, s[4:7], s82 offen
    buffer_load_dwordx4 v[60:63], v232, s[4:7], s83 offen
    s_cmp_le_i32 s30, 20
    s_mov_b64 exec, s[22:23]
    ds_read_b128 v[196:199], v229 offset:46080
    s_mov_b64 exec, -1
    ds_read_b32 v2, v231 offset:780
    s_cbranch_scc1 L_exit
    s_setprio 2
    v_mfma_f32_32x32x16_bf16 v[96:111], v[192:195], v[204:207], 0
    v_exp_f32 v176, v116
    v_exp_f32 v177, v117
    v_exp_f32 v178, v118
    v_exp_f32 v179, v119
    v_exp_f32 v180, v132
    v_exp_f32 v181, v133
    v_exp_f32 v182, v134
    v_exp_f32 v183, v135
    v_pk_fma_f32 v[176:177], v[176:177], s[56:57], s[56:57]
    v_pk_fma_f32 v[178:179], v[178:179], s[56:57], s[56:57]
    v_pk_fma_f32 v[180:181], v[180:181], s[56:57], s[56:57]
    v_pk_fma_f32 v[182:183], v[182:183], s[56:57], s[56:57]
    s_waitcnt vmcnt(4)
    v_mfma_f32_4x4x4_16b_bf16 v[144:147], v[186:187], v[64:65], 0 cbsz:4 abid:4
    v_rcp_f32 v176, v176
    v_mfma_f32_4x4x4_16b_bf16 v[148:151], v[186:187], v[66:67], 0 cbsz:4 abid:4
    v_rcp_f32 v177, v177
    v_mfma_f32_4x4x4_16b_bf16 v[152:155], v[186:187], v[68:69], 0 cbsz:4 abid:5
    v_rcp_f32 v178, v178
    v_mfma_f32_4x4x4_16b_bf16 v[156:159], v[186:187], v[70:71], 0 cbsz:4 abid:5
    v_rcp_f32 v179, v179
    v_mfma_f32_4x4x4_16b_bf16 v[160:163], v[186:187], v[72:73], 0 cbsz:4 abid:6
    v_rcp_f32 v180, v180
    v_mfma_f32_4x4x4_16b_bf16 v[164:167], v[186:187], v[74:75], 0 cbsz:4 abid:6
    v_rcp_f32 v181, v181
    v_mfma_f32_4x4x4_16b_bf16 v[168:171], v[186:187], v[76:77], 0 cbsz:4 abid:7
    v_rcp_f32 v182, v182
    v_mfma_f32_4x4x4_16b_bf16 v[172:175], v[186:187], v[78:79], 0 cbsz:4 abid:7
    v_rcp_f32 v183, v183
    v_readlane_b32 s76, v228, 49
    v_readlane_b32 s77, v228, 53
    v_readlane_b32 s78, v228, 57
    v_readlane_b32 s79, v228, 61
    v_pk_mul_f32 v[176:177], v[176:177], v[116:117]
    v_pk_mul_f32 v[178:179], v[178:179], v[118:119]
    v_pk_mul_f32 v[180:181], v[180:181], v[132:133]
    v_pk_mul_f32 v[182:183], v[182:183], v[134:135]
    s_set_gpr_idx_on s68, gpr_idx(SRC2,DST)
    v_pk_fma_f32 v[8:9], v[176:177], v[144:145], v[8:9] op_sel:[0,0,0] op_sel_hi:[0,1,1]
    v_pk_fma_f32 v[10:11], v[176:177], v[146:147], v[10:11] op_sel:[0,0,0] op_sel_hi:[0,1,1]
    v_pk_fma_f32 v[12:13], v[180:181], v[148:149], v[12:13] op_sel:[0,0,0] op_sel_hi:[0,1,1]
    v_pk_fma_f32 v[14:15], v[180:181], v[150:151], v[14:15] op_sel:[0,0,0] op_sel_hi:[0,1,1]
    s_set_gpr_idx_idx s69
    v_pk_fma_f32 v[8:9], v[176:177], v[152:153], v[8:9] op_sel:[1,0,0] op_sel_hi:[1,1,1]
    v_pk_fma_f32 v[10:11], v[176:177], v[154:155], v[10:11] op_sel:[1,0,0] op_sel_hi:[1,1,1]
    v_pk_fma_f32 v[12:13], v[180:181], v[156:157], v[12:13] op_sel:[1,0,0] op_sel_hi:[1,1,1]
    v_pk_fma_f32 v[14:15], v[180:181], v[158:159], v[14:15] op_sel:[1,0,0] op_sel_hi:[1,1,1]
    s_set_gpr_idx_idx s70
    v_pk_fma_f32 v[8:9], v[178:179], v[160:161], v[8:9] op_sel:[0,0,0] op_sel_hi:[0,1,1]
    v_pk_fma_f32 v[10:11], v[178:179], v[162:163], v[10:11] op_sel:[0,0,0] op_sel_hi:[0,1,1]
    v_pk_fma_f32 v[12:13], v[182:183], v[164:165], v[12:13] op_sel:[0,0,0] op_sel_hi:[0,1,1]
    v_pk_fma_f32 v[14:15], v[182:183], v[166:167], v[14:15] op_sel:[0,0,0] op_sel_hi:[0,1,1]
    s_set_gpr_idx_idx s71
    v_pk_fma_f32 v[8:9], v[178:179], v[168:169], v[8:9] op_sel:[1,0,0] op_sel_hi:[1,1,1]
    v_pk_fma_f32 v[10:11], v[178:179], v[170:171], v[10:11] op_sel:[1,0,0] op_sel_hi:[1,1,1]
    v_pk_fma_f32 v[12:13], v[182:183], v[172:173], v[12:13] op_sel:[1,0,0] op_sel_hi:[1,1,1]
    v_pk_fma_f32 v[14:15], v[182:183], v[174:175], v[14:15] op_sel:[1,0,0] op_sel_hi:[1,1,1]
    s_set_gpr_idx_off
    s_and_b32 s80, s76, s31
    s_and_b32 s81, s77, s31
    s_and_b32 s82, s78, s31
    s_and_b32 s83, s79, s31
    buffer_load_dwordx4 v[64:67], v232, s[4:7], s80 offen
    buffer_load_dwordx4 v[68:71], v232, s[4:7], s81 offen
    buffer_load_dwordx4 v[72:75], v232, s[4:7], s82 offen
    buffer_load_dwordx4 v[76:79], v232, s[4:7], s83 offen
    s_cmp_le_i32 s30, 24
    s_waitcnt lgkmcnt(0)
    s_cbranch_scc1 L_exit
    s_setprio 1
    v_mfma_f32_32x32x16_bf16 v[80:95], v[196:199], v[208:211], v[80:95]
    v_exp_f32 v176, v120
    v_exp_f32 v177, v121
    v_exp_f32 v178, v122
    v_exp_f32 v179, v123
    v_exp_f32 v180, v136
    v_exp_f32 v181, v137
    v_exp_f32 v182, v138
    v_exp_f32 v183, v139
    v_pk_fma_f32 v[176:177], v[176:177], s[56:57], s[56:57]
    v_pk_fma_f32 v[178:179], v[178:179], s[56:57], s[56:57]
    v_pk_fma_f32 v[180:181], v[180:181], s[56:57], s[56:57]
    v_pk_fma_f32 v[182:183], v[182:183], s[56:57], s[56:57]
    s_waitcnt vmcnt(4)
    v_mfma_f32_4x4x4_16b_bf16 v[144:147], v[186:187], v[48:49], 0 cbsz:4 abid:8
    v_rcp_f32 v176, v176
    v_mfma_f32_4x4x4_16b_bf16 v[148:151], v[186:187], v[50:51], 0 cbsz:4 abid:8
    v_rcp_f32 v177, v177
    v_mfma_f32_4x4x4_16b_bf16 v[152:155], v[186:187], v[52:53], 0 cbsz:4 abid:9
    v_rcp_f32 v178, v178
    v_mfma_f32_4x4x4_16b_bf16 v[156:159], v[186:187], v[54:55], 0 cbsz:4 abid:9
    v_rcp_f32 v179, v179
    v_mfma_f32_4x4x4_16b_bf16 v[160:163], v[186:187], v[56:57], 0 cbsz:4 abid:10
    v_rcp_f32 v180, v180
    v_mfma_f32_4x4x4_16b_bf16 v[164:167], v[186:187], v[58:59], 0 cbsz:4 abid:10
    v_rcp_f32 v181, v181
    v_mfma_f32_4x4x4_16b_bf16 v[168:171], v[186:187], v[60:61], 0 cbsz:4 abid:11
    v_rcp_f32 v182, v182
    v_mfma_f32_4x4x4_16b_bf16 v[172:175], v[186:187], v[62:63], 0 cbsz:4 abid:11
    v_rcp_f32 v183, v183
    v_readlane_b32 s64, v228, 2
    v_readlane_b32 s65, v228, 6
    v_readlane_b32 s66, v228, 10
    v_readlane_b32 s67, v228, 14
    v_and_or_b32 v229, v2, s33, v233
    v_pk_mul_f32 v[176:177], v[176:177], v[120:121]
    v_pk_mul_f32 v[178:179], v[178:179], v[122:123]
    v_pk_mul_f32 v[180:181], v[180:181], v[136:137]
    v_pk_mul_f32 v[182:183], v[182:183], v[138:139]
    s_set_gpr_idx_on s72, gpr_idx(SRC2,DST)
    v_pk_fma_f32 v[8:9], v[176:177], v[144:145], v[8:9] op_sel:[0,0,0] op_sel_hi:[0,1,1]
    v_pk_fma_f32 v[10:11], v[176:177], v[146:147], v[10:11] op_sel:[0,0,0] op_sel_hi:[0,1,1]
    v_pk_fma_f32 v[12:13], v[180:181], v[148:149], v[12:13] op_sel:[0,0,0] op_sel_hi:[0,1,1]
    v_pk_fma_f32 v[14:15], v[180:181], v[150:151], v[14:15] op_sel:[0,0,0] op_sel_hi:[0,1,1]
    s_set_gpr_idx_idx s73
    v_pk_fma_f32 v[8:9], v[176:177], v[152:153], v[8:9] op_sel:[1,0,0] op_sel_hi:[1,1,1]
    v_pk_fma_f32 v[10:11], v[176:177], v[154:155], v[10:11] op_sel:[1,0,0] op_sel_hi:[1,1,1]
    v_pk_fma_f32 v[12:13], v[180:181], v[156:157], v[12:13] op_sel:[1,0,0] op_sel_hi:[1,1,1]
    v_pk_fma_f32 v[14:15], v[180:181], v[158:159], v[14:15] op_sel:[1,0,0] op_sel_hi:[1,1,1]
    s_set_gpr_idx_idx s74
    v_pk_fma_f32 v[8:9], v[178:179], v[160:161], v[8:9] op_sel:[0,0,0] op_sel_hi:[0,1,1]
    v_pk_fma_f32 v[10:11], v[178:179], v[162:163], v[10:11] op_sel:[0,0,0] op_sel_hi:[0,1,1]
    v_pk_fma_f32 v[12:13], v[182:183], v[164:165], v[12:13] op_sel:[0,0,0] op_sel_hi:[0,1,1]
    v_pk_fma_f32 v[14:15], v[182:183], v[166:167], v[14:15] op_sel:[0,0,0] op_sel_hi:[0,1,1]
    s_set_gpr_idx_idx s75
    v_pk_fma_f32 v[8:9], v[178:179], v[168:169], v[8:9] op_sel:[1,0,0] op_sel_hi:[1,1,1]
    v_pk_fma_f32 v[10:11], v[178:179], v[170:171], v[10:11] op_sel:[1,0,0] op_sel_hi:[1,1,1]
    v_pk_fma_f32 v[12:13], v[182:183], v[172:173], v[12:13] op_sel:[1,0,0] op_sel_hi:[1,1,1]
    v_pk_fma_f32 v[14:15], v[182:183], v[174:175], v[14:15] op_sel:[1,0,0] op_sel_hi:[1,1,1]
    s_set_gpr_idx_off
    s_and_b32 s80, s64, s31
    s_and_b32 s81, s65, s31
    s_and_b32 s82, s66, s31
    s_and_b32 s83, s67, s31
    buffer_load_dwordx4 v[48:51], v232, s[4:7], s80 offen
    buffer_load_dwordx4 v[52:55], v232, s[4:7], s81 offen
    buffer_load_dwordx4 v[56:59], v232, s[4:7], s82 offen
    buffer_load_dwordx4 v[60:63], v232, s[4:7], s83 offen
    s_cmp_le_i32 s30, 28
    s_mov_b64 exec, s[20:21]
    ds_read_b128 v[192:195], v229 offset:46080
    s_mov_b64 exec, -1
    s_cbranch_scc1 L_exit
    s_setprio 0
    v_mfma_f32_32x32x16_bf16 v[96:111], v[196:199], v[212:215], v[96:111]
    v_exp_f32 v176, v124
    v_exp_f32 v177, v125
    v_exp_f32 v178, v126
    v_exp_f32 v179, v127
    v_exp_f32 v180, v140
    v_exp_f32 v181, v141
    v_exp_f32 v182, v142
    v_exp_f32 v183, v143
    v_pk_fma_f32 v[176:177], v[176:177], s[56:57], s[56:57]
    v_pk_fma_f32 v[178:179], v[178:179], s[56:57], s[56:57]
    v_pk_fma_f32 v[180:181], v[180:181], s[56:57], s[56:57]
    v_pk_fma_f32 v[182:183], v[182:183], s[56:57], s[56:57]
    s_waitcnt vmcnt(4)
    v_mfma_f32_4x4x4_16b_bf16 v[144:147], v[186:187], v[64:65], 0 cbsz:4 abid:12
    v_rcp_f32 v176, v176
    v_mfma_f32_4x4x4_16b_bf16 v[148:151], v[186:187], v[66:67], 0 cbsz:4 abid:12
    v_rcp_f32 v177, v177
    v_mfma_f32_4x4x4_16b_bf16 v[152:155], v[186:187], v[68:69], 0 cbsz:4 abid:13
    v_rcp_f32 v178, v178
    v_mfma_f32_4x4x4_16b_bf16 v[156:159], v[186:187], v[70:71], 0 cbsz:4 abid:13
    v_rcp_f32 v179, v179
    v_mfma_f32_4x4x4_16b_bf16 v[160:163], v[186:187], v[72:73], 0 cbsz:4 abid:14
    v_rcp_f32 v180, v180
    v_mfma_f32_4x4x4_16b_bf16 v[164:167], v[186:187], v[74:75], 0 cbsz:4 abid:14
    v_rcp_f32 v181, v181
    v_mfma_f32_4x4x4_16b_bf16 v[168:171], v[186:187], v[76:77], 0 cbsz:4 abid:15
    v_rcp_f32 v182, v182
    v_mfma_f32_4x4x4_16b_bf16 v[172:175], v[186:187], v[78:79], 0 cbsz:4 abid:15
    v_rcp_f32 v183, v183
    v_readlane_b32 s68, v228, 18
    v_readlane_b32 s69, v228, 22
    v_readlane_b32 s70, v228, 26
    v_readlane_b32 s71, v228, 30
    v_pk_mul_f32 v[176:177], v[176:177], v[124:125]
    v_pk_mul_f32 v[178:179], v[178:179], v[126:127]
    v_pk_mul_f32 v[180:181], v[180:181], v[140:141]
    v_pk_mul_f32 v[182:183], v[182:183], v[142:143]
    s_set_gpr_idx_on s76, gpr_idx(SRC2,DST)
    v_pk_fma_f32 v[8:9], v[176:177], v[144:145], v[8:9] op_sel:[0,0,0] op_sel_hi:[0,1,1]
    v_pk_fma_f32 v[10:11], v[176:177], v[146:147], v[10:11] op_sel:[0,0,0] op_sel_hi:[0,1,1]
    v_pk_fma_f32 v[12:13], v[180:181], v[148:149], v[12:13] op_sel:[0,0,0] op_sel_hi:[0,1,1]
    v_pk_fma_f32 v[14:15], v[180:181], v[150:151], v[14:15] op_sel:[0,0,0] op_sel_hi:[0,1,1]
    s_set_gpr_idx_idx s77
    v_pk_fma_f32 v[8:9], v[176:177], v[152:153], v[8:9] op_sel:[1,0,0] op_sel_hi:[1,1,1]
    v_pk_fma_f32 v[10:11], v[176:177], v[154:155], v[10:11] op_sel:[1,0,0] op_sel_hi:[1,1,1]
    v_pk_fma_f32 v[12:13], v[180:181], v[156:157], v[12:13] op_sel:[1,0,0] op_sel_hi:[1,1,1]
    v_pk_fma_f32 v[14:15], v[180:181], v[158:159], v[14:15] op_sel:[1,0,0] op_sel_hi:[1,1,1]
    s_set_gpr_idx_idx s78
    v_pk_fma_f32 v[8:9], v[178:179], v[160:161], v[8:9] op_sel:[0,0,0] op_sel_hi:[0,1,1]
    v_pk_fma_f32 v[10:11], v[178:179], v[162:163], v[10:11] op_sel:[0,0,0] op_sel_hi:[0,1,1]
    v_pk_fma_f32 v[12:13], v[182:183], v[164:165], v[12:13] op_sel:[0,0,0] op_sel_hi:[0,1,1]
    v_pk_fma_f32 v[14:15], v[182:183], v[166:167], v[14:15] op_sel:[0,0,0] op_sel_hi:[0,1,1]
    s_set_gpr_idx_idx s79
    v_pk_fma_f32 v[8:9], v[178:179], v[168:169], v[8:9] op_sel:[1,0,0] op_sel_hi:[1,1,1]
    v_pk_fma_f32 v[10:11], v[178:179], v[170:171], v[10:11] op_sel:[1,0,0] op_sel_hi:[1,1,1]
    v_pk_fma_f32 v[12:13], v[182:183], v[172:173], v[12:13] op_sel:[1,0,0] op_sel_hi:[1,1,1]
    v_pk_fma_f32 v[14:15], v[182:183], v[174:175], v[14:15] op_sel:[1,0,0] op_sel_hi:[1,1,1]
    s_set_gpr_idx_off
    s_and_b32 s80, s68, s31
    s_and_b32 s81, s69, s31
    s_and_b32 s82, s70, s31
    s_and_b32 s83, s71, s31
    buffer_load_dwordx4 v[64:67], v232, s[4:7], s80 offen
    buffer_load_dwordx4 v[68:71], v232, s[4:7], s81 offen
    buffer_load_dwordx4 v[72:75], v232, s[4:7], s82 offen
    buffer_load_dwordx4 v[76:79], v232, s[4:7], s83 offen
    s_cmp_le_i32 s30, 32
    s_waitcnt lgkmcnt(0)
    s_cbranch_scc1 L_exit
    s_setprio 3
    v_mfma_f32_32x32x16_bf16 v[112:127], v[192:195], v[200:203], 0
    v_exp_f32 v176, v80
    v_exp_f32 v177, v81
    v_exp_f32 v178, v82
    v_exp_f32 v179, v83
    v_exp_f32 v180, v96
    v_exp_f32 v181, v97
    v_exp_f32 v182, v98
    v_exp_f32 v183, v99
    v_pk_fma_f32 v[176:177], v[176:177], s[56:57], s[56:57]
    v_pk_fma_f32 v[178:179], v[178:179], s[56:57], s[56:57]
    v_pk_fma_f32 v[180:181], v[180:181], s[56:57], s[56:57]
    v_pk_fma_f32 v[182:183], v[182:183], s[56:57], s[56:57]
    s_waitcnt vmcnt(4)
    v_mfma_f32_4x4x4_16b_bf16 v[144:147], v[188:189], v[48:49], 0 cbsz:4 abid:0
    v_rcp_f32 v176, v176
    v_mfma_f32_4x4x4_16b_bf16 v[148:151], v[188:189], v[50:51], 0 cbsz:4 abid:0
    v_rcp_f32 v177, v177
    v_mfma_f32_4x4x4_16b_bf16 v[152:155], v[188:189], v[52:53], 0 cbsz:4 abid:1
    v_rcp_f32 v178, v178
    v_mfma_f32_4x4x4_16b_bf16 v[156:159], v[188:189], v[54:55], 0 cbsz:4 abid:1
    v_rcp_f32 v179, v179
    v_mfma_f32_4x4x4_16b_bf16 v[160:163], v[188:189], v[56:57], 0 cbsz:4 abid:2
    v_rcp_f32 v180, v180
    v_mfma_f32_4x4x4_16b_bf16 v[164:167], v[188:189], v[58:59], 0 cbsz:4 abid:2
    v_rcp_f32 v181, v181
    v_mfma_f32_4x4x4_16b_bf16 v[168:171], v[188:189], v[60:61], 0 cbsz:4 abid:3
    v_rcp_f32 v182, v182
    v_mfma_f32_4x4x4_16b_bf16 v[172:175], v[188:189], v[62:63], 0 cbsz:4 abid:3
    v_rcp_f32 v183, v183
    v_readlane_b32 s72, v228, 34
    v_readlane_b32 s73, v228, 38
    v_readlane_b32 s74, v228, 42
    v_readlane_b32 s75, v228, 46
    v_pk_mul_f32 v[176:177], v[176:177], v[80:81]
    v_pk_mul_f32 v[178:179], v[178:179], v[82:83]
    v_pk_mul_f32 v[180:181], v[180:181], v[96:97]
    v_pk_mul_f32 v[182:183], v[182:183], v[98:99]
    s_set_gpr_idx_on s64, gpr_idx(SRC2,DST)
    v_pk_fma_f32 v[8:9], v[176:177], v[144:145], v[8:9] op_sel:[0,0,0] op_sel_hi:[0,1,1]
    v_pk_fma_f32 v[10:11], v[176:177], v[146:147], v[10:11] op_sel:[0,0,0] op_sel_hi:[0,1,1]
    v_pk_fma_f32 v[12:13], v[180:181], v[148:149], v[12:13] op_sel:[0,0,0] op_sel_hi:[0,1,1]
    v_pk_fma_f32 v[14:15], v[180:181], v[150:151], v[14:15] op_sel:[0,0,0] op_sel_hi:[0,1,1]
    s_set_gpr_idx_idx s65
    v_pk_fma_f32 v[8:9], v[176:177], v[152:153], v[8:9] op_sel:[1,0,0] op_sel_hi:[1,1,1]
    v_pk_fma_f32 v[10:11], v[176:177], v[154:155], v[10:11] op_sel:[1,0,0] op_sel_hi:[1,1,1]
    v_pk_fma_f32 v[12:13], v[180:181], v[156:157], v[12:13] op_sel:[1,0,0] op_sel_hi:[1,1,1]
    v_pk_fma_f32 v[14:15], v[180:181], v[158:159], v[14:15] op_sel:[1,0,0] op_sel_hi:[1,1,1]
    s_set_gpr_idx_idx s66
    v_pk_fma_f32 v[8:9], v[178:179], v[160:161], v[8:9] op_sel:[0,0,0] op_sel_hi:[0,1,1]
    v_pk_fma_f32 v[10:11], v[178:179], v[162:163], v[10:11] op_sel:[0,0,0] op_sel_hi:[0,1,1]
    v_pk_fma_f32 v[12:13], v[182:183], v[164:165], v[12:13] op_sel:[0,0,0] op_sel_hi:[0,1,1]
    v_pk_fma_f32 v[14:15], v[182:183], v[166:167], v[14:15] op_sel:[0,0,0] op_sel_hi:[0,1,1]
    s_set_gpr_idx_idx s67
    v_pk_fma_f32 v[8:9], v[178:179], v[168:169], v[8:9] op_sel:[1,0,0] op_sel_hi:[1,1,1]
    v_pk_fma_f32 v[10:11], v[178:179], v[170:171], v[10:11] op_sel:[1,0,0] op_sel_hi:[1,1,1]
    v_pk_fma_f32 v[12:13], v[182:183], v[172:173], v[12:13] op_sel:[1,0,0] op_sel_hi:[1,1,1]
    v_pk_fma_f32 v[14:15], v[182:183], v[174:175], v[14:15] op_sel:[1,0,0] op_sel_hi:[1,1,1]
    s_set_gpr_idx_off
    s_and_b32 s80, s72, s31
    s_and_b32 s81, s73, s31
    s_and_b32 s82, s74, s31
    s_and_b32 s83, s75, s31
    buffer_load_dwordx4 v[48:51], v232, s[4:7], s80 offen
    buffer_load_dwordx4 v[52:55], v232, s[4:7], s81 offen
    buffer_load_dwordx4 v[56:59], v232, s[4:7], s82 offen
    buffer_load_dwordx4 v[60:63], v232, s[4:7], s83 offen
    s_cmp_le_i32 s30, 36
    s_mov_b64 exec, s[22:23]
    ds_read_b128 v[196:199], v229 offset:46080
    s_mov_b64 exec, -1
    ds_read_b32 v2, v231 offset:1036
    s_cbranch_scc1 L_exit
    s_setprio 2
    v_mfma_f32_32x32x16_bf16 v[128:143], v[192:195], v[204:207], 0
    v_exp_f32 v176, v84
    v_exp_f32 v177, v85
    v_exp_f32 v178, v86
    v_exp_f32 v179, v87
    v_exp_f32 v180, v100
    v_exp_f32 v181, v101
    v_exp_f32 v182, v102
    v_exp_f32 v183, v103
    v_pk_fma_f32 v[176:177], v[176:177], s[56:57], s[56:57]
    v_pk_fma_f32 v[178:179], v[178:179], s[56:57], s[56:57]
    v_pk_fma_f32 v[180:181], v[180:181], s[56:57], s[56:57]
    v_pk_fma_f32 v[182:183], v[182:183], s[56:57], s[56:57]
    s_waitcnt vmcnt(4)
    v_mfma_f32_4x4x4_16b_bf16 v[144:147], v[188:189], v[64:65], 0 cbsz:4 abid:4
    v_rcp_f32 v176, v176
    v_mfma_f32_4x4x4_16b_bf16 v[148:151], v[188:189], v[66:67], 0 cbsz:4 abid:4
    v_rcp_f32 v177, v177
    v_mfma_f32_4x4x4_16b_bf16 v[152:155], v[188:189], v[68:69], 0 cbsz:4 abid:5
    v_rcp_f32 v178, v178
    v_mfma_f32_4x4x4_16b_bf16 v[156:159], v[188:189], v[70:71], 0 cbsz:4 abid:5
    v_rcp_f32 v179, v179
    v_mfma_f32_4x4x4_16b_bf16 v[160:163], v[188:189], v[72:73], 0 cbsz:4 abid:6
    v_rcp_f32 v180, v180
    v_mfma_f32_4x4x4_16b_bf16 v[164:167], v[188:189], v[74:75], 0 cbsz:4 abid:6
    v_rcp_f32 v181, v181
    v_mfma_f32_4x4x4_16b_bf16 v[168:171], v[188:189], v[76:77], 0 cbsz:4 abid:7
    v_rcp_f32 v182, v182
    v_mfma_f32_4x4x4_16b_bf16 v[172:175], v[188:189], v[78:79], 0 cbsz:4 abid:7
    v_rcp_f32 v183, v183
    v_readlane_b32 s76, v228, 50
    v_readlane_b32 s77, v228, 54
    v_readlane_b32 s78, v228, 58
    v_readlane_b32 s79, v228, 62
    v_pk_mul_f32 v[176:177], v[176:177], v[84:85]
    v_pk_mul_f32 v[178:179], v[178:179], v[86:87]
    v_pk_mul_f32 v[180:181], v[180:181], v[100:101]
    v_pk_mul_f32 v[182:183], v[182:183], v[102:103]
    s_set_gpr_idx_on s68, gpr_idx(SRC2,DST)
    v_pk_fma_f32 v[8:9], v[176:177], v[144:145], v[8:9] op_sel:[0,0,0] op_sel_hi:[0,1,1]
    v_pk_fma_f32 v[10:11], v[176:177], v[146:147], v[10:11] op_sel:[0,0,0] op_sel_hi:[0,1,1]
    v_pk_fma_f32 v[12:13], v[180:181], v[148:149], v[12:13] op_sel:[0,0,0] op_sel_hi:[0,1,1]
    v_pk_fma_f32 v[14:15], v[180:181], v[150:151], v[14:15] op_sel:[0,0,0] op_sel_hi:[0,1,1]
    s_set_gpr_idx_idx s69
    v_pk_fma_f32 v[8:9], v[176:177], v[152:153], v[8:9] op_sel:[1,0,0] op_sel_hi:[1,1,1]
    v_pk_fma_f32 v[10:11], v[176:177], v[154:155], v[10:11] op_sel:[1,0,0] op_sel_hi:[1,1,1]
    v_pk_fma_f32 v[12:13], v[180:181], v[156:157], v[12:13] op_sel:[1,0,0] op_sel_hi:[1,1,1]
    v_pk_fma_f32 v[14:15], v[180:181], v[158:159], v[14:15] op_sel:[1,0,0] op_sel_hi:[1,1,1]
    s_set_gpr_idx_idx s70
    v_pk_fma_f32 v[8:9], v[178:179], v[160:161], v[8:9] op_sel:[0,0,0] op_sel_hi:[0,1,1]
    v_pk_fma_f32 v[10:11], v[178:179], v[162:163], v[10:11] op_sel:[0,0,0] op_sel_hi:[0,1,1]
    v_pk_fma_f32 v[12:13], v[182:183], v[164:165], v[12:13] op_sel:[0,0,0] op_sel_hi:[0,1,1]
    v_pk_fma_f32 v[14:15], v[182:183], v[166:167], v[14:15] op_sel:[0,0,0] op_sel_hi:[0,1,1]
    s_set_gpr_idx_idx s71
    v_pk_fma_f32 v[8:9], v[178:179], v[168:169], v[8:9] op_sel:[1,0,0] op_sel_hi:[1,1,1]
    v_pk_fma_f32 v[10:11], v[178:179], v[170:171], v[10:11] op_sel:[1,0,0] op_sel_hi:[1,1,1]
    v_pk_fma_f32 v[12:13], v[182:183], v[172:173], v[12:13] op_sel:[1,0,0] op_sel_hi:[1,1,1]
    v_pk_fma_f32 v[14:15], v[182:183], v[174:175], v[14:15] op_sel:[1,0,0] op_sel_hi:[1,1,1]
    s_set_gpr_idx_off
    s_and_b32 s80, s76, s31
    s_and_b32 s81, s77, s31
    s_and_b32 s82, s78, s31
    s_and_b32 s83, s79, s31
    buffer_load_dwordx4 v[64:67], v232, s[4:7], s80 offen
    buffer_load_dwordx4 v[68:71], v232, s[4:7], s81 offen
    buffer_load_dwordx4 v[72:75], v232, s[4:7], s82 offen
    buffer_load_dwordx4 v[76:79], v232, s[4:7], s83 offen
    s_cmp_le_i32 s30, 40
    s_waitcnt lgkmcnt(0)
    s_cbranch_scc1 L_exit
    s_setprio 1
    v_mfma_f32_32x32x16_bf16 v[112:127], v[196:199], v[208:211], v[112:127]
    v_exp_f32 v176, v88
    v_exp_f32 v177, v89
    v_exp_f32 v178, v90
    v_exp_f32 v179, v91
    v_exp_f32 v180, v104
    v_exp_f32 v181, v105
    v_exp_f32 v182, v106
    v_exp_f32 v183, v107
    v_pk_fma_f32 v[176:177], v[176:177], s[56:57], s[56:57]
    v_pk_fma_f32 v[178:179], v[178:179], s[56:57], s[56:57]
    v_pk_fma_f32 v[180:181], v[180:181], s[56:57], s[56:57]
    v_pk_fma_f32 v[182:183], v[182:183], s[56:57], s[56:57]
    s_waitcnt vmcnt(4)
    v_mfma_f32_4x4x4_16b_bf16 v[144:147], v[188:189], v[48:49], 0 cbsz:4 abid:8
    v_rcp_f32 v176, v176
    v_mfma_f32_4x4x4_16b_bf16 v[148:151], v[188:189], v[50:51], 0 cbsz:4 abid:8
    v_rcp_f32 v177, v177
    v_mfma_f32_4x4x4_16b_bf16 v[152:155], v[188:189], v[52:53], 0 cbsz:4 abid:9
    v_rcp_f32 v178, v178
    v_mfma_f32_4x4x4_16b_bf16 v[156:159], v[188:189], v[54:55], 0 cbsz:4 abid:9
    v_rcp_f32 v179, v179
    v_mfma_f32_4x4x4_16b_bf16 v[160:163], v[188:189], v[56:57], 0 cbsz:4 abid:10
    v_rcp_f32 v180, v180
    v_mfma_f32_4x4x4_16b_bf16 v[164:167], v[188:189], v[58:59], 0 cbsz:4 abid:10
    v_rcp_f32 v181, v181
    v_mfma_f32_4x4x4_16b_bf16 v[168:171], v[188:189], v[60:61], 0 cbsz:4 abid:11
    v_rcp_f32 v182, v182
    v_mfma_f32_4x4x4_16b_bf16 v[172:175], v[188:189], v[62:63], 0 cbsz:4 abid:11
    v_rcp_f32 v183, v183
    v_readlane_b32 s64, v228, 3
    v_readlane_b32 s65, v228, 7
    v_readlane_b32 s66, v228, 11
    v_readlane_b32 s67, v228, 15
    v_and_or_b32 v229, v2, s33, v233
    v_pk_mul_f32 v[176:177], v[176:177], v[88:89]
    v_pk_mul_f32 v[178:179], v[178:179], v[90:91]
    v_pk_mul_f32 v[180:181], v[180:181], v[104:105]
    v_pk_mul_f32 v[182:183], v[182:183], v[106:107]
    s_set_gpr_idx_on s72, gpr_idx(SRC2,DST)
    v_pk_fma_f32 v[8:9], v[176:177], v[144:145], v[8:9] op_sel:[0,0,0] op_sel_hi:[0,1,1]
    v_pk_fma_f32 v[10:11], v[176:177], v[146:147], v[10:11] op_sel:[0,0,0] op_sel_hi:[0,1,1]
    v_pk_fma_f32 v[12:13], v[180:181], v[148:149], v[12:13] op_sel:[0,0,0] op_sel_hi:[0,1,1]
    v_pk_fma_f32 v[14:15], v[180:181], v[150:151], v[14:15] op_sel:[0,0,0] op_sel_hi:[0,1,1]
    s_set_gpr_idx_idx s73
    v_pk_fma_f32 v[8:9], v[176:177], v[152:153], v[8:9] op_sel:[1,0,0] op_sel_hi:[1,1,1]
    v_pk_fma_f32 v[10:11], v[176:177], v[154:155], v[10:11] op_sel:[1,0,0] op_sel_hi:[1,1,1]
    v_pk_fma_f32 v[12:13], v[180:181], v[156:157], v[12:13] op_sel:[1,0,0] op_sel_hi:[1,1,1]
    v_pk_fma_f32 v[14:15], v[180:181], v[158:159], v[14:15] op_sel:[1,0,0] op_sel_hi:[1,1,1]
    s_set_gpr_idx_idx s74
    v_pk_fma_f32 v[8:9], v[178:179], v[160:161], v[8:9] op_sel:[0,0,0] op_sel_hi:[0,1,1]
    v_pk_fma_f32 v[10:11], v[178:179], v[162:163], v[10:11] op_sel:[0,0,0] op_sel_hi:[0,1,1]
    v_pk_fma_f32 v[12:13], v[182:183], v[164:165], v[12:13] op_sel:[0,0,0] op_sel_hi:[0,1,1]
    v_pk_fma_f32 v[14:15], v[182:183], v[166:167], v[14:15] op_sel:[0,0,0] op_sel_hi:[0,1,1]
    s_set_gpr_idx_idx s75
    v_pk_fma_f32 v[8:9], v[178:179], v[168:169], v[8:9] op_sel:[1,0,0] op_sel_hi:[1,1,1]
    v_pk_fma_f32 v[10:11], v[178:179], v[170:171], v[10:11] op_sel:[1,0,0] op_sel_hi:[1,1,1]
    v_pk_fma_f32 v[12:13], v[182:183], v[172:173], v[12:13] op_sel:[1,0,0] op_sel_hi:[1,1,1]
    v_pk_fma_f32 v[14:15], v[182:183], v[174:175], v[14:15] op_sel:[1,0,0] op_sel_hi:[1,1,1]
    s_set_gpr_idx_off
    s_and_b32 s80, s64, s31
    s_and_b32 s81, s65, s31
    s_and_b32 s82, s66, s31
    s_and_b32 s83, s67, s31
    buffer_load_dwordx4 v[48:51], v232, s[4:7], s80 offen
    buffer_load_dwordx4 v[52:55], v232, s[4:7], s81 offen
    buffer_load_dwordx4 v[56:59], v232, s[4:7], s82 offen
    buffer_load_dwordx4 v[60:63], v232, s[4:7], s83 offen
    s_cmp_le_i32 s30, 44
    s_mov_b64 exec, s[20:21]
    ds_read_b128 v[192:195], v229 offset:46080
    s_mov_b64 exec, -1
    s_cbranch_scc1 L_exit
    s_setprio 0
    v_mfma_f32_32x32x16_bf16 v[128:143], v[196:199], v[212:215], v[128:143]
    v_exp_f32 v176, v92
    v_exp_f32 v177, v93
    v_exp_f32 v178, v94
    v_exp_f32 v179, v95
    v_exp_f32 v180, v108
    v_exp_f32 v181, v109
    v_exp_f32 v182, v110
    v_exp_f32 v183, v111
    v_pk_fma_f32 v[176:177], v[176:177], s[56:57], s[56:57]
    v_pk_fma_f32 v[178:179], v[178:179], s[56:57], s[56:57]
    v_pk_fma_f32 v[180:181], v[180:181], s[56:57], s[56:57]
    v_pk_fma_f32 v[182:183], v[182:183], s[56:57], s[56:57]
    s_waitcnt vmcnt(4)
    v_mfma_f32_4x4x4_16b_bf16 v[144:147], v[188:189], v[64:65], 0 cbsz:4 abid:12
    v_rcp_f32 v176, v176
    v_mfma_f32_4x4x4_16b_bf16 v[148:151], v[188:189], v[66:67], 0 cbsz:4 abid:12
    v_rcp_f32 v177, v177
    v_mfma_f32_4x4x4_16b_bf16 v[152:155], v[188:189], v[68:69], 0 cbsz:4 abid:13
    v_rcp_f32 v178, v178
    v_mfma_f32_4x4x4_16b_bf16 v[156:159], v[188:189], v[70:71], 0 cbsz:4 abid:13
    v_rcp_f32 v179, v179
    v_mfma_f32_4x4x4_16b_bf16 v[160:163], v[188:189], v[72:73], 0 cbsz:4 abid:14
    v_rcp_f32 v180, v180
    v_mfma_f32_4x4x4_16b_bf16 v[164:167], v[188:189], v[74:75], 0 cbsz:4 abid:14
    v_rcp_f32 v181, v181
    v_mfma_f32_4x4x4_16b_bf16 v[168:171], v[188:189], v[76:77], 0 cbsz:4 abid:15
    v_rcp_f32 v182, v182
    v_mfma_f32_4x4x4_16b_bf16 v[172:175], v[188:189], v[78:79], 0 cbsz:4 abid:15
    v_rcp_f32 v183, v183
    v_readlane_b32 s68, v228, 19
    v_readlane_b32 s69, v228, 23
    v_readlane_b32 s70, v228, 27
    v_readlane_b32 s71, v228, 31
    v_pk_mul_f32 v[176:177], v[176:177], v[92:93]
    v_pk_mul_f32 v[178:179], v[178:179], v[94:95]
    v_pk_mul_f32 v[180:181], v[180:181], v[108:109]
    v_pk_mul_f32 v[182:183], v[182:183], v[110:111]
    s_set_gpr_idx_on s76, gpr_idx(SRC2,DST)
    v_pk_fma_f32 v[8:9], v[176:177], v[144:145], v[8:9] op_sel:[0,0,0] op_sel_hi:[0,1,1]
    v_pk_fma_f32 v[10:11], v[176:177], v[146:147], v[10:11] op_sel:[0,0,0] op_sel_hi:[0,1,1]
    v_pk_fma_f32 v[12:13], v[180:181], v[148:149], v[12:13] op_sel:[0,0,0] op_sel_hi:[0,1,1]
    v_pk_fma_f32 v[14:15], v[180:181], v[150:151], v[14:15] op_sel:[0,0,0] op_sel_hi:[0,1,1]
    s_set_gpr_idx_idx s77
    v_pk_fma_f32 v[8:9], v[176:177], v[152:153], v[8:9] op_sel:[1,0,0] op_sel_hi:[1,1,1]
    v_pk_fma_f32 v[10:11], v[176:177], v[154:155], v[10:11] op_sel:[1,0,0] op_sel_hi:[1,1,1]
    v_pk_fma_f32 v[12:13], v[180:181], v[156:157], v[12:13] op_sel:[1,0,0] op_sel_hi:[1,1,1]
    v_pk_fma_f32 v[14:15], v[180:181], v[158:159], v[14:15] op_sel:[1,0,0] op_sel_hi:[1,1,1]
    s_set_gpr_idx_idx s78
    v_pk_fma_f32 v[8:9], v[178:179], v[160:161], v[8:9] op_sel:[0,0,0] op_sel_hi:[0,1,1]
    v_pk_fma_f32 v[10:11], v[178:179], v[162:163], v[10:11] op_sel:[0,0,0] op_sel_hi:[0,1,1]
    v_pk_fma_f32 v[12:13], v[182:183], v[164:165], v[12:13] op_sel:[0,0,0] op_sel_hi:[0,1,1]
    v_pk_fma_f32 v[14:15], v[182:183], v[166:167], v[14:15] op_sel:[0,0,0] op_sel_hi:[0,1,1]
    s_set_gpr_idx_idx s79
    v_pk_fma_f32 v[8:9], v[178:179], v[168:169], v[8:9] op_sel:[1,0,0] op_sel_hi:[1,1,1]
    v_pk_fma_f32 v[10:11], v[178:179], v[170:171], v[10:11] op_sel:[1,0,0] op_sel_hi:[1,1,1]
    v_pk_fma_f32 v[12:13], v[182:183], v[172:173], v[12:13] op_sel:[1,0,0] op_sel_hi:[1,1,1]
    v_pk_fma_f32 v[14:15], v[182:183], v[174:175], v[14:15] op_sel:[1,0,0] op_sel_hi:[1,1,1]
    s_set_gpr_idx_off
    s_and_b32 s80, s68, s31
    s_and_b32 s81, s69, s31
    s_and_b32 s82, s70, s31
    s_and_b32 s83, s71, s31
    buffer_load_dwordx4 v[64:67], v232, s[4:7], s80 offen
    buffer_load_dwordx4 v[68:71], v232, s[4:7], s81 offen
    buffer_load_dwordx4 v[72:75], v232, s[4:7], s82 offen
    buffer_load_dwordx4 v[76:79], v232, s[4:7], s83 offen
    s_cmp_le_i32 s30, 48
    s_waitcnt lgkmcnt(0)
    s_cbranch_scc1 L_exit
    s_setprio 3
    v_mfma_f32_32x32x16_bf16 v[80:95], v[192:195], v[200:203], 0
    v_exp_f32 v176, v112
    v_exp_f32 v177, v113
    v_exp_f32 v178, v114
    v_exp_f32 v179, v115
    v_exp_f32 v180, v128
    v_exp_f32 v181, v129
    v_exp_f32 v182, v130
    v_exp_f32 v183, v131
    v_pk_fma_f32 v[176:177], v[176:177], s[56:57], s[56:57]
    v_pk_fma_f32 v[178:179], v[178:179], s[56:57], s[56:57]
    v_pk_fma_f32 v[180:181], v[180:181], s[56:57], s[56:57]
    v_pk_fma_f32 v[182:183], v[182:183], s[56:57], s[56:57]
    s_waitcnt vmcnt(4)
    v_mfma_f32_4x4x4_16b_bf16 v[144:147], v[190:191], v[48:49], 0 cbsz:4 abid:0
    v_rcp_f32 v176, v176
    v_mfma_f32_4x4x4_16b_bf16 v[148:151], v[190:191], v[50:51], 0 cbsz:4 abid:0
    v_rcp_f32 v177, v177
    v_mfma_f32_4x4x4_16b_bf16 v[152:155], v[190:191], v[52:53], 0 cbsz:4 abid:1
    v_rcp_f32 v178, v178
    v_mfma_f32_4x4x4_16b_bf16 v[156:159], v[190:191], v[54:55], 0 cbsz:4 abid:1
    v_rcp_f32 v179, v179
    v_mfma_f32_4x4x4_16b_bf16 v[160:163], v[190:191], v[56:57], 0 cbsz:4 abid:2
    v_rcp_f32 v180, v180
    v_mfma_f32_4x4x4_16b_bf16 v[164:167], v[190:191], v[58:59], 0 cbsz:4 abid:2
    v_rcp_f32 v181, v181
    v_mfma_f32_4x4x4_16b_bf16 v[168:171], v[190:191], v[60:61], 0 cbsz:4 abid:3
    v_rcp_f32 v182, v182
    v_mfma_f32_4x4x4_16b_bf16 v[172:175], v[190:191], v[62:63], 0 cbsz:4 abid:3
    v_rcp_f32 v183, v183
    v_readlane_b32 s72, v228, 35
    v_readlane_b32 s73, v228, 39
    v_readlane_b32 s74, v228, 43
    v_readlane_b32 s75, v228, 47
    v_pk_mul_f32 v[176:177], v[176:177], v[112:113]
    v_pk_mul_f32 v[178:179], v[178:179], v[114:115]
    v_pk_mul_f32 v[180:181], v[180:181], v[128:129]
    v_pk_mul_f32 v[182:183], v[182:183], v[130:131]
    s_set_gpr_idx_on s64, gpr_idx(SRC2,DST)
    v_pk_fma_f32 v[8:9], v[176:177], v[144:145], v[8:9] op_sel:[0,0,0] op_sel_hi:[0,1,1]
    v_pk_fma_f32 v[10:11], v[176:177], v[146:147], v[10:11] op_sel:[0,0,0] op_sel_hi:[0,1,1]
    v_pk_fma_f32 v[12:13], v[180:181], v[148:149], v[12:13] op_sel:[0,0,0] op_sel_hi:[0,1,1]
    v_pk_fma_f32 v[14:15], v[180:181], v[150:151], v[14:15] op_sel:[0,0,0] op_sel_hi:[0,1,1]
    s_set_gpr_idx_idx s65
    v_pk_fma_f32 v[8:9], v[176:177], v[152:153], v[8:9] op_sel:[1,0,0] op_sel_hi:[1,1,1]
    v_pk_fma_f32 v[10:11], v[176:177], v[154:155], v[10:11] op_sel:[1,0,0] op_sel_hi:[1,1,1]
    v_pk_fma_f32 v[12:13], v[180:181], v[156:157], v[12:13] op_sel:[1,0,0] op_sel_hi:[1,1,1]
    v_pk_fma_f32 v[14:15], v[180:181], v[158:159], v[14:15] op_sel:[1,0,0] op_sel_hi:[1,1,1]
    s_set_gpr_idx_idx s66
    v_pk_fma_f32 v[8:9], v[178:179], v[160:161], v[8:9] op_sel:[0,0,0] op_sel_hi:[0,1,1]
    v_pk_fma_f32 v[10:11], v[178:179], v[162:163], v[10:11] op_sel:[0,0,0] op_sel_hi:[0,1,1]
    v_pk_fma_f32 v[12:13], v[182:183], v[164:165], v[12:13] op_sel:[0,0,0] op_sel_hi:[0,1,1]
    v_pk_fma_f32 v[14:15], v[182:183], v[166:167], v[14:15] op_sel:[0,0,0] op_sel_hi:[0,1,1]
    s_set_gpr_idx_idx s67
    v_pk_fma_f32 v[8:9], v[178:179], v[168:169], v[8:9] op_sel:[1,0,0] op_sel_hi:[1,1,1]
    v_pk_fma_f32 v[10:11], v[178:179], v[170:171], v[10:11] op_sel:[1,0,0] op_sel_hi:[1,1,1]
    v_pk_fma_f32 v[12:13], v[182:183], v[172:173], v[12:13] op_sel:[1,0,0] op_sel_hi:[1,1,1]
    v_pk_fma_f32 v[14:15], v[182:183], v[174:175], v[14:15] op_sel:[1,0,0] op_sel_hi:[1,1,1]
    s_set_gpr_idx_off
    s_and_b32 s80, s72, s31
    s_and_b32 s81, s73, s31
    s_and_b32 s82, s74, s31
    s_and_b32 s83, s75, s31
    buffer_load_dwordx4 v[48:51], v232, s[4:7], s80 offen
    buffer_load_dwordx4 v[52:55], v232, s[4:7], s81 offen
    buffer_load_dwordx4 v[56:59], v232, s[4:7], s82 offen
    buffer_load_dwordx4 v[60:63], v232, s[4:7], s83 offen
    s_cmp_le_i32 s30, 52
    s_mov_b64 exec, s[22:23]
    ds_read_b128 v[196:199], v229 offset:46080
    s_mov_b64 exec, -1
    ds_read_b32 v2, v231 offset:1292
    s_cbranch_scc1 L_exit
    s_setprio 2
    v_mfma_f32_32x32x16_bf16 v[96:111], v[192:195], v[204:207], 0
    v_exp_f32 v176, v116
    v_exp_f32 v177, v117
    v_exp_f32 v178, v118
    v_exp_f32 v179, v119
    v_exp_f32 v180, v132
    v_exp_f32 v181, v133
    v_exp_f32 v182, v134
    v_exp_f32 v183, v135
    v_pk_fma_f32 v[176:177], v[176:177], s[56:57], s[56:57]
    v_pk_fma_f32 v[178:179], v[178:179], s[56:57], s[56:57]
    v_pk_fma_f32 v[180:181], v[180:181], s[56:57], s[56:57]
    v_pk_fma_f32 v[182:183], v[182:183], s[56:57], s[56:57]
    s_waitcnt vmcnt(4)
    v_mfma_f32_4x4x4_16b_bf16 v[144:147], v[190:191], v[64:65], 0 cbsz:4 abid:4
    v_rcp_f32 v176, v176
    v_mfma_f32_4x4x4_16b_bf16 v[148:151], v[190:191], v[66:67], 0 cbsz:4 abid:4
    v_rcp_f32 v177, v177
    v_mfma_f32_4x4x4_16b_bf16 v[152:155], v[190:191], v[68:69], 0 cbsz:4 abid:5
    v_rcp_f32 v178, v178
    v_mfma_f32_4x4x4_16b_bf16 v[156:159], v[190:191], v[70:71], 0 cbsz:4 abid:5
    v_rcp_f32 v179, v179
    v_mfma_f32_4x4x4_16b_bf16 v[160:163], v[190:191], v[72:73], 0 cbsz:4 abid:6
    v_rcp_f32 v180, v180
    v_mfma_f32_4x4x4_16b_bf16 v[164:167], v[190:191], v[74:75], 0 cbsz:4 abid:6
    v_rcp_f32 v181, v181
    v_mfma_f32_4x4x4_16b_bf16 v[168:171], v[190:191], v[76:77], 0 cbsz:4 abid:7
    v_rcp_f32 v182, v182
    v_mfma_f32_4x4x4_16b_bf16 v[172:175], v[190:191], v[78:79], 0 cbsz:4 abid:7
    v_rcp_f32 v183, v183
    v_readlane_b32 s76, v228, 51
    v_readlane_b32 s77, v228, 55
    v_readlane_b32 s78, v228, 59
    v_readlane_b32 s79, v228, 63
    v_pk_mul_f32 v[176:177], v[176:177], v[116:117]
    v_pk_mul_f32 v[178:179], v[178:179], v[118:119]
    v_pk_mul_f32 v[180:181], v[180:181], v[132:133]
    v_pk_mul_f32 v[182:183], v[182:183], v[134:135]
    s_set_gpr_idx_on s68, gpr_idx(SRC2,DST)
    v_pk_fma_f32 v[8:9], v[176:177], v[144:145], v[8:9] op_sel:[0,0,0] op_sel_hi:[0,1,1]
    v_pk_fma_f32 v[10:11], v[176:177], v[146:147], v[10:11] op_sel:[0,0,0] op_sel_hi:[0,1,1]
    v_pk_fma_f32 v[12:13], v[180:181], v[148:149], v[12:13] op_sel:[0,0,0] op_sel_hi:[0,1,1]
    v_pk_fma_f32 v[14:15], v[180:181], v[150:151], v[14:15] op_sel:[0,0,0] op_sel_hi:[0,1,1]
    s_set_gpr_idx_idx s69
    v_pk_fma_f32 v[8:9], v[176:177], v[152:153], v[8:9] op_sel:[1,0,0] op_sel_hi:[1,1,1]
    v_pk_fma_f32 v[10:11], v[176:177], v[154:155], v[10:11] op_sel:[1,0,0] op_sel_hi:[1,1,1]
    v_pk_fma_f32 v[12:13], v[180:181], v[156:157], v[12:13] op_sel:[1,0,0] op_sel_hi:[1,1,1]
    v_pk_fma_f32 v[14:15], v[180:181], v[158:159], v[14:15] op_sel:[1,0,0] op_sel_hi:[1,1,1]
    s_set_gpr_idx_idx s70
    v_pk_fma_f32 v[8:9], v[178:179], v[160:161], v[8:9] op_sel:[0,0,0] op_sel_hi:[0,1,1]
    v_pk_fma_f32 v[10:11], v[178:179], v[162:163], v[10:11] op_sel:[0,0,0] op_sel_hi:[0,1,1]
    v_pk_fma_f32 v[12:13], v[182:183], v[164:165], v[12:13] op_sel:[0,0,0] op_sel_hi:[0,1,1]
    v_pk_fma_f32 v[14:15], v[182:183], v[166:167], v[14:15] op_sel:[0,0,0] op_sel_hi:[0,1,1]
    s_set_gpr_idx_idx s71
    v_pk_fma_f32 v[8:9], v[178:179], v[168:169], v[8:9] op_sel:[1,0,0] op_sel_hi:[1,1,1]
    v_pk_fma_f32 v[10:11], v[178:179], v[170:171], v[10:11] op_sel:[1,0,0] op_sel_hi:[1,1,1]
    v_pk_fma_f32 v[12:13], v[182:183], v[172:173], v[12:13] op_sel:[1,0,0] op_sel_hi:[1,1,1]
    v_pk_fma_f32 v[14:15], v[182:183], v[174:175], v[14:15] op_sel:[1,0,0] op_sel_hi:[1,1,1]
    s_set_gpr_idx_off
    s_and_b32 s80, s76, s31
    s_and_b32 s81, s77, s31
    s_and_b32 s82, s78, s31
    s_and_b32 s83, s79, s31
    buffer_load_dwordx4 v[64:67], v232, s[4:7], s80 offen
    buffer_load_dwordx4 v[68:71], v232, s[4:7], s81 offen
    buffer_load_dwordx4 v[72:75], v232, s[4:7], s82 offen
    buffer_load_dwordx4 v[76:79], v232, s[4:7], s83 offen
    s_cmp_le_i32 s30, 56
    s_waitcnt lgkmcnt(0)
    s_cbranch_scc1 L_exit
    s_setprio 1
    v_cndmask_b32 v228, v4, v226, s[34:35]
    v_mfma_f32_32x32x16_bf16 v[80:95], v[196:199], v[208:211], v[80:95]
    v_exp_f32 v176, v120
    v_exp_f32 v177, v121
    v_exp_f32 v178, v122
    v_exp_f32 v179, v123
    v_exp_f32 v180, v136
    v_exp_f32 v181, v137
    v_exp_f32 v182, v138
    v_exp_f32 v183, v139
    v_pk_fma_f32 v[176:177], v[176:177], s[56:57], s[56:57]
    v_pk_fma_f32 v[178:179], v[178:179], s[56:57], s[56:57]
    v_pk_fma_f32 v[180:181], v[180:181], s[56:57], s[56:57]
    v_pk_fma_f32 v[182:183], v[182:183], s[56:57], s[56:57]
    s_waitcnt vmcnt(4)
    v_mfma_f32_4x4x4_16b_bf16 v[144:147], v[190:191], v[48:49], 0 cbsz:4 abid:8
    v_rcp_f32 v176, v176
    v_mfma_f32_4x4x4_16b_bf16 v[148:151], v[190:191], v[50:51], 0 cbsz:4 abid:8
    v_rcp_f32 v177, v177
    v_mfma_f32_4x4x4_16b_bf16 v[152:155], v[190:191], v[52:53], 0 cbsz:4 abid:9
    v_rcp_f32 v178, v178
    v_mfma_f32_4x4x4_16b_bf16 v[156:159], v[190:191], v[54:55], 0 cbsz:4 abid:9
    v_rcp_f32 v179, v179
    v_mfma_f32_4x4x4_16b_bf16 v[160:163], v[190:191], v[56:57], 0 cbsz:4 abid:10
    v_rcp_f32 v180, v180
    v_mfma_f32_4x4x4_16b_bf16 v[164:167], v[190:191], v[58:59], 0 cbsz:4 abid:10
    v_rcp_f32 v181, v181
    v_mfma_f32_4x4x4_16b_bf16 v[168:171], v[190:191], v[60:61], 0 cbsz:4 abid:11
    v_rcp_f32 v182, v182
    v_mfma_f32_4x4x4_16b_bf16 v[172:175], v[190:191], v[62:63], 0 cbsz:4 abid:11
    v_rcp_f32 v183, v183
    v_readlane_b32 s64, v228, 0
    v_readlane_b32 s65, v228, 4
    v_readlane_b32 s66, v228, 8
    v_readlane_b32 s67, v228, 12
    v_and_or_b32 v229, v2, s33, v233
    v_pk_mul_f32 v[176:177], v[176:177], v[120:121]
    v_pk_mul_f32 v[178:179], v[178:179], v[122:123]
    v_pk_mul_f32 v[180:181], v[180:181], v[136:137]
    v_pk_mul_f32 v[182:183], v[182:183], v[138:139]
    s_set_gpr_idx_on s72, gpr_idx(SRC2,DST)
    v_pk_fma_f32 v[8:9], v[176:177], v[144:145], v[8:9] op_sel:[0,0,0] op_sel_hi:[0,1,1]
    v_pk_fma_f32 v[10:11], v[176:177], v[146:147], v[10:11] op_sel:[0,0,0] op_sel_hi:[0,1,1]
    v_pk_fma_f32 v[12:13], v[180:181], v[148:149], v[12:13] op_sel:[0,0,0] op_sel_hi:[0,1,1]
    v_pk_fma_f32 v[14:15], v[180:181], v[150:151], v[14:15] op_sel:[0,0,0] op_sel_hi:[0,1,1]
    s_set_gpr_idx_idx s73
    v_pk_fma_f32 v[8:9], v[176:177], v[152:153], v[8:9] op_sel:[1,0,0] op_sel_hi:[1,1,1]
    v_pk_fma_f32 v[10:11], v[176:177], v[154:155], v[10:11] op_sel:[1,0,0] op_sel_hi:[1,1,1]
    v_pk_fma_f32 v[12:13], v[180:181], v[156:157], v[12:13] op_sel:[1,0,0] op_sel_hi:[1,1,1]
    v_pk_fma_f32 v[14:15], v[180:181], v[158:159], v[14:15] op_sel:[1,0,0] op_sel_hi:[1,1,1]
    s_set_gpr_idx_idx s74
    v_pk_fma_f32 v[8:9], v[178:179], v[160:161], v[8:9] op_sel:[0,0,0] op_sel_hi:[0,1,1]
    v_pk_fma_f32 v[10:11], v[178:179], v[162:163], v[10:11] op_sel:[0,0,0] op_sel_hi:[0,1,1]
    v_pk_fma_f32 v[12:13], v[182:183], v[164:165], v[12:13] op_sel:[0,0,0] op_sel_hi:[0,1,1]
    v_pk_fma_f32 v[14:15], v[182:183], v[166:167], v[14:15] op_sel:[0,0,0] op_sel_hi:[0,1,1]
    s_set_gpr_idx_idx s75
    v_pk_fma_f32 v[8:9], v[178:179], v[168:169], v[8:9] op_sel:[1,0,0] op_sel_hi:[1,1,1]
    v_pk_fma_f32 v[10:11], v[178:179], v[170:171], v[10:11] op_sel:[1,0,0] op_sel_hi:[1,1,1]
    v_pk_fma_f32 v[12:13], v[182:183], v[172:173], v[12:13] op_sel:[1,0,0] op_sel_hi:[1,1,1]
    v_pk_fma_f32 v[14:15], v[182:183], v[174:175], v[14:15] op_sel:[1,0,0] op_sel_hi:[1,1,1]
    s_set_gpr_idx_off
    s_and_b32 s80, s64, s31
    s_and_b32 s81, s65, s31
    s_and_b32 s82, s66, s31
    s_and_b32 s83, s67, s31
    buffer_load_dwordx4 v[48:51], v232, s[4:7], s80 offen
    buffer_load_dwordx4 v[52:55], v232, s[4:7], s81 offen
    buffer_load_dwordx4 v[56:59], v232, s[4:7], s82 offen
    buffer_load_dwordx4 v[60:63], v232, s[4:7], s83 offen
    s_cmp_le_i32 s30, 60
    s_mov_b64 exec, s[20:21]
    ds_read_b128 v[192:195], v229 offset:46080
    s_mov_b64 exec, -1
    s_cbranch_scc1 L_exit
    s_setprio 0
    v_mfma_f32_32x32x16_bf16 v[96:111], v[196:199], v[212:215], v[96:111]
    v_exp_f32 v176, v124
    v_exp_f32 v177, v125
    v_exp_f32 v178, v126
    v_exp_f32 v179, v127
    v_exp_f32 v180, v140
    v_exp_f32 v181, v141
    v_exp_f32 v182, v142
    v_exp_f32 v183, v143
    v_pk_fma_f32 v[176:177], v[176:177], s[56:57], s[56:57]
    v_pk_fma_f32 v[178:179], v[178:179], s[56:57], s[56:57]
    v_pk_fma_f32 v[180:181], v[180:181], s[56:57], s[56:57]
    v_pk_fma_f32 v[182:183], v[182:183], s[56:57], s[56:57]
    s_waitcnt vmcnt(4)
    v_mfma_f32_4x4x4_16b_bf16 v[144:147], v[190:191], v[64:65], 0 cbsz:4 abid:12
    v_rcp_f32 v176, v176
    v_mfma_f32_4x4x4_16b_bf16 v[148:151], v[190:191], v[66:67], 0 cbsz:4 abid:12
    v_rcp_f32 v177, v177
    v_mfma_f32_4x4x4_16b_bf16 v[152:155], v[190:191], v[68:69], 0 cbsz:4 abid:13
    v_rcp_f32 v178, v178
    v_mfma_f32_4x4x4_16b_bf16 v[156:159], v[190:191], v[70:71], 0 cbsz:4 abid:13
    v_rcp_f32 v179, v179
    v_mfma_f32_4x4x4_16b_bf16 v[160:163], v[190:191], v[72:73], 0 cbsz:4 abid:14
    v_rcp_f32 v180, v180
    v_mfma_f32_4x4x4_16b_bf16 v[164:167], v[190:191], v[74:75], 0 cbsz:4 abid:14
    v_rcp_f32 v181, v181
    v_mfma_f32_4x4x4_16b_bf16 v[168:171], v[190:191], v[76:77], 0 cbsz:4 abid:15
    v_rcp_f32 v182, v182
    v_mfma_f32_4x4x4_16b_bf16 v[172:175], v[190:191], v[78:79], 0 cbsz:4 abid:15
    v_rcp_f32 v183, v183
    v_readlane_b32 s68, v228, 16
    v_readlane_b32 s69, v228, 20
    v_readlane_b32 s70, v228, 24
    v_readlane_b32 s71, v228, 28
    v_pk_mul_f32 v[176:177], v[176:177], v[124:125]
    v_pk_mul_f32 v[178:179], v[178:179], v[126:127]
    v_pk_mul_f32 v[180:181], v[180:181], v[140:141]
    v_pk_mul_f32 v[182:183], v[182:183], v[142:143]
    s_set_gpr_idx_on s76, gpr_idx(SRC2,DST)
    v_pk_fma_f32 v[8:9], v[176:177], v[144:145], v[8:9] op_sel:[0,0,0] op_sel_hi:[0,1,1]
    v_pk_fma_f32 v[10:11], v[176:177], v[146:147], v[10:11] op_sel:[0,0,0] op_sel_hi:[0,1,1]
    v_pk_fma_f32 v[12:13], v[180:181], v[148:149], v[12:13] op_sel:[0,0,0] op_sel_hi:[0,1,1]
    v_pk_fma_f32 v[14:15], v[180:181], v[150:151], v[14:15] op_sel:[0,0,0] op_sel_hi:[0,1,1]
    s_set_gpr_idx_idx s77
    v_pk_fma_f32 v[8:9], v[176:177], v[152:153], v[8:9] op_sel:[1,0,0] op_sel_hi:[1,1,1]
    v_pk_fma_f32 v[10:11], v[176:177], v[154:155], v[10:11] op_sel:[1,0,0] op_sel_hi:[1,1,1]
    v_pk_fma_f32 v[12:13], v[180:181], v[156:157], v[12:13] op_sel:[1,0,0] op_sel_hi:[1,1,1]
    v_pk_fma_f32 v[14:15], v[180:181], v[158:159], v[14:15] op_sel:[1,0,0] op_sel_hi:[1,1,1]
    s_set_gpr_idx_idx s78
    v_pk_fma_f32 v[8:9], v[178:179], v[160:161], v[8:9] op_sel:[0,0,0] op_sel_hi:[0,1,1]
    v_pk_fma_f32 v[10:11], v[178:179], v[162:163], v[10:11] op_sel:[0,0,0] op_sel_hi:[0,1,1]
    v_pk_fma_f32 v[12:13], v[182:183], v[164:165], v[12:13] op_sel:[0,0,0] op_sel_hi:[0,1,1]
    v_pk_fma_f32 v[14:15], v[182:183], v[166:167], v[14:15] op_sel:[0,0,0] op_sel_hi:[0,1,1]
    s_set_gpr_idx_idx s79
    v_pk_fma_f32 v[8:9], v[178:179], v[168:169], v[8:9] op_sel:[1,0,0] op_sel_hi:[1,1,1]
    v_pk_fma_f32 v[10:11], v[178:179], v[170:171], v[10:11] op_sel:[1,0,0] op_sel_hi:[1,1,1]
    v_pk_fma_f32 v[12:13], v[182:183], v[172:173], v[12:13] op_sel:[1,0,0] op_sel_hi:[1,1,1]
    v_pk_fma_f32 v[14:15], v[182:183], v[174:175], v[14:15] op_sel:[1,0,0] op_sel_hi:[1,1,1]
    s_set_gpr_idx_off
    s_and_b32 s80, s68, s31
    s_and_b32 s81, s69, s31
    s_and_b32 s82, s70, s31
    s_and_b32 s83, s71, s31
    buffer_load_dwordx4 v[64:67], v232, s[4:7], s80 offen
    buffer_load_dwordx4 v[68:71], v232, s[4:7], s81 offen
    buffer_load_dwordx4 v[72:75], v232, s[4:7], s82 offen
    buffer_load_dwordx4 v[76:79], v232, s[4:7], s83 offen
    s_waitcnt lgkmcnt(0)
    v_add_u32 v231, 1024, v231
    s_sub_u32 s30, s30, 64
    s_branch L_sb
L_exit:
    s_setprio 0
    s_add_u32 s24, s24, 216
    s_cmp_lt_u32 s24, s25
    s_cbranch_scc0 L_epi
    s_waitcnt vmcnt(0) lgkmcnt(0)
    v_lshlrev_b32 v7, 3, v0
    v_mov_b32 v2, 0
    v_mov_b32 v3, 0
    ds_write_b64 v7, v[2:3]
    s_nop 15
    s_mul_i32 s26, s16, 5
    v_add_u32 v113, s26, v1
    v_subrev_u32 v3, 40, v113
    v_min_u32 v113, v113, v3
    v_mul_u32_u24 v3, 205, v1
    v_lshrrev_b32 v3, 10, v3
    v_mul_u32_u24 v2, 5, v3
    v_sub_u32 v115, v1, v2
    v_lshlrev_b32 v114, 2, v3
    s_lshl_b32 s81, s16, 10
    s_add_u32 s81, s81, 8192
    s_mul_i32 s80, s16, 6912
    v_lshl_add_u32 v121, v1, 2, s81
    v_lshrrev_b32 v3, 1, v1
    v_lshl_add_u32 v122, v3, 2, s81
    v_and_b32 v2, 1, v1
    v_lshlrev_b32 v123, 4, v2
    v_lshrrev_b32 v3, 1, v0
    v_mul_u32_u24 v3, 1280, v3
    v_add_u32 v124, v3, v2
    v_mul_u32_u24 v125, 48, v113
    s_lshl_b32 s26, s16, 2
    v_lshl_add_u32 v126, v115, 5, s26
    v_lshl_add_u32 v127, v1, 5, s80
    s_cmp_eq_u32 s16, 7
    s_cselect_b32 s54, 0, 1
    v_mov_b32 v80, 0xffffff
    v_mov_b32 v81, 0xffffff
    v_mov_b32 v82, 0xffffff
    v_mov_b32 v83, 0xffffff
    v_add_u32 v2, s81, v232
    ds_write_b128 v2, v[80:83]
    s_waitcnt lgkmcnt(0)
    s_barrier
    v_and_b32 v2, 1, v0
    v_max_u32 v3, s24, v235
    v_add_u32 v3, v3, v2
    s_add_u32 s27, s24, 216
    v_min_u32 v4, s27, v236
    v_add_u32 v5, v237, v3
    s_lshl_b32 s27, s24, 2
    s_sub_u32 s27, s81, s27
    v_lshl_add_u32 v6, v3, 2, s27
    v_sub_u32 v4, v4, v3
    s_branch L_exp
L_exp_more:
    v_add_u32 v6, 48, v6
    v_subrev_u32 v4, 12, v4
    s_branch L_exp
L_epi:
    v_lshlrev_b32 v5, 2, v1
    v_add_u32 v3, s48, v5
    v_cvt_pk_bf16_f32 v8, v8, v12
    v_cvt_pk_bf16_f32 v9, v9, v13
    v_cvt_pk_bf16_f32 v10, v10, v14
    v_cvt_pk_bf16_f32 v11, v11, v15
    ds_write2_b32 v3, v8, v9 offset0:0 offset1:72
    ds_write2_b32 v3, v10, v11 offset0:144 offset1:216
    v_add_u32 v3, s49, v5
    v_cvt_pk_bf16_f32 v16, v16, v20
    v_cvt_pk_bf16_f32 v17, v17, v21
    v_cvt_pk_bf16_f32 v18, v18, v22
    v_cvt_pk_bf16_f32 v19, v19, v23
    ds_write2_b32 v3, v16, v17 offset0:0 offset1:72
    ds_write2_b32 v3, v18, v19 offset0:144 offset1:216
    v_add_u32 v3, s50, v5
    v_cvt_pk_bf16_f32 v24, v24, v28
    v_cvt_pk_bf16_f32 v25, v25, v29
    v_cvt_pk_bf16_f32 v26, v26, v30
    v_cvt_pk_bf16_f32 v27, v27, v31
    ds_write2_b32 v3, v24, v25 offset0:0 offset1:72
    ds_write2_b32 v3, v26, v27 offset0:144 offset1:216
    v_add_u32 v3, s51, v5
    v_cvt_pk_bf16_f32 v32, v32, v36
    v_cvt_pk_bf16_f32 v33, v33, v37
    v_cvt_pk_bf16_f32 v34, v34, v38
    v_cvt_pk_bf16_f32 v35, v35, v39
    ds_write2_b32 v3, v32, v33 offset0:0 offset1:72
    ds_write2_b32 v3, v34, v35 offset0:144 offset1:216
    v_add_u32 v3, s52, v5
    v_cvt_pk_bf16_f32 v40, v40, v44
    v_cvt_pk_bf16_f32 v41, v41, v45
    v_cvt_pk_bf16_f32 v42, v42, v46
    v_cvt_pk_bf16_f32 v43, v43, v47
    ds_write2_b32 v3, v40, v41 offset0:0 offset1:72
    ds_write2_b32 v3, v42, v43 offset0:144 offset1:216
    s_waitcnt lgkmcnt(10)
    v_readfirstlane_b32 s38, v243
    s_cmp_eq_u32 s38, 8
    s_cbranch_scc0 L_nob
    ds_read_b128 v[192:195], v240 offset:0
    ds_read_b128 v[208:211], v240 offset:256
    ds_read_b128 v[196:199], v240 offset:8192
    ds_read_b128 v[212:215], v240 offset:8448
    ds_read_b128 v[200:203], v240 offset:16384
    ds_read_b128 v[216:219], v240 offset:16640
    ds_read_b128 v[204:207], v240 offset:24576
    ds_read_b128 v[220:223], v240 offset:24832
    s_waitcnt lgkmcnt(8)
    s_barrier
    s_branch L_haveb
L_nob:
    s_waitcnt lgkmcnt(0)
    s_barrier
    ds_read_b128 v[192:195], v240 offset:0
    ds_read_b128 v[208:211], v240 offset:256
    ds_read_b128 v[196:199], v240 offset:8192
    ds_read_b128 v[212:215], v240 offset:8448
    ds_read_b128 v[200:203], v240 offset:16384
    ds_read_b128 v[216:219], v240 offset:16640
    ds_read_b128 v[204:207], v240 offset:24576
    ds_read_b128 v[220:223], v240 offset:24832
L_haveb:
    ds_read_b128 v[80:83], v241 offset:0
    ds_read_b128 v[84:87], v241 offset:64
    ds_read_b128 v[88:91], v241 offset:128
    ds_read_b128 v[92:95], v241 offset:192
    s_waitcnt lgkmcnt(3)
    v_mfma_f32_16x16x32_bf16 v[8:11], v[80:83], v[192:195], 0
    ds_read_b128 v[96:99], v241 offset:4608
    v_mfma_f32_16x16x32_bf16 v[12:15], v[80:83], v[208:211], 0
    s_waitcnt lgkmcnt(3)
    v_mfma_f32_16x16x32_bf16 v[8:11], v[84:87], v[196:199], v[8:11]
    ds_read_b128 v[100:103], v241 offset:4672
    v_mfma_f32_16x16x32_bf16 v[12:15], v[84:87], v[212:215], v[12:15]
    s_waitcnt lgkmcnt(3)
    v_mfma_f32_16x16x32_bf16 v[8:11], v[88:91], v[200:203], v[8:11]
    ds_read_b128 v[104:107], v241 offset:4736
    v_mfma_f32_16x16x32_bf16 v[12:15], v[88:91], v[216:219], v[12:15]
    s_waitcnt lgkmcnt(3)
    v_mfma_f32_16x16x32_bf16 v[8:11], v[92:95], v[204:207], v[8:11]
    ds_read_b128 v[108:111], v241 offset:4800
    v_mfma_f32_16x16x32_bf16 v[12:15], v[92:95], v[220:223], v[12:15]
    s_waitcnt lgkmcnt(3)
    v_mfma_f32_16x16x32_bf16 v[16:19], v[96:99], v[192:195], 0
    ds_read_b128 v[112:115], v241 offset:9216
    v_mfma_f32_16x16x32_bf16 v[20:23], v[96:99], v[208:211], 0
    s_waitcnt lgkmcnt(3)
    v_mfma_f32_16x16x32_bf16 v[16:19], v[100:103], v[196:199], v[16:19]
    ds_read_b128 v[116:119], v241 offset:9280
    v_mfma_f32_16x16x32_bf16 v[20:23], v[100:103], v[212:215], v[20:23]
    v_cvt_pk_bf16_f32 v160, v8, v9
    v_cvt_pk_bf16_f32 v161, v10, v11
    v_cvt_pk_bf16_f32 v162, v12, v13
    v_cvt_pk_bf16_f32 v163, v14, v15
    buffer_store_dwordx4 v[160:163], v242, s[12:15], 0 offen sc1
    v_add_u32 v242, 1048576, v242
    s_waitcnt lgkmcnt(3)
    v_mfma_f32_16x16x32_bf16 v[16:19], v[104:107], v[200:203], v[16:19]
    ds_read_b128 v[120:123], v241 offset:9344
    v_mfma_f32_16x16x32_bf16 v[20:23], v[104:107], v[216:219], v[20:23]
    s_waitcnt lgkmcnt(3)
    v_mfma_f32_16x16x32_bf16 v[16:19], v[108:111], v[204:207], v[16:19]
    ds_read_b128 v[124:127], v241 offset:9408
    v_mfma_f32_16x16x32_bf16 v[20:23], v[108:111], v[220:223], v[20:23]
    s_waitcnt lgkmcnt(3)
    v_mfma_f32_16x16x32_bf16 v[24:27], v[112:115], v[192:195], 0
    ds_read_b128 v[128:131], v241 offset:13824
    v_mfma_f32_16x16x32_bf16 v[28:31], v[112:115], v[208:211], 0
    s_waitcnt lgkmcnt(3)
    v_mfma_f32_16x16x32_bf16 v[24:27], v[116:119], v[196:199], v[24:27]
    ds_read_b128 v[132:135], v241 offset:13888
    v_mfma_f32_16x16x32_bf16 v[28:31], v[116:119], v[212:215], v[28:31]
    v_cvt_pk_bf16_f32 v164, v16, v17
    v_cvt_pk_bf16_f32 v165, v18, v19
    v_cvt_pk_bf16_f32 v166, v20, v21
    v_cvt_pk_bf16_f32 v167, v22, v23
    buffer_store_dwordx4 v[164:167], v242, s[12:15], 0 offen sc1
    v_add_u32 v242, 1048576, v242
    s_waitcnt lgkmcnt(3)
    v_mfma_f32_16x16x32_bf16 v[24:27], v[120:123], v[200:203], v[24:27]
    ds_read_b128 v[136:139], v241 offset:13952
    v_mfma_f32_16x16x32_bf16 v[28:31], v[120:123], v[216:219], v[28:31]
    s_waitcnt lgkmcnt(3)
    v_mfma_f32_16x16x32_bf16 v[24:27], v[124:127], v[204:207], v[24:27]
    ds_read_b128 v[140:143], v241 offset:14016
    v_mfma_f32_16x16x32_bf16 v[28:31], v[124:127], v[220:223], v[28:31]
    s_waitcnt lgkmcnt(3)
    v_mfma_f32_16x16x32_bf16 v[32:35], v[128:131], v[192:195], 0
    ds_read_b128 v[144:147], v241 offset:18432
    v_mfma_f32_16x16x32_bf16 v[36:39], v[128:131], v[208:211], 0
    s_waitcnt lgkmcnt(3)
    v_mfma_f32_16x16x32_bf16 v[32:35], v[132:135], v[196:199], v[32:35]
    ds_read_b128 v[148:151], v241 offset:18496
    v_mfma_f32_16x16x32_bf16 v[36:39], v[132:135], v[212:215], v[36:39]
    v_cvt_pk_bf16_f32 v168, v24, v25
    v_cvt_pk_bf16_f32 v169, v26, v27
    v_cvt_pk_bf16_f32 v170, v28, v29
    v_cvt_pk_bf16_f32 v171, v30, v31
    buffer_store_dwordx4 v[168:171], v242, s[12:15], 0 offen sc1
    v_add_u32 v242, 1048576, v242
    s_waitcnt lgkmcnt(3)
    v_mfma_f32_16x16x32_bf16 v[32:35], v[136:139], v[200:203], v[32:35]
    ds_read_b128 v[152:155], v241 offset:18560
    v_mfma_f32_16x16x32_bf16 v[36:39], v[136:139], v[216:219], v[36:39]
    s_waitcnt lgkmcnt(3)
    v_mfma_f32_16x16x32_bf16 v[32:35], v[140:143], v[204:207], v[32:35]
    ds_read_b128 v[156:159], v241 offset:18624
    v_mfma_f32_16x16x32_bf16 v[36:39], v[140:143], v[220:223], v[36:39]
    s_waitcnt lgkmcnt(3)
    v_mfma_f32_16x16x32_bf16 v[40:43], v[144:147], v[192:195], 0
    v_mfma_f32_16x16x32_bf16 v[44:47], v[144:147], v[208:211], 0
    s_waitcnt lgkmcnt(2)
    v_mfma_f32_16x16x32_bf16 v[40:43], v[148:151], v[196:199], v[40:43]
    v_mfma_f32_16x16x32_bf16 v[44:47], v[148:151], v[212:215], v[44:47]
    s_waitcnt lgkmcnt(1)
    v_mfma_f32_16x16x32_bf16 v[40:43], v[152:155], v[200:203], v[40:43]
    v_mfma_f32_16x16x32_bf16 v[44:47], v[152:155], v[216:219], v[44:47]
    v_cvt_pk_bf16_f32 v172, v32, v33
    v_cvt_pk_bf16_f32 v173, v34, v35
    v_cvt_pk_bf16_f32 v174, v36, v37
    v_cvt_pk_bf16_f32 v175, v38, v39
    buffer_store_dwordx4 v[172:175], v242, s[12:15], 0 offen sc1
    v_add_u32 v242, 1048576, v242
    s_waitcnt lgkmcnt(0)
    v_mfma_f32_16x16x32_bf16 v[40:43], v[156:159], v[204:207], v[40:43]
    v_mfma_f32_16x16x32_bf16 v[44:47], v[156:159], v[220:223], v[44:47]
    s_nop 7
    v_cvt_pk_bf16_f32 v160, v40, v41
    v_cvt_pk_bf16_f32 v161, v42, v43
    v_cvt_pk_bf16_f32 v162, v44, v45
    v_cvt_pk_bf16_f32 v163, v46, v47
    buffer_store_dwordx4 v[160:163], v242, s[12:15], 0 offen sc1
L_end:
    s_endpgm
.section .rodata,"a"
.p2align 6
.amdhsa_kernel standalone__tensor_product_equiv_tfn__graph_kernel
.amdhsa_next_free_vgpr 250
.amdhsa_next_free_sgpr 100
.amdhsa_accum_offset 252
.amdhsa_group_segment_fixed_size 0
.amdhsa_kernarg_size 88
.amdhsa_user_sgpr_count 2
.amdhsa_user_sgpr_kernarg_segment_ptr 1
.amdhsa_system_sgpr_workgroup_id_x 1
.amdhsa_float_denorm_mode_32 3
.end_amdhsa_kernel
```

```asm
; @launch grid=(256,1,1) block=(512,1,1) lds=161808
.amdgcn_target "amdgcn-amd-amdhsa--gfx950"
.text
.globl standalone__tensor_product_equiv_tfn__graph_kernel
.p2align 8
.type standalone__tensor_product_equiv_tfn__graph_kernel,@function
standalone__tensor_product_equiv_tfn__graph_kernel:
    s_cmp_ge_u32 s2, 256
    s_cbranch_scc1 L_end
    s_load_dwordx16 s[36:51], s[0:1], 0
    s_load_dwordx2 s[52:53], s[0:1], 64
    s_load_dwordx2 s[56:57], s[0:1], 80
    v_lshrrev_b32 v2, 6, v0
    v_and_b32 v1, 63, v0
    v_readfirstlane_b32 s16, v2
    s_and_b32 s17, s2, 7
    s_lshl_b32 s17, s17, 5
    s_lshr_b32 s26, s2, 3
    s_or_b32 s17, s17, s26
    v_lshlrev_b32 v7, 3, v0
    v_mov_b32 v2, 0
    v_mov_b32 v3, 0
    v_mov_b32 v4, 161792
    ds_write_b64 v7, v[2:3]
    ds_write_b32 v4, v2
    v_lshlrev_b32 v232, 4, v1
    s_mul_i32 s26, s16, 160
    v_add_u32 v6, s26, v1
    v_lshlrev_b32 v53, 2, v6
    v_lshlrev_b32 v54, 3, v6
    s_mul_i32 s26, s16, 1920
    v_add_u32 v55, s26, v232
    s_mul_i32 s26, s16, 5120
    v_add_u32 v56, s26, v232
    s_cmp_lt_u32 s16, 7
    s_cselect_b32 s60, -1, 3
    s_mov_b32 s61, 0
    s_cselect_b64 s[62:63], -1, 15
    s_cselect_b32 s34, -1, 0xff
    s_cselect_b32 s35, 0xffffff, s34
    s_mul_i32 s58, s17, 5000
    s_mul_i32 s59, s17, 10000
    s_lshl_b32 s29, s17, 6
    s_add_u32 s29, s29, 14417920
    s_waitcnt lgkmcnt(0)
    s_mov_b32 s64, s40
    s_mov_b32 s65, s41
    s_mov_b32 s66, 1280000
    s_mov_b32 s67, 0x00020000
    buffer_load_dword v144, v53, s[64:67], s58 offen offset:0
    buffer_load_dword v145, v53, s[64:67], s58 offen offset:256
    s_mov_b64 exec, s[60:61]
    buffer_load_dword v146, v53, s[64:67], s58 offen offset:512
    s_mov_b64 exec, -1
    s_getpc_b64 s[82:83]
L_pc:
    s_lshr_b32 s80, s2, 3
    s_lshl_b32 s80, s80, 3
    s_add_u32 s80, s80, s16
    s_lshl_b32 s81, s80, 6
    s_min_u32 s81, s81, L_end-L_pc
    s_load_dword s3, s[82:83], s81
    s_lshl_b32 s81, s80, 7
    s_load_dword s3, s[50:51], s81
    s_add_u32 s81, s81, 64
    s_load_dword s3, s[50:51], s81
    s_mov_b32 s68, s38
    s_mov_b32 s69, s39
    s_mov_b32 s70, 1280000
    s_mov_b32 s71, 0x00020000
    buffer_load_dword v147, v53, s[68:71], s58 offen offset:0
    buffer_load_dword v148, v53, s[68:71], s58 offen offset:256
    s_mov_b64 exec, s[60:61]
    buffer_load_dword v149, v53, s[68:71], s58 offen offset:512
    s_mov_b64 exec, -1
    s_mov_b32 s72, s42
    s_mov_b32 s73, s43
    s_mov_b32 s74, 2560000
    s_mov_b32 s75, 0x00020000
    buffer_load_dwordx2 v[152:153], v54, s[72:75], s59 offen offset:0
    buffer_load_dwordx2 v[156:157], v54, s[72:75], s59 offen offset:512
    s_mov_b64 exec, s[60:61]
    buffer_load_dwordx2 v[160:161], v54, s[72:75], s59 offen offset:1024
    s_mov_b64 exec, -1
    s_mov_b32 s8, s56
    s_mov_b32 s9, s57
    s_mov_b32 s10, 16777216
    s_mov_b32 s11, 0x00020000
    s_mov_b32 s76, s44
    s_mov_b32 s77, s45
    s_mov_b32 s78, 10240000
    s_mov_b32 s79, 0x00020000
    s_barrier
    s_add_u32 m0, s26, 61440
    s_mul_i32 s58, s17, 40000
    buffer_load_dwordx4 v56, s[76:79], s58 offen offset:0  lds
    buffer_load_dwordx4 v56, s[76:79], s58 offen offset:1024  lds
    buffer_load_dwordx4 v56, s[76:79], s58 offen offset:2048  lds
    buffer_load_dwordx4 v56, s[76:79], s58 offen offset:3072  lds
    s_add_u32 m0, s26, 65536
    s_add_u32 s58, s58, 4096
    s_mov_b64 exec, s[62:63]
    buffer_load_dwordx4 v56, s[76:79], s58 offen  lds
    s_mov_b64 exec, -1
    v_mov_b32 v6, 1
    v_lshrrev_b32 v7, 2, v1
    v_mul_u32_u24 v7, 16320, v7
    v_add_u32 v245, v7, v232
    s_cmp_eq_u32 s16, 7
    s_cselect_b32 s59, s29, 0x40000000
    v_add_u32 v7, s59, v245
    buffer_load_dwordx4 v[64:67], v7, s[8:11], 0 offen sc1
    s_waitcnt vmcnt(12)
    v_bfe_u32 v2, v144, 3, 5
    v_and_b32 v3, 7, v144
    v_lshl_or_b32 v2, v3, 5, v2
    v_lshlrev_b32 v167, 2, v2
    ds_add_rtn_u32 v164, v167, v6 offset:3072
    v_bfe_u32 v2, v145, 3, 5
    v_and_b32 v3, 7, v145
    v_lshl_or_b32 v2, v3, 5, v2
    v_lshlrev_b32 v168, 2, v2
    ds_add_rtn_u32 v165, v168, v6 offset:3072
    s_mov_b64 exec, s[60:61]
    v_bfe_u32 v2, v146, 3, 5
    v_and_b32 v3, 7, v146
    v_lshl_or_b32 v2, v3, 5, v2
    v_lshlrev_b32 v169, 2, v2
    ds_add_rtn_u32 v166, v169, v6 offset:3072
    s_mov_b64 exec, -1
    s_movk_i32 s27, 5033
    s_waitcnt vmcnt(9)
    s_movk_i32 s27, 4797
    v_mov_b32 v5, 2352256
    s_movk_i32 s59, -1250
    v_bfe_u32 v3, v167, 7,3
    v_mad_i32_i24 v2, v3, s59, v147
    v_add_u32 v3, 10000, v2
    v_min_u32 v2, v2, v3
    v_mul_u32_u24 v3, 10922, v2
    v_mad_u32_u24 v2, v2, s27, v5
    v_min_u32 v2, v2, v3
    v_lshrrev_b32 v2, 22, v2
    v_lshrrev_b32 v3, 8, v144
    v_mad_u32_u24 v2, v3, 12, v2
    v_lshl_or_b32 v154, v147, 10, v2
    v_bfe_u32 v3, v168, 7,3
    v_mad_i32_i24 v2, v3, s59, v148
    v_add_u32 v3, 10000, v2
    v_min_u32 v2, v2, v3
    v_mul_u32_u24 v3, 10922, v2
    v_mad_u32_u24 v2, v2, s27, v5
    v_min_u32 v2, v2, v3
    v_lshrrev_b32 v2, 22, v2
    v_lshrrev_b32 v3, 8, v145
    v_mad_u32_u24 v2, v3, 12, v2
    v_lshl_or_b32 v158, v148, 10, v2
    v_bfe_u32 v3, v169, 7,3
    v_mad_i32_i24 v2, v3, s59, v149
    v_add_u32 v3, 10000, v2
    v_min_u32 v2, v2, v3
    v_mul_u32_u24 v3, 10922, v2
    v_mad_u32_u24 v2, v2, s27, v5
    v_min_u32 v2, v2, v3
    v_lshrrev_b32 v2, 22, v2
    v_lshrrev_b32 v3, 8, v146
    v_mad_u32_u24 v2, v3, 12, v2
    v_lshl_or_b32 v162, v149, 10, v2
    s_waitcnt lgkmcnt(0)
    s_barrier
    ds_read_b128 v[172:175], v232 offset:3072
    s_waitcnt lgkmcnt(0)
    v_add_u32 v50, v172, v173
    v_add_u32 v51, v50, v174
    v_add_u32 v2, v51, v175
    v_mov_b32 v3, v2
    v_lshlrev_b32 v4, 2, v54
    v_lshrrev_b32 v5, 1, v0
    v_add_u32_dpp v3, v3, v3 row_shr:1 row_mask:0xf bank_mask:0xf
    s_lshr_b32 s59, s17, 4
    s_mul_i32 s59, s59, 16320
    v_add_u32_dpp v3, v3, v3 row_shr:2 row_mask:0xf bank_mask:0xf
    s_lshl2_add_u32 s59, s17, s59
    s_add_u32 s59, s59, 14417920
    v_add_u32_dpp v3, v3, v3 row_shr:4 row_mask:0xf bank_mask:0xf
    v_lshl_add_u32 v58, v5, 6, s59
    s_nop 0
    v_add_u32_dpp v3, v3, v3 row_shr:8 row_mask:0xf bank_mask:0xf
    s_nop 1
    v_add_u32_dpp v3, v3, v3 row_bcast:15 row_mask:0xa bank_mask:0xf
    s_nop 1
    v_add_u32_dpp v3, v3, v3 row_bcast:31 row_mask:0xc bank_mask:0xf
    v_sub_u32 v48, v3, v2
    v_add_u32 v49, v48, v172
    v_add_u32 v50, v48, v50
    v_add_u32 v51, v48, v51
    ds_write_b128 v232, v[48:51] offset:10752
    ds_read_b32 v167, v167 offset:10752
    ds_read_b32 v168, v168 offset:10752
    s_mov_b64 exec, s[60:61]
    ds_read_b32 v169, v169 offset:10752
    s_mov_b64 exec, -1
    v_lshl_or_b32 v60, v172, 16, v48
    v_lshl_or_b32 v61, v173, 16, v49
    v_lshl_or_b32 v62, v174, 16, v50
    v_lshl_or_b32 v63, v175, 16, v51
    s_mov_b32 s27, 46080
    s_waitcnt vmcnt(6) lgkmcnt(0)
    v_add_lshl_u32 v2, v167, v164, 1
    v_add_u32 v3, 0, v4
    ds_write_b16 v2, v3 offset:8192
    v_mad_u32_u24 v2, v2, 6, s27
    ds_write2_b32 v2, v152, v153 offset0:0 offset1:1
    ds_write_b32 v2, v154 offset:8
    v_add_lshl_u32 v2, v168, v165, 1
    v_add_u32 v3, 2048, v4
    ds_write_b16 v2, v3 offset:8192
    v_mad_u32_u24 v2, v2, 6, s27
    ds_write2_b32 v2, v156, v157 offset0:0 offset1:1
    ds_write_b32 v2, v158 offset:8
    s_mov_b64 exec, s[60:61]
    v_add_lshl_u32 v2, v169, v166, 1
    v_add_u32 v3, 4096, v4
    ds_write_b16 v2, v3 offset:8192
    v_mad_u32_u24 v2, v2, 6, s27
    ds_write2_b32 v2, v160, v161 offset0:0 offset1:1
    ds_write_b32 v2, v162 offset:8
    s_mov_b64 exec, -1
    v_lshrrev_b32 v2, 4, v56
    v_and_b32 v2, 0xffe, v2
    v_and_b32 v5, 1, v1
    v_lshlrev_b32 v5, 4, v5
    s_waitcnt lgkmcnt(0)
    s_barrier
    buffer_load_dword v59, v58, s[8:11], 0 offen sc1
    s_mov_b32 s68, s46
    s_mov_b32 s69, s47
    s_mov_b32 s70, 4096
    s_mov_b32 s71, 0x00020000
    s_mov_b32 s64, s48
    s_mov_b32 s65, s49
    s_mov_b32 s66, 128
    s_mov_b32 s67, 0x00020000
    v_lshlrev_b32 v7, 1, v1
    s_lshl_b32 s58, s16, 9
    s_add_u32 m0, s58, 16384
    s_mov_b32 exec_hi, 0
    buffer_load_dwordx4 v232, s[68:71], s58 offen lds
    s_mov_b32 exec_hi, -1
    buffer_load_ushort v57, v7, s[64:67], 0 offen
    ds_read_b128 v[152:155], v55 offset:46080
    ds_read_b128 v[156:159], v55 offset:47104
    ds_read_u16 v164, v2 offset:8192
    ds_read_u16 v165, v2 offset:8256
    ds_read_u16 v166, v2 offset:8320
    ds_read_u16 v167, v2 offset:8384
    ds_read_u16 v168, v2 offset:8448
    s_mov_b32 s4, s36
    s_mov_b32 s5, s37
    s_mov_b32 s6, 10240000
    s_mov_b32 s7, 0x00020000
    s_mov_b32 s12, s52
    s_mov_b32 s13, s53
    s_mov_b32 s14, 10240000
    s_mov_b32 s15, 0x00020000
    s_mov_b32 s20, 0x0f0f0f0f
    s_mov_b32 s21, 0x0f0f0f0f
    s_mov_b32 s22, 0xf0f0f0f0
    s_mov_b32 s23, 0xf0f0f0f0
    s_mov_b32 s31, 0xfffffc00
    s_mov_b32 s32, 0x9c4028
    s_mov_b32 s33, 0xffe0
    s_mov_b32 s24, 0
    s_mov_b32 s25, 0
    v_mov_b32 v8, 0
    v_mov_b32 v9, 0
    v_mov_b32 v10, 0
    v_mov_b32 v11, 0
    v_mov_b32 v12, 0
    v_mov_b32 v13, 0
    v_mov_b32 v14, 0
    v_mov_b32 v15, 0
    v_mov_b32 v16, 0
    v_mov_b32 v17, 0
    v_mov_b32 v18, 0
    v_mov_b32 v19, 0
    v_mov_b32 v20, 0
    v_mov_b32 v21, 0
    v_mov_b32 v22, 0
    v_mov_b32 v23, 0
    v_mov_b32 v24, 0
    v_mov_b32 v25, 0
    v_mov_b32 v26, 0
    v_mov_b32 v27, 0
    v_mov_b32 v28, 0
    v_mov_b32 v29, 0
    v_mov_b32 v30, 0
    v_mov_b32 v31, 0
    v_mov_b32 v32, 0
    v_mov_b32 v33, 0
    v_mov_b32 v34, 0
    v_mov_b32 v35, 0
    v_mov_b32 v36, 0
    v_mov_b32 v37, 0
    v_mov_b32 v38, 0
    v_mov_b32 v39, 0
    v_mov_b32 v40, 0
    v_mov_b32 v41, 0
    v_mov_b32 v42, 0
    v_mov_b32 v43, 0
    v_mov_b32 v44, 0
    v_mov_b32 v45, 0
    v_mov_b32 v46, 0
    v_mov_b32 v47, 0
    v_mov_b32 v192, 0
    v_mov_b32 v193, 0
    v_mov_b32 v194, 0
    v_mov_b32 v195, 0
    v_mov_b32 v196, 0
    v_mov_b32 v197, 0
    v_mov_b32 v198, 0
    v_mov_b32 v199, 0
    v_mov_b32 v112, 0
    v_mov_b32 v238, 0
    s_cmp_lt_u32 s2, 16
    s_cbranch_scc1 L_map40
    v_writelane_b32 v112, 0, 0
    v_writelane_b32 v112, 5, 1
    v_writelane_b32 v112, 6, 2
    v_writelane_b32 v112, 3, 3
    v_writelane_b32 v112, 8, 4
    v_writelane_b32 v112, 7, 5
    v_writelane_b32 v112, 2, 6
    v_writelane_b32 v112, 4, 7
    v_writelane_b32 v112, 1, 8
    v_writelane_b32 v112, 16, 9
    v_writelane_b32 v112, 10, 10
    v_writelane_b32 v112, 15, 11
    v_writelane_b32 v112, 9, 12
    v_writelane_b32 v112, 24, 13
    v_writelane_b32 v112, 14, 14
    v_writelane_b32 v112, 11, 15
    v_writelane_b32 v112, 13, 16
    v_writelane_b32 v112, 12, 17
    v_writelane_b32 v112, 17, 18
    v_writelane_b32 v112, 23, 19
    v_writelane_b32 v112, 20, 20
    v_writelane_b32 v112, 22, 21
    v_writelane_b32 v112, 19, 22
    v_writelane_b32 v112, 18, 23
    v_writelane_b32 v112, 21, 24
    v_writelane_b32 v112, 28, 25
    v_writelane_b32 v112, 29, 26
    v_writelane_b32 v112, 31, 27
    v_writelane_b32 v112, 26, 28
    v_writelane_b32 v112, 25, 29
    v_writelane_b32 v112, 27, 30
    v_writelane_b32 v112, 30, 31
    v_writelane_b32 v112, 36, 32
    v_writelane_b32 v112, 33, 33
    v_writelane_b32 v112, 35, 34
    v_writelane_b32 v112, 34, 35
    v_writelane_b32 v112, 38, 36
    v_writelane_b32 v112, 39, 37
    v_writelane_b32 v112, 37, 38
    v_writelane_b32 v112, 32, 39
    s_branch L_mapd
L_map40:
    v_writelane_b32 v112, 7, 0
    v_writelane_b32 v112, 0, 1
    v_writelane_b32 v112, 5, 2
    v_writelane_b32 v112, 2, 3
    v_writelane_b32 v112, 4, 4
    v_writelane_b32 v112, 3, 5
    v_writelane_b32 v112, 1, 6
    v_writelane_b32 v112, 6, 7
    v_writelane_b32 v112, 12, 8
    v_writelane_b32 v112, 9, 9
    v_writelane_b32 v112, 14, 10
    v_writelane_b32 v112, 11, 11
    v_writelane_b32 v112, 15, 12
    v_writelane_b32 v112, 10, 13
    v_writelane_b32 v112, 8, 14
    v_writelane_b32 v112, 13, 15
    v_writelane_b32 v112, 21, 16
    v_writelane_b32 v112, 22, 17
    v_writelane_b32 v112, 19, 18
    v_writelane_b32 v112, 16, 19
    v_writelane_b32 v112, 23, 20
    v_writelane_b32 v112, 17, 21
    v_writelane_b32 v112, 18, 22
    v_writelane_b32 v112, 20, 23
    v_writelane_b32 v112, 26, 24
    v_writelane_b32 v112, 29, 25
    v_writelane_b32 v112, 27, 26
    v_writelane_b32 v112, 25, 27
    v_writelane_b32 v112, 28, 28
    v_writelane_b32 v112, 30, 29
    v_writelane_b32 v112, 24, 30
    v_writelane_b32 v112, 31, 31
    v_writelane_b32 v112, 38, 32
    v_writelane_b32 v112, 33, 33
    v_writelane_b32 v112, 36, 34
    v_writelane_b32 v112, 35, 35
    v_writelane_b32 v112, 34, 36
    v_writelane_b32 v112, 32, 37
    v_writelane_b32 v112, 37, 38
    v_writelane_b32 v112, 39, 39
L_mapd:
    v_and_b32 v2, 3, v1
    v_lshrrev_b32 v3, 2, v1
    v_lshl_add_u32 v234, v2, 4, v3
    v_lshrrev_b32 v2, 5, v1
    v_lshlrev_b32 v233, 4, v2
    s_mul_i32 s26, s16, 5
    v_add_u32 v113, s26, v1
    v_subrev_u32 v3, 40, v113
    v_min_u32 v113, v113, v3
    v_mul_u32_u24 v3, 205, v1
    v_lshrrev_b32 v3, 10, v3
    v_mul_u32_u24 v2, 5, v3
    v_sub_u32 v115, v1, v2
    v_lshlrev_b32 v114, 2, v3
    s_lshl_b32 s81, s16, 10
    s_add_u32 s81, s81, 8192
    s_mul_i32 s80, s16, 6912
    v_lshl_add_u32 v121, v1, 2, s81
    v_lshrrev_b32 v3, 1, v1
    v_lshl_add_u32 v122, v3, 2, s81
    v_and_b32 v2, 1, v1
    v_lshlrev_b32 v123, 4, v2
    v_lshrrev_b32 v3, 1, v0
    v_mul_u32_u24 v3, 1280, v3
    v_add_u32 v124, v3, v2
    v_mul_u32_u24 v125, 48, v113
    s_lshl_b32 s26, s16, 2
    v_lshl_add_u32 v126, v115, 5, s26
    v_lshl_add_u32 v127, v1, 5, s80
    s_cmp_eq_u32 s16, 7
    s_cselect_b32 s54, 0, 1
    s_lshr_b32 s26, s17, 5
    s_mul_i32 s26, s26, 1218
    s_add_u32 s26, s26, s17
    s_lshl3_add_u32 s26, s26, s16
    s_lshl_b32 s26, s26, 7
    v_lshl_add_u32 v120, v1, 15, s26
    s_and_b32 s26, s16, 3
    s_lshl_b32 s58, s26, 9
    s_add_u32 s58, s58, 129024
    v_lshrrev_b32 v3, 4, v1
    v_mul_u32_u24 v2, 1792, v3
    v_add3_u32 v240, v2, s58, v232
    s_lshr_b32 s58, s16, 2
    v_and_b32 v2, 15, v1
    v_mul_u32_u24 v241, 288, v2
    v_lshl_add_u32 v241, v3, 4, v241
    s_mul_i32 s59, s58, 23040
    v_add_u32 v241, s59, v241
    v_lshlrev_b32 v242, 18, v3
    v_lshl_add_u32 v242, v2, 4, v242
    s_mul_i32 s58, s58, 5242880
    s_lshl_b32 s59, s2, 10
    s_add_u32 s58, s58, s59
    s_lshl_b32 s59, s26, 8
    s_add_u32 s58, s58, s59
    v_add_u32 v242, s58, v242
    v_mov_b32 v244, 161792
    s_mov_b32 s72, s50
    s_mov_b32 s73, s51
    s_mov_b32 s74, 32768
    s_mov_b32 s75, 0x00020000
    s_waitcnt lgkmcnt(0)
    v_or_b32 v164, v164, v5
    v_or_b32 v165, v165, v5
    v_or_b32 v166, v166, v5
    v_or_b32 v167, v167, v5
    v_or_b32 v168, v168, v5
    s_mul_i32 s27, s17, 15360
    s_add_u32 s27, s27, 10485760
    s_mul_i32 s58, s17, 40960
    s_add_u32 s59, s58, 4096
    s_waitcnt vmcnt(4)
    s_barrier
    ds_read_b128 v[80:83], v164 offset:61440
    ds_read_b128 v[84:87], v165 offset:61440
    ds_read_b128 v[88:91], v166 offset:61440
    ds_read_b128 v[92:95], v167 offset:61440
    s_mov_b64 exec, s[62:63]
    ds_read_b128 v[96:99], v168 offset:61440
    s_mov_b64 exec, -1
    s_waitcnt vmcnt(2)
    buffer_store_dwordx4 v[152:155], v55, s[8:11], s27 offen sc1
    s_mov_b32 exec_hi, s35
    buffer_store_dwordx4 v[156:159], v55, s[8:11], s27 offen offset:1024 sc1
    s_mov_b32 exec_hi, -1
    s_waitcnt lgkmcnt(4)
    buffer_store_dwordx4 v[80:83], v56, s[8:11], s58 offen offset:0 sc1
    s_waitcnt lgkmcnt(3)
    buffer_store_dwordx4 v[84:87], v56, s[8:11], s58 offen offset:1024 sc1
    s_waitcnt lgkmcnt(2)
    buffer_store_dwordx4 v[88:91], v56, s[8:11], s58 offen offset:2048 sc1
    s_waitcnt lgkmcnt(1)
    buffer_store_dwordx4 v[92:95], v56, s[8:11], s58 offen offset:3072 sc1
    s_mov_b32 exec_lo, s34
    s_mov_b32 exec_hi, s63
    s_waitcnt lgkmcnt(0)
    buffer_store_dwordx4 v[96:99], v56, s[8:11], s59 offen offset:0 sc1
    s_mov_b64 exec, -1
    s_mov_b32 s30, 400000
    s_mov_b32 s53, s29
    s_mov_b32 s59, 0xc0000000
    s_waitcnt vmcnt(7)
    v_and_or_b32 v60, v64, s59, v60
    v_xor_b32 v246, 0x40000000, v60
    v_xor_b32 v60, 0x80000000, v60
    v_and_or_b32 v61, v65, s59, v61
    v_xor_b32 v247, 0x40000000, v61
    v_xor_b32 v61, 0x80000000, v61
    v_and_or_b32 v62, v66, s59, v62
    v_xor_b32 v248, 0x40000000, v62
    v_xor_b32 v62, 0x80000000, v62
    v_and_or_b32 v63, v67, s59, v63
    v_xor_b32 v249, 0x40000000, v63
    v_xor_b32 v63, 0x80000000, v63
    v_and_b32 v2, 0x30, v1
    v_and_b32 v3, 3, v1
    v_lshl_add_u32 v2, v3, 2, v2
    v_bfe_u32 v7, v1, 2, 2
    v_add_lshl_u32 v2, v2, v7, 1
    ds_write_b16 v2, v57 offset:6656
    v_lshlrev_b32 v3, 3, v3
    ds_read_b64 v[216:217], v3 offset:6656
    ds_read_b64 v[218:219], v3 offset:6688
    ds_read_b64 v[220:221], v3 offset:6720
    ds_read_b64 v[222:223], v3 offset:6752
    s_lshl_b32 s58, s16, 12
    s_add_u32 m0, s58, 129024
    s_cmp_eq_u32 s16, 7
    s_waitcnt vmcnt(0) lgkmcnt(0)
    s_barrier
    s_cbranch_scc0 L_nrow2
    buffer_store_dwordx4 v[60:63], v245, s[8:11], s29 offen sc1
L_nrow2:
    s_barrier
    buffer_load_dwordx4 v232, s[72:75], s58 offen offset:0 lds
    buffer_load_dwordx4 v232, s[72:75], s58 offen offset:1024 lds
    buffer_load_dwordx4 v232, s[72:75], s58 offen offset:2048 lds
    buffer_load_dwordx4 v232, s[72:75], s58 offen offset:3072 lds
    v_and_b32 v3, 31, v1
    v_lshlrev_b32 v2, 7, v233
    v_lshl_add_u32 v2, v3, 2, v2
    v_add_u32 v3, 128, v2
    ds_read2st64_b32 v[144:145], v2 offset0:64 offset1:65
    ds_read2st64_b32 v[146:147], v2 offset0:66 offset1:67
    ds_read2st64_b32 v[148:149], v2 offset0:68 offset1:69
    ds_read2st64_b32 v[150:151], v2 offset0:70 offset1:71
    ds_read2st64_b32 v[152:153], v3 offset0:64 offset1:65
    ds_read2st64_b32 v[154:155], v3 offset0:66 offset1:67
    ds_read2st64_b32 v[156:157], v3 offset0:68 offset1:69
    ds_read2st64_b32 v[158:159], v3 offset0:70 offset1:71
    s_mov_b32 s56, 0xbfb8aa3b
    s_mov_b32 s57, 0xbfb8aa3b
    s_waitcnt lgkmcnt(7)
    v_lshlrev_b32 v160, 16, v144
    v_lshlrev_b32 v161, 16, v145
    v_and_b32 v162, 0xffff0000, v144
    v_and_b32 v163, 0xffff0000, v145
    v_pk_mul_f32 v[160:161], v[160:161], s[56:57]
    v_pk_mul_f32 v[162:163], v[162:163], s[56:57]
    v_cvt_pk_bf16_f32 v200, v160, v161
    v_cvt_pk_bf16_f32 v204, v162, v163
    s_waitcnt lgkmcnt(6)
    v_lshlrev_b32 v160, 16, v146
    v_lshlrev_b32 v161, 16, v147
    v_and_b32 v162, 0xffff0000, v146
    v_and_b32 v163, 0xffff0000, v147
    v_pk_mul_f32 v[160:161], v[160:161], s[56:57]
    v_pk_mul_f32 v[162:163], v[162:163], s[56:57]
    v_cvt_pk_bf16_f32 v201, v160, v161
    v_cvt_pk_bf16_f32 v205, v162, v163
    s_waitcnt lgkmcnt(5)
    v_lshlrev_b32 v160, 16, v148
    v_lshlrev_b32 v161, 16, v149
    v_and_b32 v162, 0xffff0000, v148
    v_and_b32 v163, 0xffff0000, v149
    v_pk_mul_f32 v[160:161], v[160:161], s[56:57]
    v_pk_mul_f32 v[162:163], v[162:163], s[56:57]
    v_cvt_pk_bf16_f32 v202, v160, v161
    v_cvt_pk_bf16_f32 v206, v162, v163
    s_waitcnt lgkmcnt(4)
    v_lshlrev_b32 v160, 16, v150
    v_lshlrev_b32 v161, 16, v151
    v_and_b32 v162, 0xffff0000, v150
    v_and_b32 v163, 0xffff0000, v151
    v_pk_mul_f32 v[160:161], v[160:161], s[56:57]
    v_pk_mul_f32 v[162:163], v[162:163], s[56:57]
    v_cvt_pk_bf16_f32 v203, v160, v161
    v_cvt_pk_bf16_f32 v207, v162, v163
    s_waitcnt lgkmcnt(3)
    v_lshlrev_b32 v160, 16, v152
    v_lshlrev_b32 v161, 16, v153
    v_and_b32 v162, 0xffff0000, v152
    v_and_b32 v163, 0xffff0000, v153
    v_pk_mul_f32 v[160:161], v[160:161], s[56:57]
    v_pk_mul_f32 v[162:163], v[162:163], s[56:57]
    v_cvt_pk_bf16_f32 v208, v160, v161
    v_cvt_pk_bf16_f32 v212, v162, v163
    s_waitcnt lgkmcnt(2)
    v_lshlrev_b32 v160, 16, v154
    v_lshlrev_b32 v161, 16, v155
    v_and_b32 v162, 0xffff0000, v154
    v_and_b32 v163, 0xffff0000, v155
    v_pk_mul_f32 v[160:161], v[160:161], s[56:57]
    v_pk_mul_f32 v[162:163], v[162:163], s[56:57]
    v_cvt_pk_bf16_f32 v209, v160, v161
    v_cvt_pk_bf16_f32 v213, v162, v163
    s_waitcnt lgkmcnt(1)
    v_lshlrev_b32 v160, 16, v156
    v_lshlrev_b32 v161, 16, v157
    v_and_b32 v162, 0xffff0000, v156
    v_and_b32 v163, 0xffff0000, v157
    v_pk_mul_f32 v[160:161], v[160:161], s[56:57]
    v_pk_mul_f32 v[162:163], v[162:163], s[56:57]
    v_cvt_pk_bf16_f32 v210, v160, v161
    v_cvt_pk_bf16_f32 v214, v162, v163
    s_waitcnt lgkmcnt(0)
    v_lshlrev_b32 v160, 16, v158
    v_lshlrev_b32 v161, 16, v159
    v_and_b32 v162, 0xffff0000, v158
    v_and_b32 v163, 0xffff0000, v159
    v_pk_mul_f32 v[160:161], v[160:161], s[56:57]
    v_pk_mul_f32 v[162:163], v[162:163], s[56:57]
    v_cvt_pk_bf16_f32 v211, v160, v161
    v_cvt_pk_bf16_f32 v215, v162, v163
    v_mov_b32 v80, 0xffffff
    v_mov_b32 v81, 0xffffff
    v_mov_b32 v82, 0xffffff
    v_mov_b32 v83, 0xffffff
    v_add_u32 v2, s81, v232
    ds_write_b128 v2, v[80:83]
    v_and_b32 v7, 1, v1
L_pa:
    buffer_load_dword v6, v58, s[8:11], 0 offen sc1
    s_waitcnt vmcnt(0)
    v_xor_b32 v144, v6, v59
    v_cmpx_gt_u32 vcc, 0x40000000, v144
    s_cbranch_execz L_pda
    s_sub_u32 s30, s30, 1
    s_cbranch_scc0 L_pa
    s_endpgm
L_pda:
    s_mov_b64 exec, -1
    v_bfe_u32 v236, v6, 16, 11
    v_and_b32 v5, 0xffff, v6
    v_sub_u32 v2, v236, v7
    v_add_u32_dpp v236, v236, v236 row_shr:2 row_mask:0xf bank_mask:0xf
    v_add_u32 v5, v5, v124
    s_nop 0
    v_add_u32_dpp v236, v236, v236 row_shr:4 row_mask:0xf bank_mask:0xf
    s_nop 1
    v_add_u32_dpp v236, v236, v236 row_shr:8 row_mask:0xf bank_mask:0xf
    s_nop 1
    v_add_u32_dpp v236, v236, v236 row_bcast:15 row_mask:0xa bank_mask:0xf
    s_nop 1
    v_add_u32_dpp v236, v236, v236 row_bcast:31 row_mask:0xc bank_mask:0xf
    v_sub_u32 v3, v236, v2
    v_min_u32 v4, 216, v236
    v_lshl_add_u32 v6, v3, 2, s81
    v_sub_u32 v4, v4, v3
    v_sub_u32 v237, v5, v3
    v_sub_u32 v235, v3, v7
L_exp:
    v_cmpx_lt_i32 vcc, 0, v4
    ds_write_b32 v6, v5 offset:0
    v_add_u32 v5, 2, v5
    v_cmpx_lt_i32 vcc, 2, v4
    ds_write_b32 v6, v5 offset:8
    v_add_u32 v5, 2, v5
    v_cmpx_lt_i32 vcc, 4, v4
    ds_write_b32 v6, v5 offset:16
    v_add_u32 v5, 2, v5
    v_cmpx_lt_i32 vcc, 6, v4
    ds_write_b32 v6, v5 offset:24
    v_add_u32 v5, 2, v5
    v_cmpx_lt_i32 vcc, 8, v4
    ds_write_b32 v6, v5 offset:32
    v_add_u32 v5, 2, v5
    v_cmpx_lt_i32 vcc, 10, v4
    ds_write_b32 v6, v5 offset:40
    v_add_u32 v5, 2, v5
    v_cmpx_lt_i32 vcc, 12, v4
    s_cbranch_execnz L_exp_more
L_exp_done:
    s_mov_b64 exec, -1
    ds_read_b32 v99, v121 offset:768
    ds_read_b32 v98, v121 offset:512
    ds_read_b32 v97, v121 offset:256
    ds_read_b32 v96, v121 offset:0
    v_readlane_b32 s19, v236, 63
    s_mov_b32 s26, 10485760
    s_sub_i32 s28, s19, s24
    s_cmp_le_i32 s28, 192
    s_cbranch_scc1 L_sk3
    s_waitcnt lgkmcnt(3)
    v_mul_u32_u24 v99, 12, v99
    buffer_load_dwordx3 v[92:94], v99, s[8:11], s26 offen sc1
L_sk3:
    s_waitcnt lgkmcnt(2)
    v_mul_u32_u24 v98, 12, v98
    buffer_load_dwordx3 v[88:90], v98, s[8:11], s26 offen sc1
    s_waitcnt lgkmcnt(1)
    v_mul_u32_u24 v97, 12, v97
    buffer_load_dwordx3 v[84:86], v97, s[8:11], s26 offen sc1
    s_waitcnt lgkmcnt(0)
    v_mul_u32_u24 v96, 12, v96
    buffer_load_dwordx3 v[80:82], v96, s[8:11], s26 offen sc1
    ds_read_b32 v100, v122 offset:0
    ds_read_b32 v101, v122 offset:128
    ds_read_b32 v102, v122 offset:256
    ds_read_b32 v103, v122 offset:384
    ds_read_b32 v104, v122 offset:512
    ds_read_b32 v105, v122 offset:640
    ds_read_b32 v106, v122 offset:768
    s_max_i32 s28, s28, 0
    s_min_i32 s28, s28, 216
    s_barrier
    s_waitcnt lgkmcnt(6)
    v_lshl_or_b32 v100, v100, 5, v123
    s_add_u32 m0, s80, 46080
    s_cmp_le_u32 s28, 32
    buffer_load_dwordx4 v100, s[8:11], 0 offen sc1 lds
    s_waitcnt lgkmcnt(5)
    v_lshl_or_b32 v101, v101, 5, v123
    s_add_u32 m0, s80, 47104
    s_cmp_le_u32 s28, 64
    buffer_load_dwordx4 v101, s[8:11], 0 offen sc1 lds
    s_waitcnt lgkmcnt(0)
    v_lshl_or_b32 v102, v102, 5, v123
    v_lshl_or_b32 v103, v103, 5, v123
    v_lshl_or_b32 v104, v104, 5, v123
    v_lshl_or_b32 v105, v105, 5, v123
    v_lshl_or_b32 v106, v106, 5, v123
    s_sub_i32 s27, s28, 0
    v_cmp_gt_i32 s[36:37], s27, v1
    s_sub_i32 s27, s28, 64
    v_cmp_gt_i32 s[38:39], s27, v1
    s_sub_i32 s27, s28, 128
    v_cmp_gt_i32 s[40:41], s27, v1
    s_sub_i32 s27, s28, 192
    v_cmp_gt_i32 s[42:43], s27, v1
    v_mov_b32 v3, s19
    v_mov_b32 v4, 2048
    ds_max_u32 v4, v3
    v_mov_b32 v6, 1
    s_mov_b64 exec, 1
    ds_add_u32 v4, v3 offset:4
    s_mov_b64 exec, -1
    s_waitcnt vmcnt(5)
    s_mov_b64 exec, s[42:43]
    v_and_b32 v2, 0x3ff, v94
    v_lshlrev_b32 v95, 2, v2
    ds_add_rtn_u32 v111, v95, v6 offset:0
    s_waitcnt vmcnt(4)
    s_mov_b64 exec, s[40:41]
    v_and_b32 v2, 0x3ff, v90
    v_lshlrev_b32 v91, 2, v2
    ds_add_rtn_u32 v110, v91, v6 offset:0
    s_waitcnt vmcnt(3)
    s_mov_b64 exec, s[38:39]
    v_and_b32 v2, 0x3ff, v86
    v_lshlrev_b32 v87, 2, v2
    ds_add_rtn_u32 v109, v87, v6 offset:0
    s_waitcnt vmcnt(2)
    s_mov_b64 exec, s[36:37]
    v_and_b32 v2, 0x3ff, v82
    v_lshlrev_b32 v83, 2, v2
    ds_add_rtn_u32 v108, v83, v6 offset:0
    s_mov_b64 exec, -1
    s_waitcnt lgkmcnt(0)
    s_barrier
    ds_read_b128 v[148:151], v125 offset:0
    ds_read_b128 v[152:155], v125 offset:16
    ds_read_b128 v[156:159], v125 offset:32
    ds_read_b64 v[4:5], v4
    s_cmp_eq_u32 s24, s54
    s_cbranch_scc0 L_no2
    buffer_store_dwordx4 v[246:249], v245, s[8:11], s53 offen sc1
L_no2:
    s_cmp_le_u32 s28, 64
    s_cbranch_scc1 L_efd
    s_add_u32 m0, s80, 48128
    s_cmp_le_u32 s28, 96
    buffer_load_dwordx4 v102, s[8:11], 0 offen sc1 lds
    s_cbranch_scc1 L_efd
    s_add_u32 m0, s80, 49152
    s_cmp_le_u32 s28, 128
    buffer_load_dwordx4 v103, s[8:11], 0 offen sc1 lds
    s_cbranch_scc1 L_efd
    s_add_u32 m0, s80, 50176
    s_cmp_le_u32 s28, 160
    buffer_load_dwordx4 v104, s[8:11], 0 offen sc1 lds
    s_cbranch_scc1 L_efd
    s_add_u32 m0, s80, 51200
    s_cmp_le_u32 s28, 192
    buffer_load_dwordx4 v105, s[8:11], 0 offen sc1 lds
    s_cbranch_scc1 L_efd
    s_add_u32 m0, s80, 52224
    s_cmp_le_u32 s28, 224
    s_mov_b32 exec_hi, 0xffff
    buffer_load_dwordx4 v106, s[8:11], 0 offen sc1 lds
    s_mov_b32 exec_hi, -1
L_efd:
    v_cmp_gt_u32 vcc, 40, v1
    s_waitcnt lgkmcnt(0)
    v_readfirstlane_b32 s26, v4
    v_readfirstlane_b32 s27, v5
    v_add_u32 v3, v148, v149
    v_add3_u32 v3, v3, v150, v151
    v_add3_u32 v3, v3, v152, v153
    v_add3_u32 v3, v3, v154, v155
    v_add3_u32 v3, v3, v156, v157
    v_add3_u32 v3, v3, v158, v159
    v_lshl_or_b32 v3, v3, 6, v113
    v_cndmask_b32 v3, 0, v3, vcc
    s_max_u32 s25, s25, s26
    s_cmp_lg_u32 s24, 0
    s_cbranch_scc1 L_havepos
    v_readlane_b32 s64, v3, 0
    v_readlane_b32 s65, v3, 1
    v_readlane_b32 s66, v3, 2
    v_readlane_b32 s67, v3, 3
    v_readlane_b32 s68, v3, 4
    v_cmp_lt_u32 s[70:71], s64, v3
    v_cmp_lt_u32 s[72:73], s65, v3
    v_cmp_lt_u32 s[74:75], s66, v3
    v_cmp_lt_u32 s[76:77], s67, v3
    v_cmp_lt_u32 s[78:79], s68, v3
    s_bcnt1_i32_b64 s64, s[70:71]
    s_bcnt1_i32_b64 s65, s[72:73]
    s_bcnt1_i32_b64 s66, s[74:75]
    s_bcnt1_i32_b64 s67, s[76:77]
    s_bcnt1_i32_b64 s68, s[78:79]
    v_readlane_b32 s70, v112, s64
    v_readlane_b32 s71, v112, s65
    v_readlane_b32 s72, v112, s66
    v_readlane_b32 s73, v112, s67
    v_readlane_b32 s74, v112, s68
    v_writelane_b32 v238, s70, 0
    v_writelane_b32 v238, s71, 1
    v_writelane_b32 v238, s72, 2
    v_writelane_b32 v238, s73, 3
    v_writelane_b32 v238, s74, 4
    v_lshlrev_b32 v238, 2, v238
L_havepos:
    s_mov_b64 exec, 31
    ds_write_b32 v238, v3 offset:4096
    s_mov_b64 exec, -1
    v_lshlrev_b32 v4, 2, v1
    v_and_b32 v6, 7, v1
    v_cmp_gt_u32 s[34:35], s16, v6
    s_and_b64 s[34:35], s[34:35], vcc
    v_cmp_gt_u32 vcc, 60, v1
    s_cmp_gt_u32 s27, 1250
    s_cselect_b32 s26, 44, 0
    v_add_u32 v114, s26, v114
    v_subrev_u32 v2, 48, v114
    v_min_u32 v114, v114, v2
    s_waitcnt lgkmcnt(0)
    s_barrier
    ds_read_b32 v119, v126 offset:4096
    ds_read_b32 v4, v4 offset:4096
    s_waitcnt lgkmcnt(1)
    v_and_b32 v119, 63, v119
    v_mad_u32_u24 v3, v119, 48, v114
    ds_read_b32 v116, v3 offset:0
    s_waitcnt lgkmcnt(1)
    v_lshrrev_b32 v4, 6, v4
    v_cndmask_b32 v118, 0, v4, s[34:35]
    v_mul_u32_u24 v119, 1152, v119
    s_waitcnt lgkmcnt(0)
    v_cndmask_b32 v116, 0, v116, vcc
    v_mov_b32 v117, v116
    v_readlane_b32 s48, v119, 0
    v_readlane_b32 s49, v119, 1
    v_add_u32_dpp v117, v117, v117 row_shr:1 row_mask:0xf bank_mask:0xf
    v_add_u32_dpp v118, v118, v118 row_shr:1 row_mask:0xf bank_mask:0xf
    v_readlane_b32 s50, v119, 2
    v_add_u32_dpp v117, v117, v117 row_shr:2 row_mask:0xf bank_mask:0xf
    v_add_u32_dpp v118, v118, v118 row_shr:2 row_mask:0xf bank_mask:0xf
    v_readlane_b32 s51, v119, 3
    v_add_u32_dpp v117, v117, v117 row_shr:4 row_mask:0xf bank_mask:0xf
    v_add_u32_dpp v118, v118, v118 row_shr:4 row_mask:0xf bank_mask:0xf
    v_readlane_b32 s52, v119, 4
    v_add_u32_dpp v117, v117, v117 row_shr:8 row_mask:0xf bank_mask:0xf
    v_add_u32_dpp v118, v118, v118 row_shr:8 row_mask:0xf bank_mask:0xf
    v_lshlrev_b32 v4, 3, v115
    v_add_u32_dpp v117, v117, v117 row_bcast:15 row_mask:0xa bank_mask:0xf
    v_add_u32_dpp v118, v118, v118 row_bcast:15 row_mask:0xa bank_mask:0xf
    s_min_u32 s25, s25, 40000
    v_add_u32_dpp v117, v117, v117 row_bcast:31 row_mask:0xc bank_mask:0xf
    v_add_u32_dpp v118, v118, v118 row_bcast:31 row_mask:0xc bank_mask:0xf
    v_sub_u32 v116, v117, v116
    v_readlane_b32 s29, v118, 63
    v_readlane_b32 s18, v117, 63
    s_lshl_b32 s26, s29, 4
    s_add_u32 s26, s26, 101376
    v_lshl_add_u32 v116, v116, 4, s26
    v_lshl_or_b32 v116, v116, 10, v4
    s_mov_b64 exec, vcc
    ds_write_b32 v3, v116 offset:4608
    s_mov_b64 exec, -1
    s_min_u32 s18, s18, 1728
    v_lshl_add_u32 v230, v234, 4, s26
    v_and_b32 v2, 3, v1
    v_bfe_u32 v3, v1, 3, 2
    v_lshl_add_u32 v2, v3, 2, v2
    v_lshl_add_u32 v231, v2, 4, s26
    s_movk_i32 s27, 1023
    s_mov_b32 exec_lo, 0xfff
    s_mov_b32 exec_hi, 0x0
    buffer_load_dword v239, v120, s[4:7], 0 offen
    s_mov_b64 exec, -1
    s_waitcnt lgkmcnt(0)
    s_barrier
    s_mov_b64 exec, s[36:37]
    ds_read_b32 v96, v83 offset:4608
    s_mov_b64 exec, s[38:39]
    ds_read_b32 v97, v87 offset:4608
    s_mov_b64 exec, s[40:41]
    ds_read_b32 v98, v91 offset:4608
    s_mov_b64 exec, s[42:43]
    ds_read_b32 v99, v95 offset:4608
    s_mov_b64 exec, -1
    v_add_u32 v83, 0, v127
    v_add_u32 v87, 2048, v127
    v_add_u32 v91, 4096, v127
    v_add_u32 v95, 6144, v127
    s_waitcnt lgkmcnt(0)
    s_mov_b64 exec, s[36:37]
    v_bfi_b32 v82, s27, v96, v82
    v_lshrrev_b32 v96, 10, v96
    v_lshl_add_u32 v96, v108, 4, v96
    ds_write_b128 v96, v[80:83]
    s_mov_b64 exec, s[38:39]
    v_bfi_b32 v86, s27, v97, v86
    v_lshrrev_b32 v97, 10, v97
    v_lshl_add_u32 v97, v109, 4, v97
    ds_write_b128 v97, v[84:87]
    s_mov_b64 exec, s[40:41]
    v_bfi_b32 v90, s27, v98, v90
    v_lshrrev_b32 v98, 10, v98
    v_lshl_add_u32 v98, v110, 4, v98
    ds_write_b128 v98, v[88:91]
    s_mov_b64 exec, s[42:43]
    v_bfi_b32 v94, s27, v99, v94
    v_lshrrev_b32 v99, 10, v99
    v_lshl_add_u32 v99, v111, 4, v99
    ds_write_b128 v99, v[92:95]
    s_mov_b64 exec, -1
    v_cmp_gt_i32 vcc, s18, v234
    v_mov_b32 v4, s32
    s_waitcnt lgkmcnt(0)
    s_barrier
    ds_read_b128 v[224:227], v230
    ds_read_b32 v229, v231 offset:12
    ds_read_b32 v2, v231 offset:268
    s_mov_b32 s59, 101376
    s_waitcnt lgkmcnt(0)
    v_cndmask_b32 v228, v4, v226, vcc
    v_and_or_b32 v229, v229, s33, v233
    v_readlane_b32 s64, v228, 0
    v_readlane_b32 s65, v228, 4
    v_readlane_b32 s66, v228, 8
    v_readlane_b32 s67, v228, 12
    v_readlane_b32 s68, v228, 16
    v_readlane_b32 s69, v228, 20
    v_readlane_b32 s70, v228, 24
    v_readlane_b32 s71, v228, 28
    s_and_b32 s80, s64, s31
    buffer_load_dwordx4 v[48:51], v232, s[4:7], s80 offen
    s_and_b32 s81, s65, s31
    buffer_load_dwordx4 v[52:55], v232, s[4:7], s81 offen
    s_and_b32 s82, s66, s31
    buffer_load_dwordx4 v[56:59], v232, s[4:7], s82 offen
    s_and_b32 s83, s67, s31
    buffer_load_dwordx4 v[60:63], v232, s[4:7], s83 offen
    s_waitcnt vmcnt(5)
    s_barrier
    s_mov_b64 exec, s[20:21]
    ds_read_b128 v[192:195], v229 offset:46080
    s_mov_b64 exec, s[22:23]
    ds_read_b128 v[196:199], v229 offset:46080
    s_mov_b64 exec, -1
    v_and_or_b32 v229, v2, s33, v233
    s_waitcnt lgkmcnt(0)
    v_mfma_f32_32x32x16_bf16 v[80:95], v[192:195], v[200:203], 0
    v_mfma_f32_32x32x16_bf16 v[96:111], v[192:195], v[204:207], 0
    v_mfma_f32_32x32x16_bf16 v[80:95], v[196:199], v[208:211], v[80:95]
    v_mfma_f32_32x32x16_bf16 v[96:111], v[196:199], v[212:215], v[96:111]
    s_and_b32 s80, s68, s31
    buffer_load_dwordx4 v[64:67], v232, s[4:7], s80 offen
    s_and_b32 s81, s69, s31
    buffer_load_dwordx4 v[68:71], v232, s[4:7], s81 offen
    s_and_b32 s82, s70, s31
    buffer_load_dwordx4 v[72:75], v232, s[4:7], s82 offen
    s_and_b32 s83, s71, s31
    buffer_load_dwordx4 v[76:79], v232, s[4:7], s83 offen
    s_mov_b64 exec, s[20:21]
    ds_read_b128 v[192:195], v229 offset:46080
    s_mov_b64 exec, -1
    s_cmp_lg_u32 s24, 0
    s_cbranch_scc1 L_wdone
    v_lshrrev_b32 v7, 5, v0
    v_and_b32 v3, 31, v1
    v_lshlrev_b32 v7, 11, v7
    v_add_u32 v7, 129024, v7
    v_lshl_add_u32 v2, v3, 3, v7
    ds_read_b64 v[160:161], v2 offset:0
    ds_read_b64 v[162:163], v2 offset:256
    ds_read_b64 v[164:165], v2 offset:512
    ds_read_b64 v[166:167], v2 offset:768
    ds_read_b64 v[168:169], v2 offset:1024
    ds_read_b64 v[170:171], v2 offset:1280
    ds_read_b64 v[172:173], v2 offset:1536
    ds_read_b64 v[174:175], v2 offset:1792
    s_mov_b32 s58, 0x05040100
    s_mov_b32 s59, 0x07060302
    v_bfe_u32 v3, v0, 3, 2
    v_lshl_add_u32 v7, v3, 9, v7
    v_and_b32 v3, 7, v0
    v_lshl_add_u32 v7, v3, 5, v7
    v_mov_b32 v5, 161792
    v_mov_b32 v6, 1
    s_waitcnt lgkmcnt(0)
    v_perm_b32 v112, v162, v160, s58
    v_perm_b32 v113, v166, v164, s58
    v_perm_b32 v114, v170, v168, s58
    v_perm_b32 v115, v174, v172, s58
    ds_write_b128 v7, v[112:115] offset:0
    v_perm_b32 v116, v162, v160, s59
    v_perm_b32 v117, v166, v164, s59
    v_perm_b32 v118, v170, v168, s59
    v_perm_b32 v119, v174, v172, s59
    ds_write_b128 v7, v[116:119] offset:256
    v_perm_b32 v120, v163, v161, s58
    v_perm_b32 v121, v167, v165, s58
    v_perm_b32 v122, v171, v169, s58
    v_perm_b32 v123, v175, v173, s58
    ds_write_b128 v7, v[120:123] offset:16
    v_perm_b32 v124, v163, v161, s59
    v_perm_b32 v125, v167, v165, s59
    v_perm_b32 v126, v171, v169, s59
    v_perm_b32 v127, v175, v173, s59
    ds_write_b128 v7, v[124:127] offset:272
    s_mov_b64 exec, 1
    ds_add_u32 v5, v6
    s_mov_b64 exec, -1
L_wdone:
    s_mov_b32 s59, 101376
    s_mov_b32 s30, s18
    s_waitcnt lgkmcnt(0)
L_sb:
    v_mfma_f32_4x4x4_16b_bf16 v[144:147], v[224:225], v[216:217], 0
    v_mfma_f32_4x4x4_16b_bf16 v[148:151], v[224:225], v[218:219], 0
    v_mfma_f32_4x4x4_16b_bf16 v[152:155], v[224:225], v[220:221], 0
    v_mfma_f32_4x4x4_16b_bf16 v[156:159], v[224:225], v[222:223], 0
    v_add_u32 v230, 1024, v230
    s_sub_u32 s26, s30, 64
    v_cmp_gt_i32 s[34:35], s26, v234
    s_cmp_le_i32 s30, 0
    s_nop 0
    v_cvt_pk_bf16_f32 v184, v144, v148
    v_cvt_pk_bf16_f32 v185, v152, v156
    v_cvt_pk_bf16_f32 v186, v145, v149
    v_cvt_pk_bf16_f32 v187, v153, v157
    v_cvt_pk_bf16_f32 v188, v146, v150
    v_cvt_pk_bf16_f32 v189, v154, v158
    v_cvt_pk_bf16_f32 v190, v147, v151
    v_cvt_pk_bf16_f32 v191, v155, v159
    ds_read_b128 v[224:227], v230
    ds_read_b32 v243, v244
    s_cbranch_scc1 L_exit
    s_setprio 3
    v_mfma_f32_32x32x16_bf16 v[112:127], v[192:195], v[200:203], 0
    v_exp_f32 v176, v80
    v_exp_f32 v177, v81
    v_exp_f32 v178, v82
    v_exp_f32 v179, v83
    v_exp_f32 v180, v96
    v_exp_f32 v181, v97
    v_exp_f32 v182, v98
    v_exp_f32 v183, v99
    v_pk_fma_f32 v[176:177], v[176:177], s[56:57], s[56:57]
    v_pk_fma_f32 v[178:179], v[178:179], s[56:57], s[56:57]
    v_pk_fma_f32 v[180:181], v[180:181], s[56:57], s[56:57]
    v_pk_fma_f32 v[182:183], v[182:183], s[56:57], s[56:57]
    s_waitcnt vmcnt(4)
    v_mfma_f32_4x4x4_16b_bf16 v[144:147], v[184:185], v[48:49], 0 cbsz:4 abid:0
    v_rcp_f32 v176, v176
    v_mfma_f32_4x4x4_16b_bf16 v[148:151], v[184:185], v[50:51], 0 cbsz:4 abid:0
    v_rcp_f32 v177, v177
    v_mfma_f32_4x4x4_16b_bf16 v[152:155], v[184:185], v[52:53], 0 cbsz:4 abid:1
    v_rcp_f32 v178, v178
    v_mfma_f32_4x4x4_16b_bf16 v[156:159], v[184:185], v[54:55], 0 cbsz:4 abid:1
    v_rcp_f32 v179, v179
    v_mfma_f32_4x4x4_16b_bf16 v[160:163], v[184:185], v[56:57], 0 cbsz:4 abid:2
    v_rcp_f32 v180, v180
    v_mfma_f32_4x4x4_16b_bf16 v[164:167], v[184:185], v[58:59], 0 cbsz:4 abid:2
    v_rcp_f32 v181, v181
    v_mfma_f32_4x4x4_16b_bf16 v[168:171], v[184:185], v[60:61], 0 cbsz:4 abid:3
    v_rcp_f32 v182, v182
    v_mfma_f32_4x4x4_16b_bf16 v[172:175], v[184:185], v[62:63], 0 cbsz:4 abid:3
    v_rcp_f32 v183, v183
    v_readlane_b32 s72, v228, 32
    v_readlane_b32 s73, v228, 36
    v_readlane_b32 s74, v228, 40
    v_readlane_b32 s75, v228, 44
    v_pk_mul_f32 v[176:177], v[176:177], v[80:81]
    v_pk_mul_f32 v[178:179], v[178:179], v[82:83]
    v_pk_mul_f32 v[180:181], v[180:181], v[96:97]
    v_pk_mul_f32 v[182:183], v[182:183], v[98:99]
    s_set_gpr_idx_on s64, gpr_idx(SRC2,DST)
    v_pk_fma_f32 v[8:9], v[176:177], v[144:145], v[8:9] op_sel:[0,0,0] op_sel_hi:[0,1,1]
    v_pk_fma_f32 v[10:11], v[176:177], v[146:147], v[10:11] op_sel:[0,0,0] op_sel_hi:[0,1,1]
    v_pk_fma_f32 v[12:13], v[180:181], v[148:149], v[12:13] op_sel:[0,0,0] op_sel_hi:[0,1,1]
    v_pk_fma_f32 v[14:15], v[180:181], v[150:151], v[14:15] op_sel:[0,0,0] op_sel_hi:[0,1,1]
    s_set_gpr_idx_idx s65
    v_pk_fma_f32 v[8:9], v[176:177], v[152:153], v[8:9] op_sel:[1,0,0] op_sel_hi:[1,1,1]
    v_pk_fma_f32 v[10:11], v[176:177], v[154:155], v[10:11] op_sel:[1,0,0] op_sel_hi:[1,1,1]
    v_pk_fma_f32 v[12:13], v[180:181], v[156:157], v[12:13] op_sel:[1,0,0] op_sel_hi:[1,1,1]
    v_pk_fma_f32 v[14:15], v[180:181], v[158:159], v[14:15] op_sel:[1,0,0] op_sel_hi:[1,1,1]
    s_set_gpr_idx_idx s66
    v_pk_fma_f32 v[8:9], v[178:179], v[160:161], v[8:9] op_sel:[0,0,0] op_sel_hi:[0,1,1]
    v_pk_fma_f32 v[10:11], v[178:179], v[162:163], v[10:11] op_sel:[0,0,0] op_sel_hi:[0,1,1]
    v_pk_fma_f32 v[12:13], v[182:183], v[164:165], v[12:13] op_sel:[0,0,0] op_sel_hi:[0,1,1]
    v_pk_fma_f32 v[14:15], v[182:183], v[166:167], v[14:15] op_sel:[0,0,0] op_sel_hi:[0,1,1]
    s_set_gpr_idx_idx s67
    v_pk_fma_f32 v[8:9], v[178:179], v[168:169], v[8:9] op_sel:[1,0,0] op_sel_hi:[1,1,1]
    v_pk_fma_f32 v[10:11], v[178:179], v[170:171], v[10:11] op_sel:[1,0,0] op_sel_hi:[1,1,1]
    v_pk_fma_f32 v[12:13], v[182:183], v[172:173], v[12:13] op_sel:[1,0,0] op_sel_hi:[1,1,1]
    v_pk_fma_f32 v[14:15], v[182:183], v[174:175], v[14:15] op_sel:[1,0,0] op_sel_hi:[1,1,1]
    s_set_gpr_idx_off
    s_and_b32 s80, s72, s31
    s_and_b32 s81, s73, s31
    s_and_b32 s82, s74, s31
    s_and_b32 s83, s75, s31
    buffer_load_dwordx4 v[48:51], v232, s[4:7], s80 offen
    buffer_load_dwordx4 v[52:55], v232, s[4:7], s81 offen
    buffer_load_dwordx4 v[56:59], v232, s[4:7], s82 offen
    buffer_load_dwordx4 v[60:63], v232, s[4:7], s83 offen
    s_cmp_le_i32 s30, 4
    s_mov_b64 exec, s[22:23]
    ds_read_b128 v[196:199], v229 offset:46080
    s_mov_b64 exec, -1
    ds_read_b32 v2, v231 offset:524
    s_cbranch_scc1 L_exit
    s_setprio 2
    v_mfma_f32_32x32x16_bf16 v[128:143], v[192:195], v[204:207], 0
    v_exp_f32 v176, v84
    v_exp_f32 v177, v85
    v_exp_f32 v178, v86
    v_exp_f32 v179, v87
    v_exp_f32 v180, v100
    v_exp_f32 v181, v101
    v_exp_f32 v182, v102
    v_exp_f32 v183, v103
    v_pk_fma_f32 v[176:177], v[176:177], s[56:57], s[56:57]
    v_pk_fma_f32 v[178:179], v[178:179], s[56:57], s[56:57]
    v_pk_fma_f32 v[180:181], v[180:181], s[56:57], s[56:57]
    v_pk_fma_f32 v[182:183], v[182:183], s[56:57], s[56:57]
    s_waitcnt vmcnt(4)
    v_mfma_f32_4x4x4_16b_bf16 v[144:147], v[184:185], v[64:65], 0 cbsz:4 abid:4
    v_rcp_f32 v176, v176
    v_mfma_f32_4x4x4_16b_bf16 v[148:151], v[184:185], v[66:67], 0 cbsz:4 abid:4
    v_rcp_f32 v177, v177
    v_mfma_f32_4x4x4_16b_bf16 v[152:155], v[184:185], v[68:69], 0 cbsz:4 abid:5
    v_rcp_f32 v178, v178
    v_mfma_f32_4x4x4_16b_bf16 v[156:159], v[184:185], v[70:71], 0 cbsz:4 abid:5
    v_rcp_f32 v179, v179
    v_mfma_f32_4x4x4_16b_bf16 v[160:163], v[184:185], v[72:73], 0 cbsz:4 abid:6
    v_rcp_f32 v180, v180
    v_mfma_f32_4x4x4_16b_bf16 v[164:167], v[184:185], v[74:75], 0 cbsz:4 abid:6
    v_rcp_f32 v181, v181
    v_mfma_f32_4x4x4_16b_bf16 v[168:171], v[184:185], v[76:77], 0 cbsz:4 abid:7
    v_rcp_f32 v182, v182
    v_mfma_f32_4x4x4_16b_bf16 v[172:175], v[184:185], v[78:79], 0 cbsz:4 abid:7
    v_rcp_f32 v183, v183
    v_readlane_b32 s76, v228, 48
    v_readlane_b32 s77, v228, 52
    v_readlane_b32 s78, v228, 56
    v_readlane_b32 s79, v228, 60
    v_pk_mul_f32 v[176:177], v[176:177], v[84:85]
    v_pk_mul_f32 v[178:179], v[178:179], v[86:87]
    v_pk_mul_f32 v[180:181], v[180:181], v[100:101]
    v_pk_mul_f32 v[182:183], v[182:183], v[102:103]
    s_set_gpr_idx_on s68, gpr_idx(SRC2,DST)
    v_pk_fma_f32 v[8:9], v[176:177], v[144:145], v[8:9] op_sel:[0,0,0] op_sel_hi:[0,1,1]
    v_pk_fma_f32 v[10:11], v[176:177], v[146:147], v[10:11] op_sel:[0,0,0] op_sel_hi:[0,1,1]
    v_pk_fma_f32 v[12:13], v[180:181], v[148:149], v[12:13] op_sel:[0,0,0] op_sel_hi:[0,1,1]
    v_pk_fma_f32 v[14:15], v[180:181], v[150:151], v[14:15] op_sel:[0,0,0] op_sel_hi:[0,1,1]
    s_set_gpr_idx_idx s69
    v_pk_fma_f32 v[8:9], v[176:177], v[152:153], v[8:9] op_sel:[1,0,0] op_sel_hi:[1,1,1]
    v_pk_fma_f32 v[10:11], v[176:177], v[154:155], v[10:11] op_sel:[1,0,0] op_sel_hi:[1,1,1]
    v_pk_fma_f32 v[12:13], v[180:181], v[156:157], v[12:13] op_sel:[1,0,0] op_sel_hi:[1,1,1]
    v_pk_fma_f32 v[14:15], v[180:181], v[158:159], v[14:15] op_sel:[1,0,0] op_sel_hi:[1,1,1]
    s_set_gpr_idx_idx s70
    v_pk_fma_f32 v[8:9], v[178:179], v[160:161], v[8:9] op_sel:[0,0,0] op_sel_hi:[0,1,1]
    v_pk_fma_f32 v[10:11], v[178:179], v[162:163], v[10:11] op_sel:[0,0,0] op_sel_hi:[0,1,1]
    v_pk_fma_f32 v[12:13], v[182:183], v[164:165], v[12:13] op_sel:[0,0,0] op_sel_hi:[0,1,1]
    v_pk_fma_f32 v[14:15], v[182:183], v[166:167], v[14:15] op_sel:[0,0,0] op_sel_hi:[0,1,1]
    s_set_gpr_idx_idx s71
    v_pk_fma_f32 v[8:9], v[178:179], v[168:169], v[8:9] op_sel:[1,0,0] op_sel_hi:[1,1,1]
    v_pk_fma_f32 v[10:11], v[178:179], v[170:171], v[10:11] op_sel:[1,0,0] op_sel_hi:[1,1,1]
    v_pk_fma_f32 v[12:13], v[182:183], v[172:173], v[12:13] op_sel:[1,0,0] op_sel_hi:[1,1,1]
    v_pk_fma_f32 v[14:15], v[182:183], v[174:175], v[14:15] op_sel:[1,0,0] op_sel_hi:[1,1,1]
    s_set_gpr_idx_off
    s_and_b32 s80, s76, s31
    s_and_b32 s81, s77, s31
    s_and_b32 s82, s78, s31
    s_and_b32 s83, s79, s31
    buffer_load_dwordx4 v[64:67], v232, s[4:7], s80 offen
    buffer_load_dwordx4 v[68:71], v232, s[4:7], s81 offen
    buffer_load_dwordx4 v[72:75], v232, s[4:7], s82 offen
    buffer_load_dwordx4 v[76:79], v232, s[4:7], s83 offen
    s_cmp_le_i32 s30, 8
    s_waitcnt lgkmcnt(0)
    s_cbranch_scc1 L_exit
    s_setprio 1
    v_mfma_f32_32x32x16_bf16 v[112:127], v[196:199], v[208:211], v[112:127]
    v_exp_f32 v176, v88
    v_exp_f32 v177, v89
    v_exp_f32 v178, v90
    v_exp_f32 v179, v91
    v_exp_f32 v180, v104
    v_exp_f32 v181, v105
    v_exp_f32 v182, v106
    v_exp_f32 v183, v107
    v_pk_fma_f32 v[176:177], v[176:177], s[56:57], s[56:57]
    v_pk_fma_f32 v[178:179], v[178:179], s[56:57], s[56:57]
    v_pk_fma_f32 v[180:181], v[180:181], s[56:57], s[56:57]
    v_pk_fma_f32 v[182:183], v[182:183], s[56:57], s[56:57]
    s_waitcnt vmcnt(4)
    v_mfma_f32_4x4x4_16b_bf16 v[144:147], v[184:185], v[48:49], 0 cbsz:4 abid:8
    v_rcp_f32 v176, v176
    v_mfma_f32_4x4x4_16b_bf16 v[148:151], v[184:185], v[50:51], 0 cbsz:4 abid:8
    v_rcp_f32 v177, v177
    v_mfma_f32_4x4x4_16b_bf16 v[152:155], v[184:185], v[52:53], 0 cbsz:4 abid:9
    v_rcp_f32 v178, v178
    v_mfma_f32_4x4x4_16b_bf16 v[156:159], v[184:185], v[54:55], 0 cbsz:4 abid:9
    v_rcp_f32 v179, v179
    v_mfma_f32_4x4x4_16b_bf16 v[160:163], v[184:185], v[56:57], 0 cbsz:4 abid:10
    v_rcp_f32 v180, v180
    v_mfma_f32_4x4x4_16b_bf16 v[164:167], v[184:185], v[58:59], 0 cbsz:4 abid:10
    v_rcp_f32 v181, v181
    v_mfma_f32_4x4x4_16b_bf16 v[168:171], v[184:185], v[60:61], 0 cbsz:4 abid:11
    v_rcp_f32 v182, v182
    v_mfma_f32_4x4x4_16b_bf16 v[172:175], v[184:185], v[62:63], 0 cbsz:4 abid:11
    v_rcp_f32 v183, v183
    v_readlane_b32 s64, v228, 1
    v_readlane_b32 s65, v228, 5
    v_readlane_b32 s66, v228, 9
    v_readlane_b32 s67, v228, 13
    v_and_or_b32 v229, v2, s33, v233
    v_pk_mul_f32 v[176:177], v[176:177], v[88:89]
    v_pk_mul_f32 v[178:179], v[178:179], v[90:91]
    v_pk_mul_f32 v[180:181], v[180:181], v[104:105]
    v_pk_mul_f32 v[182:183], v[182:183], v[106:107]
    s_set_gpr_idx_on s72, gpr_idx(SRC2,DST)
    v_pk_fma_f32 v[8:9], v[176:177], v[144:145], v[8:9] op_sel:[0,0,0] op_sel_hi:[0,1,1]
    v_pk_fma_f32 v[10:11], v[176:177], v[146:147], v[10:11] op_sel:[0,0,0] op_sel_hi:[0,1,1]
    v_pk_fma_f32 v[12:13], v[180:181], v[148:149], v[12:13] op_sel:[0,0,0] op_sel_hi:[0,1,1]
    v_pk_fma_f32 v[14:15], v[180:181], v[150:151], v[14:15] op_sel:[0,0,0] op_sel_hi:[0,1,1]
    s_set_gpr_idx_idx s73
    v_pk_fma_f32 v[8:9], v[176:177], v[152:153], v[8:9] op_sel:[1,0,0] op_sel_hi:[1,1,1]
    v_pk_fma_f32 v[10:11], v[176:177], v[154:155], v[10:11] op_sel:[1,0,0] op_sel_hi:[1,1,1]
    v_pk_fma_f32 v[12:13], v[180:181], v[156:157], v[12:13] op_sel:[1,0,0] op_sel_hi:[1,1,1]
    v_pk_fma_f32 v[14:15], v[180:181], v[158:159], v[14:15] op_sel:[1,0,0] op_sel_hi:[1,1,1]
    s_set_gpr_idx_idx s74
    v_pk_fma_f32 v[8:9], v[178:179], v[160:161], v[8:9] op_sel:[0,0,0] op_sel_hi:[0,1,1]
    v_pk_fma_f32 v[10:11], v[178:179], v[162:163], v[10:11] op_sel:[0,0,0] op_sel_hi:[0,1,1]
    v_pk_fma_f32 v[12:13], v[182:183], v[164:165], v[12:13] op_sel:[0,0,0] op_sel_hi:[0,1,1]
    v_pk_fma_f32 v[14:15], v[182:183], v[166:167], v[14:15] op_sel:[0,0,0] op_sel_hi:[0,1,1]
    s_set_gpr_idx_idx s75
    v_pk_fma_f32 v[8:9], v[178:179], v[168:169], v[8:9] op_sel:[1,0,0] op_sel_hi:[1,1,1]
    v_pk_fma_f32 v[10:11], v[178:179], v[170:171], v[10:11] op_sel:[1,0,0] op_sel_hi:[1,1,1]
    v_pk_fma_f32 v[12:13], v[182:183], v[172:173], v[12:13] op_sel:[1,0,0] op_sel_hi:[1,1,1]
    v_pk_fma_f32 v[14:15], v[182:183], v[174:175], v[14:15] op_sel:[1,0,0] op_sel_hi:[1,1,1]
    s_set_gpr_idx_off
    s_and_b32 s80, s64, s31
    s_and_b32 s81, s65, s31
    s_and_b32 s82, s66, s31
    s_and_b32 s83, s67, s31
    buffer_load_dwordx4 v[48:51], v232, s[4:7], s80 offen
    buffer_load_dwordx4 v[52:55], v232, s[4:7], s81 offen
    buffer_load_dwordx4 v[56:59], v232, s[4:7], s82 offen
    buffer_load_dwordx4 v[60:63], v232, s[4:7], s83 offen
    s_cmp_le_i32 s30, 12
    s_mov_b64 exec, s[20:21]
    ds_read_b128 v[192:195], v229 offset:46080
    s_mov_b64 exec, -1
    s_cbranch_scc1 L_exit
    s_setprio 0
    v_mfma_f32_32x32x16_bf16 v[128:143], v[196:199], v[212:215], v[128:143]
    v_exp_f32 v176, v92
    v_exp_f32 v177, v93
    v_exp_f32 v178, v94
    v_exp_f32 v179, v95
    v_exp_f32 v180, v108
    v_exp_f32 v181, v109
    v_exp_f32 v182, v110
    v_exp_f32 v183, v111
    v_pk_fma_f32 v[176:177], v[176:177], s[56:57], s[56:57]
    v_pk_fma_f32 v[178:179], v[178:179], s[56:57], s[56:57]
    v_pk_fma_f32 v[180:181], v[180:181], s[56:57], s[56:57]
    v_pk_fma_f32 v[182:183], v[182:183], s[56:57], s[56:57]
    s_waitcnt vmcnt(4)
    v_mfma_f32_4x4x4_16b_bf16 v[144:147], v[184:185], v[64:65], 0 cbsz:4 abid:12
    v_rcp_f32 v176, v176
    v_mfma_f32_4x4x4_16b_bf16 v[148:151], v[184:185], v[66:67], 0 cbsz:4 abid:12
    v_rcp_f32 v177, v177
    v_mfma_f32_4x4x4_16b_bf16 v[152:155], v[184:185], v[68:69], 0 cbsz:4 abid:13
    v_rcp_f32 v178, v178
    v_mfma_f32_4x4x4_16b_bf16 v[156:159], v[184:185], v[70:71], 0 cbsz:4 abid:13
    v_rcp_f32 v179, v179
    v_mfma_f32_4x4x4_16b_bf16 v[160:163], v[184:185], v[72:73], 0 cbsz:4 abid:14
    v_rcp_f32 v180, v180
    v_mfma_f32_4x4x4_16b_bf16 v[164:167], v[184:185], v[74:75], 0 cbsz:4 abid:14
    v_rcp_f32 v181, v181
    v_mfma_f32_4x4x4_16b_bf16 v[168:171], v[184:185], v[76:77], 0 cbsz:4 abid:15
    v_rcp_f32 v182, v182
    v_mfma_f32_4x4x4_16b_bf16 v[172:175], v[184:185], v[78:79], 0 cbsz:4 abid:15
    v_rcp_f32 v183, v183
    v_readlane_b32 s68, v228, 17
    v_readlane_b32 s69, v228, 21
    v_readlane_b32 s70, v228, 25
    v_readlane_b32 s71, v228, 29
    v_pk_mul_f32 v[176:177], v[176:177], v[92:93]
    v_pk_mul_f32 v[178:179], v[178:179], v[94:95]
    v_pk_mul_f32 v[180:181], v[180:181], v[108:109]
    v_pk_mul_f32 v[182:183], v[182:183], v[110:111]
    s_set_gpr_idx_on s76, gpr_idx(SRC2,DST)
    v_pk_fma_f32 v[8:9], v[176:177], v[144:145], v[8:9] op_sel:[0,0,0] op_sel_hi:[0,1,1]
    v_pk_fma_f32 v[10:11], v[176:177], v[146:147], v[10:11] op_sel:[0,0,0] op_sel_hi:[0,1,1]
    v_pk_fma_f32 v[12:13], v[180:181], v[148:149], v[12:13] op_sel:[0,0,0] op_sel_hi:[0,1,1]
    v_pk_fma_f32 v[14:15], v[180:181], v[150:151], v[14:15] op_sel:[0,0,0] op_sel_hi:[0,1,1]
    s_set_gpr_idx_idx s77
    v_pk_fma_f32 v[8:9], v[176:177], v[152:153], v[8:9] op_sel:[1,0,0] op_sel_hi:[1,1,1]
    v_pk_fma_f32 v[10:11], v[176:177], v[154:155], v[10:11] op_sel:[1,0,0] op_sel_hi:[1,1,1]
    v_pk_fma_f32 v[12:13], v[180:181], v[156:157], v[12:13] op_sel:[1,0,0] op_sel_hi:[1,1,1]
    v_pk_fma_f32 v[14:15], v[180:181], v[158:159], v[14:15] op_sel:[1,0,0] op_sel_hi:[1,1,1]
    s_set_gpr_idx_idx s78
    v_pk_fma_f32 v[8:9], v[178:179], v[160:161], v[8:9] op_sel:[0,0,0] op_sel_hi:[0,1,1]
    v_pk_fma_f32 v[10:11], v[178:179], v[162:163], v[10:11] op_sel:[0,0,0] op_sel_hi:[0,1,1]
    v_pk_fma_f32 v[12:13], v[182:183], v[164:165], v[12:13] op_sel:[0,0,0] op_sel_hi:[0,1,1]
    v_pk_fma_f32 v[14:15], v[182:183], v[166:167], v[14:15] op_sel:[0,0,0] op_sel_hi:[0,1,1]
    s_set_gpr_idx_idx s79
    v_pk_fma_f32 v[8:9], v[178:179], v[168:169], v[8:9] op_sel:[1,0,0] op_sel_hi:[1,1,1]
    v_pk_fma_f32 v[10:11], v[178:179], v[170:171], v[10:11] op_sel:[1,0,0] op_sel_hi:[1,1,1]
    v_pk_fma_f32 v[12:13], v[182:183], v[172:173], v[12:13] op_sel:[1,0,0] op_sel_hi:[1,1,1]
    v_pk_fma_f32 v[14:15], v[182:183], v[174:175], v[14:15] op_sel:[1,0,0] op_sel_hi:[1,1,1]
    s_set_gpr_idx_off
    s_and_b32 s80, s68, s31
    s_and_b32 s81, s69, s31
    s_and_b32 s82, s70, s31
    s_and_b32 s83, s71, s31
    buffer_load_dwordx4 v[64:67], v232, s[4:7], s80 offen
    buffer_load_dwordx4 v[68:71], v232, s[4:7], s81 offen
    buffer_load_dwordx4 v[72:75], v232, s[4:7], s82 offen
    buffer_load_dwordx4 v[76:79], v232, s[4:7], s83 offen
    s_cmp_le_i32 s30, 16
    s_waitcnt lgkmcnt(0)
    s_cbranch_scc1 L_exit
    s_setprio 3
    v_mfma_f32_32x32x16_bf16 v[80:95], v[192:195], v[200:203], 0
    v_exp_f32 v176, v112
    v_exp_f32 v177, v113
    v_exp_f32 v178, v114
    v_exp_f32 v179, v115
    v_exp_f32 v180, v128
    v_exp_f32 v181, v129
    v_exp_f32 v182, v130
    v_exp_f32 v183, v131
    v_pk_fma_f32 v[176:177], v[176:177], s[56:57], s[56:57]
    v_pk_fma_f32 v[178:179], v[178:179], s[56:57], s[56:57]
    v_pk_fma_f32 v[180:181], v[180:181], s[56:57], s[56:57]
    v_pk_fma_f32 v[182:183], v[182:183], s[56:57], s[56:57]
    s_waitcnt vmcnt(4)
    v_mfma_f32_4x4x4_16b_bf16 v[144:147], v[186:187], v[48:49], 0 cbsz:4 abid:0
    v_rcp_f32 v176, v176
    v_mfma_f32_4x4x4_16b_bf16 v[148:151], v[186:187], v[50:51], 0 cbsz:4 abid:0
    v_rcp_f32 v177, v177
    v_mfma_f32_4x4x4_16b_bf16 v[152:155], v[186:187], v[52:53], 0 cbsz:4 abid:1
    v_rcp_f32 v178, v178
    v_mfma_f32_4x4x4_16b_bf16 v[156:159], v[186:187], v[54:55], 0 cbsz:4 abid:1
    v_rcp_f32 v179, v179
    v_mfma_f32_4x4x4_16b_bf16 v[160:163], v[186:187], v[56:57], 0 cbsz:4 abid:2
    v_rcp_f32 v180, v180
    v_mfma_f32_4x4x4_16b_bf16 v[164:167], v[186:187], v[58:59], 0 cbsz:4 abid:2
    v_rcp_f32 v181, v181
    v_mfma_f32_4x4x4_16b_bf16 v[168:171], v[186:187], v[60:61], 0 cbsz:4 abid:3
    v_rcp_f32 v182, v182
    v_mfma_f32_4x4x4_16b_bf16 v[172:175], v[186:187], v[62:63], 0 cbsz:4 abid:3
    v_rcp_f32 v183, v183
    v_readlane_b32 s72, v228, 33
    v_readlane_b32 s73, v228, 37
    v_readlane_b32 s74, v228, 41
    v_readlane_b32 s75, v228, 45
    v_pk_mul_f32 v[176:177], v[176:177], v[112:113]
    v_pk_mul_f32 v[178:179], v[178:179], v[114:115]
    v_pk_mul_f32 v[180:181], v[180:181], v[128:129]
    v_pk_mul_f32 v[182:183], v[182:183], v[130:131]
    s_set_gpr_idx_on s64, gpr_idx(SRC2,DST)
    v_pk_fma_f32 v[8:9], v[176:177], v[144:145], v[8:9] op_sel:[0,0,0] op_sel_hi:[0,1,1]
    v_pk_fma_f32 v[10:11], v[176:177], v[146:147], v[10:11] op_sel:[0,0,0] op_sel_hi:[0,1,1]
    v_pk_fma_f32 v[12:13], v[180:181], v[148:149], v[12:13] op_sel:[0,0,0] op_sel_hi:[0,1,1]
    v_pk_fma_f32 v[14:15], v[180:181], v[150:151], v[14:15] op_sel:[0,0,0] op_sel_hi:[0,1,1]
    s_set_gpr_idx_idx s65
    v_pk_fma_f32 v[8:9], v[176:177], v[152:153], v[8:9] op_sel:[1,0,0] op_sel_hi:[1,1,1]
    v_pk_fma_f32 v[10:11], v[176:177], v[154:155], v[10:11] op_sel:[1,0,0] op_sel_hi:[1,1,1]
    v_pk_fma_f32 v[12:13], v[180:181], v[156:157], v[12:13] op_sel:[1,0,0] op_sel_hi:[1,1,1]
    v_pk_fma_f32 v[14:15], v[180:181], v[158:159], v[14:15] op_sel:[1,0,0] op_sel_hi:[1,1,1]
    s_set_gpr_idx_idx s66
    v_pk_fma_f32 v[8:9], v[178:179], v[160:161], v[8:9] op_sel:[0,0,0] op_sel_hi:[0,1,1]
    v_pk_fma_f32 v[10:11], v[178:179], v[162:163], v[10:11] op_sel:[0,0,0] op_sel_hi:[0,1,1]
    v_pk_fma_f32 v[12:13], v[182:183], v[164:165], v[12:13] op_sel:[0,0,0] op_sel_hi:[0,1,1]
    v_pk_fma_f32 v[14:15], v[182:183], v[166:167], v[14:15] op_sel:[0,0,0] op_sel_hi:[0,1,1]
    s_set_gpr_idx_idx s67
    v_pk_fma_f32 v[8:9], v[178:179], v[168:169], v[8:9] op_sel:[1,0,0] op_sel_hi:[1,1,1]
    v_pk_fma_f32 v[10:11], v[178:179], v[170:171], v[10:11] op_sel:[1,0,0] op_sel_hi:[1,1,1]
    v_pk_fma_f32 v[12:13], v[182:183], v[172:173], v[12:13] op_sel:[1,0,0] op_sel_hi:[1,1,1]
    v_pk_fma_f32 v[14:15], v[182:183], v[174:175], v[14:15] op_sel:[1,0,0] op_sel_hi:[1,1,1]
    s_set_gpr_idx_off
    s_and_b32 s80, s72, s31
    s_and_b32 s81, s73, s31
    s_and_b32 s82, s74, s31
    s_and_b32 s83, s75, s31
    buffer_load_dwordx4 v[48:51], v232, s[4:7], s80 offen
    buffer_load_dwordx4 v[52:55], v232, s[4:7], s81 offen
    buffer_load_dwordx4 v[56:59], v232, s[4:7], s82 offen
    buffer_load_dwordx4 v[60:63], v232, s[4:7], s83 offen
    s_cmp_le_i32 s30, 20
    s_mov_b64 exec, s[22:23]
    ds_read_b128 v[196:199], v229 offset:46080
    s_mov_b64 exec, -1
    ds_read_b32 v2, v231 offset:780
    s_cbranch_scc1 L_exit
    s_setprio 2
    v_mfma_f32_32x32x16_bf16 v[96:111], v[192:195], v[204:207], 0
    v_exp_f32 v176, v116
    v_exp_f32 v177, v117
    v_exp_f32 v178, v118
    v_exp_f32 v179, v119
    v_exp_f32 v180, v132
    v_exp_f32 v181, v133
    v_exp_f32 v182, v134
    v_exp_f32 v183, v135
    v_pk_fma_f32 v[176:177], v[176:177], s[56:57], s[56:57]
    v_pk_fma_f32 v[178:179], v[178:179], s[56:57], s[56:57]
    v_pk_fma_f32 v[180:181], v[180:181], s[56:57], s[56:57]
    v_pk_fma_f32 v[182:183], v[182:183], s[56:57], s[56:57]
    s_waitcnt vmcnt(4)
    v_mfma_f32_4x4x4_16b_bf16 v[144:147], v[186:187], v[64:65], 0 cbsz:4 abid:4
    v_rcp_f32 v176, v176
    v_mfma_f32_4x4x4_16b_bf16 v[148:151], v[186:187], v[66:67], 0 cbsz:4 abid:4
    v_rcp_f32 v177, v177
    v_mfma_f32_4x4x4_16b_bf16 v[152:155], v[186:187], v[68:69], 0 cbsz:4 abid:5
    v_rcp_f32 v178, v178
    v_mfma_f32_4x4x4_16b_bf16 v[156:159], v[186:187], v[70:71], 0 cbsz:4 abid:5
    v_rcp_f32 v179, v179
    v_mfma_f32_4x4x4_16b_bf16 v[160:163], v[186:187], v[72:73], 0 cbsz:4 abid:6
    v_rcp_f32 v180, v180
    v_mfma_f32_4x4x4_16b_bf16 v[164:167], v[186:187], v[74:75], 0 cbsz:4 abid:6
    v_rcp_f32 v181, v181
    v_mfma_f32_4x4x4_16b_bf16 v[168:171], v[186:187], v[76:77], 0 cbsz:4 abid:7
    v_rcp_f32 v182, v182
    v_mfma_f32_4x4x4_16b_bf16 v[172:175], v[186:187], v[78:79], 0 cbsz:4 abid:7
    v_rcp_f32 v183, v183
    v_readlane_b32 s76, v228, 49
    v_readlane_b32 s77, v228, 53
    v_readlane_b32 s78, v228, 57
    v_readlane_b32 s79, v228, 61
    v_pk_mul_f32 v[176:177], v[176:177], v[116:117]
    v_pk_mul_f32 v[178:179], v[178:179], v[118:119]
    v_pk_mul_f32 v[180:181], v[180:181], v[132:133]
    v_pk_mul_f32 v[182:183], v[182:183], v[134:135]
    s_set_gpr_idx_on s68, gpr_idx(SRC2,DST)
    v_pk_fma_f32 v[8:9], v[176:177], v[144:145], v[8:9] op_sel:[0,0,0] op_sel_hi:[0,1,1]
    v_pk_fma_f32 v[10:11], v[176:177], v[146:147], v[10:11] op_sel:[0,0,0] op_sel_hi:[0,1,1]
    v_pk_fma_f32 v[12:13], v[180:181], v[148:149], v[12:13] op_sel:[0,0,0] op_sel_hi:[0,1,1]
    v_pk_fma_f32 v[14:15], v[180:181], v[150:151], v[14:15] op_sel:[0,0,0] op_sel_hi:[0,1,1]
    s_set_gpr_idx_idx s69
    v_pk_fma_f32 v[8:9], v[176:177], v[152:153], v[8:9] op_sel:[1,0,0] op_sel_hi:[1,1,1]
    v_pk_fma_f32 v[10:11], v[176:177], v[154:155], v[10:11] op_sel:[1,0,0] op_sel_hi:[1,1,1]
    v_pk_fma_f32 v[12:13], v[180:181], v[156:157], v[12:13] op_sel:[1,0,0] op_sel_hi:[1,1,1]
    v_pk_fma_f32 v[14:15], v[180:181], v[158:159], v[14:15] op_sel:[1,0,0] op_sel_hi:[1,1,1]
    s_set_gpr_idx_idx s70
    v_pk_fma_f32 v[8:9], v[178:179], v[160:161], v[8:9] op_sel:[0,0,0] op_sel_hi:[0,1,1]
    v_pk_fma_f32 v[10:11], v[178:179], v[162:163], v[10:11] op_sel:[0,0,0] op_sel_hi:[0,1,1]
    v_pk_fma_f32 v[12:13], v[182:183], v[164:165], v[12:13] op_sel:[0,0,0] op_sel_hi:[0,1,1]
    v_pk_fma_f32 v[14:15], v[182:183], v[166:167], v[14:15] op_sel:[0,0,0] op_sel_hi:[0,1,1]
    s_set_gpr_idx_idx s71
    v_pk_fma_f32 v[8:9], v[178:179], v[168:169], v[8:9] op_sel:[1,0,0] op_sel_hi:[1,1,1]
    v_pk_fma_f32 v[10:11], v[178:179], v[170:171], v[10:11] op_sel:[1,0,0] op_sel_hi:[1,1,1]
    v_pk_fma_f32 v[12:13], v[182:183], v[172:173], v[12:13] op_sel:[1,0,0] op_sel_hi:[1,1,1]
    v_pk_fma_f32 v[14:15], v[182:183], v[174:175], v[14:15] op_sel:[1,0,0] op_sel_hi:[1,1,1]
    s_set_gpr_idx_off
    s_and_b32 s80, s76, s31
    s_and_b32 s81, s77, s31
    s_and_b32 s82, s78, s31
    s_and_b32 s83, s79, s31
    buffer_load_dwordx4 v[64:67], v232, s[4:7], s80 offen
    buffer_load_dwordx4 v[68:71], v232, s[4:7], s81 offen
    buffer_load_dwordx4 v[72:75], v232, s[4:7], s82 offen
    buffer_load_dwordx4 v[76:79], v232, s[4:7], s83 offen
    s_cmp_le_i32 s30, 24
    s_waitcnt lgkmcnt(0)
    s_cbranch_scc1 L_exit
    s_setprio 1
    v_mfma_f32_32x32x16_bf16 v[80:95], v[196:199], v[208:211], v[80:95]
    v_exp_f32 v176, v120
    v_exp_f32 v177, v121
    v_exp_f32 v178, v122
    v_exp_f32 v179, v123
    v_exp_f32 v180, v136
    v_exp_f32 v181, v137
    v_exp_f32 v182, v138
    v_exp_f32 v183, v139
    v_pk_fma_f32 v[176:177], v[176:177], s[56:57], s[56:57]
    v_pk_fma_f32 v[178:179], v[178:179], s[56:57], s[56:57]
    v_pk_fma_f32 v[180:181], v[180:181], s[56:57], s[56:57]
    v_pk_fma_f32 v[182:183], v[182:183], s[56:57], s[56:57]
    s_waitcnt vmcnt(4)
    v_mfma_f32_4x4x4_16b_bf16 v[144:147], v[186:187], v[48:49], 0 cbsz:4 abid:8
    v_rcp_f32 v176, v176
    v_mfma_f32_4x4x4_16b_bf16 v[148:151], v[186:187], v[50:51], 0 cbsz:4 abid:8
    v_rcp_f32 v177, v177
    v_mfma_f32_4x4x4_16b_bf16 v[152:155], v[186:187], v[52:53], 0 cbsz:4 abid:9
    v_rcp_f32 v178, v178
    v_mfma_f32_4x4x4_16b_bf16 v[156:159], v[186:187], v[54:55], 0 cbsz:4 abid:9
    v_rcp_f32 v179, v179
    v_mfma_f32_4x4x4_16b_bf16 v[160:163], v[186:187], v[56:57], 0 cbsz:4 abid:10
    v_rcp_f32 v180, v180
    v_mfma_f32_4x4x4_16b_bf16 v[164:167], v[186:187], v[58:59], 0 cbsz:4 abid:10
    v_rcp_f32 v181, v181
    v_mfma_f32_4x4x4_16b_bf16 v[168:171], v[186:187], v[60:61], 0 cbsz:4 abid:11
    v_rcp_f32 v182, v182
    v_mfma_f32_4x4x4_16b_bf16 v[172:175], v[186:187], v[62:63], 0 cbsz:4 abid:11
    v_rcp_f32 v183, v183
    v_readlane_b32 s64, v228, 2
    v_readlane_b32 s65, v228, 6
    v_readlane_b32 s66, v228, 10
    v_readlane_b32 s67, v228, 14
    v_and_or_b32 v229, v2, s33, v233
    v_pk_mul_f32 v[176:177], v[176:177], v[120:121]
    v_pk_mul_f32 v[178:179], v[178:179], v[122:123]
    v_pk_mul_f32 v[180:181], v[180:181], v[136:137]
    v_pk_mul_f32 v[182:183], v[182:183], v[138:139]
    s_set_gpr_idx_on s72, gpr_idx(SRC2,DST)
    v_pk_fma_f32 v[8:9], v[176:177], v[144:145], v[8:9] op_sel:[0,0,0] op_sel_hi:[0,1,1]
    v_pk_fma_f32 v[10:11], v[176:177], v[146:147], v[10:11] op_sel:[0,0,0] op_sel_hi:[0,1,1]
    v_pk_fma_f32 v[12:13], v[180:181], v[148:149], v[12:13] op_sel:[0,0,0] op_sel_hi:[0,1,1]
    v_pk_fma_f32 v[14:15], v[180:181], v[150:151], v[14:15] op_sel:[0,0,0] op_sel_hi:[0,1,1]
    s_set_gpr_idx_idx s73
    v_pk_fma_f32 v[8:9], v[176:177], v[152:153], v[8:9] op_sel:[1,0,0] op_sel_hi:[1,1,1]
    v_pk_fma_f32 v[10:11], v[176:177], v[154:155], v[10:11] op_sel:[1,0,0] op_sel_hi:[1,1,1]
    v_pk_fma_f32 v[12:13], v[180:181], v[156:157], v[12:13] op_sel:[1,0,0] op_sel_hi:[1,1,1]
    v_pk_fma_f32 v[14:15], v[180:181], v[158:159], v[14:15] op_sel:[1,0,0] op_sel_hi:[1,1,1]
    s_set_gpr_idx_idx s74
    v_pk_fma_f32 v[8:9], v[178:179], v[160:161], v[8:9] op_sel:[0,0,0] op_sel_hi:[0,1,1]
    v_pk_fma_f32 v[10:11], v[178:179], v[162:163], v[10:11] op_sel:[0,0,0] op_sel_hi:[0,1,1]
    v_pk_fma_f32 v[12:13], v[182:183], v[164:165], v[12:13] op_sel:[0,0,0] op_sel_hi:[0,1,1]
    v_pk_fma_f32 v[14:15], v[182:183], v[166:167], v[14:15] op_sel:[0,0,0] op_sel_hi:[0,1,1]
    s_set_gpr_idx_idx s75
    v_pk_fma_f32 v[8:9], v[178:179], v[168:169], v[8:9] op_sel:[1,0,0] op_sel_hi:[1,1,1]
    v_pk_fma_f32 v[10:11], v[178:179], v[170:171], v[10:11] op_sel:[1,0,0] op_sel_hi:[1,1,1]
    v_pk_fma_f32 v[12:13], v[182:183], v[172:173], v[12:13] op_sel:[1,0,0] op_sel_hi:[1,1,1]
    v_pk_fma_f32 v[14:15], v[182:183], v[174:175], v[14:15] op_sel:[1,0,0] op_sel_hi:[1,1,1]
    s_set_gpr_idx_off
    s_and_b32 s80, s64, s31
    s_and_b32 s81, s65, s31
    s_and_b32 s82, s66, s31
    s_and_b32 s83, s67, s31
    buffer_load_dwordx4 v[48:51], v232, s[4:7], s80 offen
    buffer_load_dwordx4 v[52:55], v232, s[4:7], s81 offen
    buffer_load_dwordx4 v[56:59], v232, s[4:7], s82 offen
    buffer_load_dwordx4 v[60:63], v232, s[4:7], s83 offen
    s_cmp_le_i32 s30, 28
    s_mov_b64 exec, s[20:21]
    ds_read_b128 v[192:195], v229 offset:46080
    s_mov_b64 exec, -1
    s_cbranch_scc1 L_exit
    s_setprio 0
    v_mfma_f32_32x32x16_bf16 v[96:111], v[196:199], v[212:215], v[96:111]
    v_exp_f32 v176, v124
    v_exp_f32 v177, v125
    v_exp_f32 v178, v126
    v_exp_f32 v179, v127
    v_exp_f32 v180, v140
    v_exp_f32 v181, v141
    v_exp_f32 v182, v142
    v_exp_f32 v183, v143
    v_pk_fma_f32 v[176:177], v[176:177], s[56:57], s[56:57]
    v_pk_fma_f32 v[178:179], v[178:179], s[56:57], s[56:57]
    v_pk_fma_f32 v[180:181], v[180:181], s[56:57], s[56:57]
    v_pk_fma_f32 v[182:183], v[182:183], s[56:57], s[56:57]
    s_waitcnt vmcnt(4)
    v_mfma_f32_4x4x4_16b_bf16 v[144:147], v[186:187], v[64:65], 0 cbsz:4 abid:12
    v_rcp_f32 v176, v176
    v_mfma_f32_4x4x4_16b_bf16 v[148:151], v[186:187], v[66:67], 0 cbsz:4 abid:12
    v_rcp_f32 v177, v177
    v_mfma_f32_4x4x4_16b_bf16 v[152:155], v[186:187], v[68:69], 0 cbsz:4 abid:13
    v_rcp_f32 v178, v178
    v_mfma_f32_4x4x4_16b_bf16 v[156:159], v[186:187], v[70:71], 0 cbsz:4 abid:13
    v_rcp_f32 v179, v179
    v_mfma_f32_4x4x4_16b_bf16 v[160:163], v[186:187], v[72:73], 0 cbsz:4 abid:14
    v_rcp_f32 v180, v180
    v_mfma_f32_4x4x4_16b_bf16 v[164:167], v[186:187], v[74:75], 0 cbsz:4 abid:14
    v_rcp_f32 v181, v181
    v_mfma_f32_4x4x4_16b_bf16 v[168:171], v[186:187], v[76:77], 0 cbsz:4 abid:15
    v_rcp_f32 v182, v182
    v_mfma_f32_4x4x4_16b_bf16 v[172:175], v[186:187], v[78:79], 0 cbsz:4 abid:15
    v_rcp_f32 v183, v183
    v_readlane_b32 s68, v228, 18
    v_readlane_b32 s69, v228, 22
    v_readlane_b32 s70, v228, 26
    v_readlane_b32 s71, v228, 30
    v_pk_mul_f32 v[176:177], v[176:177], v[124:125]
    v_pk_mul_f32 v[178:179], v[178:179], v[126:127]
    v_pk_mul_f32 v[180:181], v[180:181], v[140:141]
    v_pk_mul_f32 v[182:183], v[182:183], v[142:143]
    s_set_gpr_idx_on s76, gpr_idx(SRC2,DST)
    v_pk_fma_f32 v[8:9], v[176:177], v[144:145], v[8:9] op_sel:[0,0,0] op_sel_hi:[0,1,1]
    v_pk_fma_f32 v[10:11], v[176:177], v[146:147], v[10:11] op_sel:[0,0,0] op_sel_hi:[0,1,1]
    v_pk_fma_f32 v[12:13], v[180:181], v[148:149], v[12:13] op_sel:[0,0,0] op_sel_hi:[0,1,1]
    v_pk_fma_f32 v[14:15], v[180:181], v[150:151], v[14:15] op_sel:[0,0,0] op_sel_hi:[0,1,1]
    s_set_gpr_idx_idx s77
    v_pk_fma_f32 v[8:9], v[176:177], v[152:153], v[8:9] op_sel:[1,0,0] op_sel_hi:[1,1,1]
    v_pk_fma_f32 v[10:11], v[176:177], v[154:155], v[10:11] op_sel:[1,0,0] op_sel_hi:[1,1,1]
    v_pk_fma_f32 v[12:13], v[180:181], v[156:157], v[12:13] op_sel:[1,0,0] op_sel_hi:[1,1,1]
    v_pk_fma_f32 v[14:15], v[180:181], v[158:159], v[14:15] op_sel:[1,0,0] op_sel_hi:[1,1,1]
    s_set_gpr_idx_idx s78
    v_pk_fma_f32 v[8:9], v[178:179], v[160:161], v[8:9] op_sel:[0,0,0] op_sel_hi:[0,1,1]
    v_pk_fma_f32 v[10:11], v[178:179], v[162:163], v[10:11] op_sel:[0,0,0] op_sel_hi:[0,1,1]
    v_pk_fma_f32 v[12:13], v[182:183], v[164:165], v[12:13] op_sel:[0,0,0] op_sel_hi:[0,1,1]
    v_pk_fma_f32 v[14:15], v[182:183], v[166:167], v[14:15] op_sel:[0,0,0] op_sel_hi:[0,1,1]
    s_set_gpr_idx_idx s79
    v_pk_fma_f32 v[8:9], v[178:179], v[168:169], v[8:9] op_sel:[1,0,0] op_sel_hi:[1,1,1]
    v_pk_fma_f32 v[10:11], v[178:179], v[170:171], v[10:11] op_sel:[1,0,0] op_sel_hi:[1,1,1]
    v_pk_fma_f32 v[12:13], v[182:183], v[172:173], v[12:13] op_sel:[1,0,0] op_sel_hi:[1,1,1]
    v_pk_fma_f32 v[14:15], v[182:183], v[174:175], v[14:15] op_sel:[1,0,0] op_sel_hi:[1,1,1]
    s_set_gpr_idx_off
    s_and_b32 s80, s68, s31
    s_and_b32 s81, s69, s31
    s_and_b32 s82, s70, s31
    s_and_b32 s83, s71, s31
    buffer_load_dwordx4 v[64:67], v232, s[4:7], s80 offen
    buffer_load_dwordx4 v[68:71], v232, s[4:7], s81 offen
    buffer_load_dwordx4 v[72:75], v232, s[4:7], s82 offen
    buffer_load_dwordx4 v[76:79], v232, s[4:7], s83 offen
    s_cmp_le_i32 s30, 32
    s_waitcnt lgkmcnt(0)
    s_cbranch_scc1 L_exit
    s_setprio 3
    v_mfma_f32_32x32x16_bf16 v[112:127], v[192:195], v[200:203], 0
    v_exp_f32 v176, v80
    v_exp_f32 v177, v81
    v_exp_f32 v178, v82
    v_exp_f32 v179, v83
    v_exp_f32 v180, v96
    v_exp_f32 v181, v97
    v_exp_f32 v182, v98
    v_exp_f32 v183, v99
    v_pk_fma_f32 v[176:177], v[176:177], s[56:57], s[56:57]
    v_pk_fma_f32 v[178:179], v[178:179], s[56:57], s[56:57]
    v_pk_fma_f32 v[180:181], v[180:181], s[56:57], s[56:57]
    v_pk_fma_f32 v[182:183], v[182:183], s[56:57], s[56:57]
    s_waitcnt vmcnt(4)
    v_mfma_f32_4x4x4_16b_bf16 v[144:147], v[188:189], v[48:49], 0 cbsz:4 abid:0
    v_rcp_f32 v176, v176
    v_mfma_f32_4x4x4_16b_bf16 v[148:151], v[188:189], v[50:51], 0 cbsz:4 abid:0
    v_rcp_f32 v177, v177
    v_mfma_f32_4x4x4_16b_bf16 v[152:155], v[188:189], v[52:53], 0 cbsz:4 abid:1
    v_rcp_f32 v178, v178
    v_mfma_f32_4x4x4_16b_bf16 v[156:159], v[188:189], v[54:55], 0 cbsz:4 abid:1
    v_rcp_f32 v179, v179
    v_mfma_f32_4x4x4_16b_bf16 v[160:163], v[188:189], v[56:57], 0 cbsz:4 abid:2
    v_rcp_f32 v180, v180
    v_mfma_f32_4x4x4_16b_bf16 v[164:167], v[188:189], v[58:59], 0 cbsz:4 abid:2
    v_rcp_f32 v181, v181
    v_mfma_f32_4x4x4_16b_bf16 v[168:171], v[188:189], v[60:61], 0 cbsz:4 abid:3
    v_rcp_f32 v182, v182
    v_mfma_f32_4x4x4_16b_bf16 v[172:175], v[188:189], v[62:63], 0 cbsz:4 abid:3
    v_rcp_f32 v183, v183
    v_readlane_b32 s72, v228, 34
    v_readlane_b32 s73, v228, 38
    v_readlane_b32 s74, v228, 42
    v_readlane_b32 s75, v228, 46
    v_pk_mul_f32 v[176:177], v[176:177], v[80:81]
    v_pk_mul_f32 v[178:179], v[178:179], v[82:83]
    v_pk_mul_f32 v[180:181], v[180:181], v[96:97]
    v_pk_mul_f32 v[182:183], v[182:183], v[98:99]
    s_set_gpr_idx_on s64, gpr_idx(SRC2,DST)
    v_pk_fma_f32 v[8:9], v[176:177], v[144:145], v[8:9] op_sel:[0,0,0] op_sel_hi:[0,1,1]
    v_pk_fma_f32 v[10:11], v[176:177], v[146:147], v[10:11] op_sel:[0,0,0] op_sel_hi:[0,1,1]
    v_pk_fma_f32 v[12:13], v[180:181], v[148:149], v[12:13] op_sel:[0,0,0] op_sel_hi:[0,1,1]
    v_pk_fma_f32 v[14:15], v[180:181], v[150:151], v[14:15] op_sel:[0,0,0] op_sel_hi:[0,1,1]
    s_set_gpr_idx_idx s65
    v_pk_fma_f32 v[8:9], v[176:177], v[152:153], v[8:9] op_sel:[1,0,0] op_sel_hi:[1,1,1]
    v_pk_fma_f32 v[10:11], v[176:177], v[154:155], v[10:11] op_sel:[1,0,0] op_sel_hi:[1,1,1]
    v_pk_fma_f32 v[12:13], v[180:181], v[156:157], v[12:13] op_sel:[1,0,0] op_sel_hi:[1,1,1]
    v_pk_fma_f32 v[14:15], v[180:181], v[158:159], v[14:15] op_sel:[1,0,0] op_sel_hi:[1,1,1]
    s_set_gpr_idx_idx s66
    v_pk_fma_f32 v[8:9], v[178:179], v[160:161], v[8:9] op_sel:[0,0,0] op_sel_hi:[0,1,1]
    v_pk_fma_f32 v[10:11], v[178:179], v[162:163], v[10:11] op_sel:[0,0,0] op_sel_hi:[0,1,1]
    v_pk_fma_f32 v[12:13], v[182:183], v[164:165], v[12:13] op_sel:[0,0,0] op_sel_hi:[0,1,1]
    v_pk_fma_f32 v[14:15], v[182:183], v[166:167], v[14:15] op_sel:[0,0,0] op_sel_hi:[0,1,1]
    s_set_gpr_idx_idx s67
    v_pk_fma_f32 v[8:9], v[178:179], v[168:169], v[8:9] op_sel:[1,0,0] op_sel_hi:[1,1,1]
    v_pk_fma_f32 v[10:11], v[178:179], v[170:171], v[10:11] op_sel:[1,0,0] op_sel_hi:[1,1,1]
    v_pk_fma_f32 v[12:13], v[182:183], v[172:173], v[12:13] op_sel:[1,0,0] op_sel_hi:[1,1,1]
    v_pk_fma_f32 v[14:15], v[182:183], v[174:175], v[14:15] op_sel:[1,0,0] op_sel_hi:[1,1,1]
    s_set_gpr_idx_off
    s_and_b32 s80, s72, s31
    s_and_b32 s81, s73, s31
    s_and_b32 s82, s74, s31
    s_and_b32 s83, s75, s31
    buffer_load_dwordx4 v[48:51], v232, s[4:7], s80 offen
    buffer_load_dwordx4 v[52:55], v232, s[4:7], s81 offen
    buffer_load_dwordx4 v[56:59], v232, s[4:7], s82 offen
    buffer_load_dwordx4 v[60:63], v232, s[4:7], s83 offen
    s_cmp_le_i32 s30, 36
    s_mov_b64 exec, s[22:23]
    ds_read_b128 v[196:199], v229 offset:46080
    s_mov_b64 exec, -1
    ds_read_b32 v2, v231 offset:1036
    s_cbranch_scc1 L_exit
    s_setprio 2
    v_mfma_f32_32x32x16_bf16 v[128:143], v[192:195], v[204:207], 0
    v_exp_f32 v176, v84
    v_exp_f32 v177, v85
    v_exp_f32 v178, v86
    v_exp_f32 v179, v87
    v_exp_f32 v180, v100
    v_exp_f32 v181, v101
    v_exp_f32 v182, v102
    v_exp_f32 v183, v103
    v_pk_fma_f32 v[176:177], v[176:177], s[56:57], s[56:57]
    v_pk_fma_f32 v[178:179], v[178:179], s[56:57], s[56:57]
    v_pk_fma_f32 v[180:181], v[180:181], s[56:57], s[56:57]
    v_pk_fma_f32 v[182:183], v[182:183], s[56:57], s[56:57]
    s_waitcnt vmcnt(4)
    v_mfma_f32_4x4x4_16b_bf16 v[144:147], v[188:189], v[64:65], 0 cbsz:4 abid:4
    v_rcp_f32 v176, v176
    v_mfma_f32_4x4x4_16b_bf16 v[148:151], v[188:189], v[66:67], 0 cbsz:4 abid:4
    v_rcp_f32 v177, v177
    v_mfma_f32_4x4x4_16b_bf16 v[152:155], v[188:189], v[68:69], 0 cbsz:4 abid:5
    v_rcp_f32 v178, v178
    v_mfma_f32_4x4x4_16b_bf16 v[156:159], v[188:189], v[70:71], 0 cbsz:4 abid:5
    v_rcp_f32 v179, v179
    v_mfma_f32_4x4x4_16b_bf16 v[160:163], v[188:189], v[72:73], 0 cbsz:4 abid:6
    v_rcp_f32 v180, v180
    v_mfma_f32_4x4x4_16b_bf16 v[164:167], v[188:189], v[74:75], 0 cbsz:4 abid:6
    v_rcp_f32 v181, v181
    v_mfma_f32_4x4x4_16b_bf16 v[168:171], v[188:189], v[76:77], 0 cbsz:4 abid:7
    v_rcp_f32 v182, v182
    v_mfma_f32_4x4x4_16b_bf16 v[172:175], v[188:189], v[78:79], 0 cbsz:4 abid:7
    v_rcp_f32 v183, v183
    v_readlane_b32 s76, v228, 50
    v_readlane_b32 s77, v228, 54
    v_readlane_b32 s78, v228, 58
    v_readlane_b32 s79, v228, 62
    v_pk_mul_f32 v[176:177], v[176:177], v[84:85]
    v_pk_mul_f32 v[178:179], v[178:179], v[86:87]
    v_pk_mul_f32 v[180:181], v[180:181], v[100:101]
    v_pk_mul_f32 v[182:183], v[182:183], v[102:103]
    s_set_gpr_idx_on s68, gpr_idx(SRC2,DST)
    v_pk_fma_f32 v[8:9], v[176:177], v[144:145], v[8:9] op_sel:[0,0,0] op_sel_hi:[0,1,1]
    v_pk_fma_f32 v[10:11], v[176:177], v[146:147], v[10:11] op_sel:[0,0,0] op_sel_hi:[0,1,1]
    v_pk_fma_f32 v[12:13], v[180:181], v[148:149], v[12:13] op_sel:[0,0,0] op_sel_hi:[0,1,1]
    v_pk_fma_f32 v[14:15], v[180:181], v[150:151], v[14:15] op_sel:[0,0,0] op_sel_hi:[0,1,1]
    s_set_gpr_idx_idx s69
    v_pk_fma_f32 v[8:9], v[176:177], v[152:153], v[8:9] op_sel:[1,0,0] op_sel_hi:[1,1,1]
    v_pk_fma_f32 v[10:11], v[176:177], v[154:155], v[10:11] op_sel:[1,0,0] op_sel_hi:[1,1,1]
    v_pk_fma_f32 v[12:13], v[180:181], v[156:157], v[12:13] op_sel:[1,0,0] op_sel_hi:[1,1,1]
    v_pk_fma_f32 v[14:15], v[180:181], v[158:159], v[14:15] op_sel:[1,0,0] op_sel_hi:[1,1,1]
    s_set_gpr_idx_idx s70
    v_pk_fma_f32 v[8:9], v[178:179], v[160:161], v[8:9] op_sel:[0,0,0] op_sel_hi:[0,1,1]
    v_pk_fma_f32 v[10:11], v[178:179], v[162:163], v[10:11] op_sel:[0,0,0] op_sel_hi:[0,1,1]
    v_pk_fma_f32 v[12:13], v[182:183], v[164:165], v[12:13] op_sel:[0,0,0] op_sel_hi:[0,1,1]
    v_pk_fma_f32 v[14:15], v[182:183], v[166:167], v[14:15] op_sel:[0,0,0] op_sel_hi:[0,1,1]
    s_set_gpr_idx_idx s71
    v_pk_fma_f32 v[8:9], v[178:179], v[168:169], v[8:9] op_sel:[1,0,0] op_sel_hi:[1,1,1]
    v_pk_fma_f32 v[10:11], v[178:179], v[170:171], v[10:11] op_sel:[1,0,0] op_sel_hi:[1,1,1]
    v_pk_fma_f32 v[12:13], v[182:183], v[172:173], v[12:13] op_sel:[1,0,0] op_sel_hi:[1,1,1]
    v_pk_fma_f32 v[14:15], v[182:183], v[174:175], v[14:15] op_sel:[1,0,0] op_sel_hi:[1,1,1]
    s_set_gpr_idx_off
    s_and_b32 s80, s76, s31
    s_and_b32 s81, s77, s31
    s_and_b32 s82, s78, s31
    s_and_b32 s83, s79, s31
    buffer_load_dwordx4 v[64:67], v232, s[4:7], s80 offen
    buffer_load_dwordx4 v[68:71], v232, s[4:7], s81 offen
    buffer_load_dwordx4 v[72:75], v232, s[4:7], s82 offen
    buffer_load_dwordx4 v[76:79], v232, s[4:7], s83 offen
    s_cmp_le_i32 s30, 40
    s_waitcnt lgkmcnt(0)
    s_cbranch_scc1 L_exit
    s_setprio 1
    v_mfma_f32_32x32x16_bf16 v[112:127], v[196:199], v[208:211], v[112:127]
    v_exp_f32 v176, v88
    v_exp_f32 v177, v89
    v_exp_f32 v178, v90
    v_exp_f32 v179, v91
    v_exp_f32 v180, v104
    v_exp_f32 v181, v105
    v_exp_f32 v182, v106
    v_exp_f32 v183, v107
    v_pk_fma_f32 v[176:177], v[176:177], s[56:57], s[56:57]
    v_pk_fma_f32 v[178:179], v[178:179], s[56:57], s[56:57]
    v_pk_fma_f32 v[180:181], v[180:181], s[56:57], s[56:57]
    v_pk_fma_f32 v[182:183], v[182:183], s[56:57], s[56:57]
    s_waitcnt vmcnt(4)
    v_mfma_f32_4x4x4_16b_bf16 v[144:147], v[188:189], v[48:49], 0 cbsz:4 abid:8
    v_rcp_f32 v176, v176
    v_mfma_f32_4x4x4_16b_bf16 v[148:151], v[188:189], v[50:51], 0 cbsz:4 abid:8
    v_rcp_f32 v177, v177
    v_mfma_f32_4x4x4_16b_bf16 v[152:155], v[188:189], v[52:53], 0 cbsz:4 abid:9
    v_rcp_f32 v178, v178
    v_mfma_f32_4x4x4_16b_bf16 v[156:159], v[188:189], v[54:55], 0 cbsz:4 abid:9
    v_rcp_f32 v179, v179
    v_mfma_f32_4x4x4_16b_bf16 v[160:163], v[188:189], v[56:57], 0 cbsz:4 abid:10
    v_rcp_f32 v180, v180
    v_mfma_f32_4x4x4_16b_bf16 v[164:167], v[188:189], v[58:59], 0 cbsz:4 abid:10
    v_rcp_f32 v181, v181
    v_mfma_f32_4x4x4_16b_bf16 v[168:171], v[188:189], v[60:61], 0 cbsz:4 abid:11
    v_rcp_f32 v182, v182
    v_mfma_f32_4x4x4_16b_bf16 v[172:175], v[188:189], v[62:63], 0 cbsz:4 abid:11
    v_rcp_f32 v183, v183
    v_readlane_b32 s64, v228, 3
    v_readlane_b32 s65, v228, 7
    v_readlane_b32 s66, v228, 11
    v_readlane_b32 s67, v228, 15
    v_and_or_b32 v229, v2, s33, v233
    v_pk_mul_f32 v[176:177], v[176:177], v[88:89]
    v_pk_mul_f32 v[178:179], v[178:179], v[90:91]
    v_pk_mul_f32 v[180:181], v[180:181], v[104:105]
    v_pk_mul_f32 v[182:183], v[182:183], v[106:107]
    s_set_gpr_idx_on s72, gpr_idx(SRC2,DST)
    v_pk_fma_f32 v[8:9], v[176:177], v[144:145], v[8:9] op_sel:[0,0,0] op_sel_hi:[0,1,1]
    v_pk_fma_f32 v[10:11], v[176:177], v[146:147], v[10:11] op_sel:[0,0,0] op_sel_hi:[0,1,1]
    v_pk_fma_f32 v[12:13], v[180:181], v[148:149], v[12:13] op_sel:[0,0,0] op_sel_hi:[0,1,1]
    v_pk_fma_f32 v[14:15], v[180:181], v[150:151], v[14:15] op_sel:[0,0,0] op_sel_hi:[0,1,1]
    s_set_gpr_idx_idx s73
    v_pk_fma_f32 v[8:9], v[176:177], v[152:153], v[8:9] op_sel:[1,0,0] op_sel_hi:[1,1,1]
    v_pk_fma_f32 v[10:11], v[176:177], v[154:155], v[10:11] op_sel:[1,0,0] op_sel_hi:[1,1,1]
    v_pk_fma_f32 v[12:13], v[180:181], v[156:157], v[12:13] op_sel:[1,0,0] op_sel_hi:[1,1,1]
    v_pk_fma_f32 v[14:15], v[180:181], v[158:159], v[14:15] op_sel:[1,0,0] op_sel_hi:[1,1,1]
    s_set_gpr_idx_idx s74
    v_pk_fma_f32 v[8:9], v[178:179], v[160:161], v[8:9] op_sel:[0,0,0] op_sel_hi:[0,1,1]
    v_pk_fma_f32 v[10:11], v[178:179], v[162:163], v[10:11] op_sel:[0,0,0] op_sel_hi:[0,1,1]
    v_pk_fma_f32 v[12:13], v[182:183], v[164:165], v[12:13] op_sel:[0,0,0] op_sel_hi:[0,1,1]
    v_pk_fma_f32 v[14:15], v[182:183], v[166:167], v[14:15] op_sel:[0,0,0] op_sel_hi:[0,1,1]
    s_set_gpr_idx_idx s75
    v_pk_fma_f32 v[8:9], v[178:179], v[168:169], v[8:9] op_sel:[1,0,0] op_sel_hi:[1,1,1]
    v_pk_fma_f32 v[10:11], v[178:179], v[170:171], v[10:11] op_sel:[1,0,0] op_sel_hi:[1,1,1]
    v_pk_fma_f32 v[12:13], v[182:183], v[172:173], v[12:13] op_sel:[1,0,0] op_sel_hi:[1,1,1]
    v_pk_fma_f32 v[14:15], v[182:183], v[174:175], v[14:15] op_sel:[1,0,0] op_sel_hi:[1,1,1]
    s_set_gpr_idx_off
    s_and_b32 s80, s64, s31
    s_and_b32 s81, s65, s31
    s_and_b32 s82, s66, s31
    s_and_b32 s83, s67, s31
    buffer_load_dwordx4 v[48:51], v232, s[4:7], s80 offen
    buffer_load_dwordx4 v[52:55], v232, s[4:7], s81 offen
    buffer_load_dwordx4 v[56:59], v232, s[4:7], s82 offen
    buffer_load_dwordx4 v[60:63], v232, s[4:7], s83 offen
    s_cmp_le_i32 s30, 44
    s_mov_b64 exec, s[20:21]
    ds_read_b128 v[192:195], v229 offset:46080
    s_mov_b64 exec, -1
    s_cbranch_scc1 L_exit
    s_setprio 0
    v_mfma_f32_32x32x16_bf16 v[128:143], v[196:199], v[212:215], v[128:143]
    v_exp_f32 v176, v92
    v_exp_f32 v177, v93
    v_exp_f32 v178, v94
    v_exp_f32 v179, v95
    v_exp_f32 v180, v108
    v_exp_f32 v181, v109
    v_exp_f32 v182, v110
    v_exp_f32 v183, v111
    v_pk_fma_f32 v[176:177], v[176:177], s[56:57], s[56:57]
    v_pk_fma_f32 v[178:179], v[178:179], s[56:57], s[56:57]
    v_pk_fma_f32 v[180:181], v[180:181], s[56:57], s[56:57]
    v_pk_fma_f32 v[182:183], v[182:183], s[56:57], s[56:57]
    s_waitcnt vmcnt(4)
    v_mfma_f32_4x4x4_16b_bf16 v[144:147], v[188:189], v[64:65], 0 cbsz:4 abid:12
    v_rcp_f32 v176, v176
    v_mfma_f32_4x4x4_16b_bf16 v[148:151], v[188:189], v[66:67], 0 cbsz:4 abid:12
    v_rcp_f32 v177, v177
    v_mfma_f32_4x4x4_16b_bf16 v[152:155], v[188:189], v[68:69], 0 cbsz:4 abid:13
    v_rcp_f32 v178, v178
    v_mfma_f32_4x4x4_16b_bf16 v[156:159], v[188:189], v[70:71], 0 cbsz:4 abid:13
    v_rcp_f32 v179, v179
    v_mfma_f32_4x4x4_16b_bf16 v[160:163], v[188:189], v[72:73], 0 cbsz:4 abid:14
    v_rcp_f32 v180, v180
    v_mfma_f32_4x4x4_16b_bf16 v[164:167], v[188:189], v[74:75], 0 cbsz:4 abid:14
    v_rcp_f32 v181, v181
    v_mfma_f32_4x4x4_16b_bf16 v[168:171], v[188:189], v[76:77], 0 cbsz:4 abid:15
    v_rcp_f32 v182, v182
    v_mfma_f32_4x4x4_16b_bf16 v[172:175], v[188:189], v[78:79], 0 cbsz:4 abid:15
    v_rcp_f32 v183, v183
    v_readlane_b32 s68, v228, 19
    v_readlane_b32 s69, v228, 23
    v_readlane_b32 s70, v228, 27
    v_readlane_b32 s71, v228, 31
    v_pk_mul_f32 v[176:177], v[176:177], v[92:93]
    v_pk_mul_f32 v[178:179], v[178:179], v[94:95]
    v_pk_mul_f32 v[180:181], v[180:181], v[108:109]
    v_pk_mul_f32 v[182:183], v[182:183], v[110:111]
    s_set_gpr_idx_on s76, gpr_idx(SRC2,DST)
    v_pk_fma_f32 v[8:9], v[176:177], v[144:145], v[8:9] op_sel:[0,0,0] op_sel_hi:[0,1,1]
    v_pk_fma_f32 v[10:11], v[176:177], v[146:147], v[10:11] op_sel:[0,0,0] op_sel_hi:[0,1,1]
    v_pk_fma_f32 v[12:13], v[180:181], v[148:149], v[12:13] op_sel:[0,0,0] op_sel_hi:[0,1,1]
    v_pk_fma_f32 v[14:15], v[180:181], v[150:151], v[14:15] op_sel:[0,0,0] op_sel_hi:[0,1,1]
    s_set_gpr_idx_idx s77
    v_pk_fma_f32 v[8:9], v[176:177], v[152:153], v[8:9] op_sel:[1,0,0] op_sel_hi:[1,1,1]
    v_pk_fma_f32 v[10:11], v[176:177], v[154:155], v[10:11] op_sel:[1,0,0] op_sel_hi:[1,1,1]
    v_pk_fma_f32 v[12:13], v[180:181], v[156:157], v[12:13] op_sel:[1,0,0] op_sel_hi:[1,1,1]
    v_pk_fma_f32 v[14:15], v[180:181], v[158:159], v[14:15] op_sel:[1,0,0] op_sel_hi:[1,1,1]
    s_set_gpr_idx_idx s78
    v_pk_fma_f32 v[8:9], v[178:179], v[160:161], v[8:9] op_sel:[0,0,0] op_sel_hi:[0,1,1]
    v_pk_fma_f32 v[10:11], v[178:179], v[162:163], v[10:11] op_sel:[0,0,0] op_sel_hi:[0,1,1]
    v_pk_fma_f32 v[12:13], v[182:183], v[164:165], v[12:13] op_sel:[0,0,0] op_sel_hi:[0,1,1]
    v_pk_fma_f32 v[14:15], v[182:183], v[166:167], v[14:15] op_sel:[0,0,0] op_sel_hi:[0,1,1]
    s_set_gpr_idx_idx s79
    v_pk_fma_f32 v[8:9], v[178:179], v[168:169], v[8:9] op_sel:[1,0,0] op_sel_hi:[1,1,1]
    v_pk_fma_f32 v[10:11], v[178:179], v[170:171], v[10:11] op_sel:[1,0,0] op_sel_hi:[1,1,1]
    v_pk_fma_f32 v[12:13], v[182:183], v[172:173], v[12:13] op_sel:[1,0,0] op_sel_hi:[1,1,1]
    v_pk_fma_f32 v[14:15], v[182:183], v[174:175], v[14:15] op_sel:[1,0,0] op_sel_hi:[1,1,1]
    s_set_gpr_idx_off
    s_and_b32 s80, s68, s31
    s_and_b32 s81, s69, s31
    s_and_b32 s82, s70, s31
    s_and_b32 s83, s71, s31
    buffer_load_dwordx4 v[64:67], v232, s[4:7], s80 offen
    buffer_load_dwordx4 v[68:71], v232, s[4:7], s81 offen
    buffer_load_dwordx4 v[72:75], v232, s[4:7], s82 offen
    buffer_load_dwordx4 v[76:79], v232, s[4:7], s83 offen
    s_cmp_le_i32 s30, 48
    s_waitcnt lgkmcnt(0)
    s_cbranch_scc1 L_exit
    s_setprio 3
    v_mfma_f32_32x32x16_bf16 v[80:95], v[192:195], v[200:203], 0
    v_exp_f32 v176, v112
    v_exp_f32 v177, v113
    v_exp_f32 v178, v114
    v_exp_f32 v179, v115
    v_exp_f32 v180, v128
    v_exp_f32 v181, v129
    v_exp_f32 v182, v130
    v_exp_f32 v183, v131
    v_pk_fma_f32 v[176:177], v[176:177], s[56:57], s[56:57]
    v_pk_fma_f32 v[178:179], v[178:179], s[56:57], s[56:57]
    v_pk_fma_f32 v[180:181], v[180:181], s[56:57], s[56:57]
    v_pk_fma_f32 v[182:183], v[182:183], s[56:57], s[56:57]
    s_waitcnt vmcnt(4)
    v_mfma_f32_4x4x4_16b_bf16 v[144:147], v[190:191], v[48:49], 0 cbsz:4 abid:0
    v_rcp_f32 v176, v176
    v_mfma_f32_4x4x4_16b_bf16 v[148:151], v[190:191], v[50:51], 0 cbsz:4 abid:0
    v_rcp_f32 v177, v177
    v_mfma_f32_4x4x4_16b_bf16 v[152:155], v[190:191], v[52:53], 0 cbsz:4 abid:1
    v_rcp_f32 v178, v178
    v_mfma_f32_4x4x4_16b_bf16 v[156:159], v[190:191], v[54:55], 0 cbsz:4 abid:1
    v_rcp_f32 v179, v179
    v_mfma_f32_4x4x4_16b_bf16 v[160:163], v[190:191], v[56:57], 0 cbsz:4 abid:2
    v_rcp_f32 v180, v180
    v_mfma_f32_4x4x4_16b_bf16 v[164:167], v[190:191], v[58:59], 0 cbsz:4 abid:2
    v_rcp_f32 v181, v181
    v_mfma_f32_4x4x4_16b_bf16 v[168:171], v[190:191], v[60:61], 0 cbsz:4 abid:3
    v_rcp_f32 v182, v182
    v_mfma_f32_4x4x4_16b_bf16 v[172:175], v[190:191], v[62:63], 0 cbsz:4 abid:3
    v_rcp_f32 v183, v183
    v_readlane_b32 s72, v228, 35
    v_readlane_b32 s73, v228, 39
    v_readlane_b32 s74, v228, 43
    v_readlane_b32 s75, v228, 47
    v_pk_mul_f32 v[176:177], v[176:177], v[112:113]
    v_pk_mul_f32 v[178:179], v[178:179], v[114:115]
    v_pk_mul_f32 v[180:181], v[180:181], v[128:129]
    v_pk_mul_f32 v[182:183], v[182:183], v[130:131]
    s_set_gpr_idx_on s64, gpr_idx(SRC2,DST)
    v_pk_fma_f32 v[8:9], v[176:177], v[144:145], v[8:9] op_sel:[0,0,0] op_sel_hi:[0,1,1]
    v_pk_fma_f32 v[10:11], v[176:177], v[146:147], v[10:11] op_sel:[0,0,0] op_sel_hi:[0,1,1]
    v_pk_fma_f32 v[12:13], v[180:181], v[148:149], v[12:13] op_sel:[0,0,0] op_sel_hi:[0,1,1]
    v_pk_fma_f32 v[14:15], v[180:181], v[150:151], v[14:15] op_sel:[0,0,0] op_sel_hi:[0,1,1]
    s_set_gpr_idx_idx s65
    v_pk_fma_f32 v[8:9], v[176:177], v[152:153], v[8:9] op_sel:[1,0,0] op_sel_hi:[1,1,1]
    v_pk_fma_f32 v[10:11], v[176:177], v[154:155], v[10:11] op_sel:[1,0,0] op_sel_hi:[1,1,1]
    v_pk_fma_f32 v[12:13], v[180:181], v[156:157], v[12:13] op_sel:[1,0,0] op_sel_hi:[1,1,1]
    v_pk_fma_f32 v[14:15], v[180:181], v[158:159], v[14:15] op_sel:[1,0,0] op_sel_hi:[1,1,1]
    s_set_gpr_idx_idx s66
    v_pk_fma_f32 v[8:9], v[178:179], v[160:161], v[8:9] op_sel:[0,0,0] op_sel_hi:[0,1,1]
    v_pk_fma_f32 v[10:11], v[178:179], v[162:163], v[10:11] op_sel:[0,0,0] op_sel_hi:[0,1,1]
    v_pk_fma_f32 v[12:13], v[182:183], v[164:165], v[12:13] op_sel:[0,0,0] op_sel_hi:[0,1,1]
    v_pk_fma_f32 v[14:15], v[182:183], v[166:167], v[14:15] op_sel:[0,0,0] op_sel_hi:[0,1,1]
    s_set_gpr_idx_idx s67
    v_pk_fma_f32 v[8:9], v[178:179], v[168:169], v[8:9] op_sel:[1,0,0] op_sel_hi:[1,1,1]
    v_pk_fma_f32 v[10:11], v[178:179], v[170:171], v[10:11] op_sel:[1,0,0] op_sel_hi:[1,1,1]
    v_pk_fma_f32 v[12:13], v[182:183], v[172:173], v[12:13] op_sel:[1,0,0] op_sel_hi:[1,1,1]
    v_pk_fma_f32 v[14:15], v[182:183], v[174:175], v[14:15] op_sel:[1,0,0] op_sel_hi:[1,1,1]
    s_set_gpr_idx_off
    s_and_b32 s80, s72, s31
    s_and_b32 s81, s73, s31
    s_and_b32 s82, s74, s31
    s_and_b32 s83, s75, s31
    buffer_load_dwordx4 v[48:51], v232, s[4:7], s80 offen
    buffer_load_dwordx4 v[52:55], v232, s[4:7], s81 offen
    buffer_load_dwordx4 v[56:59], v232, s[4:7], s82 offen
    buffer_load_dwordx4 v[60:63], v232, s[4:7], s83 offen
    s_cmp_le_i32 s30, 52
    s_mov_b64 exec, s[22:23]
    ds_read_b128 v[196:199], v229 offset:46080
    s_mov_b64 exec, -1
    ds_read_b32 v2, v231 offset:1292
    s_cbranch_scc1 L_exit
    s_setprio 2
    v_mfma_f32_32x32x16_bf16 v[96:111], v[192:195], v[204:207], 0
    v_exp_f32 v176, v116
    v_exp_f32 v177, v117
    v_exp_f32 v178, v118
    v_exp_f32 v179, v119
    v_exp_f32 v180, v132
    v_exp_f32 v181, v133
    v_exp_f32 v182, v134
    v_exp_f32 v183, v135
    v_pk_fma_f32 v[176:177], v[176:177], s[56:57], s[56:57]
    v_pk_fma_f32 v[178:179], v[178:179], s[56:57], s[56:57]
    v_pk_fma_f32 v[180:181], v[180:181], s[56:57], s[56:57]
    v_pk_fma_f32 v[182:183], v[182:183], s[56:57], s[56:57]
    s_waitcnt vmcnt(4)
    v_mfma_f32_4x4x4_16b_bf16 v[144:147], v[190:191], v[64:65], 0 cbsz:4 abid:4
    v_rcp_f32 v176, v176
    v_mfma_f32_4x4x4_16b_bf16 v[148:151], v[190:191], v[66:67], 0 cbsz:4 abid:4
    v_rcp_f32 v177, v177
    v_mfma_f32_4x4x4_16b_bf16 v[152:155], v[190:191], v[68:69], 0 cbsz:4 abid:5
    v_rcp_f32 v178, v178
    v_mfma_f32_4x4x4_16b_bf16 v[156:159], v[190:191], v[70:71], 0 cbsz:4 abid:5
    v_rcp_f32 v179, v179
    v_mfma_f32_4x4x4_16b_bf16 v[160:163], v[190:191], v[72:73], 0 cbsz:4 abid:6
    v_rcp_f32 v180, v180
    v_mfma_f32_4x4x4_16b_bf16 v[164:167], v[190:191], v[74:75], 0 cbsz:4 abid:6
    v_rcp_f32 v181, v181
    v_mfma_f32_4x4x4_16b_bf16 v[168:171], v[190:191], v[76:77], 0 cbsz:4 abid:7
    v_rcp_f32 v182, v182
    v_mfma_f32_4x4x4_16b_bf16 v[172:175], v[190:191], v[78:79], 0 cbsz:4 abid:7
    v_rcp_f32 v183, v183
    v_readlane_b32 s76, v228, 51
    v_readlane_b32 s77, v228, 55
    v_readlane_b32 s78, v228, 59
    v_readlane_b32 s79, v228, 63
    v_pk_mul_f32 v[176:177], v[176:177], v[116:117]
    v_pk_mul_f32 v[178:179], v[178:179], v[118:119]
    v_pk_mul_f32 v[180:181], v[180:181], v[132:133]
    v_pk_mul_f32 v[182:183], v[182:183], v[134:135]
    s_set_gpr_idx_on s68, gpr_idx(SRC2,DST)
    v_pk_fma_f32 v[8:9], v[176:177], v[144:145], v[8:9] op_sel:[0,0,0] op_sel_hi:[0,1,1]
    v_pk_fma_f32 v[10:11], v[176:177], v[146:147], v[10:11] op_sel:[0,0,0] op_sel_hi:[0,1,1]
    v_pk_fma_f32 v[12:13], v[180:181], v[148:149], v[12:13] op_sel:[0,0,0] op_sel_hi:[0,1,1]
    v_pk_fma_f32 v[14:15], v[180:181], v[150:151], v[14:15] op_sel:[0,0,0] op_sel_hi:[0,1,1]
    s_set_gpr_idx_idx s69
    v_pk_fma_f32 v[8:9], v[176:177], v[152:153], v[8:9] op_sel:[1,0,0] op_sel_hi:[1,1,1]
    v_pk_fma_f32 v[10:11], v[176:177], v[154:155], v[10:11] op_sel:[1,0,0] op_sel_hi:[1,1,1]
    v_pk_fma_f32 v[12:13], v[180:181], v[156:157], v[12:13] op_sel:[1,0,0] op_sel_hi:[1,1,1]
    v_pk_fma_f32 v[14:15], v[180:181], v[158:159], v[14:15] op_sel:[1,0,0] op_sel_hi:[1,1,1]
    s_set_gpr_idx_idx s70
    v_pk_fma_f32 v[8:9], v[178:179], v[160:161], v[8:9] op_sel:[0,0,0] op_sel_hi:[0,1,1]
    v_pk_fma_f32 v[10:11], v[178:179], v[162:163], v[10:11] op_sel:[0,0,0] op_sel_hi:[0,1,1]
    v_pk_fma_f32 v[12:13], v[182:183], v[164:165], v[12:13] op_sel:[0,0,0] op_sel_hi:[0,1,1]
    v_pk_fma_f32 v[14:15], v[182:183], v[166:167], v[14:15] op_sel:[0,0,0] op_sel_hi:[0,1,1]
    s_set_gpr_idx_idx s71
    v_pk_fma_f32 v[8:9], v[178:179], v[168:169], v[8:9] op_sel:[1,0,0] op_sel_hi:[1,1,1]
    v_pk_fma_f32 v[10:11], v[178:179], v[170:171], v[10:11] op_sel:[1,0,0] op_sel_hi:[1,1,1]
    v_pk_fma_f32 v[12:13], v[182:183], v[172:173], v[12:13] op_sel:[1,0,0] op_sel_hi:[1,1,1]
    v_pk_fma_f32 v[14:15], v[182:183], v[174:175], v[14:15] op_sel:[1,0,0] op_sel_hi:[1,1,1]
    s_set_gpr_idx_off
    s_and_b32 s80, s76, s31
    s_and_b32 s81, s77, s31
    s_and_b32 s82, s78, s31
    s_and_b32 s83, s79, s31
    buffer_load_dwordx4 v[64:67], v232, s[4:7], s80 offen
    buffer_load_dwordx4 v[68:71], v232, s[4:7], s81 offen
    buffer_load_dwordx4 v[72:75], v232, s[4:7], s82 offen
    buffer_load_dwordx4 v[76:79], v232, s[4:7], s83 offen
    s_cmp_le_i32 s30, 56
    s_waitcnt lgkmcnt(0)
    s_cbranch_scc1 L_exit
    s_setprio 1
    v_cndmask_b32 v228, v4, v226, s[34:35]
    v_mfma_f32_32x32x16_bf16 v[80:95], v[196:199], v[208:211], v[80:95]
    v_exp_f32 v176, v120
    v_exp_f32 v177, v121
    v_exp_f32 v178, v122
    v_exp_f32 v179, v123
    v_exp_f32 v180, v136
    v_exp_f32 v181, v137
    v_exp_f32 v182, v138
    v_exp_f32 v183, v139
    v_pk_fma_f32 v[176:177], v[176:177], s[56:57], s[56:57]
    v_pk_fma_f32 v[178:179], v[178:179], s[56:57], s[56:57]
    v_pk_fma_f32 v[180:181], v[180:181], s[56:57], s[56:57]
    v_pk_fma_f32 v[182:183], v[182:183], s[56:57], s[56:57]
    s_waitcnt vmcnt(4)
    v_mfma_f32_4x4x4_16b_bf16 v[144:147], v[190:191], v[48:49], 0 cbsz:4 abid:8
    v_rcp_f32 v176, v176
    v_mfma_f32_4x4x4_16b_bf16 v[148:151], v[190:191], v[50:51], 0 cbsz:4 abid:8
    v_rcp_f32 v177, v177
    v_mfma_f32_4x4x4_16b_bf16 v[152:155], v[190:191], v[52:53], 0 cbsz:4 abid:9
    v_rcp_f32 v178, v178
    v_mfma_f32_4x4x4_16b_bf16 v[156:159], v[190:191], v[54:55], 0 cbsz:4 abid:9
    v_rcp_f32 v179, v179
    v_mfma_f32_4x4x4_16b_bf16 v[160:163], v[190:191], v[56:57], 0 cbsz:4 abid:10
    v_rcp_f32 v180, v180
    v_mfma_f32_4x4x4_16b_bf16 v[164:167], v[190:191], v[58:59], 0 cbsz:4 abid:10
    v_rcp_f32 v181, v181
    v_mfma_f32_4x4x4_16b_bf16 v[168:171], v[190:191], v[60:61], 0 cbsz:4 abid:11
    v_rcp_f32 v182, v182
    v_mfma_f32_4x4x4_16b_bf16 v[172:175], v[190:191], v[62:63], 0 cbsz:4 abid:11
    v_rcp_f32 v183, v183
    v_readlane_b32 s64, v228, 0
    v_readlane_b32 s65, v228, 4
    v_readlane_b32 s66, v228, 8
    v_readlane_b32 s67, v228, 12
    v_and_or_b32 v229, v2, s33, v233
    v_pk_mul_f32 v[176:177], v[176:177], v[120:121]
    v_pk_mul_f32 v[178:179], v[178:179], v[122:123]
    v_pk_mul_f32 v[180:181], v[180:181], v[136:137]
    v_pk_mul_f32 v[182:183], v[182:183], v[138:139]
    s_set_gpr_idx_on s72, gpr_idx(SRC2,DST)
    v_pk_fma_f32 v[8:9], v[176:177], v[144:145], v[8:9] op_sel:[0,0,0] op_sel_hi:[0,1,1]
    v_pk_fma_f32 v[10:11], v[176:177], v[146:147], v[10:11] op_sel:[0,0,0] op_sel_hi:[0,1,1]
    v_pk_fma_f32 v[12:13], v[180:181], v[148:149], v[12:13] op_sel:[0,0,0] op_sel_hi:[0,1,1]
    v_pk_fma_f32 v[14:15], v[180:181], v[150:151], v[14:15] op_sel:[0,0,0] op_sel_hi:[0,1,1]
    s_set_gpr_idx_idx s73
    v_pk_fma_f32 v[8:9], v[176:177], v[152:153], v[8:9] op_sel:[1,0,0] op_sel_hi:[1,1,1]
    v_pk_fma_f32 v[10:11], v[176:177], v[154:155], v[10:11] op_sel:[1,0,0] op_sel_hi:[1,1,1]
    v_pk_fma_f32 v[12:13], v[180:181], v[156:157], v[12:13] op_sel:[1,0,0] op_sel_hi:[1,1,1]
    v_pk_fma_f32 v[14:15], v[180:181], v[158:159], v[14:15] op_sel:[1,0,0] op_sel_hi:[1,1,1]
    s_set_gpr_idx_idx s74
    v_pk_fma_f32 v[8:9], v[178:179], v[160:161], v[8:9] op_sel:[0,0,0] op_sel_hi:[0,1,1]
    v_pk_fma_f32 v[10:11], v[178:179], v[162:163], v[10:11] op_sel:[0,0,0] op_sel_hi:[0,1,1]
    v_pk_fma_f32 v[12:13], v[182:183], v[164:165], v[12:13] op_sel:[0,0,0] op_sel_hi:[0,1,1]
    v_pk_fma_f32 v[14:15], v[182:183], v[166:167], v[14:15] op_sel:[0,0,0] op_sel_hi:[0,1,1]
    s_set_gpr_idx_idx s75
    v_pk_fma_f32 v[8:9], v[178:179], v[168:169], v[8:9] op_sel:[1,0,0] op_sel_hi:[1,1,1]
    v_pk_fma_f32 v[10:11], v[178:179], v[170:171], v[10:11] op_sel:[1,0,0] op_sel_hi:[1,1,1]
    v_pk_fma_f32 v[12:13], v[182:183], v[172:173], v[12:13] op_sel:[1,0,0] op_sel_hi:[1,1,1]
    v_pk_fma_f32 v[14:15], v[182:183], v[174:175], v[14:15] op_sel:[1,0,0] op_sel_hi:[1,1,1]
    s_set_gpr_idx_off
    s_and_b32 s80, s64, s31
    s_and_b32 s81, s65, s31
    s_and_b32 s82, s66, s31
    s_and_b32 s83, s67, s31
    buffer_load_dwordx4 v[48:51], v232, s[4:7], s80 offen
    buffer_load_dwordx4 v[52:55], v232, s[4:7], s81 offen
    buffer_load_dwordx4 v[56:59], v232, s[4:7], s82 offen
    buffer_load_dwordx4 v[60:63], v232, s[4:7], s83 offen
    s_cmp_le_i32 s30, 60
    s_mov_b64 exec, s[20:21]
    ds_read_b128 v[192:195], v229 offset:46080
    s_mov_b64 exec, -1
    s_cbranch_scc1 L_exit
    s_setprio 0
    v_mfma_f32_32x32x16_bf16 v[96:111], v[196:199], v[212:215], v[96:111]
    v_exp_f32 v176, v124
    v_exp_f32 v177, v125
    v_exp_f32 v178, v126
    v_exp_f32 v179, v127
    v_exp_f32 v180, v140
    v_exp_f32 v181, v141
    v_exp_f32 v182, v142
    v_exp_f32 v183, v143
    v_pk_fma_f32 v[176:177], v[176:177], s[56:57], s[56:57]
    v_pk_fma_f32 v[178:179], v[178:179], s[56:57], s[56:57]
    v_pk_fma_f32 v[180:181], v[180:181], s[56:57], s[56:57]
    v_pk_fma_f32 v[182:183], v[182:183], s[56:57], s[56:57]
    s_waitcnt vmcnt(4)
    v_mfma_f32_4x4x4_16b_bf16 v[144:147], v[190:191], v[64:65], 0 cbsz:4 abid:12
    v_rcp_f32 v176, v176
    v_mfma_f32_4x4x4_16b_bf16 v[148:151], v[190:191], v[66:67], 0 cbsz:4 abid:12
    v_rcp_f32 v177, v177
    v_mfma_f32_4x4x4_16b_bf16 v[152:155], v[190:191], v[68:69], 0 cbsz:4 abid:13
    v_rcp_f32 v178, v178
    v_mfma_f32_4x4x4_16b_bf16 v[156:159], v[190:191], v[70:71], 0 cbsz:4 abid:13
    v_rcp_f32 v179, v179
    v_mfma_f32_4x4x4_16b_bf16 v[160:163], v[190:191], v[72:73], 0 cbsz:4 abid:14
    v_rcp_f32 v180, v180
    v_mfma_f32_4x4x4_16b_bf16 v[164:167], v[190:191], v[74:75], 0 cbsz:4 abid:14
    v_rcp_f32 v181, v181
    v_mfma_f32_4x4x4_16b_bf16 v[168:171], v[190:191], v[76:77], 0 cbsz:4 abid:15
    v_rcp_f32 v182, v182
    v_mfma_f32_4x4x4_16b_bf16 v[172:175], v[190:191], v[78:79], 0 cbsz:4 abid:15
    v_rcp_f32 v183, v183
    v_readlane_b32 s68, v228, 16
    v_readlane_b32 s69, v228, 20
    v_readlane_b32 s70, v228, 24
    v_readlane_b32 s71, v228, 28
    v_pk_mul_f32 v[176:177], v[176:177], v[124:125]
    v_pk_mul_f32 v[178:179], v[178:179], v[126:127]
    v_pk_mul_f32 v[180:181], v[180:181], v[140:141]
    v_pk_mul_f32 v[182:183], v[182:183], v[142:143]
    s_set_gpr_idx_on s76, gpr_idx(SRC2,DST)
    v_pk_fma_f32 v[8:9], v[176:177], v[144:145], v[8:9] op_sel:[0,0,0] op_sel_hi:[0,1,1]
    v_pk_fma_f32 v[10:11], v[176:177], v[146:147], v[10:11] op_sel:[0,0,0] op_sel_hi:[0,1,1]
    v_pk_fma_f32 v[12:13], v[180:181], v[148:149], v[12:13] op_sel:[0,0,0] op_sel_hi:[0,1,1]
    v_pk_fma_f32 v[14:15], v[180:181], v[150:151], v[14:15] op_sel:[0,0,0] op_sel_hi:[0,1,1]
    s_set_gpr_idx_idx s77
    v_pk_fma_f32 v[8:9], v[176:177], v[152:153], v[8:9] op_sel:[1,0,0] op_sel_hi:[1,1,1]
    v_pk_fma_f32 v[10:11], v[176:177], v[154:155], v[10:11] op_sel:[1,0,0] op_sel_hi:[1,1,1]
    v_pk_fma_f32 v[12:13], v[180:181], v[156:157], v[12:13] op_sel:[1,0,0] op_sel_hi:[1,1,1]
    v_pk_fma_f32 v[14:15], v[180:181], v[158:159], v[14:15] op_sel:[1,0,0] op_sel_hi:[1,1,1]
    s_set_gpr_idx_idx s78
    v_pk_fma_f32 v[8:9], v[178:179], v[160:161], v[8:9] op_sel:[0,0,0] op_sel_hi:[0,1,1]
    v_pk_fma_f32 v[10:11], v[178:179], v[162:163], v[10:11] op_sel:[0,0,0] op_sel_hi:[0,1,1]
    v_pk_fma_f32 v[12:13], v[182:183], v[164:165], v[12:13] op_sel:[0,0,0] op_sel_hi:[0,1,1]
    v_pk_fma_f32 v[14:15], v[182:183], v[166:167], v[14:15] op_sel:[0,0,0] op_sel_hi:[0,1,1]
    s_set_gpr_idx_idx s79
    v_pk_fma_f32 v[8:9], v[178:179], v[168:169], v[8:9] op_sel:[1,0,0] op_sel_hi:[1,1,1]
    v_pk_fma_f32 v[10:11], v[178:179], v[170:171], v[10:11] op_sel:[1,0,0] op_sel_hi:[1,1,1]
    v_pk_fma_f32 v[12:13], v[182:183], v[172:173], v[12:13] op_sel:[1,0,0] op_sel_hi:[1,1,1]
    v_pk_fma_f32 v[14:15], v[182:183], v[174:175], v[14:15] op_sel:[1,0,0] op_sel_hi:[1,1,1]
    s_set_gpr_idx_off
    s_and_b32 s80, s68, s31
    s_and_b32 s81, s69, s31
    s_and_b32 s82, s70, s31
    s_and_b32 s83, s71, s31
    buffer_load_dwordx4 v[64:67], v232, s[4:7], s80 offen
    buffer_load_dwordx4 v[68:71], v232, s[4:7], s81 offen
    buffer_load_dwordx4 v[72:75], v232, s[4:7], s82 offen
    buffer_load_dwordx4 v[76:79], v232, s[4:7], s83 offen
    s_waitcnt lgkmcnt(0)
    v_add_u32 v231, 1024, v231
    s_sub_u32 s30, s30, 64
    s_branch L_sb
L_exit:
    s_setprio 0
    s_add_u32 s24, s24, 216
    s_cmp_lt_u32 s24, s25
    s_cbranch_scc0 L_epi
    s_waitcnt vmcnt(0) lgkmcnt(0)
    v_lshlrev_b32 v7, 3, v0
    v_mov_b32 v2, 0
    v_mov_b32 v3, 0
    ds_write_b64 v7, v[2:3]
    s_nop 15
    s_mul_i32 s26, s16, 5
    v_add_u32 v113, s26, v1
    v_subrev_u32 v3, 40, v113
    v_min_u32 v113, v113, v3
    v_mul_u32_u24 v3, 205, v1
    v_lshrrev_b32 v3, 10, v3
    v_mul_u32_u24 v2, 5, v3
    v_sub_u32 v115, v1, v2
    v_lshlrev_b32 v114, 2, v3
    s_lshl_b32 s81, s16, 10
    s_add_u32 s81, s81, 8192
    s_mul_i32 s80, s16, 6912
    v_lshl_add_u32 v121, v1, 2, s81
    v_lshrrev_b32 v3, 1, v1
    v_lshl_add_u32 v122, v3, 2, s81
    v_and_b32 v2, 1, v1
    v_lshlrev_b32 v123, 4, v2
    v_lshrrev_b32 v3, 1, v0
    v_mul_u32_u24 v3, 1280, v3
    v_add_u32 v124, v3, v2
    v_mul_u32_u24 v125, 48, v113
    s_lshl_b32 s26, s16, 2
    v_lshl_add_u32 v126, v115, 5, s26
    v_lshl_add_u32 v127, v1, 5, s80
    s_cmp_eq_u32 s16, 7
    s_cselect_b32 s54, 0, 1
    s_lshr_b32 s26, s17, 5
    s_mul_i32 s26, s26, 1218
    s_add_u32 s26, s26, s17
    s_lshl3_add_u32 s26, s26, s16
    s_lshl_b32 s26, s26, 7
    v_lshl_add_u32 v120, v1, 15, s26
    v_mov_b32 v80, 0xffffff
    v_mov_b32 v81, 0xffffff
    v_mov_b32 v82, 0xffffff
    v_mov_b32 v83, 0xffffff
    v_add_u32 v2, s81, v232
    ds_write_b128 v2, v[80:83]
    s_waitcnt lgkmcnt(0)
    s_barrier
    v_and_b32 v2, 1, v0
    v_max_u32 v3, s24, v235
    v_add_u32 v3, v3, v2
    s_add_u32 s27, s24, 216
    v_min_u32 v4, s27, v236
    v_add_u32 v5, v237, v3
    s_lshl_b32 s27, s24, 2
    s_sub_u32 s27, s81, s27
    v_lshl_add_u32 v6, v3, 2, s27
    v_sub_u32 v4, v4, v3
    s_branch L_exp
L_exp_more:
    v_add_u32 v6, 48, v6
    v_subrev_u32 v4, 12, v4
    s_branch L_exp
L_epi:
    v_lshlrev_b32 v5, 2, v1
    v_add_u32 v3, s48, v5
    v_cvt_pk_bf16_f32 v8, v8, v12
    v_cvt_pk_bf16_f32 v9, v9, v13
    v_cvt_pk_bf16_f32 v10, v10, v14
    v_cvt_pk_bf16_f32 v11, v11, v15
    ds_write2_b32 v3, v8, v9 offset0:0 offset1:72
    ds_write2_b32 v3, v10, v11 offset0:144 offset1:216
    v_add_u32 v3, s49, v5
    v_cvt_pk_bf16_f32 v16, v16, v20
    v_cvt_pk_bf16_f32 v17, v17, v21
    v_cvt_pk_bf16_f32 v18, v18, v22
    v_cvt_pk_bf16_f32 v19, v19, v23
    ds_write2_b32 v3, v16, v17 offset0:0 offset1:72
    ds_write2_b32 v3, v18, v19 offset0:144 offset1:216
    v_add_u32 v3, s50, v5
    v_cvt_pk_bf16_f32 v24, v24, v28
    v_cvt_pk_bf16_f32 v25, v25, v29
    v_cvt_pk_bf16_f32 v26, v26, v30
    v_cvt_pk_bf16_f32 v27, v27, v31
    ds_write2_b32 v3, v24, v25 offset0:0 offset1:72
    ds_write2_b32 v3, v26, v27 offset0:144 offset1:216
    v_add_u32 v3, s51, v5
    v_cvt_pk_bf16_f32 v32, v32, v36
    v_cvt_pk_bf16_f32 v33, v33, v37
    v_cvt_pk_bf16_f32 v34, v34, v38
    v_cvt_pk_bf16_f32 v35, v35, v39
    ds_write2_b32 v3, v32, v33 offset0:0 offset1:72
    ds_write2_b32 v3, v34, v35 offset0:144 offset1:216
    v_add_u32 v3, s52, v5
    v_cvt_pk_bf16_f32 v40, v40, v44
    v_cvt_pk_bf16_f32 v41, v41, v45
    v_cvt_pk_bf16_f32 v42, v42, v46
    v_cvt_pk_bf16_f32 v43, v43, v47
    ds_write2_b32 v3, v40, v41 offset0:0 offset1:72
    ds_write2_b32 v3, v42, v43 offset0:144 offset1:216
    s_waitcnt lgkmcnt(10)
    v_readfirstlane_b32 s38, v243
    s_cmp_eq_u32 s38, 8
    s_cbranch_scc0 L_nob
    ds_read_b128 v[192:195], v240 offset:0
    ds_read_b128 v[208:211], v240 offset:256
    ds_read_b128 v[196:199], v240 offset:8192
    ds_read_b128 v[212:215], v240 offset:8448
    ds_read_b128 v[200:203], v240 offset:16384
    ds_read_b128 v[216:219], v240 offset:16640
    ds_read_b128 v[204:207], v240 offset:24576
    ds_read_b128 v[220:223], v240 offset:24832
    s_waitcnt lgkmcnt(8)
    s_barrier
    s_branch L_haveb
L_nob:
    s_waitcnt lgkmcnt(0)
    s_barrier
    ds_read_b128 v[192:195], v240 offset:0
    ds_read_b128 v[208:211], v240 offset:256
    ds_read_b128 v[196:199], v240 offset:8192
    ds_read_b128 v[212:215], v240 offset:8448
    ds_read_b128 v[200:203], v240 offset:16384
    ds_read_b128 v[216:219], v240 offset:16640
    ds_read_b128 v[204:207], v240 offset:24576
    ds_read_b128 v[220:223], v240 offset:24832
L_haveb:
    ds_read_b128 v[80:83], v241 offset:0
    ds_read_b128 v[84:87], v241 offset:64
    ds_read_b128 v[88:91], v241 offset:128
    ds_read_b128 v[92:95], v241 offset:192
    s_waitcnt lgkmcnt(3)
    v_mfma_f32_16x16x32_bf16 v[8:11], v[80:83], v[192:195], 0
    ds_read_b128 v[96:99], v241 offset:4608
    v_mfma_f32_16x16x32_bf16 v[12:15], v[80:83], v[208:211], 0
    s_waitcnt lgkmcnt(3)
    v_mfma_f32_16x16x32_bf16 v[8:11], v[84:87], v[196:199], v[8:11]
    ds_read_b128 v[100:103], v241 offset:4672
    v_mfma_f32_16x16x32_bf16 v[12:15], v[84:87], v[212:215], v[12:15]
    s_waitcnt lgkmcnt(3)
    v_mfma_f32_16x16x32_bf16 v[8:11], v[88:91], v[200:203], v[8:11]
    ds_read_b128 v[104:107], v241 offset:4736
    v_mfma_f32_16x16x32_bf16 v[12:15], v[88:91], v[216:219], v[12:15]
    s_waitcnt lgkmcnt(3)
    v_mfma_f32_16x16x32_bf16 v[8:11], v[92:95], v[204:207], v[8:11]
    ds_read_b128 v[108:111], v241 offset:4800
    v_mfma_f32_16x16x32_bf16 v[12:15], v[92:95], v[220:223], v[12:15]
    s_waitcnt lgkmcnt(3)
    v_mfma_f32_16x16x32_bf16 v[16:19], v[96:99], v[192:195], 0
    ds_read_b128 v[112:115], v241 offset:9216
    v_mfma_f32_16x16x32_bf16 v[20:23], v[96:99], v[208:211], 0
    s_waitcnt lgkmcnt(3)
    v_mfma_f32_16x16x32_bf16 v[16:19], v[100:103], v[196:199], v[16:19]
    ds_read_b128 v[116:119], v241 offset:9280
    v_mfma_f32_16x16x32_bf16 v[20:23], v[100:103], v[212:215], v[20:23]
    v_cvt_pk_bf16_f32 v160, v8, v9
    v_cvt_pk_bf16_f32 v161, v10, v11
    v_cvt_pk_bf16_f32 v162, v12, v13
    v_cvt_pk_bf16_f32 v163, v14, v15
    buffer_store_dwordx4 v[160:163], v242, s[12:15], 0 offen sc1
    v_add_u32 v242, 1048576, v242
    s_waitcnt lgkmcnt(3)
    v_mfma_f32_16x16x32_bf16 v[16:19], v[104:107], v[200:203], v[16:19]
    ds_read_b128 v[120:123], v241 offset:9344
    v_mfma_f32_16x16x32_bf16 v[20:23], v[104:107], v[216:219], v[20:23]
    s_waitcnt lgkmcnt(3)
    v_mfma_f32_16x16x32_bf16 v[16:19], v[108:111], v[204:207], v[16:19]
    ds_read_b128 v[124:127], v241 offset:9408
    v_mfma_f32_16x16x32_bf16 v[20:23], v[108:111], v[220:223], v[20:23]
    s_waitcnt lgkmcnt(3)
    v_mfma_f32_16x16x32_bf16 v[24:27], v[112:115], v[192:195], 0
    ds_read_b128 v[128:131], v241 offset:13824
    v_mfma_f32_16x16x32_bf16 v[28:31], v[112:115], v[208:211], 0
    s_waitcnt lgkmcnt(3)
    v_mfma_f32_16x16x32_bf16 v[24:27], v[116:119], v[196:199], v[24:27]
    ds_read_b128 v[132:135], v241 offset:13888
    v_mfma_f32_16x16x32_bf16 v[28:31], v[116:119], v[212:215], v[28:31]
    v_cvt_pk_bf16_f32 v164, v16, v17
    v_cvt_pk_bf16_f32 v165, v18, v19
    v_cvt_pk_bf16_f32 v166, v20, v21
    v_cvt_pk_bf16_f32 v167, v22, v23
    buffer_store_dwordx4 v[164:167], v242, s[12:15], 0 offen sc1
    v_add_u32 v242, 1048576, v242
    s_waitcnt lgkmcnt(3)
    v_mfma_f32_16x16x32_bf16 v[24:27], v[120:123], v[200:203], v[24:27]
    ds_read_b128 v[136:139], v241 offset:13952
    v_mfma_f32_16x16x32_bf16 v[28:31], v[120:123], v[216:219], v[28:31]
    s_waitcnt lgkmcnt(3)
    v_mfma_f32_16x16x32_bf16 v[24:27], v[124:127], v[204:207], v[24:27]
    ds_read_b128 v[140:143], v241 offset:14016
    v_mfma_f32_16x16x32_bf16 v[28:31], v[124:127], v[220:223], v[28:31]
    s_waitcnt lgkmcnt(3)
    v_mfma_f32_16x16x32_bf16 v[32:35], v[128:131], v[192:195], 0
    ds_read_b128 v[144:147], v241 offset:18432
    v_mfma_f32_16x16x32_bf16 v[36:39], v[128:131], v[208:211], 0
    s_waitcnt lgkmcnt(3)
    v_mfma_f32_16x16x32_bf16 v[32:35], v[132:135], v[196:199], v[32:35]
    ds_read_b128 v[148:151], v241 offset:18496
    v_mfma_f32_16x16x32_bf16 v[36:39], v[132:135], v[212:215], v[36:39]
    v_cvt_pk_bf16_f32 v168, v24, v25
    v_cvt_pk_bf16_f32 v169, v26, v27
    v_cvt_pk_bf16_f32 v170, v28, v29
    v_cvt_pk_bf16_f32 v171, v30, v31
    buffer_store_dwordx4 v[168:171], v242, s[12:15], 0 offen sc1
    v_add_u32 v242, 1048576, v242
    s_waitcnt lgkmcnt(3)
    v_mfma_f32_16x16x32_bf16 v[32:35], v[136:139], v[200:203], v[32:35]
    ds_read_b128 v[152:155], v241 offset:18560
    v_mfma_f32_16x16x32_bf16 v[36:39], v[136:139], v[216:219], v[36:39]
    s_waitcnt lgkmcnt(3)
    v_mfma_f32_16x16x32_bf16 v[32:35], v[140:143], v[204:207], v[32:35]
    ds_read_b128 v[156:159], v241 offset:18624
    v_mfma_f32_16x16x32_bf16 v[36:39], v[140:143], v[220:223], v[36:39]
    s_waitcnt lgkmcnt(3)
    v_mfma_f32_16x16x32_bf16 v[40:43], v[144:147], v[192:195], 0
    v_mfma_f32_16x16x32_bf16 v[44:47], v[144:147], v[208:211], 0
    s_waitcnt lgkmcnt(2)
    v_mfma_f32_16x16x32_bf16 v[40:43], v[148:151], v[196:199], v[40:43]
    v_mfma_f32_16x16x32_bf16 v[44:47], v[148:151], v[212:215], v[44:47]
    s_waitcnt lgkmcnt(1)
    v_mfma_f32_16x16x32_bf16 v[40:43], v[152:155], v[200:203], v[40:43]
    v_mfma_f32_16x16x32_bf16 v[44:47], v[152:155], v[216:219], v[44:47]
    v_cvt_pk_bf16_f32 v172, v32, v33
    v_cvt_pk_bf16_f32 v173, v34, v35
    v_cvt_pk_bf16_f32 v174, v36, v37
    v_cvt_pk_bf16_f32 v175, v38, v39
    buffer_store_dwordx4 v[172:175], v242, s[12:15], 0 offen sc1
    v_add_u32 v242, 1048576, v242
    s_waitcnt lgkmcnt(0)
    v_mfma_f32_16x16x32_bf16 v[40:43], v[156:159], v[204:207], v[40:43]
    v_mfma_f32_16x16x32_bf16 v[44:47], v[156:159], v[220:223], v[44:47]
    s_nop 7
    v_cvt_pk_bf16_f32 v160, v40, v41
    v_cvt_pk_bf16_f32 v161, v42, v43
    v_cvt_pk_bf16_f32 v162, v44, v45
    v_cvt_pk_bf16_f32 v163, v46, v47
    buffer_store_dwordx4 v[160:163], v242, s[12:15], 0 offen sc1
L_end:
    s_endpgm
.section .rodata,"a"
.p2align 6
.amdhsa_kernel standalone__tensor_product_equiv_tfn__graph_kernel
.amdhsa_next_free_vgpr 250
.amdhsa_next_free_sgpr 100
.amdhsa_accum_offset 252
.amdhsa_group_segment_fixed_size 0
.amdhsa_kernarg_size 88
.amdhsa_user_sgpr_count 2
.amdhsa_user_sgpr_kernarg_segment_ptr 1
.amdhsa_system_sgpr_workgroup_id_x 1
.amdhsa_float_denorm_mode_32 3
.end_amdhsa_kernel
```

```asm
; @launch grid=(256,1,1) block=(512,1,1) lds=161808
.amdgcn_target "amdgcn-amd-amdhsa--gfx950"
.text
.globl standalone__tensor_product_equiv_tfn__graph_kernel
.p2align 8
.type standalone__tensor_product_equiv_tfn__graph_kernel,@function
standalone__tensor_product_equiv_tfn__graph_kernel:
    s_cmp_ge_u32 s2, 256
    s_cbranch_scc1 L_end
    s_load_dwordx16 s[36:51], s[0:1], 0
    s_load_dwordx2 s[52:53], s[0:1], 64
    s_load_dwordx2 s[56:57], s[0:1], 80
    v_lshrrev_b32 v2, 6, v0
    v_and_b32 v1, 63, v0
    v_readfirstlane_b32 s16, v2
    s_and_b32 s17, s2, 7
    s_lshl_b32 s17, s17, 5
    s_lshr_b32 s26, s2, 3
    s_or_b32 s17, s17, s26
    v_lshlrev_b32 v7, 3, v0
    v_mov_b32 v2, 0
    v_mov_b32 v3, 0
    v_mov_b32 v4, 161792
    ds_write_b64 v7, v[2:3]
    ds_write_b32 v4, v2
    v_lshlrev_b32 v232, 4, v1
    s_mul_i32 s26, s16, 160
    v_add_u32 v6, s26, v1
    v_lshlrev_b32 v53, 2, v6
    v_lshlrev_b32 v54, 3, v6
    s_mul_i32 s26, s16, 1920
    v_add_u32 v55, s26, v232
    s_mul_i32 s26, s16, 5120
    v_add_u32 v56, s26, v232
    s_cmp_lt_u32 s16, 7
    s_cselect_b32 s60, -1, 3
    s_mov_b32 s61, 0
    s_cselect_b64 s[62:63], -1, 15
    s_cselect_b32 s34, -1, 0xff
    s_cselect_b32 s35, 0xffffff, s34
    s_mul_i32 s58, s17, 5000
    s_mul_i32 s59, s17, 10000
    s_lshl_b32 s29, s17, 6
    s_add_u32 s29, s29, 14417920
    s_waitcnt lgkmcnt(0)
    s_mov_b32 s64, s40
    s_mov_b32 s65, s41
    s_mov_b32 s66, 1280000
    s_mov_b32 s67, 0x00020000
    buffer_load_dword v144, v53, s[64:67], s58 offen offset:0
    buffer_load_dword v145, v53, s[64:67], s58 offen offset:256
    s_mov_b64 exec, s[60:61]
    buffer_load_dword v146, v53, s[64:67], s58 offen offset:512
    s_mov_b64 exec, -1
    s_getpc_b64 s[82:83]
L_pc:
    s_lshr_b32 s80, s2, 3
    s_lshl_b32 s80, s80, 3
    s_add_u32 s80, s80, s16
    s_lshl_b32 s81, s80, 6
    s_min_u32 s81, s81, L_end-L_pc
    s_load_dword s3, s[82:83], s81
    s_lshl_b32 s81, s80, 7
    s_load_dword s3, s[50:51], s81
    s_add_u32 s81, s81, 64
    s_load_dword s3, s[50:51], s81
    s_mov_b32 s68, s38
    s_mov_b32 s69, s39
    s_mov_b32 s70, 1280000
    s_mov_b32 s71, 0x00020000
    buffer_load_dword v147, v53, s[68:71], s58 offen offset:0
    buffer_load_dword v148, v53, s[68:71], s58 offen offset:256
    s_mov_b64 exec, s[60:61]
    buffer_load_dword v149, v53, s[68:71], s58 offen offset:512
    s_mov_b64 exec, -1
    s_mov_b32 s72, s42
    s_mov_b32 s73, s43
    s_mov_b32 s74, 2560000
    s_mov_b32 s75, 0x00020000
    buffer_load_dwordx2 v[152:153], v54, s[72:75], s59 offen offset:0
    buffer_load_dwordx2 v[156:157], v54, s[72:75], s59 offen offset:512
    s_mov_b64 exec, s[60:61]
    buffer_load_dwordx2 v[160:161], v54, s[72:75], s59 offen offset:1024
    s_mov_b64 exec, -1
    s_mov_b32 s8, s56
    s_mov_b32 s9, s57
    s_mov_b32 s10, 16777216
    s_mov_b32 s11, 0x00020000
    s_mov_b32 s76, s44
    s_mov_b32 s77, s45
    s_mov_b32 s78, 10240000
    s_mov_b32 s79, 0x00020000
    s_barrier
    s_add_u32 m0, s26, 61440
    s_mul_i32 s58, s17, 40000
    buffer_load_dwordx4 v56, s[76:79], s58 offen offset:0  lds
    buffer_load_dwordx4 v56, s[76:79], s58 offen offset:1024  lds
    buffer_load_dwordx4 v56, s[76:79], s58 offen offset:2048  lds
    buffer_load_dwordx4 v56, s[76:79], s58 offen offset:3072  lds
    s_add_u32 m0, s26, 65536
    s_add_u32 s58, s58, 4096
    s_mov_b64 exec, s[62:63]
    buffer_load_dwordx4 v56, s[76:79], s58 offen  lds
    s_mov_b64 exec, -1
    v_mov_b32 v6, 1
    v_lshrrev_b32 v7, 2, v1
    v_mul_u32_u24 v7, 16320, v7
    v_add_u32 v245, v7, v232
    s_cmp_eq_u32 s16, 7
    s_cselect_b32 s59, s29, 0x40000000
    v_add_u32 v7, s59, v245
    buffer_load_dwordx4 v[64:67], v7, s[8:11], 0 offen sc1
    s_waitcnt vmcnt(12)
    v_bfe_u32 v2, v144, 3, 5
    v_and_b32 v3, 7, v144
    v_lshl_or_b32 v2, v3, 5, v2
    v_lshlrev_b32 v167, 2, v2
    ds_add_rtn_u32 v164, v167, v6 offset:3072
    v_bfe_u32 v2, v145, 3, 5
    v_and_b32 v3, 7, v145
    v_lshl_or_b32 v2, v3, 5, v2
    v_lshlrev_b32 v168, 2, v2
    ds_add_rtn_u32 v165, v168, v6 offset:3072
    s_mov_b64 exec, s[60:61]
    v_bfe_u32 v2, v146, 3, 5
    v_and_b32 v3, 7, v146
    v_lshl_or_b32 v2, v3, 5, v2
    v_lshlrev_b32 v169, 2, v2
    ds_add_rtn_u32 v166, v169, v6 offset:3072
    s_mov_b64 exec, -1
    s_movk_i32 s27, 5033
    s_waitcnt vmcnt(9)
    s_movk_i32 s27, 4797
    v_mov_b32 v5, 2352256
    s_movk_i32 s59, -1250
    v_bfe_u32 v3, v167, 7,3
    v_mad_i32_i24 v2, v3, s59, v147
    v_add_u32 v3, 10000, v2
    v_min_u32 v2, v2, v3
    v_mul_u32_u24 v3, 10922, v2
    v_mad_u32_u24 v2, v2, s27, v5
    v_min_u32 v2, v2, v3
    v_lshrrev_b32 v2, 22, v2
    v_lshrrev_b32 v3, 8, v144
    v_mad_u32_u24 v2, v3, 12, v2
    v_lshl_or_b32 v154, v147, 10, v2
    v_bfe_u32 v3, v168, 7,3
    v_mad_i32_i24 v2, v3, s59, v148
    v_add_u32 v3, 10000, v2
    v_min_u32 v2, v2, v3
    v_mul_u32_u24 v3, 10922, v2
    v_mad_u32_u24 v2, v2, s27, v5
    v_min_u32 v2, v2, v3
    v_lshrrev_b32 v2, 22, v2
    v_lshrrev_b32 v3, 8, v145
    v_mad_u32_u24 v2, v3, 12, v2
    v_lshl_or_b32 v158, v148, 10, v2
    v_bfe_u32 v3, v169, 7,3
    v_mad_i32_i24 v2, v3, s59, v149
    v_add_u32 v3, 10000, v2
    v_min_u32 v2, v2, v3
    v_mul_u32_u24 v3, 10922, v2
    v_mad_u32_u24 v2, v2, s27, v5
    v_min_u32 v2, v2, v3
    v_lshrrev_b32 v2, 22, v2
    v_lshrrev_b32 v3, 8, v146
    v_mad_u32_u24 v2, v3, 12, v2
    v_lshl_or_b32 v162, v149, 10, v2
    s_waitcnt lgkmcnt(0)
    s_barrier
    ds_read_b128 v[172:175], v232 offset:3072
    s_waitcnt lgkmcnt(0)
    v_add_u32 v50, v172, v173
    v_add_u32 v51, v50, v174
    v_add_u32 v2, v51, v175
    v_mov_b32 v3, v2
    v_lshlrev_b32 v4, 2, v54
    v_lshrrev_b32 v5, 1, v0
    v_add_u32_dpp v3, v3, v3 row_shr:1 row_mask:0xf bank_mask:0xf
    s_lshr_b32 s59, s17, 4
    s_mul_i32 s59, s59, 16320
    v_add_u32_dpp v3, v3, v3 row_shr:2 row_mask:0xf bank_mask:0xf
    s_lshl2_add_u32 s59, s17, s59
    s_add_u32 s59, s59, 14417920
    v_add_u32_dpp v3, v3, v3 row_shr:4 row_mask:0xf bank_mask:0xf
    v_lshl_add_u32 v58, v5, 6, s59
    s_nop 0
    v_add_u32_dpp v3, v3, v3 row_shr:8 row_mask:0xf bank_mask:0xf
    s_nop 1
    v_add_u32_dpp v3, v3, v3 row_bcast:15 row_mask:0xa bank_mask:0xf
    s_nop 1
    v_add_u32_dpp v3, v3, v3 row_bcast:31 row_mask:0xc bank_mask:0xf
    v_sub_u32 v48, v3, v2
    v_add_u32 v49, v48, v172
    v_add_u32 v50, v48, v50
    v_add_u32 v51, v48, v51
    ds_write_b128 v232, v[48:51] offset:10752
    ds_read_b32 v167, v167 offset:10752
    ds_read_b32 v168, v168 offset:10752
    s_mov_b64 exec, s[60:61]
    ds_read_b32 v169, v169 offset:10752
    s_mov_b64 exec, -1
    v_lshl_or_b32 v60, v172, 16, v48
    v_lshl_or_b32 v61, v173, 16, v49
    v_lshl_or_b32 v62, v174, 16, v50
    v_lshl_or_b32 v63, v175, 16, v51
    s_mov_b32 s27, 46080
    s_waitcnt vmcnt(6) lgkmcnt(0)
    v_add_lshl_u32 v2, v167, v164, 1
    v_add_u32 v3, 0, v4
    ds_write_b16 v2, v3 offset:8192
    v_mad_u32_u24 v2, v2, 6, s27
    ds_write2_b32 v2, v152, v153 offset0:0 offset1:1
    ds_write_b32 v2, v154 offset:8
    v_add_lshl_u32 v2, v168, v165, 1
    v_add_u32 v3, 2048, v4
    ds_write_b16 v2, v3 offset:8192
    v_mad_u32_u24 v2, v2, 6, s27
    ds_write2_b32 v2, v156, v157 offset0:0 offset1:1
    ds_write_b32 v2, v158 offset:8
    s_mov_b64 exec, s[60:61]
    v_add_lshl_u32 v2, v169, v166, 1
    v_add_u32 v3, 4096, v4
    ds_write_b16 v2, v3 offset:8192
    v_mad_u32_u24 v2, v2, 6, s27
    ds_write2_b32 v2, v160, v161 offset0:0 offset1:1
    ds_write_b32 v2, v162 offset:8
    s_mov_b64 exec, -1
    v_lshrrev_b32 v2, 4, v56
    v_and_b32 v2, 0xffe, v2
    v_and_b32 v5, 1, v1
    v_lshlrev_b32 v5, 4, v5
    s_waitcnt lgkmcnt(0)
    s_barrier
    buffer_load_dword v59, v58, s[8:11], 0 offen sc1
    s_mov_b32 s68, s46
    s_mov_b32 s69, s47
    s_mov_b32 s70, 4096
    s_mov_b32 s71, 0x00020000
    s_mov_b32 s64, s48
    s_mov_b32 s65, s49
    s_mov_b32 s66, 128
    s_mov_b32 s67, 0x00020000
    v_lshlrev_b32 v7, 1, v1
    s_lshl_b32 s58, s16, 9
    s_add_u32 m0, s58, 16384
    s_mov_b32 exec_hi, 0
    buffer_load_dwordx4 v232, s[68:71], s58 offen lds
    s_mov_b32 exec_hi, -1
    buffer_load_ushort v57, v7, s[64:67], 0 offen
    ds_read_b128 v[152:155], v55 offset:46080
    ds_read_b128 v[156:159], v55 offset:47104
    ds_read_u16 v164, v2 offset:8192
    ds_read_u16 v165, v2 offset:8256
    ds_read_u16 v166, v2 offset:8320
    ds_read_u16 v167, v2 offset:8384
    ds_read_u16 v168, v2 offset:8448
    s_mov_b32 s4, s36
    s_mov_b32 s5, s37
    s_mov_b32 s6, 10240000
    s_mov_b32 s7, 0x00020000
    s_mov_b32 s12, s52
    s_mov_b32 s13, s53
    s_mov_b32 s14, 10240000
    s_mov_b32 s15, 0x00020000
    s_mov_b32 s20, 0x0f0f0f0f
    s_mov_b32 s21, 0x0f0f0f0f
    s_mov_b32 s22, 0xf0f0f0f0
    s_mov_b32 s23, 0xf0f0f0f0
    s_mov_b32 s31, 0xfffffc00
    s_mov_b32 s32, 0x9c4028
    s_mov_b32 s33, 0xffe0
    s_mov_b32 s24, 0
    s_mov_b32 s25, 0
    v_mov_b32 v8, 0
    v_mov_b32 v9, 0
    v_mov_b32 v10, 0
    v_mov_b32 v11, 0
    v_mov_b32 v12, 0
    v_mov_b32 v13, 0
    v_mov_b32 v14, 0
    v_mov_b32 v15, 0
    v_mov_b32 v16, 0
    v_mov_b32 v17, 0
    v_mov_b32 v18, 0
    v_mov_b32 v19, 0
    v_mov_b32 v20, 0
    v_mov_b32 v21, 0
    v_mov_b32 v22, 0
    v_mov_b32 v23, 0
    v_mov_b32 v24, 0
    v_mov_b32 v25, 0
    v_mov_b32 v26, 0
    v_mov_b32 v27, 0
    v_mov_b32 v28, 0
    v_mov_b32 v29, 0
    v_mov_b32 v30, 0
    v_mov_b32 v31, 0
    v_mov_b32 v32, 0
    v_mov_b32 v33, 0
    v_mov_b32 v34, 0
    v_mov_b32 v35, 0
    v_mov_b32 v36, 0
    v_mov_b32 v37, 0
    v_mov_b32 v38, 0
    v_mov_b32 v39, 0
    v_mov_b32 v40, 0
    v_mov_b32 v41, 0
    v_mov_b32 v42, 0
    v_mov_b32 v43, 0
    v_mov_b32 v44, 0
    v_mov_b32 v45, 0
    v_mov_b32 v46, 0
    v_mov_b32 v47, 0
    v_mov_b32 v192, 0
    v_mov_b32 v193, 0
    v_mov_b32 v194, 0
    v_mov_b32 v195, 0
    v_mov_b32 v196, 0
    v_mov_b32 v197, 0
    v_mov_b32 v198, 0
    v_mov_b32 v199, 0
    v_mov_b32 v112, 0
    v_mov_b32 v238, 0
    s_cmp_lt_u32 s2, 16
    s_cbranch_scc1 L_map40
    v_writelane_b32 v112, 0, 0
    v_writelane_b32 v112, 5, 1
    v_writelane_b32 v112, 6, 2
    v_writelane_b32 v112, 3, 3
    v_writelane_b32 v112, 8, 4
    v_writelane_b32 v112, 7, 5
    v_writelane_b32 v112, 2, 6
    v_writelane_b32 v112, 4, 7
    v_writelane_b32 v112, 1, 8
    v_writelane_b32 v112, 16, 9
    v_writelane_b32 v112, 10, 10
    v_writelane_b32 v112, 15, 11
    v_writelane_b32 v112, 9, 12
    v_writelane_b32 v112, 24, 13
    v_writelane_b32 v112, 14, 14
    v_writelane_b32 v112, 11, 15
    v_writelane_b32 v112, 13, 16
    v_writelane_b32 v112, 12, 17
    v_writelane_b32 v112, 17, 18
    v_writelane_b32 v112, 23, 19
    v_writelane_b32 v112, 20, 20
    v_writelane_b32 v112, 22, 21
    v_writelane_b32 v112, 19, 22
    v_writelane_b32 v112, 18, 23
    v_writelane_b32 v112, 21, 24
    v_writelane_b32 v112, 28, 25
    v_writelane_b32 v112, 29, 26
    v_writelane_b32 v112, 31, 27
    v_writelane_b32 v112, 26, 28
    v_writelane_b32 v112, 25, 29
    v_writelane_b32 v112, 27, 30
    v_writelane_b32 v112, 30, 31
    v_writelane_b32 v112, 36, 32
    v_writelane_b32 v112, 33, 33
    v_writelane_b32 v112, 35, 34
    v_writelane_b32 v112, 34, 35
    v_writelane_b32 v112, 38, 36
    v_writelane_b32 v112, 39, 37
    v_writelane_b32 v112, 37, 38
    v_writelane_b32 v112, 32, 39
    s_branch L_mapd
L_map40:
    v_writelane_b32 v112, 7, 0
    v_writelane_b32 v112, 0, 1
    v_writelane_b32 v112, 5, 2
    v_writelane_b32 v112, 2, 3
    v_writelane_b32 v112, 4, 4
    v_writelane_b32 v112, 3, 5
    v_writelane_b32 v112, 1, 6
    v_writelane_b32 v112, 6, 7
    v_writelane_b32 v112, 12, 8
    v_writelane_b32 v112, 9, 9
    v_writelane_b32 v112, 14, 10
    v_writelane_b32 v112, 11, 11
    v_writelane_b32 v112, 15, 12
    v_writelane_b32 v112, 10, 13
    v_writelane_b32 v112, 8, 14
    v_writelane_b32 v112, 13, 15
    v_writelane_b32 v112, 21, 16
    v_writelane_b32 v112, 22, 17
    v_writelane_b32 v112, 19, 18
    v_writelane_b32 v112, 16, 19
    v_writelane_b32 v112, 23, 20
    v_writelane_b32 v112, 17, 21
    v_writelane_b32 v112, 18, 22
    v_writelane_b32 v112, 20, 23
    v_writelane_b32 v112, 26, 24
    v_writelane_b32 v112, 29, 25
    v_writelane_b32 v112, 27, 26
    v_writelane_b32 v112, 25, 27
    v_writelane_b32 v112, 28, 28
    v_writelane_b32 v112, 30, 29
    v_writelane_b32 v112, 24, 30
    v_writelane_b32 v112, 31, 31
    v_writelane_b32 v112, 38, 32
    v_writelane_b32 v112, 33, 33
    v_writelane_b32 v112, 36, 34
    v_writelane_b32 v112, 35, 35
    v_writelane_b32 v112, 34, 36
    v_writelane_b32 v112, 32, 37
    v_writelane_b32 v112, 37, 38
    v_writelane_b32 v112, 39, 39
L_mapd:
    v_and_b32 v2, 3, v1
    v_lshrrev_b32 v3, 2, v1
    v_lshl_add_u32 v234, v2, 4, v3
    v_lshrrev_b32 v2, 5, v1
    v_lshlrev_b32 v233, 4, v2
    s_mul_i32 s26, s16, 5
    v_add_u32 v113, s26, v1
    v_subrev_u32 v3, 40, v113
    v_min_u32 v113, v113, v3
    v_mul_u32_u24 v3, 205, v1
    v_lshrrev_b32 v3, 10, v3
    v_mul_u32_u24 v2, 5, v3
    v_sub_u32 v115, v1, v2
    v_lshlrev_b32 v114, 2, v3
    s_lshl_b32 s81, s16, 10
    s_add_u32 s81, s81, 8192
    s_mul_i32 s80, s16, 6912
    v_lshl_add_u32 v121, v1, 2, s81
    v_lshrrev_b32 v3, 1, v1
    v_lshl_add_u32 v122, v3, 2, s81
    v_and_b32 v2, 1, v1
    v_lshlrev_b32 v123, 4, v2
    v_lshrrev_b32 v3, 1, v0
    v_mul_u32_u24 v3, 1280, v3
    v_add_u32 v124, v3, v2
    v_mul_u32_u24 v125, 48, v113
    s_lshl_b32 s26, s16, 2
    v_lshl_add_u32 v126, v115, 5, s26
    v_lshl_add_u32 v127, v1, 5, s80
    s_cmp_eq_u32 s16, 7
    s_cselect_b32 s54, 0, 1
    s_lshr_b32 s26, s17, 5
    s_mul_i32 s26, s26, 1218
    s_add_u32 s26, s26, s17
    s_lshl3_add_u32 s26, s26, s16
    s_lshl_b32 s26, s26, 7
    v_lshl_add_u32 v120, v1, 15, s26
    s_and_b32 s26, s16, 3
    s_lshl_b32 s58, s26, 9
    s_add_u32 s58, s58, 129024
    v_lshrrev_b32 v3, 4, v1
    v_mul_u32_u24 v2, 1792, v3
    v_add3_u32 v240, v2, s58, v232
    s_lshr_b32 s58, s16, 2
    v_and_b32 v2, 15, v1
    v_mul_u32_u24 v241, 288, v2
    v_lshl_add_u32 v241, v3, 4, v241
    s_mul_i32 s59, s58, 23040
    v_add_u32 v241, s59, v241
    v_lshlrev_b32 v242, 18, v3
    v_lshl_add_u32 v242, v2, 4, v242
    s_mul_i32 s58, s58, 5242880
    s_lshl_b32 s59, s2, 10
    s_add_u32 s58, s58, s59
    s_lshl_b32 s59, s26, 8
    s_add_u32 s58, s58, s59
    v_add_u32 v242, s58, v242
    v_mov_b32 v244, 161792
    s_mov_b32 s72, s50
    s_mov_b32 s73, s51
    s_mov_b32 s74, 32768
    s_mov_b32 s75, 0x00020000
    s_waitcnt lgkmcnt(0)
    v_or_b32 v164, v164, v5
    v_or_b32 v165, v165, v5
    v_or_b32 v166, v166, v5
    v_or_b32 v167, v167, v5
    v_or_b32 v168, v168, v5
    s_mul_i32 s27, s17, 15360
    s_add_u32 s27, s27, 10485760
    s_mul_i32 s58, s17, 40960
    s_add_u32 s59, s58, 4096
    s_waitcnt vmcnt(4)
    s_barrier
    ds_read_b128 v[80:83], v164 offset:61440
    ds_read_b128 v[84:87], v165 offset:61440
    ds_read_b128 v[88:91], v166 offset:61440
    ds_read_b128 v[92:95], v167 offset:61440
    s_mov_b64 exec, s[62:63]
    ds_read_b128 v[96:99], v168 offset:61440
    s_mov_b64 exec, -1
    s_waitcnt vmcnt(2)
    buffer_store_dwordx4 v[152:155], v55, s[8:11], s27 offen sc1
    s_mov_b32 exec_hi, s35
    buffer_store_dwordx4 v[156:159], v55, s[8:11], s27 offen offset:1024 sc1
    s_mov_b32 exec_hi, -1
    s_waitcnt lgkmcnt(4)
    buffer_store_dwordx4 v[80:83], v56, s[8:11], s58 offen offset:0 sc1
    s_waitcnt lgkmcnt(3)
    buffer_store_dwordx4 v[84:87], v56, s[8:11], s58 offen offset:1024 sc1
    s_waitcnt lgkmcnt(2)
    buffer_store_dwordx4 v[88:91], v56, s[8:11], s58 offen offset:2048 sc1
    s_waitcnt lgkmcnt(1)
    buffer_store_dwordx4 v[92:95], v56, s[8:11], s58 offen offset:3072 sc1
    s_mov_b32 exec_lo, s34
    s_mov_b32 exec_hi, s63
    s_waitcnt lgkmcnt(0)
    buffer_store_dwordx4 v[96:99], v56, s[8:11], s59 offen offset:0 sc1
    s_mov_b64 exec, -1
    s_mov_b32 s30, 400000
    s_mov_b32 s53, s29
    s_mov_b32 s59, 0xc0000000
    s_waitcnt vmcnt(7)
    v_and_or_b32 v60, v64, s59, v60
    v_xor_b32 v246, 0x40000000, v60
    v_xor_b32 v60, 0x80000000, v60
    v_and_or_b32 v61, v65, s59, v61
    v_xor_b32 v247, 0x40000000, v61
    v_xor_b32 v61, 0x80000000, v61
    v_and_or_b32 v62, v66, s59, v62
    v_xor_b32 v248, 0x40000000, v62
    v_xor_b32 v62, 0x80000000, v62
    v_and_or_b32 v63, v67, s59, v63
    v_xor_b32 v249, 0x40000000, v63
    v_xor_b32 v63, 0x80000000, v63
    v_and_b32 v2, 0x30, v1
    v_and_b32 v3, 3, v1
    v_lshl_add_u32 v2, v3, 2, v2
    v_bfe_u32 v7, v1, 2, 2
    v_add_lshl_u32 v2, v2, v7, 1
    ds_write_b16 v2, v57 offset:6656
    v_lshlrev_b32 v3, 3, v3
    ds_read_b64 v[216:217], v3 offset:6656
    ds_read_b64 v[218:219], v3 offset:6688
    ds_read_b64 v[220:221], v3 offset:6720
    ds_read_b64 v[222:223], v3 offset:6752
    s_lshl_b32 s58, s16, 12
    s_add_u32 m0, s58, 129024
    s_cmp_eq_u32 s16, 7
    s_waitcnt vmcnt(0) lgkmcnt(0)
    s_barrier
    s_cbranch_scc0 L_nrow2
    buffer_store_dwordx4 v[60:63], v245, s[8:11], s29 offen sc1
L_nrow2:
    s_barrier
    buffer_load_dwordx4 v232, s[72:75], s58 offen offset:0 lds
    buffer_load_dwordx4 v232, s[72:75], s58 offen offset:1024 lds
    buffer_load_dwordx4 v232, s[72:75], s58 offen offset:2048 lds
    buffer_load_dwordx4 v232, s[72:75], s58 offen offset:3072 lds
    v_and_b32 v3, 31, v1
    v_lshlrev_b32 v2, 7, v233
    v_lshl_add_u32 v2, v3, 2, v2
    v_add_u32 v3, 128, v2
    ds_read2st64_b32 v[144:145], v2 offset0:64 offset1:65
    ds_read2st64_b32 v[146:147], v2 offset0:66 offset1:67
    ds_read2st64_b32 v[148:149], v2 offset0:68 offset1:69
    ds_read2st64_b32 v[150:151], v2 offset0:70 offset1:71
    ds_read2st64_b32 v[152:153], v3 offset0:64 offset1:65
    ds_read2st64_b32 v[154:155], v3 offset0:66 offset1:67
    ds_read2st64_b32 v[156:157], v3 offset0:68 offset1:69
    ds_read2st64_b32 v[158:159], v3 offset0:70 offset1:71
    s_mov_b32 s56, 0xbfb8aa3b
    s_mov_b32 s57, 0xbfb8aa3b
    s_waitcnt lgkmcnt(7)
    v_lshlrev_b32 v160, 16, v144
    v_lshlrev_b32 v161, 16, v145
    v_and_b32 v162, 0xffff0000, v144
    v_and_b32 v163, 0xffff0000, v145
    v_pk_mul_f32 v[160:161], v[160:161], s[56:57]
    v_pk_mul_f32 v[162:163], v[162:163], s[56:57]
    v_cvt_pk_bf16_f32 v200, v160, v161
    v_cvt_pk_bf16_f32 v204, v162, v163
    s_waitcnt lgkmcnt(6)
    v_lshlrev_b32 v160, 16, v146
    v_lshlrev_b32 v161, 16, v147
    v_and_b32 v162, 0xffff0000, v146
    v_and_b32 v163, 0xffff0000, v147
    v_pk_mul_f32 v[160:161], v[160:161], s[56:57]
    v_pk_mul_f32 v[162:163], v[162:163], s[56:57]
    v_cvt_pk_bf16_f32 v201, v160, v161
    v_cvt_pk_bf16_f32 v205, v162, v163
    s_waitcnt lgkmcnt(5)
    v_lshlrev_b32 v160, 16, v148
    v_lshlrev_b32 v161, 16, v149
    v_and_b32 v162, 0xffff0000, v148
    v_and_b32 v163, 0xffff0000, v149
    v_pk_mul_f32 v[160:161], v[160:161], s[56:57]
    v_pk_mul_f32 v[162:163], v[162:163], s[56:57]
    v_cvt_pk_bf16_f32 v202, v160, v161
    v_cvt_pk_bf16_f32 v206, v162, v163
    s_waitcnt lgkmcnt(4)
    v_lshlrev_b32 v160, 16, v150
    v_lshlrev_b32 v161, 16, v151
    v_and_b32 v162, 0xffff0000, v150
    v_and_b32 v163, 0xffff0000, v151
    v_pk_mul_f32 v[160:161], v[160:161], s[56:57]
    v_pk_mul_f32 v[162:163], v[162:163], s[56:57]
    v_cvt_pk_bf16_f32 v203, v160, v161
    v_cvt_pk_bf16_f32 v207, v162, v163
    s_waitcnt lgkmcnt(3)
    v_lshlrev_b32 v160, 16, v152
    v_lshlrev_b32 v161, 16, v153
    v_and_b32 v162, 0xffff0000, v152
    v_and_b32 v163, 0xffff0000, v153
    v_pk_mul_f32 v[160:161], v[160:161], s[56:57]
    v_pk_mul_f32 v[162:163], v[162:163], s[56:57]
    v_cvt_pk_bf16_f32 v208, v160, v161
    v_cvt_pk_bf16_f32 v212, v162, v163
    s_waitcnt lgkmcnt(2)
    v_lshlrev_b32 v160, 16, v154
    v_lshlrev_b32 v161, 16, v155
    v_and_b32 v162, 0xffff0000, v154
    v_and_b32 v163, 0xffff0000, v155
    v_pk_mul_f32 v[160:161], v[160:161], s[56:57]
    v_pk_mul_f32 v[162:163], v[162:163], s[56:57]
    v_cvt_pk_bf16_f32 v209, v160, v161
    v_cvt_pk_bf16_f32 v213, v162, v163
    s_waitcnt lgkmcnt(1)
    v_lshlrev_b32 v160, 16, v156
    v_lshlrev_b32 v161, 16, v157
    v_and_b32 v162, 0xffff0000, v156
    v_and_b32 v163, 0xffff0000, v157
    v_pk_mul_f32 v[160:161], v[160:161], s[56:57]
    v_pk_mul_f32 v[162:163], v[162:163], s[56:57]
    v_cvt_pk_bf16_f32 v210, v160, v161
    v_cvt_pk_bf16_f32 v214, v162, v163
    s_waitcnt lgkmcnt(0)
    v_lshlrev_b32 v160, 16, v158
    v_lshlrev_b32 v161, 16, v159
    v_and_b32 v162, 0xffff0000, v158
    v_and_b32 v163, 0xffff0000, v159
    v_pk_mul_f32 v[160:161], v[160:161], s[56:57]
    v_pk_mul_f32 v[162:163], v[162:163], s[56:57]
    v_cvt_pk_bf16_f32 v211, v160, v161
    v_cvt_pk_bf16_f32 v215, v162, v163
    v_mov_b32 v80, 0xffffff
    v_mov_b32 v81, 0xffffff
    v_mov_b32 v82, 0xffffff
    v_mov_b32 v83, 0xffffff
    v_add_u32 v2, s81, v232
    ds_write_b128 v2, v[80:83]
    v_and_b32 v7, 1, v1
L_pa:
    buffer_load_dword v6, v58, s[8:11], 0 offen sc1
    s_waitcnt vmcnt(0)
L_pw:
    v_xor_b32 v144, v6, v59
    v_cmpx_gt_u32 vcc, 0x40000000, v144
    s_cbranch_execz L_pda
    s_sub_u32 s30, s30, 1
    s_cbranch_scc0 L_pa
    s_endpgm
L_exp_more:
    v_add_u32 v6, 48, v6
    v_subrev_u32 v4, 12, v4
    s_branch L_exp
L_pda:
    s_mov_b64 exec, -1
    v_bfe_u32 v236, v6, 16, 11
    v_and_b32 v5, 0xffff, v6
    v_sub_u32 v2, v236, v7
    v_add_u32_dpp v236, v236, v236 row_shr:2 row_mask:0xf bank_mask:0xf
    v_add_u32 v5, v5, v124
    s_nop 0
    v_add_u32_dpp v236, v236, v236 row_shr:4 row_mask:0xf bank_mask:0xf
    s_nop 1
    v_add_u32_dpp v236, v236, v236 row_shr:8 row_mask:0xf bank_mask:0xf
    s_nop 1
    v_add_u32_dpp v236, v236, v236 row_bcast:15 row_mask:0xa bank_mask:0xf
    s_nop 1
    v_add_u32_dpp v236, v236, v236 row_bcast:31 row_mask:0xc bank_mask:0xf
    v_sub_u32 v3, v236, v2
    v_min_u32 v4, 216, v236
    v_lshl_add_u32 v6, v3, 2, s81
    v_sub_u32 v4, v4, v3
    v_sub_u32 v237, v5, v3
    v_sub_u32 v235, v3, v7
L_exp:
    v_cmpx_lt_i32 vcc, 0, v4
    ds_write_b32 v6, v5 offset:0
    v_add_u32 v5, 2, v5
    v_cmpx_lt_i32 vcc, 2, v4
    ds_write_b32 v6, v5 offset:8
    v_add_u32 v5, 2, v5
    v_cmpx_lt_i32 vcc, 4, v4
    ds_write_b32 v6, v5 offset:16
    v_add_u32 v5, 2, v5
    v_cmpx_lt_i32 vcc, 6, v4
    ds_write_b32 v6, v5 offset:24
    v_add_u32 v5, 2, v5
    v_cmpx_lt_i32 vcc, 8, v4
    ds_write_b32 v6, v5 offset:32
    v_add_u32 v5, 2, v5
    v_cmpx_lt_i32 vcc, 10, v4
    ds_write_b32 v6, v5 offset:40
    v_add_u32 v5, 2, v5
    v_cmpx_lt_i32 vcc, 12, v4
    s_cbranch_execnz L_exp_more
L_exp_done:
    s_mov_b64 exec, -1
    ds_read_b32 v99, v121 offset:768
    ds_read_b32 v98, v121 offset:512
    ds_read_b32 v97, v121 offset:256
    ds_read_b32 v96, v121 offset:0
    v_readlane_b32 s19, v236, 63
    s_mov_b32 s26, 10485760
    s_sub_i32 s28, s19, s24
    s_cmp_le_i32 s28, 192
    s_cbranch_scc1 L_sk3
    s_waitcnt lgkmcnt(3)
    v_mul_u32_u24 v99, 12, v99
    buffer_load_dwordx3 v[92:94], v99, s[8:11], s26 offen sc1
L_sk3:
    s_waitcnt lgkmcnt(2)
    v_mul_u32_u24 v98, 12, v98
    buffer_load_dwordx3 v[88:90], v98, s[8:11], s26 offen sc1
    s_waitcnt lgkmcnt(1)
    v_mul_u32_u24 v97, 12, v97
    buffer_load_dwordx3 v[84:86], v97, s[8:11], s26 offen sc1
    s_waitcnt lgkmcnt(0)
    v_mul_u32_u24 v96, 12, v96
    buffer_load_dwordx3 v[80:82], v96, s[8:11], s26 offen sc1
    ds_read_b32 v100, v122 offset:0
    ds_read_b32 v101, v122 offset:128
    ds_read_b32 v102, v122 offset:256
    ds_read_b32 v103, v122 offset:384
    ds_read_b32 v104, v122 offset:512
    ds_read_b32 v105, v122 offset:640
    ds_read_b32 v106, v122 offset:768
    s_max_i32 s28, s28, 0
    s_min_i32 s28, s28, 216
    s_barrier
    s_waitcnt lgkmcnt(6)
    v_lshl_or_b32 v100, v100, 5, v123
    s_add_u32 m0, s80, 46080
    s_cmp_le_u32 s28, 32
    buffer_load_dwordx4 v100, s[8:11], 0 offen sc1 lds
    s_waitcnt lgkmcnt(5)
    v_lshl_or_b32 v101, v101, 5, v123
    s_add_u32 m0, s80, 47104
    s_cmp_le_u32 s28, 64
    buffer_load_dwordx4 v101, s[8:11], 0 offen sc1 lds
    s_waitcnt lgkmcnt(0)
    v_lshl_or_b32 v102, v102, 5, v123
    v_lshl_or_b32 v103, v103, 5, v123
    v_lshl_or_b32 v104, v104, 5, v123
    v_lshl_or_b32 v105, v105, 5, v123
    v_lshl_or_b32 v106, v106, 5, v123
    s_sub_i32 s27, s28, 0
    v_cmp_gt_i32 s[36:37], s27, v1
    s_sub_i32 s27, s28, 64
    v_cmp_gt_i32 s[38:39], s27, v1
    s_sub_i32 s27, s28, 128
    v_cmp_gt_i32 s[40:41], s27, v1
    s_sub_i32 s27, s28, 192
    v_cmp_gt_i32 s[42:43], s27, v1
    v_mov_b32 v3, s19
    v_mov_b32 v4, 2048
    ds_max_u32 v4, v3
    v_mov_b32 v6, 1
    s_mov_b64 exec, 1
    ds_add_u32 v4, v3 offset:4
    s_mov_b64 exec, -1
    s_waitcnt vmcnt(5)
    s_mov_b64 exec, s[42:43]
    v_and_b32 v2, 0x3ff, v94
    v_lshlrev_b32 v95, 2, v2
    ds_add_rtn_u32 v111, v95, v6 offset:0
    s_waitcnt vmcnt(4)
    s_mov_b64 exec, s[40:41]
    v_and_b32 v2, 0x3ff, v90
    v_lshlrev_b32 v91, 2, v2
    ds_add_rtn_u32 v110, v91, v6 offset:0
    s_waitcnt vmcnt(3)
    s_mov_b64 exec, s[38:39]
    v_and_b32 v2, 0x3ff, v86
    v_lshlrev_b32 v87, 2, v2
    ds_add_rtn_u32 v109, v87, v6 offset:0
    s_waitcnt vmcnt(2)
    s_mov_b64 exec, s[36:37]
    v_and_b32 v2, 0x3ff, v82
    v_lshlrev_b32 v83, 2, v2
    ds_add_rtn_u32 v108, v83, v6 offset:0
    s_mov_b64 exec, -1
    s_waitcnt lgkmcnt(0)
    s_barrier
    ds_read_b128 v[148:151], v125 offset:0
    ds_read_b128 v[152:155], v125 offset:16
    ds_read_b128 v[156:159], v125 offset:32
    ds_read_b64 v[4:5], v4
    s_cmp_eq_u32 s24, s54
    s_cbranch_scc0 L_no2
    buffer_store_dwordx4 v[246:249], v245, s[8:11], s53 offen sc1
L_no2:
    s_cmp_le_u32 s28, 64
    s_cbranch_scc1 L_efd
    s_add_u32 m0, s80, 48128
    s_cmp_le_u32 s28, 96
    buffer_load_dwordx4 v102, s[8:11], 0 offen sc1 lds
    s_cbranch_scc1 L_efd
    s_add_u32 m0, s80, 49152
    s_cmp_le_u32 s28, 128
    buffer_load_dwordx4 v103, s[8:11], 0 offen sc1 lds
    s_cbranch_scc1 L_efd
    s_add_u32 m0, s80, 50176
    s_cmp_le_u32 s28, 160
    buffer_load_dwordx4 v104, s[8:11], 0 offen sc1 lds
    s_cbranch_scc1 L_efd
    s_add_u32 m0, s80, 51200
    s_cmp_le_u32 s28, 192
    buffer_load_dwordx4 v105, s[8:11], 0 offen sc1 lds
    s_cbranch_scc1 L_efd
    s_add_u32 m0, s80, 52224
    s_cmp_le_u32 s28, 224
    s_mov_b32 exec_hi, 0xffff
    buffer_load_dwordx4 v106, s[8:11], 0 offen sc1 lds
    s_mov_b32 exec_hi, -1
L_efd:
    v_cmp_gt_u32 vcc, 40, v1
    s_waitcnt lgkmcnt(0)
    v_readfirstlane_b32 s26, v4
    v_readfirstlane_b32 s27, v5
    v_add_u32 v3, v148, v149
    v_add3_u32 v3, v3, v150, v151
    v_add3_u32 v3, v3, v152, v153
    v_add3_u32 v3, v3, v154, v155
    v_add3_u32 v3, v3, v156, v157
    v_add3_u32 v3, v3, v158, v159
    v_lshl_or_b32 v3, v3, 6, v113
    v_cndmask_b32 v3, 0, v3, vcc
    s_max_u32 s25, s25, s26
    s_cmp_lg_u32 s24, 0
    s_cbranch_scc1 L_havepos
    v_readlane_b32 s64, v3, 0
    v_readlane_b32 s65, v3, 1
    v_readlane_b32 s66, v3, 2
    v_readlane_b32 s67, v3, 3
    v_readlane_b32 s68, v3, 4
    v_cmp_lt_u32 s[70:71], s64, v3
    v_cmp_lt_u32 s[72:73], s65, v3
    v_cmp_lt_u32 s[74:75], s66, v3
    v_cmp_lt_u32 s[76:77], s67, v3
    v_cmp_lt_u32 s[78:79], s68, v3
    s_bcnt1_i32_b64 s64, s[70:71]
    s_bcnt1_i32_b64 s65, s[72:73]
    s_bcnt1_i32_b64 s66, s[74:75]
    s_bcnt1_i32_b64 s67, s[76:77]
    s_bcnt1_i32_b64 s68, s[78:79]
    v_readlane_b32 s70, v112, s64
    v_readlane_b32 s71, v112, s65
    v_readlane_b32 s72, v112, s66
    v_readlane_b32 s73, v112, s67
    v_readlane_b32 s74, v112, s68
    v_writelane_b32 v238, s70, 0
    v_writelane_b32 v238, s71, 1
    v_writelane_b32 v238, s72, 2
    v_writelane_b32 v238, s73, 3
    v_writelane_b32 v238, s74, 4
    v_lshlrev_b32 v238, 2, v238
L_havepos:
    s_mov_b64 exec, 31
    ds_write_b32 v238, v3 offset:4096
    s_mov_b64 exec, -1
    v_lshlrev_b32 v4, 2, v1
    v_and_b32 v6, 7, v1
    v_cmp_gt_u32 s[34:35], s16, v6
    s_and_b64 s[34:35], s[34:35], vcc
    v_cmp_gt_u32 vcc, 60, v1
    s_cmp_gt_u32 s27, 1250
    s_cselect_b32 s26, 44, 0
    v_add_u32 v114, s26, v114
    v_subrev_u32 v2, 48, v114
    v_min_u32 v114, v114, v2
    s_waitcnt lgkmcnt(0)
    s_barrier
    ds_read_b32 v119, v126 offset:4096
    ds_read_b32 v4, v4 offset:4096
    s_waitcnt lgkmcnt(1)
    v_and_b32 v119, 63, v119
    v_mad_u32_u24 v3, v119, 48, v114
    ds_read_b32 v116, v3 offset:0
    s_waitcnt lgkmcnt(1)
    v_lshrrev_b32 v4, 6, v4
    v_cndmask_b32 v118, 0, v4, s[34:35]
    v_mul_u32_u24 v119, 1152, v119
    s_waitcnt lgkmcnt(0)
    v_cndmask_b32 v116, 0, v116, vcc
    v_mov_b32 v117, v116
    v_readlane_b32 s48, v119, 0
    v_readlane_b32 s49, v119, 1
    v_add_u32_dpp v117, v117, v117 row_shr:1 row_mask:0xf bank_mask:0xf
    v_add_u32_dpp v118, v118, v118 row_shr:1 row_mask:0xf bank_mask:0xf
    v_readlane_b32 s50, v119, 2
    v_add_u32_dpp v117, v117, v117 row_shr:2 row_mask:0xf bank_mask:0xf
    v_add_u32_dpp v118, v118, v118 row_shr:2 row_mask:0xf bank_mask:0xf
    v_readlane_b32 s51, v119, 3
    v_add_u32_dpp v117, v117, v117 row_shr:4 row_mask:0xf bank_mask:0xf
    v_add_u32_dpp v118, v118, v118 row_shr:4 row_mask:0xf bank_mask:0xf
    v_readlane_b32 s52, v119, 4
    v_add_u32_dpp v117, v117, v117 row_shr:8 row_mask:0xf bank_mask:0xf
    v_add_u32_dpp v118, v118, v118 row_shr:8 row_mask:0xf bank_mask:0xf
    v_lshlrev_b32 v4, 3, v115
    v_add_u32_dpp v117, v117, v117 row_bcast:15 row_mask:0xa bank_mask:0xf
    v_add_u32_dpp v118, v118, v118 row_bcast:15 row_mask:0xa bank_mask:0xf
    s_min_u32 s25, s25, 40000
    v_add_u32_dpp v117, v117, v117 row_bcast:31 row_mask:0xc bank_mask:0xf
    v_add_u32_dpp v118, v118, v118 row_bcast:31 row_mask:0xc bank_mask:0xf
    v_sub_u32 v116, v117, v116
    v_readlane_b32 s29, v118, 63
    v_readlane_b32 s18, v117, 63
    s_lshl_b32 s26, s29, 4
    s_add_u32 s26, s26, 101376
    v_lshl_add_u32 v116, v116, 4, s26
    v_lshl_or_b32 v116, v116, 10, v4
    s_mov_b64 exec, vcc
    ds_write_b32 v3, v116 offset:4608
    s_mov_b64 exec, -1
    s_min_u32 s18, s18, 1728
    v_lshl_add_u32 v230, v234, 4, s26
    v_and_b32 v2, 3, v1
    v_bfe_u32 v3, v1, 3, 2
    v_lshl_add_u32 v2, v3, 2, v2
    v_lshl_add_u32 v231, v2, 4, s26
    s_movk_i32 s27, 1023
    s_mov_b32 exec_lo, 0xfff
    s_mov_b32 exec_hi, 0x0
    buffer_load_dword v239, v120, s[4:7], 0 offen
    s_mov_b64 exec, -1
    s_waitcnt lgkmcnt(0)
    s_barrier
    s_mov_b64 exec, s[36:37]
    ds_read_b32 v96, v83 offset:4608
    s_mov_b64 exec, s[38:39]
    ds_read_b32 v97, v87 offset:4608
    s_mov_b64 exec, s[40:41]
    ds_read_b32 v98, v91 offset:4608
    s_mov_b64 exec, s[42:43]
    ds_read_b32 v99, v95 offset:4608
    s_mov_b64 exec, -1
    v_add_u32 v83, 0, v127
    v_add_u32 v87, 2048, v127
    v_add_u32 v91, 4096, v127
    v_add_u32 v95, 6144, v127
    s_waitcnt lgkmcnt(0)
    s_mov_b64 exec, s[36:37]
    v_bfi_b32 v82, s27, v96, v82
    v_lshrrev_b32 v96, 10, v96
    v_lshl_add_u32 v96, v108, 4, v96
    ds_write_b128 v96, v[80:83]
    s_mov_b64 exec, s[38:39]
    v_bfi_b32 v86, s27, v97, v86
    v_lshrrev_b32 v97, 10, v97
    v_lshl_add_u32 v97, v109, 4, v97
    ds_write_b128 v97, v[84:87]
    s_mov_b64 exec, s[40:41]
    v_bfi_b32 v90, s27, v98, v90
    v_lshrrev_b32 v98, 10, v98
    v_lshl_add_u32 v98, v110, 4, v98
    ds_write_b128 v98, v[88:91]
    s_mov_b64 exec, s[42:43]
    v_bfi_b32 v94, s27, v99, v94
    v_lshrrev_b32 v99, 10, v99
    v_lshl_add_u32 v99, v111, 4, v99
    ds_write_b128 v99, v[92:95]
    s_mov_b64 exec, -1
    v_cmp_gt_i32 vcc, s18, v234
    v_mov_b32 v4, s32
    s_waitcnt lgkmcnt(0)
    s_barrier
    ds_read_b128 v[224:227], v230
    ds_read_b32 v229, v231 offset:12
    ds_read_b32 v2, v231 offset:268
    s_mov_b32 s59, 101376
    s_waitcnt lgkmcnt(0)
    v_cndmask_b32 v228, v4, v226, vcc
    v_and_or_b32 v229, v229, s33, v233
    v_readlane_b32 s64, v228, 0
    v_readlane_b32 s65, v228, 4
    v_readlane_b32 s66, v228, 8
    v_readlane_b32 s67, v228, 12
    v_readlane_b32 s68, v228, 16
    v_readlane_b32 s69, v228, 20
    v_readlane_b32 s70, v228, 24
    v_readlane_b32 s71, v228, 28
    s_and_b32 s80, s64, s31
    buffer_load_dwordx4 v[48:51], v232, s[4:7], s80 offen
    s_and_b32 s81, s65, s31
    buffer_load_dwordx4 v[52:55], v232, s[4:7], s81 offen
    s_and_b32 s82, s66, s31
    buffer_load_dwordx4 v[56:59], v232, s[4:7], s82 offen
    s_and_b32 s83, s67, s31
    buffer_load_dwordx4 v[60:63], v232, s[4:7], s83 offen
    s_waitcnt vmcnt(5)
    s_barrier
    s_mov_b64 exec, s[20:21]
    ds_read_b128 v[192:195], v229 offset:46080
    s_mov_b64 exec, s[22:23]
    ds_read_b128 v[196:199], v229 offset:46080
    s_mov_b64 exec, -1
    v_and_or_b32 v229, v2, s33, v233
    s_waitcnt lgkmcnt(0)
    v_mfma_f32_32x32x16_bf16 v[80:95], v[192:195], v[200:203], 0
    v_mfma_f32_32x32x16_bf16 v[96:111], v[192:195], v[204:207], 0
    v_mfma_f32_32x32x16_bf16 v[80:95], v[196:199], v[208:211], v[80:95]
    v_mfma_f32_32x32x16_bf16 v[96:111], v[196:199], v[212:215], v[96:111]
    s_and_b32 s80, s68, s31
    buffer_load_dwordx4 v[64:67], v232, s[4:7], s80 offen
    s_and_b32 s81, s69, s31
    buffer_load_dwordx4 v[68:71], v232, s[4:7], s81 offen
    s_and_b32 s82, s70, s31
    buffer_load_dwordx4 v[72:75], v232, s[4:7], s82 offen
    s_and_b32 s83, s71, s31
    buffer_load_dwordx4 v[76:79], v232, s[4:7], s83 offen
    s_mov_b64 exec, s[20:21]
    ds_read_b128 v[192:195], v229 offset:46080
    s_mov_b64 exec, -1
    s_cmp_lg_u32 s24, 0
    s_cbranch_scc1 L_wdone
    v_lshrrev_b32 v7, 5, v0
    v_and_b32 v3, 31, v1
    v_lshlrev_b32 v7, 11, v7
    v_add_u32 v7, 129024, v7
    v_lshl_add_u32 v2, v3, 3, v7
    ds_read_b64 v[160:161], v2 offset:0
    ds_read_b64 v[162:163], v2 offset:256
    ds_read_b64 v[164:165], v2 offset:512
    ds_read_b64 v[166:167], v2 offset:768
    ds_read_b64 v[168:169], v2 offset:1024
    ds_read_b64 v[170:171], v2 offset:1280
    ds_read_b64 v[172:173], v2 offset:1536
    ds_read_b64 v[174:175], v2 offset:1792
    s_mov_b32 s58, 0x05040100
    s_mov_b32 s59, 0x07060302
    v_bfe_u32 v3, v0, 3, 2
    v_lshl_add_u32 v7, v3, 9, v7
    v_and_b32 v3, 7, v0
    v_lshl_add_u32 v7, v3, 5, v7
    v_mov_b32 v5, 161792
    v_mov_b32 v6, 1
    s_waitcnt lgkmcnt(0)
    v_perm_b32 v112, v162, v160, s58
    v_perm_b32 v113, v166, v164, s58
    v_perm_b32 v114, v170, v168, s58
    v_perm_b32 v115, v174, v172, s58
    ds_write_b128 v7, v[112:115] offset:0
    v_perm_b32 v116, v162, v160, s59
    v_perm_b32 v117, v166, v164, s59
    v_perm_b32 v118, v170, v168, s59
    v_perm_b32 v119, v174, v172, s59
    ds_write_b128 v7, v[116:119] offset:256
    v_perm_b32 v120, v163, v161, s58
    v_perm_b32 v121, v167, v165, s58
    v_perm_b32 v122, v171, v169, s58
    v_perm_b32 v123, v175, v173, s58
    ds_write_b128 v7, v[120:123] offset:16
    v_perm_b32 v124, v163, v161, s59
    v_perm_b32 v125, v167, v165, s59
    v_perm_b32 v126, v171, v169, s59
    v_perm_b32 v127, v175, v173, s59
    ds_write_b128 v7, v[124:127] offset:272
    s_mov_b64 exec, 1
    ds_add_u32 v5, v6
    s_mov_b64 exec, -1
L_wdone:
    s_mov_b32 s59, 101376
    s_mov_b32 s30, s18
    s_waitcnt lgkmcnt(0)
L_sb:
    v_mfma_f32_4x4x4_16b_bf16 v[144:147], v[224:225], v[216:217], 0
    v_mfma_f32_4x4x4_16b_bf16 v[148:151], v[224:225], v[218:219], 0
    v_mfma_f32_4x4x4_16b_bf16 v[152:155], v[224:225], v[220:221], 0
    v_mfma_f32_4x4x4_16b_bf16 v[156:159], v[224:225], v[222:223], 0
    v_add_u32 v230, 1024, v230
    s_sub_u32 s26, s30, 64
    v_cmp_gt_i32 s[34:35], s26, v234
    s_cmp_le_i32 s30, 0
    s_nop 0
    v_cvt_pk_bf16_f32 v184, v144, v148
    v_cvt_pk_bf16_f32 v185, v152, v156
    v_cvt_pk_bf16_f32 v186, v145, v149
    v_cvt_pk_bf16_f32 v187, v153, v157
    v_cvt_pk_bf16_f32 v188, v146, v150
    v_cvt_pk_bf16_f32 v189, v154, v158
    v_cvt_pk_bf16_f32 v190, v147, v151
    v_cvt_pk_bf16_f32 v191, v155, v159
    ds_read_b128 v[224:227], v230
    ds_read_b32 v243, v244
    s_cbranch_scc1 L_exit
    s_setprio 3
    v_mfma_f32_32x32x16_bf16 v[112:127], v[192:195], v[200:203], 0
    v_exp_f32 v176, v80
    v_exp_f32 v177, v81
    v_exp_f32 v178, v82
    v_exp_f32 v179, v83
    v_exp_f32 v180, v96
    v_exp_f32 v181, v97
    v_exp_f32 v182, v98
    v_exp_f32 v183, v99
    v_pk_fma_f32 v[176:177], v[176:177], s[56:57], s[56:57]
    v_pk_fma_f32 v[178:179], v[178:179], s[56:57], s[56:57]
    v_pk_fma_f32 v[180:181], v[180:181], s[56:57], s[56:57]
    v_pk_fma_f32 v[182:183], v[182:183], s[56:57], s[56:57]
    s_waitcnt vmcnt(4)
    v_mfma_f32_4x4x4_16b_bf16 v[144:147], v[184:185], v[48:49], 0 cbsz:4 abid:0
    v_rcp_f32 v176, v176
    v_mfma_f32_4x4x4_16b_bf16 v[148:151], v[184:185], v[50:51], 0 cbsz:4 abid:0
    v_rcp_f32 v177, v177
    v_mfma_f32_4x4x4_16b_bf16 v[152:155], v[184:185], v[52:53], 0 cbsz:4 abid:1
    v_rcp_f32 v178, v178
    v_mfma_f32_4x4x4_16b_bf16 v[156:159], v[184:185], v[54:55], 0 cbsz:4 abid:1
    v_rcp_f32 v179, v179
    v_mfma_f32_4x4x4_16b_bf16 v[160:163], v[184:185], v[56:57], 0 cbsz:4 abid:2
    v_rcp_f32 v180, v180
    v_mfma_f32_4x4x4_16b_bf16 v[164:167], v[184:185], v[58:59], 0 cbsz:4 abid:2
    v_rcp_f32 v181, v181
    v_mfma_f32_4x4x4_16b_bf16 v[168:171], v[184:185], v[60:61], 0 cbsz:4 abid:3
    v_rcp_f32 v182, v182
    v_mfma_f32_4x4x4_16b_bf16 v[172:175], v[184:185], v[62:63], 0 cbsz:4 abid:3
    v_rcp_f32 v183, v183
    v_readlane_b32 s72, v228, 32
    v_readlane_b32 s73, v228, 36
    v_readlane_b32 s74, v228, 40
    v_readlane_b32 s75, v228, 44
    v_pk_mul_f32 v[176:177], v[176:177], v[80:81]
    v_pk_mul_f32 v[178:179], v[178:179], v[82:83]
    v_pk_mul_f32 v[180:181], v[180:181], v[96:97]
    v_pk_mul_f32 v[182:183], v[182:183], v[98:99]
    s_set_gpr_idx_on s64, gpr_idx(SRC2,DST)
    v_pk_fma_f32 v[8:9], v[176:177], v[144:145], v[8:9] op_sel:[0,0,0] op_sel_hi:[0,1,1]
    v_pk_fma_f32 v[10:11], v[176:177], v[146:147], v[10:11] op_sel:[0,0,0] op_sel_hi:[0,1,1]
    v_pk_fma_f32 v[12:13], v[180:181], v[148:149], v[12:13] op_sel:[0,0,0] op_sel_hi:[0,1,1]
    v_pk_fma_f32 v[14:15], v[180:181], v[150:151], v[14:15] op_sel:[0,0,0] op_sel_hi:[0,1,1]
    s_set_gpr_idx_idx s65
    v_pk_fma_f32 v[8:9], v[176:177], v[152:153], v[8:9] op_sel:[1,0,0] op_sel_hi:[1,1,1]
    v_pk_fma_f32 v[10:11], v[176:177], v[154:155], v[10:11] op_sel:[1,0,0] op_sel_hi:[1,1,1]
    v_pk_fma_f32 v[12:13], v[180:181], v[156:157], v[12:13] op_sel:[1,0,0] op_sel_hi:[1,1,1]
    v_pk_fma_f32 v[14:15], v[180:181], v[158:159], v[14:15] op_sel:[1,0,0] op_sel_hi:[1,1,1]
    s_set_gpr_idx_idx s66
    v_pk_fma_f32 v[8:9], v[178:179], v[160:161], v[8:9] op_sel:[0,0,0] op_sel_hi:[0,1,1]
    v_pk_fma_f32 v[10:11], v[178:179], v[162:163], v[10:11] op_sel:[0,0,0] op_sel_hi:[0,1,1]
    v_pk_fma_f32 v[12:13], v[182:183], v[164:165], v[12:13] op_sel:[0,0,0] op_sel_hi:[0,1,1]
    v_pk_fma_f32 v[14:15], v[182:183], v[166:167], v[14:15] op_sel:[0,0,0] op_sel_hi:[0,1,1]
    s_set_gpr_idx_idx s67
    v_pk_fma_f32 v[8:9], v[178:179], v[168:169], v[8:9] op_sel:[1,0,0] op_sel_hi:[1,1,1]
    v_pk_fma_f32 v[10:11], v[178:179], v[170:171], v[10:11] op_sel:[1,0,0] op_sel_hi:[1,1,1]
    v_pk_fma_f32 v[12:13], v[182:183], v[172:173], v[12:13] op_sel:[1,0,0] op_sel_hi:[1,1,1]
    v_pk_fma_f32 v[14:15], v[182:183], v[174:175], v[14:15] op_sel:[1,0,0] op_sel_hi:[1,1,1]
    s_set_gpr_idx_off
    s_and_b32 s80, s72, s31
    s_and_b32 s81, s73, s31
    s_and_b32 s82, s74, s31
    s_and_b32 s83, s75, s31
    buffer_load_dwordx4 v[48:51], v232, s[4:7], s80 offen
    buffer_load_dwordx4 v[52:55], v232, s[4:7], s81 offen
    buffer_load_dwordx4 v[56:59], v232, s[4:7], s82 offen
    buffer_load_dwordx4 v[60:63], v232, s[4:7], s83 offen
    s_cmp_le_i32 s30, 4
    s_mov_b64 exec, s[22:23]
    ds_read_b128 v[196:199], v229 offset:46080
    s_mov_b64 exec, -1
    ds_read_b32 v2, v231 offset:524
    s_cbranch_scc1 L_exit
    s_setprio 2
    v_mfma_f32_32x32x16_bf16 v[128:143], v[192:195], v[204:207], 0
    v_exp_f32 v176, v84
    v_exp_f32 v177, v85
    v_exp_f32 v178, v86
    v_exp_f32 v179, v87
    v_exp_f32 v180, v100
    v_exp_f32 v181, v101
    v_exp_f32 v182, v102
    v_exp_f32 v183, v103
    v_pk_fma_f32 v[176:177], v[176:177], s[56:57], s[56:57]
    v_pk_fma_f32 v[178:179], v[178:179], s[56:57], s[56:57]
    v_pk_fma_f32 v[180:181], v[180:181], s[56:57], s[56:57]
    v_pk_fma_f32 v[182:183], v[182:183], s[56:57], s[56:57]
    s_waitcnt vmcnt(4)
    v_mfma_f32_4x4x4_16b_bf16 v[144:147], v[184:185], v[64:65], 0 cbsz:4 abid:4
    v_rcp_f32 v176, v176
    v_mfma_f32_4x4x4_16b_bf16 v[148:151], v[184:185], v[66:67], 0 cbsz:4 abid:4
    v_rcp_f32 v177, v177
    v_mfma_f32_4x4x4_16b_bf16 v[152:155], v[184:185], v[68:69], 0 cbsz:4 abid:5
    v_rcp_f32 v178, v178
    v_mfma_f32_4x4x4_16b_bf16 v[156:159], v[184:185], v[70:71], 0 cbsz:4 abid:5
    v_rcp_f32 v179, v179
    v_mfma_f32_4x4x4_16b_bf16 v[160:163], v[184:185], v[72:73], 0 cbsz:4 abid:6
    v_rcp_f32 v180, v180
    v_mfma_f32_4x4x4_16b_bf16 v[164:167], v[184:185], v[74:75], 0 cbsz:4 abid:6
    v_rcp_f32 v181, v181
    v_mfma_f32_4x4x4_16b_bf16 v[168:171], v[184:185], v[76:77], 0 cbsz:4 abid:7
    v_rcp_f32 v182, v182
    v_mfma_f32_4x4x4_16b_bf16 v[172:175], v[184:185], v[78:79], 0 cbsz:4 abid:7
    v_rcp_f32 v183, v183
    v_readlane_b32 s76, v228, 48
    v_readlane_b32 s77, v228, 52
    v_readlane_b32 s78, v228, 56
    v_readlane_b32 s79, v228, 60
    v_pk_mul_f32 v[176:177], v[176:177], v[84:85]
    v_pk_mul_f32 v[178:179], v[178:179], v[86:87]
    v_pk_mul_f32 v[180:181], v[180:181], v[100:101]
    v_pk_mul_f32 v[182:183], v[182:183], v[102:103]
    s_set_gpr_idx_on s68, gpr_idx(SRC2,DST)
    v_pk_fma_f32 v[8:9], v[176:177], v[144:145], v[8:9] op_sel:[0,0,0] op_sel_hi:[0,1,1]
    v_pk_fma_f32 v[10:11], v[176:177], v[146:147], v[10:11] op_sel:[0,0,0] op_sel_hi:[0,1,1]
    v_pk_fma_f32 v[12:13], v[180:181], v[148:149], v[12:13] op_sel:[0,0,0] op_sel_hi:[0,1,1]
    v_pk_fma_f32 v[14:15], v[180:181], v[150:151], v[14:15] op_sel:[0,0,0] op_sel_hi:[0,1,1]
    s_set_gpr_idx_idx s69
    v_pk_fma_f32 v[8:9], v[176:177], v[152:153], v[8:9] op_sel:[1,0,0] op_sel_hi:[1,1,1]
    v_pk_fma_f32 v[10:11], v[176:177], v[154:155], v[10:11] op_sel:[1,0,0] op_sel_hi:[1,1,1]
    v_pk_fma_f32 v[12:13], v[180:181], v[156:157], v[12:13] op_sel:[1,0,0] op_sel_hi:[1,1,1]
    v_pk_fma_f32 v[14:15], v[180:181], v[158:159], v[14:15] op_sel:[1,0,0] op_sel_hi:[1,1,1]
    s_set_gpr_idx_idx s70
    v_pk_fma_f32 v[8:9], v[178:179], v[160:161], v[8:9] op_sel:[0,0,0] op_sel_hi:[0,1,1]
    v_pk_fma_f32 v[10:11], v[178:179], v[162:163], v[10:11] op_sel:[0,0,0] op_sel_hi:[0,1,1]
    v_pk_fma_f32 v[12:13], v[182:183], v[164:165], v[12:13] op_sel:[0,0,0] op_sel_hi:[0,1,1]
    v_pk_fma_f32 v[14:15], v[182:183], v[166:167], v[14:15] op_sel:[0,0,0] op_sel_hi:[0,1,1]
    s_set_gpr_idx_idx s71
    v_pk_fma_f32 v[8:9], v[178:179], v[168:169], v[8:9] op_sel:[1,0,0] op_sel_hi:[1,1,1]
    v_pk_fma_f32 v[10:11], v[178:179], v[170:171], v[10:11] op_sel:[1,0,0] op_sel_hi:[1,1,1]
    v_pk_fma_f32 v[12:13], v[182:183], v[172:173], v[12:13] op_sel:[1,0,0] op_sel_hi:[1,1,1]
    v_pk_fma_f32 v[14:15], v[182:183], v[174:175], v[14:15] op_sel:[1,0,0] op_sel_hi:[1,1,1]
    s_set_gpr_idx_off
    s_and_b32 s80, s76, s31
    s_and_b32 s81, s77, s31
    s_and_b32 s82, s78, s31
    s_and_b32 s83, s79, s31
    buffer_load_dwordx4 v[64:67], v232, s[4:7], s80 offen
    buffer_load_dwordx4 v[68:71], v232, s[4:7], s81 offen
    buffer_load_dwordx4 v[72:75], v232, s[4:7], s82 offen
    buffer_load_dwordx4 v[76:79], v232, s[4:7], s83 offen
    s_cmp_le_i32 s30, 8
    s_waitcnt lgkmcnt(0)
    s_cbranch_scc1 L_exit
    s_setprio 1
    v_mfma_f32_32x32x16_bf16 v[112:127], v[196:199], v[208:211], v[112:127]
    v_exp_f32 v176, v88
    v_exp_f32 v177, v89
    v_exp_f32 v178, v90
    v_exp_f32 v179, v91
    v_exp_f32 v180, v104
    v_exp_f32 v181, v105
    v_exp_f32 v182, v106
    v_exp_f32 v183, v107
    v_pk_fma_f32 v[176:177], v[176:177], s[56:57], s[56:57]
    v_pk_fma_f32 v[178:179], v[178:179], s[56:57], s[56:57]
    v_pk_fma_f32 v[180:181], v[180:181], s[56:57], s[56:57]
    v_pk_fma_f32 v[182:183], v[182:183], s[56:57], s[56:57]
    s_waitcnt vmcnt(4)
    v_mfma_f32_4x4x4_16b_bf16 v[144:147], v[184:185], v[48:49], 0 cbsz:4 abid:8
    v_rcp_f32 v176, v176
    v_mfma_f32_4x4x4_16b_bf16 v[148:151], v[184:185], v[50:51], 0 cbsz:4 abid:8
    v_rcp_f32 v177, v177
    v_mfma_f32_4x4x4_16b_bf16 v[152:155], v[184:185], v[52:53], 0 cbsz:4 abid:9
    v_rcp_f32 v178, v178
    v_mfma_f32_4x4x4_16b_bf16 v[156:159], v[184:185], v[54:55], 0 cbsz:4 abid:9
    v_rcp_f32 v179, v179
    v_mfma_f32_4x4x4_16b_bf16 v[160:163], v[184:185], v[56:57], 0 cbsz:4 abid:10
    v_rcp_f32 v180, v180
    v_mfma_f32_4x4x4_16b_bf16 v[164:167], v[184:185], v[58:59], 0 cbsz:4 abid:10
    v_rcp_f32 v181, v181
    v_mfma_f32_4x4x4_16b_bf16 v[168:171], v[184:185], v[60:61], 0 cbsz:4 abid:11
    v_rcp_f32 v182, v182
    v_mfma_f32_4x4x4_16b_bf16 v[172:175], v[184:185], v[62:63], 0 cbsz:4 abid:11
    v_rcp_f32 v183, v183
    v_readlane_b32 s64, v228, 1
    v_readlane_b32 s65, v228, 5
    v_readlane_b32 s66, v228, 9
    v_readlane_b32 s67, v228, 13
    v_and_or_b32 v229, v2, s33, v233
    v_pk_mul_f32 v[176:177], v[176:177], v[88:89]
    v_pk_mul_f32 v[178:179], v[178:179], v[90:91]
    v_pk_mul_f32 v[180:181], v[180:181], v[104:105]
    v_pk_mul_f32 v[182:183], v[182:183], v[106:107]
    s_set_gpr_idx_on s72, gpr_idx(SRC2,DST)
    v_pk_fma_f32 v[8:9], v[176:177], v[144:145], v[8:9] op_sel:[0,0,0] op_sel_hi:[0,1,1]
    v_pk_fma_f32 v[10:11], v[176:177], v[146:147], v[10:11] op_sel:[0,0,0] op_sel_hi:[0,1,1]
    v_pk_fma_f32 v[12:13], v[180:181], v[148:149], v[12:13] op_sel:[0,0,0] op_sel_hi:[0,1,1]
    v_pk_fma_f32 v[14:15], v[180:181], v[150:151], v[14:15] op_sel:[0,0,0] op_sel_hi:[0,1,1]
    s_set_gpr_idx_idx s73
    v_pk_fma_f32 v[8:9], v[176:177], v[152:153], v[8:9] op_sel:[1,0,0] op_sel_hi:[1,1,1]
    v_pk_fma_f32 v[10:11], v[176:177], v[154:155], v[10:11] op_sel:[1,0,0] op_sel_hi:[1,1,1]
    v_pk_fma_f32 v[12:13], v[180:181], v[156:157], v[12:13] op_sel:[1,0,0] op_sel_hi:[1,1,1]
    v_pk_fma_f32 v[14:15], v[180:181], v[158:159], v[14:15] op_sel:[1,0,0] op_sel_hi:[1,1,1]
    s_set_gpr_idx_idx s74
    v_pk_fma_f32 v[8:9], v[178:179], v[160:161], v[8:9] op_sel:[0,0,0] op_sel_hi:[0,1,1]
    v_pk_fma_f32 v[10:11], v[178:179], v[162:163], v[10:11] op_sel:[0,0,0] op_sel_hi:[0,1,1]
    v_pk_fma_f32 v[12:13], v[182:183], v[164:165], v[12:13] op_sel:[0,0,0] op_sel_hi:[0,1,1]
    v_pk_fma_f32 v[14:15], v[182:183], v[166:167], v[14:15] op_sel:[0,0,0] op_sel_hi:[0,1,1]
    s_set_gpr_idx_idx s75
    v_pk_fma_f32 v[8:9], v[178:179], v[168:169], v[8:9] op_sel:[1,0,0] op_sel_hi:[1,1,1]
    v_pk_fma_f32 v[10:11], v[178:179], v[170:171], v[10:11] op_sel:[1,0,0] op_sel_hi:[1,1,1]
    v_pk_fma_f32 v[12:13], v[182:183], v[172:173], v[12:13] op_sel:[1,0,0] op_sel_hi:[1,1,1]
    v_pk_fma_f32 v[14:15], v[182:183], v[174:175], v[14:15] op_sel:[1,0,0] op_sel_hi:[1,1,1]
    s_set_gpr_idx_off
    s_and_b32 s80, s64, s31
    s_and_b32 s81, s65, s31
    s_and_b32 s82, s66, s31
    s_and_b32 s83, s67, s31
    buffer_load_dwordx4 v[48:51], v232, s[4:7], s80 offen
    buffer_load_dwordx4 v[52:55], v232, s[4:7], s81 offen
    buffer_load_dwordx4 v[56:59], v232, s[4:7], s82 offen
    buffer_load_dwordx4 v[60:63], v232, s[4:7], s83 offen
    s_cmp_le_i32 s30, 12
    s_mov_b64 exec, s[20:21]
    ds_read_b128 v[192:195], v229 offset:46080
    s_mov_b64 exec, -1
    s_cbranch_scc1 L_exit
    s_setprio 0
    v_mfma_f32_32x32x16_bf16 v[128:143], v[196:199], v[212:215], v[128:143]
    v_exp_f32 v176, v92
    v_exp_f32 v177, v93
    v_exp_f32 v178, v94
    v_exp_f32 v179, v95
    v_exp_f32 v180, v108
    v_exp_f32 v181, v109
    v_exp_f32 v182, v110
    v_exp_f32 v183, v111
    v_pk_fma_f32 v[176:177], v[176:177], s[56:57], s[56:57]
    v_pk_fma_f32 v[178:179], v[178:179], s[56:57], s[56:57]
    v_pk_fma_f32 v[180:181], v[180:181], s[56:57], s[56:57]
    v_pk_fma_f32 v[182:183], v[182:183], s[56:57], s[56:57]
    s_waitcnt vmcnt(4)
    v_mfma_f32_4x4x4_16b_bf16 v[144:147], v[184:185], v[64:65], 0 cbsz:4 abid:12
    v_rcp_f32 v176, v176
    v_mfma_f32_4x4x4_16b_bf16 v[148:151], v[184:185], v[66:67], 0 cbsz:4 abid:12
    v_rcp_f32 v177, v177
    v_mfma_f32_4x4x4_16b_bf16 v[152:155], v[184:185], v[68:69], 0 cbsz:4 abid:13
    v_rcp_f32 v178, v178
    v_mfma_f32_4x4x4_16b_bf16 v[156:159], v[184:185], v[70:71], 0 cbsz:4 abid:13
    v_rcp_f32 v179, v179
    v_mfma_f32_4x4x4_16b_bf16 v[160:163], v[184:185], v[72:73], 0 cbsz:4 abid:14
    v_rcp_f32 v180, v180
    v_mfma_f32_4x4x4_16b_bf16 v[164:167], v[184:185], v[74:75], 0 cbsz:4 abid:14
    v_rcp_f32 v181, v181
    v_mfma_f32_4x4x4_16b_bf16 v[168:171], v[184:185], v[76:77], 0 cbsz:4 abid:15
    v_rcp_f32 v182, v182
    v_mfma_f32_4x4x4_16b_bf16 v[172:175], v[184:185], v[78:79], 0 cbsz:4 abid:15
    v_rcp_f32 v183, v183
    v_readlane_b32 s68, v228, 17
    v_readlane_b32 s69, v228, 21
    v_readlane_b32 s70, v228, 25
    v_readlane_b32 s71, v228, 29
    v_pk_mul_f32 v[176:177], v[176:177], v[92:93]
    v_pk_mul_f32 v[178:179], v[178:179], v[94:95]
    v_pk_mul_f32 v[180:181], v[180:181], v[108:109]
    v_pk_mul_f32 v[182:183], v[182:183], v[110:111]
    s_set_gpr_idx_on s76, gpr_idx(SRC2,DST)
    v_pk_fma_f32 v[8:9], v[176:177], v[144:145], v[8:9] op_sel:[0,0,0] op_sel_hi:[0,1,1]
    v_pk_fma_f32 v[10:11], v[176:177], v[146:147], v[10:11] op_sel:[0,0,0] op_sel_hi:[0,1,1]
    v_pk_fma_f32 v[12:13], v[180:181], v[148:149], v[12:13] op_sel:[0,0,0] op_sel_hi:[0,1,1]
    v_pk_fma_f32 v[14:15], v[180:181], v[150:151], v[14:15] op_sel:[0,0,0] op_sel_hi:[0,1,1]
    s_set_gpr_idx_idx s77
    v_pk_fma_f32 v[8:9], v[176:177], v[152:153], v[8:9] op_sel:[1,0,0] op_sel_hi:[1,1,1]
    v_pk_fma_f32 v[10:11], v[176:177], v[154:155], v[10:11] op_sel:[1,0,0] op_sel_hi:[1,1,1]
    v_pk_fma_f32 v[12:13], v[180:181], v[156:157], v[12:13] op_sel:[1,0,0] op_sel_hi:[1,1,1]
    v_pk_fma_f32 v[14:15], v[180:181], v[158:159], v[14:15] op_sel:[1,0,0] op_sel_hi:[1,1,1]
    s_set_gpr_idx_idx s78
    v_pk_fma_f32 v[8:9], v[178:179], v[160:161], v[8:9] op_sel:[0,0,0] op_sel_hi:[0,1,1]
    v_pk_fma_f32 v[10:11], v[178:179], v[162:163], v[10:11] op_sel:[0,0,0] op_sel_hi:[0,1,1]
    v_pk_fma_f32 v[12:13], v[182:183], v[164:165], v[12:13] op_sel:[0,0,0] op_sel_hi:[0,1,1]
    v_pk_fma_f32 v[14:15], v[182:183], v[166:167], v[14:15] op_sel:[0,0,0] op_sel_hi:[0,1,1]
    s_set_gpr_idx_idx s79
    v_pk_fma_f32 v[8:9], v[178:179], v[168:169], v[8:9] op_sel:[1,0,0] op_sel_hi:[1,1,1]
    v_pk_fma_f32 v[10:11], v[178:179], v[170:171], v[10:11] op_sel:[1,0,0] op_sel_hi:[1,1,1]
    v_pk_fma_f32 v[12:13], v[182:183], v[172:173], v[12:13] op_sel:[1,0,0] op_sel_hi:[1,1,1]
    v_pk_fma_f32 v[14:15], v[182:183], v[174:175], v[14:15] op_sel:[1,0,0] op_sel_hi:[1,1,1]
    s_set_gpr_idx_off
    s_and_b32 s80, s68, s31
    s_and_b32 s81, s69, s31
    s_and_b32 s82, s70, s31
    s_and_b32 s83, s71, s31
    buffer_load_dwordx4 v[64:67], v232, s[4:7], s80 offen
    buffer_load_dwordx4 v[68:71], v232, s[4:7], s81 offen
    buffer_load_dwordx4 v[72:75], v232, s[4:7], s82 offen
    buffer_load_dwordx4 v[76:79], v232, s[4:7], s83 offen
    s_cmp_le_i32 s30, 16
    s_waitcnt lgkmcnt(0)
    s_cbranch_scc1 L_exit
    s_setprio 3
    v_mfma_f32_32x32x16_bf16 v[80:95], v[192:195], v[200:203], 0
    v_exp_f32 v176, v112
    v_exp_f32 v177, v113
    v_exp_f32 v178, v114
    v_exp_f32 v179, v115
    v_exp_f32 v180, v128
    v_exp_f32 v181, v129
    v_exp_f32 v182, v130
    v_exp_f32 v183, v131
    v_pk_fma_f32 v[176:177], v[176:177], s[56:57], s[56:57]
    v_pk_fma_f32 v[178:179], v[178:179], s[56:57], s[56:57]
    v_pk_fma_f32 v[180:181], v[180:181], s[56:57], s[56:57]
    v_pk_fma_f32 v[182:183], v[182:183], s[56:57], s[56:57]
    s_waitcnt vmcnt(4)
    v_mfma_f32_4x4x4_16b_bf16 v[144:147], v[186:187], v[48:49], 0 cbsz:4 abid:0
    v_rcp_f32 v176, v176
    v_mfma_f32_4x4x4_16b_bf16 v[148:151], v[186:187], v[50:51], 0 cbsz:4 abid:0
    v_rcp_f32 v177, v177
    v_mfma_f32_4x4x4_16b_bf16 v[152:155], v[186:187], v[52:53], 0 cbsz:4 abid:1
    v_rcp_f32 v178, v178
    v_mfma_f32_4x4x4_16b_bf16 v[156:159], v[186:187], v[54:55], 0 cbsz:4 abid:1
    v_rcp_f32 v179, v179
    v_mfma_f32_4x4x4_16b_bf16 v[160:163], v[186:187], v[56:57], 0 cbsz:4 abid:2
    v_rcp_f32 v180, v180
    v_mfma_f32_4x4x4_16b_bf16 v[164:167], v[186:187], v[58:59], 0 cbsz:4 abid:2
    v_rcp_f32 v181, v181
    v_mfma_f32_4x4x4_16b_bf16 v[168:171], v[186:187], v[60:61], 0 cbsz:4 abid:3
    v_rcp_f32 v182, v182
    v_mfma_f32_4x4x4_16b_bf16 v[172:175], v[186:187], v[62:63], 0 cbsz:4 abid:3
    v_rcp_f32 v183, v183
    v_readlane_b32 s72, v228, 33
    v_readlane_b32 s73, v228, 37
    v_readlane_b32 s74, v228, 41
    v_readlane_b32 s75, v228, 45
    v_pk_mul_f32 v[176:177], v[176:177], v[112:113]
    v_pk_mul_f32 v[178:179], v[178:179], v[114:115]
    v_pk_mul_f32 v[180:181], v[180:181], v[128:129]
    v_pk_mul_f32 v[182:183], v[182:183], v[130:131]
    s_set_gpr_idx_on s64, gpr_idx(SRC2,DST)
    v_pk_fma_f32 v[8:9], v[176:177], v[144:145], v[8:9] op_sel:[0,0,0] op_sel_hi:[0,1,1]
    v_pk_fma_f32 v[10:11], v[176:177], v[146:147], v[10:11] op_sel:[0,0,0] op_sel_hi:[0,1,1]
    v_pk_fma_f32 v[12:13], v[180:181], v[148:149], v[12:13] op_sel:[0,0,0] op_sel_hi:[0,1,1]
    v_pk_fma_f32 v[14:15], v[180:181], v[150:151], v[14:15] op_sel:[0,0,0] op_sel_hi:[0,1,1]
    s_set_gpr_idx_idx s65
    v_pk_fma_f32 v[8:9], v[176:177], v[152:153], v[8:9] op_sel:[1,0,0] op_sel_hi:[1,1,1]
    v_pk_fma_f32 v[10:11], v[176:177], v[154:155], v[10:11] op_sel:[1,0,0] op_sel_hi:[1,1,1]
    v_pk_fma_f32 v[12:13], v[180:181], v[156:157], v[12:13] op_sel:[1,0,0] op_sel_hi:[1,1,1]
    v_pk_fma_f32 v[14:15], v[180:181], v[158:159], v[14:15] op_sel:[1,0,0] op_sel_hi:[1,1,1]
    s_set_gpr_idx_idx s66
    v_pk_fma_f32 v[8:9], v[178:179], v[160:161], v[8:9] op_sel:[0,0,0] op_sel_hi:[0,1,1]
    v_pk_fma_f32 v[10:11], v[178:179], v[162:163], v[10:11] op_sel:[0,0,0] op_sel_hi:[0,1,1]
    v_pk_fma_f32 v[12:13], v[182:183], v[164:165], v[12:13] op_sel:[0,0,0] op_sel_hi:[0,1,1]
    v_pk_fma_f32 v[14:15], v[182:183], v[166:167], v[14:15] op_sel:[0,0,0] op_sel_hi:[0,1,1]
    s_set_gpr_idx_idx s67
    v_pk_fma_f32 v[8:9], v[178:179], v[168:169], v[8:9] op_sel:[1,0,0] op_sel_hi:[1,1,1]
    v_pk_fma_f32 v[10:11], v[178:179], v[170:171], v[10:11] op_sel:[1,0,0] op_sel_hi:[1,1,1]
    v_pk_fma_f32 v[12:13], v[182:183], v[172:173], v[12:13] op_sel:[1,0,0] op_sel_hi:[1,1,1]
    v_pk_fma_f32 v[14:15], v[182:183], v[174:175], v[14:15] op_sel:[1,0,0] op_sel_hi:[1,1,1]
    s_set_gpr_idx_off
    s_and_b32 s80, s72, s31
    s_and_b32 s81, s73, s31
    s_and_b32 s82, s74, s31
    s_and_b32 s83, s75, s31
    buffer_load_dwordx4 v[48:51], v232, s[4:7], s80 offen
    buffer_load_dwordx4 v[52:55], v232, s[4:7], s81 offen
    buffer_load_dwordx4 v[56:59], v232, s[4:7], s82 offen
    buffer_load_dwordx4 v[60:63], v232, s[4:7], s83 offen
    s_cmp_le_i32 s30, 20
    s_mov_b64 exec, s[22:23]
    ds_read_b128 v[196:199], v229 offset:46080
    s_mov_b64 exec, -1
    ds_read_b32 v2, v231 offset:780
    s_cbranch_scc1 L_exit
    s_setprio 2
    v_mfma_f32_32x32x16_bf16 v[96:111], v[192:195], v[204:207], 0
    v_exp_f32 v176, v116
    v_exp_f32 v177, v117
    v_exp_f32 v178, v118
    v_exp_f32 v179, v119
    v_exp_f32 v180, v132
    v_exp_f32 v181, v133
    v_exp_f32 v182, v134
    v_exp_f32 v183, v135
    v_pk_fma_f32 v[176:177], v[176:177], s[56:57], s[56:57]
    v_pk_fma_f32 v[178:179], v[178:179], s[56:57], s[56:57]
    v_pk_fma_f32 v[180:181], v[180:181], s[56:57], s[56:57]
    v_pk_fma_f32 v[182:183], v[182:183], s[56:57], s[56:57]
    s_waitcnt vmcnt(4)
    v_mfma_f32_4x4x4_16b_bf16 v[144:147], v[186:187], v[64:65], 0 cbsz:4 abid:4
    v_rcp_f32 v176, v176
    v_mfma_f32_4x4x4_16b_bf16 v[148:151], v[186:187], v[66:67], 0 cbsz:4 abid:4
    v_rcp_f32 v177, v177
    v_mfma_f32_4x4x4_16b_bf16 v[152:155], v[186:187], v[68:69], 0 cbsz:4 abid:5
    v_rcp_f32 v178, v178
    v_mfma_f32_4x4x4_16b_bf16 v[156:159], v[186:187], v[70:71], 0 cbsz:4 abid:5
    v_rcp_f32 v179, v179
    v_mfma_f32_4x4x4_16b_bf16 v[160:163], v[186:187], v[72:73], 0 cbsz:4 abid:6
    v_rcp_f32 v180, v180
    v_mfma_f32_4x4x4_16b_bf16 v[164:167], v[186:187], v[74:75], 0 cbsz:4 abid:6
    v_rcp_f32 v181, v181
    v_mfma_f32_4x4x4_16b_bf16 v[168:171], v[186:187], v[76:77], 0 cbsz:4 abid:7
    v_rcp_f32 v182, v182
    v_mfma_f32_4x4x4_16b_bf16 v[172:175], v[186:187], v[78:79], 0 cbsz:4 abid:7
    v_rcp_f32 v183, v183
    v_readlane_b32 s76, v228, 49
    v_readlane_b32 s77, v228, 53
    v_readlane_b32 s78, v228, 57
    v_readlane_b32 s79, v228, 61
    v_pk_mul_f32 v[176:177], v[176:177], v[116:117]
    v_pk_mul_f32 v[178:179], v[178:179], v[118:119]
    v_pk_mul_f32 v[180:181], v[180:181], v[132:133]
    v_pk_mul_f32 v[182:183], v[182:183], v[134:135]
    s_set_gpr_idx_on s68, gpr_idx(SRC2,DST)
    v_pk_fma_f32 v[8:9], v[176:177], v[144:145], v[8:9] op_sel:[0,0,0] op_sel_hi:[0,1,1]
    v_pk_fma_f32 v[10:11], v[176:177], v[146:147], v[10:11] op_sel:[0,0,0] op_sel_hi:[0,1,1]
    v_pk_fma_f32 v[12:13], v[180:181], v[148:149], v[12:13] op_sel:[0,0,0] op_sel_hi:[0,1,1]
    v_pk_fma_f32 v[14:15], v[180:181], v[150:151], v[14:15] op_sel:[0,0,0] op_sel_hi:[0,1,1]
    s_set_gpr_idx_idx s69
    v_pk_fma_f32 v[8:9], v[176:177], v[152:153], v[8:9] op_sel:[1,0,0] op_sel_hi:[1,1,1]
    v_pk_fma_f32 v[10:11], v[176:177], v[154:155], v[10:11] op_sel:[1,0,0] op_sel_hi:[1,1,1]
    v_pk_fma_f32 v[12:13], v[180:181], v[156:157], v[12:13] op_sel:[1,0,0] op_sel_hi:[1,1,1]
    v_pk_fma_f32 v[14:15], v[180:181], v[158:159], v[14:15] op_sel:[1,0,0] op_sel_hi:[1,1,1]
    s_set_gpr_idx_idx s70
    v_pk_fma_f32 v[8:9], v[178:179], v[160:161], v[8:9] op_sel:[0,0,0] op_sel_hi:[0,1,1]
    v_pk_fma_f32 v[10:11], v[178:179], v[162:163], v[10:11] op_sel:[0,0,0] op_sel_hi:[0,1,1]
    v_pk_fma_f32 v[12:13], v[182:183], v[164:165], v[12:13] op_sel:[0,0,0] op_sel_hi:[0,1,1]
    v_pk_fma_f32 v[14:15], v[182:183], v[166:167], v[14:15] op_sel:[0,0,0] op_sel_hi:[0,1,1]
    s_set_gpr_idx_idx s71
    v_pk_fma_f32 v[8:9], v[178:179], v[168:169], v[8:9] op_sel:[1,0,0] op_sel_hi:[1,1,1]
    v_pk_fma_f32 v[10:11], v[178:179], v[170:171], v[10:11] op_sel:[1,0,0] op_sel_hi:[1,1,1]
    v_pk_fma_f32 v[12:13], v[182:183], v[172:173], v[12:13] op_sel:[1,0,0] op_sel_hi:[1,1,1]
    v_pk_fma_f32 v[14:15], v[182:183], v[174:175], v[14:15] op_sel:[1,0,0] op_sel_hi:[1,1,1]
    s_set_gpr_idx_off
    s_and_b32 s80, s76, s31
    s_and_b32 s81, s77, s31
    s_and_b32 s82, s78, s31
    s_and_b32 s83, s79, s31
    buffer_load_dwordx4 v[64:67], v232, s[4:7], s80 offen
    buffer_load_dwordx4 v[68:71], v232, s[4:7], s81 offen
    buffer_load_dwordx4 v[72:75], v232, s[4:7], s82 offen
    buffer_load_dwordx4 v[76:79], v232, s[4:7], s83 offen
    s_cmp_le_i32 s30, 24
    s_waitcnt lgkmcnt(0)
    s_cbranch_scc1 L_exit
    s_setprio 1
    v_mfma_f32_32x32x16_bf16 v[80:95], v[196:199], v[208:211], v[80:95]
    v_exp_f32 v176, v120
    v_exp_f32 v177, v121
    v_exp_f32 v178, v122
    v_exp_f32 v179, v123
    v_exp_f32 v180, v136
    v_exp_f32 v181, v137
    v_exp_f32 v182, v138
    v_exp_f32 v183, v139
    v_pk_fma_f32 v[176:177], v[176:177], s[56:57], s[56:57]
    v_pk_fma_f32 v[178:179], v[178:179], s[56:57], s[56:57]
    v_pk_fma_f32 v[180:181], v[180:181], s[56:57], s[56:57]
    v_pk_fma_f32 v[182:183], v[182:183], s[56:57], s[56:57]
    s_waitcnt vmcnt(4)
    v_mfma_f32_4x4x4_16b_bf16 v[144:147], v[186:187], v[48:49], 0 cbsz:4 abid:8
    v_rcp_f32 v176, v176
    v_mfma_f32_4x4x4_16b_bf16 v[148:151], v[186:187], v[50:51], 0 cbsz:4 abid:8
    v_rcp_f32 v177, v177
    v_mfma_f32_4x4x4_16b_bf16 v[152:155], v[186:187], v[52:53], 0 cbsz:4 abid:9
    v_rcp_f32 v178, v178
    v_mfma_f32_4x4x4_16b_bf16 v[156:159], v[186:187], v[54:55], 0 cbsz:4 abid:9
    v_rcp_f32 v179, v179
    v_mfma_f32_4x4x4_16b_bf16 v[160:163], v[186:187], v[56:57], 0 cbsz:4 abid:10
    v_rcp_f32 v180, v180
    v_mfma_f32_4x4x4_16b_bf16 v[164:167], v[186:187], v[58:59], 0 cbsz:4 abid:10
    v_rcp_f32 v181, v181
    v_mfma_f32_4x4x4_16b_bf16 v[168:171], v[186:187], v[60:61], 0 cbsz:4 abid:11
    v_rcp_f32 v182, v182
    v_mfma_f32_4x4x4_16b_bf16 v[172:175], v[186:187], v[62:63], 0 cbsz:4 abid:11
    v_rcp_f32 v183, v183
    v_readlane_b32 s64, v228, 2
    v_readlane_b32 s65, v228, 6
    v_readlane_b32 s66, v228, 10
    v_readlane_b32 s67, v228, 14
    v_and_or_b32 v229, v2, s33, v233
    v_pk_mul_f32 v[176:177], v[176:177], v[120:121]
    v_pk_mul_f32 v[178:179], v[178:179], v[122:123]
    v_pk_mul_f32 v[180:181], v[180:181], v[136:137]
    v_pk_mul_f32 v[182:183], v[182:183], v[138:139]
    s_set_gpr_idx_on s72, gpr_idx(SRC2,DST)
    v_pk_fma_f32 v[8:9], v[176:177], v[144:145], v[8:9] op_sel:[0,0,0] op_sel_hi:[0,1,1]
    v_pk_fma_f32 v[10:11], v[176:177], v[146:147], v[10:11] op_sel:[0,0,0] op_sel_hi:[0,1,1]
    v_pk_fma_f32 v[12:13], v[180:181], v[148:149], v[12:13] op_sel:[0,0,0] op_sel_hi:[0,1,1]
    v_pk_fma_f32 v[14:15], v[180:181], v[150:151], v[14:15] op_sel:[0,0,0] op_sel_hi:[0,1,1]
    s_set_gpr_idx_idx s73
    v_pk_fma_f32 v[8:9], v[176:177], v[152:153], v[8:9] op_sel:[1,0,0] op_sel_hi:[1,1,1]
    v_pk_fma_f32 v[10:11], v[176:177], v[154:155], v[10:11] op_sel:[1,0,0] op_sel_hi:[1,1,1]
    v_pk_fma_f32 v[12:13], v[180:181], v[156:157], v[12:13] op_sel:[1,0,0] op_sel_hi:[1,1,1]
    v_pk_fma_f32 v[14:15], v[180:181], v[158:159], v[14:15] op_sel:[1,0,0] op_sel_hi:[1,1,1]
    s_set_gpr_idx_idx s74
    v_pk_fma_f32 v[8:9], v[178:179], v[160:161], v[8:9] op_sel:[0,0,0] op_sel_hi:[0,1,1]
    v_pk_fma_f32 v[10:11], v[178:179], v[162:163], v[10:11] op_sel:[0,0,0] op_sel_hi:[0,1,1]
    v_pk_fma_f32 v[12:13], v[182:183], v[164:165], v[12:13] op_sel:[0,0,0] op_sel_hi:[0,1,1]
    v_pk_fma_f32 v[14:15], v[182:183], v[166:167], v[14:15] op_sel:[0,0,0] op_sel_hi:[0,1,1]
    s_set_gpr_idx_idx s75
    v_pk_fma_f32 v[8:9], v[178:179], v[168:169], v[8:9] op_sel:[1,0,0] op_sel_hi:[1,1,1]
    v_pk_fma_f32 v[10:11], v[178:179], v[170:171], v[10:11] op_sel:[1,0,0] op_sel_hi:[1,1,1]
    v_pk_fma_f32 v[12:13], v[182:183], v[172:173], v[12:13] op_sel:[1,0,0] op_sel_hi:[1,1,1]
    v_pk_fma_f32 v[14:15], v[182:183], v[174:175], v[14:15] op_sel:[1,0,0] op_sel_hi:[1,1,1]
    s_set_gpr_idx_off
    s_and_b32 s80, s64, s31
    s_and_b32 s81, s65, s31
    s_and_b32 s82, s66, s31
    s_and_b32 s83, s67, s31
    buffer_load_dwordx4 v[48:51], v232, s[4:7], s80 offen
    buffer_load_dwordx4 v[52:55], v232, s[4:7], s81 offen
    buffer_load_dwordx4 v[56:59], v232, s[4:7], s82 offen
    buffer_load_dwordx4 v[60:63], v232, s[4:7], s83 offen
    s_cmp_le_i32 s30, 28
    s_mov_b64 exec, s[20:21]
    ds_read_b128 v[192:195], v229 offset:46080
    s_mov_b64 exec, -1
    s_cbranch_scc1 L_exit
    s_setprio 0
    v_mfma_f32_32x32x16_bf16 v[96:111], v[196:199], v[212:215], v[96:111]
    v_exp_f32 v176, v124
    v_exp_f32 v177, v125
    v_exp_f32 v178, v126
    v_exp_f32 v179, v127
    v_exp_f32 v180, v140
    v_exp_f32 v181, v141
    v_exp_f32 v182, v142
    v_exp_f32 v183, v143
    v_pk_fma_f32 v[176:177], v[176:177], s[56:57], s[56:57]
    v_pk_fma_f32 v[178:179], v[178:179], s[56:57], s[56:57]
    v_pk_fma_f32 v[180:181], v[180:181], s[56:57], s[56:57]
    v_pk_fma_f32 v[182:183], v[182:183], s[56:57], s[56:57]
    s_waitcnt vmcnt(4)
    v_mfma_f32_4x4x4_16b_bf16 v[144:147], v[186:187], v[64:65], 0 cbsz:4 abid:12
    v_rcp_f32 v176, v176
    v_mfma_f32_4x4x4_16b_bf16 v[148:151], v[186:187], v[66:67], 0 cbsz:4 abid:12
    v_rcp_f32 v177, v177
    v_mfma_f32_4x4x4_16b_bf16 v[152:155], v[186:187], v[68:69], 0 cbsz:4 abid:13
    v_rcp_f32 v178, v178
    v_mfma_f32_4x4x4_16b_bf16 v[156:159], v[186:187], v[70:71], 0 cbsz:4 abid:13
    v_rcp_f32 v179, v179
    v_mfma_f32_4x4x4_16b_bf16 v[160:163], v[186:187], v[72:73], 0 cbsz:4 abid:14
    v_rcp_f32 v180, v180
    v_mfma_f32_4x4x4_16b_bf16 v[164:167], v[186:187], v[74:75], 0 cbsz:4 abid:14
    v_rcp_f32 v181, v181
    v_mfma_f32_4x4x4_16b_bf16 v[168:171], v[186:187], v[76:77], 0 cbsz:4 abid:15
    v_rcp_f32 v182, v182
    v_mfma_f32_4x4x4_16b_bf16 v[172:175], v[186:187], v[78:79], 0 cbsz:4 abid:15
    v_rcp_f32 v183, v183
    v_readlane_b32 s68, v228, 18
    v_readlane_b32 s69, v228, 22
    v_readlane_b32 s70, v228, 26
    v_readlane_b32 s71, v228, 30
    v_pk_mul_f32 v[176:177], v[176:177], v[124:125]
    v_pk_mul_f32 v[178:179], v[178:179], v[126:127]
    v_pk_mul_f32 v[180:181], v[180:181], v[140:141]
    v_pk_mul_f32 v[182:183], v[182:183], v[142:143]
    s_set_gpr_idx_on s76, gpr_idx(SRC2,DST)
    v_pk_fma_f32 v[8:9], v[176:177], v[144:145], v[8:9] op_sel:[0,0,0] op_sel_hi:[0,1,1]
    v_pk_fma_f32 v[10:11], v[176:177], v[146:147], v[10:11] op_sel:[0,0,0] op_sel_hi:[0,1,1]
    v_pk_fma_f32 v[12:13], v[180:181], v[148:149], v[12:13] op_sel:[0,0,0] op_sel_hi:[0,1,1]
    v_pk_fma_f32 v[14:15], v[180:181], v[150:151], v[14:15] op_sel:[0,0,0] op_sel_hi:[0,1,1]
    s_set_gpr_idx_idx s77
    v_pk_fma_f32 v[8:9], v[176:177], v[152:153], v[8:9] op_sel:[1,0,0] op_sel_hi:[1,1,1]
    v_pk_fma_f32 v[10:11], v[176:177], v[154:155], v[10:11] op_sel:[1,0,0] op_sel_hi:[1,1,1]
    v_pk_fma_f32 v[12:13], v[180:181], v[156:157], v[12:13] op_sel:[1,0,0] op_sel_hi:[1,1,1]
    v_pk_fma_f32 v[14:15], v[180:181], v[158:159], v[14:15] op_sel:[1,0,0] op_sel_hi:[1,1,1]
    s_set_gpr_idx_idx s78
    v_pk_fma_f32 v[8:9], v[178:179], v[160:161], v[8:9] op_sel:[0,0,0] op_sel_hi:[0,1,1]
    v_pk_fma_f32 v[10:11], v[178:179], v[162:163], v[10:11] op_sel:[0,0,0] op_sel_hi:[0,1,1]
    v_pk_fma_f32 v[12:13], v[182:183], v[164:165], v[12:13] op_sel:[0,0,0] op_sel_hi:[0,1,1]
    v_pk_fma_f32 v[14:15], v[182:183], v[166:167], v[14:15] op_sel:[0,0,0] op_sel_hi:[0,1,1]
    s_set_gpr_idx_idx s79
    v_pk_fma_f32 v[8:9], v[178:179], v[168:169], v[8:9] op_sel:[1,0,0] op_sel_hi:[1,1,1]
    v_pk_fma_f32 v[10:11], v[178:179], v[170:171], v[10:11] op_sel:[1,0,0] op_sel_hi:[1,1,1]
    v_pk_fma_f32 v[12:13], v[182:183], v[172:173], v[12:13] op_sel:[1,0,0] op_sel_hi:[1,1,1]
    v_pk_fma_f32 v[14:15], v[182:183], v[174:175], v[14:15] op_sel:[1,0,0] op_sel_hi:[1,1,1]
    s_set_gpr_idx_off
    s_and_b32 s80, s68, s31
    s_and_b32 s81, s69, s31
    s_and_b32 s82, s70, s31
    s_and_b32 s83, s71, s31
    buffer_load_dwordx4 v[64:67], v232, s[4:7], s80 offen
    buffer_load_dwordx4 v[68:71], v232, s[4:7], s81 offen
    buffer_load_dwordx4 v[72:75], v232, s[4:7], s82 offen
    buffer_load_dwordx4 v[76:79], v232, s[4:7], s83 offen
    s_cmp_le_i32 s30, 32
    s_waitcnt lgkmcnt(0)
    s_cbranch_scc1 L_exit
    s_setprio 3
    v_mfma_f32_32x32x16_bf16 v[112:127], v[192:195], v[200:203], 0
    v_exp_f32 v176, v80
    v_exp_f32 v177, v81
    v_exp_f32 v178, v82
    v_exp_f32 v179, v83
    v_exp_f32 v180, v96
    v_exp_f32 v181, v97
    v_exp_f32 v182, v98
    v_exp_f32 v183, v99
    v_pk_fma_f32 v[176:177], v[176:177], s[56:57], s[56:57]
    v_pk_fma_f32 v[178:179], v[178:179], s[56:57], s[56:57]
    v_pk_fma_f32 v[180:181], v[180:181], s[56:57], s[56:57]
    v_pk_fma_f32 v[182:183], v[182:183], s[56:57], s[56:57]
    s_waitcnt vmcnt(4)
    v_mfma_f32_4x4x4_16b_bf16 v[144:147], v[188:189], v[48:49], 0 cbsz:4 abid:0
    v_rcp_f32 v176, v176
    v_mfma_f32_4x4x4_16b_bf16 v[148:151], v[188:189], v[50:51], 0 cbsz:4 abid:0
    v_rcp_f32 v177, v177
    v_mfma_f32_4x4x4_16b_bf16 v[152:155], v[188:189], v[52:53], 0 cbsz:4 abid:1
    v_rcp_f32 v178, v178
    v_mfma_f32_4x4x4_16b_bf16 v[156:159], v[188:189], v[54:55], 0 cbsz:4 abid:1
    v_rcp_f32 v179, v179
    v_mfma_f32_4x4x4_16b_bf16 v[160:163], v[188:189], v[56:57], 0 cbsz:4 abid:2
    v_rcp_f32 v180, v180
    v_mfma_f32_4x4x4_16b_bf16 v[164:167], v[188:189], v[58:59], 0 cbsz:4 abid:2
    v_rcp_f32 v181, v181
    v_mfma_f32_4x4x4_16b_bf16 v[168:171], v[188:189], v[60:61], 0 cbsz:4 abid:3
    v_rcp_f32 v182, v182
    v_mfma_f32_4x4x4_16b_bf16 v[172:175], v[188:189], v[62:63], 0 cbsz:4 abid:3
    v_rcp_f32 v183, v183
    v_readlane_b32 s72, v228, 34
    v_readlane_b32 s73, v228, 38
    v_readlane_b32 s74, v228, 42
    v_readlane_b32 s75, v228, 46
    v_pk_mul_f32 v[176:177], v[176:177], v[80:81]
    v_pk_mul_f32 v[178:179], v[178:179], v[82:83]
    v_pk_mul_f32 v[180:181], v[180:181], v[96:97]
    v_pk_mul_f32 v[182:183], v[182:183], v[98:99]
    s_set_gpr_idx_on s64, gpr_idx(SRC2,DST)
    v_pk_fma_f32 v[8:9], v[176:177], v[144:145], v[8:9] op_sel:[0,0,0] op_sel_hi:[0,1,1]
    v_pk_fma_f32 v[10:11], v[176:177], v[146:147], v[10:11] op_sel:[0,0,0] op_sel_hi:[0,1,1]
    v_pk_fma_f32 v[12:13], v[180:181], v[148:149], v[12:13] op_sel:[0,0,0] op_sel_hi:[0,1,1]
    v_pk_fma_f32 v[14:15], v[180:181], v[150:151], v[14:15] op_sel:[0,0,0] op_sel_hi:[0,1,1]
    s_set_gpr_idx_idx s65
    v_pk_fma_f32 v[8:9], v[176:177], v[152:153], v[8:9] op_sel:[1,0,0] op_sel_hi:[1,1,1]
    v_pk_fma_f32 v[10:11], v[176:177], v[154:155], v[10:11] op_sel:[1,0,0] op_sel_hi:[1,1,1]
    v_pk_fma_f32 v[12:13], v[180:181], v[156:157], v[12:13] op_sel:[1,0,0] op_sel_hi:[1,1,1]
    v_pk_fma_f32 v[14:15], v[180:181], v[158:159], v[14:15] op_sel:[1,0,0] op_sel_hi:[1,1,1]
    s_set_gpr_idx_idx s66
    v_pk_fma_f32 v[8:9], v[178:179], v[160:161], v[8:9] op_sel:[0,0,0] op_sel_hi:[0,1,1]
    v_pk_fma_f32 v[10:11], v[178:179], v[162:163], v[10:11] op_sel:[0,0,0] op_sel_hi:[0,1,1]
    v_pk_fma_f32 v[12:13], v[182:183], v[164:165], v[12:13] op_sel:[0,0,0] op_sel_hi:[0,1,1]
    v_pk_fma_f32 v[14:15], v[182:183], v[166:167], v[14:15] op_sel:[0,0,0] op_sel_hi:[0,1,1]
    s_set_gpr_idx_idx s67
    v_pk_fma_f32 v[8:9], v[178:179], v[168:169], v[8:9] op_sel:[1,0,0] op_sel_hi:[1,1,1]
    v_pk_fma_f32 v[10:11], v[178:179], v[170:171], v[10:11] op_sel:[1,0,0] op_sel_hi:[1,1,1]
    v_pk_fma_f32 v[12:13], v[182:183], v[172:173], v[12:13] op_sel:[1,0,0] op_sel_hi:[1,1,1]
    v_pk_fma_f32 v[14:15], v[182:183], v[174:175], v[14:15] op_sel:[1,0,0] op_sel_hi:[1,1,1]
    s_set_gpr_idx_off
    s_and_b32 s80, s72, s31
    s_and_b32 s81, s73, s31
    s_and_b32 s82, s74, s31
    s_and_b32 s83, s75, s31
    buffer_load_dwordx4 v[48:51], v232, s[4:7], s80 offen
    buffer_load_dwordx4 v[52:55], v232, s[4:7], s81 offen
    buffer_load_dwordx4 v[56:59], v232, s[4:7], s82 offen
    buffer_load_dwordx4 v[60:63], v232, s[4:7], s83 offen
    s_cmp_le_i32 s30, 36
    s_mov_b64 exec, s[22:23]
    ds_read_b128 v[196:199], v229 offset:46080
    s_mov_b64 exec, -1
    ds_read_b32 v2, v231 offset:1036
    s_cbranch_scc1 L_exit
    s_setprio 2
    v_mfma_f32_32x32x16_bf16 v[128:143], v[192:195], v[204:207], 0
    v_exp_f32 v176, v84
    v_exp_f32 v177, v85
    v_exp_f32 v178, v86
    v_exp_f32 v179, v87
    v_exp_f32 v180, v100
    v_exp_f32 v181, v101
    v_exp_f32 v182, v102
    v_exp_f32 v183, v103
    v_pk_fma_f32 v[176:177], v[176:177], s[56:57], s[56:57]
    v_pk_fma_f32 v[178:179], v[178:179], s[56:57], s[56:57]
    v_pk_fma_f32 v[180:181], v[180:181], s[56:57], s[56:57]
    v_pk_fma_f32 v[182:183], v[182:183], s[56:57], s[56:57]
    s_waitcnt vmcnt(4)
    v_mfma_f32_4x4x4_16b_bf16 v[144:147], v[188:189], v[64:65], 0 cbsz:4 abid:4
    v_rcp_f32 v176, v176
    v_mfma_f32_4x4x4_16b_bf16 v[148:151], v[188:189], v[66:67], 0 cbsz:4 abid:4
    v_rcp_f32 v177, v177
    v_mfma_f32_4x4x4_16b_bf16 v[152:155], v[188:189], v[68:69], 0 cbsz:4 abid:5
    v_rcp_f32 v178, v178
    v_mfma_f32_4x4x4_16b_bf16 v[156:159], v[188:189], v[70:71], 0 cbsz:4 abid:5
    v_rcp_f32 v179, v179
    v_mfma_f32_4x4x4_16b_bf16 v[160:163], v[188:189], v[72:73], 0 cbsz:4 abid:6
    v_rcp_f32 v180, v180
    v_mfma_f32_4x4x4_16b_bf16 v[164:167], v[188:189], v[74:75], 0 cbsz:4 abid:6
    v_rcp_f32 v181, v181
    v_mfma_f32_4x4x4_16b_bf16 v[168:171], v[188:189], v[76:77], 0 cbsz:4 abid:7
    v_rcp_f32 v182, v182
    v_mfma_f32_4x4x4_16b_bf16 v[172:175], v[188:189], v[78:79], 0 cbsz:4 abid:7
    v_rcp_f32 v183, v183
    v_readlane_b32 s76, v228, 50
    v_readlane_b32 s77, v228, 54
    v_readlane_b32 s78, v228, 58
    v_readlane_b32 s79, v228, 62
    v_pk_mul_f32 v[176:177], v[176:177], v[84:85]
    v_pk_mul_f32 v[178:179], v[178:179], v[86:87]
    v_pk_mul_f32 v[180:181], v[180:181], v[100:101]
    v_pk_mul_f32 v[182:183], v[182:183], v[102:103]
    s_set_gpr_idx_on s68, gpr_idx(SRC2,DST)
    v_pk_fma_f32 v[8:9], v[176:177], v[144:145], v[8:9] op_sel:[0,0,0] op_sel_hi:[0,1,1]
    v_pk_fma_f32 v[10:11], v[176:177], v[146:147], v[10:11] op_sel:[0,0,0] op_sel_hi:[0,1,1]
    v_pk_fma_f32 v[12:13], v[180:181], v[148:149], v[12:13] op_sel:[0,0,0] op_sel_hi:[0,1,1]
    v_pk_fma_f32 v[14:15], v[180:181], v[150:151], v[14:15] op_sel:[0,0,0] op_sel_hi:[0,1,1]
    s_set_gpr_idx_idx s69
    v_pk_fma_f32 v[8:9], v[176:177], v[152:153], v[8:9] op_sel:[1,0,0] op_sel_hi:[1,1,1]
    v_pk_fma_f32 v[10:11], v[176:177], v[154:155], v[10:11] op_sel:[1,0,0] op_sel_hi:[1,1,1]
    v_pk_fma_f32 v[12:13], v[180:181], v[156:157], v[12:13] op_sel:[1,0,0] op_sel_hi:[1,1,1]
    v_pk_fma_f32 v[14:15], v[180:181], v[158:159], v[14:15] op_sel:[1,0,0] op_sel_hi:[1,1,1]
    s_set_gpr_idx_idx s70
    v_pk_fma_f32 v[8:9], v[178:179], v[160:161], v[8:9] op_sel:[0,0,0] op_sel_hi:[0,1,1]
    v_pk_fma_f32 v[10:11], v[178:179], v[162:163], v[10:11] op_sel:[0,0,0] op_sel_hi:[0,1,1]
    v_pk_fma_f32 v[12:13], v[182:183], v[164:165], v[12:13] op_sel:[0,0,0] op_sel_hi:[0,1,1]
    v_pk_fma_f32 v[14:15], v[182:183], v[166:167], v[14:15] op_sel:[0,0,0] op_sel_hi:[0,1,1]
    s_set_gpr_idx_idx s71
    v_pk_fma_f32 v[8:9], v[178:179], v[168:169], v[8:9] op_sel:[1,0,0] op_sel_hi:[1,1,1]
    v_pk_fma_f32 v[10:11], v[178:179], v[170:171], v[10:11] op_sel:[1,0,0] op_sel_hi:[1,1,1]
    v_pk_fma_f32 v[12:13], v[182:183], v[172:173], v[12:13] op_sel:[1,0,0] op_sel_hi:[1,1,1]
    v_pk_fma_f32 v[14:15], v[182:183], v[174:175], v[14:15] op_sel:[1,0,0] op_sel_hi:[1,1,1]
    s_set_gpr_idx_off
    s_and_b32 s80, s76, s31
    s_and_b32 s81, s77, s31
    s_and_b32 s82, s78, s31
    s_and_b32 s83, s79, s31
    buffer_load_dwordx4 v[64:67], v232, s[4:7], s80 offen
    buffer_load_dwordx4 v[68:71], v232, s[4:7], s81 offen
    buffer_load_dwordx4 v[72:75], v232, s[4:7], s82 offen
    buffer_load_dwordx4 v[76:79], v232, s[4:7], s83 offen
    s_cmp_le_i32 s30, 40
    s_waitcnt lgkmcnt(0)
    s_cbranch_scc1 L_exit
    s_setprio 1
    v_mfma_f32_32x32x16_bf16 v[112:127], v[196:199], v[208:211], v[112:127]
    v_exp_f32 v176, v88
    v_exp_f32 v177, v89
    v_exp_f32 v178, v90
    v_exp_f32 v179, v91
    v_exp_f32 v180, v104
    v_exp_f32 v181, v105
    v_exp_f32 v182, v106
    v_exp_f32 v183, v107
    v_pk_fma_f32 v[176:177], v[176:177], s[56:57], s[56:57]
    v_pk_fma_f32 v[178:179], v[178:179], s[56:57], s[56:57]
    v_pk_fma_f32 v[180:181], v[180:181], s[56:57], s[56:57]
    v_pk_fma_f32 v[182:183], v[182:183], s[56:57], s[56:57]
    s_waitcnt vmcnt(4)
    v_mfma_f32_4x4x4_16b_bf16 v[144:147], v[188:189], v[48:49], 0 cbsz:4 abid:8
    v_rcp_f32 v176, v176
    v_mfma_f32_4x4x4_16b_bf16 v[148:151], v[188:189], v[50:51], 0 cbsz:4 abid:8
    v_rcp_f32 v177, v177
    v_mfma_f32_4x4x4_16b_bf16 v[152:155], v[188:189], v[52:53], 0 cbsz:4 abid:9
    v_rcp_f32 v178, v178
    v_mfma_f32_4x4x4_16b_bf16 v[156:159], v[188:189], v[54:55], 0 cbsz:4 abid:9
    v_rcp_f32 v179, v179
    v_mfma_f32_4x4x4_16b_bf16 v[160:163], v[188:189], v[56:57], 0 cbsz:4 abid:10
    v_rcp_f32 v180, v180
    v_mfma_f32_4x4x4_16b_bf16 v[164:167], v[188:189], v[58:59], 0 cbsz:4 abid:10
    v_rcp_f32 v181, v181
    v_mfma_f32_4x4x4_16b_bf16 v[168:171], v[188:189], v[60:61], 0 cbsz:4 abid:11
    v_rcp_f32 v182, v182
    v_mfma_f32_4x4x4_16b_bf16 v[172:175], v[188:189], v[62:63], 0 cbsz:4 abid:11
    v_rcp_f32 v183, v183
    v_readlane_b32 s64, v228, 3
    v_readlane_b32 s65, v228, 7
    v_readlane_b32 s66, v228, 11
    v_readlane_b32 s67, v228, 15
    v_and_or_b32 v229, v2, s33, v233
    v_pk_mul_f32 v[176:177], v[176:177], v[88:89]
    v_pk_mul_f32 v[178:179], v[178:179], v[90:91]
    v_pk_mul_f32 v[180:181], v[180:181], v[104:105]
    v_pk_mul_f32 v[182:183], v[182:183], v[106:107]
    s_set_gpr_idx_on s72, gpr_idx(SRC2,DST)
    v_pk_fma_f32 v[8:9], v[176:177], v[144:145], v[8:9] op_sel:[0,0,0] op_sel_hi:[0,1,1]
    v_pk_fma_f32 v[10:11], v[176:177], v[146:147], v[10:11] op_sel:[0,0,0] op_sel_hi:[0,1,1]
    v_pk_fma_f32 v[12:13], v[180:181], v[148:149], v[12:13] op_sel:[0,0,0] op_sel_hi:[0,1,1]
    v_pk_fma_f32 v[14:15], v[180:181], v[150:151], v[14:15] op_sel:[0,0,0] op_sel_hi:[0,1,1]
    s_set_gpr_idx_idx s73
    v_pk_fma_f32 v[8:9], v[176:177], v[152:153], v[8:9] op_sel:[1,0,0] op_sel_hi:[1,1,1]
    v_pk_fma_f32 v[10:11], v[176:177], v[154:155], v[10:11] op_sel:[1,0,0] op_sel_hi:[1,1,1]
    v_pk_fma_f32 v[12:13], v[180:181], v[156:157], v[12:13] op_sel:[1,0,0] op_sel_hi:[1,1,1]
    v_pk_fma_f32 v[14:15], v[180:181], v[158:159], v[14:15] op_sel:[1,0,0] op_sel_hi:[1,1,1]
    s_set_gpr_idx_idx s74
    v_pk_fma_f32 v[8:9], v[178:179], v[160:161], v[8:9] op_sel:[0,0,0] op_sel_hi:[0,1,1]
    v_pk_fma_f32 v[10:11], v[178:179], v[162:163], v[10:11] op_sel:[0,0,0] op_sel_hi:[0,1,1]
    v_pk_fma_f32 v[12:13], v[182:183], v[164:165], v[12:13] op_sel:[0,0,0] op_sel_hi:[0,1,1]
    v_pk_fma_f32 v[14:15], v[182:183], v[166:167], v[14:15] op_sel:[0,0,0] op_sel_hi:[0,1,1]
    s_set_gpr_idx_idx s75
    v_pk_fma_f32 v[8:9], v[178:179], v[168:169], v[8:9] op_sel:[1,0,0] op_sel_hi:[1,1,1]
    v_pk_fma_f32 v[10:11], v[178:179], v[170:171], v[10:11] op_sel:[1,0,0] op_sel_hi:[1,1,1]
    v_pk_fma_f32 v[12:13], v[182:183], v[172:173], v[12:13] op_sel:[1,0,0] op_sel_hi:[1,1,1]
    v_pk_fma_f32 v[14:15], v[182:183], v[174:175], v[14:15] op_sel:[1,0,0] op_sel_hi:[1,1,1]
    s_set_gpr_idx_off
    s_and_b32 s80, s64, s31
    s_and_b32 s81, s65, s31
    s_and_b32 s82, s66, s31
    s_and_b32 s83, s67, s31
    buffer_load_dwordx4 v[48:51], v232, s[4:7], s80 offen
    buffer_load_dwordx4 v[52:55], v232, s[4:7], s81 offen
    buffer_load_dwordx4 v[56:59], v232, s[4:7], s82 offen
    buffer_load_dwordx4 v[60:63], v232, s[4:7], s83 offen
    s_cmp_le_i32 s30, 44
    s_mov_b64 exec, s[20:21]
    ds_read_b128 v[192:195], v229 offset:46080
    s_mov_b64 exec, -1
    s_cbranch_scc1 L_exit
    s_setprio 0
    v_mfma_f32_32x32x16_bf16 v[128:143], v[196:199], v[212:215], v[128:143]
    v_exp_f32 v176, v92
    v_exp_f32 v177, v93
    v_exp_f32 v178, v94
    v_exp_f32 v179, v95
    v_exp_f32 v180, v108
    v_exp_f32 v181, v109
    v_exp_f32 v182, v110
    v_exp_f32 v183, v111
    v_pk_fma_f32 v[176:177], v[176:177], s[56:57], s[56:57]
    v_pk_fma_f32 v[178:179], v[178:179], s[56:57], s[56:57]
    v_pk_fma_f32 v[180:181], v[180:181], s[56:57], s[56:57]
    v_pk_fma_f32 v[182:183], v[182:183], s[56:57], s[56:57]
    s_waitcnt vmcnt(4)
    v_mfma_f32_4x4x4_16b_bf16 v[144:147], v[188:189], v[64:65], 0 cbsz:4 abid:12
    v_rcp_f32 v176, v176
    v_mfma_f32_4x4x4_16b_bf16 v[148:151], v[188:189], v[66:67], 0 cbsz:4 abid:12
    v_rcp_f32 v177, v177
    v_mfma_f32_4x4x4_16b_bf16 v[152:155], v[188:189], v[68:69], 0 cbsz:4 abid:13
    v_rcp_f32 v178, v178
    v_mfma_f32_4x4x4_16b_bf16 v[156:159], v[188:189], v[70:71], 0 cbsz:4 abid:13
    v_rcp_f32 v179, v179
    v_mfma_f32_4x4x4_16b_bf16 v[160:163], v[188:189], v[72:73], 0 cbsz:4 abid:14
    v_rcp_f32 v180, v180
    v_mfma_f32_4x4x4_16b_bf16 v[164:167], v[188:189], v[74:75], 0 cbsz:4 abid:14
    v_rcp_f32 v181, v181
    v_mfma_f32_4x4x4_16b_bf16 v[168:171], v[188:189], v[76:77], 0 cbsz:4 abid:15
    v_rcp_f32 v182, v182
    v_mfma_f32_4x4x4_16b_bf16 v[172:175], v[188:189], v[78:79], 0 cbsz:4 abid:15
    v_rcp_f32 v183, v183
    v_readlane_b32 s68, v228, 19
    v_readlane_b32 s69, v228, 23
    v_readlane_b32 s70, v228, 27
    v_readlane_b32 s71, v228, 31
    v_pk_mul_f32 v[176:177], v[176:177], v[92:93]
    v_pk_mul_f32 v[178:179], v[178:179], v[94:95]
    v_pk_mul_f32 v[180:181], v[180:181], v[108:109]
    v_pk_mul_f32 v[182:183], v[182:183], v[110:111]
    s_set_gpr_idx_on s76, gpr_idx(SRC2,DST)
    v_pk_fma_f32 v[8:9], v[176:177], v[144:145], v[8:9] op_sel:[0,0,0] op_sel_hi:[0,1,1]
    v_pk_fma_f32 v[10:11], v[176:177], v[146:147], v[10:11] op_sel:[0,0,0] op_sel_hi:[0,1,1]
    v_pk_fma_f32 v[12:13], v[180:181], v[148:149], v[12:13] op_sel:[0,0,0] op_sel_hi:[0,1,1]
    v_pk_fma_f32 v[14:15], v[180:181], v[150:151], v[14:15] op_sel:[0,0,0] op_sel_hi:[0,1,1]
    s_set_gpr_idx_idx s77
    v_pk_fma_f32 v[8:9], v[176:177], v[152:153], v[8:9] op_sel:[1,0,0] op_sel_hi:[1,1,1]
    v_pk_fma_f32 v[10:11], v[176:177], v[154:155], v[10:11] op_sel:[1,0,0] op_sel_hi:[1,1,1]
    v_pk_fma_f32 v[12:13], v[180:181], v[156:157], v[12:13] op_sel:[1,0,0] op_sel_hi:[1,1,1]
    v_pk_fma_f32 v[14:15], v[180:181], v[158:159], v[14:15] op_sel:[1,0,0] op_sel_hi:[1,1,1]
    s_set_gpr_idx_idx s78
    v_pk_fma_f32 v[8:9], v[178:179], v[160:161], v[8:9] op_sel:[0,0,0] op_sel_hi:[0,1,1]
    v_pk_fma_f32 v[10:11], v[178:179], v[162:163], v[10:11] op_sel:[0,0,0] op_sel_hi:[0,1,1]
    v_pk_fma_f32 v[12:13], v[182:183], v[164:165], v[12:13] op_sel:[0,0,0] op_sel_hi:[0,1,1]
    v_pk_fma_f32 v[14:15], v[182:183], v[166:167], v[14:15] op_sel:[0,0,0] op_sel_hi:[0,1,1]
    s_set_gpr_idx_idx s79
    v_pk_fma_f32 v[8:9], v[178:179], v[168:169], v[8:9] op_sel:[1,0,0] op_sel_hi:[1,1,1]
    v_pk_fma_f32 v[10:11], v[178:179], v[170:171], v[10:11] op_sel:[1,0,0] op_sel_hi:[1,1,1]
    v_pk_fma_f32 v[12:13], v[182:183], v[172:173], v[12:13] op_sel:[1,0,0] op_sel_hi:[1,1,1]
    v_pk_fma_f32 v[14:15], v[182:183], v[174:175], v[14:15] op_sel:[1,0,0] op_sel_hi:[1,1,1]
    s_set_gpr_idx_off
    s_and_b32 s80, s68, s31
    s_and_b32 s81, s69, s31
    s_and_b32 s82, s70, s31
    s_and_b32 s83, s71, s31
    buffer_load_dwordx4 v[64:67], v232, s[4:7], s80 offen
    buffer_load_dwordx4 v[68:71], v232, s[4:7], s81 offen
    buffer_load_dwordx4 v[72:75], v232, s[4:7], s82 offen
    buffer_load_dwordx4 v[76:79], v232, s[4:7], s83 offen
    s_cmp_le_i32 s30, 48
    s_waitcnt lgkmcnt(0)
    s_cbranch_scc1 L_exit
    s_setprio 3
    v_mfma_f32_32x32x16_bf16 v[80:95], v[192:195], v[200:203], 0
    v_exp_f32 v176, v112
    v_exp_f32 v177, v113
    v_exp_f32 v178, v114
    v_exp_f32 v179, v115
    v_exp_f32 v180, v128
    v_exp_f32 v181, v129
    v_exp_f32 v182, v130
    v_exp_f32 v183, v131
    v_pk_fma_f32 v[176:177], v[176:177], s[56:57], s[56:57]
    v_pk_fma_f32 v[178:179], v[178:179], s[56:57], s[56:57]
    v_pk_fma_f32 v[180:181], v[180:181], s[56:57], s[56:57]
    v_pk_fma_f32 v[182:183], v[182:183], s[56:57], s[56:57]
    s_waitcnt vmcnt(4)
    v_mfma_f32_4x4x4_16b_bf16 v[144:147], v[190:191], v[48:49], 0 cbsz:4 abid:0
    v_rcp_f32 v176, v176
    v_mfma_f32_4x4x4_16b_bf16 v[148:151], v[190:191], v[50:51], 0 cbsz:4 abid:0
    v_rcp_f32 v177, v177
    v_mfma_f32_4x4x4_16b_bf16 v[152:155], v[190:191], v[52:53], 0 cbsz:4 abid:1
    v_rcp_f32 v178, v178
    v_mfma_f32_4x4x4_16b_bf16 v[156:159], v[190:191], v[54:55], 0 cbsz:4 abid:1
    v_rcp_f32 v179, v179
    v_mfma_f32_4x4x4_16b_bf16 v[160:163], v[190:191], v[56:57], 0 cbsz:4 abid:2
    v_rcp_f32 v180, v180
    v_mfma_f32_4x4x4_16b_bf16 v[164:167], v[190:191], v[58:59], 0 cbsz:4 abid:2
    v_rcp_f32 v181, v181
    v_mfma_f32_4x4x4_16b_bf16 v[168:171], v[190:191], v[60:61], 0 cbsz:4 abid:3
    v_rcp_f32 v182, v182
    v_mfma_f32_4x4x4_16b_bf16 v[172:175], v[190:191], v[62:63], 0 cbsz:4 abid:3
    v_rcp_f32 v183, v183
    v_readlane_b32 s72, v228, 35
    v_readlane_b32 s73, v228, 39
    v_readlane_b32 s74, v228, 43
    v_readlane_b32 s75, v228, 47
    v_pk_mul_f32 v[176:177], v[176:177], v[112:113]
    v_pk_mul_f32 v[178:179], v[178:179], v[114:115]
    v_pk_mul_f32 v[180:181], v[180:181], v[128:129]
    v_pk_mul_f32 v[182:183], v[182:183], v[130:131]
    s_set_gpr_idx_on s64, gpr_idx(SRC2,DST)
    v_pk_fma_f32 v[8:9], v[176:177], v[144:145], v[8:9] op_sel:[0,0,0] op_sel_hi:[0,1,1]
    v_pk_fma_f32 v[10:11], v[176:177], v[146:147], v[10:11] op_sel:[0,0,0] op_sel_hi:[0,1,1]
    v_pk_fma_f32 v[12:13], v[180:181], v[148:149], v[12:13] op_sel:[0,0,0] op_sel_hi:[0,1,1]
    v_pk_fma_f32 v[14:15], v[180:181], v[150:151], v[14:15] op_sel:[0,0,0] op_sel_hi:[0,1,1]
    s_set_gpr_idx_idx s65
    v_pk_fma_f32 v[8:9], v[176:177], v[152:153], v[8:9] op_sel:[1,0,0] op_sel_hi:[1,1,1]
    v_pk_fma_f32 v[10:11], v[176:177], v[154:155], v[10:11] op_sel:[1,0,0] op_sel_hi:[1,1,1]
    v_pk_fma_f32 v[12:13], v[180:181], v[156:157], v[12:13] op_sel:[1,0,0] op_sel_hi:[1,1,1]
    v_pk_fma_f32 v[14:15], v[180:181], v[158:159], v[14:15] op_sel:[1,0,0] op_sel_hi:[1,1,1]
    s_set_gpr_idx_idx s66
    v_pk_fma_f32 v[8:9], v[178:179], v[160:161], v[8:9] op_sel:[0,0,0] op_sel_hi:[0,1,1]
    v_pk_fma_f32 v[10:11], v[178:179], v[162:163], v[10:11] op_sel:[0,0,0] op_sel_hi:[0,1,1]
    v_pk_fma_f32 v[12:13], v[182:183], v[164:165], v[12:13] op_sel:[0,0,0] op_sel_hi:[0,1,1]
    v_pk_fma_f32 v[14:15], v[182:183], v[166:167], v[14:15] op_sel:[0,0,0] op_sel_hi:[0,1,1]
    s_set_gpr_idx_idx s67
    v_pk_fma_f32 v[8:9], v[178:179], v[168:169], v[8:9] op_sel:[1,0,0] op_sel_hi:[1,1,1]
    v_pk_fma_f32 v[10:11], v[178:179], v[170:171], v[10:11] op_sel:[1,0,0] op_sel_hi:[1,1,1]
    v_pk_fma_f32 v[12:13], v[182:183], v[172:173], v[12:13] op_sel:[1,0,0] op_sel_hi:[1,1,1]
    v_pk_fma_f32 v[14:15], v[182:183], v[174:175], v[14:15] op_sel:[1,0,0] op_sel_hi:[1,1,1]
    s_set_gpr_idx_off
    s_and_b32 s80, s72, s31
    s_and_b32 s81, s73, s31
    s_and_b32 s82, s74, s31
    s_and_b32 s83, s75, s31
    buffer_load_dwordx4 v[48:51], v232, s[4:7], s80 offen
    buffer_load_dwordx4 v[52:55], v232, s[4:7], s81 offen
    buffer_load_dwordx4 v[56:59], v232, s[4:7], s82 offen
    buffer_load_dwordx4 v[60:63], v232, s[4:7], s83 offen
    s_cmp_le_i32 s30, 52
    s_mov_b64 exec, s[22:23]
    ds_read_b128 v[196:199], v229 offset:46080
    s_mov_b64 exec, -1
    ds_read_b32 v2, v231 offset:1292
    s_cbranch_scc1 L_exit
    s_setprio 2
    v_mfma_f32_32x32x16_bf16 v[96:111], v[192:195], v[204:207], 0
    v_exp_f32 v176, v116
    v_exp_f32 v177, v117
    v_exp_f32 v178, v118
    v_exp_f32 v179, v119
    v_exp_f32 v180, v132
    v_exp_f32 v181, v133
    v_exp_f32 v182, v134
    v_exp_f32 v183, v135
    v_pk_fma_f32 v[176:177], v[176:177], s[56:57], s[56:57]
    v_pk_fma_f32 v[178:179], v[178:179], s[56:57], s[56:57]
    v_pk_fma_f32 v[180:181], v[180:181], s[56:57], s[56:57]
    v_pk_fma_f32 v[182:183], v[182:183], s[56:57], s[56:57]
    s_waitcnt vmcnt(4)
    v_mfma_f32_4x4x4_16b_bf16 v[144:147], v[190:191], v[64:65], 0 cbsz:4 abid:4
    v_rcp_f32 v176, v176
    v_mfma_f32_4x4x4_16b_bf16 v[148:151], v[190:191], v[66:67], 0 cbsz:4 abid:4
    v_rcp_f32 v177, v177
    v_mfma_f32_4x4x4_16b_bf16 v[152:155], v[190:191], v[68:69], 0 cbsz:4 abid:5
    v_rcp_f32 v178, v178
    v_mfma_f32_4x4x4_16b_bf16 v[156:159], v[190:191], v[70:71], 0 cbsz:4 abid:5
    v_rcp_f32 v179, v179
    v_mfma_f32_4x4x4_16b_bf16 v[160:163], v[190:191], v[72:73], 0 cbsz:4 abid:6
    v_rcp_f32 v180, v180
    v_mfma_f32_4x4x4_16b_bf16 v[164:167], v[190:191], v[74:75], 0 cbsz:4 abid:6
    v_rcp_f32 v181, v181
    v_mfma_f32_4x4x4_16b_bf16 v[168:171], v[190:191], v[76:77], 0 cbsz:4 abid:7
    v_rcp_f32 v182, v182
    v_mfma_f32_4x4x4_16b_bf16 v[172:175], v[190:191], v[78:79], 0 cbsz:4 abid:7
    v_rcp_f32 v183, v183
    v_readlane_b32 s76, v228, 51
    v_readlane_b32 s77, v228, 55
    v_readlane_b32 s78, v228, 59
    v_readlane_b32 s79, v228, 63
    v_pk_mul_f32 v[176:177], v[176:177], v[116:117]
    v_pk_mul_f32 v[178:179], v[178:179], v[118:119]
    v_pk_mul_f32 v[180:181], v[180:181], v[132:133]
    v_pk_mul_f32 v[182:183], v[182:183], v[134:135]
    s_set_gpr_idx_on s68, gpr_idx(SRC2,DST)
    v_pk_fma_f32 v[8:9], v[176:177], v[144:145], v[8:9] op_sel:[0,0,0] op_sel_hi:[0,1,1]
    v_pk_fma_f32 v[10:11], v[176:177], v[146:147], v[10:11] op_sel:[0,0,0] op_sel_hi:[0,1,1]
    v_pk_fma_f32 v[12:13], v[180:181], v[148:149], v[12:13] op_sel:[0,0,0] op_sel_hi:[0,1,1]
    v_pk_fma_f32 v[14:15], v[180:181], v[150:151], v[14:15] op_sel:[0,0,0] op_sel_hi:[0,1,1]
    s_set_gpr_idx_idx s69
    v_pk_fma_f32 v[8:9], v[176:177], v[152:153], v[8:9] op_sel:[1,0,0] op_sel_hi:[1,1,1]
    v_pk_fma_f32 v[10:11], v[176:177], v[154:155], v[10:11] op_sel:[1,0,0] op_sel_hi:[1,1,1]
    v_pk_fma_f32 v[12:13], v[180:181], v[156:157], v[12:13] op_sel:[1,0,0] op_sel_hi:[1,1,1]
    v_pk_fma_f32 v[14:15], v[180:181], v[158:159], v[14:15] op_sel:[1,0,0] op_sel_hi:[1,1,1]
    s_set_gpr_idx_idx s70
    v_pk_fma_f32 v[8:9], v[178:179], v[160:161], v[8:9] op_sel:[0,0,0] op_sel_hi:[0,1,1]
    v_pk_fma_f32 v[10:11], v[178:179], v[162:163], v[10:11] op_sel:[0,0,0] op_sel_hi:[0,1,1]
    v_pk_fma_f32 v[12:13], v[182:183], v[164:165], v[12:13] op_sel:[0,0,0] op_sel_hi:[0,1,1]
    v_pk_fma_f32 v[14:15], v[182:183], v[166:167], v[14:15] op_sel:[0,0,0] op_sel_hi:[0,1,1]
    s_set_gpr_idx_idx s71
    v_pk_fma_f32 v[8:9], v[178:179], v[168:169], v[8:9] op_sel:[1,0,0] op_sel_hi:[1,1,1]
    v_pk_fma_f32 v[10:11], v[178:179], v[170:171], v[10:11] op_sel:[1,0,0] op_sel_hi:[1,1,1]
    v_pk_fma_f32 v[12:13], v[182:183], v[172:173], v[12:13] op_sel:[1,0,0] op_sel_hi:[1,1,1]
    v_pk_fma_f32 v[14:15], v[182:183], v[174:175], v[14:15] op_sel:[1,0,0] op_sel_hi:[1,1,1]
    s_set_gpr_idx_off
    s_and_b32 s80, s76, s31
    s_and_b32 s81, s77, s31
    s_and_b32 s82, s78, s31
    s_and_b32 s83, s79, s31
    buffer_load_dwordx4 v[64:67], v232, s[4:7], s80 offen
    buffer_load_dwordx4 v[68:71], v232, s[4:7], s81 offen
    buffer_load_dwordx4 v[72:75], v232, s[4:7], s82 offen
    buffer_load_dwordx4 v[76:79], v232, s[4:7], s83 offen
    s_cmp_le_i32 s30, 56
    s_waitcnt lgkmcnt(0)
    s_cbranch_scc1 L_exit
    s_setprio 1
    v_cndmask_b32 v228, v4, v226, s[34:35]
    v_mfma_f32_32x32x16_bf16 v[80:95], v[196:199], v[208:211], v[80:95]
    v_exp_f32 v176, v120
    v_exp_f32 v177, v121
    v_exp_f32 v178, v122
    v_exp_f32 v179, v123
    v_exp_f32 v180, v136
    v_exp_f32 v181, v137
    v_exp_f32 v182, v138
    v_exp_f32 v183, v139
    v_pk_fma_f32 v[176:177], v[176:177], s[56:57], s[56:57]
    v_pk_fma_f32 v[178:179], v[178:179], s[56:57], s[56:57]
    v_pk_fma_f32 v[180:181], v[180:181], s[56:57], s[56:57]
    v_pk_fma_f32 v[182:183], v[182:183], s[56:57], s[56:57]
    s_waitcnt vmcnt(4)
    v_mfma_f32_4x4x4_16b_bf16 v[144:147], v[190:191], v[48:49], 0 cbsz:4 abid:8
    v_rcp_f32 v176, v176
    v_mfma_f32_4x4x4_16b_bf16 v[148:151], v[190:191], v[50:51], 0 cbsz:4 abid:8
    v_rcp_f32 v177, v177
    v_mfma_f32_4x4x4_16b_bf16 v[152:155], v[190:191], v[52:53], 0 cbsz:4 abid:9
    v_rcp_f32 v178, v178
    v_mfma_f32_4x4x4_16b_bf16 v[156:159], v[190:191], v[54:55], 0 cbsz:4 abid:9
    v_rcp_f32 v179, v179
    v_mfma_f32_4x4x4_16b_bf16 v[160:163], v[190:191], v[56:57], 0 cbsz:4 abid:10
    v_rcp_f32 v180, v180
    v_mfma_f32_4x4x4_16b_bf16 v[164:167], v[190:191], v[58:59], 0 cbsz:4 abid:10
    v_rcp_f32 v181, v181
    v_mfma_f32_4x4x4_16b_bf16 v[168:171], v[190:191], v[60:61], 0 cbsz:4 abid:11
    v_rcp_f32 v182, v182
    v_mfma_f32_4x4x4_16b_bf16 v[172:175], v[190:191], v[62:63], 0 cbsz:4 abid:11
    v_rcp_f32 v183, v183
    v_readlane_b32 s64, v228, 0
    v_readlane_b32 s65, v228, 4
    v_readlane_b32 s66, v228, 8
    v_readlane_b32 s67, v228, 12
    v_and_or_b32 v229, v2, s33, v233
    v_pk_mul_f32 v[176:177], v[176:177], v[120:121]
    v_pk_mul_f32 v[178:179], v[178:179], v[122:123]
    v_pk_mul_f32 v[180:181], v[180:181], v[136:137]
    v_pk_mul_f32 v[182:183], v[182:183], v[138:139]
    s_set_gpr_idx_on s72, gpr_idx(SRC2,DST)
    v_pk_fma_f32 v[8:9], v[176:177], v[144:145], v[8:9] op_sel:[0,0,0] op_sel_hi:[0,1,1]
    v_pk_fma_f32 v[10:11], v[176:177], v[146:147], v[10:11] op_sel:[0,0,0] op_sel_hi:[0,1,1]
    v_pk_fma_f32 v[12:13], v[180:181], v[148:149], v[12:13] op_sel:[0,0,0] op_sel_hi:[0,1,1]
    v_pk_fma_f32 v[14:15], v[180:181], v[150:151], v[14:15] op_sel:[0,0,0] op_sel_hi:[0,1,1]
    s_set_gpr_idx_idx s73
    v_pk_fma_f32 v[8:9], v[176:177], v[152:153], v[8:9] op_sel:[1,0,0] op_sel_hi:[1,1,1]
    v_pk_fma_f32 v[10:11], v[176:177], v[154:155], v[10:11] op_sel:[1,0,0] op_sel_hi:[1,1,1]
    v_pk_fma_f32 v[12:13], v[180:181], v[156:157], v[12:13] op_sel:[1,0,0] op_sel_hi:[1,1,1]
    v_pk_fma_f32 v[14:15], v[180:181], v[158:159], v[14:15] op_sel:[1,0,0] op_sel_hi:[1,1,1]
    s_set_gpr_idx_idx s74
    v_pk_fma_f32 v[8:9], v[178:179], v[160:161], v[8:9] op_sel:[0,0,0] op_sel_hi:[0,1,1]
    v_pk_fma_f32 v[10:11], v[178:179], v[162:163], v[10:11] op_sel:[0,0,0] op_sel_hi:[0,1,1]
    v_pk_fma_f32 v[12:13], v[182:183], v[164:165], v[12:13] op_sel:[0,0,0] op_sel_hi:[0,1,1]
    v_pk_fma_f32 v[14:15], v[182:183], v[166:167], v[14:15] op_sel:[0,0,0] op_sel_hi:[0,1,1]
    s_set_gpr_idx_idx s75
    v_pk_fma_f32 v[8:9], v[178:179], v[168:169], v[8:9] op_sel:[1,0,0] op_sel_hi:[1,1,1]
    v_pk_fma_f32 v[10:11], v[178:179], v[170:171], v[10:11] op_sel:[1,0,0] op_sel_hi:[1,1,1]
    v_pk_fma_f32 v[12:13], v[182:183], v[172:173], v[12:13] op_sel:[1,0,0] op_sel_hi:[1,1,1]
    v_pk_fma_f32 v[14:15], v[182:183], v[174:175], v[14:15] op_sel:[1,0,0] op_sel_hi:[1,1,1]
    s_set_gpr_idx_off
    s_and_b32 s80, s64, s31
    s_and_b32 s81, s65, s31
    s_and_b32 s82, s66, s31
    s_and_b32 s83, s67, s31
    buffer_load_dwordx4 v[48:51], v232, s[4:7], s80 offen
    buffer_load_dwordx4 v[52:55], v232, s[4:7], s81 offen
    buffer_load_dwordx4 v[56:59], v232, s[4:7], s82 offen
    buffer_load_dwordx4 v[60:63], v232, s[4:7], s83 offen
    s_cmp_le_i32 s30, 60
    s_mov_b64 exec, s[20:21]
    ds_read_b128 v[192:195], v229 offset:46080
    s_mov_b64 exec, -1
    s_cbranch_scc1 L_exit
    s_setprio 0
    v_mfma_f32_32x32x16_bf16 v[96:111], v[196:199], v[212:215], v[96:111]
    v_exp_f32 v176, v124
    v_exp_f32 v177, v125
    v_exp_f32 v178, v126
    v_exp_f32 v179, v127
    v_exp_f32 v180, v140
    v_exp_f32 v181, v141
    v_exp_f32 v182, v142
    v_exp_f32 v183, v143
    v_pk_fma_f32 v[176:177], v[176:177], s[56:57], s[56:57]
    v_pk_fma_f32 v[178:179], v[178:179], s[56:57], s[56:57]
    v_pk_fma_f32 v[180:181], v[180:181], s[56:57], s[56:57]
    v_pk_fma_f32 v[182:183], v[182:183], s[56:57], s[56:57]
    s_waitcnt vmcnt(4)
    v_mfma_f32_4x4x4_16b_bf16 v[144:147], v[190:191], v[64:65], 0 cbsz:4 abid:12
    v_rcp_f32 v176, v176
    v_mfma_f32_4x4x4_16b_bf16 v[148:151], v[190:191], v[66:67], 0 cbsz:4 abid:12
    v_rcp_f32 v177, v177
    v_mfma_f32_4x4x4_16b_bf16 v[152:155], v[190:191], v[68:69], 0 cbsz:4 abid:13
    v_rcp_f32 v178, v178
    v_mfma_f32_4x4x4_16b_bf16 v[156:159], v[190:191], v[70:71], 0 cbsz:4 abid:13
    v_rcp_f32 v179, v179
    v_mfma_f32_4x4x4_16b_bf16 v[160:163], v[190:191], v[72:73], 0 cbsz:4 abid:14
    v_rcp_f32 v180, v180
    v_mfma_f32_4x4x4_16b_bf16 v[164:167], v[190:191], v[74:75], 0 cbsz:4 abid:14
    v_rcp_f32 v181, v181
    v_mfma_f32_4x4x4_16b_bf16 v[168:171], v[190:191], v[76:77], 0 cbsz:4 abid:15
    v_rcp_f32 v182, v182
    v_mfma_f32_4x4x4_16b_bf16 v[172:175], v[190:191], v[78:79], 0 cbsz:4 abid:15
    v_rcp_f32 v183, v183
    v_readlane_b32 s68, v228, 16
    v_readlane_b32 s69, v228, 20
    v_readlane_b32 s70, v228, 24
    v_readlane_b32 s71, v228, 28
    v_pk_mul_f32 v[176:177], v[176:177], v[124:125]
    v_pk_mul_f32 v[178:179], v[178:179], v[126:127]
    v_pk_mul_f32 v[180:181], v[180:181], v[140:141]
    v_pk_mul_f32 v[182:183], v[182:183], v[142:143]
    s_set_gpr_idx_on s76, gpr_idx(SRC2,DST)
    v_pk_fma_f32 v[8:9], v[176:177], v[144:145], v[8:9] op_sel:[0,0,0] op_sel_hi:[0,1,1]
    v_pk_fma_f32 v[10:11], v[176:177], v[146:147], v[10:11] op_sel:[0,0,0] op_sel_hi:[0,1,1]
    v_pk_fma_f32 v[12:13], v[180:181], v[148:149], v[12:13] op_sel:[0,0,0] op_sel_hi:[0,1,1]
    v_pk_fma_f32 v[14:15], v[180:181], v[150:151], v[14:15] op_sel:[0,0,0] op_sel_hi:[0,1,1]
    s_set_gpr_idx_idx s77
    v_pk_fma_f32 v[8:9], v[176:177], v[152:153], v[8:9] op_sel:[1,0,0] op_sel_hi:[1,1,1]
    v_pk_fma_f32 v[10:11], v[176:177], v[154:155], v[10:11] op_sel:[1,0,0] op_sel_hi:[1,1,1]
    v_pk_fma_f32 v[12:13], v[180:181], v[156:157], v[12:13] op_sel:[1,0,0] op_sel_hi:[1,1,1]
    v_pk_fma_f32 v[14:15], v[180:181], v[158:159], v[14:15] op_sel:[1,0,0] op_sel_hi:[1,1,1]
    s_set_gpr_idx_idx s78
    v_pk_fma_f32 v[8:9], v[178:179], v[160:161], v[8:9] op_sel:[0,0,0] op_sel_hi:[0,1,1]
    v_pk_fma_f32 v[10:11], v[178:179], v[162:163], v[10:11] op_sel:[0,0,0] op_sel_hi:[0,1,1]
    v_pk_fma_f32 v[12:13], v[182:183], v[164:165], v[12:13] op_sel:[0,0,0] op_sel_hi:[0,1,1]
    v_pk_fma_f32 v[14:15], v[182:183], v[166:167], v[14:15] op_sel:[0,0,0] op_sel_hi:[0,1,1]
    s_set_gpr_idx_idx s79
    v_pk_fma_f32 v[8:9], v[178:179], v[168:169], v[8:9] op_sel:[1,0,0] op_sel_hi:[1,1,1]
    v_pk_fma_f32 v[10:11], v[178:179], v[170:171], v[10:11] op_sel:[1,0,0] op_sel_hi:[1,1,1]
    v_pk_fma_f32 v[12:13], v[182:183], v[172:173], v[12:13] op_sel:[1,0,0] op_sel_hi:[1,1,1]
    v_pk_fma_f32 v[14:15], v[182:183], v[174:175], v[14:15] op_sel:[1,0,0] op_sel_hi:[1,1,1]
    s_set_gpr_idx_off
    s_and_b32 s80, s68, s31
    s_and_b32 s81, s69, s31
    s_and_b32 s82, s70, s31
    s_and_b32 s83, s71, s31
    buffer_load_dwordx4 v[64:67], v232, s[4:7], s80 offen
    buffer_load_dwordx4 v[68:71], v232, s[4:7], s81 offen
    buffer_load_dwordx4 v[72:75], v232, s[4:7], s82 offen
    buffer_load_dwordx4 v[76:79], v232, s[4:7], s83 offen
    s_waitcnt lgkmcnt(0)
    v_add_u32 v231, 1024, v231
    s_sub_u32 s30, s30, 64
    s_branch L_sb
L_exit:
    s_setprio 0
    s_add_u32 s24, s24, 216
    s_cmp_lt_u32 s24, s25
    s_cbranch_scc1 L_next
    v_lshlrev_b32 v5, 2, v1
    v_add_u32 v3, s48, v5
    v_cvt_pk_bf16_f32 v8, v8, v12
    v_cvt_pk_bf16_f32 v9, v9, v13
    v_cvt_pk_bf16_f32 v10, v10, v14
    v_cvt_pk_bf16_f32 v11, v11, v15
    ds_write2_b32 v3, v8, v9 offset0:0 offset1:72
    ds_write2_b32 v3, v10, v11 offset0:144 offset1:216
    v_add_u32 v3, s49, v5
    v_cvt_pk_bf16_f32 v16, v16, v20
    v_cvt_pk_bf16_f32 v17, v17, v21
    v_cvt_pk_bf16_f32 v18, v18, v22
    v_cvt_pk_bf16_f32 v19, v19, v23
    ds_write2_b32 v3, v16, v17 offset0:0 offset1:72
    ds_write2_b32 v3, v18, v19 offset0:144 offset1:216
    v_add_u32 v3, s50, v5
    v_cvt_pk_bf16_f32 v24, v24, v28
    v_cvt_pk_bf16_f32 v25, v25, v29
    v_cvt_pk_bf16_f32 v26, v26, v30
    v_cvt_pk_bf16_f32 v27, v27, v31
    ds_write2_b32 v3, v24, v25 offset0:0 offset1:72
    ds_write2_b32 v3, v26, v27 offset0:144 offset1:216
    v_add_u32 v3, s51, v5
    v_cvt_pk_bf16_f32 v32, v32, v36
    v_cvt_pk_bf16_f32 v33, v33, v37
    v_cvt_pk_bf16_f32 v34, v34, v38
    v_cvt_pk_bf16_f32 v35, v35, v39
    ds_write2_b32 v3, v32, v33 offset0:0 offset1:72
    ds_write2_b32 v3, v34, v35 offset0:144 offset1:216
    v_add_u32 v3, s52, v5
    v_cvt_pk_bf16_f32 v40, v40, v44
    v_cvt_pk_bf16_f32 v41, v41, v45
    v_cvt_pk_bf16_f32 v42, v42, v46
    v_cvt_pk_bf16_f32 v43, v43, v47
    ds_write2_b32 v3, v40, v41 offset0:0 offset1:72
    ds_write2_b32 v3, v42, v43 offset0:144 offset1:216
    s_waitcnt lgkmcnt(10)
    v_readfirstlane_b32 s38, v243
    s_cmp_eq_u32 s38, 8
    s_cbranch_scc0 L_nob
    ds_read_b128 v[192:195], v240 offset:0
    ds_read_b128 v[208:211], v240 offset:256
    ds_read_b128 v[196:199], v240 offset:8192
    ds_read_b128 v[212:215], v240 offset:8448
    ds_read_b128 v[200:203], v240 offset:16384
    ds_read_b128 v[216:219], v240 offset:16640
    ds_read_b128 v[204:207], v240 offset:24576
    ds_read_b128 v[220:223], v240 offset:24832
    s_waitcnt lgkmcnt(8)
    s_barrier
    s_branch L_haveb
L_nob:
    s_waitcnt lgkmcnt(0)
    s_barrier
    ds_read_b128 v[192:195], v240 offset:0
    ds_read_b128 v[208:211], v240 offset:256
    ds_read_b128 v[196:199], v240 offset:8192
    ds_read_b128 v[212:215], v240 offset:8448
    ds_read_b128 v[200:203], v240 offset:16384
    ds_read_b128 v[216:219], v240 offset:16640
    ds_read_b128 v[204:207], v240 offset:24576
    ds_read_b128 v[220:223], v240 offset:24832
L_haveb:
    ds_read_b128 v[80:83], v241 offset:0
    ds_read_b128 v[84:87], v241 offset:64
    ds_read_b128 v[88:91], v241 offset:128
    ds_read_b128 v[92:95], v241 offset:192
    s_waitcnt lgkmcnt(3)
    v_mfma_f32_16x16x32_bf16 v[8:11], v[80:83], v[192:195], 0
    ds_read_b128 v[96:99], v241 offset:4608
    v_mfma_f32_16x16x32_bf16 v[12:15], v[80:83], v[208:211], 0
    s_waitcnt lgkmcnt(3)
    v_mfma_f32_16x16x32_bf16 v[8:11], v[84:87], v[196:199], v[8:11]
    ds_read_b128 v[100:103], v241 offset:4672
    v_mfma_f32_16x16x32_bf16 v[12:15], v[84:87], v[212:215], v[12:15]
    s_waitcnt lgkmcnt(3)
    v_mfma_f32_16x16x32_bf16 v[8:11], v[88:91], v[200:203], v[8:11]
    ds_read_b128 v[104:107], v241 offset:4736
    v_mfma_f32_16x16x32_bf16 v[12:15], v[88:91], v[216:219], v[12:15]
    s_waitcnt lgkmcnt(3)
    v_mfma_f32_16x16x32_bf16 v[8:11], v[92:95], v[204:207], v[8:11]
    ds_read_b128 v[108:111], v241 offset:4800
    v_mfma_f32_16x16x32_bf16 v[12:15], v[92:95], v[220:223], v[12:15]
    s_waitcnt lgkmcnt(3)
    v_mfma_f32_16x16x32_bf16 v[16:19], v[96:99], v[192:195], 0
    ds_read_b128 v[112:115], v241 offset:9216
    v_mfma_f32_16x16x32_bf16 v[20:23], v[96:99], v[208:211], 0
    s_waitcnt lgkmcnt(3)
    v_mfma_f32_16x16x32_bf16 v[16:19], v[100:103], v[196:199], v[16:19]
    ds_read_b128 v[116:119], v241 offset:9280
    v_mfma_f32_16x16x32_bf16 v[20:23], v[100:103], v[212:215], v[20:23]
    v_cvt_pk_bf16_f32 v160, v8, v9
    v_cvt_pk_bf16_f32 v161, v10, v11
    v_cvt_pk_bf16_f32 v162, v12, v13
    v_cvt_pk_bf16_f32 v163, v14, v15
    buffer_store_dwordx4 v[160:163], v242, s[12:15], 0 offen sc1
    v_add_u32 v242, 1048576, v242
    s_waitcnt lgkmcnt(3)
    v_mfma_f32_16x16x32_bf16 v[16:19], v[104:107], v[200:203], v[16:19]
    ds_read_b128 v[120:123], v241 offset:9344
    v_mfma_f32_16x16x32_bf16 v[20:23], v[104:107], v[216:219], v[20:23]
    s_waitcnt lgkmcnt(3)
    v_mfma_f32_16x16x32_bf16 v[16:19], v[108:111], v[204:207], v[16:19]
    ds_read_b128 v[124:127], v241 offset:9408
    v_mfma_f32_16x16x32_bf16 v[20:23], v[108:111], v[220:223], v[20:23]
    s_waitcnt lgkmcnt(3)
    v_mfma_f32_16x16x32_bf16 v[24:27], v[112:115], v[192:195], 0
    ds_read_b128 v[128:131], v241 offset:13824
    v_mfma_f32_16x16x32_bf16 v[28:31], v[112:115], v[208:211], 0
    s_waitcnt lgkmcnt(3)
    v_mfma_f32_16x16x32_bf16 v[24:27], v[116:119], v[196:199], v[24:27]
    ds_read_b128 v[132:135], v241 offset:13888
    v_mfma_f32_16x16x32_bf16 v[28:31], v[116:119], v[212:215], v[28:31]
    v_cvt_pk_bf16_f32 v164, v16, v17
    v_cvt_pk_bf16_f32 v165, v18, v19
    v_cvt_pk_bf16_f32 v166, v20, v21
    v_cvt_pk_bf16_f32 v167, v22, v23
    buffer_store_dwordx4 v[164:167], v242, s[12:15], 0 offen sc1
    v_add_u32 v242, 1048576, v242
    s_waitcnt lgkmcnt(3)
    v_mfma_f32_16x16x32_bf16 v[24:27], v[120:123], v[200:203], v[24:27]
    ds_read_b128 v[136:139], v241 offset:13952
    v_mfma_f32_16x16x32_bf16 v[28:31], v[120:123], v[216:219], v[28:31]
    s_waitcnt lgkmcnt(3)
    v_mfma_f32_16x16x32_bf16 v[24:27], v[124:127], v[204:207], v[24:27]
    ds_read_b128 v[140:143], v241 offset:14016
    v_mfma_f32_16x16x32_bf16 v[28:31], v[124:127], v[220:223], v[28:31]
    s_waitcnt lgkmcnt(3)
    v_mfma_f32_16x16x32_bf16 v[32:35], v[128:131], v[192:195], 0
    ds_read_b128 v[144:147], v241 offset:18432
    v_mfma_f32_16x16x32_bf16 v[36:39], v[128:131], v[208:211], 0
    s_waitcnt lgkmcnt(3)
    v_mfma_f32_16x16x32_bf16 v[32:35], v[132:135], v[196:199], v[32:35]
    ds_read_b128 v[148:151], v241 offset:18496
    v_mfma_f32_16x16x32_bf16 v[36:39], v[132:135], v[212:215], v[36:39]
    v_cvt_pk_bf16_f32 v168, v24, v25
    v_cvt_pk_bf16_f32 v169, v26, v27
    v_cvt_pk_bf16_f32 v170, v28, v29
    v_cvt_pk_bf16_f32 v171, v30, v31
    buffer_store_dwordx4 v[168:171], v242, s[12:15], 0 offen sc1
    v_add_u32 v242, 1048576, v242
    s_waitcnt lgkmcnt(3)
    v_mfma_f32_16x16x32_bf16 v[32:35], v[136:139], v[200:203], v[32:35]
    ds_read_b128 v[152:155], v241 offset:18560
    v_mfma_f32_16x16x32_bf16 v[36:39], v[136:139], v[216:219], v[36:39]
    s_waitcnt lgkmcnt(3)
    v_mfma_f32_16x16x32_bf16 v[32:35], v[140:143], v[204:207], v[32:35]
    ds_read_b128 v[156:159], v241 offset:18624
    v_mfma_f32_16x16x32_bf16 v[36:39], v[140:143], v[220:223], v[36:39]
    s_waitcnt lgkmcnt(3)
    v_mfma_f32_16x16x32_bf16 v[40:43], v[144:147], v[192:195], 0
    v_mfma_f32_16x16x32_bf16 v[44:47], v[144:147], v[208:211], 0
    s_waitcnt lgkmcnt(2)
    v_mfma_f32_16x16x32_bf16 v[40:43], v[148:151], v[196:199], v[40:43]
    v_mfma_f32_16x16x32_bf16 v[44:47], v[148:151], v[212:215], v[44:47]
    s_waitcnt lgkmcnt(1)
    v_mfma_f32_16x16x32_bf16 v[40:43], v[152:155], v[200:203], v[40:43]
    v_mfma_f32_16x16x32_bf16 v[44:47], v[152:155], v[216:219], v[44:47]
    v_cvt_pk_bf16_f32 v172, v32, v33
    v_cvt_pk_bf16_f32 v173, v34, v35
    v_cvt_pk_bf16_f32 v174, v36, v37
    v_cvt_pk_bf16_f32 v175, v38, v39
    buffer_store_dwordx4 v[172:175], v242, s[12:15], 0 offen sc1
    v_add_u32 v242, 1048576, v242
    s_waitcnt lgkmcnt(0)
    v_mfma_f32_16x16x32_bf16 v[40:43], v[156:159], v[204:207], v[40:43]
    v_mfma_f32_16x16x32_bf16 v[44:47], v[156:159], v[220:223], v[44:47]
    s_nop 7
    v_cvt_pk_bf16_f32 v160, v40, v41
    v_cvt_pk_bf16_f32 v161, v42, v43
    v_cvt_pk_bf16_f32 v162, v44, v45
    v_cvt_pk_bf16_f32 v163, v46, v47
    buffer_store_dwordx4 v[160:163], v242, s[12:15], 0 offen sc1
L_end:
    s_endpgm
L_next:
    s_waitcnt vmcnt(0) lgkmcnt(0)
    v_lshlrev_b32 v7, 3, v0
    v_mov_b32 v2, 0
    v_mov_b32 v3, 0
    ds_write_b64 v7, v[2:3]
    s_nop 15
    s_mul_i32 s26, s16, 5
    v_add_u32 v113, s26, v1
    v_subrev_u32 v3, 40, v113
    v_min_u32 v113, v113, v3
    v_mul_u32_u24 v3, 205, v1
    v_lshrrev_b32 v3, 10, v3
    v_mul_u32_u24 v2, 5, v3
    v_sub_u32 v115, v1, v2
    v_lshlrev_b32 v114, 2, v3
    s_lshl_b32 s81, s16, 10
    s_add_u32 s81, s81, 8192
    s_mul_i32 s80, s16, 6912
    v_lshl_add_u32 v121, v1, 2, s81
    v_lshrrev_b32 v3, 1, v1
    v_lshl_add_u32 v122, v3, 2, s81
    v_and_b32 v2, 1, v1
    v_lshlrev_b32 v123, 4, v2
    v_lshrrev_b32 v3, 1, v0
    v_mul_u32_u24 v3, 1280, v3
    v_add_u32 v124, v3, v2
    v_mul_u32_u24 v125, 48, v113
    s_lshl_b32 s26, s16, 2
    v_lshl_add_u32 v126, v115, 5, s26
    v_lshl_add_u32 v127, v1, 5, s80
    s_cmp_eq_u32 s16, 7
    s_cselect_b32 s54, 0, 1
    s_lshr_b32 s26, s17, 5
    s_mul_i32 s26, s26, 1218
    s_add_u32 s26, s26, s17
    s_lshl3_add_u32 s26, s26, s16
    s_lshl_b32 s26, s26, 7
    v_lshl_add_u32 v120, v1, 15, s26
    v_mov_b32 v80, 0xffffff
    v_mov_b32 v81, 0xffffff
    v_mov_b32 v82, 0xffffff
    v_mov_b32 v83, 0xffffff
    v_add_u32 v2, s81, v232
    ds_write_b128 v2, v[80:83]
    s_waitcnt lgkmcnt(0)
    s_barrier
    v_and_b32 v2, 1, v0
    v_max_u32 v3, s24, v235
    v_add_u32 v3, v3, v2
    s_add_u32 s27, s24, 216
    v_min_u32 v4, s27, v236
    v_add_u32 v5, v237, v3
    s_lshl_b32 s27, s24, 2
    s_sub_u32 s27, s81, s27
    v_lshl_add_u32 v6, v3, 2, s27
    v_sub_u32 v4, v4, v3
    s_branch L_exp
.section .rodata,"a"
.p2align 6
.amdhsa_kernel standalone__tensor_product_equiv_tfn__graph_kernel
.amdhsa_next_free_vgpr 250
.amdhsa_next_free_sgpr 100
.amdhsa_accum_offset 252
.amdhsa_group_segment_fixed_size 0
.amdhsa_kernarg_size 88
.amdhsa_user_sgpr_count 2
.amdhsa_user_sgpr_kernarg_segment_ptr 1
.amdhsa_system_sgpr_workgroup_id_x 1
.amdhsa_float_denorm_mode_32 3
.end_amdhsa_kernel
```
